```python
import torch

def _softmax(x, axis=-1):
    return torch.softmax(x, dim=axis)
def _gelu(x):
    return torch.nn.functional.gelu(x, approximate="tanh")
def _silu(x):
    return torch.nn.functional.silu(x)
def _sigmoid(x):
    return torch.sigmoid(x)
def _layernorm(x, axis=-1, eps=1e-5):
    m = x.mean(dim=axis, keepdim=True)
    v = x.var(dim=axis, keepdim=True, unbiased=False)
    return (x - m) / torch.sqrt(v + eps)
def _scatter_add(tgt, idx, src, axis=0):
    return tgt.clone().index_add_(axis, idx, src)
def _segment_sum(src, seg, n):
    out = torch.zeros((n,) + src.shape[1:], dtype=src.dtype)
    return out.index_add_(0, seg, src)
def _pad(x, pw):
    flat = tuple(v for pair in reversed(pw) for v in pair)
    return torch.nn.functional.pad(x, flat)

kernel_name = 'gated_mix__ssm_conv_s4__moe_arch_mod__prompt'

def setup_inputs():

    _w = (lambda a: (lambda t: t.to(torch.bfloat16) if t.is_floating_point() else t)(torch.as_tensor(a)))
    def _A_setup():
        B, L, D, N = 1, 2048, 576, 128
        A_re = -(lambda _x: torch.exp(torch.as_tensor(_x)))((lambda *s: torch.randn(*s, dtype=torch.bfloat16) * 3.2)(D, N))
        A_im = torch.pi * (lambda *s: torch.randn(*s, dtype=torch.bfloat16) * 0.05)(D, N)
        B_re = (lambda *s: torch.randn(*s, dtype=torch.bfloat16) * 0.2)(D, N)
        B_im = (lambda *s: torch.randn(*s, dtype=torch.bfloat16) * 0.2)(D, N)
        C_re = (lambda *s: torch.randn(*s, dtype=torch.bfloat16) * 0.2)(D, N)
        C_im = (lambda *s: torch.randn(*s, dtype=torch.bfloat16) * 0.2)(D, N)
        log_dt = (lambda *s: torch.randn(*s, dtype=torch.bfloat16) * 0.05)(D) * 0.5 - 4.0
        Dskip = (lambda *s: torch.randn(*s, dtype=torch.bfloat16) * 0.1)(D)
        return {
            "u": _w((lambda *s: torch.randn(*s, dtype=torch.bfloat16) * 0.05)(B, L, D)),
            "A_re": _w(A_re),
            "A_im": _w(A_im),
            "B_re": _w(B_re),
            "B_im": _w(B_im),
            "C_re": _w(C_re),
            "C_im": _w(C_im),
            "log_dt": _w(log_dt),
            "Dskip": _w(Dskip),
        }
    _A_in = _A_setup()

    def _B_setup():
        B, S, D, F, C = 1, 2048, 576, 4608, 8
        return {
            "x": _w((lambda *s: torch.randn(*s, dtype=torch.bfloat16) * 0.05)(B, S, D)),
            "w_r": _w((lambda *s: torch.randn(*s, dtype=torch.bfloat16) * 3.2)(D)),
            "w_gate": _w((lambda *s: torch.randn(*s, dtype=torch.bfloat16) * 0.1)(D, F)),
            "w_up": _w((lambda *s: torch.randn(*s, dtype=torch.bfloat16) * 0.1)(D, F)),
            "w_down": _w((lambda *s: torch.randn(*s, dtype=torch.bfloat16) * 0.1)(F, D)),
        }
    _B_in = _B_setup()

    return {
        "A_u": _A_in["u"],
        "A_A_re": _A_in["A_re"],
        "A_A_im": _A_in["A_im"],
        "A_B_re": _A_in["B_re"],
        "A_B_im": _A_in["B_im"],
        "A_C_re": _A_in["C_re"],
        "A_C_im": _A_in["C_im"],
        "A_log_dt": _A_in["log_dt"],
        "A_Dskip": _A_in["Dskip"],
        "B_x": _B_in["x"],
        "B_w_r": _B_in["w_r"],
        "B_w_gate": _B_in["w_gate"],
        "B_w_up": _B_in["w_up"],
        "B_w_down": _B_in["w_down"],
        "gate_w": _w((lambda *s: torch.randn(*s, dtype=torch.bfloat16) * 0.05)(576) * 16.0),
    }

def reference(A_u, A_A_re, A_A_im, A_B_re, A_B_im, A_C_re, A_C_im, A_log_dt, A_Dskip, B_x, B_w_r, B_w_gate, B_w_up, B_w_down, gate_w):
    def _A_ref(u, A_re, A_im, B_re, B_im, C_re, C_im, log_dt, Dskip):
        Bsz, L, D = u.shape
        dt = torch.exp(log_dt)[:, None]
        A = A_re + 1j * A_im
        Bc = B_re + 1j * B_im
        Cc = C_re + 1j * C_im
        logdA = dt * A
        dB = dt * Bc
        l = (lambda x, dt: x.to(dt))(torch.arange(L), A_re.dtype)
        P = torch.exp(logdA[:, :, None] * l[None, None, :])
        K = torch.einsum("dn,dnl,dn->dl", Cc, P, dB).real
        L2 = 2 * L
        Kp = _pad(K, ((0, 0), (0, L)))
        up = (lambda x, *d: x.permute(*d))(u, 0, 2, 1)
        up = _pad(up, ((0, 0), (0, 0), (0, L)))
        Kf = (lambda x, axes=(-2,-1): torch.fft.rfft2(x.float(), dim=axes))(Kp[:, None, :], axes=(-2, -1))
        Uf = (lambda x, axes=(-2,-1): torch.fft.rfft2(x.float(), dim=axes))(up[:, :, None, :], axes=(-2, -1))
        Yf = Uf * Kf[None, :, :, :]
        y = (lambda x, s, axes=(-2,-1): torch.fft.irfft2(x, s=s, dim=axes).to(torch.bfloat16))(Yf, (1, L2), axes=(-2, -1))[:, :, 0, :L]
        y = (lambda x, *d: x.permute(*d))(y, 0, 2, 1) + u * Dskip[None, None, :]
        return y

    def _B_ref(x, w_r, w_gate, w_up, w_down):
        B, S, D = x.shape
        C = 8
        r = x @ w_r
        idx = torch.argsort(-r, axis=-1)[:, :C]
        idx_e = (lambda x, n, axis: torch.repeat_interleave(x, n, dim=axis))(idx.reshape(B, C, 1), D, axis=2)
        x_sel = (lambda x, i, axis: torch.take_along_dim(x, i, dim=axis))(x, idx_e, axis=1)
        g = _silu(x_sel @ w_gate)
        u = x_sel @ w_up
        y = (g * u) @ w_down
        r_sel = _sigmoid((lambda x, i, axis: torch.take_along_dim(x, i, dim=axis))(r, idx, axis=1))
        y = y * r_sel.reshape(B, C, 1)
        b_off = (torch.arange(B) * S).reshape(B, 1)
        flat_idx = (idx + b_off).reshape(B * C)
        zero = (x * 0.0).reshape(B * S, D)
        upd = _scatter_add(zero, flat_idx, y.reshape(B * C, D), axis=0)
        return x + upd.reshape(B, S, D)

    x = A_u
    g = _sigmoid((x * gate_w).sum(-1, keepdims=True))
    a = _A_ref(x, A_A_re, A_A_im, A_B_re, A_B_im, A_C_re, A_C_im, A_log_dt, A_Dskip)
    b = _B_ref(x, B_w_r, B_w_gate, B_w_up, B_w_down)
    return g * a + (1 - g) * b
```

```asm
; @launch kernel=k1_kernel grid=(256,1,1) block=(768,1,1) lds=163840
.amdgcn_target "amdgcn-amd-amdhsa--gfx950"
.text
.p2align 8
.globl k1_kernel
.type k1_kernel,@function
k1_kernel:
    s_cmp_ge_u32 s2, 256
    s_cbranch_scc1 K_END
    v_lshrrev_b32 v1, 6, v0
    v_and_b32 v2, 63, v0
    v_readfirstlane_b32 s3, v1
    v_mov_b32 v1, 0
    s_cmp_lg_u32 s3, 7
    s_cbranch_scc1 K_NOZ
    v_lshlrev_b32 v3, 2, v2
    ds_write_b32 v3, v1
    s_waitcnt lgkmcnt(0)
K_NOZ:
    s_load_dwordx16 s[16:31], s[0:1], 0
    s_load_dwordx16 s[32:47], s[0:1], 64
    s_load_dwordx4 s[48:51], s[0:1], 128
    v_and_b32 v3, 15, v2
    v_lshrrev_b32 v4, 4, v2
    s_and_b32 s4, s2, 7
    s_lshr_b32 s5, s2, 3
    s_cmp_eq_u32 s3, 8
    s_cbranch_scc1 ROUTER
    s_cmp_lg_u32 s3, 10
    s_cbranch_scc1 K_NOCPF
    s_cmp_lg_u32 s5, 9
    s_cbranch_scc1 K_NOCPF
    s_getpc_b64 s[8:9]
    s_and_b32 s8, s8, 0xffffff00
    v_lshlrev_b32 v8, 7, v2
    v_add_u32 v9, 0, v8
    v_min_u32 v9, CODE_END-k1_kernel-4, v9
    global_load_dword v160, v9, s[8:9]
    v_add_u32 v9, 8192, v8
    v_min_u32 v9, CODE_END-k1_kernel-4, v9
    global_load_dword v161, v9, s[8:9]
    v_add_u32 v9, 16384, v8
    v_min_u32 v9, CODE_END-k1_kernel-4, v9
    global_load_dword v162, v9, s[8:9]
    v_add_u32 v9, 24576, v8
    v_min_u32 v9, CODE_END-k1_kernel-4, v9
    global_load_dword v163, v9, s[8:9]
K_NOCPF:
    s_cmp_ge_u32 s5, 14
    s_cbranch_scc1 K_CONV
    s_mul_i32 s7, s4, 9
    s_add_u32 s7, s7, s5
    s_mov_b32 s12, s3
    s_cmp_lt_u32 s3, 2
    s_cbranch_scc1 GATE
    s_cmp_ge_u32 s5, 9
    s_cbranch_scc1 HELPER
    s_cmp_lt_u32 s3, 8
    s_cbranch_scc1 F_COMP
    s_branch F_LOAD
K_CONV:
    s_mul_i32 s7, s4, 18
    s_add_u32 s7, s7, s5
    s_sub_u32 s7, s7, 14
    s_cmp_lt_u32 s3, 8
    s_cbranch_scc1 C_KGEN
    s_sub_u32 s12, s3, 9
    s_cmp_lt_u32 s3, 11
    s_cbranch_scc1 GATE
C_LOAD:
    s_setprio 3
    s_sub_u32 s12, s5, 14
    s_mul_i32 s12, s12, 57
    s_lshr_b32 s12, s12, 5
    v_mul_u32_u24 v5, 1152, v2
    s_lshl_b32 s13, s7, 3
    s_andn2_b32 s8, s13, 15
    v_add_u32 v6, s8, v5
    s_lshr_b32 s8, s13, 7
    s_lshl_b32 s9, s4, 1
    s_add_u32 s9, s9, 1
    s_sub_u32 s8, s9, s8
    s_lshl_b32 s8, s8, 7
    v_add_u32 v5, s8, v5
    s_waitcnt lgkmcnt(0)
    s_mov_b32 s52, s16
    s_mov_b32 s53, s17
    s_mov_b32 s54, 2359296
    s_mov_b32 s55, 0x20000
    s_barrier
    s_mul_i32 s15, s12, 73728
    s_lshl_b32 s14, s12, 10
    s_add_u32 m0, s14, 91520
    s_add_u32 s12, s12, 1
    buffer_load_dwordx4 v6, s[52:55], s15 offen lds
    buffer_load_dword v8, v5, s[52:55], s15 offen
    s_and_b32 s12, s12, 31
    s_mul_i32 s15, s12, 73728
    s_lshl_b32 s14, s12, 10
    s_add_u32 m0, s14, 91520
    s_add_u32 s12, s12, 1
    buffer_load_dwordx4 v6, s[52:55], s15 offen lds
    buffer_load_dword v9, v5, s[52:55], s15 offen
    s_and_b32 s12, s12, 31
    s_mul_i32 s15, s12, 73728
    s_lshl_b32 s14, s12, 10
    s_add_u32 m0, s14, 91520
    s_add_u32 s12, s12, 1
    buffer_load_dwordx4 v6, s[52:55], s15 offen lds
    s_and_b32 s12, s12, 31
    s_mul_i32 s15, s12, 73728
    s_lshl_b32 s14, s12, 10
    s_add_u32 m0, s14, 91520
    s_add_u32 s12, s12, 1
    buffer_load_dwordx4 v6, s[52:55], s15 offen lds
    s_and_b32 s12, s12, 31
    s_waitcnt vmcnt(3)
    s_mul_i32 s15, s12, 73728
    s_lshl_b32 s14, s12, 10
    s_add_u32 m0, s14, 91520
    s_add_u32 s12, s12, 1
    buffer_load_dwordx4 v6, s[52:55], s15 offen lds
    s_and_b32 s12, s12, 31
    s_waitcnt vmcnt(3)
    s_mul_i32 s15, s12, 73728
    s_lshl_b32 s14, s12, 10
    s_add_u32 m0, s14, 91520
    s_add_u32 s12, s12, 1
    buffer_load_dwordx4 v6, s[52:55], s15 offen lds
    s_and_b32 s12, s12, 31
    s_waitcnt vmcnt(3)
    s_mul_i32 s15, s12, 73728
    s_lshl_b32 s14, s12, 10
    s_add_u32 m0, s14, 91520
    s_add_u32 s12, s12, 1
    buffer_load_dwordx4 v6, s[52:55], s15 offen lds
    s_and_b32 s12, s12, 31
    s_waitcnt vmcnt(3)
    s_mul_i32 s15, s12, 73728
    s_lshl_b32 s14, s12, 10
    s_add_u32 m0, s14, 91520
    s_add_u32 s12, s12, 1
    buffer_load_dwordx4 v6, s[52:55], s15 offen lds
    s_and_b32 s12, s12, 31
    s_waitcnt vmcnt(3)
    s_mul_i32 s15, s12, 73728
    s_lshl_b32 s14, s12, 10
    s_add_u32 m0, s14, 91520
    s_add_u32 s12, s12, 1
    buffer_load_dwordx4 v6, s[52:55], s15 offen lds
    s_and_b32 s12, s12, 31
    s_waitcnt vmcnt(3)
    s_mul_i32 s15, s12, 73728
    s_lshl_b32 s14, s12, 10
    s_add_u32 m0, s14, 91520
    s_add_u32 s12, s12, 1
    buffer_load_dwordx4 v6, s[52:55], s15 offen lds
    s_and_b32 s12, s12, 31
    s_waitcnt vmcnt(3)
    s_mul_i32 s15, s12, 73728
    s_lshl_b32 s14, s12, 10
    s_add_u32 m0, s14, 91520
    s_add_u32 s12, s12, 1
    buffer_load_dwordx4 v6, s[52:55], s15 offen lds
    s_and_b32 s12, s12, 31
    s_waitcnt vmcnt(3)
    s_mul_i32 s15, s12, 73728
    s_lshl_b32 s14, s12, 10
    s_add_u32 m0, s14, 91520
    s_add_u32 s12, s12, 1
    buffer_load_dwordx4 v6, s[52:55], s15 offen lds
    s_and_b32 s12, s12, 31
    s_waitcnt vmcnt(3)
    s_mul_i32 s15, s12, 73728
    s_lshl_b32 s14, s12, 10
    s_add_u32 m0, s14, 91520
    s_add_u32 s12, s12, 1
    buffer_load_dwordx4 v6, s[52:55], s15 offen lds
    s_and_b32 s12, s12, 31
    s_waitcnt vmcnt(3)
    s_mul_i32 s15, s12, 73728
    s_lshl_b32 s14, s12, 10
    s_add_u32 m0, s14, 91520
    s_add_u32 s12, s12, 1
    buffer_load_dwordx4 v6, s[52:55], s15 offen lds
    s_and_b32 s12, s12, 31
    s_waitcnt vmcnt(3)
    s_mul_i32 s15, s12, 73728
    s_lshl_b32 s14, s12, 10
    s_add_u32 m0, s14, 91520
    s_add_u32 s12, s12, 1
    buffer_load_dwordx4 v6, s[52:55], s15 offen lds
    s_and_b32 s12, s12, 31
    s_waitcnt vmcnt(3)
    s_mul_i32 s15, s12, 73728
    s_lshl_b32 s14, s12, 10
    s_add_u32 m0, s14, 91520
    s_add_u32 s12, s12, 1
    buffer_load_dwordx4 v6, s[52:55], s15 offen lds
    s_and_b32 s12, s12, 31
    s_waitcnt vmcnt(3)
    s_mul_i32 s15, s12, 73728
    s_lshl_b32 s14, s12, 10
    s_add_u32 m0, s14, 91520
    s_add_u32 s12, s12, 1
    buffer_load_dwordx4 v6, s[52:55], s15 offen lds
    s_and_b32 s12, s12, 31
    s_waitcnt vmcnt(3)
    s_mul_i32 s15, s12, 73728
    s_lshl_b32 s14, s12, 10
    s_add_u32 m0, s14, 91520
    s_add_u32 s12, s12, 1
    buffer_load_dwordx4 v6, s[52:55], s15 offen lds
    s_and_b32 s12, s12, 31
    s_waitcnt vmcnt(3)
    s_mul_i32 s15, s12, 73728
    s_lshl_b32 s14, s12, 10
    s_add_u32 m0, s14, 91520
    s_add_u32 s12, s12, 1
    buffer_load_dwordx4 v6, s[52:55], s15 offen lds
    s_and_b32 s12, s12, 31
    s_waitcnt vmcnt(3)
    s_mul_i32 s15, s12, 73728
    s_lshl_b32 s14, s12, 10
    s_add_u32 m0, s14, 91520
    s_add_u32 s12, s12, 1
    buffer_load_dwordx4 v6, s[52:55], s15 offen lds
    s_and_b32 s12, s12, 31
    s_waitcnt vmcnt(3)
    s_mul_i32 s15, s12, 73728
    s_lshl_b32 s14, s12, 10
    s_add_u32 m0, s14, 91520
    s_add_u32 s12, s12, 1
    buffer_load_dwordx4 v6, s[52:55], s15 offen lds
    s_and_b32 s12, s12, 31
    s_waitcnt vmcnt(3)
    s_mul_i32 s15, s12, 73728
    s_lshl_b32 s14, s12, 10
    s_add_u32 m0, s14, 91520
    s_add_u32 s12, s12, 1
    buffer_load_dwordx4 v6, s[52:55], s15 offen lds
    s_and_b32 s12, s12, 31
    s_waitcnt vmcnt(3)
    s_mul_i32 s15, s12, 73728
    s_lshl_b32 s14, s12, 10
    s_add_u32 m0, s14, 91520
    s_add_u32 s12, s12, 1
    buffer_load_dwordx4 v6, s[52:55], s15 offen lds
    s_and_b32 s12, s12, 31
    s_waitcnt vmcnt(3)
    s_mul_i32 s15, s12, 73728
    s_lshl_b32 s14, s12, 10
    s_add_u32 m0, s14, 91520
    s_add_u32 s12, s12, 1
    buffer_load_dwordx4 v6, s[52:55], s15 offen lds
    s_and_b32 s12, s12, 31
    s_waitcnt vmcnt(3)
    s_mul_i32 s15, s12, 73728
    s_lshl_b32 s14, s12, 10
    s_add_u32 m0, s14, 91520
    s_add_u32 s12, s12, 1
    buffer_load_dwordx4 v6, s[52:55], s15 offen lds
    s_and_b32 s12, s12, 31
    s_waitcnt vmcnt(3)
    s_mul_i32 s15, s12, 73728
    s_lshl_b32 s14, s12, 10
    s_add_u32 m0, s14, 91520
    s_add_u32 s12, s12, 1
    buffer_load_dwordx4 v6, s[52:55], s15 offen lds
    s_and_b32 s12, s12, 31
    s_waitcnt vmcnt(3)
    s_mul_i32 s15, s12, 73728
    s_lshl_b32 s14, s12, 10
    s_add_u32 m0, s14, 91520
    s_add_u32 s12, s12, 1
    buffer_load_dwordx4 v6, s[52:55], s15 offen lds
    s_and_b32 s12, s12, 31
    s_waitcnt vmcnt(3)
    s_mul_i32 s15, s12, 73728
    s_lshl_b32 s14, s12, 10
    s_add_u32 m0, s14, 91520
    s_add_u32 s12, s12, 1
    buffer_load_dwordx4 v6, s[52:55], s15 offen lds
    s_and_b32 s12, s12, 31
    s_waitcnt vmcnt(3)
    s_mul_i32 s15, s12, 73728
    s_lshl_b32 s14, s12, 10
    s_add_u32 m0, s14, 91520
    s_add_u32 s12, s12, 1
    buffer_load_dwordx4 v6, s[52:55], s15 offen lds
    s_and_b32 s12, s12, 31
    s_waitcnt vmcnt(3)
    s_mul_i32 s15, s12, 73728
    s_lshl_b32 s14, s12, 10
    s_add_u32 m0, s14, 91520
    s_add_u32 s12, s12, 1
    buffer_load_dwordx4 v6, s[52:55], s15 offen lds
    s_and_b32 s12, s12, 31
    s_waitcnt vmcnt(3)
    s_mul_i32 s15, s12, 73728
    s_lshl_b32 s14, s12, 10
    s_add_u32 m0, s14, 91520
    s_add_u32 s12, s12, 1
    buffer_load_dwordx4 v6, s[52:55], s15 offen lds
    s_and_b32 s12, s12, 31
    s_waitcnt vmcnt(3)
    s_mul_i32 s15, s12, 73728
    s_lshl_b32 s14, s12, 10
    s_add_u32 m0, s14, 91520
    s_add_u32 s12, s12, 1
    buffer_load_dwordx4 v6, s[52:55], s15 offen lds
    s_and_b32 s12, s12, 31
C_IO:
    s_setprio 3
    s_mul_i32 s7, s4, 18
    s_add_u32 s7, s7, s5
    s_sub_u32 s7, s7, 14
    s_lshl_b32 s55, s7, 3
    s_sub_u32 s12, s3, 8
    s_load_dwordx2 s[58:59], s[32:33], s55
    s_mov_b32 s60, s46
    s_mov_b32 s61, s47
    s_mov_b32 s62, 2359296
    s_mov_b32 s63, 0x20000
    v_and_b32 v11, 1, v2
    v_lshlrev_b32 v11, 4, v11
    v_sub_u32 v11, 16, v11
    s_waitcnt lgkmcnt(0)
    s_lshl_b32 s64, s58, 16
    s_and_b32 s65, s58, 0xffff0000
    s_lshl_b32 s66, s59, 16
    s_and_b32 s67, s59, 0xffff0000
    s_mov_b32 s9, 0
SP_1:
    ds_read_b32 v10, v1 offset:8
    s_waitcnt lgkmcnt(0)
    v_readfirstlane_b32 s8, v10
    s_add_u32 s9, s9, 1
    s_cmp_lg_u32 s8, 0
    s_cbranch_scc1 SP_1_D
    s_cmp_lt_u32 s9, 524288
    s_cbranch_scc1 SP_1
SP_1_D:
    s_waitcnt vmcnt(0)
    s_barrier
    s_barrier
    s_barrier
    s_lshl_b32 s14, s12, 2
    s_lshl_b32 s8, s14, 6
    v_add_u32 v12, s8, v2
    v_lshrrev_b32 v13, 1, v12
    v_lshlrev_b32 v13, 3, v13
    v_add_u32 v13, 8192, v13
    s_and_b32 s8, s55, 8
    s_add_u32 s8, s8, 91520
    v_lshl_add_u32 v12, v12, 4, s8
    ds_read_b64 v[24:25], v12 offset:0
    ds_read_b64 v[26:27], v12 offset:1024
    ds_read_b64 v[28:29], v12 offset:2048
    ds_read_b64 v[30:31], v12 offset:3072
    s_mov_b32 s9, 0
GPI_2:
    global_load_dwordx2 v[16:17], v13, s[50:51] offset:0 sc1
    global_load_dwordx2 v[18:19], v13, s[50:51] offset:256 sc1
    global_load_dwordx2 v[20:21], v13, s[50:51] offset:512 sc1
    global_load_dwordx2 v[22:23], v13, s[50:51] offset:768 sc1
    s_waitcnt vmcnt(0) lgkmcnt(0)
    v_xor_b32 v14, v17, v10
    v_bitop3_b32 v14, v14, v19, v10 bitop3:0xf6
    v_bitop3_b32 v14, v14, v21, v10 bitop3:0xf6
    v_bitop3_b32 v14, v14, v23, v10 bitop3:0xf6
    v_cmp_ne_u32 vcc, 0, v14
    s_add_u32 s9, s9, 1
    s_cmp_eq_u64 vcc, 0
    s_cbranch_scc1 GPI_2_D
    s_sleep 2
    s_cmp_lt_u32 s9, 131072
    s_cbranch_scc1 GPI_2
GPI_2_D:
    v_lshlrev_b32 v48, v11, v16
    v_and_b32 v48, 0xffff0000, v48
    v_sub_f32 v36, 1.0, v48
    v_cvt_pk_bf16_f32 v36, v36, v36
    v_and_b32 v36, 0xffff0000, v36
    v_lshlrev_b32 v32, 16, v24
    v_and_b32 v33, 0xffff0000, v24
    v_lshlrev_b32 v34, 16, v25
    v_and_b32 v35, 0xffff0000, v25
    v_pk_mul_f32 v[40:41], v[32:33], s[64:65]
    v_pk_mul_f32 v[44:45], v[32:33], v[36:37] op_sel_hi:[1,0]
    v_pk_mul_f32 v[42:43], v[34:35], s[66:67]
    v_pk_mul_f32 v[46:47], v[34:35], v[36:37] op_sel_hi:[1,0]
    v_cvt_pk_bf16_f32 v41, v40, v41
    v_lshlrev_b32 v40, 16, v41
    v_and_b32 v41, 0xffff0000, v41
    v_cvt_pk_bf16_f32 v43, v42, v43
    v_lshlrev_b32 v42, 16, v43
    v_and_b32 v43, 0xffff0000, v43
    v_cvt_pk_bf16_f32 v45, v44, v45
    v_lshlrev_b32 v44, 16, v45
    v_and_b32 v45, 0xffff0000, v45
    v_cvt_pk_bf16_f32 v47, v46, v47
    v_lshlrev_b32 v46, 16, v47
    v_and_b32 v47, 0xffff0000, v47
    v_lshlrev_b32 v58, v11, v18
    v_and_b32 v58, 0xffff0000, v58
    v_sub_f32 v36, 1.0, v58
    v_cvt_pk_bf16_f32 v36, v36, v36
    v_and_b32 v36, 0xffff0000, v36
    v_lshlrev_b32 v32, 16, v26
    v_and_b32 v33, 0xffff0000, v26
    v_lshlrev_b32 v34, 16, v27
    v_and_b32 v35, 0xffff0000, v27
    v_pk_mul_f32 v[50:51], v[32:33], s[64:65]
    v_pk_mul_f32 v[54:55], v[32:33], v[36:37] op_sel_hi:[1,0]
    v_pk_mul_f32 v[52:53], v[34:35], s[66:67]
    v_pk_mul_f32 v[56:57], v[34:35], v[36:37] op_sel_hi:[1,0]
    v_cvt_pk_bf16_f32 v51, v50, v51
    v_lshlrev_b32 v50, 16, v51
    v_and_b32 v51, 0xffff0000, v51
    v_cvt_pk_bf16_f32 v53, v52, v53
    v_lshlrev_b32 v52, 16, v53
    v_and_b32 v53, 0xffff0000, v53
    v_cvt_pk_bf16_f32 v55, v54, v55
    v_lshlrev_b32 v54, 16, v55
    v_and_b32 v55, 0xffff0000, v55
    v_cvt_pk_bf16_f32 v57, v56, v57
    v_lshlrev_b32 v56, 16, v57
    v_and_b32 v57, 0xffff0000, v57
    v_lshlrev_b32 v68, v11, v20
    v_and_b32 v68, 0xffff0000, v68
    v_sub_f32 v36, 1.0, v68
    v_cvt_pk_bf16_f32 v36, v36, v36
    v_and_b32 v36, 0xffff0000, v36
    v_lshlrev_b32 v32, 16, v28
    v_and_b32 v33, 0xffff0000, v28
    v_lshlrev_b32 v34, 16, v29
    v_and_b32 v35, 0xffff0000, v29
    v_pk_mul_f32 v[60:61], v[32:33], s[64:65]
    v_pk_mul_f32 v[64:65], v[32:33], v[36:37] op_sel_hi:[1,0]
    v_pk_mul_f32 v[62:63], v[34:35], s[66:67]
    v_pk_mul_f32 v[66:67], v[34:35], v[36:37] op_sel_hi:[1,0]
    v_cvt_pk_bf16_f32 v61, v60, v61
    v_lshlrev_b32 v60, 16, v61
    v_and_b32 v61, 0xffff0000, v61
    v_cvt_pk_bf16_f32 v63, v62, v63
    v_lshlrev_b32 v62, 16, v63
    v_and_b32 v63, 0xffff0000, v63
    v_cvt_pk_bf16_f32 v65, v64, v65
    v_lshlrev_b32 v64, 16, v65
    v_and_b32 v65, 0xffff0000, v65
    v_cvt_pk_bf16_f32 v67, v66, v67
    v_lshlrev_b32 v66, 16, v67
    v_and_b32 v67, 0xffff0000, v67
    v_lshlrev_b32 v78, v11, v22
    v_and_b32 v78, 0xffff0000, v78
    v_sub_f32 v36, 1.0, v78
    v_cvt_pk_bf16_f32 v36, v36, v36
    v_and_b32 v36, 0xffff0000, v36
    v_lshlrev_b32 v32, 16, v30
    v_and_b32 v33, 0xffff0000, v30
    v_lshlrev_b32 v34, 16, v31
    v_and_b32 v35, 0xffff0000, v31
    v_pk_mul_f32 v[70:71], v[32:33], s[64:65]
    v_pk_mul_f32 v[74:75], v[32:33], v[36:37] op_sel_hi:[1,0]
    v_pk_mul_f32 v[72:73], v[34:35], s[66:67]
    v_pk_mul_f32 v[76:77], v[34:35], v[36:37] op_sel_hi:[1,0]
    v_cvt_pk_bf16_f32 v71, v70, v71
    v_lshlrev_b32 v70, 16, v71
    v_and_b32 v71, 0xffff0000, v71
    v_cvt_pk_bf16_f32 v73, v72, v73
    v_lshlrev_b32 v72, 16, v73
    v_and_b32 v73, 0xffff0000, v73
    v_cvt_pk_bf16_f32 v75, v74, v75
    v_lshlrev_b32 v74, 16, v75
    v_and_b32 v75, 0xffff0000, v75
    v_cvt_pk_bf16_f32 v77, v76, v77
    v_lshlrev_b32 v76, 16, v77
    v_and_b32 v77, 0xffff0000, v77
    s_lshl_b32 s14, s12, 2
    v_bfe_u32 v12, v2, 2, 2
    v_mul_u32_u24 v12, 4160, v12
    v_and_b32 v13, 3, v2
    v_lshl_add_u32 v13, v4, 2, v13
    v_lshl_add_u32 v12, v13, 3, v12
    s_lshl_b32 s8, s14, 7
    v_add_u32 v12, s8, v12
    s_lshl_b32 s8, s14, 9
    v_lshl_add_u32 v13, v2, 3, s8
    v_mul_u32_u24 v14, 1152, v2
    v_add_u32 v14, s55, v14
    s_mul_i32 s15, s14, 73728
    s_mov_b32 s9, 0
SP_3:
    ds_read_b32 v15, v1 offset:32
    s_waitcnt lgkmcnt(0)
    v_readfirstlane_b32 s8, v15
    s_add_u32 s9, s9, 1
    s_cmp_ge_u32 s8, 4
    s_cbranch_scc1 SP_3_D
    s_sleep 1
    s_cmp_lt_u32 s9, 524288
    s_cbranch_scc1 SP_3
SP_3_D:
    ds_read_b64_tr_b16 v[16:17], v12 offset:256
    ds_read_b64_tr_b16 v[18:19], v12 offset:384
    ds_read_b64_tr_b16 v[20:21], v12 offset:512
    ds_read_b64_tr_b16 v[22:23], v12 offset:640
    s_waitcnt lgkmcnt(3)
    v_lshlrev_b32 v32, 16, v16
    v_and_b32 v33, 0xffff0000, v16
    v_lshlrev_b32 v34, 16, v17
    v_and_b32 v35, 0xffff0000, v17
    v_pk_add_f32 v[32:33], v[32:33], v[40:41]
    v_pk_add_f32 v[34:35], v[34:35], v[42:43]
    v_cvt_pk_bf16_f32 v16, v32, v33
    v_cvt_pk_bf16_f32 v17, v34, v35
    v_lshlrev_b32 v32, 16, v16
    v_and_b32 v33, 0xffff0000, v16
    v_lshlrev_b32 v34, 16, v17
    v_and_b32 v35, 0xffff0000, v17
    v_pk_mul_f32 v[32:33], v[32:33], v[48:49] op_sel_hi:[1,0]
    v_pk_mul_f32 v[34:35], v[34:35], v[48:49] op_sel_hi:[1,0]
    v_cvt_pk_bf16_f32 v16, v32, v33
    v_cvt_pk_bf16_f32 v17, v34, v35
    v_lshlrev_b32 v32, 16, v16
    v_and_b32 v33, 0xffff0000, v16
    v_lshlrev_b32 v34, 16, v17
    v_and_b32 v35, 0xffff0000, v17
    v_pk_add_f32 v[32:33], v[32:33], v[44:45]
    v_pk_add_f32 v[34:35], v[34:35], v[46:47]
    v_cvt_pk_bf16_f32 v40, v32, v33
    v_cvt_pk_bf16_f32 v41, v34, v35
    buffer_store_dwordx2 v[40:41], v14, s[60:63], s15 offen
    s_add_u32 s15, s15, 73728
    s_waitcnt lgkmcnt(2)
    v_lshlrev_b32 v32, 16, v18
    v_and_b32 v33, 0xffff0000, v18
    v_lshlrev_b32 v34, 16, v19
    v_and_b32 v35, 0xffff0000, v19
    v_pk_add_f32 v[32:33], v[32:33], v[50:51]
    v_pk_add_f32 v[34:35], v[34:35], v[52:53]
    v_cvt_pk_bf16_f32 v18, v32, v33
    v_cvt_pk_bf16_f32 v19, v34, v35
    v_lshlrev_b32 v32, 16, v18
    v_and_b32 v33, 0xffff0000, v18
    v_lshlrev_b32 v34, 16, v19
    v_and_b32 v35, 0xffff0000, v19
    v_pk_mul_f32 v[32:33], v[32:33], v[58:59] op_sel_hi:[1,0]
    v_pk_mul_f32 v[34:35], v[34:35], v[58:59] op_sel_hi:[1,0]
    v_cvt_pk_bf16_f32 v18, v32, v33
    v_cvt_pk_bf16_f32 v19, v34, v35
    v_lshlrev_b32 v32, 16, v18
    v_and_b32 v33, 0xffff0000, v18
    v_lshlrev_b32 v34, 16, v19
    v_and_b32 v35, 0xffff0000, v19
    v_pk_add_f32 v[32:33], v[32:33], v[54:55]
    v_pk_add_f32 v[34:35], v[34:35], v[56:57]
    v_cvt_pk_bf16_f32 v50, v32, v33
    v_cvt_pk_bf16_f32 v51, v34, v35
    buffer_store_dwordx2 v[50:51], v14, s[60:63], s15 offen
    s_add_u32 s15, s15, 73728
    s_waitcnt lgkmcnt(1)
    v_lshlrev_b32 v32, 16, v20
    v_and_b32 v33, 0xffff0000, v20
    v_lshlrev_b32 v34, 16, v21
    v_and_b32 v35, 0xffff0000, v21
    v_pk_add_f32 v[32:33], v[32:33], v[60:61]
    v_pk_add_f32 v[34:35], v[34:35], v[62:63]
    v_cvt_pk_bf16_f32 v20, v32, v33
    v_cvt_pk_bf16_f32 v21, v34, v35
    v_lshlrev_b32 v32, 16, v20
    v_and_b32 v33, 0xffff0000, v20
    v_lshlrev_b32 v34, 16, v21
    v_and_b32 v35, 0xffff0000, v21
    v_pk_mul_f32 v[32:33], v[32:33], v[68:69] op_sel_hi:[1,0]
    v_pk_mul_f32 v[34:35], v[34:35], v[68:69] op_sel_hi:[1,0]
    v_cvt_pk_bf16_f32 v20, v32, v33
    v_cvt_pk_bf16_f32 v21, v34, v35
    v_lshlrev_b32 v32, 16, v20
    v_and_b32 v33, 0xffff0000, v20
    v_lshlrev_b32 v34, 16, v21
    v_and_b32 v35, 0xffff0000, v21
    v_pk_add_f32 v[32:33], v[32:33], v[64:65]
    v_pk_add_f32 v[34:35], v[34:35], v[66:67]
    v_cvt_pk_bf16_f32 v60, v32, v33
    v_cvt_pk_bf16_f32 v61, v34, v35
    buffer_store_dwordx2 v[60:61], v14, s[60:63], s15 offen
    s_add_u32 s15, s15, 73728
    s_waitcnt lgkmcnt(0)
    v_lshlrev_b32 v32, 16, v22
    v_and_b32 v33, 0xffff0000, v22
    v_lshlrev_b32 v34, 16, v23
    v_and_b32 v35, 0xffff0000, v23
    v_pk_add_f32 v[32:33], v[32:33], v[70:71]
    v_pk_add_f32 v[34:35], v[34:35], v[72:73]
    v_cvt_pk_bf16_f32 v22, v32, v33
    v_cvt_pk_bf16_f32 v23, v34, v35
    v_lshlrev_b32 v32, 16, v22
    v_and_b32 v33, 0xffff0000, v22
    v_lshlrev_b32 v34, 16, v23
    v_and_b32 v35, 0xffff0000, v23
    v_pk_mul_f32 v[32:33], v[32:33], v[78:79] op_sel_hi:[1,0]
    v_pk_mul_f32 v[34:35], v[34:35], v[78:79] op_sel_hi:[1,0]
    v_cvt_pk_bf16_f32 v22, v32, v33
    v_cvt_pk_bf16_f32 v23, v34, v35
    v_lshlrev_b32 v32, 16, v22
    v_and_b32 v33, 0xffff0000, v22
    v_lshlrev_b32 v34, 16, v23
    v_and_b32 v35, 0xffff0000, v23
    v_pk_add_f32 v[32:33], v[32:33], v[74:75]
    v_pk_add_f32 v[34:35], v[34:35], v[76:77]
    v_cvt_pk_bf16_f32 v70, v32, v33
    v_cvt_pk_bf16_f32 v71, v34, v35
    buffer_store_dwordx2 v[70:71], v14, s[60:63], s15 offen
    s_add_u32 s15, s15, 73728
    ds_write_b64 v13, v[16:17] offset:16896
    ds_write_b64 v13, v[18:19] offset:17408
    ds_write_b64 v13, v[20:21] offset:17920
    ds_write_b64 v13, v[22:23] offset:18432
    s_waitcnt lgkmcnt(0)
    s_lshl_b32 s14, s12, 1
    s_add_u32 s14, s14, 16
    s_lshl_b32 s8, s14, 6
    v_add_u32 v12, s8, v2
    v_lshrrev_b32 v13, 1, v12
    v_lshlrev_b32 v13, 3, v13
    v_add_u32 v13, 8192, v13
    s_and_b32 s8, s55, 8
    s_add_u32 s8, s8, 91520
    v_lshl_add_u32 v12, v12, 4, s8
    ds_read_b64 v[24:25], v12 offset:0
    ds_read_b64 v[26:27], v12 offset:1024
    s_mov_b32 s9, 0
GPJ_4:
    global_load_dwordx2 v[16:17], v13, s[50:51] offset:0 sc1
    global_load_dwordx2 v[18:19], v13, s[50:51] offset:256 sc1
    s_waitcnt vmcnt(0) lgkmcnt(0)
    v_xor_b32 v14, v17, v10
    v_bitop3_b32 v14, v14, v19, v10 bitop3:0xf6
    v_cmp_ne_u32 vcc, 0, v14
    s_add_u32 s9, s9, 1
    s_cmp_eq_u64 vcc, 0
    s_cbranch_scc1 GPJ_4_D
    s_sleep 2
    s_cmp_lt_u32 s9, 131072
    s_cbranch_scc1 GPJ_4
GPJ_4_D:
    v_lshlrev_b32 v88, v11, v16
    v_and_b32 v88, 0xffff0000, v88
    v_sub_f32 v36, 1.0, v88
    v_cvt_pk_bf16_f32 v36, v36, v36
    v_and_b32 v36, 0xffff0000, v36
    v_lshlrev_b32 v32, 16, v24
    v_and_b32 v33, 0xffff0000, v24
    v_lshlrev_b32 v34, 16, v25
    v_and_b32 v35, 0xffff0000, v25
    v_pk_mul_f32 v[80:81], v[32:33], s[64:65]
    v_pk_mul_f32 v[84:85], v[32:33], v[36:37] op_sel_hi:[1,0]
    v_pk_mul_f32 v[82:83], v[34:35], s[66:67]
    v_pk_mul_f32 v[86:87], v[34:35], v[36:37] op_sel_hi:[1,0]
    v_cvt_pk_bf16_f32 v81, v80, v81
    v_lshlrev_b32 v80, 16, v81
    v_and_b32 v81, 0xffff0000, v81
    v_cvt_pk_bf16_f32 v83, v82, v83
    v_lshlrev_b32 v82, 16, v83
    v_and_b32 v83, 0xffff0000, v83
    v_cvt_pk_bf16_f32 v85, v84, v85
    v_lshlrev_b32 v84, 16, v85
    v_and_b32 v85, 0xffff0000, v85
    v_cvt_pk_bf16_f32 v87, v86, v87
    v_lshlrev_b32 v86, 16, v87
    v_and_b32 v87, 0xffff0000, v87
    v_lshlrev_b32 v98, v11, v18
    v_and_b32 v98, 0xffff0000, v98
    v_sub_f32 v36, 1.0, v98
    v_cvt_pk_bf16_f32 v36, v36, v36
    v_and_b32 v36, 0xffff0000, v36
    v_lshlrev_b32 v32, 16, v26
    v_and_b32 v33, 0xffff0000, v26
    v_lshlrev_b32 v34, 16, v27
    v_and_b32 v35, 0xffff0000, v27
    v_pk_mul_f32 v[90:91], v[32:33], s[64:65]
    v_pk_mul_f32 v[94:95], v[32:33], v[36:37] op_sel_hi:[1,0]
    v_pk_mul_f32 v[92:93], v[34:35], s[66:67]
    v_pk_mul_f32 v[96:97], v[34:35], v[36:37] op_sel_hi:[1,0]
    v_cvt_pk_bf16_f32 v91, v90, v91
    v_lshlrev_b32 v90, 16, v91
    v_and_b32 v91, 0xffff0000, v91
    v_cvt_pk_bf16_f32 v93, v92, v93
    v_lshlrev_b32 v92, 16, v93
    v_and_b32 v93, 0xffff0000, v93
    v_cvt_pk_bf16_f32 v95, v94, v95
    v_lshlrev_b32 v94, 16, v95
    v_and_b32 v95, 0xffff0000, v95
    v_cvt_pk_bf16_f32 v97, v96, v97
    v_lshlrev_b32 v96, 16, v97
    v_and_b32 v97, 0xffff0000, v97
    s_cmp_eq_u32 s3, 11
    s_cbranch_scc1 C_FIN
    v_bfe_u32 v12, v2, 2, 2
    v_mul_u32_u24 v12, 4160, v12
    v_and_b32 v13, 3, v2
    v_lshl_add_u32 v13, v4, 2, v13
    v_lshl_add_u32 v12, v13, 3, v12
    s_lshl_b32 s8, s14, 7
    v_add_u32 v12, s8, v12
    s_lshl_b32 s8, s14, 9
    v_lshl_add_u32 v13, v2, 3, s8
    v_mul_u32_u24 v14, 1152, v2
    v_add_u32 v14, s55, v14
    s_mul_i32 s15, s14, 73728
    s_mov_b32 s9, 0
SP_5:
    ds_read_b32 v15, v1 offset:36
    s_waitcnt lgkmcnt(0)
    v_readfirstlane_b32 s8, v15
    s_add_u32 s9, s9, 1
    s_cmp_ge_u32 s8, 4
    s_cbranch_scc1 SP_5_D
    s_cmp_lt_u32 s9, 524288
    s_cbranch_scc1 SP_5
SP_5_D:
    ds_read_b64_tr_b16 v[16:17], v12 offset:256
    ds_read_b64_tr_b16 v[18:19], v12 offset:384
    s_waitcnt lgkmcnt(1)
    v_lshlrev_b32 v32, 16, v16
    v_and_b32 v33, 0xffff0000, v16
    v_lshlrev_b32 v34, 16, v17
    v_and_b32 v35, 0xffff0000, v17
    v_pk_add_f32 v[32:33], v[32:33], v[80:81]
    v_pk_add_f32 v[34:35], v[34:35], v[82:83]
    v_cvt_pk_bf16_f32 v16, v32, v33
    v_cvt_pk_bf16_f32 v17, v34, v35
    v_lshlrev_b32 v32, 16, v16
    v_and_b32 v33, 0xffff0000, v16
    v_lshlrev_b32 v34, 16, v17
    v_and_b32 v35, 0xffff0000, v17
    v_pk_mul_f32 v[32:33], v[32:33], v[88:89] op_sel_hi:[1,0]
    v_pk_mul_f32 v[34:35], v[34:35], v[88:89] op_sel_hi:[1,0]
    v_cvt_pk_bf16_f32 v16, v32, v33
    v_cvt_pk_bf16_f32 v17, v34, v35
    v_lshlrev_b32 v32, 16, v16
    v_and_b32 v33, 0xffff0000, v16
    v_lshlrev_b32 v34, 16, v17
    v_and_b32 v35, 0xffff0000, v17
    v_pk_add_f32 v[32:33], v[32:33], v[84:85]
    v_pk_add_f32 v[34:35], v[34:35], v[86:87]
    v_cvt_pk_bf16_f32 v80, v32, v33
    v_cvt_pk_bf16_f32 v81, v34, v35
    buffer_store_dwordx2 v[80:81], v14, s[60:63], s15 offen
    s_add_u32 s15, s15, 73728
    s_waitcnt lgkmcnt(0)
    v_lshlrev_b32 v32, 16, v18
    v_and_b32 v33, 0xffff0000, v18
    v_lshlrev_b32 v34, 16, v19
    v_and_b32 v35, 0xffff0000, v19
    v_pk_add_f32 v[32:33], v[32:33], v[90:91]
    v_pk_add_f32 v[34:35], v[34:35], v[92:93]
    v_cvt_pk_bf16_f32 v18, v32, v33
    v_cvt_pk_bf16_f32 v19, v34, v35
    v_lshlrev_b32 v32, 16, v18
    v_and_b32 v33, 0xffff0000, v18
    v_lshlrev_b32 v34, 16, v19
    v_and_b32 v35, 0xffff0000, v19
    v_pk_mul_f32 v[32:33], v[32:33], v[98:99] op_sel_hi:[1,0]
    v_pk_mul_f32 v[34:35], v[34:35], v[98:99] op_sel_hi:[1,0]
    v_cvt_pk_bf16_f32 v18, v32, v33
    v_cvt_pk_bf16_f32 v19, v34, v35
    v_lshlrev_b32 v32, 16, v18
    v_and_b32 v33, 0xffff0000, v18
    v_lshlrev_b32 v34, 16, v19
    v_and_b32 v35, 0xffff0000, v19
    v_pk_add_f32 v[32:33], v[32:33], v[94:95]
    v_pk_add_f32 v[34:35], v[34:35], v[96:97]
    v_cvt_pk_bf16_f32 v90, v32, v33
    v_cvt_pk_bf16_f32 v91, v34, v35
    buffer_store_dwordx2 v[90:91], v14, s[60:63], s15 offen
    s_add_u32 s15, s15, 73728
    ds_write_b64 v13, v[16:17] offset:16896
    ds_write_b64 v13, v[18:19] offset:17408
    s_waitcnt lgkmcnt(0)
    s_waitcnt vmcnt(0)
    v_mov_b32 v8, 1
    s_mov_b64 exec, 1
    ds_add_u32 v1, v8 offset:40
    s_mov_b64 exec, -1
    s_endpgm
C_FIN:
    v_and_b32 v5, 7, v2
    v_lshlrev_b32 v5, 3, v5
    v_add_u32 v5, 16384, v5
    s_mov_b32 s9, 0
C_SPOLL:
    global_load_dwordx2 v[16:17], v5, s[50:51] sc1
    s_waitcnt vmcnt(0)
    v_cmp_ne_u32 vcc, v17, v10
    s_add_u32 s9, s9, 1
    s_cmp_eq_u64 vcc, 0
    s_cbranch_scc1 C_SOK
    s_sleep 4
    s_cmp_lt_u32 s9, 131072
    s_cbranch_scc1 C_SPOLL
C_SOK:
    v_and_b32 v18, 0x7ff, v16
    v_sub_u32 v18, 2047, v18
    v_lshrrev_b32 v19, 1, v18
    v_lshlrev_b32 v19, 3, v19
    v_add_u32 v19, 8192, v19
    s_mov_b32 s9, 0
C_G2POLL:
    global_load_dwordx2 v[22:23], v19, s[50:51] sc1
    s_waitcnt vmcnt(0)
    v_cmp_ne_u32 vcc, v23, v10
    s_add_u32 s9, s9, 1
    s_cmp_eq_u64 vcc, 0
    s_cbranch_scc1 C_G2OK
    s_cmp_lt_u32 s9, 131072
    s_cbranch_scc1 C_G2POLL
C_G2OK:
    v_and_b32 v19, 1, v4
    v_lshrrev_b32 v20, 1, v4
    v_lshl_or_b32 v19, v19, 1, v20
    v_lshlrev_b32 v19, 1, v19
    s_and_b32 s8, s55, 8
    s_add_u32 s8, s8, 91520
    v_lshl_add_u32 v23, v18, 4, v19
    v_add_u32 v23, s8, v23
    ds_read_u16 v105, v23
    v_and_b32 v20, 0xffff0000, v16
    v_ashrrev_i32 v21, 31, v20
    v_not_b32 v21, v21
    v_or_b32 v21, 0x80000000, v21
    v_and_b32 v21, 0xffff0000, v21
    v_xor_b32 v20, v20, v21
    v_mul_f32 v21, 0xbfb8aa3b, v20
    v_exp_f32 v21, v21
    s_nop 0
    v_add_f32 v21, 1.0, v21
    v_rcp_f32 v104, v21
    s_nop 0
    v_cvt_pk_bf16_f32 v104, v104, v104
    v_and_b32 v104, 0xffff0000, v104
    v_and_b32 v21, 1, v18
    v_lshlrev_b32 v21, 4, v21
    v_sub_u32 v21, 16, v21
    v_lshlrev_b32 v22, v21, v22
    v_and_b32 v22, 0xffff0000, v22
    v_sub_f32 v106, 1.0, v22
    v_cvt_pk_bf16_f32 v106, v106, v106
    v_and_b32 v106, 0xffff0000, v106
    v_lshl_add_u32 v107, v18, 3, v19
    v_mul_u32_u24 v108, 1152, v18
    v_add3_u32 v108, v108, v19, s55
    s_mul_i32 s8, s7, 9216
    s_add_u32 s8, s8, 32768
    v_lshl_add_u32 v5, v2, 4, s8
    v_add_u32 v6, 0x1000, v5
    v_add_u32 v7, 0x2000, v5
    v_lshrrev_b32 v110, 0, v10
    v_lshrrev_b32 v111, 8, v10
    v_lshrrev_b32 v112, 16, v10
    v_lshrrev_b32 v113, 24, v10
    s_waitcnt lgkmcnt(0)
    v_lshlrev_b32 v105, 16, v105
    v_bfe_u32 v12, v2, 2, 2
    v_mul_u32_u24 v12, 4160, v12
    v_and_b32 v13, 3, v2
    v_lshl_add_u32 v13, v4, 2, v13
    v_lshl_add_u32 v12, v13, 3, v12
    s_lshl_b32 s8, s14, 7
    v_add_u32 v12, s8, v12
    s_lshl_b32 s8, s14, 9
    v_lshl_add_u32 v13, v2, 3, s8
    v_mul_u32_u24 v14, 1152, v2
    v_add_u32 v14, s55, v14
    s_mul_i32 s15, s14, 73728
    s_mov_b32 s9, 0
SP_6:
    ds_read_b32 v15, v1 offset:36
    s_waitcnt lgkmcnt(0)
    v_readfirstlane_b32 s8, v15
    s_add_u32 s9, s9, 1
    s_cmp_ge_u32 s8, 4
    s_cbranch_scc1 SP_6_D
    s_cmp_lt_u32 s9, 524288
    s_cbranch_scc1 SP_6
SP_6_D:
    ds_read_b64_tr_b16 v[16:17], v12 offset:256
    ds_read_b64_tr_b16 v[18:19], v12 offset:384
    s_waitcnt lgkmcnt(1)
    v_lshlrev_b32 v32, 16, v16
    v_and_b32 v33, 0xffff0000, v16
    v_lshlrev_b32 v34, 16, v17
    v_and_b32 v35, 0xffff0000, v17
    v_pk_add_f32 v[32:33], v[32:33], v[80:81]
    v_pk_add_f32 v[34:35], v[34:35], v[82:83]
    v_cvt_pk_bf16_f32 v16, v32, v33
    v_cvt_pk_bf16_f32 v17, v34, v35
    v_lshlrev_b32 v32, 16, v16
    v_and_b32 v33, 0xffff0000, v16
    v_lshlrev_b32 v34, 16, v17
    v_and_b32 v35, 0xffff0000, v17
    v_pk_mul_f32 v[32:33], v[32:33], v[88:89] op_sel_hi:[1,0]
    v_pk_mul_f32 v[34:35], v[34:35], v[88:89] op_sel_hi:[1,0]
    v_cvt_pk_bf16_f32 v16, v32, v33
    v_cvt_pk_bf16_f32 v17, v34, v35
    v_lshlrev_b32 v32, 16, v16
    v_and_b32 v33, 0xffff0000, v16
    v_lshlrev_b32 v34, 16, v17
    v_and_b32 v35, 0xffff0000, v17
    v_pk_add_f32 v[32:33], v[32:33], v[84:85]
    v_pk_add_f32 v[34:35], v[34:35], v[86:87]
    v_cvt_pk_bf16_f32 v80, v32, v33
    v_cvt_pk_bf16_f32 v81, v34, v35
    buffer_store_dwordx2 v[80:81], v14, s[60:63], s15 offen
    s_add_u32 s15, s15, 73728
    s_waitcnt lgkmcnt(0)
    v_lshlrev_b32 v32, 16, v18
    v_and_b32 v33, 0xffff0000, v18
    v_lshlrev_b32 v34, 16, v19
    v_and_b32 v35, 0xffff0000, v19
    v_pk_add_f32 v[32:33], v[32:33], v[90:91]
    v_pk_add_f32 v[34:35], v[34:35], v[92:93]
    v_cvt_pk_bf16_f32 v18, v32, v33
    v_cvt_pk_bf16_f32 v19, v34, v35
    v_lshlrev_b32 v32, 16, v18
    v_and_b32 v33, 0xffff0000, v18
    v_lshlrev_b32 v34, 16, v19
    v_and_b32 v35, 0xffff0000, v19
    v_pk_mul_f32 v[32:33], v[32:33], v[98:99] op_sel_hi:[1,0]
    v_pk_mul_f32 v[34:35], v[34:35], v[98:99] op_sel_hi:[1,0]
    v_cvt_pk_bf16_f32 v18, v32, v33
    v_cvt_pk_bf16_f32 v19, v34, v35
    v_lshlrev_b32 v32, 16, v18
    v_and_b32 v33, 0xffff0000, v18
    v_lshlrev_b32 v34, 16, v19
    v_and_b32 v35, 0xffff0000, v19
    v_pk_add_f32 v[32:33], v[32:33], v[94:95]
    v_pk_add_f32 v[34:35], v[34:35], v[96:97]
    v_cvt_pk_bf16_f32 v90, v32, v33
    v_cvt_pk_bf16_f32 v91, v34, v35
    buffer_store_dwordx2 v[90:91], v14, s[60:63], s15 offen
    s_add_u32 s15, s15, 73728
    ds_write_b64 v13, v[16:17] offset:16896
    ds_write_b64 v13, v[18:19] offset:17408
    s_waitcnt lgkmcnt(0)
    s_mov_b32 s9, 0
C_MPOLL:
    global_load_dwordx4 v[120:123], v5, s[50:51] offset:0 sc1
    global_load_dwordx4 v[124:127], v5, s[50:51] offset:1024 sc1
    global_load_dwordx4 v[128:131], v5, s[50:51] offset:2048 sc1
    global_load_dwordx4 v[132:135], v5, s[50:51] offset:3072 sc1
    global_load_dwordx4 v[136:139], v6, s[50:51] offset:0 sc1
    global_load_dwordx4 v[140:143], v6, s[50:51] offset:1024 sc1
    global_load_dwordx4 v[144:147], v6, s[50:51] offset:2048 sc1
    global_load_dwordx4 v[148:151], v6, s[50:51] offset:3072 sc1
    global_load_dwordx4 v[152:155], v7, s[50:51] offset:0 sc1
    s_waitcnt vmcnt(8)
    v_xor_b32 v26, v120, v10
    v_bitop3_b32 v26, v26, v121, v111 bitop3:0xf6
    v_bitop3_b32 v26, v26, v122, v112 bitop3:0xf6
    v_bitop3_b32 v26, v26, v123, v113 bitop3:0xf6
    s_waitcnt vmcnt(7)
    v_bitop3_b32 v26, v26, v124, v110 bitop3:0xf6
    v_bitop3_b32 v26, v26, v125, v111 bitop3:0xf6
    v_bitop3_b32 v26, v26, v126, v112 bitop3:0xf6
    v_bitop3_b32 v26, v26, v127, v113 bitop3:0xf6
    v_pk_add_f32 v[28:29], v[120:121], v[124:125]
    v_pk_add_f32 v[30:31], v[122:123], v[126:127]
    s_waitcnt vmcnt(6)
    v_bitop3_b32 v26, v26, v128, v110 bitop3:0xf6
    v_bitop3_b32 v26, v26, v129, v111 bitop3:0xf6
    v_bitop3_b32 v26, v26, v130, v112 bitop3:0xf6
    v_bitop3_b32 v26, v26, v131, v113 bitop3:0xf6
    v_pk_add_f32 v[28:29], v[28:29], v[128:129]
    v_pk_add_f32 v[30:31], v[30:31], v[130:131]
    s_waitcnt vmcnt(5)
    v_bitop3_b32 v26, v26, v132, v110 bitop3:0xf6
    v_bitop3_b32 v26, v26, v133, v111 bitop3:0xf6
    v_bitop3_b32 v26, v26, v134, v112 bitop3:0xf6
    v_bitop3_b32 v26, v26, v135, v113 bitop3:0xf6
    v_pk_add_f32 v[28:29], v[28:29], v[132:133]
    v_pk_add_f32 v[30:31], v[30:31], v[134:135]
    s_waitcnt vmcnt(4)
    v_bitop3_b32 v26, v26, v136, v110 bitop3:0xf6
    v_bitop3_b32 v26, v26, v137, v111 bitop3:0xf6
    v_bitop3_b32 v26, v26, v138, v112 bitop3:0xf6
    v_bitop3_b32 v26, v26, v139, v113 bitop3:0xf6
    v_pk_add_f32 v[28:29], v[28:29], v[136:137]
    v_pk_add_f32 v[30:31], v[30:31], v[138:139]
    s_waitcnt vmcnt(3)
    v_bitop3_b32 v26, v26, v140, v110 bitop3:0xf6
    v_bitop3_b32 v26, v26, v141, v111 bitop3:0xf6
    v_bitop3_b32 v26, v26, v142, v112 bitop3:0xf6
    v_bitop3_b32 v26, v26, v143, v113 bitop3:0xf6
    v_pk_add_f32 v[28:29], v[28:29], v[140:141]
    v_pk_add_f32 v[30:31], v[30:31], v[142:143]
    s_waitcnt vmcnt(2)
    v_bitop3_b32 v26, v26, v144, v110 bitop3:0xf6
    v_bitop3_b32 v26, v26, v145, v111 bitop3:0xf6
    v_bitop3_b32 v26, v26, v146, v112 bitop3:0xf6
    v_bitop3_b32 v26, v26, v147, v113 bitop3:0xf6
    v_pk_add_f32 v[28:29], v[28:29], v[144:145]
    v_pk_add_f32 v[30:31], v[30:31], v[146:147]
    s_waitcnt vmcnt(1)
    v_bitop3_b32 v26, v26, v148, v110 bitop3:0xf6
    v_bitop3_b32 v26, v26, v149, v111 bitop3:0xf6
    v_bitop3_b32 v26, v26, v150, v112 bitop3:0xf6
    v_bitop3_b32 v26, v26, v151, v113 bitop3:0xf6
    v_pk_add_f32 v[28:29], v[28:29], v[148:149]
    v_pk_add_f32 v[30:31], v[30:31], v[150:151]
    s_waitcnt vmcnt(0)
    v_bitop3_b32 v26, v26, v152, v110 bitop3:0xf6
    v_bitop3_b32 v26, v26, v153, v111 bitop3:0xf6
    v_bitop3_b32 v26, v26, v154, v112 bitop3:0xf6
    v_bitop3_b32 v26, v26, v155, v113 bitop3:0xf6
    v_pk_add_f32 v[28:29], v[28:29], v[152:153]
    v_pk_add_f32 v[30:31], v[30:31], v[154:155]
    v_and_b32 v26, 0xff, v26
    v_cmp_ne_u32 vcc, 0, v26
    s_add_u32 s9, s9, 1
    s_cmp_eq_u64 vcc, 0
    s_cbranch_scc1 C_MOK
    s_cmp_lt_u32 s9, 131072
    s_cbranch_scc1 C_MPOLL
C_MOK:
    v_permlane32_swap_b32 v28, v29
    v_permlane32_swap_b32 v30, v31
    v_add_f32 v28, v28, v29
    v_add_f32 v30, v30, v31
    s_nop 1
    v_permlane16_swap_b32 v28, v30
    v_add_f32 v28, v28, v30
    s_nop 1
    v_add_f32_dpp v28, v28, v28 row_ror:8 row_mask:0xf bank_mask:0xf
    v_cvt_pk_bf16_f32 v28, v28, v28
    v_and_b32 v28, 0xffff0000, v28
    v_mul_f32 v28, v28, v104
    v_cvt_pk_bf16_f32 v28, v28, v28
    v_and_b32 v28, 0xffff0000, v28
    v_add_f32 v28, v28, v105
    v_cvt_pk_bf16_f32 v28, v28, v28
    v_and_b32 v28, 0xffff0000, v28
    v_mul_f32 v28, v28, v106
    v_cvt_pk_bf16_f32 v28, v28, v28
    v_and_b32 v28, 0xffff0000, v28
    s_mov_b32 s9, 0
SP_7:
    ds_read_b32 v27, v1 offset:40
    s_waitcnt lgkmcnt(0)
    v_readfirstlane_b32 s8, v27
    s_add_u32 s9, s9, 1
    s_cmp_ge_u32 s8, 7
    s_cbranch_scc1 SP_7_D
    s_cmp_lt_u32 s9, 524288
    s_cbranch_scc1 SP_7
SP_7_D:
    ds_read_u16 v24, v107 offset:16896
    s_waitcnt lgkmcnt(0)
    v_lshlrev_b32 v24, 16, v24
    v_add_f32 v28, v28, v24
    v_cvt_pk_bf16_f32 v28, v28, v28
    s_mov_b32 exec_lo, 0x00ff00ff
    s_mov_b32 exec_hi, 0x00ff00ff
    global_store_short v108, v28, s[46:47]
    s_mov_b64 exec, -1
    s_endpgm
ROUTER:
    s_setprio 3
    v_lshrrev_b32 v5, 3, v2
    v_and_b32 v6, 7, v2
    v_lshlrev_b32 v9, 4, v6
    v_mul_u32_u24 v8, 1152, v5
    s_mul_i32 s8, s2, 9216
    v_add3_u32 v8, v8, v9, s8
    v_lshlrev_b32 v7, 4, v2
    v_min_u32 v10, 7, v2
    v_lshlrev_b32 v10, 4, v10
    s_mov_b32 m0, 147712
    s_waitcnt lgkmcnt(0)
    s_load_dword s10, s[50:51], 16640
    global_load_lds_dwordx4 v8, s[16:17] offset:0
    s_mov_b32 m0, 148608
    s_nop 0
    global_load_lds_dwordx4 v8, s[16:17] offset:128
    s_mov_b32 m0, 149504
    s_nop 0
    global_load_lds_dwordx4 v8, s[16:17] offset:256
    s_mov_b32 m0, 150400
    s_nop 0
    global_load_lds_dwordx4 v8, s[16:17] offset:384
    s_mov_b32 m0, 151296
    s_nop 0
    global_load_lds_dwordx4 v8, s[16:17] offset:512
    s_mov_b32 m0, 152192
    s_nop 0
    global_load_lds_dwordx4 v8, s[16:17] offset:640
    s_mov_b32 m0, 153088
    s_nop 0
    global_load_lds_dwordx4 v8, s[16:17] offset:768
    s_mov_b32 m0, 153984
    s_nop 0
    global_load_lds_dwordx4 v8, s[16:17] offset:896
    s_mov_b32 m0, 154880
    s_nop 0
    global_load_lds_dwordx4 v8, s[16:17] offset:1024
    s_mov_b32 m0, 158080
    s_nop 0
    global_load_lds_dwordx4 v7, s[44:45]
    global_load_lds_dwordx4 v10, s[44:45] offset:1024
    global_load_dwordx4 v[52:55], v9, s[36:37] offset:0
    global_load_dwordx4 v[56:59], v9, s[36:37] offset:128
    global_load_dwordx4 v[60:63], v9, s[36:37] offset:256
    global_load_dwordx4 v[64:67], v9, s[36:37] offset:384
    global_load_dwordx4 v[68:71], v9, s[36:37] offset:512
    global_load_dwordx4 v[72:75], v9, s[36:37] offset:640
    global_load_dwordx4 v[76:79], v9, s[36:37] offset:768
    global_load_dwordx4 v[80:83], v9, s[36:37] offset:896
    global_load_dwordx4 v[84:87], v9, s[36:37] offset:1024
    s_barrier
    v_add_u32 v7, 147712, v7
    s_lshl_b32 s8, s2, 5
    v_lshl_add_u32 v15, v4, 3, s8
    s_mov_b32 s11, 0xffff
    v_mov_b32 v8, 0
    v_mov_b32 v9, 0
    v_mov_b32 v10, 0
    v_mov_b32 v11, 0
    s_waitcnt lgkmcnt(0)
    s_add_u32 s10, s10, 1
    s_addc_u32 s10, s10, 0
    v_mov_b32 v14, s10
    v_mov_b32 v13, s10
    s_waitcnt vmcnt(9)
    ds_read_b128 v[16:19], v7 offset:0
    ds_read_b128 v[20:23], v7 offset:1024
    ds_read_b128 v[24:27], v7 offset:2048
    ds_read_b128 v[28:31], v7 offset:3072
    ds_read_b128 v[32:35], v7 offset:4096
    ds_read_b128 v[36:39], v7 offset:5120
    ds_read_b128 v[40:43], v7 offset:6144
    ds_read_b128 v[44:47], v7 offset:7168
    ds_read_b128 v[48:51], v7 offset:8192
    ds_write_b32 v1, v14 offset:8
    s_waitcnt vmcnt(8) lgkmcnt(9)
    v_dot2c_f32_bf16 v8, v16, v52
    v_dot2c_f32_bf16 v9, v17, v53
    v_dot2c_f32_bf16 v10, v18, v54
    v_dot2c_f32_bf16 v11, v19, v55
    s_waitcnt vmcnt(7) lgkmcnt(8)
    v_dot2c_f32_bf16 v8, v20, v56
    v_dot2c_f32_bf16 v9, v21, v57
    v_dot2c_f32_bf16 v10, v22, v58
    v_dot2c_f32_bf16 v11, v23, v59
    s_waitcnt vmcnt(6) lgkmcnt(7)
    v_dot2c_f32_bf16 v8, v24, v60
    v_dot2c_f32_bf16 v9, v25, v61
    v_dot2c_f32_bf16 v10, v26, v62
    v_dot2c_f32_bf16 v11, v27, v63
    s_waitcnt vmcnt(5) lgkmcnt(6)
    v_dot2c_f32_bf16 v8, v28, v64
    v_dot2c_f32_bf16 v9, v29, v65
    v_dot2c_f32_bf16 v10, v30, v66
    v_dot2c_f32_bf16 v11, v31, v67
    s_waitcnt vmcnt(4) lgkmcnt(5)
    v_dot2c_f32_bf16 v8, v32, v68
    v_dot2c_f32_bf16 v9, v33, v69
    v_dot2c_f32_bf16 v10, v34, v70
    v_dot2c_f32_bf16 v11, v35, v71
    s_waitcnt vmcnt(3) lgkmcnt(4)
    v_dot2c_f32_bf16 v8, v36, v72
    v_dot2c_f32_bf16 v9, v37, v73
    v_dot2c_f32_bf16 v10, v38, v74
    v_dot2c_f32_bf16 v11, v39, v75
    s_waitcnt vmcnt(2) lgkmcnt(3)
    v_dot2c_f32_bf16 v8, v40, v76
    v_dot2c_f32_bf16 v9, v41, v77
    v_dot2c_f32_bf16 v10, v42, v78
    v_dot2c_f32_bf16 v11, v43, v79
    s_waitcnt vmcnt(1) lgkmcnt(2)
    v_dot2c_f32_bf16 v8, v44, v80
    v_dot2c_f32_bf16 v9, v45, v81
    v_dot2c_f32_bf16 v10, v46, v82
    v_dot2c_f32_bf16 v11, v47, v83
    s_waitcnt vmcnt(0) lgkmcnt(1)
    v_dot2c_f32_bf16 v8, v48, v84
    v_dot2c_f32_bf16 v9, v49, v85
    v_dot2c_f32_bf16 v10, v50, v86
    v_dot2c_f32_bf16 v11, v51, v87
    s_nop 0
    v_add_f32 v8, v8, v9
    s_nop 0
    v_add_f32 v10, v10, v11
    v_add_f32 v8, v8, v10
    s_nop 1
    v_add_f32_dpp v8, v8, v8 quad_perm:[1,0,3,2] row_mask:0xf bank_mask:0xf
    s_nop 1
    v_add_f32_dpp v8, v8, v8 quad_perm:[2,3,0,1] row_mask:0xf bank_mask:0xf
    s_nop 1
    v_add_f32_dpp v8, v8, v8 row_half_mirror row_mask:0xf bank_mask:0xf
    v_cvt_pk_bf16_f32 v8, v8, v8
    v_ashrrev_i32 v9, 31, v8
    v_or_b32 v9, 0x80008000, v9
    v_xor_b32 v8, v8, v9
    s_nop 1
    v_mov_b32_dpp v9, v8 row_ror:8 row_mask:0xf bank_mask:0xf
    s_mov_b32 exec_lo, 0x00010001
    s_mov_b32 exec_hi, 0x00010001
    v_bfi_b32 v12, s11, v8, v9
    global_store_dwordx2 v15, v[12:13], s[50:51] sc1
    s_mov_b64 exec, -1
    ds_write_b32 v1, v14 offset:0
    s_cmp_ge_u32 s5, 14
    s_cbranch_scc1 C_IO
    s_cmp_lt_u32 s5, 9
    s_cbranch_scc1 SELECT
    s_endpgm
GATE:
    v_lshlrev_b32 v6, 3, v2
    s_lshl_b32 s8, s12, 9
    s_add_u32 s8, s8, 147712
    v_add_u32 v5, s8, v6
    v_lshlrev_b32 v6, 3, v3
    v_add_u32 v6, 158080, v6
    s_lshl_b32 s8, s2, 1
    s_add_u32 s8, s8, s12
    v_mov_b32 v8, 0
    v_mov_b32 v9, 0
    v_mov_b32 v10, 0x3f803f80
    s_lshl_b32 s8, s8, 4
    s_add_u32 s8, s8, 8192
    v_lshrrev_b32 v7, 5, v2
    v_lshl_add_u32 v7, v7, 3, s8
    s_barrier
    s_mov_b32 s9, 0
SP_8:
    ds_read_b32 v13, v1 offset:8
    s_waitcnt lgkmcnt(0)
    v_readfirstlane_b32 s8, v13
    s_add_u32 s9, s9, 1
    s_cmp_lg_u32 s8, 0
    s_cbranch_scc1 SP_8_D
    s_sleep 1
    s_cmp_lt_u32 s9, 524288
    s_cbranch_scc1 SP_8
SP_8_D:
    ds_read_b64 v[16:17], v5 offset:0
    ds_read_b64 v[34:35], v6 offset:0
    ds_read_b64 v[18:19], v5 offset:1024
    ds_read_b64 v[36:37], v6 offset:128
    ds_read_b64 v[20:21], v5 offset:2048
    ds_read_b64 v[38:39], v6 offset:256
    ds_read_b64 v[22:23], v5 offset:3072
    ds_read_b64 v[40:41], v6 offset:384
    ds_read_b64 v[24:25], v5 offset:4096
    ds_read_b64 v[42:43], v6 offset:512
    ds_read_b64 v[26:27], v5 offset:5120
    ds_read_b64 v[44:45], v6 offset:640
    ds_read_b64 v[28:29], v5 offset:6144
    ds_read_b64 v[46:47], v6 offset:768
    ds_read_b64 v[30:31], v5 offset:7168
    ds_read_b64 v[48:49], v6 offset:896
    ds_read_b64 v[32:33], v5 offset:8192
    ds_read_b64 v[50:51], v6 offset:1024
    s_waitcnt lgkmcnt(15)
    v_lshlrev_b32 v52, 16, v16
    v_and_b32 v53, 0xffff0000, v16
    v_lshlrev_b32 v54, 16, v34
    v_and_b32 v55, 0xffff0000, v34
    v_mul_f32 v52, v52, v54
    v_mul_f32 v53, v53, v55
    v_cvt_pk_bf16_f32 v52, v52, v53
    v_dot2c_f32_bf16 v8, v52, v10
    v_lshlrev_b32 v56, 16, v17
    v_and_b32 v57, 0xffff0000, v17
    v_lshlrev_b32 v58, 16, v35
    v_and_b32 v59, 0xffff0000, v35
    v_mul_f32 v56, v56, v58
    v_mul_f32 v57, v57, v59
    v_cvt_pk_bf16_f32 v56, v56, v57
    v_dot2c_f32_bf16 v9, v56, v10
    v_lshlrev_b32 v52, 16, v18
    v_and_b32 v53, 0xffff0000, v18
    s_waitcnt lgkmcnt(14)
    v_lshlrev_b32 v54, 16, v36
    v_and_b32 v55, 0xffff0000, v36
    v_mul_f32 v52, v52, v54
    v_mul_f32 v53, v53, v55
    v_cvt_pk_bf16_f32 v52, v52, v53
    v_dot2c_f32_bf16 v8, v52, v10
    v_lshlrev_b32 v56, 16, v19
    v_and_b32 v57, 0xffff0000, v19
    v_lshlrev_b32 v58, 16, v37
    v_and_b32 v59, 0xffff0000, v37
    v_mul_f32 v56, v56, v58
    v_mul_f32 v57, v57, v59
    v_cvt_pk_bf16_f32 v56, v56, v57
    v_dot2c_f32_bf16 v9, v56, v10
    s_waitcnt lgkmcnt(13)
    v_lshlrev_b32 v52, 16, v20
    v_and_b32 v53, 0xffff0000, v20
    s_waitcnt lgkmcnt(12)
    v_lshlrev_b32 v54, 16, v38
    v_and_b32 v55, 0xffff0000, v38
    v_mul_f32 v52, v52, v54
    v_mul_f32 v53, v53, v55
    v_cvt_pk_bf16_f32 v52, v52, v53
    v_dot2c_f32_bf16 v8, v52, v10
    v_lshlrev_b32 v56, 16, v21
    v_and_b32 v57, 0xffff0000, v21
    v_lshlrev_b32 v58, 16, v39
    v_and_b32 v59, 0xffff0000, v39
    v_mul_f32 v56, v56, v58
    v_mul_f32 v57, v57, v59
    v_cvt_pk_bf16_f32 v56, v56, v57
    v_dot2c_f32_bf16 v9, v56, v10
    s_waitcnt lgkmcnt(11)
    v_lshlrev_b32 v52, 16, v22
    v_and_b32 v53, 0xffff0000, v22
    s_waitcnt lgkmcnt(10)
    v_lshlrev_b32 v54, 16, v40
    v_and_b32 v55, 0xffff0000, v40
    v_mul_f32 v52, v52, v54
    v_mul_f32 v53, v53, v55
    v_cvt_pk_bf16_f32 v52, v52, v53
    v_dot2c_f32_bf16 v8, v52, v10
    v_lshlrev_b32 v56, 16, v23
    v_and_b32 v57, 0xffff0000, v23
    v_lshlrev_b32 v58, 16, v41
    v_and_b32 v59, 0xffff0000, v41
    v_mul_f32 v56, v56, v58
    v_mul_f32 v57, v57, v59
    v_cvt_pk_bf16_f32 v56, v56, v57
    v_dot2c_f32_bf16 v9, v56, v10
    s_waitcnt lgkmcnt(9)
    v_lshlrev_b32 v52, 16, v24
    v_and_b32 v53, 0xffff0000, v24
    s_waitcnt lgkmcnt(8)
    v_lshlrev_b32 v54, 16, v42
    v_and_b32 v55, 0xffff0000, v42
    v_mul_f32 v52, v52, v54
    v_mul_f32 v53, v53, v55
    v_cvt_pk_bf16_f32 v52, v52, v53
    v_dot2c_f32_bf16 v8, v52, v10
    v_lshlrev_b32 v56, 16, v25
    v_and_b32 v57, 0xffff0000, v25
    v_lshlrev_b32 v58, 16, v43
    v_and_b32 v59, 0xffff0000, v43
    v_mul_f32 v56, v56, v58
    v_mul_f32 v57, v57, v59
    v_cvt_pk_bf16_f32 v56, v56, v57
    v_dot2c_f32_bf16 v9, v56, v10
    s_waitcnt lgkmcnt(7)
    v_lshlrev_b32 v52, 16, v26
    v_and_b32 v53, 0xffff0000, v26
    s_waitcnt lgkmcnt(6)
    v_lshlrev_b32 v54, 16, v44
    v_and_b32 v55, 0xffff0000, v44
    v_mul_f32 v52, v52, v54
    v_mul_f32 v53, v53, v55
    v_cvt_pk_bf16_f32 v52, v52, v53
    v_dot2c_f32_bf16 v8, v52, v10
    v_lshlrev_b32 v56, 16, v27
    v_and_b32 v57, 0xffff0000, v27
    v_lshlrev_b32 v58, 16, v45
    v_and_b32 v59, 0xffff0000, v45
    v_mul_f32 v56, v56, v58
    v_mul_f32 v57, v57, v59
    v_cvt_pk_bf16_f32 v56, v56, v57
    v_dot2c_f32_bf16 v9, v56, v10
    s_waitcnt lgkmcnt(5)
    v_lshlrev_b32 v52, 16, v28
    v_and_b32 v53, 0xffff0000, v28
    s_waitcnt lgkmcnt(4)
    v_lshlrev_b32 v54, 16, v46
    v_and_b32 v55, 0xffff0000, v46
    v_mul_f32 v52, v52, v54
    v_mul_f32 v53, v53, v55
    v_cvt_pk_bf16_f32 v52, v52, v53
    v_dot2c_f32_bf16 v8, v52, v10
    v_lshlrev_b32 v56, 16, v29
    v_and_b32 v57, 0xffff0000, v29
    v_lshlrev_b32 v58, 16, v47
    v_and_b32 v59, 0xffff0000, v47
    v_mul_f32 v56, v56, v58
    v_mul_f32 v57, v57, v59
    v_cvt_pk_bf16_f32 v56, v56, v57
    v_dot2c_f32_bf16 v9, v56, v10
    s_waitcnt lgkmcnt(3)
    v_lshlrev_b32 v52, 16, v30
    v_and_b32 v53, 0xffff0000, v30
    s_waitcnt lgkmcnt(2)
    v_lshlrev_b32 v54, 16, v48
    v_and_b32 v55, 0xffff0000, v48
    v_mul_f32 v52, v52, v54
    v_mul_f32 v53, v53, v55
    v_cvt_pk_bf16_f32 v52, v52, v53
    v_dot2c_f32_bf16 v8, v52, v10
    v_lshlrev_b32 v56, 16, v31
    v_and_b32 v57, 0xffff0000, v31
    v_lshlrev_b32 v58, 16, v49
    v_and_b32 v59, 0xffff0000, v49
    v_mul_f32 v56, v56, v58
    v_mul_f32 v57, v57, v59
    v_cvt_pk_bf16_f32 v56, v56, v57
    v_dot2c_f32_bf16 v9, v56, v10
    s_waitcnt lgkmcnt(1)
    v_lshlrev_b32 v52, 16, v32
    v_and_b32 v53, 0xffff0000, v32
    s_waitcnt lgkmcnt(0)
    v_lshlrev_b32 v54, 16, v50
    v_and_b32 v55, 0xffff0000, v50
    v_mul_f32 v52, v52, v54
    v_mul_f32 v53, v53, v55
    v_cvt_pk_bf16_f32 v52, v52, v53
    v_dot2c_f32_bf16 v8, v52, v10
    v_lshlrev_b32 v56, 16, v33
    v_and_b32 v57, 0xffff0000, v33
    v_lshlrev_b32 v58, 16, v51
    v_and_b32 v59, 0xffff0000, v51
    v_mul_f32 v56, v56, v58
    v_mul_f32 v57, v57, v59
    v_cvt_pk_bf16_f32 v56, v56, v57
    v_dot2c_f32_bf16 v9, v56, v10
    v_mov_b32 v11, 1
    s_mov_b64 exec, 1
    ds_add_u32 v1, v11 offset:12
    s_mov_b64 exec, -1
    v_add_f32 v8, v8, v9
    s_nop 1
    v_add_f32_dpp v8, v8, v8 row_ror:8 row_mask:0xf bank_mask:0xf
    s_nop 1
    v_add_f32_dpp v8, v8, v8 row_ror:4 row_mask:0xf bank_mask:0xf
    s_nop 1
    v_add_f32_dpp v8, v8, v8 row_ror:2 row_mask:0xf bank_mask:0xf
    s_nop 1
    v_add_f32_dpp v8, v8, v8 row_ror:1 row_mask:0xf bank_mask:0xf
    v_cvt_pk_bf16_f32 v8, v8, v8
    v_and_b32 v8, 0xffff0000, v8
    v_mul_f32 v9, 0xbfb8aa3b, v8
    v_exp_f32 v9, v9
    s_nop 0
    v_add_f32 v9, 1.0, v9
    v_rcp_f32 v8, v9
    s_nop 0
    v_cvt_pk_bf16_f32 v8, v8, v8
    s_mov_b32 s11, 0xffff
    s_nop 0
    v_mov_b32_dpp v9, v8 row_bcast:15 row_mask:0xa bank_mask:0xf
    v_bfi_b32 v12, s11, v9, v8
    s_mov_b32 exec_lo, 0x00010000
    s_mov_b32 exec_hi, 0x00010000
    global_store_dwordx2 v7, v[12:13], s[50:51] sc1
    s_mov_b64 exec, -1
    s_cmp_lt_u32 s5, 9
    s_cbranch_scc1 F_COMP2
    s_cmp_ge_u32 s5, 14
    s_cbranch_scc1 C_IO
    s_endpgm
SELECT:
    s_mov_b32 s52, s16
    s_mov_b32 s53, s17
    s_mov_b32 s54, 2359296
    s_mov_b32 s55, 0x20000
    v_lshlrev_b32 v7, 4, v2
    v_add_u32 v15, 0x1000, v7
    v_lshlrev_b32 v8, 2, v2
    v_sub_u32 v8, 2047, v8
    v_subrev_u32 v48, 0, v8
    v_subrev_u32 v49, 1, v8
    v_subrev_u32 v50, 2, v8
    v_subrev_u32 v51, 3, v8
    v_subrev_u32 v52, 256, v8
    v_subrev_u32 v53, 257, v8
    v_subrev_u32 v54, 258, v8
    v_subrev_u32 v55, 259, v8
    v_subrev_u32 v56, 512, v8
    v_subrev_u32 v57, 513, v8
    v_subrev_u32 v58, 514, v8
    v_subrev_u32 v59, 515, v8
    v_subrev_u32 v60, 768, v8
    v_subrev_u32 v61, 769, v8
    v_subrev_u32 v62, 770, v8
    v_subrev_u32 v63, 771, v8
    v_subrev_u32 v64, 1024, v8
    v_subrev_u32 v65, 1025, v8
    v_subrev_u32 v66, 1026, v8
    v_subrev_u32 v67, 1027, v8
    v_subrev_u32 v68, 1280, v8
    v_subrev_u32 v69, 1281, v8
    v_subrev_u32 v70, 1282, v8
    v_subrev_u32 v71, 1283, v8
    v_subrev_u32 v72, 1536, v8
    v_subrev_u32 v73, 1537, v8
    v_subrev_u32 v74, 1538, v8
    v_subrev_u32 v75, 1539, v8
    v_subrev_u32 v76, 1792, v8
    v_subrev_u32 v77, 1793, v8
    v_subrev_u32 v78, 1794, v8
    v_subrev_u32 v79, 1795, v8
    v_lshrrev_b32 v9, 3, v2
    v_and_b32 v9, 6, v9
    v_xor_b32 v9, v9, v2
    v_and_b32 v9, 7, v9
    v_lshlrev_b32 v5, 4, v9
    v_mov_b32 v12, 0
    v_mov_b32 v6, 0
    s_mov_b32 s11, 0xffff0000
    s_mov_b32 s9, 0
SP_9:
    ds_read_b32 v13, v1 offset:12
    s_waitcnt lgkmcnt(0)
    v_readfirstlane_b32 s8, v13
    s_add_u32 s9, s9, 1
    s_cmp_ge_u32 s8, 2
    s_cbranch_scc1 SP_9_D
    s_cmp_lt_u32 s9, 524288
    s_cbranch_scc1 SP_9
SP_9_D:
    s_mov_b32 s9, 0
    s_waitcnt vmcnt(0)
SEL_POLL:
    global_load_dwordx4 v[16:19], v7, s[50:51] offset:0 sc1
    global_load_dwordx4 v[20:23], v7, s[50:51] offset:1024 sc1
    global_load_dwordx4 v[24:27], v7, s[50:51] offset:2048 sc1
    global_load_dwordx4 v[28:31], v7, s[50:51] offset:3072 sc1
    global_load_dwordx4 v[32:35], v15, s[50:51] offset:0 sc1
    global_load_dwordx4 v[36:39], v15, s[50:51] offset:1024 sc1
    global_load_dwordx4 v[40:43], v15, s[50:51] offset:2048 sc1
    global_load_dwordx4 v[44:47], v15, s[50:51] offset:3072 sc1
    s_waitcnt vmcnt(7)
    v_xor_b32 v13, v17, v14
    v_bitop3_b32 v13, v13, v19, v14 bitop3:0xf6
    s_waitcnt vmcnt(6)
    v_bitop3_b32 v13, v13, v21, v14 bitop3:0xf6
    v_bitop3_b32 v13, v13, v23, v14 bitop3:0xf6
    s_waitcnt vmcnt(5)
    v_bitop3_b32 v13, v13, v25, v14 bitop3:0xf6
    v_bitop3_b32 v13, v13, v27, v14 bitop3:0xf6
    s_waitcnt vmcnt(4)
    v_bitop3_b32 v13, v13, v29, v14 bitop3:0xf6
    v_bitop3_b32 v13, v13, v31, v14 bitop3:0xf6
    s_waitcnt vmcnt(3)
    v_bitop3_b32 v13, v13, v33, v14 bitop3:0xf6
    v_bitop3_b32 v13, v13, v35, v14 bitop3:0xf6
    s_waitcnt vmcnt(2)
    v_bitop3_b32 v13, v13, v37, v14 bitop3:0xf6
    v_bitop3_b32 v13, v13, v39, v14 bitop3:0xf6
    s_waitcnt vmcnt(1)
    v_bitop3_b32 v13, v13, v41, v14 bitop3:0xf6
    v_bitop3_b32 v13, v13, v43, v14 bitop3:0xf6
    s_waitcnt vmcnt(0)
    v_bitop3_b32 v13, v13, v45, v14 bitop3:0xf6
    v_bitop3_b32 v13, v13, v47, v14 bitop3:0xf6
    v_cmp_ne_u32 vcc, 0, v13
    s_add_u32 s9, s9, 1
    s_cmp_eq_u64 vcc, 0
    s_cbranch_scc1 SEL_GOT
    s_cmp_lt_u32 s9, 131072
    s_cbranch_scc1 SEL_POLL
SEL_GOT:
    v_lshl_or_b32 v80, v16, 16, v48
    v_and_or_b32 v81, v16, s11, v49
    v_lshl_or_b32 v82, v18, 16, v50
    v_and_or_b32 v83, v18, s11, v51
    v_min_u32 v9, v80, v81
    v_max_u32 v8, v80, v81
    v_med3_u32 v9, v8, v9, v82
    v_max_u32 v8, v8, v82
    v_med3_u32 v9, v8, v9, v83
    v_max_u32 v8, v8, v83
    v_lshl_or_b32 v84, v20, 16, v52
    v_and_or_b32 v85, v20, s11, v53
    v_lshl_or_b32 v86, v22, 16, v54
    v_and_or_b32 v87, v22, s11, v55
    v_med3_u32 v9, v8, v9, v84
    v_max_u32 v8, v8, v84
    v_med3_u32 v9, v8, v9, v85
    v_max_u32 v8, v8, v85
    v_med3_u32 v9, v8, v9, v86
    v_max_u32 v8, v8, v86
    v_med3_u32 v9, v8, v9, v87
    v_max_u32 v8, v8, v87
    v_lshl_or_b32 v88, v24, 16, v56
    v_and_or_b32 v89, v24, s11, v57
    v_lshl_or_b32 v90, v26, 16, v58
    v_and_or_b32 v91, v26, s11, v59
    v_med3_u32 v9, v8, v9, v88
    v_max_u32 v8, v8, v88
    v_med3_u32 v9, v8, v9, v89
    v_max_u32 v8, v8, v89
    v_med3_u32 v9, v8, v9, v90
    v_max_u32 v8, v8, v90
    v_med3_u32 v9, v8, v9, v91
    v_max_u32 v8, v8, v91
    v_lshl_or_b32 v92, v28, 16, v60
    v_and_or_b32 v93, v28, s11, v61
    v_lshl_or_b32 v94, v30, 16, v62
    v_and_or_b32 v95, v30, s11, v63
    v_med3_u32 v9, v8, v9, v92
    v_max_u32 v8, v8, v92
    v_med3_u32 v9, v8, v9, v93
    v_max_u32 v8, v8, v93
    v_med3_u32 v9, v8, v9, v94
    v_max_u32 v8, v8, v94
    v_med3_u32 v9, v8, v9, v95
    v_max_u32 v8, v8, v95
    v_lshl_or_b32 v96, v32, 16, v64
    v_and_or_b32 v97, v32, s11, v65
    v_lshl_or_b32 v98, v34, 16, v66
    v_and_or_b32 v99, v34, s11, v67
    v_med3_u32 v9, v8, v9, v96
    v_max_u32 v8, v8, v96
    v_med3_u32 v9, v8, v9, v97
    v_max_u32 v8, v8, v97
    v_med3_u32 v9, v8, v9, v98
    v_max_u32 v8, v8, v98
    v_med3_u32 v9, v8, v9, v99
    v_max_u32 v8, v8, v99
    v_lshl_or_b32 v100, v36, 16, v68
    v_and_or_b32 v101, v36, s11, v69
    v_lshl_or_b32 v102, v38, 16, v70
    v_and_or_b32 v103, v38, s11, v71
    v_med3_u32 v9, v8, v9, v100
    v_max_u32 v8, v8, v100
    v_med3_u32 v9, v8, v9, v101
    v_max_u32 v8, v8, v101
    v_med3_u32 v9, v8, v9, v102
    v_max_u32 v8, v8, v102
    v_med3_u32 v9, v8, v9, v103
    v_max_u32 v8, v8, v103
    v_lshl_or_b32 v104, v40, 16, v72
    v_and_or_b32 v105, v40, s11, v73
    v_lshl_or_b32 v106, v42, 16, v74
    v_and_or_b32 v107, v42, s11, v75
    v_med3_u32 v9, v8, v9, v104
    v_max_u32 v8, v8, v104
    v_med3_u32 v9, v8, v9, v105
    v_max_u32 v8, v8, v105
    v_med3_u32 v9, v8, v9, v106
    v_max_u32 v8, v8, v106
    v_med3_u32 v9, v8, v9, v107
    v_max_u32 v8, v8, v107
    v_lshl_or_b32 v108, v44, 16, v76
    v_and_or_b32 v109, v44, s11, v77
    v_lshl_or_b32 v110, v46, 16, v78
    v_and_or_b32 v111, v46, s11, v79
    v_med3_u32 v9, v8, v9, v108
    v_max_u32 v8, v8, v108
    v_med3_u32 v9, v8, v9, v109
    v_max_u32 v8, v8, v109
    v_med3_u32 v9, v8, v9, v110
    v_max_u32 v8, v8, v110
    v_med3_u32 v9, v8, v9, v111
    v_max_u32 v8, v8, v111
    v_mov_b32 v10, v8
    s_nop 1
    v_max_u32_dpp v10, v10, v10 row_shr:1 row_mask:0xf bank_mask:0xf
    s_nop 1
    v_max_u32_dpp v10, v10, v10 row_shr:2 row_mask:0xf bank_mask:0xf
    s_nop 1
    v_max_u32_dpp v10, v10, v10 row_shr:4 row_mask:0xf bank_mask:0xf
    s_nop 1
    v_max_u32_dpp v10, v10, v10 row_shr:8 row_mask:0xf bank_mask:0xf
    s_nop 1
    v_max_u32_dpp v10, v10, v10 row_bcast:15 row_mask:0xa bank_mask:0xf
    s_nop 1
    v_max_u32_dpp v10, v10, v10 row_bcast:31 row_mask:0xc bank_mask:0xf
    s_nop 0
    v_readlane_b32 s8, v10, 63
    s_mov_b32 s12, s8
    v_subrev_u32 v10, s12, v8
    v_subrev_u32 v11, s12, v9
    v_max_u32 v10, v10, v11
    s_and_b32 s13, s12, 0x7ff
    s_sub_u32 s13, 2047, s13
    v_max_u32_dpp v10, v10, v10 row_shr:1 row_mask:0xf bank_mask:0xf
    s_mul_i32 s13, s13, 1152
    s_nop 0
    v_max_u32_dpp v10, v10, v10 row_shr:2 row_mask:0xf bank_mask:0xf
    s_mov_b32 exec_lo, 0xff
    s_mov_b32 exec_hi, 0x0
    v_add_u32 v12, s13, v5
    v_mov_b32 v6, s12
    s_mov_b64 exec, -1
    v_max_u32_dpp v10, v10, v10 row_shr:4 row_mask:0xf bank_mask:0xf
    s_nop 1
    v_max_u32_dpp v10, v10, v10 row_shr:8 row_mask:0xf bank_mask:0xf
    s_nop 1
    v_max_u32_dpp v10, v10, v10 row_bcast:15 row_mask:0xa bank_mask:0xf
    s_nop 1
    v_max_u32_dpp v10, v10, v10 row_bcast:31 row_mask:0xc bank_mask:0xf
    s_nop 0
    v_readlane_b32 s8, v10, 63
    s_add_u32 s12, s12, s8
    v_subrev_u32 v10, s12, v8
    v_subrev_u32 v11, s12, v9
    v_max_u32 v10, v10, v11
    s_and_b32 s13, s12, 0x7ff
    s_sub_u32 s13, 2047, s13
    v_max_u32_dpp v10, v10, v10 row_shr:1 row_mask:0xf bank_mask:0xf
    s_mul_i32 s13, s13, 1152
    s_nop 0
    v_max_u32_dpp v10, v10, v10 row_shr:2 row_mask:0xf bank_mask:0xf
    s_mov_b32 exec_lo, 0xff00
    s_mov_b32 exec_hi, 0x0
    v_add_u32 v12, s13, v5
    v_mov_b32 v6, s12
    s_mov_b64 exec, -1
    v_max_u32_dpp v10, v10, v10 row_shr:4 row_mask:0xf bank_mask:0xf
    s_nop 1
    v_max_u32_dpp v10, v10, v10 row_shr:8 row_mask:0xf bank_mask:0xf
    s_nop 1
    v_max_u32_dpp v10, v10, v10 row_bcast:15 row_mask:0xa bank_mask:0xf
    s_nop 1
    v_max_u32_dpp v10, v10, v10 row_bcast:31 row_mask:0xc bank_mask:0xf
    s_nop 0
    v_readlane_b32 s8, v10, 63
    s_add_u32 s12, s12, s8
    v_subrev_u32 v10, s12, v8
    v_subrev_u32 v11, s12, v9
    v_max_u32 v10, v10, v11
    s_and_b32 s13, s12, 0x7ff
    s_sub_u32 s13, 2047, s13
    v_max_u32_dpp v10, v10, v10 row_shr:1 row_mask:0xf bank_mask:0xf
    s_mul_i32 s13, s13, 1152
    s_nop 0
    v_max_u32_dpp v10, v10, v10 row_shr:2 row_mask:0xf bank_mask:0xf
    s_mov_b32 exec_lo, 0xff0000
    s_mov_b32 exec_hi, 0x0
    v_add_u32 v12, s13, v5
    v_mov_b32 v6, s12
    s_mov_b64 exec, -1
    v_max_u32_dpp v10, v10, v10 row_shr:4 row_mask:0xf bank_mask:0xf
    s_nop 1
    v_max_u32_dpp v10, v10, v10 row_shr:8 row_mask:0xf bank_mask:0xf
    s_nop 1
    v_max_u32_dpp v10, v10, v10 row_bcast:15 row_mask:0xa bank_mask:0xf
    s_nop 1
    v_max_u32_dpp v10, v10, v10 row_bcast:31 row_mask:0xc bank_mask:0xf
    s_nop 0
    v_readlane_b32 s8, v10, 63
    s_add_u32 s12, s12, s8
    v_subrev_u32 v10, s12, v8
    v_subrev_u32 v11, s12, v9
    v_max_u32 v10, v10, v11
    s_and_b32 s13, s12, 0x7ff
    s_sub_u32 s13, 2047, s13
    v_max_u32_dpp v10, v10, v10 row_shr:1 row_mask:0xf bank_mask:0xf
    s_mul_i32 s13, s13, 1152
    s_nop 0
    v_max_u32_dpp v10, v10, v10 row_shr:2 row_mask:0xf bank_mask:0xf
    s_mov_b32 exec_lo, 0xff000000
    s_mov_b32 exec_hi, 0x0
    v_add_u32 v12, s13, v5
    v_mov_b32 v6, s12
    s_mov_b64 exec, -1
    v_max_u32_dpp v10, v10, v10 row_shr:4 row_mask:0xf bank_mask:0xf
    s_nop 1
    v_max_u32_dpp v10, v10, v10 row_shr:8 row_mask:0xf bank_mask:0xf
    s_nop 1
    v_max_u32_dpp v10, v10, v10 row_bcast:15 row_mask:0xa bank_mask:0xf
    s_nop 1
    v_max_u32_dpp v10, v10, v10 row_bcast:31 row_mask:0xc bank_mask:0xf
    s_nop 0
    v_readlane_b32 s8, v10, 63
    s_add_u32 s12, s12, s8
    v_subrev_u32 v10, s12, v8
    v_subrev_u32 v11, s12, v9
    v_max_u32 v10, v10, v11
    s_and_b32 s13, s12, 0x7ff
    s_sub_u32 s13, 2047, s13
    v_max_u32_dpp v10, v10, v10 row_shr:1 row_mask:0xf bank_mask:0xf
    s_mul_i32 s13, s13, 1152
    s_nop 0
    v_max_u32_dpp v10, v10, v10 row_shr:2 row_mask:0xf bank_mask:0xf
    s_mov_b32 exec_lo, 0x0
    s_mov_b32 exec_hi, 0xff
    v_add_u32 v12, s13, v5
    v_mov_b32 v6, s12
    s_mov_b64 exec, -1
    v_max_u32_dpp v10, v10, v10 row_shr:4 row_mask:0xf bank_mask:0xf
    s_nop 1
    v_max_u32_dpp v10, v10, v10 row_shr:8 row_mask:0xf bank_mask:0xf
    s_nop 1
    v_max_u32_dpp v10, v10, v10 row_bcast:15 row_mask:0xa bank_mask:0xf
    s_nop 1
    v_max_u32_dpp v10, v10, v10 row_bcast:31 row_mask:0xc bank_mask:0xf
    s_nop 0
    v_readlane_b32 s8, v10, 63
    s_add_u32 s12, s12, s8
    v_subrev_u32 v10, s12, v8
    v_subrev_u32 v11, s12, v9
    v_max_u32 v10, v10, v11
    s_and_b32 s13, s12, 0x7ff
    s_sub_u32 s13, 2047, s13
    v_max_u32_dpp v10, v10, v10 row_shr:1 row_mask:0xf bank_mask:0xf
    s_mul_i32 s13, s13, 1152
    s_nop 0
    v_max_u32_dpp v10, v10, v10 row_shr:2 row_mask:0xf bank_mask:0xf
    s_mov_b32 exec_lo, 0x0
    s_mov_b32 exec_hi, 0xff00
    v_add_u32 v12, s13, v5
    v_mov_b32 v6, s12
    s_mov_b64 exec, -1
    v_max_u32_dpp v10, v10, v10 row_shr:4 row_mask:0xf bank_mask:0xf
    s_nop 1
    v_max_u32_dpp v10, v10, v10 row_shr:8 row_mask:0xf bank_mask:0xf
    s_nop 1
    v_max_u32_dpp v10, v10, v10 row_bcast:15 row_mask:0xa bank_mask:0xf
    s_nop 1
    v_max_u32_dpp v10, v10, v10 row_bcast:31 row_mask:0xc bank_mask:0xf
    s_nop 0
    v_readlane_b32 s8, v10, 63
    s_add_u32 s12, s12, s8
    v_subrev_u32 v10, s12, v8
    v_subrev_u32 v11, s12, v9
    v_max_u32 v10, v10, v11
    s_and_b32 s13, s12, 0x7ff
    s_sub_u32 s13, 2047, s13
    v_max_u32_dpp v10, v10, v10 row_shr:1 row_mask:0xf bank_mask:0xf
    s_mul_i32 s13, s13, 1152
    s_nop 0
    v_max_u32_dpp v10, v10, v10 row_shr:2 row_mask:0xf bank_mask:0xf
    s_mov_b32 exec_lo, 0x0
    s_mov_b32 exec_hi, 0xff0000
    v_add_u32 v12, s13, v5
    v_mov_b32 v6, s12
    s_mov_b64 exec, -1
    v_max_u32_dpp v10, v10, v10 row_shr:4 row_mask:0xf bank_mask:0xf
    s_nop 1
    v_max_u32_dpp v10, v10, v10 row_shr:8 row_mask:0xf bank_mask:0xf
    s_nop 1
    v_max_u32_dpp v10, v10, v10 row_bcast:15 row_mask:0xa bank_mask:0xf
    s_nop 1
    v_max_u32_dpp v10, v10, v10 row_bcast:31 row_mask:0xc bank_mask:0xf
    s_nop 0
    v_readlane_b32 s8, v10, 63
    s_add_u32 s12, s12, s8
    s_and_b32 s13, s12, 0x7ff
    s_sub_u32 s13, 2047, s13
    s_mul_i32 s13, s13, 1152
    s_mov_b32 exec_lo, 0x0
    s_mov_b32 exec_hi, 0xff000000
    v_add_u32 v12, s13, v5
    v_mov_b32 v6, s12
    s_mov_b64 exec, -1
    s_mov_b32 s14, 0
SEL_GATHER:
    s_mov_b32 m0, 147712
    s_nop 0
    buffer_load_dwordx4 v12, s[52:55], 0 offen offset:0 lds
    s_mov_b32 m0, 148608
    s_nop 0
    buffer_load_dwordx4 v12, s[52:55], 0 offen offset:128 lds
    s_mov_b32 m0, 149504
    s_nop 0
    buffer_load_dwordx4 v12, s[52:55], 0 offen offset:256 lds
    s_mov_b32 m0, 150400
    s_nop 0
    buffer_load_dwordx4 v12, s[52:55], 0 offen offset:384 lds
    s_mov_b32 m0, 151296
    s_nop 0
    buffer_load_dwordx4 v12, s[52:55], 0 offen offset:512 lds
    s_mov_b32 m0, 152192
    s_nop 0
    buffer_load_dwordx4 v12, s[52:55], 0 offen offset:640 lds
    s_mov_b32 m0, 153088
    s_nop 0
    buffer_load_dwordx4 v12, s[52:55], 0 offen offset:768 lds
    s_mov_b32 m0, 153984
    s_nop 0
    buffer_load_dwordx4 v12, s[52:55], 0 offen offset:896 lds
    s_mov_b32 m0, 154880
    s_nop 0
    buffer_load_dwordx4 v12, s[52:55], 0 offen offset:1024 lds
    s_cmp_lg_u32 s14, 0
    s_cbranch_scc1 SEL_OK
    v_sub_u32 v16, v80, v9
    v_sub_u32 v17, v81, v9
    v_sub_u32 v18, v82, v9
    v_sub_u32 v19, v83, v9
    v_sub_u32 v20, v84, v9
    v_sub_u32 v21, v85, v9
    v_sub_u32 v22, v86, v9
    v_sub_u32 v23, v87, v9
    v_sub_u32 v24, v88, v9
    v_sub_u32 v25, v89, v9
    v_sub_u32 v26, v90, v9
    v_sub_u32 v27, v91, v9
    v_sub_u32 v28, v92, v9
    v_sub_u32 v29, v93, v9
    v_sub_u32 v30, v94, v9
    v_sub_u32 v31, v95, v9
    v_sub_u32 v32, v96, v9
    v_sub_u32 v33, v97, v9
    v_sub_u32 v34, v98, v9
    v_sub_u32 v35, v99, v9
    v_sub_u32 v36, v100, v9
    v_sub_u32 v37, v101, v9
    v_sub_u32 v38, v102, v9
    v_sub_u32 v39, v103, v9
    v_sub_u32 v40, v104, v9
    v_sub_u32 v41, v105, v9
    v_sub_u32 v42, v106, v9
    v_sub_u32 v43, v107, v9
    v_sub_u32 v44, v108, v9
    v_sub_u32 v45, v109, v9
    v_sub_u32 v46, v110, v9
    v_sub_u32 v47, v111, v9
    v_max3_u32 v16, v16, v17, v18
    v_max3_u32 v19, v19, v20, v21
    v_max3_u32 v22, v22, v23, v24
    v_max3_u32 v25, v25, v26, v27
    v_max3_u32 v28, v28, v29, v30
    v_max3_u32 v31, v31, v32, v33
    v_max3_u32 v34, v34, v35, v36
    v_max3_u32 v37, v37, v38, v39
    v_max3_u32 v40, v40, v41, v42
    v_max3_u32 v43, v43, v44, v45
    v_max3_u32 v16, v16, v19, v22
    v_max3_u32 v25, v25, v28, v31
    v_max3_u32 v34, v34, v37, v40
    v_max3_u32 v43, v43, v46, v47
    v_max3_u32 v16, v16, v25, v34
    v_max_u32 v16, v16, v43
    v_add_u32 v16, v16, v9
    v_cmp_lt_u32 vcc, s12, v16
    s_cmp_eq_u64 vcc, 0
    s_cbranch_scc1 SEL_OK
    s_waitcnt vmcnt(0)
    s_mov_b32 s12, 0
    s_mov_b64 s[56:57], 0xff
SEL_SLOW:
    v_subrev_u32 v16, s12, v80
    v_subrev_u32 v17, s12, v81
    v_subrev_u32 v18, s12, v82
    v_subrev_u32 v19, s12, v83
    v_subrev_u32 v20, s12, v84
    v_subrev_u32 v21, s12, v85
    v_subrev_u32 v22, s12, v86
    v_subrev_u32 v23, s12, v87
    v_subrev_u32 v24, s12, v88
    v_subrev_u32 v25, s12, v89
    v_subrev_u32 v26, s12, v90
    v_subrev_u32 v27, s12, v91
    v_subrev_u32 v28, s12, v92
    v_subrev_u32 v29, s12, v93
    v_subrev_u32 v30, s12, v94
    v_subrev_u32 v31, s12, v95
    v_subrev_u32 v32, s12, v96
    v_subrev_u32 v33, s12, v97
    v_subrev_u32 v34, s12, v98
    v_subrev_u32 v35, s12, v99
    v_subrev_u32 v36, s12, v100
    v_subrev_u32 v37, s12, v101
    v_subrev_u32 v38, s12, v102
    v_subrev_u32 v39, s12, v103
    v_subrev_u32 v40, s12, v104
    v_subrev_u32 v41, s12, v105
    v_subrev_u32 v42, s12, v106
    v_subrev_u32 v43, s12, v107
    v_subrev_u32 v44, s12, v108
    v_subrev_u32 v45, s12, v109
    v_subrev_u32 v46, s12, v110
    v_subrev_u32 v47, s12, v111
    v_max3_u32 v16, v16, v17, v18
    v_max3_u32 v19, v19, v20, v21
    v_max3_u32 v22, v22, v23, v24
    v_max3_u32 v25, v25, v26, v27
    v_max3_u32 v28, v28, v29, v30
    v_max3_u32 v31, v31, v32, v33
    v_max3_u32 v34, v34, v35, v36
    v_max3_u32 v37, v37, v38, v39
    v_max3_u32 v40, v40, v41, v42
    v_max3_u32 v43, v43, v44, v45
    v_max3_u32 v16, v16, v19, v22
    v_max3_u32 v25, v25, v28, v31
    v_max3_u32 v34, v34, v37, v40
    v_max3_u32 v43, v43, v46, v47
    v_max3_u32 v16, v16, v25, v34
    v_max_u32 v16, v16, v43
    s_nop 1
    v_max_u32_dpp v16, v16, v16 row_shr:1 row_mask:0xf bank_mask:0xf
    s_nop 1
    v_max_u32_dpp v16, v16, v16 row_shr:2 row_mask:0xf bank_mask:0xf
    s_nop 1
    v_max_u32_dpp v16, v16, v16 row_shr:4 row_mask:0xf bank_mask:0xf
    s_nop 1
    v_max_u32_dpp v16, v16, v16 row_shr:8 row_mask:0xf bank_mask:0xf
    s_nop 1
    v_max_u32_dpp v16, v16, v16 row_bcast:15 row_mask:0xa bank_mask:0xf
    s_nop 1
    v_max_u32_dpp v16, v16, v16 row_bcast:31 row_mask:0xc bank_mask:0xf
    s_nop 0
    v_readlane_b32 s8, v16, 63
    s_add_u32 s12, s12, s8
    s_and_b32 s13, s12, 0x7ff
    s_sub_u32 s13, 2047, s13
    s_mul_i32 s13, s13, 1152
    s_mov_b64 exec, s[56:57]
    v_add_u32 v12, s13, v5
    v_mov_b32 v6, s12
    s_mov_b64 exec, -1
    s_lshl_b64 s[56:57], s[56:57], 8
    s_add_u32 s14, s14, 1
    s_cmp_lt_u32 s14, 8
    s_cbranch_scc1 SEL_SLOW
    s_branch SEL_GATHER
SEL_OK:
    s_cmp_lg_u32 s2, 0
    s_cbranch_scc1 SEL_NOPUB
    v_mov_b32 v7, v14
    v_add_u32 v8, 16384, v2
    s_mov_b32 exec_lo, 0x01010101
    s_mov_b32 exec_hi, 0x01010101
    global_store_dwordx2 v8, v[6:7], s[50:51] sc1
    s_mov_b64 exec, 1
    global_store_dword v8, v14, s[50:51] offset:256 sc1
    s_mov_b64 exec, -1
    s_waitcnt vmcnt(2)
    s_branch SEL_END
SEL_NOPUB:
    s_waitcnt vmcnt(0)
SEL_END:
    s_barrier
    s_endpgm
F_LOAD:
    s_sub_u32 s12, s3, 9
    v_lshrrev_b32 v5, 3, v2
    v_bfe_u32 v6, v2, 4, 1
    v_xor_b32 v6, v6, v2
    v_and_b32 v6, 7, v6
    s_movk_i32 s8, 9216
    v_mul_lo_u32 v7, v5, s8
    v_lshl_add_u32 v8, v6, 4, v7
    v_xor_b32 v9, 32, v8
    v_xor_b32 v10, 64, v8
    v_xor_b32 v11, 96, v8
    v_bfe_u32 v6, v2, 4, 1
    v_lshlrev_b32 v6, 1, v6
    v_xor_b32 v6, v6, v2
    v_and_b32 v6, 7, v6
    v_mul_u32_u24 v7, 1152, v5
    v_lshl_add_u32 v12, v6, 4, v7
    v_xor_b32 v13, 64, v12
    s_mul_i32 s13, s12, 147456
    s_lshl_b32 s8, s7, 7
    s_add_u32 s13, s13, s8
    s_mul_i32 s14, s12, 24576
    s_add_u32 s14, s14, 256
    s_lshl_b32 s15, s12, 12
    s_add_u32 s15, s15, 256
    s_waitcnt lgkmcnt(0)
    s_mov_b32 s52, s38
    s_mov_b32 s53, s39
    s_mov_b32 s54, 5308416
    s_mov_b32 s55, 0x20000
    s_mov_b32 s56, s40
    s_mov_b32 s57, s41
    s_mov_b32 s58, 5308416
    s_mov_b32 s59, 0x20000
    s_mov_b32 s60, s42
    s_mov_b32 s61, s43
    s_mov_b32 s62, 5308416
    s_mov_b32 s63, 0x20000
    s_barrier
    s_add_u32 m0, s15, 0
    s_nop 0
    buffer_load_dwordx4 v8, s[52:55], s13 offen lds
    s_add_u32 m0, s15, 1024
    s_nop 0
    buffer_load_dwordx4 v10, s[56:59], s13 offen lds
    s_add_u32 s13, s13, 73728
    s_add_u32 m0, s15, 2048
    s_nop 0
    buffer_load_dwordx4 v9, s[52:55], s13 offen lds
    s_add_u32 m0, s15, 3072
    s_nop 0
    buffer_load_dwordx4 v11, s[56:59], s13 offen lds
    s_add_u32 s13, s13, 368640
    s_add_u32 m0, s15, 12288
    s_nop 0
    buffer_load_dwordx4 v8, s[52:55], s13 offen lds
    s_add_u32 m0, s15, 13312
    s_nop 0
    buffer_load_dwordx4 v10, s[56:59], s13 offen lds
    s_add_u32 s13, s13, 73728
    s_add_u32 m0, s15, 14336
    s_nop 0
    buffer_load_dwordx4 v9, s[52:55], s13 offen lds
    s_add_u32 m0, s15, 15360
    s_nop 0
    buffer_load_dwordx4 v11, s[56:59], s13 offen lds
    s_add_u32 s13, s13, 368640
    s_add_u32 m0, s15, 24576
    s_nop 0
    buffer_load_dwordx4 v8, s[52:55], s13 offen lds
    s_add_u32 m0, s15, 25600
    s_nop 0
    buffer_load_dwordx4 v10, s[56:59], s13 offen lds
    s_add_u32 s13, s13, 73728
    s_waitcnt vmcnt(9)
    s_add_u32 m0, s15, 26624
    s_nop 0
    buffer_load_dwordx4 v9, s[52:55], s13 offen lds
    s_waitcnt vmcnt(9)
    s_add_u32 m0, s15, 27648
    s_nop 0
    buffer_load_dwordx4 v11, s[56:59], s13 offen lds
    s_add_u32 s13, s13, 368640
    s_waitcnt vmcnt(9)
    s_add_u32 m0, s15, 36864
    s_nop 0
    buffer_load_dwordx4 v8, s[52:55], s13 offen lds
    s_waitcnt vmcnt(9)
    s_add_u32 m0, s15, 37888
    s_nop 0
    buffer_load_dwordx4 v10, s[56:59], s13 offen lds
    s_add_u32 s13, s13, 73728
    s_waitcnt vmcnt(9)
    s_add_u32 m0, s15, 38912
    s_nop 0
    buffer_load_dwordx4 v9, s[52:55], s13 offen lds
    s_waitcnt vmcnt(9)
    s_add_u32 m0, s15, 39936
    s_nop 0
    buffer_load_dwordx4 v11, s[56:59], s13 offen lds
    s_add_u32 s13, s13, 368640
    s_waitcnt vmcnt(9)
    s_add_u32 m0, s15, 49152
    s_nop 0
    buffer_load_dwordx4 v8, s[52:55], s13 offen lds
    s_waitcnt vmcnt(9)
    s_add_u32 m0, s15, 50176
    s_nop 0
    buffer_load_dwordx4 v10, s[56:59], s13 offen lds
    s_add_u32 s13, s13, 73728
    s_waitcnt vmcnt(9)
    s_add_u32 m0, s15, 51200
    s_nop 0
    buffer_load_dwordx4 v9, s[52:55], s13 offen lds
    s_waitcnt vmcnt(9)
    s_add_u32 m0, s15, 52224
    s_nop 0
    buffer_load_dwordx4 v11, s[56:59], s13 offen lds
    s_add_u32 s13, s13, 368640
    s_waitcnt vmcnt(9)
    s_add_u32 m0, s15, 61440
    s_nop 0
    buffer_load_dwordx4 v8, s[52:55], s13 offen lds
    s_waitcnt vmcnt(9)
    s_add_u32 m0, s15, 62464
    s_nop 0
    buffer_load_dwordx4 v10, s[56:59], s13 offen lds
    s_add_u32 s13, s13, 73728
    s_waitcnt vmcnt(9)
    s_add_u32 m0, s15, 63488
    s_nop 0
    buffer_load_dwordx4 v9, s[52:55], s13 offen lds
    s_waitcnt vmcnt(9)
    s_add_u32 m0, s15, 64512
    s_nop 0
    buffer_load_dwordx4 v11, s[56:59], s13 offen lds
    s_add_u32 s13, s13, 368640
    s_waitcnt vmcnt(9)
    s_add_u32 m0, s15, 73728
    s_nop 0
    buffer_load_dwordx4 v8, s[52:55], s13 offen lds
    s_waitcnt vmcnt(9)
    s_add_u32 m0, s15, 74752
    s_nop 0
    buffer_load_dwordx4 v10, s[56:59], s13 offen lds
    s_add_u32 s13, s13, 73728
    s_waitcnt vmcnt(9)
    s_add_u32 m0, s15, 75776
    s_nop 0
    buffer_load_dwordx4 v9, s[52:55], s13 offen lds
    s_waitcnt vmcnt(9)
    s_add_u32 m0, s15, 76800
    s_nop 0
    buffer_load_dwordx4 v11, s[56:59], s13 offen lds
    s_add_u32 s13, s13, 368640
    s_waitcnt vmcnt(9)
    s_add_u32 m0, s15, 86016
    s_nop 0
    buffer_load_dwordx4 v8, s[52:55], s13 offen lds
    s_waitcnt vmcnt(9)
    s_add_u32 m0, s15, 87040
    s_nop 0
    buffer_load_dwordx4 v10, s[56:59], s13 offen lds
    s_add_u32 s13, s13, 73728
    s_waitcnt vmcnt(9)
    s_add_u32 m0, s15, 88064
    s_nop 0
    buffer_load_dwordx4 v9, s[52:55], s13 offen lds
    s_waitcnt vmcnt(9)
    s_add_u32 m0, s15, 89088
    s_nop 0
    buffer_load_dwordx4 v11, s[56:59], s13 offen lds
    s_add_u32 s13, s13, 368640
    s_waitcnt vmcnt(9)
    s_add_u32 m0, s15, 98304
    s_nop 0
    buffer_load_dwordx4 v8, s[52:55], s13 offen lds
    s_waitcnt vmcnt(9)
    v_mov_b32 v14, 1
    s_mov_b64 exec, 1
    ds_add_u32 v1, v14 offset:16
    s_mov_b64 exec, -1
    s_add_u32 m0, s15, 99328
    s_nop 0
    buffer_load_dwordx4 v10, s[56:59], s13 offen lds
    s_add_u32 s13, s13, 73728
    s_waitcnt vmcnt(9)
    s_add_u32 m0, s15, 100352
    s_nop 0
    buffer_load_dwordx4 v9, s[52:55], s13 offen lds
    s_waitcnt vmcnt(9)
    s_add_u32 m0, s15, 101376
    s_nop 0
    buffer_load_dwordx4 v11, s[56:59], s13 offen lds
    s_add_u32 s13, s13, 368640
    s_waitcnt vmcnt(9)
    s_add_u32 m0, s15, 110592
    s_nop 0
    buffer_load_dwordx4 v8, s[52:55], s13 offen lds
    s_waitcnt vmcnt(9)
    s_add_u32 m0, s15, 111616
    s_nop 0
    buffer_load_dwordx4 v10, s[56:59], s13 offen lds
    s_add_u32 s13, s13, 73728
    s_waitcnt vmcnt(9)
    s_add_u32 m0, s15, 112640
    s_nop 0
    buffer_load_dwordx4 v9, s[52:55], s13 offen lds
    s_waitcnt vmcnt(9)
    s_add_u32 m0, s15, 113664
    s_nop 0
    buffer_load_dwordx4 v11, s[56:59], s13 offen lds
    s_add_u32 s13, s13, 368640
    s_waitcnt vmcnt(9)
    s_add_u32 m0, s15, 122880
    s_nop 0
    buffer_load_dwordx4 v8, s[52:55], s13 offen lds
    s_waitcnt vmcnt(9)
    s_add_u32 m0, s15, 123904
    s_nop 0
    buffer_load_dwordx4 v10, s[56:59], s13 offen lds
    s_add_u32 s13, s13, 73728
    s_waitcnt vmcnt(9)
    s_add_u32 m0, s15, 124928
    s_nop 0
    buffer_load_dwordx4 v9, s[52:55], s13 offen lds
    s_waitcnt vmcnt(9)
    s_add_u32 m0, s15, 125952
    s_nop 0
    buffer_load_dwordx4 v11, s[56:59], s13 offen lds
    s_add_u32 s13, s13, 368640
    s_waitcnt vmcnt(9)
    s_add_u32 m0, s15, 135168
    s_nop 0
    buffer_load_dwordx4 v8, s[52:55], s13 offen lds
    s_waitcnt vmcnt(9)
    s_add_u32 m0, s15, 136192
    s_nop 0
    buffer_load_dwordx4 v10, s[56:59], s13 offen lds
    s_add_u32 s13, s13, 73728
    s_waitcnt vmcnt(9)
    s_add_u32 m0, s15, 137216
    s_nop 0
    buffer_load_dwordx4 v9, s[52:55], s13 offen lds
    s_waitcnt vmcnt(9)
    s_add_u32 m0, s15, 138240
    s_nop 0
    buffer_load_dwordx4 v11, s[56:59], s13 offen lds
    s_add_u32 s13, s13, 368640
    s_mul_i32 s13, s7, 73728
    s_mul_i32 s8, s12, 384
    s_add_u32 s13, s13, s8
    s_mov_b32 s9, 0
SP_10:
    ds_read_b32 v14, v1 offset:24
    s_waitcnt lgkmcnt(0)
    v_readfirstlane_b32 s8, v14
    s_add_u32 s9, s9, 1
    s_cmp_ge_u32 s8, 8
    s_cbranch_scc1 SP_10_D
    s_cmp_lt_u32 s9, 524288
    s_cbranch_scc1 SP_10
SP_10_D:
    s_waitcnt vmcnt(9)
    s_add_u32 m0, s14, 0
    s_nop 0
    buffer_load_dwordx4 v12, s[60:63], s13 offen lds
    s_add_u32 s13, s13, 9216
    s_waitcnt vmcnt(9)
    s_add_u32 m0, s14, 1024
    s_nop 0
    buffer_load_dwordx4 v13, s[60:63], s13 offen lds
    s_add_u32 s13, s13, 9216
    s_waitcnt vmcnt(9)
    s_add_u32 m0, s14, 2048
    s_nop 0
    buffer_load_dwordx4 v12, s[60:63], s13 offen lds
    s_add_u32 s13, s13, 9216
    s_waitcnt vmcnt(9)
    s_add_u32 m0, s14, 3072
    s_nop 0
    buffer_load_dwordx4 v13, s[60:63], s13 offen lds
    s_add_u32 s13, s13, 9216
    s_waitcnt vmcnt(9)
    s_add_u32 m0, s14, 4096
    s_nop 0
    buffer_load_dwordx4 v12, s[60:63], s13 offen lds
    s_add_u32 s13, s13, 9216
    s_waitcnt vmcnt(9)
    s_add_u32 m0, s14, 5120
    s_nop 0
    buffer_load_dwordx4 v13, s[60:63], s13 offen lds
    s_add_u32 s13, s13, 9216
    s_waitcnt vmcnt(9)
    s_add_u32 m0, s14, 6144
    s_nop 0
    buffer_load_dwordx4 v12, s[60:63], s13 offen lds
    s_add_u32 s13, s13, 9216
    s_waitcnt vmcnt(9)
    s_add_u32 m0, s14, 7168
    s_nop 0
    buffer_load_dwordx4 v13, s[60:63], s13 offen lds
    s_add_u32 s13, s13, 4294902912
    s_waitcnt vmcnt(9)
    s_add_u32 m0, s14, 8192
    s_nop 0
    buffer_load_dwordx4 v12, s[60:63], s13 offen lds
    s_add_u32 s13, s13, 9216
    s_waitcnt vmcnt(9)
    v_mov_b32 v14, 1
    s_mov_b64 exec, 1
    ds_add_u32 v1, v14 offset:20
    s_mov_b64 exec, -1
    s_add_u32 m0, s14, 9216
    s_nop 0
    buffer_load_dwordx4 v13, s[60:63], s13 offen lds
    s_add_u32 s13, s13, 9216
    s_waitcnt vmcnt(9)
    s_add_u32 m0, s14, 10240
    s_nop 0
    buffer_load_dwordx4 v12, s[60:63], s13 offen lds
    s_add_u32 s13, s13, 9216
    s_waitcnt vmcnt(9)
    s_add_u32 m0, s14, 11264
    s_nop 0
    buffer_load_dwordx4 v13, s[60:63], s13 offen lds
    s_add_u32 s13, s13, 9216
    s_waitcnt vmcnt(9)
    s_add_u32 m0, s14, 12288
    s_nop 0
    buffer_load_dwordx4 v12, s[60:63], s13 offen lds
    s_add_u32 s13, s13, 9216
    s_waitcnt vmcnt(9)
    s_add_u32 m0, s14, 13312
    s_nop 0
    buffer_load_dwordx4 v13, s[60:63], s13 offen lds
    s_add_u32 s13, s13, 9216
    s_waitcnt vmcnt(9)
    s_add_u32 m0, s14, 14336
    s_nop 0
    buffer_load_dwordx4 v12, s[60:63], s13 offen lds
    s_add_u32 s13, s13, 9216
    s_waitcnt vmcnt(9)
    s_add_u32 m0, s14, 15360
    s_nop 0
    buffer_load_dwordx4 v13, s[60:63], s13 offen lds
    s_add_u32 s13, s13, 4294902912
    s_waitcnt vmcnt(9)
    s_add_u32 m0, s14, 16384
    s_nop 0
    buffer_load_dwordx4 v12, s[60:63], s13 offen lds
    s_add_u32 s13, s13, 9216
    s_waitcnt vmcnt(9)
    s_add_u32 m0, s14, 17408
    s_nop 0
    buffer_load_dwordx4 v13, s[60:63], s13 offen lds
    s_add_u32 s13, s13, 9216
    s_waitcnt vmcnt(9)
    s_add_u32 m0, s14, 18432
    s_nop 0
    buffer_load_dwordx4 v12, s[60:63], s13 offen lds
    s_add_u32 s13, s13, 9216
    s_waitcnt vmcnt(9)
    s_add_u32 m0, s14, 19456
    s_nop 0
    buffer_load_dwordx4 v13, s[60:63], s13 offen lds
    s_add_u32 s13, s13, 9216
    s_waitcnt vmcnt(9)
    s_add_u32 m0, s14, 20480
    s_nop 0
    buffer_load_dwordx4 v12, s[60:63], s13 offen lds
    s_add_u32 s13, s13, 9216
    s_waitcnt vmcnt(9)
    s_add_u32 m0, s14, 21504
    s_nop 0
    buffer_load_dwordx4 v13, s[60:63], s13 offen lds
    s_add_u32 s13, s13, 9216
    s_waitcnt vmcnt(9)
    s_add_u32 m0, s14, 22528
    s_nop 0
    buffer_load_dwordx4 v12, s[60:63], s13 offen lds
    s_add_u32 s13, s13, 9216
    s_waitcnt vmcnt(9)
    s_add_u32 m0, s14, 23552
    s_nop 0
    buffer_load_dwordx4 v13, s[60:63], s13 offen lds
    s_add_u32 s13, s13, 4294902912
    s_barrier
    s_waitcnt vmcnt(0)
    s_barrier
    s_endpgm
F_COMP:
    s_barrier
F_COMP2:
    v_lshrrev_b32 v5, 2, v3
    v_bfe_u32 v6, v3, 1, 1
    v_bfe_u32 v7, v3, 3, 1
    v_and_b32 v8, 1, v4
    v_lshl_or_b32 v7, v8, 1, v7
    v_lshl_or_b32 v9, v6, 2, v7
    v_xor_b32 v9, s3, v9
    v_lshlrev_b32 v9, 4, v9
    v_lshl_add_u32 v9, v5, 7, v9
    v_lshl_add_u32 v9, v6, 10, v9
    v_lshl_add_u32 v9, v4, 11, v9
    v_and_b32 v8, 1, v3
    v_lshl_add_u32 v9, v8, 3, v9
    v_add_u32 v10, 33024, v9
    v_add_u32 v11, 73984, v9
    v_add_u32 v12, 106752, v9
    s_and_b32 s12, s3, 3
    v_xor_b32 v13, s12, v7
    v_lshlrev_b32 v13, 5, v13
    v_lshl_add_u32 v13, v5, 7, v13
    v_lshl_add_u32 v13, v4, 10, v13
    v_and_b32 v8, 3, v3
    v_lshl_add_u32 v13, v8, 3, v13
    s_lshr_b32 s13, s3, 2
    s_lshl_b32 s13, s13, 13
    v_add_u32 v13, s13, v13
    v_add_u32 v14, 33024, v13
    v_and_b32 v5, 7, v3
    v_and_b32 v6, 6, v3
    v_xor_b32 v6, v6, v4
    v_lshlrev_b32 v6, 4, v6
    v_lshl_add_u32 v6, v5, 7, v6
    v_add_u32 v15, 147712, v6
    v_xor_b32 v140, 64, v15
    v_and_b32 v6, 1, v4
    v_lshlrev_b32 v6, 2, v6
    v_lshrrev_b32 v7, 1, v4
    v_add_u32 v6, v6, v7
    v_bfe_u32 v7, v3, 3, 1
    v_lshl_add_u32 v6, v7, 1, v6
    s_lshl_b32 s12, s3, 3
    v_add_lshl_u32 v6, v6, s12, 1
    v_mul_u32_u24 v7, 144, v5
    v_add_u32 v7, 156928, v7
    v_add_u32 v141, v6, v7
    v_lshl_add_u32 v142, v4, 4, v7
    s_lshl_b32 s12, s3, 2
    v_add_u32 v6, s12, v4
    v_mul_u32_u24 v6, 9216, v6
    s_lshl_b32 s12, s7, 7
    s_add_u32 s12, s12, 32768
    v_lshl_add_u32 v7, v3, 4, s12
    v_add_u32 v143, v6, v7
    s_waitcnt lgkmcnt(0)
    s_mov_b32 s52, s50
    s_mov_b32 s53, s51
    s_mov_b32 s54, 268435456
    s_mov_b32 s55, 0x20000
    s_mov_b32 s9, 0
SP_11:
    ds_read_b32 v8, v1 offset:16
    s_waitcnt lgkmcnt(0)
    v_readfirstlane_b32 s8, v8
    s_add_u32 s9, s9, 1
    s_cmp_ge_u32 s8, 3
    s_cbranch_scc1 SP_11_D
    s_sleep 1
    s_cmp_lt_u32 s9, 524288
    s_cbranch_scc1 SP_11
SP_11_D:
    ds_read_b64_tr_b16 v[16:17], v9 offset:256
    ds_read_b64_tr_b16 v[18:19], v9 offset:768
    ds_read_b64_tr_b16 v[20:21], v9 offset:8448
    ds_read_b64_tr_b16 v[22:23], v9 offset:8960
    ds_read_b64_tr_b16 v[24:25], v9 offset:16640
    ds_read_b64_tr_b16 v[26:27], v9 offset:17152
    ds_read_b64_tr_b16 v[28:29], v9 offset:24832
    ds_read_b64_tr_b16 v[30:31], v9 offset:25344
    ds_read_b64_tr_b16 v[32:33], v10 offset:0
    ds_read_b64_tr_b16 v[34:35], v10 offset:512
    ds_read_b64_tr_b16 v[36:37], v10 offset:8192
    ds_read_b64_tr_b16 v[38:39], v10 offset:8704
    ds_read_b64_tr_b16 v[40:41], v10 offset:16384
    ds_read_b64_tr_b16 v[42:43], v10 offset:16896
    ds_read_b64_tr_b16 v[44:45], v10 offset:24576
    ds_read_b64_tr_b16 v[46:47], v10 offset:25088
    ds_read_b64_tr_b16 v[48:49], v10 offset:32768
    ds_read_b64_tr_b16 v[50:51], v10 offset:33280
    s_waitcnt lgkmcnt(0)
    v_mov_b32 v8, 1
    s_mov_b64 exec, 1
    ds_add_u32 v1, v8 offset:24
    s_mov_b64 exec, -1
    s_mov_b32 s9, 0
SP_12:
    ds_read_b32 v8, v1 offset:20
    s_waitcnt lgkmcnt(0)
    v_readfirstlane_b32 s8, v8
    s_add_u32 s9, s9, 1
    s_cmp_ge_u32 s8, 3
    s_cbranch_scc1 SP_12_D
    s_sleep 1
    s_cmp_lt_u32 s9, 524288
    s_cbranch_scc1 SP_12
SP_12_D:
    ds_read_b64_tr_b16 v[52:53], v11 offset:0
    ds_read_b64_tr_b16 v[54:55], v11 offset:512
    ds_read_b64_tr_b16 v[56:57], v11 offset:8192
    ds_read_b64_tr_b16 v[58:59], v11 offset:8704
    ds_read_b64_tr_b16 v[60:61], v11 offset:16384
    ds_read_b64_tr_b16 v[62:63], v11 offset:16896
    ds_read_b64_tr_b16 v[64:65], v11 offset:24576
    ds_read_b64_tr_b16 v[66:67], v11 offset:25088
    ds_read_b64_tr_b16 v[68:69], v12 offset:0
    ds_read_b64_tr_b16 v[70:71], v12 offset:512
    ds_read_b64_tr_b16 v[72:73], v12 offset:8192
    ds_read_b64_tr_b16 v[74:75], v12 offset:8704
    ds_read_b64_tr_b16 v[76:77], v12 offset:16384
    ds_read_b64_tr_b16 v[78:79], v12 offset:16896
    ds_read_b64_tr_b16 v[80:81], v12 offset:24576
    ds_read_b64_tr_b16 v[82:83], v12 offset:25088
    ds_read_b64_tr_b16 v[84:85], v12 offset:32768
    ds_read_b64_tr_b16 v[86:87], v12 offset:33280
    s_mov_b32 s56, 0xff00ff00
    s_mov_b32 s57, 0xff00ff00
    s_mov_b32 s60, 0x7060500
    s_mov_b32 s61, 0x7060501
    s_mov_b32 s62, 0x7060502
    s_mov_b32 s63, 0x7060503
    s_waitcnt lgkmcnt(0)
    s_barrier
    ds_read_b128 v[88:91], v15 offset:0
    ds_read_b128 v[92:95], v140 offset:0
    ds_read_b128 v[96:99], v15 offset:1024
    ds_read_b128 v[100:103], v140 offset:1024
    ds_read_b128 v[104:107], v15 offset:2048
    ds_read_b128 v[108:111], v140 offset:2048
    ds_read_b128 v[112:115], v15 offset:3072
    ds_read_b128 v[116:119], v140 offset:3072
    ds_read_b32 v144, v1 offset:0
    s_waitcnt lgkmcnt(8)
    v_mfma_f32_16x16x32_bf16 v[120:123], v[16:19], v[88:91], 0
    ds_read_b128 v[88:91], v15 offset:4096
    s_waitcnt lgkmcnt(8)
    v_mfma_f32_16x16x32_bf16 v[120:123], v[20:23], v[92:95], v[120:123]
    ds_read_b128 v[92:95], v140 offset:4096
    s_waitcnt lgkmcnt(8)
    v_mfma_f32_16x16x32_bf16 v[120:123], v[24:27], v[96:99], v[120:123]
    ds_read_b128 v[96:99], v15 offset:5120
    s_waitcnt lgkmcnt(8)
    v_mfma_f32_16x16x32_bf16 v[120:123], v[28:31], v[100:103], v[120:123]
    ds_read_b128 v[100:103], v140 offset:5120
    s_waitcnt lgkmcnt(8)
    v_mfma_f32_16x16x32_bf16 v[120:123], v[32:35], v[104:107], v[120:123]
    ds_read_b128 v[104:107], v15 offset:6144
    s_waitcnt lgkmcnt(8)
    v_mfma_f32_16x16x32_bf16 v[120:123], v[36:39], v[108:111], v[120:123]
    ds_read_b128 v[108:111], v140 offset:6144
    s_waitcnt lgkmcnt(8)
    v_mfma_f32_16x16x32_bf16 v[120:123], v[40:43], v[112:115], v[120:123]
    ds_read_b128 v[112:115], v15 offset:7168
    s_waitcnt lgkmcnt(8)
    v_mfma_f32_16x16x32_bf16 v[120:123], v[44:47], v[116:119], v[120:123]
    ds_read_b128 v[116:119], v140 offset:7168
    s_waitcnt lgkmcnt(7)
    v_mfma_f32_16x16x32_bf16 v[120:123], v[48:51], v[88:91], v[120:123]
    ds_read_b128 v[88:91], v15 offset:8192
    s_waitcnt lgkmcnt(7)
    v_mfma_f32_16x16x32_bf16 v[120:123], v[52:55], v[92:95], v[120:123]
    ds_read_b128 v[92:95], v140 offset:8192
    s_waitcnt lgkmcnt(7)
    v_mfma_f32_16x16x32_bf16 v[120:123], v[56:59], v[96:99], v[120:123]
    s_waitcnt lgkmcnt(6)
    v_mfma_f32_16x16x32_bf16 v[120:123], v[60:63], v[100:103], v[120:123]
    s_waitcnt lgkmcnt(5)
    v_mfma_f32_16x16x32_bf16 v[120:123], v[64:67], v[104:107], v[120:123]
    s_waitcnt lgkmcnt(4)
    v_mfma_f32_16x16x32_bf16 v[120:123], v[68:71], v[108:111], v[120:123]
    s_waitcnt lgkmcnt(3)
    v_mfma_f32_16x16x32_bf16 v[120:123], v[72:75], v[112:115], v[120:123]
    s_waitcnt lgkmcnt(2)
    v_mfma_f32_16x16x32_bf16 v[120:123], v[76:79], v[116:119], v[120:123]
    s_waitcnt lgkmcnt(1)
    v_mfma_f32_16x16x32_bf16 v[120:123], v[80:83], v[88:91], v[120:123]
    s_waitcnt lgkmcnt(0)
    v_mfma_f32_16x16x32_bf16 v[120:123], v[84:87], v[92:95], v[120:123]
    s_nop 7
    v_permlane32_swap_b32 v120, v121
    v_permlane32_swap_b32 v122, v123
    v_cndmask_b32 v120, v120, v122, s[56:57]
    v_cndmask_b32 v121, v121, v123, s[56:57]
    v_cvt_pk_bf16_f32 v121, v120, v121
    v_lshlrev_b32 v120, 16, v121
    v_mul_f32 v122, 0xbfb8aa3b, v120
    v_exp_f32 v122, v122
    v_and_b32 v121, 0xffff0000, v121
    v_add_f32 v122, 1.0, v122
    v_rcp_f32 v122, v122
    s_nop 0
    v_mul_f32 v120, v120, v122
    v_cvt_pk_bf16_f32 v120, v120, v120
    v_and_b32 v120, 0xffff0000, v120
    v_mul_f32 v120, v120, v121
    v_cvt_pk_bf16_f32 v120, v120, v120
    ds_write_b16 v141, v120
    s_waitcnt lgkmcnt(0)
    s_barrier
    ds_read_b128 v[88:91], v142 offset:0
    ds_read_b128 v[92:95], v142 offset:64
    ds_read_b64_tr_b16 v[16:17], v13 offset:256
    ds_read_b64_tr_b16 v[18:19], v13 offset:768
    ds_read_b64_tr_b16 v[20:21], v13 offset:4352
    ds_read_b64_tr_b16 v[22:23], v13 offset:4864
    ds_read_b64_tr_b16 v[24:25], v13 offset:16640
    ds_read_b64_tr_b16 v[26:27], v13 offset:17152
    ds_read_b64_tr_b16 v[28:29], v13 offset:20736
    ds_read_b64_tr_b16 v[30:31], v13 offset:21248
    ds_read_b64_tr_b16 v[32:33], v13 offset:33024
    ds_read_b64_tr_b16 v[34:35], v13 offset:33536
    ds_read_b64_tr_b16 v[36:37], v13 offset:37120
    ds_read_b64_tr_b16 v[38:39], v13 offset:37632
    ds_read_b64_tr_b16 v[40:41], v13 offset:49408
    ds_read_b64_tr_b16 v[42:43], v13 offset:49920
    ds_read_b64_tr_b16 v[44:45], v13 offset:53504
    ds_read_b64_tr_b16 v[46:47], v13 offset:54016
    ds_read_b64_tr_b16 v[48:49], v14 offset:32768
    ds_read_b64_tr_b16 v[50:51], v14 offset:33280
    ds_read_b64_tr_b16 v[52:53], v14 offset:36864
    ds_read_b64_tr_b16 v[54:55], v14 offset:37376
    s_waitcnt lgkmcnt(15)
    v_mfma_f32_16x16x32_bf16 v[120:123], v[16:19], v[88:91], 0
    v_mfma_f32_16x16x32_bf16 v[120:123], v[20:23], v[92:95], v[120:123]
    s_waitcnt lgkmcnt(14)
    v_mfma_f32_16x16x32_bf16 v[124:127], v[24:27], v[88:91], 0
    s_waitcnt lgkmcnt(12)
    v_mfma_f32_16x16x32_bf16 v[124:127], v[28:31], v[92:95], v[124:127]
    s_waitcnt lgkmcnt(10)
    v_mfma_f32_16x16x32_bf16 v[128:131], v[32:35], v[88:91], 0
    s_waitcnt lgkmcnt(8)
    v_mfma_f32_16x16x32_bf16 v[128:131], v[36:39], v[92:95], v[128:131]
    s_waitcnt lgkmcnt(6)
    v_mfma_f32_16x16x32_bf16 v[132:135], v[40:43], v[88:91], 0
    s_waitcnt lgkmcnt(4)
    v_mfma_f32_16x16x32_bf16 v[132:135], v[44:47], v[92:95], v[132:135]
    s_waitcnt lgkmcnt(2)
    v_mfma_f32_16x16x32_bf16 v[136:139], v[48:51], v[88:91], 0
    s_waitcnt lgkmcnt(0)
    v_mfma_f32_16x16x32_bf16 v[136:139], v[52:55], v[92:95], v[136:139]
    s_not_b64 exec, s[56:57]
    v_perm_b32 v120, v120, v144, s60
    v_perm_b32 v121, v121, v144, s61
    v_perm_b32 v122, v122, v144, s62
    v_perm_b32 v123, v123, v144, s63
    s_mov_b32 s12, 0
    buffer_store_dwordx4 v[120:123], v143, s[52:55], s12 offen sc1
    v_perm_b32 v124, v124, v144, s60
    v_perm_b32 v125, v125, v144, s61
    v_perm_b32 v126, v126, v144, s62
    v_perm_b32 v127, v127, v144, s63
    s_mov_b32 s12, 294912
    buffer_store_dwordx4 v[124:127], v143, s[52:55], s12 offen sc1
    v_perm_b32 v128, v128, v144, s60
    v_perm_b32 v129, v129, v144, s61
    v_perm_b32 v130, v130, v144, s62
    v_perm_b32 v131, v131, v144, s63
    s_mov_b32 s12, 589824
    buffer_store_dwordx4 v[128:131], v143, s[52:55], s12 offen sc1
    v_perm_b32 v132, v132, v144, s60
    v_perm_b32 v133, v133, v144, s61
    v_perm_b32 v134, v134, v144, s62
    v_perm_b32 v135, v135, v144, s63
    s_mov_b32 s12, 884736
    buffer_store_dwordx4 v[132:135], v143, s[52:55], s12 offen sc1
    s_cmp_ge_u32 s3, 4
    s_cbranch_scc1 F_DONE
    v_perm_b32 v136, v136, v144, s60
    v_perm_b32 v137, v137, v144, s61
    v_perm_b32 v138, v138, v144, s62
    v_perm_b32 v139, v139, v144, s63
    s_mov_b32 s12, 1179648
    buffer_store_dwordx4 v[136:139], v143, s[52:55], s12 offen sc1
F_DONE:
    s_mov_b64 exec, -1
    s_endpgm
HELPER:
    s_cmp_ge_u32 s3, 6
    s_cbranch_scc1 K_END
    s_sub_u32 s8, s5, 9
    s_mul_i32 s8, s8, 4
    s_add_u32 s12, s3, s8
    s_add_u32 s12, s12, 165
    v_mul_u32_u24 v5, 57, v2
    v_lshrrev_b32 v5, 9, v5
    v_mul_u32_u24 v6, 9, v5
    v_sub_u32 v6, v2, v6
    v_mul_u32_u24 v5, 9216, v5
    v_lshl_add_u32 v5, v6, 7, v5
    s_mul_i32 s8, s4, 1152
    v_add_u32 v5, s8, v5
    s_mul_i32 s8, s4, 663552
    s_sub_u32 s8, s8, 1359872
    v_lshl_add_u32 v6, v2, 7, s8
    s_waitcnt lgkmcnt(0)
    s_bitcmp1_b32 s12, 0
    s_cselect_b32 s52, s40, s38
    s_cselect_b32 s53, s41, s39
    s_mov_b32 s54, 5308416
    s_mov_b32 s55, 0x20000
    s_mov_b32 s56, s42
    s_mov_b32 s57, s43
    s_mov_b32 s58, 5308416
    s_mov_b32 s59, 0x20000
    s_barrier
    s_cmp_ge_u32 s12, 166
    s_cbranch_scc1 PF_13
    s_lshr_b32 s8, s12, 1
    s_mul_i32 s8, s8, 64512
    buffer_load_dword v8, v5, s[52:55], s8 offen
    s_branch PF_13_D
PF_13:
    s_min_u32 s8, s12, 246
    s_lshl_b32 s8, s8, 13
    v_add_u32 v7, s8, v6
    buffer_load_dword v8, v7, s[56:59], 0 offen
PF_13_D:
    s_add_u32 s12, s12, 20
    s_waitcnt vmcnt(0)
    s_cmp_ge_u32 s12, 166
    s_cbranch_scc1 PF_14
    s_lshr_b32 s8, s12, 1
    s_mul_i32 s8, s8, 64512
    buffer_load_dword v8, v5, s[52:55], s8 offen
    s_branch PF_14_D
PF_14:
    s_min_u32 s8, s12, 246
    s_lshl_b32 s8, s8, 13
    v_add_u32 v7, s8, v6
    buffer_load_dword v8, v7, s[56:59], 0 offen
PF_14_D:
    s_add_u32 s12, s12, 20
    s_waitcnt vmcnt(0)
    s_cmp_ge_u32 s12, 166
    s_cbranch_scc1 PF_15
    s_lshr_b32 s8, s12, 1
    s_mul_i32 s8, s8, 64512
    buffer_load_dword v8, v5, s[52:55], s8 offen
    s_branch PF_15_D
PF_15:
    s_min_u32 s8, s12, 246
    s_lshl_b32 s8, s8, 13
    v_add_u32 v7, s8, v6
    buffer_load_dword v8, v7, s[56:59], 0 offen
PF_15_D:
    s_add_u32 s12, s12, 20
    s_waitcnt vmcnt(0)
    s_cmp_ge_u32 s12, 166
    s_cbranch_scc1 PF_16
    s_lshr_b32 s8, s12, 1
    s_mul_i32 s8, s8, 64512
    buffer_load_dword v8, v5, s[52:55], s8 offen
    s_branch PF_16_D
PF_16:
    s_min_u32 s8, s12, 246
    s_lshl_b32 s8, s8, 13
    v_add_u32 v7, s8, v6
    buffer_load_dword v8, v7, s[56:59], 0 offen
PF_16_D:
    s_add_u32 s12, s12, 20
    s_endpgm
C_KGEN:
    s_and_b32 s12, s3, 3
    s_lshr_b32 s13, s3, 2
    s_lshl_b32 s14, s7, 2
    s_add_u32 s14, s14, s12
    s_lshl_b32 s8, s14, 8
    v_lshl_add_u32 v5, v2, 2, s8
    s_lshl_b32 s55, s7, 3
    s_setprio 2
    s_mul_i32 s15, s3, 4608
    s_add_u32 s15, s15, 256
    s_mul_i32 s52, s12, 8960
    s_add_u32 s52, s52, 37120
    s_mul_i32 s53, s12, 4640
    s_add_u32 s53, s53, 72960
    v_mul_u32_u24 v7, 288, v3
    v_lshl_add_u32 v7, v4, 4, v7
    v_add_u32 v7, s15, v7
    s_mov_b32 m0, s15
    s_lshl_b32 s11, s13, 4
    s_sub_u32 s11, 16, s11
    s_waitcnt lgkmcnt(0)
    s_load_dwordx2 s[58:59], s[30:31], s55
    global_load_dword v16, v5, s[18:19]
    global_load_dword v17, v5, s[20:21]
    global_load_dword v18, v5, s[22:23]
    global_load_dword v19, v5, s[24:25]
    global_load_dword v20, v5, s[26:27]
    global_load_dword v21, v5, s[28:29]
    s_barrier
    s_cmp_eq_u32 s13, 0
    s_cbranch_scc1 C_SETA
    v_mov_b32 v24, 0
    v_mov_b32 v25, 0
    v_mov_b32 v26, 0
    v_mov_b32 v27, 0
    v_bfe_u32 v8, v2, 2, 2
    v_mul_u32_u24 v8, 2240, v8
    v_and_b32 v9, 3, v2
    v_lshl_add_u32 v10, v9, 4, v8
    v_add_u32 v10, s52, v10
    ds_write_b128 v10, v[24:27] offset:2096
    v_and_b32 v9, 1, v2
    v_lshl_add_u32 v10, v9, 4, v8
    v_add_u32 v10, s52, v10
    ds_write_b128 v10, v[24:27]
    v_min_u32 v9, 29, v2
    v_lshl_add_u32 v10, v9, 4, s53
    ds_write_b128 v10, v[24:27] offset:4096
    s_branch C_SETD
C_SETA:
    v_lshl_add_u32 v8, v4, 3, v3
    v_sub_u32 v8, 39, v8
    s_mov_b32 s8, 0x3c000000
    v_mov_b32 v10, 127
    v_mov_b32 v11, 0
    v_lshlrev_b64 v[10:11], v8, v[10:11]
    v_alignbit_b32 v10, v11, v10, 19
    v_bfe_i32 v11, v10, 0, 1
    v_bfe_i32 v12, v10, 1, 1
    v_and_b32 v11, 0x3c00, v11
    v_and_or_b32 v142, v12, s8, v11
    v_bfe_i32 v11, v10, 2, 1
    v_bfe_i32 v12, v10, 3, 1
    v_and_b32 v11, 0x3c00, v11
    v_and_or_b32 v143, v12, s8, v11
    v_bfe_i32 v11, v10, 4, 1
    v_bfe_i32 v12, v10, 5, 1
    v_and_b32 v11, 0x3c00, v11
    v_and_or_b32 v144, v12, s8, v11
    v_bfe_i32 v11, v10, 6, 1
    v_bfe_i32 v12, v10, 7, 1
    v_and_b32 v11, 0x3c00, v11
    v_and_or_b32 v145, v12, s8, v11
    v_mov_b32 v10, 511
    v_mov_b32 v11, 0
    v_lshlrev_b64 v[10:11], v8, v[10:11]
    v_alignbit_b32 v10, v11, v10, 20
    v_bfe_i32 v11, v10, 0, 1
    v_bfe_i32 v12, v10, 1, 1
    v_and_b32 v11, 0x3c00, v11
    v_and_or_b32 v146, v12, s8, v11
    v_bfe_i32 v11, v10, 2, 1
    v_bfe_i32 v12, v10, 3, 1
    v_and_b32 v11, 0x3c00, v11
    v_and_or_b32 v147, v12, s8, v11
    v_bfe_i32 v11, v10, 4, 1
    v_bfe_i32 v12, v10, 5, 1
    v_and_b32 v11, 0x3c00, v11
    v_and_or_b32 v148, v12, s8, v11
    v_bfe_i32 v11, v10, 6, 1
    v_bfe_i32 v12, v10, 7, 1
    v_and_b32 v11, 0x3c00, v11
    v_and_or_b32 v149, v12, s8, v11
C_SETD:
    s_waitcnt lgkmcnt(0)
    s_lshl_b32 s8, s12, 4
    s_lshr_b64 s[58:59], s[58:59], s8
    s_lshl_b32 s8, s58, 16
    v_mov_b32 v44, s8
    v_mul_f32 v45, 0x3fb8aa3b, v44
    v_mov_b32 v46, 0x3fb8aa3b
    v_fma_f32 v46, v44, v46, -v45
    v_mov_b32 v47, 0x32a57060
    v_fma_f32 v46, v44, v47, v46
    v_exp_f32 v45, v45
    v_mul_f32 v46, 0x3f317218, v46
    v_fma_f32 v45, v45, v46, v45
    v_cvt_pk_bf16_f32 v45, v45, v45
    v_and_b32 v36, 0xffff0000, v45
    s_waitcnt vmcnt(0)
    s_mov_b32 s8, 0x7fff7fff
    v_and_b32 v46, s8, v18
    v_and_b32 v47, s8, v19
    v_and_b32 v48, s8, v20
    v_and_b32 v49, s8, v21
    v_pk_max_u16 v46, v46, v47
    v_pk_max_u16 v48, v48, v49
    v_lshlrev_b32 v44, 16, v46
    v_and_b32 v45, 0xffff0000, v46
    v_lshlrev_b32 v46, 16, v48
    v_and_b32 v47, 0xffff0000, v48
    v_mul_f32 v44, v44, v46
    v_mul_f32 v45, v45, v47
    v_max_f32 v44, v44, v45
    v_mul_f32 v44, v44, v36
    v_lshlrev_b32 v16, s11, v16
    v_lshlrev_b32 v17, s11, v17
    v_max_u32_dpp v44, v44, v44 row_shr:1 row_mask:0xf bank_mask:0xf
    v_lshlrev_b32 v18, s11, v18
    v_lshlrev_b32 v19, s11, v19
    v_max_u32_dpp v44, v44, v44 row_shr:2 row_mask:0xf bank_mask:0xf
    v_lshlrev_b32 v20, s11, v20
    v_lshlrev_b32 v21, s11, v21
    v_max_u32_dpp v44, v44, v44 row_shr:4 row_mask:0xf bank_mask:0xf
    v_and_b32 v16, 0xffff0000, v16
    v_and_b32 v17, 0xffff0000, v17
    v_max_u32_dpp v44, v44, v44 row_shr:8 row_mask:0xf bank_mask:0xf
    v_and_b32 v18, 0xffff0000, v18
    v_and_b32 v19, 0xffff0000, v19
    v_max_u32_dpp v44, v44, v44 row_bcast:15 row_mask:0xa bank_mask:0xf
    v_and_b32 v20, 0xffff0000, v20
    v_and_b32 v21, 0xffff0000, v21
    v_max_u32_dpp v44, v44, v44 row_bcast:31 row_mask:0xc bank_mask:0xf
    v_mul_f32 v37, 0x3fb8aa3b, v36
    v_readlane_b32 s8, v44, 63
    v_mul_f32 v38, 0x3e22f983, v36
    v_mul_f32 v40, v16, v37
    v_mul_f32 v41, v17, v38
    s_lshr_b32 s8, s8, 23
    s_sub_u32 s8, 258, s8
    s_min_u32 s8, s8, 253
    s_sub_u32 s54, 127, s8
    s_lshl_b32 s8, s8, 23
    v_exp_f32 v24, v40
    v_fract_f32 v47, v41
    v_cos_f32 v46, v47
    v_sin_f32 v47, v47
    v_mul_f32 v46, v24, v46
    v_mul_f32 v47, v24, v47
    v_mul_f32 v18, v18, v36
    v_mul_f32 v19, v19, v36
    v_pk_mul_f32 v[42:43], v[20:21], v[18:19] op_sel:[0,0] op_sel_hi:[0,1]
    v_pk_fma_f32 v[42:43], v[20:21], v[18:19], v[42:43] op_sel:[1,1,0] op_sel_hi:[1,0,1] neg_lo:[0,1,0]
    v_mul_f32 v42, s8, v42
    v_mul_f32 v43, s8, v43
    v_pk_mul_f32 v[48:49], v[46:47], v[46:47] op_sel:[0,0] op_sel_hi:[0,1]
    v_pk_fma_f32 v[48:49], v[46:47], v[46:47], v[48:49] op_sel:[1,1,0] op_sel_hi:[1,0,1] neg_lo:[0,1,0]
    v_pk_mul_f32 v[52:53], v[48:49], v[48:49] op_sel:[0,0] op_sel_hi:[0,1]
    v_pk_fma_f32 v[52:53], v[48:49], v[48:49], v[52:53] op_sel:[1,1,0] op_sel_hi:[1,0,1] neg_lo:[0,1,0]
    v_pk_mul_f32 v[60:61], v[52:53], v[52:53] op_sel:[0,0] op_sel_hi:[0,1]
    v_pk_fma_f32 v[60:61], v[52:53], v[52:53], v[60:61] op_sel:[1,1,0] op_sel_hi:[1,0,1] neg_lo:[0,1,0]
    v_mov_b32 v30, 0x3c00
    v_xor_b32 v61, 0x80000000, v61
    ds_write_addtid_b32 v30
    v_cvt_pk_f16_f32 v26, v60, v61
    ds_write_addtid_b32 v26 offset:288
    v_pk_mul_f32 v[62:63], v[60:61], v[60:61] op_sel:[0,0] op_sel_hi:[0,1]
    v_pk_fma_f32 v[62:63], v[60:61], v[60:61], v[62:63] op_sel:[1,1,0] op_sel_hi:[1,0,1] neg_lo:[0,1,0]
    v_cvt_pk_f16_f32 v27, v62, v63
    ds_write_addtid_b32 v27 offset:576
    v_pk_mul_f32 v[64:65], v[62:63], v[60:61] op_sel:[0,0] op_sel_hi:[0,1]
    v_pk_fma_f32 v[64:65], v[62:63], v[60:61], v[64:65] op_sel:[1,1,0] op_sel_hi:[1,0,1] neg_lo:[0,1,0]
    v_cvt_pk_f16_f32 v28, v64, v65
    ds_write_addtid_b32 v28 offset:864
    v_pk_mul_f32 v[62:63], v[64:65], v[60:61] op_sel:[0,0] op_sel_hi:[0,1]
    v_pk_fma_f32 v[62:63], v[64:65], v[60:61], v[62:63] op_sel:[1,1,0] op_sel_hi:[1,0,1] neg_lo:[0,1,0]
    v_cvt_pk_f16_f32 v29, v62, v63
    ds_write_addtid_b32 v29 offset:1152
    v_pk_mul_f32 v[64:65], v[62:63], v[60:61] op_sel:[0,0] op_sel_hi:[0,1]
    v_pk_fma_f32 v[64:65], v[62:63], v[60:61], v[64:65] op_sel:[1,1,0] op_sel_hi:[1,0,1] neg_lo:[0,1,0]
    v_cvt_pk_f16_f32 v26, v64, v65
    ds_write_addtid_b32 v26 offset:1440
    v_pk_mul_f32 v[62:63], v[64:65], v[60:61] op_sel:[0,0] op_sel_hi:[0,1]
    v_pk_fma_f32 v[62:63], v[64:65], v[60:61], v[62:63] op_sel:[1,1,0] op_sel_hi:[1,0,1] neg_lo:[0,1,0]
    v_cvt_pk_f16_f32 v27, v62, v63
    ds_write_addtid_b32 v27 offset:1728
    v_pk_mul_f32 v[64:65], v[62:63], v[60:61] op_sel:[0,0] op_sel_hi:[0,1]
    v_pk_fma_f32 v[64:65], v[62:63], v[60:61], v[64:65] op_sel:[1,1,0] op_sel_hi:[1,0,1] neg_lo:[0,1,0]
    v_cvt_pk_f16_f32 v28, v64, v65
    ds_write_addtid_b32 v28 offset:2016
    v_pk_mul_f32 v[62:63], v[64:65], v[60:61] op_sel:[0,0] op_sel_hi:[0,1]
    v_pk_fma_f32 v[62:63], v[64:65], v[60:61], v[62:63] op_sel:[1,1,0] op_sel_hi:[1,0,1] neg_lo:[0,1,0]
    v_cvt_pk_f16_f32 v29, v62, v63
    ds_write_addtid_b32 v29 offset:2304
    v_pk_mul_f32 v[64:65], v[62:63], v[60:61] op_sel:[0,0] op_sel_hi:[0,1]
    v_pk_fma_f32 v[64:65], v[62:63], v[60:61], v[64:65] op_sel:[1,1,0] op_sel_hi:[1,0,1] neg_lo:[0,1,0]
    v_cvt_pk_f16_f32 v26, v64, v65
    ds_write_addtid_b32 v26 offset:2592
    v_pk_mul_f32 v[62:63], v[64:65], v[60:61] op_sel:[0,0] op_sel_hi:[0,1]
    v_pk_fma_f32 v[62:63], v[64:65], v[60:61], v[62:63] op_sel:[1,1,0] op_sel_hi:[1,0,1] neg_lo:[0,1,0]
    v_cvt_pk_f16_f32 v27, v62, v63
    ds_write_addtid_b32 v27 offset:2880
    v_pk_mul_f32 v[64:65], v[62:63], v[60:61] op_sel:[0,0] op_sel_hi:[0,1]
    v_pk_fma_f32 v[64:65], v[62:63], v[60:61], v[64:65] op_sel:[1,1,0] op_sel_hi:[1,0,1] neg_lo:[0,1,0]
    v_cvt_pk_f16_f32 v28, v64, v65
    ds_write_addtid_b32 v28 offset:3168
    v_pk_mul_f32 v[62:63], v[64:65], v[60:61] op_sel:[0,0] op_sel_hi:[0,1]
    v_pk_fma_f32 v[62:63], v[64:65], v[60:61], v[62:63] op_sel:[1,1,0] op_sel_hi:[1,0,1] neg_lo:[0,1,0]
    v_cvt_pk_f16_f32 v29, v62, v63
    ds_write_addtid_b32 v29 offset:3456
    v_pk_mul_f32 v[64:65], v[62:63], v[60:61] op_sel:[0,0] op_sel_hi:[0,1]
    v_pk_fma_f32 v[64:65], v[62:63], v[60:61], v[64:65] op_sel:[1,1,0] op_sel_hi:[1,0,1] neg_lo:[0,1,0]
    v_cvt_pk_f16_f32 v26, v64, v65
    ds_write_addtid_b32 v26 offset:3744
    v_pk_mul_f32 v[62:63], v[64:65], v[60:61] op_sel:[0,0] op_sel_hi:[0,1]
    v_pk_fma_f32 v[62:63], v[64:65], v[60:61], v[62:63] op_sel:[1,1,0] op_sel_hi:[1,0,1] neg_lo:[0,1,0]
    v_cvt_pk_f16_f32 v27, v62, v63
    ds_write_addtid_b32 v27 offset:4032
    v_pk_mul_f32 v[64:65], v[62:63], v[60:61] op_sel:[0,0] op_sel_hi:[0,1]
    v_pk_fma_f32 v[64:65], v[62:63], v[60:61], v[64:65] op_sel:[1,1,0] op_sel_hi:[1,0,1] neg_lo:[0,1,0]
    v_cvt_pk_f16_f32 v28, v64, v65
    ds_write_addtid_b32 v28 offset:4320
    ds_read_b128 v[72:75], v7 offset:0
    ds_read_b128 v[76:79], v7 offset:64
    ds_read_b128 v[80:83], v7 offset:128
    ds_read_b128 v[84:87], v7 offset:192
    v_mul_f32 v44, 0x43000000, v40
    v_mul_f32 v45, 0x43000000, v41
    v_exp_f32 v24, v44
    v_fract_f32 v45, v45
    v_cos_f32 v44, v45
    v_sin_f32 v45, v45
    v_mul_f32 v44, v24, v44
    v_mul_f32 v45, v24, v45
    v_pk_mul_f32 v[50:51], v[48:49], v[46:47] op_sel:[0,0] op_sel_hi:[0,1]
    v_pk_fma_f32 v[50:51], v[48:49], v[46:47], v[50:51] op_sel:[1,1,0] op_sel_hi:[1,0,1] neg_lo:[0,1,0]
    v_pk_mul_f32 v[54:55], v[52:53], v[46:47] op_sel:[0,0] op_sel_hi:[0,1]
    v_pk_fma_f32 v[54:55], v[52:53], v[46:47], v[54:55] op_sel:[1,1,0] op_sel_hi:[1,0,1] neg_lo:[0,1,0]
    v_pk_mul_f32 v[56:57], v[50:51], v[50:51] op_sel:[0,0] op_sel_hi:[0,1]
    v_pk_fma_f32 v[56:57], v[50:51], v[50:51], v[56:57] op_sel:[1,1,0] op_sel_hi:[1,0,1] neg_lo:[0,1,0]
    v_pk_mul_f32 v[58:59], v[56:57], v[46:47] op_sel:[0,0] op_sel_hi:[0,1]
    v_pk_fma_f32 v[58:59], v[56:57], v[46:47], v[58:59] op_sel:[1,1,0] op_sel_hi:[1,0,1] neg_lo:[0,1,0]
    v_cvt_pk_f16_f32 v29, v42, v43
    ds_write_addtid_b32 v29 offset:0
    v_pk_mul_f32 v[60:61], v[42:43], v[46:47] op_sel:[0,0] op_sel_hi:[0,1]
    v_pk_fma_f32 v[60:61], v[42:43], v[46:47], v[60:61] op_sel:[1,1,0] op_sel_hi:[1,0,1] neg_lo:[0,1,0]
    v_cvt_pk_f16_f32 v26, v60, v61
    ds_write_addtid_b32 v26 offset:288
    v_pk_mul_f32 v[62:63], v[42:43], v[48:49] op_sel:[0,0] op_sel_hi:[0,1]
    v_pk_fma_f32 v[62:63], v[42:43], v[48:49], v[62:63] op_sel:[1,1,0] op_sel_hi:[1,0,1] neg_lo:[0,1,0]
    v_cvt_pk_f16_f32 v27, v62, v63
    ds_write_addtid_b32 v27 offset:576
    v_pk_mul_f32 v[60:61], v[42:43], v[50:51] op_sel:[0,0] op_sel_hi:[0,1]
    v_pk_fma_f32 v[60:61], v[42:43], v[50:51], v[60:61] op_sel:[1,1,0] op_sel_hi:[1,0,1] neg_lo:[0,1,0]
    v_cvt_pk_f16_f32 v28, v60, v61
    ds_write_addtid_b32 v28 offset:864
    v_pk_mul_f32 v[62:63], v[42:43], v[52:53] op_sel:[0,0] op_sel_hi:[0,1]
    v_pk_fma_f32 v[62:63], v[42:43], v[52:53], v[62:63] op_sel:[1,1,0] op_sel_hi:[1,0,1] neg_lo:[0,1,0]
    v_cvt_pk_f16_f32 v29, v62, v63
    ds_write_addtid_b32 v29 offset:1152
    v_pk_mul_f32 v[60:61], v[42:43], v[54:55] op_sel:[0,0] op_sel_hi:[0,1]
    v_pk_fma_f32 v[60:61], v[42:43], v[54:55], v[60:61] op_sel:[1,1,0] op_sel_hi:[1,0,1] neg_lo:[0,1,0]
    v_cvt_pk_f16_f32 v26, v60, v61
    ds_write_addtid_b32 v26 offset:1440
    v_pk_mul_f32 v[62:63], v[42:43], v[56:57] op_sel:[0,0] op_sel_hi:[0,1]
    v_pk_fma_f32 v[62:63], v[42:43], v[56:57], v[62:63] op_sel:[1,1,0] op_sel_hi:[1,0,1] neg_lo:[0,1,0]
    v_cvt_pk_f16_f32 v27, v62, v63
    ds_write_addtid_b32 v27 offset:1728
    v_pk_mul_f32 v[60:61], v[42:43], v[58:59] op_sel:[0,0] op_sel_hi:[0,1]
    v_pk_fma_f32 v[60:61], v[42:43], v[58:59], v[60:61] op_sel:[1,1,0] op_sel_hi:[1,0,1] neg_lo:[0,1,0]
    v_cvt_pk_f16_f32 v28, v60, v61
    ds_write_addtid_b32 v28 offset:2016
    v_pk_mul_f32 v[66:67], v[42:43], v[44:45] op_sel:[0,0] op_sel_hi:[0,1]
    v_pk_fma_f32 v[66:67], v[42:43], v[44:45], v[66:67] op_sel:[1,1,0] op_sel_hi:[1,0,1] neg_lo:[0,1,0]
    v_cvt_pk_f16_f32 v29, v66, v67
    ds_write_addtid_b32 v29 offset:2304
    v_pk_mul_f32 v[62:63], v[66:67], v[46:47] op_sel:[0,0] op_sel_hi:[0,1]
    v_pk_fma_f32 v[62:63], v[66:67], v[46:47], v[62:63] op_sel:[1,1,0] op_sel_hi:[1,0,1] neg_lo:[0,1,0]
    v_cvt_pk_f16_f32 v26, v62, v63
    ds_write_addtid_b32 v26 offset:2592
    v_pk_mul_f32 v[60:61], v[66:67], v[48:49] op_sel:[0,0] op_sel_hi:[0,1]
    v_pk_fma_f32 v[60:61], v[66:67], v[48:49], v[60:61] op_sel:[1,1,0] op_sel_hi:[1,0,1] neg_lo:[0,1,0]
    v_cvt_pk_f16_f32 v27, v60, v61
    ds_write_addtid_b32 v27 offset:2880
    v_pk_mul_f32 v[62:63], v[66:67], v[50:51] op_sel:[0,0] op_sel_hi:[0,1]
    v_pk_fma_f32 v[62:63], v[66:67], v[50:51], v[62:63] op_sel:[1,1,0] op_sel_hi:[1,0,1] neg_lo:[0,1,0]
    v_cvt_pk_f16_f32 v28, v62, v63
    ds_write_addtid_b32 v28 offset:3168
    v_pk_mul_f32 v[60:61], v[66:67], v[52:53] op_sel:[0,0] op_sel_hi:[0,1]
    v_pk_fma_f32 v[60:61], v[66:67], v[52:53], v[60:61] op_sel:[1,1,0] op_sel_hi:[1,0,1] neg_lo:[0,1,0]
    v_cvt_pk_f16_f32 v29, v60, v61
    ds_write_addtid_b32 v29 offset:3456
    v_pk_mul_f32 v[62:63], v[66:67], v[54:55] op_sel:[0,0] op_sel_hi:[0,1]
    v_pk_fma_f32 v[62:63], v[66:67], v[54:55], v[62:63] op_sel:[1,1,0] op_sel_hi:[1,0,1] neg_lo:[0,1,0]
    v_cvt_pk_f16_f32 v26, v62, v63
    ds_write_addtid_b32 v26 offset:3744
    v_pk_mul_f32 v[60:61], v[66:67], v[56:57] op_sel:[0,0] op_sel_hi:[0,1]
    v_pk_fma_f32 v[60:61], v[66:67], v[56:57], v[60:61] op_sel:[1,1,0] op_sel_hi:[1,0,1] neg_lo:[0,1,0]
    v_cvt_pk_f16_f32 v27, v60, v61
    ds_write_addtid_b32 v27 offset:4032
    v_pk_mul_f32 v[62:63], v[66:67], v[58:59] op_sel:[0,0] op_sel_hi:[0,1]
    v_pk_fma_f32 v[62:63], v[66:67], v[58:59], v[62:63] op_sel:[1,1,0] op_sel_hi:[1,0,1] neg_lo:[0,1,0]
    v_cvt_pk_f16_f32 v28, v62, v63
    ds_write_addtid_b32 v28 offset:4320
    v_pk_mul_f32 v[68:69], v[66:67], v[44:45] op_sel:[0,0] op_sel_hi:[0,1]
    v_pk_fma_f32 v[68:69], v[66:67], v[44:45], v[68:69] op_sel:[1,1,0] op_sel_hi:[1,0,1] neg_lo:[0,1,0]
    ds_read_b128 v[88:91], v7 offset:0
    ds_read_b128 v[92:95], v7 offset:64
    ds_read_b128 v[96:99], v7 offset:128
    ds_read_b128 v[100:103], v7 offset:192
    v_cvt_pk_f16_f32 v29, v68, v69
    ds_write_addtid_b32 v29 offset:0
    v_pk_mul_f32 v[60:61], v[68:69], v[48:49] op_sel:[0,0] op_sel_hi:[0,1]
    v_pk_fma_f32 v[60:61], v[68:69], v[48:49], v[60:61] op_sel:[1,1,0] op_sel_hi:[1,0,1] neg_lo:[0,1,0]
    v_cvt_pk_f16_f32 v26, v60, v61
    ds_write_addtid_b32 v26 offset:288
    v_pk_mul_f32 v[62:63], v[68:69], v[52:53] op_sel:[0,0] op_sel_hi:[0,1]
    v_pk_fma_f32 v[62:63], v[68:69], v[52:53], v[62:63] op_sel:[1,1,0] op_sel_hi:[1,0,1] neg_lo:[0,1,0]
    v_cvt_pk_f16_f32 v27, v62, v63
    ds_write_addtid_b32 v27 offset:576
    v_pk_mul_f32 v[60:61], v[68:69], v[56:57] op_sel:[0,0] op_sel_hi:[0,1]
    v_pk_fma_f32 v[60:61], v[68:69], v[56:57], v[60:61] op_sel:[1,1,0] op_sel_hi:[1,0,1] neg_lo:[0,1,0]
    v_cvt_pk_f16_f32 v28, v60, v61
    ds_write_addtid_b32 v28 offset:864
    v_pk_mul_f32 v[66:67], v[68:69], v[44:45] op_sel:[0,0] op_sel_hi:[0,1]
    v_pk_fma_f32 v[66:67], v[68:69], v[44:45], v[66:67] op_sel:[1,1,0] op_sel_hi:[1,0,1] neg_lo:[0,1,0]
    v_cvt_pk_f16_f32 v29, v66, v67
    ds_write_addtid_b32 v29 offset:1152
    s_waitcnt lgkmcnt(8)
    v_mfma_f32_16x16x32_f16 v[104:107], v[88:91], v[72:75], 0
    v_pk_mul_f32 v[62:63], v[66:67], v[48:49] op_sel:[0,0] op_sel_hi:[0,1]
    v_pk_fma_f32 v[62:63], v[66:67], v[48:49], v[62:63] op_sel:[1,1,0] op_sel_hi:[1,0,1] neg_lo:[0,1,0]
    v_cvt_pk_f16_f32 v26, v62, v63
    ds_write_addtid_b32 v26 offset:1440
    s_waitcnt lgkmcnt(8)
    v_mfma_f32_16x16x32_f16 v[104:107], v[92:95], v[76:79], v[104:107]
    v_pk_mul_f32 v[60:61], v[66:67], v[52:53] op_sel:[0,0] op_sel_hi:[0,1]
    v_pk_fma_f32 v[60:61], v[66:67], v[52:53], v[60:61] op_sel:[1,1,0] op_sel_hi:[1,0,1] neg_lo:[0,1,0]
    v_cvt_pk_f16_f32 v27, v60, v61
    ds_write_addtid_b32 v27 offset:1728
    s_waitcnt lgkmcnt(8)
    v_mfma_f32_16x16x32_f16 v[104:107], v[96:99], v[80:83], v[104:107]
    v_pk_mul_f32 v[62:63], v[66:67], v[56:57] op_sel:[0,0] op_sel_hi:[0,1]
    v_pk_fma_f32 v[62:63], v[66:67], v[56:57], v[62:63] op_sel:[1,1,0] op_sel_hi:[1,0,1] neg_lo:[0,1,0]
    v_cvt_pk_f16_f32 v28, v62, v63
    ds_write_addtid_b32 v28 offset:2016
    s_waitcnt lgkmcnt(8)
    v_mfma_f32_16x16x32_f16 v[104:107], v[100:103], v[84:87], v[104:107]
    v_pk_mul_f32 v[68:69], v[66:67], v[44:45] op_sel:[0,0] op_sel_hi:[0,1]
    v_pk_fma_f32 v[68:69], v[66:67], v[44:45], v[68:69] op_sel:[1,1,0] op_sel_hi:[1,0,1] neg_lo:[0,1,0]
    v_cvt_pk_f16_f32 v29, v68, v69
    ds_write_addtid_b32 v29 offset:2304
    v_pk_mul_f32 v[60:61], v[68:69], v[52:53] op_sel:[0,0] op_sel_hi:[0,1]
    v_pk_fma_f32 v[60:61], v[68:69], v[52:53], v[60:61] op_sel:[1,1,0] op_sel_hi:[1,0,1] neg_lo:[0,1,0]
    v_cvt_pk_f16_f32 v26, v60, v61
    ds_write_addtid_b32 v26 offset:2592
    v_pk_mul_f32 v[66:67], v[68:69], v[44:45] op_sel:[0,0] op_sel_hi:[0,1]
    v_pk_fma_f32 v[66:67], v[68:69], v[44:45], v[66:67] op_sel:[1,1,0] op_sel_hi:[1,0,1] neg_lo:[0,1,0]
    v_cvt_pk_f16_f32 v27, v66, v67
    ds_write_addtid_b32 v27 offset:2880
    v_pk_mul_f32 v[62:63], v[66:67], v[52:53] op_sel:[0,0] op_sel_hi:[0,1]
    v_pk_fma_f32 v[62:63], v[66:67], v[52:53], v[62:63] op_sel:[1,1,0] op_sel_hi:[1,0,1] neg_lo:[0,1,0]
    v_cvt_pk_f16_f32 v28, v62, v63
    ds_write_addtid_b32 v28 offset:3168
    v_pk_mul_f32 v[68:69], v[66:67], v[44:45] op_sel:[0,0] op_sel_hi:[0,1]
    v_pk_fma_f32 v[68:69], v[66:67], v[44:45], v[68:69] op_sel:[1,1,0] op_sel_hi:[1,0,1] neg_lo:[0,1,0]
    v_cvt_pk_f16_f32 v29, v68, v69
    ds_write_addtid_b32 v29 offset:3456
    v_pk_mul_f32 v[60:61], v[68:69], v[52:53] op_sel:[0,0] op_sel_hi:[0,1]
    v_pk_fma_f32 v[60:61], v[68:69], v[52:53], v[60:61] op_sel:[1,1,0] op_sel_hi:[1,0,1] neg_lo:[0,1,0]
    v_cvt_pk_f16_f32 v26, v60, v61
    ds_write_addtid_b32 v26 offset:3744
    v_pk_mul_f32 v[66:67], v[68:69], v[44:45] op_sel:[0,0] op_sel_hi:[0,1]
    v_pk_fma_f32 v[66:67], v[68:69], v[44:45], v[66:67] op_sel:[1,1,0] op_sel_hi:[1,0,1] neg_lo:[0,1,0]
    v_cvt_pk_f16_f32 v27, v66, v67
    ds_write_addtid_b32 v27 offset:4032
    v_pk_mul_f32 v[62:63], v[66:67], v[52:53] op_sel:[0,0] op_sel_hi:[0,1]
    v_pk_fma_f32 v[62:63], v[66:67], v[52:53], v[62:63] op_sel:[1,1,0] op_sel_hi:[1,0,1] neg_lo:[0,1,0]
    v_cvt_pk_f16_f32 v28, v62, v63
    ds_write_addtid_b32 v28 offset:4320
    v_pk_mul_f32 v[68:69], v[66:67], v[44:45] op_sel:[0,0] op_sel_hi:[0,1]
    v_pk_fma_f32 v[68:69], v[66:67], v[44:45], v[68:69] op_sel:[1,1,0] op_sel_hi:[1,0,1] neg_lo:[0,1,0]
    ds_read_b128 v[88:91], v7 offset:0
    ds_read_b128 v[92:95], v7 offset:64
    ds_read_b128 v[96:99], v7 offset:128
    ds_read_b128 v[100:103], v7 offset:192
    v_cvt_pk_f16_f32 v29, v68, v69
    ds_write_addtid_b32 v29 offset:0
    v_pk_mul_f32 v[66:67], v[68:69], v[44:45] op_sel:[0,0] op_sel_hi:[0,1]
    v_pk_fma_f32 v[66:67], v[68:69], v[44:45], v[66:67] op_sel:[1,1,0] op_sel_hi:[1,0,1] neg_lo:[0,1,0]
    v_cvt_pk_f16_f32 v26, v66, v67
    ds_write_addtid_b32 v26 offset:288
    v_pk_mul_f32 v[68:69], v[66:67], v[44:45] op_sel:[0,0] op_sel_hi:[0,1]
    v_pk_fma_f32 v[68:69], v[66:67], v[44:45], v[68:69] op_sel:[1,1,0] op_sel_hi:[1,0,1] neg_lo:[0,1,0]
    v_cvt_pk_f16_f32 v27, v68, v69
    ds_write_addtid_b32 v27 offset:576
    v_pk_mul_f32 v[66:67], v[68:69], v[44:45] op_sel:[0,0] op_sel_hi:[0,1]
    v_pk_fma_f32 v[66:67], v[68:69], v[44:45], v[66:67] op_sel:[1,1,0] op_sel_hi:[1,0,1] neg_lo:[0,1,0]
    v_cvt_pk_f16_f32 v28, v66, v67
    ds_write_addtid_b32 v28 offset:864
    v_pk_mul_f32 v[68:69], v[66:67], v[44:45] op_sel:[0,0] op_sel_hi:[0,1]
    v_pk_fma_f32 v[68:69], v[66:67], v[44:45], v[68:69] op_sel:[1,1,0] op_sel_hi:[1,0,1] neg_lo:[0,1,0]
    v_cvt_pk_f16_f32 v29, v68, v69
    ds_write_addtid_b32 v29 offset:1152
    v_pk_mul_f32 v[66:67], v[68:69], v[44:45] op_sel:[0,0] op_sel_hi:[0,1]
    v_pk_fma_f32 v[66:67], v[68:69], v[44:45], v[66:67] op_sel:[1,1,0] op_sel_hi:[1,0,1] neg_lo:[0,1,0]
    s_waitcnt lgkmcnt(8)
    v_mfma_f32_16x16x32_f16 v[108:111], v[88:91], v[72:75], 0
    v_cvt_pk_f16_f32 v26, v66, v67
    ds_write_addtid_b32 v26 offset:1440
    v_pk_mul_f32 v[68:69], v[66:67], v[44:45] op_sel:[0,0] op_sel_hi:[0,1]
    v_pk_fma_f32 v[68:69], v[66:67], v[44:45], v[68:69] op_sel:[1,1,0] op_sel_hi:[1,0,1] neg_lo:[0,1,0]
    s_waitcnt lgkmcnt(8)
    v_mfma_f32_16x16x32_f16 v[108:111], v[92:95], v[76:79], v[108:111]
    v_cvt_pk_f16_f32 v27, v68, v69
    ds_write_addtid_b32 v27 offset:1728
    v_pk_mul_f32 v[66:67], v[68:69], v[44:45] op_sel:[0,0] op_sel_hi:[0,1]
    v_pk_fma_f32 v[66:67], v[68:69], v[44:45], v[66:67] op_sel:[1,1,0] op_sel_hi:[1,0,1] neg_lo:[0,1,0]
    s_waitcnt lgkmcnt(8)
    v_mfma_f32_16x16x32_f16 v[108:111], v[96:99], v[80:83], v[108:111]
    v_cvt_pk_f16_f32 v28, v66, v67
    ds_write_addtid_b32 v28 offset:2016
    v_pk_mul_f32 v[68:69], v[66:67], v[44:45] op_sel:[0,0] op_sel_hi:[0,1]
    v_pk_fma_f32 v[68:69], v[66:67], v[44:45], v[68:69] op_sel:[1,1,0] op_sel_hi:[1,0,1] neg_lo:[0,1,0]
    s_waitcnt lgkmcnt(8)
    v_mfma_f32_16x16x32_f16 v[108:111], v[100:103], v[84:87], v[108:111]
    v_cvt_pk_f16_f32 v29, v68, v69
    ds_write_addtid_b32 v29 offset:2304
    ds_read_b128 v[88:91], v7 offset:0
    ds_read_b128 v[92:95], v7 offset:64
    ds_read_b128 v[96:99], v7 offset:128
    ds_read_b128 v[100:103], v7 offset:192
    v_lshl_add_u32 v8, v2, 4, s15
    s_waitcnt lgkmcnt(3)
    v_mfma_f32_16x16x32_f16 v[112:115], v[88:91], v[72:75], 0
    s_waitcnt lgkmcnt(2)
    v_mfma_f32_16x16x32_f16 v[112:115], v[92:95], v[76:79], v[112:115]
    s_waitcnt lgkmcnt(1)
    v_mfma_f32_16x16x32_f16 v[112:115], v[96:99], v[80:83], v[112:115]
    s_waitcnt lgkmcnt(0)
    v_mfma_f32_16x16x32_f16 v[112:115], v[100:103], v[84:87], v[112:115]
    s_lshl_b32 s8, s12, 2
    s_add_u32 s8, s8, 16
    v_mov_b32 v9, s8
    s_cmp_eq_u32 s13, 0
    s_cbranch_scc1 C_KA
    ds_write_b128 v8, v[104:107] offset:0
    ds_write_b128 v8, v[108:111] offset:1024
    s_nop 0
    ds_write_b128 v8, v[112:115] offset:2048
    s_waitcnt lgkmcnt(0)
    v_mov_b32 v10, 1
    s_mov_b64 exec, 1
    ds_add_u32 v9, v10
    s_mov_b64 exec, -1
    s_branch C_KDONE
C_KA:
    v_lshrrev_b32 v10, 1, v4
    v_and_b32 v11, 1, v4
    v_lshlrev_b32 v10, 8, v10
    v_lshl_add_u32 v10, v11, 3, v10
    v_lshl_add_u32 v10, v3, 4, v10
    v_add_u32 v10, s15, v10
    v_cmp_gt_u32 vcc, 2, v4
    v_lshlrev_b32 v11, 2, v3
    v_lshlrev_b32 v12, 3, v3
    v_cndmask_b32 v11, v11, v12, vcc
    v_lshl_add_u32 v11, v4, 7, v11
    v_add_u32 v11, s15, v11
    v_mov_b32 v12, 64
    v_cndmask_b32 v12, v12, 4, vcc
    v_add_u32 v12, v12, v11
    v_lshlrev_b32 v13, 1, v3
    v_lshl_add_u32 v13, v4, 7, v13
    v_add_u32 v13, s15, v13
    v_lshlrev_b32 v14, 5, v2
    v_lshlrev_b32 v15, 4, v2
    v_add_u32 v15, 256, v15
    v_min_u32 v14, v14, v15
    v_lshlrev_b32 v15, 3, v2
    v_add_u32 v15, 512, v15
    v_min_u32 v14, v14, v15
    v_add_u32 v14, s15, v14
    v_min_u32 v15, 15, v2
    v_lshl_add_u32 v15, v15, 2, s15
    v_lshlrev_b32 v16, 2, v4
    v_sub_u32 v16, v3, v16
    v_lshl_add_u32 v16, v16, 2, s15
    v_add_u32 v16, 2100, v16
    v_lshl_add_u32 v17, v2, 5, s52
    s_mov_b32 s56, 0x01000100
    s_mov_b32 s57, 0x03020302
    s_mov_b32 s9, 0
SP_17:
    ds_read_b32 v18, v9
    s_waitcnt lgkmcnt(0)
    v_readfirstlane_b32 s8, v18
    s_add_u32 s9, s9, 1
    s_cmp_ge_u32 s8, 1
    s_cbranch_scc1 SP_17_D
    s_cmp_lt_u32 s9, 524288
    s_cbranch_scc1 SP_17
SP_17_D:
    ds_read_b128 v[88:91], v8 offset:18432
    ds_read_b128 v[92:95], v8 offset:19456
    ds_read_b128 v[96:99], v8 offset:20480
    s_waitcnt lgkmcnt(2)
    v_pk_add_f32 v[104:105], v[104:105], v[88:89]
    v_cvt_pk_f16_f32 v20, v104, v105
    v_pk_add_f32 v[106:107], v[106:107], v[90:91]
    v_cvt_pk_f16_f32 v21, v106, v107
    ds_write_b64 v10, v[20:21]
    s_waitcnt lgkmcnt(2)
    v_pk_add_f32 v[108:109], v[108:109], v[92:93]
    v_cvt_pk_f16_f32 v22, v108, v109
    v_pk_add_f32 v[110:111], v[110:111], v[94:95]
    v_cvt_pk_f16_f32 v23, v110, v111
    ds_write_b32 v11, v22 offset:512
    ds_write_b32 v12, v23 offset:512
    s_waitcnt lgkmcnt(3)
    v_pk_add_f32 v[112:113], v[112:113], v[96:97]
    v_cvt_pk_f16_f32 v24, v112, v113
    v_pk_add_f32 v[114:115], v[114:115], v[98:99]
    v_cvt_pk_f16_f32 v25, v114, v115
    ds_write_b16 v13, v24 offset:1024
    ds_read_b64 v[32:33], v14 offset:0
    ds_read_b64 v[34:35], v14 offset:8
    ds_read_b64 v[36:37], v14 offset:16
    ds_read_b64 v[38:39], v14 offset:24
    ds_write_b16 v13, v24 offset:2110
    ds_write_b16_d16_hi v13, v24 offset:2142
    ds_write_b16 v13, v25 offset:2174
    ds_write_b16_d16_hi v13, v25 offset:2206
    ds_write_b32 v15, v1 offset:2048
    ds_read2_b32 v[150:151], v16 offset0:3 offset1:2
    ds_read2_b32 v[152:153], v16 offset0:1 offset1:0
    ds_read2_b32 v[154:155], v16 offset0:19 offset1:18
    ds_read2_b32 v[156:157], v16 offset0:17 offset1:16
    ds_read2_b32 v[158:159], v16 offset0:35 offset1:34
    ds_read2_b32 v[160:161], v16 offset0:33 offset1:32
    ds_read2_b32 v[162:163], v16 offset0:51 offset1:50
    ds_read2_b32 v[164:165], v16 offset0:49 offset1:48
    s_mov_b32 exec_lo, 0xffff0000
    s_mov_b32 exec_hi, 0
    s_waitcnt lgkmcnt(13)
    v_alignbit_b32 v39, v36, v35, 16
    v_perm_b32 v38, v35, v35, s56
    v_alignbit_b32 v37, v35, v34, 16
    v_perm_b32 v36, v34, v34, s56
    v_alignbit_b32 v35, v34, v33, 16
    v_perm_b32 v34, v33, v33, s56
    v_alignbit_b32 v33, v33, v32, 16
    v_perm_b32 v32, v32, v32, s56
    s_mov_b32 exec_lo, 0
    s_mov_b32 exec_hi, -1
    v_perm_b32 v39, v34, v34, s56
    v_perm_b32 v38, v33, v33, s57
    v_mov_b32 v37, v33
    v_perm_b32 v36, v33, v33, s56
    v_perm_b32 v35, v33, v33, s56
    v_perm_b32 v34, v32, v32, s57
    v_mov_b32 v33, v32
    v_perm_b32 v32, v32, v32, s56
    s_mov_b64 exec, -1
    ds_write_b128 v17, v[32:35] offset:32
    ds_write_b128 v17, v[36:39] offset:48
    v_mov_b32_dpp v30, v38 wave_shr:1 row_mask:0xf bank_mask:0xf bound_ctrl:0
    v_mov_b32_dpp v31, v39 wave_shr:1 row_mask:0xf bank_mask:0xf bound_ctrl:0
    v_alignbit_b32 v44, v32, v31, 16
    v_alignbit_b32 v45, v33, v32, 16
    v_alignbit_b32 v46, v34, v33, 16
    v_alignbit_b32 v47, v35, v34, 16
    ds_write_b128 v17, v[44:47] offset:2272
    v_alignbit_b32 v48, v36, v35, 16
    v_alignbit_b32 v49, v37, v36, 16
    v_alignbit_b32 v50, v38, v37, 16
    v_alignbit_b32 v51, v39, v38, 16
    ds_write_b128 v17, v[48:51] offset:2288
    v_pk_mov_b32 v[52:53], v[30:31], v[32:33] op_sel:[1,0]
    v_pk_mov_b32 v[54:55], v[32:33], v[34:35] op_sel:[1,0]
    ds_write_b128 v17, v[52:55] offset:4512
    v_pk_mov_b32 v[56:57], v[34:35], v[36:37] op_sel:[1,0]
    v_pk_mov_b32 v[58:59], v[36:37], v[38:39] op_sel:[1,0]
    ds_write_b128 v17, v[56:59] offset:4528
    v_alignbit_b32 v60, v31, v30, 16
    v_alignbit_b32 v61, v32, v31, 16
    v_alignbit_b32 v62, v33, v32, 16
    v_alignbit_b32 v63, v34, v33, 16
    ds_write_b128 v17, v[60:63] offset:6752
    v_alignbit_b32 v64, v35, v34, 16
    v_alignbit_b32 v65, v36, v35, 16
    v_alignbit_b32 v66, v37, v36, 16
    v_alignbit_b32 v67, v38, v37, 16
    ds_write_b128 v17, v[64:67] offset:6768
    v_alignbit_b32 v72, v39, v38, 16
    v_mov_b32 v73, v39
    v_mov_b32 v74, v39
    v_mov_b32 v75, v39
    v_mov_b32 v78, v39
    v_mov_b32 v79, v39
    v_mov_b32 v80, v39
    v_mov_b32 v82, v39
    v_mov_b32 v83, v39
    v_mov_b32 v84, v39
    v_and_b32 v76, 0xffff, v39
    v_and_b32 v81, 0xffff, v39
    v_mov_b32 v77, 0
    v_mov_b32 v85, 0
    s_mov_b32 exec_lo, 0
    s_mov_b32 exec_hi, 0x80000000
    ds_write_b128 v17, v[72:75] offset:6784
    ds_write_b128 v17, v[74:77] offset:64
    ds_write_b128 v17, v[78:81] offset:4544
    ds_write_b128 v17, v[82:85] offset:2304
    s_mov_b64 exec, -1
C_KDONE:
    s_setprio 0
    v_bfe_u32 v8, v2, 2, 2
    v_and_b32 v9, 3, v2
    v_lshlrev_b32 v10, 2, v9
    v_sub_u32 v10, v10, v8
    v_lshl_add_u32 v10, v4, 4, v10
    s_lshl_b32 s8, s3, 12
    s_and_b32 s9, s55, 8
    s_add_u32 s8, s8, s9
    s_add_u32 s8, s8, 91568
    v_lshl_add_u32 v10, v10, 4, s8
    v_lshrrev_b32 v11, 2, v2
    v_lshlrev_b32 v11, 3, v11
    s_lshl_b32 s8, s3, 9
    s_sub_u32 s8, 76664, s8
    v_sub_u32 v11, s8, v11
    v_mul_u32_u24 v12, 4640, v9
    v_add_u32 v12, v12, v11
    v_lshlrev_b32 v9, 2, v9
    s_lshl_b32 s8, s12, 2
    v_mov_b32 v14, s8
    s_mov_b32 s56, 0x7fff7fff
    v_and_b32 v8, 3, v3
    v_sub_u32 v8, 3, v8
    v_mul_u32_u24 v8, 2240, v8
    v_lshrrev_b32 v13, 2, v3
    v_lshl_add_u32 v13, v4, 1, v13
    v_lshl_add_u32 v8, v13, 3, v8
    v_add3_u32 v5, v8, s52, 8
    v_lshlrev_b32 v8, 1, v3
    v_sub_u32 v8, v4, v8
    v_lshlrev_b32 v8, 4, v8
    s_add_u32 s8, s53, 480
    v_add_u32 v6, s8, v8
    v_lshl_add_u32 v8, v3, 2, v4
    s_mul_i32 s8, s12, 4160
    v_lshl_add_u32 v7, v8, 3, s8
    s_waitcnt lgkmcnt(0)
    s_barrier
    ds_read_b64_tr_b16 v[16:17], v10 offset:0
    ds_read_b64_tr_b16 v[18:19], v10 offset:1024
    ds_read_b64_tr_b16 v[20:21], v10 offset:2048
    ds_read_b64_tr_b16 v[22:23], v10 offset:3072
    s_waitcnt lgkmcnt(3)
    v_and_b32 v24, s56, v16
    v_and_b32 v25, s56, v17
    v_pk_max_u16 v15, v24, v25
    s_waitcnt lgkmcnt(2)
    v_and_b32 v26, s56, v18
    v_pk_max_u16 v15, v15, v26
    v_and_b32 v27, s56, v19
    v_pk_max_u16 v15, v15, v27
    s_waitcnt lgkmcnt(1)
    v_and_b32 v28, s56, v20
    v_pk_max_u16 v15, v15, v28
    v_and_b32 v29, s56, v21
    v_pk_max_u16 v15, v15, v29
    s_waitcnt lgkmcnt(0)
    v_and_b32 v30, s56, v22
    v_pk_max_u16 v15, v15, v30
    v_and_b32 v31, s56, v23
    v_pk_max_u16 v15, v15, v31
    v_lshlrev_b32 v13, 16, v15
    v_max_u32 v15, v15, v13
    s_nop 1
    v_max_u32_dpp v15, v15, v15 row_ror:4 row_mask:0xf bank_mask:0xf
    s_nop 1
    v_max_u32_dpp v15, v15, v15 row_ror:8 row_mask:0xf bank_mask:0xf
    s_mov_b32 exec_lo, 0x000f000f
    s_mov_b32 exec_hi, 0x000f000f
    ds_max_u32 v9, v15 offset:48
    s_mov_b64 exec, -1
    s_waitcnt lgkmcnt(0)
    s_barrier
    ds_read_b32 v15, v9 offset:48
    ds_read_b32 v14, v14 offset:48
    s_waitcnt lgkmcnt(1)
    v_and_b32 v15, 0x7f800000, v15
    v_subrev_u32 v15, 218103808, v15
    v_max_i32 v15, 0, v15
    v_alignbit_b32 v13, v15, v15, 16
    v_or_b32 v15, v15, v13
    v_pk_sub_u16 v24, v24, v15 clamp
    v_pk_lshlrev_b16 v24, 3, v24 op_sel_hi:[0,1]
    v_bfi_b32 v24, s56, v24, v16
    v_pk_sub_u16 v25, v25, v15 clamp
    v_pk_lshlrev_b16 v25, 3, v25 op_sel_hi:[0,1]
    v_bfi_b32 v25, s56, v25, v17
    ds_write_b64 v12, v[24:25] offset:384
    v_pk_sub_u16 v26, v26, v15 clamp
    v_pk_lshlrev_b16 v26, 3, v26 op_sel_hi:[0,1]
    v_bfi_b32 v26, s56, v26, v18
    v_pk_sub_u16 v27, v27, v15 clamp
    v_pk_lshlrev_b16 v27, 3, v27 op_sel_hi:[0,1]
    v_bfi_b32 v27, s56, v27, v19
    ds_write_b64 v12, v[26:27] offset:256
    v_pk_sub_u16 v28, v28, v15 clamp
    v_pk_lshlrev_b16 v28, 3, v28 op_sel_hi:[0,1]
    v_bfi_b32 v28, s56, v28, v20
    v_pk_sub_u16 v29, v29, v15 clamp
    v_pk_lshlrev_b16 v29, 3, v29 op_sel_hi:[0,1]
    v_bfi_b32 v29, s56, v29, v21
    ds_write_b64 v12, v[28:29] offset:128
    v_pk_sub_u16 v30, v30, v15 clamp
    v_pk_lshlrev_b16 v30, 3, v30 op_sel_hi:[0,1]
    v_bfi_b32 v30, s56, v30, v22
    v_pk_sub_u16 v31, v31, v15 clamp
    v_pk_lshlrev_b16 v31, 3, v31 op_sel_hi:[0,1]
    v_bfi_b32 v31, s56, v31, v23
    ds_write_b64 v12, v[30:31] offset:0
    s_waitcnt lgkmcnt(4)
    v_bfe_u32 v14, v14, 23, 8
    v_subrev_u32 v14, 26, v14
    v_max_i32 v14, 0, v14
    s_sub_u32 s54, s54, 112
    v_add_u32 v167, s54, v14
    s_waitcnt lgkmcnt(0)
    s_barrier
    s_cmp_eq_u32 s13, 0
    s_cbranch_scc1 C_G1
    s_setprio 2
    ds_read_b64 v[32:33], v5 offset:0
    ds_read_b64 v[34:35], v5 offset:8
    ds_read_b128 v[60:63], v6 offset:2048
    ds_read_b128 v[56:59], v6 offset:2560
    ds_read_b128 v[52:55], v6 offset:3072
    ds_read_b128 v[48:51], v6 offset:3584
    ds_read_b64 v[36:37], v5 offset:512
    ds_read_b64 v[38:39], v5 offset:520
    ds_read_b64 v[40:41], v5 offset:1024
    ds_read_b64 v[42:43], v5 offset:1032
    ds_read_b64 v[44:45], v5 offset:1536
    ds_read_b64 v[46:47], v5 offset:1544
    ds_read_b64 v[76:77], v5 offset:64
    ds_read_b64 v[78:79], v5 offset:72
    s_waitcnt lgkmcnt(11)
    v_mfma_f32_16x16x32_f16 v[28:31], v[32:35], v[60:63], 0
    ds_read_b128 v[104:107], v6 offset:2112
    s_waitcnt lgkmcnt(11)
    v_mfma_f32_16x16x32_f16 v[24:27], v[32:35], v[56:59], 0
    ds_read_b128 v[100:103], v6 offset:2624
    s_waitcnt lgkmcnt(11)
    v_mfma_f32_16x16x32_f16 v[20:23], v[32:35], v[52:55], 0
    ds_read_b128 v[96:99], v6 offset:3136
    s_waitcnt lgkmcnt(11)
    v_mfma_f32_16x16x32_f16 v[16:19], v[32:35], v[48:51], 0
    ds_read_b128 v[92:95], v6 offset:3648
    s_waitcnt lgkmcnt(10)
    v_mfma_f32_16x16x32_f16 v[28:31], v[36:39], v[56:59], v[28:31]
    ds_read_b64 v[80:81], v5 offset:576
    v_mfma_f32_16x16x32_f16 v[24:27], v[36:39], v[52:55], v[24:27]
    ds_read_b64 v[82:83], v5 offset:584
    v_mfma_f32_16x16x32_f16 v[20:23], v[36:39], v[48:51], v[20:23]
    ds_read_b64 v[84:85], v5 offset:1088
    s_waitcnt lgkmcnt(11)
    v_mfma_f32_16x16x32_f16 v[28:31], v[40:43], v[52:55], v[28:31]
    ds_read_b64 v[86:87], v5 offset:1096
    v_mfma_f32_16x16x32_f16 v[24:27], v[40:43], v[48:51], v[24:27]
    ds_read_b64 v[88:89], v5 offset:1600
    s_waitcnt lgkmcnt(11)
    v_mfma_f32_16x16x32_f16 v[28:31], v[44:47], v[48:51], v[28:31]
    ds_read_b64 v[90:91], v5 offset:1608
    ds_read_b64 v[32:33], v5 offset:128
    ds_read_b64 v[34:35], v5 offset:136
    s_waitcnt lgkmcnt(8)
    v_mfma_f32_16x16x32_f16 v[28:31], v[76:79], v[104:107], v[28:31]
    ds_read_b128 v[60:63], v6 offset:2176
    v_mfma_f32_16x16x32_f16 v[24:27], v[76:79], v[100:103], v[24:27]
    ds_read_b128 v[56:59], v6 offset:2688
    v_mfma_f32_16x16x32_f16 v[20:23], v[76:79], v[96:99], v[20:23]
    ds_read_b128 v[52:55], v6 offset:3200
    v_mfma_f32_16x16x32_f16 v[16:19], v[76:79], v[92:95], v[16:19]
    ds_read_b128 v[48:51], v6 offset:3712
    s_waitcnt lgkmcnt(10)
    v_mfma_f32_16x16x32_f16 v[28:31], v[80:83], v[100:103], v[28:31]
    ds_read_b64 v[36:37], v5 offset:640
    v_mfma_f32_16x16x32_f16 v[24:27], v[80:83], v[96:99], v[24:27]
    ds_read_b64 v[38:39], v5 offset:648
    v_mfma_f32_16x16x32_f16 v[20:23], v[80:83], v[92:95], v[20:23]
    ds_read_b64 v[40:41], v5 offset:1152
    s_waitcnt lgkmcnt(11)
    v_mfma_f32_16x16x32_f16 v[28:31], v[84:87], v[96:99], v[28:31]
    ds_read_b64 v[42:43], v5 offset:1160
    v_mfma_f32_16x16x32_f16 v[24:27], v[84:87], v[92:95], v[24:27]
    ds_read_b64 v[44:45], v5 offset:1664
    s_waitcnt lgkmcnt(11)
    v_mfma_f32_16x16x32_f16 v[28:31], v[88:91], v[92:95], v[28:31]
    ds_read_b64 v[46:47], v5 offset:1672
    ds_read_b64 v[76:77], v5 offset:192
    ds_read_b64 v[78:79], v5 offset:200
    s_waitcnt lgkmcnt(8)
    v_mfma_f32_16x16x32_f16 v[28:31], v[32:35], v[60:63], v[28:31]
    ds_read_b128 v[104:107], v6 offset:2240
    v_mfma_f32_16x16x32_f16 v[24:27], v[32:35], v[56:59], v[24:27]
    ds_read_b128 v[100:103], v6 offset:2752
    v_mfma_f32_16x16x32_f16 v[20:23], v[32:35], v[52:55], v[20:23]
    ds_read_b128 v[96:99], v6 offset:3264
    v_mfma_f32_16x16x32_f16 v[16:19], v[32:35], v[48:51], v[16:19]
    ds_read_b128 v[92:95], v6 offset:3776
    s_waitcnt lgkmcnt(10)
    v_mfma_f32_16x16x32_f16 v[28:31], v[36:39], v[56:59], v[28:31]
    ds_read_b64 v[80:81], v5 offset:704
    v_mfma_f32_16x16x32_f16 v[24:27], v[36:39], v[52:55], v[24:27]
    ds_read_b64 v[82:83], v5 offset:712
    v_mfma_f32_16x16x32_f16 v[20:23], v[36:39], v[48:51], v[20:23]
    ds_read_b64 v[84:85], v5 offset:1216
    s_waitcnt lgkmcnt(11)
    v_mfma_f32_16x16x32_f16 v[28:31], v[40:43], v[52:55], v[28:31]
    ds_read_b64 v[86:87], v5 offset:1224
    v_mfma_f32_16x16x32_f16 v[24:27], v[40:43], v[48:51], v[24:27]
    ds_read_b64 v[88:89], v5 offset:1728
    s_waitcnt lgkmcnt(11)
    v_mfma_f32_16x16x32_f16 v[28:31], v[44:47], v[48:51], v[28:31]
    ds_read_b64 v[90:91], v5 offset:1736
    ds_read_b64 v[32:33], v5 offset:256
    ds_read_b64 v[34:35], v5 offset:264
    s_waitcnt lgkmcnt(8)
    v_mfma_f32_16x16x32_f16 v[28:31], v[76:79], v[104:107], v[28:31]
    ds_read_b128 v[60:63], v6 offset:2304
    v_mfma_f32_16x16x32_f16 v[24:27], v[76:79], v[100:103], v[24:27]
    ds_read_b128 v[56:59], v6 offset:2816
    v_mfma_f32_16x16x32_f16 v[20:23], v[76:79], v[96:99], v[20:23]
    ds_read_b128 v[52:55], v6 offset:3328
    v_mfma_f32_16x16x32_f16 v[16:19], v[76:79], v[92:95], v[16:19]
    ds_read_b128 v[48:51], v6 offset:3840
    s_waitcnt lgkmcnt(10)
    v_mfma_f32_16x16x32_f16 v[28:31], v[80:83], v[100:103], v[28:31]
    ds_read_b64 v[36:37], v5 offset:768
    v_mfma_f32_16x16x32_f16 v[24:27], v[80:83], v[96:99], v[24:27]
    ds_read_b64 v[38:39], v5 offset:776
    v_mfma_f32_16x16x32_f16 v[20:23], v[80:83], v[92:95], v[20:23]
    ds_read_b64 v[40:41], v5 offset:1280
    s_waitcnt lgkmcnt(11)
    v_mfma_f32_16x16x32_f16 v[28:31], v[84:87], v[96:99], v[28:31]
    ds_read_b64 v[42:43], v5 offset:1288
    v_mfma_f32_16x16x32_f16 v[24:27], v[84:87], v[92:95], v[24:27]
    ds_read_b64 v[44:45], v5 offset:1792
    s_waitcnt lgkmcnt(11)
    v_mfma_f32_16x16x32_f16 v[28:31], v[88:91], v[92:95], v[28:31]
    ds_read_b64 v[46:47], v5 offset:1800
    ds_read_b64 v[76:77], v5 offset:320
    ds_read_b64 v[78:79], v5 offset:328
    s_waitcnt lgkmcnt(8)
    v_mfma_f32_16x16x32_f16 v[28:31], v[32:35], v[60:63], v[28:31]
    ds_read_b128 v[104:107], v6 offset:2368
    v_mfma_f32_16x16x32_f16 v[24:27], v[32:35], v[56:59], v[24:27]
    ds_read_b128 v[100:103], v6 offset:2880
    v_mfma_f32_16x16x32_f16 v[20:23], v[32:35], v[52:55], v[20:23]
    ds_read_b128 v[96:99], v6 offset:3392
    v_mfma_f32_16x16x32_f16 v[16:19], v[32:35], v[48:51], v[16:19]
    ds_read_b128 v[92:95], v6 offset:3904
    s_waitcnt lgkmcnt(10)
    v_mfma_f32_16x16x32_f16 v[28:31], v[36:39], v[56:59], v[28:31]
    ds_read_b64 v[80:81], v5 offset:832
    v_mfma_f32_16x16x32_f16 v[24:27], v[36:39], v[52:55], v[24:27]
    ds_read_b64 v[82:83], v5 offset:840
    v_mfma_f32_16x16x32_f16 v[20:23], v[36:39], v[48:51], v[20:23]
    ds_read_b64 v[84:85], v5 offset:1344
    s_waitcnt lgkmcnt(11)
    v_mfma_f32_16x16x32_f16 v[28:31], v[40:43], v[52:55], v[28:31]
    ds_read_b64 v[86:87], v5 offset:1352
    v_mfma_f32_16x16x32_f16 v[24:27], v[40:43], v[48:51], v[24:27]
    ds_read_b64 v[88:89], v5 offset:1856
    s_waitcnt lgkmcnt(11)
    v_mfma_f32_16x16x32_f16 v[28:31], v[44:47], v[48:51], v[28:31]
    ds_read_b64 v[90:91], v5 offset:1864
    ds_read_b64 v[32:33], v5 offset:384
    ds_read_b64 v[34:35], v5 offset:392
    s_waitcnt lgkmcnt(8)
    v_mfma_f32_16x16x32_f16 v[28:31], v[76:79], v[104:107], v[28:31]
    ds_read_b128 v[60:63], v6 offset:2432
    v_mfma_f32_16x16x32_f16 v[24:27], v[76:79], v[100:103], v[24:27]
    ds_read_b128 v[56:59], v6 offset:2944
    v_mfma_f32_16x16x32_f16 v[20:23], v[76:79], v[96:99], v[20:23]
    ds_read_b128 v[52:55], v6 offset:3456
    v_mfma_f32_16x16x32_f16 v[16:19], v[76:79], v[92:95], v[16:19]
    ds_read_b128 v[48:51], v6 offset:3968
    s_waitcnt lgkmcnt(10)
    v_mfma_f32_16x16x32_f16 v[28:31], v[80:83], v[100:103], v[28:31]
    ds_read_b64 v[36:37], v5 offset:896
    v_mfma_f32_16x16x32_f16 v[24:27], v[80:83], v[96:99], v[24:27]
    ds_read_b64 v[38:39], v5 offset:904
    v_mfma_f32_16x16x32_f16 v[20:23], v[80:83], v[92:95], v[20:23]
    ds_read_b64 v[40:41], v5 offset:1408
    s_waitcnt lgkmcnt(11)
    v_mfma_f32_16x16x32_f16 v[28:31], v[84:87], v[96:99], v[28:31]
    ds_read_b64 v[42:43], v5 offset:1416
    v_mfma_f32_16x16x32_f16 v[24:27], v[84:87], v[92:95], v[24:27]
    ds_read_b64 v[44:45], v5 offset:1920
    s_waitcnt lgkmcnt(11)
    v_mfma_f32_16x16x32_f16 v[28:31], v[88:91], v[92:95], v[28:31]
    ds_read_b64 v[46:47], v5 offset:1928
    ds_read_b64 v[76:77], v5 offset:448
    ds_read_b64 v[78:79], v5 offset:456
    s_waitcnt lgkmcnt(8)
    v_mfma_f32_16x16x32_f16 v[28:31], v[32:35], v[60:63], v[28:31]
    ds_read_b128 v[104:107], v6 offset:2496
    v_mfma_f32_16x16x32_f16 v[24:27], v[32:35], v[56:59], v[24:27]
    ds_read_b128 v[100:103], v6 offset:3008
    v_mfma_f32_16x16x32_f16 v[20:23], v[32:35], v[52:55], v[20:23]
    ds_read_b128 v[96:99], v6 offset:3520
    v_mfma_f32_16x16x32_f16 v[16:19], v[32:35], v[48:51], v[16:19]
    ds_read_b128 v[92:95], v6 offset:4032
    s_waitcnt lgkmcnt(10)
    v_mfma_f32_16x16x32_f16 v[28:31], v[36:39], v[56:59], v[28:31]
    ds_read_b64 v[80:81], v5 offset:960
    v_mfma_f32_16x16x32_f16 v[24:27], v[36:39], v[52:55], v[24:27]
    ds_read_b64 v[82:83], v5 offset:968
    v_mfma_f32_16x16x32_f16 v[20:23], v[36:39], v[48:51], v[20:23]
    ds_read_b64 v[84:85], v5 offset:1472
    s_waitcnt lgkmcnt(11)
    v_mfma_f32_16x16x32_f16 v[28:31], v[40:43], v[52:55], v[28:31]
    ds_read_b64 v[86:87], v5 offset:1480
    v_mfma_f32_16x16x32_f16 v[24:27], v[40:43], v[48:51], v[24:27]
    ds_read_b64 v[88:89], v5 offset:1984
    s_waitcnt lgkmcnt(11)
    v_mfma_f32_16x16x32_f16 v[28:31], v[44:47], v[48:51], v[28:31]
    ds_read_b64 v[90:91], v5 offset:1992
    s_waitcnt lgkmcnt(6)
    v_mfma_f32_16x16x32_f16 v[28:31], v[76:79], v[104:107], v[28:31]
    v_mfma_f32_16x16x32_f16 v[24:27], v[76:79], v[100:103], v[24:27]
    v_mfma_f32_16x16x32_f16 v[20:23], v[76:79], v[96:99], v[20:23]
    v_mfma_f32_16x16x32_f16 v[16:19], v[76:79], v[92:95], v[16:19]
    s_waitcnt lgkmcnt(4)
    v_mfma_f32_16x16x32_f16 v[28:31], v[80:83], v[100:103], v[28:31]
    v_mfma_f32_16x16x32_f16 v[24:27], v[80:83], v[96:99], v[24:27]
    v_mfma_f32_16x16x32_f16 v[20:23], v[80:83], v[92:95], v[20:23]
    s_waitcnt lgkmcnt(2)
    v_mfma_f32_16x16x32_f16 v[28:31], v[84:87], v[96:99], v[28:31]
    v_mfma_f32_16x16x32_f16 v[24:27], v[84:87], v[92:95], v[24:27]
    s_waitcnt lgkmcnt(0)
    v_mfma_f32_16x16x32_f16 v[28:31], v[88:91], v[92:95], v[28:31]
    v_ldexp_f32 v16, v16, v167
    v_ldexp_f32 v17, v17, v167
    v_ldexp_f32 v18, v18, v167
    v_ldexp_f32 v19, v19, v167
    v_cvt_pk_bf16_f32 v16, v16, v17
    v_cvt_pk_bf16_f32 v17, v18, v19
    ds_write_b64 v7, v[16:17] offset:256
    v_ldexp_f32 v20, v20, v167
    v_ldexp_f32 v21, v21, v167
    v_ldexp_f32 v22, v22, v167
    v_ldexp_f32 v23, v23, v167
    v_cvt_pk_bf16_f32 v20, v20, v21
    v_cvt_pk_bf16_f32 v21, v22, v23
    ds_write_b64 v7, v[20:21] offset:768
    v_ldexp_f32 v24, v24, v167
    v_ldexp_f32 v25, v25, v167
    v_ldexp_f32 v26, v26, v167
    v_ldexp_f32 v27, v27, v167
    v_cvt_pk_bf16_f32 v24, v24, v25
    v_cvt_pk_bf16_f32 v25, v26, v27
    ds_write_b64 v7, v[24:25] offset:1280
    v_ldexp_f32 v28, v28, v167
    v_ldexp_f32 v29, v29, v167
    v_ldexp_f32 v30, v30, v167
    v_ldexp_f32 v31, v31, v167
    v_cvt_pk_bf16_f32 v28, v28, v29
    v_cvt_pk_bf16_f32 v29, v30, v31
    ds_write_b64 v7, v[28:29] offset:1792
    s_waitcnt lgkmcnt(0)
    v_mov_b32 v8, 1
    s_mov_b64 exec, 1
    ds_add_u32 v1, v8 offset:32
    s_mov_b64 exec, -1
    s_setprio 3
    s_lshl_b32 s14, s12, 1
    s_add_u32 s14, s14, 24
    ds_read_b32 v10, v1 offset:0
    s_load_dwordx2 s[58:59], s[32:33], s55
    s_mov_b32 s60, s46
    s_mov_b32 s61, s47
    s_mov_b32 s62, 2359296
    s_mov_b32 s63, 0x20000
    v_and_b32 v11, 1, v2
    v_lshlrev_b32 v11, 4, v11
    v_sub_u32 v11, 16, v11
    s_waitcnt lgkmcnt(0)
    s_lshl_b32 s64, s58, 16
    s_and_b32 s65, s58, 0xffff0000
    s_lshl_b32 s66, s59, 16
    s_and_b32 s67, s59, 0xffff0000
    s_lshl_b32 s8, s14, 6
    v_add_u32 v12, s8, v2
    v_lshrrev_b32 v13, 1, v12
    v_lshlrev_b32 v13, 3, v13
    v_add_u32 v13, 8192, v13
    s_and_b32 s8, s55, 8
    s_add_u32 s8, s8, 91520
    v_lshl_add_u32 v12, v12, 4, s8
    ds_read_b64 v[24:25], v12 offset:0
    ds_read_b64 v[26:27], v12 offset:1024
    s_mov_b32 s9, 0
GPB_18:
    global_load_dwordx2 v[16:17], v13, s[50:51] offset:0 sc1
    global_load_dwordx2 v[18:19], v13, s[50:51] offset:256 sc1
    s_waitcnt vmcnt(0) lgkmcnt(0)
    v_xor_b32 v14, v17, v10
    v_bitop3_b32 v14, v14, v19, v10 bitop3:0xf6
    v_cmp_ne_u32 vcc, 0, v14
    s_add_u32 s9, s9, 1
    s_cmp_eq_u64 vcc, 0
    s_cbranch_scc1 GPB_18_D
    s_sleep 2
    s_cmp_lt_u32 s9, 131072
    s_cbranch_scc1 GPB_18
GPB_18_D:
    v_lshlrev_b32 v48, v11, v16
    v_and_b32 v48, 0xffff0000, v48
    v_sub_f32 v36, 1.0, v48
    v_cvt_pk_bf16_f32 v36, v36, v36
    v_and_b32 v36, 0xffff0000, v36
    v_lshlrev_b32 v32, 16, v24
    v_and_b32 v33, 0xffff0000, v24
    v_lshlrev_b32 v34, 16, v25
    v_and_b32 v35, 0xffff0000, v25
    v_pk_mul_f32 v[40:41], v[32:33], s[64:65]
    v_pk_mul_f32 v[44:45], v[32:33], v[36:37] op_sel_hi:[1,0]
    v_pk_mul_f32 v[42:43], v[34:35], s[66:67]
    v_pk_mul_f32 v[46:47], v[34:35], v[36:37] op_sel_hi:[1,0]
    v_cvt_pk_bf16_f32 v41, v40, v41
    v_lshlrev_b32 v40, 16, v41
    v_and_b32 v41, 0xffff0000, v41
    v_cvt_pk_bf16_f32 v43, v42, v43
    v_lshlrev_b32 v42, 16, v43
    v_and_b32 v43, 0xffff0000, v43
    v_cvt_pk_bf16_f32 v45, v44, v45
    v_lshlrev_b32 v44, 16, v45
    v_and_b32 v45, 0xffff0000, v45
    v_cvt_pk_bf16_f32 v47, v46, v47
    v_lshlrev_b32 v46, 16, v47
    v_and_b32 v47, 0xffff0000, v47
    v_lshlrev_b32 v58, v11, v18
    v_and_b32 v58, 0xffff0000, v58
    v_sub_f32 v36, 1.0, v58
    v_cvt_pk_bf16_f32 v36, v36, v36
    v_and_b32 v36, 0xffff0000, v36
    v_lshlrev_b32 v32, 16, v26
    v_and_b32 v33, 0xffff0000, v26
    v_lshlrev_b32 v34, 16, v27
    v_and_b32 v35, 0xffff0000, v27
    v_pk_mul_f32 v[50:51], v[32:33], s[64:65]
    v_pk_mul_f32 v[54:55], v[32:33], v[36:37] op_sel_hi:[1,0]
    v_pk_mul_f32 v[52:53], v[34:35], s[66:67]
    v_pk_mul_f32 v[56:57], v[34:35], v[36:37] op_sel_hi:[1,0]
    v_cvt_pk_bf16_f32 v51, v50, v51
    v_lshlrev_b32 v50, 16, v51
    v_and_b32 v51, 0xffff0000, v51
    v_cvt_pk_bf16_f32 v53, v52, v53
    v_lshlrev_b32 v52, 16, v53
    v_and_b32 v53, 0xffff0000, v53
    v_cvt_pk_bf16_f32 v55, v54, v55
    v_lshlrev_b32 v54, 16, v55
    v_and_b32 v55, 0xffff0000, v55
    v_cvt_pk_bf16_f32 v57, v56, v57
    v_lshlrev_b32 v56, 16, v57
    v_and_b32 v57, 0xffff0000, v57
    v_bfe_u32 v12, v2, 2, 2
    v_mul_u32_u24 v12, 4160, v12
    v_and_b32 v13, 3, v2
    v_lshl_add_u32 v13, v4, 2, v13
    v_lshl_add_u32 v12, v13, 3, v12
    s_lshl_b32 s8, s14, 7
    v_add_u32 v12, s8, v12
    s_lshl_b32 s8, s14, 9
    v_lshl_add_u32 v13, v2, 3, s8
    v_mul_u32_u24 v14, 1152, v2
    v_add_u32 v14, s55, v14
    s_mul_i32 s15, s14, 73728
    s_mov_b32 s9, 0
SP_19:
    ds_read_b32 v15, v1 offset:36
    s_waitcnt lgkmcnt(0)
    v_readfirstlane_b32 s8, v15
    s_add_u32 s9, s9, 1
    s_cmp_ge_u32 s8, 4
    s_cbranch_scc1 SP_19_D
    s_cmp_lt_u32 s9, 524288
    s_cbranch_scc1 SP_19
SP_19_D:
    ds_read_b64_tr_b16 v[16:17], v12 offset:256
    ds_read_b64_tr_b16 v[18:19], v12 offset:384
    s_waitcnt lgkmcnt(1)
    v_lshlrev_b32 v32, 16, v16
    v_and_b32 v33, 0xffff0000, v16
    v_lshlrev_b32 v34, 16, v17
    v_and_b32 v35, 0xffff0000, v17
    v_pk_add_f32 v[32:33], v[32:33], v[40:41]
    v_pk_add_f32 v[34:35], v[34:35], v[42:43]
    v_cvt_pk_bf16_f32 v16, v32, v33
    v_cvt_pk_bf16_f32 v17, v34, v35
    v_lshlrev_b32 v32, 16, v16
    v_and_b32 v33, 0xffff0000, v16
    v_lshlrev_b32 v34, 16, v17
    v_and_b32 v35, 0xffff0000, v17
    v_pk_mul_f32 v[32:33], v[32:33], v[48:49] op_sel_hi:[1,0]
    v_pk_mul_f32 v[34:35], v[34:35], v[48:49] op_sel_hi:[1,0]
    v_cvt_pk_bf16_f32 v16, v32, v33
    v_cvt_pk_bf16_f32 v17, v34, v35
    v_lshlrev_b32 v32, 16, v16
    v_and_b32 v33, 0xffff0000, v16
    v_lshlrev_b32 v34, 16, v17
    v_and_b32 v35, 0xffff0000, v17
    v_pk_add_f32 v[32:33], v[32:33], v[44:45]
    v_pk_add_f32 v[34:35], v[34:35], v[46:47]
    v_cvt_pk_bf16_f32 v40, v32, v33
    v_cvt_pk_bf16_f32 v41, v34, v35
    buffer_store_dwordx2 v[40:41], v14, s[60:63], s15 offen
    s_add_u32 s15, s15, 73728
    s_waitcnt lgkmcnt(0)
    v_lshlrev_b32 v32, 16, v18
    v_and_b32 v33, 0xffff0000, v18
    v_lshlrev_b32 v34, 16, v19
    v_and_b32 v35, 0xffff0000, v19
    v_pk_add_f32 v[32:33], v[32:33], v[50:51]
    v_pk_add_f32 v[34:35], v[34:35], v[52:53]
    v_cvt_pk_bf16_f32 v18, v32, v33
    v_cvt_pk_bf16_f32 v19, v34, v35
    v_lshlrev_b32 v32, 16, v18
    v_and_b32 v33, 0xffff0000, v18
    v_lshlrev_b32 v34, 16, v19
    v_and_b32 v35, 0xffff0000, v19
    v_pk_mul_f32 v[32:33], v[32:33], v[58:59] op_sel_hi:[1,0]
    v_pk_mul_f32 v[34:35], v[34:35], v[58:59] op_sel_hi:[1,0]
    v_cvt_pk_bf16_f32 v18, v32, v33
    v_cvt_pk_bf16_f32 v19, v34, v35
    v_lshlrev_b32 v32, 16, v18
    v_and_b32 v33, 0xffff0000, v18
    v_lshlrev_b32 v34, 16, v19
    v_and_b32 v35, 0xffff0000, v19
    v_pk_add_f32 v[32:33], v[32:33], v[54:55]
    v_pk_add_f32 v[34:35], v[34:35], v[56:57]
    v_cvt_pk_bf16_f32 v50, v32, v33
    v_cvt_pk_bf16_f32 v51, v34, v35
    buffer_store_dwordx2 v[50:51], v14, s[60:63], s15 offen
    s_add_u32 s15, s15, 73728
    ds_write_b64 v13, v[16:17] offset:16896
    ds_write_b64 v13, v[18:19] offset:17408
    s_waitcnt lgkmcnt(0)
    s_waitcnt vmcnt(0)
    v_mov_b32 v8, 1
    s_mov_b64 exec, 1
    ds_add_u32 v1, v8 offset:40
    s_mov_b64 exec, -1
    s_endpgm
C_G1:
    s_setprio 1
    ds_read_b128 v[76:79], v6 offset:3584
    ds_read_b128 v[92:95], v6 offset:3600
    ds_read_b128 v[80:83], v6 offset:3072
    ds_read_b128 v[96:99], v6 offset:3088
    ds_read_b128 v[84:87], v6 offset:2560
    ds_read_b128 v[100:103], v6 offset:2576
    ds_read_b128 v[88:91], v6 offset:2048
    ds_read_b128 v[104:107], v6 offset:2064
    ds_read_b64 v[8:9], v5 offset:2048
    ds_read_b64 v[10:11], v5 offset:2056
    s_waitcnt lgkmcnt(9)
    v_mfma_f32_16x16x32_f16 v[108:111], v[76:79], v[142:145], 0
    s_waitcnt lgkmcnt(8)
    v_mfma_f32_16x16x32_f16 v[124:127], v[92:95], v[146:149], 0
    s_waitcnt lgkmcnt(7)
    v_mfma_f32_16x16x32_f16 v[112:115], v[80:83], v[142:145], 0
    s_waitcnt lgkmcnt(6)
    v_mfma_f32_16x16x32_f16 v[128:131], v[96:99], v[146:149], 0
    s_waitcnt lgkmcnt(5)
    v_mfma_f32_16x16x32_f16 v[116:119], v[84:87], v[142:145], 0
    ds_read_b64 v[32:33], v5 offset:0
    s_waitcnt lgkmcnt(5)
    v_mfma_f32_16x16x32_f16 v[132:135], v[100:103], v[146:149], 0
    ds_read_b64 v[34:35], v5 offset:8
    s_waitcnt lgkmcnt(5)
    v_mfma_f32_16x16x32_f16 v[120:123], v[88:91], v[142:145], 0
    ds_read_b128 v[72:75], v6 offset:0
    s_waitcnt lgkmcnt(5)
    v_mfma_f32_16x16x32_f16 v[136:139], v[104:107], v[146:149], 0
    ds_read_b128 v[68:71], v6 offset:512
    s_waitcnt lgkmcnt(4)
    v_mfma_f32_16x16x32_f16 v[16:19], v[8:11], v[76:79], 0
    ds_read_b128 v[64:67], v6 offset:1024
    v_cvt_pk_f16_f32 v108, v108, v124
    v_cvt_pk_f16_f32 v109, v109, v125
    v_cvt_pk_f16_f32 v110, v110, v126
    v_cvt_pk_f16_f32 v111, v111, v127
    v_mfma_f32_16x16x32_f16 v[20:23], v[8:11], v[80:83], 0
    ds_read_b128 v[60:63], v6 offset:1536
    v_cvt_pk_f16_f32 v112, v112, v128
    v_cvt_pk_f16_f32 v113, v113, v129
    v_cvt_pk_f16_f32 v114, v114, v130
    v_cvt_pk_f16_f32 v115, v115, v131
    v_mfma_f32_16x16x32_f16 v[24:27], v[8:11], v[84:87], 0
    ds_read_b64 v[36:37], v5 offset:512
    v_cvt_pk_f16_f32 v116, v116, v132
    v_cvt_pk_f16_f32 v117, v117, v133
    v_cvt_pk_f16_f32 v118, v118, v134
    v_cvt_pk_f16_f32 v119, v119, v135
    v_mfma_f32_16x16x32_f16 v[28:31], v[8:11], v[88:91], 0
    ds_read_b64 v[38:39], v5 offset:520
    v_cvt_pk_f16_f32 v120, v120, v136
    v_cvt_pk_f16_f32 v121, v121, v137
    v_cvt_pk_f16_f32 v122, v122, v138
    v_cvt_pk_f16_f32 v123, v123, v139
    v_mfma_f32_16x16x32_f16 v[28:31], v[108:111], v[162:165], v[28:31]
    ds_read_b128 v[56:59], v6 offset:2048
    v_mfma_f32_16x16x32_f16 v[24:27], v[108:111], v[158:161], v[24:27]
    ds_read_b64 v[40:41], v5 offset:1024
    v_mfma_f32_16x16x32_f16 v[20:23], v[108:111], v[154:157], v[20:23]
    ds_read_b64 v[42:43], v5 offset:1032
    v_mfma_f32_16x16x32_f16 v[16:19], v[108:111], v[150:153], v[16:19]
    ds_read_b128 v[52:55], v6 offset:2560
    v_mfma_f32_16x16x32_f16 v[28:31], v[112:115], v[158:161], v[28:31]
    ds_read_b64 v[44:45], v5 offset:1536
    v_mfma_f32_16x16x32_f16 v[24:27], v[112:115], v[154:157], v[24:27]
    ds_read_b64 v[46:47], v5 offset:1544
    v_mfma_f32_16x16x32_f16 v[20:23], v[112:115], v[150:153], v[20:23]
    ds_read_b128 v[48:51], v6 offset:3072
    v_mfma_f32_16x16x32_f16 v[28:31], v[116:119], v[154:157], v[28:31]
    v_mfma_f32_16x16x32_f16 v[24:27], v[116:119], v[150:153], v[24:27]
    v_mfma_f32_16x16x32_f16 v[28:31], v[120:123], v[150:153], v[28:31]
    s_waitcnt lgkmcnt(9)
    v_mfma_f32_16x16x32_f16 v[28:31], v[32:35], v[72:75], v[28:31]
    ds_read_b64 v[76:77], v5 offset:64
    v_mfma_f32_16x16x32_f16 v[24:27], v[32:35], v[68:71], v[24:27]
    ds_read_b64 v[78:79], v5 offset:72
    v_mfma_f32_16x16x32_f16 v[20:23], v[32:35], v[64:67], v[20:23]
    ds_read_b128 v[116:119], v6 offset:64
    v_mfma_f32_16x16x32_f16 v[16:19], v[32:35], v[60:63], v[16:19]
    ds_read_b128 v[112:115], v6 offset:576
    s_waitcnt lgkmcnt(10)
    v_mfma_f32_16x16x32_f16 v[28:31], v[36:39], v[68:71], v[28:31]
    ds_read_b128 v[108:111], v6 offset:1088
    v_mfma_f32_16x16x32_f16 v[24:27], v[36:39], v[64:67], v[24:27]
    ds_read_b128 v[104:107], v6 offset:1600
    v_mfma_f32_16x16x32_f16 v[20:23], v[36:39], v[60:63], v[20:23]
    ds_read_b64 v[80:81], v5 offset:576
    v_mfma_f32_16x16x32_f16 v[16:19], v[36:39], v[56:59], v[16:19]
    ds_read_b64 v[82:83], v5 offset:584
    s_waitcnt lgkmcnt(11)
    v_mfma_f32_16x16x32_f16 v[28:31], v[40:43], v[64:67], v[28:31]
    ds_read_b128 v[100:103], v6 offset:2112
    v_mfma_f32_16x16x32_f16 v[24:27], v[40:43], v[60:63], v[24:27]
    ds_read_b64 v[84:85], v5 offset:1088
    v_mfma_f32_16x16x32_f16 v[20:23], v[40:43], v[56:59], v[20:23]
    ds_read_b64 v[86:87], v5 offset:1096
    v_mfma_f32_16x16x32_f16 v[16:19], v[40:43], v[52:55], v[16:19]
    ds_read_b128 v[96:99], v6 offset:2624
    s_waitcnt lgkmcnt(12)
    v_mfma_f32_16x16x32_f16 v[28:31], v[44:47], v[60:63], v[28:31]
    ds_read_b64 v[88:89], v5 offset:1600
    v_mfma_f32_16x16x32_f16 v[24:27], v[44:47], v[56:59], v[24:27]
    ds_read_b64 v[90:91], v5 offset:1608
    v_mfma_f32_16x16x32_f16 v[20:23], v[44:47], v[52:55], v[20:23]
    ds_read_b128 v[92:95], v6 offset:3136
    v_mfma_f32_16x16x32_f16 v[16:19], v[44:47], v[48:51], v[16:19]
    s_waitcnt lgkmcnt(9)
    v_mfma_f32_16x16x32_f16 v[28:31], v[76:79], v[116:119], v[28:31]
    ds_read_b64 v[32:33], v5 offset:128
    v_mfma_f32_16x16x32_f16 v[24:27], v[76:79], v[112:115], v[24:27]
    ds_read_b64 v[34:35], v5 offset:136
    v_mfma_f32_16x16x32_f16 v[20:23], v[76:79], v[108:111], v[20:23]
    ds_read_b128 v[72:75], v6 offset:128
    v_mfma_f32_16x16x32_f16 v[16:19], v[76:79], v[104:107], v[16:19]
    ds_read_b128 v[68:71], v6 offset:640
    s_waitcnt lgkmcnt(10)
    v_mfma_f32_16x16x32_f16 v[28:31], v[80:83], v[112:115], v[28:31]
    ds_read_b128 v[64:67], v6 offset:1152
    v_mfma_f32_16x16x32_f16 v[24:27], v[80:83], v[108:111], v[24:27]
    ds_read_b128 v[60:63], v6 offset:1664
    v_mfma_f32_16x16x32_f16 v[20:23], v[80:83], v[104:107], v[20:23]
    ds_read_b64 v[36:37], v5 offset:640
    v_mfma_f32_16x16x32_f16 v[16:19], v[80:83], v[100:103], v[16:19]
    ds_read_b64 v[38:39], v5 offset:648
    s_waitcnt lgkmcnt(11)
    v_mfma_f32_16x16x32_f16 v[28:31], v[84:87], v[108:111], v[28:31]
    ds_read_b128 v[56:59], v6 offset:2176
    v_mfma_f32_16x16x32_f16 v[24:27], v[84:87], v[104:107], v[24:27]
    ds_read_b64 v[40:41], v5 offset:1152
    v_mfma_f32_16x16x32_f16 v[20:23], v[84:87], v[100:103], v[20:23]
    ds_read_b64 v[42:43], v5 offset:1160
    v_mfma_f32_16x16x32_f16 v[16:19], v[84:87], v[96:99], v[16:19]
    ds_read_b128 v[52:55], v6 offset:2688
    s_waitcnt lgkmcnt(12)
    v_mfma_f32_16x16x32_f16 v[28:31], v[88:91], v[104:107], v[28:31]
    ds_read_b64 v[44:45], v5 offset:1664
    v_mfma_f32_16x16x32_f16 v[24:27], v[88:91], v[100:103], v[24:27]
    ds_read_b64 v[46:47], v5 offset:1672
    v_mfma_f32_16x16x32_f16 v[20:23], v[88:91], v[96:99], v[20:23]
    ds_read_b128 v[48:51], v6 offset:3200
    v_mfma_f32_16x16x32_f16 v[16:19], v[88:91], v[92:95], v[16:19]
    s_waitcnt lgkmcnt(9)
    v_mfma_f32_16x16x32_f16 v[28:31], v[32:35], v[72:75], v[28:31]
    ds_read_b64 v[76:77], v5 offset:192
    v_mfma_f32_16x16x32_f16 v[24:27], v[32:35], v[68:71], v[24:27]
    ds_read_b64 v[78:79], v5 offset:200
    v_mfma_f32_16x16x32_f16 v[20:23], v[32:35], v[64:67], v[20:23]
    ds_read_b128 v[116:119], v6 offset:192
    v_mfma_f32_16x16x32_f16 v[16:19], v[32:35], v[60:63], v[16:19]
    ds_read_b128 v[112:115], v6 offset:704
    s_waitcnt lgkmcnt(10)
    v_mfma_f32_16x16x32_f16 v[28:31], v[36:39], v[68:71], v[28:31]
    ds_read_b128 v[108:111], v6 offset:1216
    v_mfma_f32_16x16x32_f16 v[24:27], v[36:39], v[64:67], v[24:27]
    ds_read_b128 v[104:107], v6 offset:1728
    v_mfma_f32_16x16x32_f16 v[20:23], v[36:39], v[60:63], v[20:23]
    ds_read_b64 v[80:81], v5 offset:704
    v_mfma_f32_16x16x32_f16 v[16:19], v[36:39], v[56:59], v[16:19]
    ds_read_b64 v[82:83], v5 offset:712
    s_waitcnt lgkmcnt(11)
    v_mfma_f32_16x16x32_f16 v[28:31], v[40:43], v[64:67], v[28:31]
    ds_read_b128 v[100:103], v6 offset:2240
    v_mfma_f32_16x16x32_f16 v[24:27], v[40:43], v[60:63], v[24:27]
    ds_read_b64 v[84:85], v5 offset:1216
    v_mfma_f32_16x16x32_f16 v[20:23], v[40:43], v[56:59], v[20:23]
    ds_read_b64 v[86:87], v5 offset:1224
    v_mfma_f32_16x16x32_f16 v[16:19], v[40:43], v[52:55], v[16:19]
    ds_read_b128 v[96:99], v6 offset:2752
    s_waitcnt lgkmcnt(12)
    v_mfma_f32_16x16x32_f16 v[28:31], v[44:47], v[60:63], v[28:31]
    ds_read_b64 v[88:89], v5 offset:1728
    v_mfma_f32_16x16x32_f16 v[24:27], v[44:47], v[56:59], v[24:27]
    ds_read_b64 v[90:91], v5 offset:1736
    v_mfma_f32_16x16x32_f16 v[20:23], v[44:47], v[52:55], v[20:23]
    ds_read_b128 v[92:95], v6 offset:3264
    v_mfma_f32_16x16x32_f16 v[16:19], v[44:47], v[48:51], v[16:19]
    s_waitcnt lgkmcnt(9)
    v_mfma_f32_16x16x32_f16 v[28:31], v[76:79], v[116:119], v[28:31]
    ds_read_b64 v[32:33], v5 offset:256
    v_mfma_f32_16x16x32_f16 v[24:27], v[76:79], v[112:115], v[24:27]
    ds_read_b64 v[34:35], v5 offset:264
    v_mfma_f32_16x16x32_f16 v[20:23], v[76:79], v[108:111], v[20:23]
    ds_read_b128 v[72:75], v6 offset:256
    v_mfma_f32_16x16x32_f16 v[16:19], v[76:79], v[104:107], v[16:19]
    ds_read_b128 v[68:71], v6 offset:768
    s_waitcnt lgkmcnt(10)
    v_mfma_f32_16x16x32_f16 v[28:31], v[80:83], v[112:115], v[28:31]
    ds_read_b128 v[64:67], v6 offset:1280
    v_mfma_f32_16x16x32_f16 v[24:27], v[80:83], v[108:111], v[24:27]
    ds_read_b128 v[60:63], v6 offset:1792
    v_mfma_f32_16x16x32_f16 v[20:23], v[80:83], v[104:107], v[20:23]
    ds_read_b64 v[36:37], v5 offset:768
    v_mfma_f32_16x16x32_f16 v[16:19], v[80:83], v[100:103], v[16:19]
    ds_read_b64 v[38:39], v5 offset:776
    s_waitcnt lgkmcnt(11)
    v_mfma_f32_16x16x32_f16 v[28:31], v[84:87], v[108:111], v[28:31]
    ds_read_b128 v[56:59], v6 offset:2304
    v_mfma_f32_16x16x32_f16 v[24:27], v[84:87], v[104:107], v[24:27]
    ds_read_b64 v[40:41], v5 offset:1280
    v_mfma_f32_16x16x32_f16 v[20:23], v[84:87], v[100:103], v[20:23]
    ds_read_b64 v[42:43], v5 offset:1288
    v_mfma_f32_16x16x32_f16 v[16:19], v[84:87], v[96:99], v[16:19]
    ds_read_b128 v[52:55], v6 offset:2816
    s_waitcnt lgkmcnt(12)
    v_mfma_f32_16x16x32_f16 v[28:31], v[88:91], v[104:107], v[28:31]
    ds_read_b64 v[44:45], v5 offset:1792
    v_mfma_f32_16x16x32_f16 v[24:27], v[88:91], v[100:103], v[24:27]
    ds_read_b64 v[46:47], v5 offset:1800
    v_mfma_f32_16x16x32_f16 v[20:23], v[88:91], v[96:99], v[20:23]
    ds_read_b128 v[48:51], v6 offset:3328
    v_mfma_f32_16x16x32_f16 v[16:19], v[88:91], v[92:95], v[16:19]
    s_waitcnt lgkmcnt(9)
    v_mfma_f32_16x16x32_f16 v[28:31], v[32:35], v[72:75], v[28:31]
    ds_read_b64 v[76:77], v5 offset:320
    v_mfma_f32_16x16x32_f16 v[24:27], v[32:35], v[68:71], v[24:27]
    ds_read_b64 v[78:79], v5 offset:328
    v_mfma_f32_16x16x32_f16 v[20:23], v[32:35], v[64:67], v[20:23]
    ds_read_b128 v[116:119], v6 offset:320
    v_mfma_f32_16x16x32_f16 v[16:19], v[32:35], v[60:63], v[16:19]
    ds_read_b128 v[112:115], v6 offset:832
    s_waitcnt lgkmcnt(10)
    v_mfma_f32_16x16x32_f16 v[28:31], v[36:39], v[68:71], v[28:31]
    ds_read_b128 v[108:111], v6 offset:1344
    v_mfma_f32_16x16x32_f16 v[24:27], v[36:39], v[64:67], v[24:27]
    ds_read_b128 v[104:107], v6 offset:1856
    v_mfma_f32_16x16x32_f16 v[20:23], v[36:39], v[60:63], v[20:23]
    ds_read_b64 v[80:81], v5 offset:832
    v_mfma_f32_16x16x32_f16 v[16:19], v[36:39], v[56:59], v[16:19]
    ds_read_b64 v[82:83], v5 offset:840
    s_waitcnt lgkmcnt(11)
    v_mfma_f32_16x16x32_f16 v[28:31], v[40:43], v[64:67], v[28:31]
    ds_read_b128 v[100:103], v6 offset:2368
    v_mfma_f32_16x16x32_f16 v[24:27], v[40:43], v[60:63], v[24:27]
    ds_read_b64 v[84:85], v5 offset:1344
    v_mfma_f32_16x16x32_f16 v[20:23], v[40:43], v[56:59], v[20:23]
    ds_read_b64 v[86:87], v5 offset:1352
    v_mfma_f32_16x16x32_f16 v[16:19], v[40:43], v[52:55], v[16:19]
    ds_read_b128 v[96:99], v6 offset:2880
    s_waitcnt lgkmcnt(12)
    v_mfma_f32_16x16x32_f16 v[28:31], v[44:47], v[60:63], v[28:31]
    ds_read_b64 v[88:89], v5 offset:1856
    v_mfma_f32_16x16x32_f16 v[24:27], v[44:47], v[56:59], v[24:27]
    ds_read_b64 v[90:91], v5 offset:1864
    v_mfma_f32_16x16x32_f16 v[20:23], v[44:47], v[52:55], v[20:23]
    ds_read_b128 v[92:95], v6 offset:3392
    v_mfma_f32_16x16x32_f16 v[16:19], v[44:47], v[48:51], v[16:19]
    s_waitcnt lgkmcnt(9)
    v_mfma_f32_16x16x32_f16 v[28:31], v[76:79], v[116:119], v[28:31]
    ds_read_b64 v[32:33], v5 offset:384
    v_mfma_f32_16x16x32_f16 v[24:27], v[76:79], v[112:115], v[24:27]
    ds_read_b64 v[34:35], v5 offset:392
    v_mfma_f32_16x16x32_f16 v[20:23], v[76:79], v[108:111], v[20:23]
    ds_read_b128 v[72:75], v6 offset:384
    v_mfma_f32_16x16x32_f16 v[16:19], v[76:79], v[104:107], v[16:19]
    ds_read_b128 v[68:71], v6 offset:896
    s_waitcnt lgkmcnt(10)
    v_mfma_f32_16x16x32_f16 v[28:31], v[80:83], v[112:115], v[28:31]
    ds_read_b128 v[64:67], v6 offset:1408
    v_mfma_f32_16x16x32_f16 v[24:27], v[80:83], v[108:111], v[24:27]
    ds_read_b128 v[60:63], v6 offset:1920
    v_mfma_f32_16x16x32_f16 v[20:23], v[80:83], v[104:107], v[20:23]
    ds_read_b64 v[36:37], v5 offset:896
    v_mfma_f32_16x16x32_f16 v[16:19], v[80:83], v[100:103], v[16:19]
    ds_read_b64 v[38:39], v5 offset:904
    s_waitcnt lgkmcnt(11)
    v_mfma_f32_16x16x32_f16 v[28:31], v[84:87], v[108:111], v[28:31]
    ds_read_b128 v[56:59], v6 offset:2432
    v_mfma_f32_16x16x32_f16 v[24:27], v[84:87], v[104:107], v[24:27]
    ds_read_b64 v[40:41], v5 offset:1408
    v_mfma_f32_16x16x32_f16 v[20:23], v[84:87], v[100:103], v[20:23]
    ds_read_b64 v[42:43], v5 offset:1416
    v_mfma_f32_16x16x32_f16 v[16:19], v[84:87], v[96:99], v[16:19]
    ds_read_b128 v[52:55], v6 offset:2944
    s_waitcnt lgkmcnt(12)
    v_mfma_f32_16x16x32_f16 v[28:31], v[88:91], v[104:107], v[28:31]
    ds_read_b64 v[44:45], v5 offset:1920
    v_mfma_f32_16x16x32_f16 v[24:27], v[88:91], v[100:103], v[24:27]
    ds_read_b64 v[46:47], v5 offset:1928
    v_mfma_f32_16x16x32_f16 v[20:23], v[88:91], v[96:99], v[20:23]
    ds_read_b128 v[48:51], v6 offset:3456
    v_mfma_f32_16x16x32_f16 v[16:19], v[88:91], v[92:95], v[16:19]
    s_waitcnt lgkmcnt(9)
    v_mfma_f32_16x16x32_f16 v[28:31], v[32:35], v[72:75], v[28:31]
    ds_read_b64 v[76:77], v5 offset:448
    v_mfma_f32_16x16x32_f16 v[24:27], v[32:35], v[68:71], v[24:27]
    ds_read_b64 v[78:79], v5 offset:456
    v_mfma_f32_16x16x32_f16 v[20:23], v[32:35], v[64:67], v[20:23]
    ds_read_b128 v[116:119], v6 offset:448
    v_mfma_f32_16x16x32_f16 v[16:19], v[32:35], v[60:63], v[16:19]
    ds_read_b128 v[112:115], v6 offset:960
    s_waitcnt lgkmcnt(10)
    v_mfma_f32_16x16x32_f16 v[28:31], v[36:39], v[68:71], v[28:31]
    ds_read_b128 v[108:111], v6 offset:1472
    v_mfma_f32_16x16x32_f16 v[24:27], v[36:39], v[64:67], v[24:27]
    ds_read_b128 v[104:107], v6 offset:1984
    v_mfma_f32_16x16x32_f16 v[20:23], v[36:39], v[60:63], v[20:23]
    ds_read_b64 v[80:81], v5 offset:960
    v_mfma_f32_16x16x32_f16 v[16:19], v[36:39], v[56:59], v[16:19]
    ds_read_b64 v[82:83], v5 offset:968
    s_waitcnt lgkmcnt(11)
    v_mfma_f32_16x16x32_f16 v[28:31], v[40:43], v[64:67], v[28:31]
    ds_read_b128 v[100:103], v6 offset:2496
    v_mfma_f32_16x16x32_f16 v[24:27], v[40:43], v[60:63], v[24:27]
    ds_read_b64 v[84:85], v5 offset:1472
    v_mfma_f32_16x16x32_f16 v[20:23], v[40:43], v[56:59], v[20:23]
    ds_read_b64 v[86:87], v5 offset:1480
    v_mfma_f32_16x16x32_f16 v[16:19], v[40:43], v[52:55], v[16:19]
    ds_read_b128 v[96:99], v6 offset:3008
    s_waitcnt lgkmcnt(12)
    v_mfma_f32_16x16x32_f16 v[28:31], v[44:47], v[60:63], v[28:31]
    ds_read_b64 v[88:89], v5 offset:1984
    v_mfma_f32_16x16x32_f16 v[24:27], v[44:47], v[56:59], v[24:27]
    ds_read_b64 v[90:91], v5 offset:1992
    v_mfma_f32_16x16x32_f16 v[20:23], v[44:47], v[52:55], v[20:23]
    ds_read_b128 v[92:95], v6 offset:3520
    v_mfma_f32_16x16x32_f16 v[16:19], v[44:47], v[48:51], v[16:19]
    s_waitcnt lgkmcnt(9)
    v_mfma_f32_16x16x32_f16 v[28:31], v[76:79], v[116:119], v[28:31]
    v_mfma_f32_16x16x32_f16 v[24:27], v[76:79], v[112:115], v[24:27]
    v_mfma_f32_16x16x32_f16 v[20:23], v[76:79], v[108:111], v[20:23]
    v_mfma_f32_16x16x32_f16 v[16:19], v[76:79], v[104:107], v[16:19]
    s_waitcnt lgkmcnt(6)
    v_mfma_f32_16x16x32_f16 v[28:31], v[80:83], v[112:115], v[28:31]
    v_mfma_f32_16x16x32_f16 v[24:27], v[80:83], v[108:111], v[24:27]
    v_mfma_f32_16x16x32_f16 v[20:23], v[80:83], v[104:107], v[20:23]
    v_mfma_f32_16x16x32_f16 v[16:19], v[80:83], v[100:103], v[16:19]
    s_waitcnt lgkmcnt(3)
    v_mfma_f32_16x16x32_f16 v[28:31], v[84:87], v[108:111], v[28:31]
    v_mfma_f32_16x16x32_f16 v[24:27], v[84:87], v[104:107], v[24:27]
    v_mfma_f32_16x16x32_f16 v[20:23], v[84:87], v[100:103], v[20:23]
    v_mfma_f32_16x16x32_f16 v[16:19], v[84:87], v[96:99], v[16:19]
    s_waitcnt lgkmcnt(0)
    v_mfma_f32_16x16x32_f16 v[28:31], v[88:91], v[104:107], v[28:31]
    v_mfma_f32_16x16x32_f16 v[24:27], v[88:91], v[100:103], v[24:27]
    v_mfma_f32_16x16x32_f16 v[20:23], v[88:91], v[96:99], v[20:23]
    v_mfma_f32_16x16x32_f16 v[16:19], v[88:91], v[92:95], v[16:19]
    s_nop 4
    v_ldexp_f32 v28, v28, v167
    v_ldexp_f32 v29, v29, v167
    v_ldexp_f32 v30, v30, v167
    v_ldexp_f32 v31, v31, v167
    v_cvt_pk_bf16_f32 v28, v28, v29
    v_cvt_pk_bf16_f32 v29, v30, v31
    ds_write_b64 v7, v[28:29] offset:3840
    v_ldexp_f32 v24, v24, v167
    v_ldexp_f32 v25, v25, v167
    v_ldexp_f32 v26, v26, v167
    v_ldexp_f32 v27, v27, v167
    v_cvt_pk_bf16_f32 v24, v24, v25
    v_cvt_pk_bf16_f32 v25, v26, v27
    ds_write_b64 v7, v[24:25] offset:3328
    v_ldexp_f32 v20, v20, v167
    v_ldexp_f32 v21, v21, v167
    v_ldexp_f32 v22, v22, v167
    v_ldexp_f32 v23, v23, v167
    v_cvt_pk_bf16_f32 v20, v20, v21
    v_cvt_pk_bf16_f32 v21, v22, v23
    ds_write_b64 v7, v[20:21] offset:2816
    v_ldexp_f32 v16, v16, v167
    v_ldexp_f32 v17, v17, v167
    v_ldexp_f32 v18, v18, v167
    v_ldexp_f32 v19, v19, v167
    v_cvt_pk_bf16_f32 v16, v16, v17
    v_cvt_pk_bf16_f32 v17, v18, v19
    ds_write_b64 v7, v[16:17] offset:2304
    s_waitcnt lgkmcnt(0)
    v_mov_b32 v8, 1
    s_mov_b64 exec, 1
    ds_add_u32 v1, v8 offset:36
    s_mov_b64 exec, -1
    s_endpgm
K_END:
    s_endpgm
CODE_END:
.section .rodata,"a"
.p2align 6
.amdhsa_kernel k1_kernel
  .amdhsa_next_free_vgpr 168
  .amdhsa_next_free_sgpr 102
  .amdhsa_accum_offset 168
  .amdhsa_group_segment_fixed_size 0
  .amdhsa_kernarg_size 144
  .amdhsa_user_sgpr_count 2
  .amdhsa_user_sgpr_kernarg_segment_ptr 1
  .amdhsa_system_sgpr_workgroup_id_x 1
.end_amdhsa_kernel
```

```asm
; @launch kernel=k1_kernel grid=(256,1,1) block=(768,1,1) lds=163840
.amdgcn_target "amdgcn-amd-amdhsa--gfx950"
.text
.p2align 8
.globl k1_kernel
.type k1_kernel,@function
k1_kernel:
    s_cmp_ge_u32 s2, 256
    s_cbranch_scc1 K_END
    v_lshrrev_b32 v1, 6, v0
    v_and_b32 v2, 63, v0
    v_readfirstlane_b32 s3, v1
    v_mov_b32 v1, 0
    s_cmp_lg_u32 s3, 7
    s_cbranch_scc1 K_NOZ
    v_lshlrev_b32 v3, 2, v2
    ds_write_b32 v3, v1
    s_waitcnt lgkmcnt(0)
K_NOZ:
    s_load_dwordx16 s[16:31], s[0:1], 0
    s_load_dwordx16 s[32:47], s[0:1], 64
    s_load_dwordx4 s[48:51], s[0:1], 128
    v_and_b32 v3, 15, v2
    v_lshrrev_b32 v4, 4, v2
    s_and_b32 s4, s2, 7
    s_lshr_b32 s5, s2, 3
    s_cmp_eq_u32 s3, 8
    s_cbranch_scc1 ROUTER
    s_cmp_lg_u32 s3, 10
    s_cbranch_scc1 K_NOCPF
    s_cmp_lg_u32 s5, 9
    s_cbranch_scc1 K_NOCPF
    s_getpc_b64 s[8:9]
    s_and_b32 s8, s8, 0xffffff00
    v_lshlrev_b32 v8, 7, v2
    v_add_u32 v9, 0, v8
    v_min_u32 v9, CODE_END-k1_kernel-4, v9
    global_load_dword v160, v9, s[8:9]
    v_add_u32 v9, 8192, v8
    v_min_u32 v9, CODE_END-k1_kernel-4, v9
    global_load_dword v161, v9, s[8:9]
    v_add_u32 v9, 16384, v8
    v_min_u32 v9, CODE_END-k1_kernel-4, v9
    global_load_dword v162, v9, s[8:9]
    v_add_u32 v9, 24576, v8
    v_min_u32 v9, CODE_END-k1_kernel-4, v9
    global_load_dword v163, v9, s[8:9]
K_NOCPF:
    s_cmp_ge_u32 s5, 14
    s_cbranch_scc1 K_CONV
    s_mul_i32 s7, s4, 9
    s_add_u32 s7, s7, s5
    s_mov_b32 s12, s3
    s_cmp_lt_u32 s3, 2
    s_cbranch_scc1 GATE
    s_cmp_ge_u32 s5, 9
    s_cbranch_scc1 HELPER
    s_cmp_lt_u32 s3, 8
    s_cbranch_scc1 F_COMP
    s_branch F_LOAD
K_CONV:
    s_mul_i32 s7, s4, 18
    s_add_u32 s7, s7, s5
    s_sub_u32 s7, s7, 14
    s_cmp_lt_u32 s3, 8
    s_cbranch_scc1 C_KGEN
    s_sub_u32 s12, s3, 9
    s_cmp_lt_u32 s3, 11
    s_cbranch_scc1 GATE
C_LOAD:
    s_setprio 3
    s_sub_u32 s13, s5, 14
    s_mul_i32 s8, s13, 73728
    s_lshl_b32 s9, s4, 7
    s_add_u32 s8, s8, s9
    v_mul_u32_u24 v9, 1152, v2
    v_add_u32 v9, s8, v9
    s_add_u32 s8, s13, 18
    s_min_u32 s8, s8, 31
    s_sub_u32 s8, s8, s13
    s_mul_i32 s8, s8, 73728
    v_add_u32 v8, s8, v9
    v_mul_u32_u24 v6, 4608, v2
    s_lshl_b32 s8, s7, 3
    v_add_u32 v6, s8, v6
    v_lshlrev_b32 v7, 3, v2
    v_sub_u32 v7, 73464, v7
    s_mov_b32 s56, 0x05040100
    s_mov_b32 s58, 0x07060302
    s_mul_i32 s8, s4, 663552
    s_mul_i32 s9, s13, 36864
    s_add_u32 s8, s8, s9
    v_lshl_add_u32 v14, v2, 7, s8
    v_min_u32 v15, 31, v2
    v_lshl_add_u32 v15, v15, 7, s8
    s_mov_b32 s57, s13
    s_waitcnt lgkmcnt(0)
    s_mov_b32 s72, s16
    s_mov_b32 s73, s17
    s_mov_b32 s74, 2359296
    s_mov_b32 s75, 0x20000
    s_barrier
    global_load_dword v10, v9, s[16:17]
    global_load_dword v11, v9, s[16:17] offset:128
    global_load_dword v10, v8, s[16:17]
    global_load_dword v11, v8, s[16:17] offset:128
    s_mul_i32 s7, s4, 18
    s_add_u32 s7, s7, s5
    s_sub_u32 s7, s7, 14
    s_lshl_b32 s55, s7, 3
    s_sub_u32 s12, s3, 8
    s_mov_b32 s60, s46
    s_mov_b32 s61, s47
    s_mov_b32 s62, 2359296
    s_mov_b32 s63, 0x20000
    s_mov_b32 s15, 0
    v_mov_b32 v12, 1
    s_waitcnt vmcnt(2)
    buffer_load_dwordx2 v[104:105], v6, s[72:75], s15 offen offset:0
    buffer_load_dwordx2 v[106:107], v6, s[72:75], s15 offen offset:1152
    buffer_load_dwordx2 v[108:109], v6, s[72:75], s15 offen offset:2304
    buffer_load_dwordx2 v[110:111], v6, s[72:75], s15 offen offset:3456
    s_add_u32 s15, s15, 294912
    buffer_load_dwordx2 v[112:113], v6, s[72:75], s15 offen offset:0
    s_waitcnt vmcnt(4)
    buffer_load_dwordx2 v[114:115], v6, s[72:75], s15 offen offset:1152
    s_waitcnt vmcnt(4)
    buffer_load_dwordx2 v[116:117], v6, s[72:75], s15 offen offset:2304
    s_waitcnt vmcnt(4)
    buffer_load_dwordx2 v[118:119], v6, s[72:75], s15 offen offset:3456
    s_add_u32 s15, s15, 294912
    s_waitcnt vmcnt(4)
    buffer_load_dwordx2 v[120:121], v6, s[72:75], s15 offen offset:0
    v_perm_b32 v16, v108, v110, s56
    v_perm_b32 v17, v104, v106, s56
    ds_write_b64 v7, v[16:17] offset:3584
    v_perm_b32 v18, v108, v110, s58
    v_perm_b32 v19, v104, v106, s58
    ds_write_b64 v7, v[18:19] offset:8256
    v_perm_b32 v20, v109, v111, s56
    v_perm_b32 v21, v105, v107, s56
    ds_write_b64 v7, v[20:21] offset:12928
    v_perm_b32 v22, v109, v111, s58
    v_perm_b32 v23, v105, v107, s58
    ds_write_b64 v7, v[22:23] offset:17600
    s_waitcnt vmcnt(4)
    buffer_load_dwordx2 v[122:123], v6, s[72:75], s15 offen offset:1152
    s_waitcnt vmcnt(4)
    buffer_load_dwordx2 v[124:125], v6, s[72:75], s15 offen offset:2304
    s_waitcnt vmcnt(4)
    buffer_load_dwordx2 v[126:127], v6, s[72:75], s15 offen offset:3456
    s_add_u32 s15, s15, 294912
    s_waitcnt vmcnt(4)
    buffer_load_dwordx2 v[128:129], v6, s[72:75], s15 offen offset:0
    v_perm_b32 v24, v116, v118, s56
    v_perm_b32 v25, v112, v114, s56
    ds_write_b64 v7, v[24:25] offset:3072
    v_perm_b32 v26, v116, v118, s58
    v_perm_b32 v27, v112, v114, s58
    ds_write_b64 v7, v[26:27] offset:7744
    v_perm_b32 v28, v117, v119, s56
    v_perm_b32 v29, v113, v115, s56
    ds_write_b64 v7, v[28:29] offset:12416
    v_perm_b32 v30, v117, v119, s58
    v_perm_b32 v31, v113, v115, s58
    ds_write_b64 v7, v[30:31] offset:17088
    s_waitcnt vmcnt(4)
    buffer_load_dwordx2 v[130:131], v6, s[72:75], s15 offen offset:1152
    s_waitcnt vmcnt(4)
    buffer_load_dwordx2 v[132:133], v6, s[72:75], s15 offen offset:2304
    s_waitcnt vmcnt(4)
    buffer_load_dwordx2 v[134:135], v6, s[72:75], s15 offen offset:3456
    s_add_u32 s15, s15, 294912
    s_waitcnt vmcnt(4)
    buffer_load_dwordx2 v[136:137], v6, s[72:75], s15 offen offset:0
    v_perm_b32 v16, v124, v126, s56
    v_perm_b32 v17, v120, v122, s56
    ds_write_b64 v7, v[16:17] offset:2560
    v_perm_b32 v18, v124, v126, s58
    v_perm_b32 v19, v120, v122, s58
    ds_write_b64 v7, v[18:19] offset:7232
    v_perm_b32 v20, v125, v127, s56
    v_perm_b32 v21, v121, v123, s56
    ds_write_b64 v7, v[20:21] offset:11904
    v_perm_b32 v22, v125, v127, s58
    v_perm_b32 v23, v121, v123, s58
    ds_write_b64 v7, v[22:23] offset:16576
    s_waitcnt vmcnt(4)
    buffer_load_dwordx2 v[138:139], v6, s[72:75], s15 offen offset:1152
    s_waitcnt vmcnt(4)
    buffer_load_dwordx2 v[140:141], v6, s[72:75], s15 offen offset:2304
    s_waitcnt vmcnt(4)
    buffer_load_dwordx2 v[142:143], v6, s[72:75], s15 offen offset:3456
    s_add_u32 s15, s15, 294912
    s_waitcnt vmcnt(4)
    buffer_load_dwordx2 v[144:145], v6, s[72:75], s15 offen offset:0
    v_perm_b32 v24, v132, v134, s56
    v_perm_b32 v25, v128, v130, s56
    ds_write_b64 v7, v[24:25] offset:2048
    v_perm_b32 v26, v132, v134, s58
    v_perm_b32 v27, v128, v130, s58
    ds_write_b64 v7, v[26:27] offset:6720
    v_perm_b32 v28, v133, v135, s56
    v_perm_b32 v29, v129, v131, s56
    ds_write_b64 v7, v[28:29] offset:11392
    v_perm_b32 v30, v133, v135, s58
    v_perm_b32 v31, v129, v131, s58
    ds_write_b64 v7, v[30:31] offset:16064
    ds_write_b32 v1, v12 offset:80
    s_waitcnt vmcnt(4)
    buffer_load_dwordx2 v[146:147], v6, s[72:75], s15 offen offset:1152
    s_waitcnt vmcnt(4)
    buffer_load_dwordx2 v[148:149], v6, s[72:75], s15 offen offset:2304
    s_waitcnt vmcnt(4)
    buffer_load_dwordx2 v[150:151], v6, s[72:75], s15 offen offset:3456
    s_add_u32 s15, s15, 294912
    s_waitcnt vmcnt(4)
    buffer_load_dwordx2 v[152:153], v6, s[72:75], s15 offen offset:0
    v_perm_b32 v16, v140, v142, s56
    v_perm_b32 v17, v136, v138, s56
    ds_write_b64 v7, v[16:17] offset:1536
    v_perm_b32 v18, v140, v142, s58
    v_perm_b32 v19, v136, v138, s58
    ds_write_b64 v7, v[18:19] offset:6208
    v_perm_b32 v20, v141, v143, s56
    v_perm_b32 v21, v137, v139, s56
    ds_write_b64 v7, v[20:21] offset:10880
    v_perm_b32 v22, v141, v143, s58
    v_perm_b32 v23, v137, v139, s58
    ds_write_b64 v7, v[22:23] offset:15552
    s_waitcnt vmcnt(4)
    buffer_load_dwordx2 v[154:155], v6, s[72:75], s15 offen offset:1152
    s_waitcnt vmcnt(4)
    buffer_load_dwordx2 v[156:157], v6, s[72:75], s15 offen offset:2304
    s_waitcnt vmcnt(4)
    buffer_load_dwordx2 v[158:159], v6, s[72:75], s15 offen offset:3456
    s_add_u32 s15, s15, 294912
    s_waitcnt vmcnt(4)
    buffer_load_dwordx2 v[160:161], v6, s[72:75], s15 offen offset:0
    v_perm_b32 v24, v148, v150, s56
    v_perm_b32 v25, v144, v146, s56
    ds_write_b64 v7, v[24:25] offset:1024
    v_perm_b32 v26, v148, v150, s58
    v_perm_b32 v27, v144, v146, s58
    ds_write_b64 v7, v[26:27] offset:5696
    v_perm_b32 v28, v149, v151, s56
    v_perm_b32 v29, v145, v147, s56
    ds_write_b64 v7, v[28:29] offset:10368
    v_perm_b32 v30, v149, v151, s58
    v_perm_b32 v31, v145, v147, s58
    ds_write_b64 v7, v[30:31] offset:15040
    s_waitcnt vmcnt(4)
    buffer_load_dwordx2 v[162:163], v6, s[72:75], s15 offen offset:1152
    s_waitcnt vmcnt(4)
    buffer_load_dwordx2 v[164:165], v6, s[72:75], s15 offen offset:2304
    s_waitcnt vmcnt(4)
    buffer_load_dwordx2 v[166:167], v6, s[72:75], s15 offen offset:3456
    s_add_u32 s15, s15, 294912
    v_add_u32 v88, 0, v14
    global_load_dword v96, v88, s[42:43]
    v_add_u32 v89, 8192, v14
    global_load_dword v97, v89, s[42:43]
    v_add_u32 v90, 16384, v14
    global_load_dword v98, v90, s[42:43]
    v_add_u32 v91, 24576, v14
    global_load_dword v99, v91, s[42:43]
    v_add_u32 v92, 32768, v15
    global_load_dword v100, v92, s[42:43]
    s_waitcnt vmcnt(9)
    v_perm_b32 v16, v156, v158, s56
    v_perm_b32 v17, v152, v154, s56
    ds_write_b64 v7, v[16:17] offset:512
    v_perm_b32 v18, v156, v158, s58
    v_perm_b32 v19, v152, v154, s58
    ds_write_b64 v7, v[18:19] offset:5184
    v_perm_b32 v20, v157, v159, s56
    v_perm_b32 v21, v153, v155, s56
    ds_write_b64 v7, v[20:21] offset:9856
    v_perm_b32 v22, v157, v159, s58
    v_perm_b32 v23, v153, v155, s58
    ds_write_b64 v7, v[22:23] offset:14528
    s_waitcnt vmcnt(8)
    s_waitcnt vmcnt(7)
    s_waitcnt vmcnt(6)
    s_waitcnt vmcnt(5)
    v_perm_b32 v24, v164, v166, s56
    v_perm_b32 v25, v160, v162, s56
    ds_write_b64 v7, v[24:25] offset:0
    v_perm_b32 v26, v164, v166, s58
    v_perm_b32 v27, v160, v162, s58
    ds_write_b64 v7, v[26:27] offset:4672
    v_perm_b32 v28, v165, v167, s56
    v_perm_b32 v29, v161, v163, s56
    ds_write_b64 v7, v[28:29] offset:9344
    v_perm_b32 v30, v165, v167, s58
    v_perm_b32 v31, v161, v163, s58
    ds_write_b64 v7, v[30:31] offset:14016
    ds_write_b32 v1, v12 offset:84
    s_branch C_IO2
C_IO:
    s_mul_i32 s7, s4, 18
    s_add_u32 s7, s7, s5
    s_sub_u32 s7, s7, 14
    s_lshl_b32 s55, s7, 3
    s_sub_u32 s12, s3, 8
    s_mov_b32 s60, s46
    s_mov_b32 s61, s47
    s_mov_b32 s62, 2359296
    s_mov_b32 s63, 0x20000
C_IO2:
    s_lshl_b32 s14, s12, 1
    s_add_u32 s14, s14, 16
    s_lshl_b32 s8, s14, 8
    s_add_u32 s8, s8, 8192
    v_xor_b32 v6, 63, v2
    v_lshrrev_b32 v6, 1, v6
    v_lshl_add_u32 v6, v6, 3, s8
    s_lshl_b32 s14, s12, 2
    s_lshl_b32 s8, s14, 8
    s_add_u32 s8, s8, 8192
    v_xor_b32 v5, 63, v2
    v_lshrrev_b32 v5, 1, v5
    v_lshl_add_u32 v5, v5, 3, s8
    s_mov_b32 s9, 0
SP_1:
    ds_read_b32 v10, v1 offset:8
    s_waitcnt lgkmcnt(0)
    v_readfirstlane_b32 s8, v10
    s_add_u32 s9, s9, 1
    s_cmp_lg_u32 s8, 0
    s_cbranch_scc1 SP_1_D
    s_cmp_lt_u32 s9, 524288
    s_cbranch_scc1 SP_1
SP_1_D:
    s_setprio 0
    s_mov_b32 s9, 0
SP_2:
    ds_read_b32 v12, v1 offset:80
    s_waitcnt lgkmcnt(0)
    v_readfirstlane_b32 s8, v12
    s_add_u32 s9, s9, 1
    s_cmp_ge_u32 s8, 1
    s_cbranch_scc1 SP_2_D
    s_sleep 2
    s_cmp_lt_u32 s9, 524288
    s_cbranch_scc1 SP_2
SP_2_D:
    s_setprio 3
    global_load_dwordx2 v[104:105], v5, s[50:51] offset:0 sc1
    global_load_dwordx2 v[106:107], v5, s[50:51] offset:256 sc1
    global_load_dwordx2 v[108:109], v5, s[50:51] offset:512 sc1
    global_load_dwordx2 v[110:111], v5, s[50:51] offset:768 sc1
    global_load_dwordx2 v[112:113], v6, s[50:51] offset:0 sc1
    global_load_dwordx2 v[114:115], v6, s[50:51] offset:256 sc1
    v_bfe_u32 v12, v2, 2, 2
    v_mul_u32_u24 v12, 4672, v12
    v_and_b32 v13, 3, v2
    v_lshl_add_u32 v13, v4, 2, v13
    v_lshl_add_u32 v12, v13, 3, v12
    s_lshl_b32 s8, s14, 7
    s_sub_u32 s8, 76544, s8
    v_add_u32 v12, s8, v12
    ds_read_b64_tr_b16 v[44:45], v12 offset:384
    ds_read_b64_tr_b16 v[50:51], v12 offset:256
    ds_read_b64_tr_b16 v[56:57], v12 offset:128
    ds_read_b64_tr_b16 v[62:63], v12 offset:0
    s_waitcnt lgkmcnt(0)
    v_lshlrev_b32 v40, 16, v44
    v_and_b32 v41, 0xffff0000, v44
    v_lshlrev_b32 v42, 16, v45
    v_and_b32 v43, 0xffff0000, v45
    v_lshlrev_b32 v46, 16, v50
    v_and_b32 v47, 0xffff0000, v50
    v_lshlrev_b32 v48, 16, v51
    v_and_b32 v49, 0xffff0000, v51
    v_lshlrev_b32 v52, 16, v56
    v_and_b32 v53, 0xffff0000, v56
    v_lshlrev_b32 v54, 16, v57
    v_and_b32 v55, 0xffff0000, v57
    v_lshlrev_b32 v58, 16, v62
    v_and_b32 v59, 0xffff0000, v62
    v_lshlrev_b32 v60, 16, v63
    v_and_b32 v61, 0xffff0000, v63
    s_mov_b32 s9, 0
GP_3:
    s_waitcnt vmcnt(0)
    v_xor_b32 v14, v105, v10
    v_bitop3_b32 v14, v14, v107, v10 bitop3:0xf6
    v_bitop3_b32 v14, v14, v109, v10 bitop3:0xf6
    v_bitop3_b32 v14, v14, v111, v10 bitop3:0xf6
    v_bitop3_b32 v14, v14, v113, v10 bitop3:0xf6
    v_bitop3_b32 v14, v14, v115, v10 bitop3:0xf6
    v_cmp_ne_u32 vcc, 0, v14
    s_add_u32 s9, s9, 1
    s_cmp_eq_u64 vcc, 0
    s_cbranch_scc1 GP_3_D
    s_cmp_ge_u32 s9, 131072
    s_cbranch_scc1 GP_3_D
    global_load_dwordx2 v[104:105], v5, s[50:51] offset:0 sc1
    global_load_dwordx2 v[106:107], v5, s[50:51] offset:256 sc1
    global_load_dwordx2 v[108:109], v5, s[50:51] offset:512 sc1
    global_load_dwordx2 v[110:111], v5, s[50:51] offset:768 sc1
    global_load_dwordx2 v[112:113], v6, s[50:51] offset:0 sc1
    global_load_dwordx2 v[114:115], v6, s[50:51] offset:256 sc1
    s_branch GP_3
GP_3_D:
    v_and_b32 v11, 1, v2
    v_lshlrev_b32 v11, 4, v11
    s_lshl_b32 s8, s14, 8
    s_add_u32 s8, s8, 91648
    v_xor_b32 v12, 63, v2
    v_lshl_add_u32 v12, v12, 2, s8
    v_lshlrev_b32 v44, v11, v104
    v_lshlrev_b32 v50, v11, v106
    v_lshlrev_b32 v56, v11, v108
    v_lshlrev_b32 v62, v11, v110
    v_and_b32 v44, 0xffff0000, v44
    v_and_b32 v50, 0xffff0000, v50
    v_and_b32 v56, 0xffff0000, v56
    v_and_b32 v62, 0xffff0000, v62
    v_sub_f32 v45, 1.0, v44
    v_sub_f32 v51, 1.0, v50
    v_sub_f32 v57, 1.0, v56
    v_sub_f32 v63, 1.0, v62
    v_cvt_pk_bf16_f32 v45, v45, v45
    v_cvt_pk_bf16_f32 v51, v51, v51
    v_cvt_pk_bf16_f32 v57, v57, v57
    v_cvt_pk_bf16_f32 v63, v63, v63
    v_and_b32 v45, 0xffff0000, v45
    v_and_b32 v51, 0xffff0000, v51
    v_and_b32 v57, 0xffff0000, v57
    v_and_b32 v63, 0xffff0000, v63
    v_mul_f32 v40, v40, v45
    v_mul_f32 v41, v41, v45
    v_mul_f32 v42, v42, v45
    v_mul_f32 v43, v43, v45
    ds_write_b32 v12, v44 offset:0
    v_mul_f32 v46, v46, v51
    v_mul_f32 v47, v47, v51
    v_mul_f32 v48, v48, v51
    v_mul_f32 v49, v49, v51
    ds_write_b32 v12, v50 offset:256
    v_mul_f32 v52, v52, v57
    v_mul_f32 v53, v53, v57
    v_mul_f32 v54, v54, v57
    v_mul_f32 v55, v55, v57
    ds_write_b32 v12, v56 offset:512
    v_mul_f32 v58, v58, v63
    v_mul_f32 v59, v59, v63
    v_mul_f32 v60, v60, v63
    v_mul_f32 v61, v61, v63
    ds_write_b32 v12, v62 offset:768
    v_bfe_u32 v12, v2, 2, 2
    v_mul_u32_u24 v12, 4160, v12
    v_and_b32 v13, 3, v2
    v_lshl_add_u32 v13, v4, 2, v13
    v_lshl_add_u32 v12, v13, 3, v12
    s_lshl_b32 s8, s14, 7
    s_sub_u32 s8, 103424, s8
    v_add_u32 v12, s8, v12
    v_xor_b32 v14, 63, v2
    v_mul_u32_u24 v14, 1152, v14
    v_add_u32 v14, s55, v14
    s_mul_i32 s15, s14, 73728
    s_setprio 0
    s_mov_b32 s9, 0
SP_4:
    ds_read_b32 v15, v1 offset:32
    s_waitcnt lgkmcnt(0)
    v_readfirstlane_b32 s8, v15
    s_add_u32 s9, s9, 1
    s_cmp_ge_u32 s8, 4
    s_cbranch_scc1 SP_4_D
    s_sleep 2
    s_cmp_lt_u32 s9, 524288
    s_cbranch_scc1 SP_4
SP_4_D:
    s_setprio 3
    ds_read_b64_tr_b16 v[16:17], v12 offset:384
    ds_read_b64_tr_b16 v[18:19], v12 offset:256
    ds_read_b64_tr_b16 v[20:21], v12 offset:128
    ds_read_b64_tr_b16 v[22:23], v12 offset:0
    s_waitcnt lgkmcnt(3)
    v_lshlrev_b32 v24, 16, v16
    v_and_b32 v25, 0xffff0000, v16
    v_lshlrev_b32 v26, 16, v17
    v_and_b32 v27, 0xffff0000, v17
    v_fmac_f32 v40, v24, v44
    v_fmac_f32 v41, v25, v44
    v_fmac_f32 v42, v26, v44
    v_fmac_f32 v43, v27, v44
    v_cvt_pk_bf16_f32 v40, v40, v41
    v_cvt_pk_bf16_f32 v41, v42, v43
    buffer_store_dwordx2 v[40:41], v14, s[60:63], s15 offen
    s_add_u32 s15, s15, 73728
    s_waitcnt lgkmcnt(2)
    v_lshlrev_b32 v28, 16, v18
    v_and_b32 v29, 0xffff0000, v18
    v_lshlrev_b32 v30, 16, v19
    v_and_b32 v31, 0xffff0000, v19
    v_fmac_f32 v46, v28, v50
    v_fmac_f32 v47, v29, v50
    v_fmac_f32 v48, v30, v50
    v_fmac_f32 v49, v31, v50
    v_cvt_pk_bf16_f32 v46, v46, v47
    v_cvt_pk_bf16_f32 v47, v48, v49
    buffer_store_dwordx2 v[46:47], v14, s[60:63], s15 offen
    s_add_u32 s15, s15, 73728
    s_waitcnt lgkmcnt(1)
    v_lshlrev_b32 v32, 16, v20
    v_and_b32 v33, 0xffff0000, v20
    v_lshlrev_b32 v34, 16, v21
    v_and_b32 v35, 0xffff0000, v21
    v_fmac_f32 v52, v32, v56
    v_fmac_f32 v53, v33, v56
    v_fmac_f32 v54, v34, v56
    v_fmac_f32 v55, v35, v56
    v_cvt_pk_bf16_f32 v52, v52, v53
    v_cvt_pk_bf16_f32 v53, v54, v55
    buffer_store_dwordx2 v[52:53], v14, s[60:63], s15 offen
    s_add_u32 s15, s15, 73728
    s_waitcnt lgkmcnt(0)
    v_lshlrev_b32 v36, 16, v22
    v_and_b32 v37, 0xffff0000, v22
    v_lshlrev_b32 v38, 16, v23
    v_and_b32 v39, 0xffff0000, v23
    v_fmac_f32 v58, v36, v62
    v_fmac_f32 v59, v37, v62
    v_fmac_f32 v60, v38, v62
    v_fmac_f32 v61, v39, v62
    v_cvt_pk_bf16_f32 v58, v58, v59
    v_cvt_pk_bf16_f32 v59, v60, v61
    buffer_store_dwordx2 v[58:59], v14, s[60:63], s15 offen
    s_add_u32 s15, s15, 73728
    s_setprio 0
    s_mov_b32 s9, 0
SP_5:
    ds_read_b32 v12, v1 offset:84
    s_waitcnt lgkmcnt(0)
    v_readfirstlane_b32 s8, v12
    s_add_u32 s9, s9, 1
    s_cmp_ge_u32 s8, 1
    s_cbranch_scc1 SP_5_D
    s_sleep 2
    s_cmp_lt_u32 s9, 524288
    s_cbranch_scc1 SP_5
SP_5_D:
    s_setprio 3
    s_lshl_b32 s14, s12, 1
    s_add_u32 s14, s14, 16
    v_bfe_u32 v12, v2, 2, 2
    v_mul_u32_u24 v12, 4672, v12
    v_and_b32 v13, 3, v2
    v_lshl_add_u32 v13, v4, 2, v13
    v_lshl_add_u32 v12, v13, 3, v12
    s_lshl_b32 s8, s14, 7
    s_sub_u32 s8, 76800, s8
    v_add_u32 v12, s8, v12
    ds_read_b64_tr_b16 v[68:69], v12 offset:128
    ds_read_b64_tr_b16 v[74:75], v12 offset:0
    s_waitcnt lgkmcnt(0)
    v_lshlrev_b32 v64, 16, v68
    v_and_b32 v65, 0xffff0000, v68
    v_lshlrev_b32 v66, 16, v69
    v_and_b32 v67, 0xffff0000, v69
    v_lshlrev_b32 v70, 16, v74
    v_and_b32 v71, 0xffff0000, v74
    v_lshlrev_b32 v72, 16, v75
    v_and_b32 v73, 0xffff0000, v75
    v_and_b32 v11, 1, v2
    v_lshlrev_b32 v11, 4, v11
    s_lshl_b32 s8, s14, 8
    s_add_u32 s8, s8, 91648
    v_xor_b32 v12, 63, v2
    v_lshl_add_u32 v12, v12, 2, s8
    v_lshlrev_b32 v68, v11, v112
    v_lshlrev_b32 v74, v11, v114
    v_and_b32 v68, 0xffff0000, v68
    v_and_b32 v74, 0xffff0000, v74
    v_sub_f32 v69, 1.0, v68
    v_sub_f32 v75, 1.0, v74
    v_cvt_pk_bf16_f32 v69, v69, v69
    v_cvt_pk_bf16_f32 v75, v75, v75
    v_and_b32 v69, 0xffff0000, v69
    v_and_b32 v75, 0xffff0000, v75
    v_mul_f32 v64, v64, v69
    v_mul_f32 v65, v65, v69
    v_mul_f32 v66, v66, v69
    v_mul_f32 v67, v67, v69
    ds_write_b32 v12, v68 offset:0
    v_mul_f32 v70, v70, v75
    v_mul_f32 v71, v71, v75
    v_mul_f32 v72, v72, v75
    v_mul_f32 v73, v73, v75
    ds_write_b32 v12, v74 offset:256
    v_bfe_u32 v12, v2, 2, 2
    v_mul_u32_u24 v12, 4160, v12
    v_and_b32 v13, 3, v2
    v_lshl_add_u32 v13, v4, 2, v13
    v_lshl_add_u32 v12, v13, 3, v12
    s_lshl_b32 s8, s14, 7
    s_sub_u32 s8, 103680, s8
    v_add_u32 v12, s8, v12
    v_xor_b32 v14, 63, v2
    v_mul_u32_u24 v14, 1152, v14
    v_add_u32 v14, s55, v14
    s_mul_i32 s15, s14, 73728
    s_setprio 0
    s_mov_b32 s9, 0
SP_6:
    ds_read_b32 v15, v1 offset:36
    s_waitcnt lgkmcnt(0)
    v_readfirstlane_b32 s8, v15
    s_add_u32 s9, s9, 1
    s_cmp_ge_u32 s8, 4
    s_cbranch_scc1 SP_6_D
    s_sleep 2
    s_cmp_lt_u32 s9, 524288
    s_cbranch_scc1 SP_6
SP_6_D:
    s_setprio 3
    ds_read_b64_tr_b16 v[16:17], v12 offset:128
    ds_read_b64_tr_b16 v[18:19], v12 offset:0
    s_waitcnt lgkmcnt(1)
    v_lshlrev_b32 v24, 16, v16
    v_and_b32 v25, 0xffff0000, v16
    v_lshlrev_b32 v26, 16, v17
    v_and_b32 v27, 0xffff0000, v17
    v_fmac_f32 v64, v24, v68
    v_fmac_f32 v65, v25, v68
    v_fmac_f32 v66, v26, v68
    v_fmac_f32 v67, v27, v68
    v_cvt_pk_bf16_f32 v64, v64, v65
    v_cvt_pk_bf16_f32 v65, v66, v67
    buffer_store_dwordx2 v[64:65], v14, s[60:63], s15 offen
    s_add_u32 s15, s15, 73728
    s_waitcnt lgkmcnt(0)
    v_lshlrev_b32 v28, 16, v18
    v_and_b32 v29, 0xffff0000, v18
    v_lshlrev_b32 v30, 16, v19
    v_and_b32 v31, 0xffff0000, v19
    v_fmac_f32 v70, v28, v74
    v_fmac_f32 v71, v29, v74
    v_fmac_f32 v72, v30, v74
    v_fmac_f32 v73, v31, v74
    v_cvt_pk_bf16_f32 v70, v70, v71
    v_cvt_pk_bf16_f32 v71, v72, v73
    buffer_store_dwordx2 v[70:71], v14, s[60:63], s15 offen
    s_add_u32 s15, s15, 73728
    s_waitcnt vmcnt(0)
    v_mov_b32 v8, 1
    s_mov_b64 exec, 1
    ds_add_u32 v1, v8 offset:40
    s_mov_b64 exec, -1
    s_endpgm
C_FIN:
    s_setprio 0
    v_and_b32 v8, 7, v2
    v_lshlrev_b32 v8, 3, v8
    v_add_u32 v8, 16384, v8
    s_mul_i32 s8, s7, 9216
    s_add_u32 s8, s8, 32768
    v_lshl_add_u32 v5, v2, 4, s8
    v_add_u32 v6, 0x1000, v5
    v_add_u32 v7, 0x2000, v5
    s_waitcnt lgkmcnt(0)
    v_lshrrev_b32 v110, 0, v10
    v_lshrrev_b32 v111, 8, v10
    v_lshrrev_b32 v112, 16, v10
    v_lshrrev_b32 v113, 24, v10
    s_mov_b32 s9, 0
C_SPOLL:
    global_load_dwordx2 v[16:17], v8, s[50:51] sc1
    s_waitcnt vmcnt(0)
    v_cmp_ne_u32 vcc, v17, v10
    s_add_u32 s9, s9, 1
    s_cmp_eq_u64 vcc, 0
    s_cbranch_scc1 C_SOK
    s_sleep 4
    s_cmp_lt_u32 s9, 131072
    s_cbranch_scc1 C_SPOLL
C_SOK:
    s_setprio 0
    s_mov_b32 s9, 0
SP_7:
    ds_read_b32 v12, v1 offset:84
    s_waitcnt lgkmcnt(0)
    v_readfirstlane_b32 s8, v12
    s_add_u32 s9, s9, 1
    s_cmp_ge_u32 s8, 1
    s_cbranch_scc1 SP_7_D
    s_sleep 1
    s_cmp_lt_u32 s9, 524288
    s_cbranch_scc1 SP_7
SP_7_D:
    s_setprio 3
    v_and_b32 v18, 0x7ff, v16
    v_sub_u32 v18, 2047, v18
    v_and_b32 v19, 1, v4
    v_lshrrev_b32 v20, 1, v4
    v_lshl_or_b32 v19, v19, 1, v20
    v_lshlrev_b32 v19, 1, v19
    v_and_b32 v22, 0x7ff, v16
    v_mul_u32_u24 v23, 2336, v19
    v_lshl_add_u32 v23, v22, 1, v23
    v_add_u32 v23, 72960, v23
    ds_read_u16 v105, v23
    v_and_b32 v20, 0xffff0000, v16
    v_ashrrev_i32 v21, 31, v20
    v_not_b32 v21, v21
    v_or_b32 v21, 0x80000000, v21
    v_and_b32 v21, 0xffff0000, v21
    v_xor_b32 v20, v20, v21
    v_mul_f32 v21, 0xbfb8aa3b, v20
    v_exp_f32 v21, v21
    s_nop 0
    v_add_f32 v21, 1.0, v21
    v_rcp_f32 v104, v21
    s_nop 0
    v_cvt_pk_bf16_f32 v104, v104, v104
    v_and_b32 v104, 0xffff0000, v104
    v_lshlrev_b32 v106, 2, v18
    v_add_u32 v106, 91648, v106
    v_mul_u32_u24 v107, 2080, v19
    v_lshl_add_u32 v107, v22, 1, v107
    v_add_u32 v107, 99840, v107
    v_mul_u32_u24 v108, 1152, v18
    v_add3_u32 v108, v108, v19, s55
    s_waitcnt lgkmcnt(0)
    v_lshlrev_b32 v105, 16, v105
    s_mov_b32 s9, 0
    s_setprio 0
    s_mov_b64 exec, 1
C_M1:
    global_load_dword v26, v5, s[50:51] sc1
    s_waitcnt vmcnt(0)
    v_xor_b32 v26, v26, v10
    v_and_b32 v26, 0xff, v26
    v_cmp_ne_u32 vcc, 0, v26
    s_add_u32 s9, s9, 1
    s_cmp_eq_u64 vcc, 0
    s_cbranch_scc1 C_M1D
    s_cmp_lt_u32 s9, 131072
    s_cbranch_scc1 C_M1
C_M1D:
    s_mov_b64 exec, -1
    s_setprio 3
    s_mov_b32 s9, 0
C_MPOLL:
    global_load_dwordx4 v[120:123], v5, s[50:51] offset:0 sc1
    global_load_dwordx4 v[124:127], v5, s[50:51] offset:1024 sc1
    global_load_dwordx4 v[128:131], v5, s[50:51] offset:2048 sc1
    global_load_dwordx4 v[132:135], v5, s[50:51] offset:3072 sc1
    global_load_dwordx4 v[136:139], v6, s[50:51] offset:0 sc1
    global_load_dwordx4 v[140:143], v6, s[50:51] offset:1024 sc1
    global_load_dwordx4 v[144:147], v6, s[50:51] offset:2048 sc1
    global_load_dwordx4 v[148:151], v6, s[50:51] offset:3072 sc1
    global_load_dwordx4 v[152:155], v7, s[50:51] offset:0 sc1
    s_waitcnt vmcnt(8)
    v_xor_b32 v26, v120, v10
    v_bitop3_b32 v26, v26, v121, v111 bitop3:0xf6
    v_bitop3_b32 v26, v26, v122, v112 bitop3:0xf6
    v_bitop3_b32 v26, v26, v123, v113 bitop3:0xf6
    s_waitcnt vmcnt(7)
    v_bitop3_b32 v26, v26, v124, v110 bitop3:0xf6
    v_bitop3_b32 v26, v26, v125, v111 bitop3:0xf6
    v_bitop3_b32 v26, v26, v126, v112 bitop3:0xf6
    v_bitop3_b32 v26, v26, v127, v113 bitop3:0xf6
    v_pk_add_f32 v[28:29], v[120:121], v[124:125]
    v_pk_add_f32 v[30:31], v[122:123], v[126:127]
    s_waitcnt vmcnt(6)
    v_bitop3_b32 v26, v26, v128, v110 bitop3:0xf6
    v_bitop3_b32 v26, v26, v129, v111 bitop3:0xf6
    v_bitop3_b32 v26, v26, v130, v112 bitop3:0xf6
    v_bitop3_b32 v26, v26, v131, v113 bitop3:0xf6
    v_pk_add_f32 v[28:29], v[28:29], v[128:129]
    v_pk_add_f32 v[30:31], v[30:31], v[130:131]
    s_waitcnt vmcnt(5)
    v_bitop3_b32 v26, v26, v132, v110 bitop3:0xf6
    v_bitop3_b32 v26, v26, v133, v111 bitop3:0xf6
    v_bitop3_b32 v26, v26, v134, v112 bitop3:0xf6
    v_bitop3_b32 v26, v26, v135, v113 bitop3:0xf6
    v_pk_add_f32 v[28:29], v[28:29], v[132:133]
    v_pk_add_f32 v[30:31], v[30:31], v[134:135]
    s_waitcnt vmcnt(4)
    v_bitop3_b32 v26, v26, v136, v110 bitop3:0xf6
    v_bitop3_b32 v26, v26, v137, v111 bitop3:0xf6
    v_bitop3_b32 v26, v26, v138, v112 bitop3:0xf6
    v_bitop3_b32 v26, v26, v139, v113 bitop3:0xf6
    v_pk_add_f32 v[28:29], v[28:29], v[136:137]
    v_pk_add_f32 v[30:31], v[30:31], v[138:139]
    s_waitcnt vmcnt(3)
    v_bitop3_b32 v26, v26, v140, v110 bitop3:0xf6
    v_bitop3_b32 v26, v26, v141, v111 bitop3:0xf6
    v_bitop3_b32 v26, v26, v142, v112 bitop3:0xf6
    v_bitop3_b32 v26, v26, v143, v113 bitop3:0xf6
    v_pk_add_f32 v[28:29], v[28:29], v[140:141]
    v_pk_add_f32 v[30:31], v[30:31], v[142:143]
    s_waitcnt vmcnt(2)
    v_bitop3_b32 v26, v26, v144, v110 bitop3:0xf6
    v_bitop3_b32 v26, v26, v145, v111 bitop3:0xf6
    v_bitop3_b32 v26, v26, v146, v112 bitop3:0xf6
    v_bitop3_b32 v26, v26, v147, v113 bitop3:0xf6
    v_pk_add_f32 v[28:29], v[28:29], v[144:145]
    v_pk_add_f32 v[30:31], v[30:31], v[146:147]
    s_waitcnt vmcnt(1)
    v_bitop3_b32 v26, v26, v148, v110 bitop3:0xf6
    v_bitop3_b32 v26, v26, v149, v111 bitop3:0xf6
    v_bitop3_b32 v26, v26, v150, v112 bitop3:0xf6
    v_bitop3_b32 v26, v26, v151, v113 bitop3:0xf6
    v_pk_add_f32 v[28:29], v[28:29], v[148:149]
    v_pk_add_f32 v[30:31], v[30:31], v[150:151]
    s_waitcnt vmcnt(0)
    v_bitop3_b32 v26, v26, v152, v110 bitop3:0xf6
    v_bitop3_b32 v26, v26, v153, v111 bitop3:0xf6
    v_bitop3_b32 v26, v26, v154, v112 bitop3:0xf6
    v_bitop3_b32 v26, v26, v155, v113 bitop3:0xf6
    v_pk_add_f32 v[28:29], v[28:29], v[152:153]
    v_pk_add_f32 v[30:31], v[30:31], v[154:155]
    v_and_b32 v26, 0xff, v26
    v_cmp_ne_u32 vcc, 0, v26
    s_add_u32 s9, s9, 1
    s_cmp_eq_u64 vcc, 0
    s_cbranch_scc1 C_MOK
    s_sleep 2
    s_cmp_lt_u32 s9, 131072
    s_cbranch_scc1 C_MPOLL
C_MOK:
    v_permlane32_swap_b32 v28, v29
    v_permlane32_swap_b32 v30, v31
    v_add_f32 v28, v28, v29
    v_add_f32 v30, v30, v31
    s_nop 1
    v_permlane16_swap_b32 v28, v30
    v_add_f32 v28, v28, v30
    s_nop 1
    v_add_f32_dpp v28, v28, v28 row_ror:8 row_mask:0xf bank_mask:0xf
    v_cvt_pk_bf16_f32 v28, v28, v28
    v_and_b32 v28, 0xffff0000, v28
    v_mul_f32 v28, v28, v104
    v_cvt_pk_bf16_f32 v28, v28, v28
    v_and_b32 v28, 0xffff0000, v28
    v_add_f32 v28, v28, v105
    v_cvt_pk_bf16_f32 v28, v28, v28
    v_and_b32 v28, 0xffff0000, v28
    s_setprio 0
    s_mov_b32 s9, 0
SP_8:
    ds_read_b32 v27, v1 offset:40
    s_waitcnt lgkmcnt(0)
    v_readfirstlane_b32 s8, v27
    s_add_u32 s9, s9, 1
    s_cmp_ge_u32 s8, 7
    s_cbranch_scc1 SP_8_D
    s_cmp_lt_u32 s9, 524288
    s_cbranch_scc1 SP_8
SP_8_D:
    s_setprio 3
    ds_read_b32 v25, v106
    ds_read_u16 v24, v107
    s_waitcnt lgkmcnt(0)
    v_sub_f32 v26, 1.0, v25
    v_lshlrev_b32 v24, 16, v24
    v_cvt_pk_bf16_f32 v26, v26, v26
    v_and_b32 v26, 0xffff0000, v26
    v_mul_f32 v28, v28, v26
    v_fmac_f32 v28, v24, v25
    v_cvt_pk_bf16_f32 v28, v28, v28
    s_mov_b32 exec_lo, 0x00ff00ff
    s_mov_b32 exec_hi, 0x00ff00ff
    global_store_short v108, v28, s[46:47]
    s_mov_b64 exec, -1
    s_endpgm
ROUTER:
    s_setprio 3
    v_lshrrev_b32 v5, 3, v2
    v_and_b32 v6, 7, v2
    v_lshlrev_b32 v9, 4, v6
    v_mul_u32_u24 v8, 1152, v5
    s_mul_i32 s8, s2, 9216
    v_add3_u32 v8, v8, v9, s8
    v_lshlrev_b32 v7, 4, v2
    v_min_u32 v10, 7, v2
    v_lshlrev_b32 v10, 4, v10
    s_mov_b32 m0, 147712
    s_waitcnt lgkmcnt(0)
    s_load_dword s10, s[50:51], 16640
    global_load_lds_dwordx4 v8, s[16:17] offset:0
    s_mov_b32 m0, 148608
    s_nop 0
    global_load_lds_dwordx4 v8, s[16:17] offset:128
    s_mov_b32 m0, 149504
    s_nop 0
    global_load_lds_dwordx4 v8, s[16:17] offset:256
    s_mov_b32 m0, 150400
    s_nop 0
    global_load_lds_dwordx4 v8, s[16:17] offset:384
    s_mov_b32 m0, 151296
    s_nop 0
    global_load_lds_dwordx4 v8, s[16:17] offset:512
    s_mov_b32 m0, 152192
    s_nop 0
    global_load_lds_dwordx4 v8, s[16:17] offset:640
    s_mov_b32 m0, 153088
    s_nop 0
    global_load_lds_dwordx4 v8, s[16:17] offset:768
    s_mov_b32 m0, 153984
    s_nop 0
    global_load_lds_dwordx4 v8, s[16:17] offset:896
    s_mov_b32 m0, 154880
    s_nop 0
    global_load_lds_dwordx4 v8, s[16:17] offset:1024
    s_mov_b32 m0, 158080
    s_nop 0
    global_load_lds_dwordx4 v7, s[44:45]
    global_load_lds_dwordx4 v10, s[44:45] offset:1024
    global_load_dwordx4 v[52:55], v9, s[36:37] offset:0
    global_load_dwordx4 v[56:59], v9, s[36:37] offset:128
    global_load_dwordx4 v[60:63], v9, s[36:37] offset:256
    global_load_dwordx4 v[64:67], v9, s[36:37] offset:384
    global_load_dwordx4 v[68:71], v9, s[36:37] offset:512
    global_load_dwordx4 v[72:75], v9, s[36:37] offset:640
    global_load_dwordx4 v[76:79], v9, s[36:37] offset:768
    global_load_dwordx4 v[80:83], v9, s[36:37] offset:896
    global_load_dwordx4 v[84:87], v9, s[36:37] offset:1024
    s_barrier
    v_add_u32 v7, 147712, v7
    s_lshl_b32 s8, s2, 5
    v_lshl_add_u32 v15, v4, 3, s8
    s_mov_b32 s11, 0xffff
    v_mov_b32 v8, 0
    v_mov_b32 v9, 0
    v_mov_b32 v10, 0
    v_mov_b32 v11, 0
    s_waitcnt lgkmcnt(0)
    s_add_u32 s10, s10, 1
    s_addc_u32 s10, s10, 0
    v_mov_b32 v14, s10
    v_mov_b32 v13, s10
    s_waitcnt vmcnt(9)
    ds_read_b128 v[16:19], v7 offset:0
    ds_read_b128 v[20:23], v7 offset:1024
    ds_read_b128 v[24:27], v7 offset:2048
    ds_read_b128 v[28:31], v7 offset:3072
    ds_read_b128 v[32:35], v7 offset:4096
    ds_read_b128 v[36:39], v7 offset:5120
    ds_read_b128 v[40:43], v7 offset:6144
    ds_read_b128 v[44:47], v7 offset:7168
    ds_read_b128 v[48:51], v7 offset:8192
    ds_write_b32 v1, v14 offset:8
    s_waitcnt vmcnt(8) lgkmcnt(9)
    v_dot2c_f32_bf16 v8, v16, v52
    v_dot2c_f32_bf16 v9, v17, v53
    v_dot2c_f32_bf16 v10, v18, v54
    v_dot2c_f32_bf16 v11, v19, v55
    s_waitcnt vmcnt(7) lgkmcnt(8)
    v_dot2c_f32_bf16 v8, v20, v56
    v_dot2c_f32_bf16 v9, v21, v57
    v_dot2c_f32_bf16 v10, v22, v58
    v_dot2c_f32_bf16 v11, v23, v59
    s_waitcnt vmcnt(6) lgkmcnt(7)
    v_dot2c_f32_bf16 v8, v24, v60
    v_dot2c_f32_bf16 v9, v25, v61
    v_dot2c_f32_bf16 v10, v26, v62
    v_dot2c_f32_bf16 v11, v27, v63
    s_waitcnt vmcnt(5) lgkmcnt(6)
    v_dot2c_f32_bf16 v8, v28, v64
    v_dot2c_f32_bf16 v9, v29, v65
    v_dot2c_f32_bf16 v10, v30, v66
    v_dot2c_f32_bf16 v11, v31, v67
    s_waitcnt vmcnt(4) lgkmcnt(5)
    v_dot2c_f32_bf16 v8, v32, v68
    v_dot2c_f32_bf16 v9, v33, v69
    v_dot2c_f32_bf16 v10, v34, v70
    v_dot2c_f32_bf16 v11, v35, v71
    s_waitcnt vmcnt(3) lgkmcnt(4)
    v_dot2c_f32_bf16 v8, v36, v72
    v_dot2c_f32_bf16 v9, v37, v73
    v_dot2c_f32_bf16 v10, v38, v74
    v_dot2c_f32_bf16 v11, v39, v75
    s_waitcnt vmcnt(2) lgkmcnt(3)
    v_dot2c_f32_bf16 v8, v40, v76
    v_dot2c_f32_bf16 v9, v41, v77
    v_dot2c_f32_bf16 v10, v42, v78
    v_dot2c_f32_bf16 v11, v43, v79
    s_waitcnt vmcnt(1) lgkmcnt(2)
    v_dot2c_f32_bf16 v8, v44, v80
    v_dot2c_f32_bf16 v9, v45, v81
    v_dot2c_f32_bf16 v10, v46, v82
    v_dot2c_f32_bf16 v11, v47, v83
    s_waitcnt vmcnt(0) lgkmcnt(1)
    v_dot2c_f32_bf16 v8, v48, v84
    v_dot2c_f32_bf16 v9, v49, v85
    v_dot2c_f32_bf16 v10, v50, v86
    v_dot2c_f32_bf16 v11, v51, v87
    s_nop 0
    v_add_f32 v8, v8, v9
    s_nop 0
    v_add_f32 v10, v10, v11
    v_add_f32 v8, v8, v10
    s_nop 1
    v_add_f32_dpp v8, v8, v8 quad_perm:[1,0,3,2] row_mask:0xf bank_mask:0xf
    s_nop 1
    v_add_f32_dpp v8, v8, v8 quad_perm:[2,3,0,1] row_mask:0xf bank_mask:0xf
    s_nop 1
    v_add_f32_dpp v8, v8, v8 row_half_mirror row_mask:0xf bank_mask:0xf
    v_cvt_pk_bf16_f32 v8, v8, v8
    v_ashrrev_i32 v9, 31, v8
    v_or_b32 v9, 0x80008000, v9
    v_xor_b32 v8, v8, v9
    s_nop 1
    v_mov_b32_dpp v9, v8 row_ror:8 row_mask:0xf bank_mask:0xf
    s_mov_b32 exec_lo, 0x00010001
    s_mov_b32 exec_hi, 0x00010001
    v_bfi_b32 v12, s11, v8, v9
    global_store_dwordx2 v15, v[12:13], s[50:51] sc1
    s_mov_b64 exec, -1
    ds_write_b32 v1, v14 offset:0
    s_cmp_ge_u32 s5, 14
    s_cbranch_scc1 C_IO
    s_cmp_lt_u32 s5, 9
    s_cbranch_scc1 SELECT
    s_endpgm
GATE:
    s_lshl_b32 s8, s12, 9
    s_add_u32 s8, s8, 147712
    v_lshl_add_u32 v5, v2, 2, s8
    v_and_b32 v6, 31, v2
    v_lshlrev_b32 v6, 2, v6
    v_add_u32 v6, 158080, v6
    s_lshl_b32 s8, s2, 1
    s_add_u32 s8, s8, s12
    v_mov_b32 v8, 0
    v_mov_b32 v9, 0
    v_mov_b32 v10, 0x3f803f80
    s_lshl_b32 s8, s8, 4
    s_add_u32 s8, s8, 8192
    v_lshrrev_b32 v7, 5, v2
    v_lshl_add_u32 v7, v7, 3, s8
    s_barrier
    s_mov_b32 s9, 0
SP_9:
    ds_read_b32 v13, v1 offset:8
    s_waitcnt lgkmcnt(0)
    v_readfirstlane_b32 s8, v13
    s_add_u32 s9, s9, 1
    s_cmp_lg_u32 s8, 0
    s_cbranch_scc1 SP_9_D
    s_sleep 1
    s_cmp_lt_u32 s9, 524288
    s_cbranch_scc1 SP_9
SP_9_D:
    ds_read2_b32 v[34:35], v6 offset0:0 offset1:32
    ds_read2_b32 v[36:37], v6 offset0:64 offset1:96
    ds_read2_b32 v[38:39], v6 offset0:128 offset1:160
    ds_read2_b32 v[40:41], v6 offset0:192 offset1:224
    ds_read_b32 v42, v6 offset:1024
    ds_read2st64_b32 v[16:17], v5 offset0:0 offset1:1
    ds_read2st64_b32 v[18:19], v5 offset0:4 offset1:5
    ds_read2st64_b32 v[20:21], v5 offset0:8 offset1:9
    ds_read2st64_b32 v[22:23], v5 offset0:12 offset1:13
    ds_read2st64_b32 v[24:25], v5 offset0:16 offset1:17
    ds_read2st64_b32 v[26:27], v5 offset0:20 offset1:21
    ds_read2st64_b32 v[28:29], v5 offset0:24 offset1:25
    ds_read2st64_b32 v[30:31], v5 offset0:28 offset1:29
    ds_read2st64_b32 v[32:33], v5 offset0:32 offset1:33
    s_waitcnt lgkmcnt(13)
    v_and_b32 v44, 0xffff, v34
    v_and_b32 v34, 0xffff0000, v34
    v_and_b32 v45, 0xffff, v35
    v_and_b32 v35, 0xffff0000, v35
    s_waitcnt lgkmcnt(12)
    v_and_b32 v46, 0xffff, v36
    v_and_b32 v36, 0xffff0000, v36
    v_and_b32 v47, 0xffff, v37
    v_and_b32 v37, 0xffff0000, v37
    s_waitcnt lgkmcnt(11)
    v_and_b32 v48, 0xffff, v38
    v_and_b32 v38, 0xffff0000, v38
    v_and_b32 v49, 0xffff, v39
    v_and_b32 v39, 0xffff0000, v39
    s_waitcnt lgkmcnt(10)
    v_and_b32 v50, 0xffff, v40
    v_and_b32 v40, 0xffff0000, v40
    v_and_b32 v51, 0xffff, v41
    v_and_b32 v41, 0xffff0000, v41
    s_waitcnt lgkmcnt(9)
    v_and_b32 v52, 0xffff, v42
    v_and_b32 v42, 0xffff0000, v42
    s_waitcnt lgkmcnt(8)
    v_dot2_f32_bf16 v56, v16, v44, 0
    v_dot2_f32_bf16 v57, v16, v34, 0
    v_dot2_f32_bf16 v58, v17, v44, 0
    v_dot2_f32_bf16 v59, v17, v34, 0
    s_waitcnt lgkmcnt(7)
    v_dot2_f32_bf16 v60, v18, v45, 0
    v_dot2_f32_bf16 v61, v18, v35, 0
    v_dot2_f32_bf16 v62, v19, v45, 0
    v_dot2_f32_bf16 v63, v19, v35, 0
    v_cvt_pk_bf16_f32 v56, v56, v57
    v_cvt_pk_bf16_f32 v58, v58, v59
    v_dot2c_f32_bf16 v8, v56, v10
    v_dot2c_f32_bf16 v9, v58, v10
    s_waitcnt lgkmcnt(6)
    v_dot2_f32_bf16 v56, v20, v46, 0
    v_dot2_f32_bf16 v57, v20, v36, 0
    v_dot2_f32_bf16 v58, v21, v46, 0
    v_dot2_f32_bf16 v59, v21, v36, 0
    v_cvt_pk_bf16_f32 v60, v60, v61
    v_cvt_pk_bf16_f32 v62, v62, v63
    v_dot2c_f32_bf16 v8, v60, v10
    v_dot2c_f32_bf16 v9, v62, v10
    s_waitcnt lgkmcnt(5)
    v_dot2_f32_bf16 v60, v22, v47, 0
    v_dot2_f32_bf16 v61, v22, v37, 0
    v_dot2_f32_bf16 v62, v23, v47, 0
    v_dot2_f32_bf16 v63, v23, v37, 0
    v_cvt_pk_bf16_f32 v56, v56, v57
    v_cvt_pk_bf16_f32 v58, v58, v59
    v_dot2c_f32_bf16 v8, v56, v10
    v_dot2c_f32_bf16 v9, v58, v10
    s_waitcnt lgkmcnt(4)
    v_dot2_f32_bf16 v56, v24, v48, 0
    v_dot2_f32_bf16 v57, v24, v38, 0
    v_dot2_f32_bf16 v58, v25, v48, 0
    v_dot2_f32_bf16 v59, v25, v38, 0
    v_cvt_pk_bf16_f32 v60, v60, v61
    v_cvt_pk_bf16_f32 v62, v62, v63
    v_dot2c_f32_bf16 v8, v60, v10
    v_dot2c_f32_bf16 v9, v62, v10
    s_waitcnt lgkmcnt(3)
    v_dot2_f32_bf16 v60, v26, v49, 0
    v_dot2_f32_bf16 v61, v26, v39, 0
    v_dot2_f32_bf16 v62, v27, v49, 0
    v_dot2_f32_bf16 v63, v27, v39, 0
    v_cvt_pk_bf16_f32 v56, v56, v57
    v_cvt_pk_bf16_f32 v58, v58, v59
    v_dot2c_f32_bf16 v8, v56, v10
    v_dot2c_f32_bf16 v9, v58, v10
    s_waitcnt lgkmcnt(2)
    v_dot2_f32_bf16 v56, v28, v50, 0
    v_dot2_f32_bf16 v57, v28, v40, 0
    v_dot2_f32_bf16 v58, v29, v50, 0
    v_dot2_f32_bf16 v59, v29, v40, 0
    v_cvt_pk_bf16_f32 v60, v60, v61
    v_cvt_pk_bf16_f32 v62, v62, v63
    v_dot2c_f32_bf16 v8, v60, v10
    v_dot2c_f32_bf16 v9, v62, v10
    s_waitcnt lgkmcnt(1)
    v_dot2_f32_bf16 v60, v30, v51, 0
    v_dot2_f32_bf16 v61, v30, v41, 0
    v_dot2_f32_bf16 v62, v31, v51, 0
    v_dot2_f32_bf16 v63, v31, v41, 0
    v_cvt_pk_bf16_f32 v56, v56, v57
    v_cvt_pk_bf16_f32 v58, v58, v59
    v_dot2c_f32_bf16 v8, v56, v10
    v_dot2c_f32_bf16 v9, v58, v10
    s_waitcnt lgkmcnt(0)
    v_dot2_f32_bf16 v56, v32, v52, 0
    v_dot2_f32_bf16 v57, v32, v42, 0
    v_dot2_f32_bf16 v58, v33, v52, 0
    v_dot2_f32_bf16 v59, v33, v42, 0
    v_cvt_pk_bf16_f32 v60, v60, v61
    v_cvt_pk_bf16_f32 v62, v62, v63
    v_dot2c_f32_bf16 v8, v60, v10
    v_dot2c_f32_bf16 v9, v62, v10
    v_cvt_pk_bf16_f32 v56, v56, v57
    v_cvt_pk_bf16_f32 v58, v58, v59
    v_dot2c_f32_bf16 v8, v56, v10
    v_dot2c_f32_bf16 v9, v58, v10
    v_mov_b32 v11, 1
    s_mov_b64 exec, 1
    ds_add_u32 v1, v11 offset:12
    s_mov_b64 exec, -1
    v_permlane16_swap_b32 v8, v9
    v_add_f32 v8, v8, v9
    s_nop 1
    v_add_f32_dpp v8, v8, v8 row_ror:8 row_mask:0xf bank_mask:0xf
    s_nop 1
    v_add_f32_dpp v8, v8, v8 row_ror:4 row_mask:0xf bank_mask:0xf
    s_nop 1
    v_add_f32_dpp v8, v8, v8 row_ror:2 row_mask:0xf bank_mask:0xf
    s_nop 1
    v_add_f32_dpp v8, v8, v8 row_ror:1 row_mask:0xf bank_mask:0xf
    v_cvt_pk_bf16_f32 v8, v8, v8
    v_and_b32 v8, 0xffff0000, v8
    v_mul_f32 v9, 0xbfb8aa3b, v8
    v_exp_f32 v9, v9
    s_nop 0
    v_add_f32 v9, 1.0, v9
    v_rcp_f32 v8, v9
    s_nop 0
    v_cvt_pk_bf16_f32 v8, v8, v8
    s_mov_b32 s11, 0xffff
    v_mov_b32 v9, v8
    v_lshl_add_u32 v7, v4, 3, v7
    s_nop 0
    v_permlane32_swap_b32 v8, v9
    v_bfi_b32 v12, s11, v8, v9
    s_mov_b64 exec, 0x00010001
    global_store_dwordx2 v7, v[12:13], s[50:51] sc1
    s_mov_b64 exec, -1
    s_cmp_lt_u32 s5, 9
    s_cbranch_scc1 F_COMP2
    s_cmp_ge_u32 s5, 14
    s_cbranch_scc1 C_IO
    s_endpgm
SELECT:
    s_mov_b32 s52, s16
    s_mov_b32 s53, s17
    s_mov_b32 s54, 2359296
    s_mov_b32 s55, 0x20000
    v_lshlrev_b32 v7, 4, v2
    v_add_u32 v15, 0x1000, v7
    v_lshlrev_b32 v8, 2, v2
    v_sub_u32 v8, 2047, v8
    v_subrev_u32 v48, 0, v8
    v_subrev_u32 v49, 1, v8
    v_subrev_u32 v50, 2, v8
    v_subrev_u32 v51, 3, v8
    v_subrev_u32 v52, 256, v8
    v_subrev_u32 v53, 257, v8
    v_subrev_u32 v54, 258, v8
    v_subrev_u32 v55, 259, v8
    v_subrev_u32 v56, 512, v8
    v_subrev_u32 v57, 513, v8
    v_subrev_u32 v58, 514, v8
    v_subrev_u32 v59, 515, v8
    v_subrev_u32 v60, 768, v8
    v_subrev_u32 v61, 769, v8
    v_subrev_u32 v62, 770, v8
    v_subrev_u32 v63, 771, v8
    v_subrev_u32 v64, 1024, v8
    v_subrev_u32 v65, 1025, v8
    v_subrev_u32 v66, 1026, v8
    v_subrev_u32 v67, 1027, v8
    v_subrev_u32 v68, 1280, v8
    v_subrev_u32 v69, 1281, v8
    v_subrev_u32 v70, 1282, v8
    v_subrev_u32 v71, 1283, v8
    v_subrev_u32 v72, 1536, v8
    v_subrev_u32 v73, 1537, v8
    v_subrev_u32 v74, 1538, v8
    v_subrev_u32 v75, 1539, v8
    v_subrev_u32 v76, 1792, v8
    v_subrev_u32 v77, 1793, v8
    v_subrev_u32 v78, 1794, v8
    v_subrev_u32 v79, 1795, v8
    v_lshrrev_b32 v9, 3, v2
    v_and_b32 v9, 6, v9
    v_xor_b32 v9, v9, v2
    v_and_b32 v9, 7, v9
    v_lshlrev_b32 v5, 4, v9
    v_mov_b32 v12, 0
    v_mov_b32 v6, 0
    s_mov_b32 s11, 0xffff0000
    s_mov_b32 s9, 0
SP_10:
    ds_read_b32 v13, v1 offset:12
    s_waitcnt lgkmcnt(0)
    v_readfirstlane_b32 s8, v13
    s_add_u32 s9, s9, 1
    s_cmp_ge_u32 s8, 2
    s_cbranch_scc1 SP_10_D
    s_cmp_lt_u32 s9, 524288
    s_cbranch_scc1 SP_10
SP_10_D:
    s_mov_b32 s9, 0
    s_waitcnt vmcnt(0)
    s_sleep 12
SEL_POLL:
    global_load_dwordx4 v[16:19], v7, s[50:51] offset:0 sc1
    global_load_dwordx4 v[20:23], v7, s[50:51] offset:1024 sc1
    global_load_dwordx4 v[24:27], v7, s[50:51] offset:2048 sc1
    global_load_dwordx4 v[28:31], v7, s[50:51] offset:3072 sc1
    global_load_dwordx4 v[32:35], v15, s[50:51] offset:0 sc1
    global_load_dwordx4 v[36:39], v15, s[50:51] offset:1024 sc1
    global_load_dwordx4 v[40:43], v15, s[50:51] offset:2048 sc1
    global_load_dwordx4 v[44:47], v15, s[50:51] offset:3072 sc1
    s_waitcnt vmcnt(7)
    v_xor_b32 v13, v17, v14
    v_bitop3_b32 v13, v13, v19, v14 bitop3:0xf6
    s_waitcnt vmcnt(6)
    v_bitop3_b32 v13, v13, v21, v14 bitop3:0xf6
    v_bitop3_b32 v13, v13, v23, v14 bitop3:0xf6
    s_waitcnt vmcnt(5)
    v_bitop3_b32 v13, v13, v25, v14 bitop3:0xf6
    v_bitop3_b32 v13, v13, v27, v14 bitop3:0xf6
    s_waitcnt vmcnt(4)
    v_bitop3_b32 v13, v13, v29, v14 bitop3:0xf6
    v_bitop3_b32 v13, v13, v31, v14 bitop3:0xf6
    s_waitcnt vmcnt(3)
    v_bitop3_b32 v13, v13, v33, v14 bitop3:0xf6
    v_bitop3_b32 v13, v13, v35, v14 bitop3:0xf6
    s_waitcnt vmcnt(2)
    v_bitop3_b32 v13, v13, v37, v14 bitop3:0xf6
    v_bitop3_b32 v13, v13, v39, v14 bitop3:0xf6
    s_waitcnt vmcnt(1)
    v_bitop3_b32 v13, v13, v41, v14 bitop3:0xf6
    v_bitop3_b32 v13, v13, v43, v14 bitop3:0xf6
    s_waitcnt vmcnt(0)
    v_bitop3_b32 v13, v13, v45, v14 bitop3:0xf6
    v_bitop3_b32 v13, v13, v47, v14 bitop3:0xf6
    v_cmp_ne_u32 vcc, 0, v13
    s_add_u32 s9, s9, 1
    s_cmp_eq_u64 vcc, 0
    s_cbranch_scc1 SEL_GOT
    s_cmp_lt_u32 s9, 131072
    s_cbranch_scc1 SEL_POLL
SEL_GOT:
    v_lshl_or_b32 v80, v16, 16, v48
    v_and_or_b32 v81, v16, s11, v49
    v_lshl_or_b32 v82, v18, 16, v50
    v_and_or_b32 v83, v18, s11, v51
    v_min_u32 v9, v80, v81
    v_max_u32 v8, v80, v81
    v_med3_u32 v9, v8, v9, v82
    v_max_u32 v8, v8, v82
    v_med3_u32 v9, v8, v9, v83
    v_max_u32 v8, v8, v83
    v_lshl_or_b32 v84, v20, 16, v52
    v_and_or_b32 v85, v20, s11, v53
    v_lshl_or_b32 v86, v22, 16, v54
    v_and_or_b32 v87, v22, s11, v55
    v_med3_u32 v9, v8, v9, v84
    v_max_u32 v8, v8, v84
    v_med3_u32 v9, v8, v9, v85
    v_max_u32 v8, v8, v85
    v_med3_u32 v9, v8, v9, v86
    v_max_u32 v8, v8, v86
    v_med3_u32 v9, v8, v9, v87
    v_max_u32 v8, v8, v87
    v_lshl_or_b32 v88, v24, 16, v56
    v_and_or_b32 v89, v24, s11, v57
    v_lshl_or_b32 v90, v26, 16, v58
    v_and_or_b32 v91, v26, s11, v59
    v_med3_u32 v9, v8, v9, v88
    v_max_u32 v8, v8, v88
    v_med3_u32 v9, v8, v9, v89
    v_max_u32 v8, v8, v89
    v_med3_u32 v9, v8, v9, v90
    v_max_u32 v8, v8, v90
    v_med3_u32 v9, v8, v9, v91
    v_max_u32 v8, v8, v91
    v_lshl_or_b32 v92, v28, 16, v60
    v_and_or_b32 v93, v28, s11, v61
    v_lshl_or_b32 v94, v30, 16, v62
    v_and_or_b32 v95, v30, s11, v63
    v_med3_u32 v9, v8, v9, v92
    v_max_u32 v8, v8, v92
    v_med3_u32 v9, v8, v9, v93
    v_max_u32 v8, v8, v93
    v_med3_u32 v9, v8, v9, v94
    v_max_u32 v8, v8, v94
    v_med3_u32 v9, v8, v9, v95
    v_max_u32 v8, v8, v95
    v_lshl_or_b32 v96, v32, 16, v64
    v_and_or_b32 v97, v32, s11, v65
    v_lshl_or_b32 v98, v34, 16, v66
    v_and_or_b32 v99, v34, s11, v67
    v_med3_u32 v9, v8, v9, v96
    v_max_u32 v8, v8, v96
    v_med3_u32 v9, v8, v9, v97
    v_max_u32 v8, v8, v97
    v_med3_u32 v9, v8, v9, v98
    v_max_u32 v8, v8, v98
    v_med3_u32 v9, v8, v9, v99
    v_max_u32 v8, v8, v99
    v_lshl_or_b32 v100, v36, 16, v68
    v_and_or_b32 v101, v36, s11, v69
    v_lshl_or_b32 v102, v38, 16, v70
    v_and_or_b32 v103, v38, s11, v71
    v_med3_u32 v9, v8, v9, v100
    v_max_u32 v8, v8, v100
    v_med3_u32 v9, v8, v9, v101
    v_max_u32 v8, v8, v101
    v_med3_u32 v9, v8, v9, v102
    v_max_u32 v8, v8, v102
    v_med3_u32 v9, v8, v9, v103
    v_max_u32 v8, v8, v103
    v_lshl_or_b32 v104, v40, 16, v72
    v_and_or_b32 v105, v40, s11, v73
    v_lshl_or_b32 v106, v42, 16, v74
    v_and_or_b32 v107, v42, s11, v75
    v_med3_u32 v9, v8, v9, v104
    v_max_u32 v8, v8, v104
    v_med3_u32 v9, v8, v9, v105
    v_max_u32 v8, v8, v105
    v_med3_u32 v9, v8, v9, v106
    v_max_u32 v8, v8, v106
    v_med3_u32 v9, v8, v9, v107
    v_max_u32 v8, v8, v107
    v_lshl_or_b32 v108, v44, 16, v76
    v_and_or_b32 v109, v44, s11, v77
    v_lshl_or_b32 v110, v46, 16, v78
    v_and_or_b32 v111, v46, s11, v79
    v_med3_u32 v9, v8, v9, v108
    v_max_u32 v8, v8, v108
    v_med3_u32 v9, v8, v9, v109
    v_max_u32 v8, v8, v109
    v_med3_u32 v9, v8, v9, v110
    v_max_u32 v8, v8, v110
    v_med3_u32 v9, v8, v9, v111
    v_max_u32 v8, v8, v111
    v_mov_b32 v10, v8
    s_nop 1
    v_max_u32_dpp v10, v10, v10 row_shr:1 row_mask:0xf bank_mask:0xf
    s_nop 1
    v_max_u32_dpp v10, v10, v10 row_shr:2 row_mask:0xf bank_mask:0xf
    s_nop 1
    v_max_u32_dpp v10, v10, v10 row_shr:4 row_mask:0xf bank_mask:0xf
    s_nop 1
    v_max_u32_dpp v10, v10, v10 row_shr:8 row_mask:0xf bank_mask:0xf
    s_nop 1
    v_max_u32_dpp v10, v10, v10 row_bcast:15 row_mask:0xa bank_mask:0xf
    s_nop 1
    v_max_u32_dpp v10, v10, v10 row_bcast:31 row_mask:0xc bank_mask:0xf
    s_nop 0
    v_readlane_b32 s8, v10, 63
    s_mov_b32 s12, s8
    v_subrev_u32 v10, s12, v8
    v_subrev_u32 v11, s12, v9
    v_max_u32 v10, v10, v11
    s_and_b32 s13, s12, 0x7ff
    s_sub_u32 s13, 2047, s13
    v_max_u32_dpp v10, v10, v10 row_shr:1 row_mask:0xf bank_mask:0xf
    s_mul_i32 s13, s13, 1152
    s_nop 0
    v_max_u32_dpp v10, v10, v10 row_shr:2 row_mask:0xf bank_mask:0xf
    s_mov_b32 exec_lo, 0xff
    s_mov_b32 exec_hi, 0x0
    v_add_u32 v12, s13, v5
    v_mov_b32 v6, s12
    s_mov_b64 exec, -1
    v_max_u32_dpp v10, v10, v10 row_shr:4 row_mask:0xf bank_mask:0xf
    s_nop 1
    v_max_u32_dpp v10, v10, v10 row_shr:8 row_mask:0xf bank_mask:0xf
    s_nop 1
    v_max_u32_dpp v10, v10, v10 row_bcast:15 row_mask:0xa bank_mask:0xf
    s_nop 1
    v_max_u32_dpp v10, v10, v10 row_bcast:31 row_mask:0xc bank_mask:0xf
    s_nop 0
    v_readlane_b32 s8, v10, 63
    s_add_u32 s12, s12, s8
    v_subrev_u32 v10, s12, v8
    v_subrev_u32 v11, s12, v9
    v_max_u32 v10, v10, v11
    s_and_b32 s13, s12, 0x7ff
    s_sub_u32 s13, 2047, s13
    v_max_u32_dpp v10, v10, v10 row_shr:1 row_mask:0xf bank_mask:0xf
    s_mul_i32 s13, s13, 1152
    s_nop 0
    v_max_u32_dpp v10, v10, v10 row_shr:2 row_mask:0xf bank_mask:0xf
    s_mov_b32 exec_lo, 0xff00
    s_mov_b32 exec_hi, 0x0
    v_add_u32 v12, s13, v5
    v_mov_b32 v6, s12
    s_mov_b64 exec, -1
    v_max_u32_dpp v10, v10, v10 row_shr:4 row_mask:0xf bank_mask:0xf
    s_nop 1
    v_max_u32_dpp v10, v10, v10 row_shr:8 row_mask:0xf bank_mask:0xf
    s_nop 1
    v_max_u32_dpp v10, v10, v10 row_bcast:15 row_mask:0xa bank_mask:0xf
    s_nop 1
    v_max_u32_dpp v10, v10, v10 row_bcast:31 row_mask:0xc bank_mask:0xf
    s_nop 0
    v_readlane_b32 s8, v10, 63
    s_add_u32 s12, s12, s8
    v_subrev_u32 v10, s12, v8
    v_subrev_u32 v11, s12, v9
    v_max_u32 v10, v10, v11
    s_and_b32 s13, s12, 0x7ff
    s_sub_u32 s13, 2047, s13
    v_max_u32_dpp v10, v10, v10 row_shr:1 row_mask:0xf bank_mask:0xf
    s_mul_i32 s13, s13, 1152
    s_nop 0
    v_max_u32_dpp v10, v10, v10 row_shr:2 row_mask:0xf bank_mask:0xf
    s_mov_b32 exec_lo, 0xff0000
    s_mov_b32 exec_hi, 0x0
    v_add_u32 v12, s13, v5
    v_mov_b32 v6, s12
    s_mov_b64 exec, -1
    v_max_u32_dpp v10, v10, v10 row_shr:4 row_mask:0xf bank_mask:0xf
    s_nop 1
    v_max_u32_dpp v10, v10, v10 row_shr:8 row_mask:0xf bank_mask:0xf
    s_nop 1
    v_max_u32_dpp v10, v10, v10 row_bcast:15 row_mask:0xa bank_mask:0xf
    s_nop 1
    v_max_u32_dpp v10, v10, v10 row_bcast:31 row_mask:0xc bank_mask:0xf
    s_nop 0
    v_readlane_b32 s8, v10, 63
    s_add_u32 s12, s12, s8
    v_subrev_u32 v10, s12, v8
    v_subrev_u32 v11, s12, v9
    v_max_u32 v10, v10, v11
    s_and_b32 s13, s12, 0x7ff
    s_sub_u32 s13, 2047, s13
    v_max_u32_dpp v10, v10, v10 row_shr:1 row_mask:0xf bank_mask:0xf
    s_mul_i32 s13, s13, 1152
    s_nop 0
    v_max_u32_dpp v10, v10, v10 row_shr:2 row_mask:0xf bank_mask:0xf
    s_mov_b32 exec_lo, 0xff000000
    s_mov_b32 exec_hi, 0x0
    v_add_u32 v12, s13, v5
    v_mov_b32 v6, s12
    s_mov_b64 exec, -1
    v_max_u32_dpp v10, v10, v10 row_shr:4 row_mask:0xf bank_mask:0xf
    s_nop 1
    v_max_u32_dpp v10, v10, v10 row_shr:8 row_mask:0xf bank_mask:0xf
    s_nop 1
    v_max_u32_dpp v10, v10, v10 row_bcast:15 row_mask:0xa bank_mask:0xf
    s_nop 1
    v_max_u32_dpp v10, v10, v10 row_bcast:31 row_mask:0xc bank_mask:0xf
    s_nop 0
    v_readlane_b32 s8, v10, 63
    s_add_u32 s12, s12, s8
    v_subrev_u32 v10, s12, v8
    v_subrev_u32 v11, s12, v9
    v_max_u32 v10, v10, v11
    s_and_b32 s13, s12, 0x7ff
    s_sub_u32 s13, 2047, s13
    v_max_u32_dpp v10, v10, v10 row_shr:1 row_mask:0xf bank_mask:0xf
    s_mul_i32 s13, s13, 1152
    s_nop 0
    v_max_u32_dpp v10, v10, v10 row_shr:2 row_mask:0xf bank_mask:0xf
    s_mov_b32 exec_lo, 0x0
    s_mov_b32 exec_hi, 0xff
    v_add_u32 v12, s13, v5
    v_mov_b32 v6, s12
    s_mov_b64 exec, -1
    v_max_u32_dpp v10, v10, v10 row_shr:4 row_mask:0xf bank_mask:0xf
    s_nop 1
    v_max_u32_dpp v10, v10, v10 row_shr:8 row_mask:0xf bank_mask:0xf
    s_nop 1
    v_max_u32_dpp v10, v10, v10 row_bcast:15 row_mask:0xa bank_mask:0xf
    s_nop 1
    v_max_u32_dpp v10, v10, v10 row_bcast:31 row_mask:0xc bank_mask:0xf
    s_nop 0
    v_readlane_b32 s8, v10, 63
    s_add_u32 s12, s12, s8
    v_subrev_u32 v10, s12, v8
    v_subrev_u32 v11, s12, v9
    v_max_u32 v10, v10, v11
    s_and_b32 s13, s12, 0x7ff
    s_sub_u32 s13, 2047, s13
    v_max_u32_dpp v10, v10, v10 row_shr:1 row_mask:0xf bank_mask:0xf
    s_mul_i32 s13, s13, 1152
    s_nop 0
    v_max_u32_dpp v10, v10, v10 row_shr:2 row_mask:0xf bank_mask:0xf
    s_mov_b32 exec_lo, 0x0
    s_mov_b32 exec_hi, 0xff00
    v_add_u32 v12, s13, v5
    v_mov_b32 v6, s12
    s_mov_b64 exec, -1
    v_max_u32_dpp v10, v10, v10 row_shr:4 row_mask:0xf bank_mask:0xf
    s_nop 1
    v_max_u32_dpp v10, v10, v10 row_shr:8 row_mask:0xf bank_mask:0xf
    s_nop 1
    v_max_u32_dpp v10, v10, v10 row_bcast:15 row_mask:0xa bank_mask:0xf
    s_nop 1
    v_max_u32_dpp v10, v10, v10 row_bcast:31 row_mask:0xc bank_mask:0xf
    s_nop 0
    v_readlane_b32 s8, v10, 63
    s_add_u32 s12, s12, s8
    v_subrev_u32 v10, s12, v8
    v_subrev_u32 v11, s12, v9
    v_max_u32 v10, v10, v11
    s_and_b32 s13, s12, 0x7ff
    s_sub_u32 s13, 2047, s13
    v_max_u32_dpp v10, v10, v10 row_shr:1 row_mask:0xf bank_mask:0xf
    s_mul_i32 s13, s13, 1152
    s_nop 0
    v_max_u32_dpp v10, v10, v10 row_shr:2 row_mask:0xf bank_mask:0xf
    s_mov_b32 exec_lo, 0x0
    s_mov_b32 exec_hi, 0xff0000
    v_add_u32 v12, s13, v5
    v_mov_b32 v6, s12
    s_mov_b64 exec, -1
    v_max_u32_dpp v10, v10, v10 row_shr:4 row_mask:0xf bank_mask:0xf
    s_nop 1
    v_max_u32_dpp v10, v10, v10 row_shr:8 row_mask:0xf bank_mask:0xf
    s_nop 1
    v_max_u32_dpp v10, v10, v10 row_bcast:15 row_mask:0xa bank_mask:0xf
    s_nop 1
    v_max_u32_dpp v10, v10, v10 row_bcast:31 row_mask:0xc bank_mask:0xf
    s_nop 0
    v_readlane_b32 s8, v10, 63
    s_add_u32 s12, s12, s8
    s_and_b32 s13, s12, 0x7ff
    s_sub_u32 s13, 2047, s13
    s_mul_i32 s13, s13, 1152
    s_mov_b32 exec_lo, 0x0
    s_mov_b32 exec_hi, 0xff000000
    v_add_u32 v12, s13, v5
    v_mov_b32 v6, s12
    s_mov_b64 exec, -1
    s_mov_b32 s14, 0
SEL_GATHER:
    s_mov_b32 m0, 147712
    s_nop 0
    buffer_load_dwordx4 v12, s[52:55], 0 offen offset:0 lds
    s_mov_b32 m0, 148608
    s_nop 0
    buffer_load_dwordx4 v12, s[52:55], 0 offen offset:128 lds
    s_mov_b32 m0, 149504
    s_nop 0
    buffer_load_dwordx4 v12, s[52:55], 0 offen offset:256 lds
    s_mov_b32 m0, 150400
    s_nop 0
    buffer_load_dwordx4 v12, s[52:55], 0 offen offset:384 lds
    s_mov_b32 m0, 151296
    s_nop 0
    buffer_load_dwordx4 v12, s[52:55], 0 offen offset:512 lds
    s_mov_b32 m0, 152192
    s_nop 0
    buffer_load_dwordx4 v12, s[52:55], 0 offen offset:640 lds
    s_mov_b32 m0, 153088
    s_nop 0
    buffer_load_dwordx4 v12, s[52:55], 0 offen offset:768 lds
    s_mov_b32 m0, 153984
    s_nop 0
    buffer_load_dwordx4 v12, s[52:55], 0 offen offset:896 lds
    s_mov_b32 m0, 154880
    s_nop 0
    buffer_load_dwordx4 v12, s[52:55], 0 offen offset:1024 lds
    s_cmp_lg_u32 s14, 0
    s_cbranch_scc1 SEL_OK
    v_sub_u32 v16, v80, v9
    v_sub_u32 v17, v81, v9
    v_sub_u32 v18, v82, v9
    v_sub_u32 v19, v83, v9
    v_sub_u32 v20, v84, v9
    v_sub_u32 v21, v85, v9
    v_sub_u32 v22, v86, v9
    v_sub_u32 v23, v87, v9
    v_sub_u32 v24, v88, v9
    v_sub_u32 v25, v89, v9
    v_sub_u32 v26, v90, v9
    v_sub_u32 v27, v91, v9
    v_sub_u32 v28, v92, v9
    v_sub_u32 v29, v93, v9
    v_sub_u32 v30, v94, v9
    v_sub_u32 v31, v95, v9
    v_sub_u32 v32, v96, v9
    v_sub_u32 v33, v97, v9
    v_sub_u32 v34, v98, v9
    v_sub_u32 v35, v99, v9
    v_sub_u32 v36, v100, v9
    v_sub_u32 v37, v101, v9
    v_sub_u32 v38, v102, v9
    v_sub_u32 v39, v103, v9
    v_sub_u32 v40, v104, v9
    v_sub_u32 v41, v105, v9
    v_sub_u32 v42, v106, v9
    v_sub_u32 v43, v107, v9
    v_sub_u32 v44, v108, v9
    v_sub_u32 v45, v109, v9
    v_sub_u32 v46, v110, v9
    v_sub_u32 v47, v111, v9
    v_max3_u32 v16, v16, v17, v18
    v_max3_u32 v19, v19, v20, v21
    v_max3_u32 v22, v22, v23, v24
    v_max3_u32 v25, v25, v26, v27
    v_max3_u32 v28, v28, v29, v30
    v_max3_u32 v31, v31, v32, v33
    v_max3_u32 v34, v34, v35, v36
    v_max3_u32 v37, v37, v38, v39
    v_max3_u32 v40, v40, v41, v42
    v_max3_u32 v43, v43, v44, v45
    v_max3_u32 v16, v16, v19, v22
    v_max3_u32 v25, v25, v28, v31
    v_max3_u32 v34, v34, v37, v40
    v_max3_u32 v43, v43, v46, v47
    v_max3_u32 v16, v16, v25, v34
    v_max_u32 v16, v16, v43
    v_add_u32 v16, v16, v9
    v_cmp_lt_u32 vcc, s12, v16
    s_cmp_eq_u64 vcc, 0
    s_cbranch_scc1 SEL_OK
    s_waitcnt vmcnt(0)
    s_mov_b32 s12, 0
    s_mov_b64 s[56:57], 0xff
SEL_SLOW:
    v_subrev_u32 v16, s12, v80
    v_subrev_u32 v17, s12, v81
    v_subrev_u32 v18, s12, v82
    v_subrev_u32 v19, s12, v83
    v_subrev_u32 v20, s12, v84
    v_subrev_u32 v21, s12, v85
    v_subrev_u32 v22, s12, v86
    v_subrev_u32 v23, s12, v87
    v_subrev_u32 v24, s12, v88
    v_subrev_u32 v25, s12, v89
    v_subrev_u32 v26, s12, v90
    v_subrev_u32 v27, s12, v91
    v_subrev_u32 v28, s12, v92
    v_subrev_u32 v29, s12, v93
    v_subrev_u32 v30, s12, v94
    v_subrev_u32 v31, s12, v95
    v_subrev_u32 v32, s12, v96
    v_subrev_u32 v33, s12, v97
    v_subrev_u32 v34, s12, v98
    v_subrev_u32 v35, s12, v99
    v_subrev_u32 v36, s12, v100
    v_subrev_u32 v37, s12, v101
    v_subrev_u32 v38, s12, v102
    v_subrev_u32 v39, s12, v103
    v_subrev_u32 v40, s12, v104
    v_subrev_u32 v41, s12, v105
    v_subrev_u32 v42, s12, v106
    v_subrev_u32 v43, s12, v107
    v_subrev_u32 v44, s12, v108
    v_subrev_u32 v45, s12, v109
    v_subrev_u32 v46, s12, v110
    v_subrev_u32 v47, s12, v111
    v_max3_u32 v16, v16, v17, v18
    v_max3_u32 v19, v19, v20, v21
    v_max3_u32 v22, v22, v23, v24
    v_max3_u32 v25, v25, v26, v27
    v_max3_u32 v28, v28, v29, v30
    v_max3_u32 v31, v31, v32, v33
    v_max3_u32 v34, v34, v35, v36
    v_max3_u32 v37, v37, v38, v39
    v_max3_u32 v40, v40, v41, v42
    v_max3_u32 v43, v43, v44, v45
    v_max3_u32 v16, v16, v19, v22
    v_max3_u32 v25, v25, v28, v31
    v_max3_u32 v34, v34, v37, v40
    v_max3_u32 v43, v43, v46, v47
    v_max3_u32 v16, v16, v25, v34
    v_max_u32 v16, v16, v43
    s_nop 1
    v_max_u32_dpp v16, v16, v16 row_shr:1 row_mask:0xf bank_mask:0xf
    s_nop 1
    v_max_u32_dpp v16, v16, v16 row_shr:2 row_mask:0xf bank_mask:0xf
    s_nop 1
    v_max_u32_dpp v16, v16, v16 row_shr:4 row_mask:0xf bank_mask:0xf
    s_nop 1
    v_max_u32_dpp v16, v16, v16 row_shr:8 row_mask:0xf bank_mask:0xf
    s_nop 1
    v_max_u32_dpp v16, v16, v16 row_bcast:15 row_mask:0xa bank_mask:0xf
    s_nop 1
    v_max_u32_dpp v16, v16, v16 row_bcast:31 row_mask:0xc bank_mask:0xf
    s_nop 0
    v_readlane_b32 s8, v16, 63
    s_add_u32 s12, s12, s8
    s_and_b32 s13, s12, 0x7ff
    s_sub_u32 s13, 2047, s13
    s_mul_i32 s13, s13, 1152
    s_mov_b64 exec, s[56:57]
    v_add_u32 v12, s13, v5
    v_mov_b32 v6, s12
    s_mov_b64 exec, -1
    s_lshl_b64 s[56:57], s[56:57], 8
    s_add_u32 s14, s14, 1
    s_cmp_lt_u32 s14, 8
    s_cbranch_scc1 SEL_SLOW
    s_branch SEL_GATHER
SEL_OK:
    s_cmp_lg_u32 s2, 0
    s_cbranch_scc1 SEL_NOPUB
    v_mov_b32 v7, v14
    v_add_u32 v8, 16384, v2
    s_mov_b32 exec_lo, 0x01010101
    s_mov_b32 exec_hi, 0x01010101
    global_store_dwordx2 v8, v[6:7], s[50:51] sc1
    s_mov_b64 exec, 1
    global_store_dword v8, v14, s[50:51] offset:256 sc1
    s_mov_b64 exec, -1
    s_waitcnt vmcnt(2)
    s_branch SEL_END
SEL_NOPUB:
    s_waitcnt vmcnt(0)
SEL_END:
    v_mov_b32 v8, 3
    ds_write_b32 v1, v8 offset:84
    s_endpgm
F_LOAD:
    s_sub_u32 s12, s3, 9
    v_lshrrev_b32 v5, 3, v2
    v_bfe_u32 v6, v2, 4, 1
    v_xor_b32 v6, v6, v2
    v_and_b32 v6, 7, v6
    s_movk_i32 s8, 9216
    v_mul_lo_u32 v7, v5, s8
    v_lshl_add_u32 v8, v6, 4, v7
    v_xor_b32 v9, 32, v8
    v_xor_b32 v10, 64, v8
    v_xor_b32 v11, 96, v8
    v_bfe_u32 v6, v2, 4, 1
    v_lshlrev_b32 v6, 1, v6
    v_xor_b32 v6, v6, v2
    v_and_b32 v6, 7, v6
    v_mul_u32_u24 v7, 1152, v5
    v_lshl_add_u32 v12, v6, 4, v7
    v_xor_b32 v13, 64, v12
    s_mul_i32 s13, s12, 294912
    s_lshl_b32 s8, s7, 7
    s_add_u32 s13, s13, s8
    s_lshl_b32 s15, s12, 13
    s_add_u32 s15, s15, 256
    s_mul_i32 s14, s12, 24576
    s_add_u32 s14, s14, 73984
    s_mul_i32 s11, s7, 73728
    s_mul_i32 s8, s12, 384
    s_add_u32 s11, s11, s8
    s_waitcnt lgkmcnt(0)
    s_mov_b32 s52, s38
    s_mov_b32 s53, s39
    s_mov_b32 s54, 5308416
    s_mov_b32 s55, 0x20000
    s_mov_b32 s56, s40
    s_mov_b32 s57, s41
    s_mov_b32 s58, 5308416
    s_mov_b32 s59, 0x20000
    s_mov_b32 s60, s42
    s_mov_b32 s61, s43
    s_mov_b32 s62, 5308416
    s_mov_b32 s63, 0x20000
    s_barrier
    s_add_u32 m0, s15, 0
    s_nop 0
    buffer_load_dwordx4 v8, s[52:55], s13 offen  lds
    s_add_u32 m0, s15, 1024
    s_nop 0
    buffer_load_dwordx4 v10, s[56:59], s13 offen  lds
    s_add_u32 s13, s13, 73728
    s_add_u32 m0, s15, 2048
    s_nop 0
    buffer_load_dwordx4 v9, s[52:55], s13 offen  lds
    s_add_u32 m0, s15, 3072
    s_nop 0
    buffer_load_dwordx4 v11, s[56:59], s13 offen  lds
    s_add_u32 s13, s13, 73728
    s_add_u32 m0, s15, 4096
    s_nop 0
    buffer_load_dwordx4 v8, s[52:55], s13 offen  lds
    s_add_u32 m0, s15, 5120
    s_nop 0
    buffer_load_dwordx4 v10, s[56:59], s13 offen  lds
    s_add_u32 s13, s13, 73728
    s_add_u32 m0, s15, 6144
    s_nop 0
    buffer_load_dwordx4 v9, s[52:55], s13 offen  lds
    s_add_u32 m0, s15, 7168
    s_nop 0
    buffer_load_dwordx4 v11, s[56:59], s13 offen  lds
    s_add_u32 s13, s13, 663552
    s_add_u32 m0, s15, 24576
    s_nop 0
    buffer_load_dwordx4 v8, s[52:55], s13 offen  lds
    s_add_u32 m0, s15, 25600
    s_nop 0
    buffer_load_dwordx4 v10, s[56:59], s13 offen  lds
    s_add_u32 s13, s13, 73728
    s_waitcnt vmcnt(9)
    s_add_u32 m0, s15, 26624
    s_nop 0
    buffer_load_dwordx4 v9, s[52:55], s13 offen  lds
    s_waitcnt vmcnt(9)
    s_add_u32 m0, s15, 27648
    s_nop 0
    buffer_load_dwordx4 v11, s[56:59], s13 offen  lds
    s_add_u32 s13, s13, 73728
    s_waitcnt vmcnt(9)
    s_add_u32 m0, s15, 28672
    s_nop 0
    buffer_load_dwordx4 v8, s[52:55], s13 offen  lds
    s_waitcnt vmcnt(9)
    s_add_u32 m0, s15, 29696
    s_nop 0
    buffer_load_dwordx4 v10, s[56:59], s13 offen  lds
    s_add_u32 s13, s13, 73728
    s_waitcnt vmcnt(9)
    s_add_u32 m0, s15, 30720
    s_nop 0
    buffer_load_dwordx4 v9, s[52:55], s13 offen  lds
    s_waitcnt vmcnt(9)
    s_add_u32 m0, s15, 31744
    s_nop 0
    buffer_load_dwordx4 v11, s[56:59], s13 offen  lds
    s_add_u32 s13, s13, 663552
    s_waitcnt vmcnt(9)
    s_add_u32 m0, s15, 49152
    s_nop 0
    buffer_load_dwordx4 v8, s[52:55], s13 offen  lds
    s_waitcnt vmcnt(9)
    v_mov_b32 v14, 1
    s_mov_b64 exec, 1
    ds_add_u32 v1, v14 offset:16
    s_mov_b64 exec, -1
    s_add_u32 m0, s15, 50176
    s_nop 0
    buffer_load_dwordx4 v10, s[56:59], s13 offen  lds
    s_add_u32 s13, s13, 73728
    s_waitcnt vmcnt(9)
    s_add_u32 m0, s15, 51200
    s_nop 0
    buffer_load_dwordx4 v9, s[52:55], s13 offen  lds
    s_waitcnt vmcnt(9)
    s_add_u32 m0, s15, 52224
    s_nop 0
    buffer_load_dwordx4 v11, s[56:59], s13 offen  lds
    s_add_u32 s13, s13, 73728
    s_waitcnt vmcnt(9)
    s_add_u32 m0, s15, 53248
    s_nop 0
    buffer_load_dwordx4 v8, s[52:55], s13 offen  lds
    s_waitcnt vmcnt(9)
    s_add_u32 m0, s15, 54272
    s_nop 0
    buffer_load_dwordx4 v10, s[56:59], s13 offen  lds
    s_add_u32 s13, s13, 73728
    s_waitcnt vmcnt(9)
    s_add_u32 m0, s15, 55296
    s_nop 0
    buffer_load_dwordx4 v9, s[52:55], s13 offen  lds
    s_waitcnt vmcnt(9)
    s_add_u32 m0, s15, 56320
    s_nop 0
    buffer_load_dwordx4 v11, s[56:59], s13 offen  lds
    s_add_u32 s13, s13, 663552
    s_mov_b32 s9, 0
SP_11:
    ds_read_b32 v14, v1 offset:48
    s_waitcnt lgkmcnt(0)
    v_readfirstlane_b32 s8, v14
    s_add_u32 s9, s9, 1
    s_cmp_ge_u32 s8, 8
    s_cbranch_scc1 SP_11_D
    s_cmp_lt_u32 s9, 524288
    s_cbranch_scc1 SP_11
SP_11_D:
    s_waitcnt vmcnt(9)
    s_add_u32 m0, s15, 0
    s_nop 0
    buffer_load_dwordx4 v8, s[52:55], s13 offen  lds
    s_waitcnt vmcnt(9)
    v_mov_b32 v14, 1
    s_mov_b64 exec, 1
    ds_add_u32 v1, v14 offset:20
    s_mov_b64 exec, -1
    s_add_u32 m0, s15, 1024
    s_nop 0
    buffer_load_dwordx4 v10, s[56:59], s13 offen  lds
    s_add_u32 s13, s13, 73728
    s_waitcnt vmcnt(9)
    s_add_u32 m0, s15, 2048
    s_nop 0
    buffer_load_dwordx4 v9, s[52:55], s13 offen  lds
    s_waitcnt vmcnt(9)
    s_add_u32 m0, s15, 3072
    s_nop 0
    buffer_load_dwordx4 v11, s[56:59], s13 offen  lds
    s_add_u32 s13, s13, 73728
    s_waitcnt vmcnt(9)
    s_add_u32 m0, s15, 4096
    s_nop 0
    buffer_load_dwordx4 v8, s[52:55], s13 offen  lds
    s_waitcnt vmcnt(9)
    s_add_u32 m0, s15, 5120
    s_nop 0
    buffer_load_dwordx4 v10, s[56:59], s13 offen  lds
    s_add_u32 s13, s13, 73728
    s_waitcnt vmcnt(9)
    s_add_u32 m0, s15, 6144
    s_nop 0
    buffer_load_dwordx4 v9, s[52:55], s13 offen  lds
    s_waitcnt vmcnt(9)
    s_add_u32 m0, s15, 7168
    s_nop 0
    buffer_load_dwordx4 v11, s[56:59], s13 offen  lds
    s_add_u32 s13, s13, 663552
    s_mov_b32 s9, 0
SP_12:
    ds_read_b32 v14, v1 offset:52
    s_waitcnt lgkmcnt(0)
    v_readfirstlane_b32 s8, v14
    s_add_u32 s9, s9, 1
    s_cmp_ge_u32 s8, 8
    s_cbranch_scc1 SP_12_D
    s_cmp_lt_u32 s9, 524288
    s_cbranch_scc1 SP_12
SP_12_D:
    s_waitcnt vmcnt(9)
    s_add_u32 m0, s15, 24576
    s_nop 0
    buffer_load_dwordx4 v8, s[52:55], s13 offen  lds
    s_waitcnt vmcnt(9)
    v_mov_b32 v14, 1
    s_mov_b64 exec, 1
    ds_add_u32 v1, v14 offset:24
    s_mov_b64 exec, -1
    s_add_u32 m0, s15, 25600
    s_nop 0
    buffer_load_dwordx4 v10, s[56:59], s13 offen  lds
    s_add_u32 s13, s13, 73728
    s_waitcnt vmcnt(9)
    s_add_u32 m0, s15, 26624
    s_nop 0
    buffer_load_dwordx4 v9, s[52:55], s13 offen  lds
    s_waitcnt vmcnt(9)
    s_add_u32 m0, s15, 27648
    s_nop 0
    buffer_load_dwordx4 v11, s[56:59], s13 offen  lds
    s_add_u32 s13, s13, 73728
    s_waitcnt vmcnt(9)
    s_add_u32 m0, s15, 28672
    s_nop 0
    buffer_load_dwordx4 v8, s[52:55], s13 offen  lds
    s_waitcnt vmcnt(9)
    s_add_u32 m0, s15, 29696
    s_nop 0
    buffer_load_dwordx4 v10, s[56:59], s13 offen  lds
    s_add_u32 s13, s13, 73728
    s_waitcnt vmcnt(9)
    s_add_u32 m0, s15, 30720
    s_nop 0
    buffer_load_dwordx4 v9, s[52:55], s13 offen  lds
    s_waitcnt vmcnt(9)
    s_add_u32 m0, s15, 31744
    s_nop 0
    buffer_load_dwordx4 v11, s[56:59], s13 offen  lds
    s_add_u32 s13, s13, 663552
    s_mov_b32 s9, 0
SP_13:
    ds_read_b32 v14, v1 offset:56
    s_waitcnt lgkmcnt(0)
    v_readfirstlane_b32 s8, v14
    s_add_u32 s9, s9, 1
    s_cmp_ge_u32 s8, 8
    s_cbranch_scc1 SP_13_D
    s_cmp_lt_u32 s9, 524288
    s_cbranch_scc1 SP_13
SP_13_D:
    s_waitcnt vmcnt(9)
    s_add_u32 m0, s15, 49152
    s_nop 0
    buffer_load_dwordx4 v8, s[52:55], s13 offen  lds
    s_waitcnt vmcnt(9)
    v_mov_b32 v14, 1
    s_mov_b64 exec, 1
    ds_add_u32 v1, v14 offset:28
    s_mov_b64 exec, -1
    s_add_u32 m0, s15, 50176
    s_nop 0
    buffer_load_dwordx4 v10, s[56:59], s13 offen  lds
    s_add_u32 s13, s13, 73728
    s_waitcnt vmcnt(9)
    s_add_u32 m0, s15, 51200
    s_nop 0
    buffer_load_dwordx4 v9, s[52:55], s13 offen  lds
    s_waitcnt vmcnt(9)
    s_add_u32 m0, s15, 52224
    s_nop 0
    buffer_load_dwordx4 v11, s[56:59], s13 offen  lds
    s_add_u32 s13, s13, 73728
    s_waitcnt vmcnt(9)
    s_add_u32 m0, s15, 53248
    s_nop 0
    buffer_load_dwordx4 v8, s[52:55], s13 offen  lds
    s_waitcnt vmcnt(9)
    s_add_u32 m0, s15, 54272
    s_nop 0
    buffer_load_dwordx4 v10, s[56:59], s13 offen  lds
    s_add_u32 s13, s13, 73728
    s_waitcnt vmcnt(9)
    s_add_u32 m0, s15, 55296
    s_nop 0
    buffer_load_dwordx4 v9, s[52:55], s13 offen  lds
    s_waitcnt vmcnt(9)
    s_add_u32 m0, s15, 56320
    s_nop 0
    buffer_load_dwordx4 v11, s[56:59], s13 offen  lds
    s_add_u32 s13, s13, 663552
    s_waitcnt vmcnt(9)
    s_add_u32 m0, s14, 0
    s_nop 0
    buffer_load_dwordx4 v12, s[60:63], s11 offen  lds
    s_add_u32 s11, s11, 9216
    s_waitcnt vmcnt(9)
    v_mov_b32 v14, 1
    s_mov_b64 exec, 1
    ds_add_u32 v1, v14 offset:32
    s_mov_b64 exec, -1
    s_add_u32 m0, s14, 1024
    s_nop 0
    buffer_load_dwordx4 v13, s[60:63], s11 offen  lds
    s_add_u32 s11, s11, 9216
    s_waitcnt vmcnt(9)
    s_add_u32 m0, s14, 2048
    s_nop 0
    buffer_load_dwordx4 v12, s[60:63], s11 offen  lds
    s_add_u32 s11, s11, 9216
    s_waitcnt vmcnt(9)
    s_add_u32 m0, s14, 3072
    s_nop 0
    buffer_load_dwordx4 v13, s[60:63], s11 offen  lds
    s_add_u32 s11, s11, 9216
    s_waitcnt vmcnt(9)
    s_add_u32 m0, s14, 4096
    s_nop 0
    buffer_load_dwordx4 v12, s[60:63], s11 offen  lds
    s_add_u32 s11, s11, 9216
    s_waitcnt vmcnt(9)
    s_add_u32 m0, s14, 5120
    s_nop 0
    buffer_load_dwordx4 v13, s[60:63], s11 offen  lds
    s_add_u32 s11, s11, 9216
    s_waitcnt vmcnt(9)
    s_add_u32 m0, s14, 6144
    s_nop 0
    buffer_load_dwordx4 v12, s[60:63], s11 offen  lds
    s_add_u32 s11, s11, 9216
    s_waitcnt vmcnt(9)
    s_add_u32 m0, s14, 7168
    s_nop 0
    buffer_load_dwordx4 v13, s[60:63], s11 offen  lds
    s_add_u32 s11, s11, 4294902912
    s_waitcnt vmcnt(9)
    s_add_u32 m0, s14, 8192
    s_nop 0
    buffer_load_dwordx4 v12, s[60:63], s11 offen  lds
    s_add_u32 s11, s11, 9216
    s_waitcnt vmcnt(9)
    v_mov_b32 v14, 1
    s_mov_b64 exec, 1
    ds_add_u32 v1, v14 offset:36
    s_mov_b64 exec, -1
    s_add_u32 m0, s14, 9216
    s_nop 0
    buffer_load_dwordx4 v13, s[60:63], s11 offen  lds
    s_add_u32 s11, s11, 9216
    s_waitcnt vmcnt(9)
    s_add_u32 m0, s14, 10240
    s_nop 0
    buffer_load_dwordx4 v12, s[60:63], s11 offen  lds
    s_add_u32 s11, s11, 9216
    s_waitcnt vmcnt(9)
    s_add_u32 m0, s14, 11264
    s_nop 0
    buffer_load_dwordx4 v13, s[60:63], s11 offen  lds
    s_add_u32 s11, s11, 9216
    s_waitcnt vmcnt(9)
    s_add_u32 m0, s14, 12288
    s_nop 0
    buffer_load_dwordx4 v12, s[60:63], s11 offen  lds
    s_add_u32 s11, s11, 9216
    s_waitcnt vmcnt(9)
    s_add_u32 m0, s14, 13312
    s_nop 0
    buffer_load_dwordx4 v13, s[60:63], s11 offen  lds
    s_add_u32 s11, s11, 9216
    s_waitcnt vmcnt(9)
    s_add_u32 m0, s14, 14336
    s_nop 0
    buffer_load_dwordx4 v12, s[60:63], s11 offen  lds
    s_add_u32 s11, s11, 9216
    s_waitcnt vmcnt(9)
    s_add_u32 m0, s14, 15360
    s_nop 0
    buffer_load_dwordx4 v13, s[60:63], s11 offen  lds
    s_add_u32 s11, s11, 4294902912
    s_waitcnt vmcnt(9)
    s_add_u32 m0, s14, 16384
    s_nop 0
    buffer_load_dwordx4 v12, s[60:63], s11 offen  lds
    s_add_u32 s11, s11, 9216
    s_waitcnt vmcnt(9)
    s_add_u32 m0, s14, 17408
    s_nop 0
    buffer_load_dwordx4 v13, s[60:63], s11 offen  lds
    s_add_u32 s11, s11, 9216
    s_waitcnt vmcnt(9)
    s_add_u32 m0, s14, 18432
    s_nop 0
    buffer_load_dwordx4 v12, s[60:63], s11 offen  lds
    s_add_u32 s11, s11, 9216
    s_waitcnt vmcnt(9)
    s_add_u32 m0, s14, 19456
    s_nop 0
    buffer_load_dwordx4 v13, s[60:63], s11 offen  lds
    s_add_u32 s11, s11, 9216
    s_waitcnt vmcnt(9)
    s_add_u32 m0, s14, 20480
    s_nop 0
    buffer_load_dwordx4 v12, s[60:63], s11 offen  lds
    s_add_u32 s11, s11, 9216
    s_waitcnt vmcnt(9)
    s_add_u32 m0, s14, 21504
    s_nop 0
    buffer_load_dwordx4 v13, s[60:63], s11 offen  lds
    s_add_u32 s11, s11, 9216
    s_waitcnt vmcnt(9)
    s_add_u32 m0, s14, 22528
    s_nop 0
    buffer_load_dwordx4 v12, s[60:63], s11 offen  lds
    s_add_u32 s11, s11, 9216
    s_waitcnt vmcnt(9)
    s_add_u32 m0, s14, 23552
    s_nop 0
    buffer_load_dwordx4 v13, s[60:63], s11 offen  lds
    s_add_u32 s11, s11, 4294902912
    s_waitcnt vmcnt(0)
    v_mov_b32 v14, 1
    s_mov_b64 exec, 1
    ds_add_u32 v1, v14 offset:80
    s_mov_b64 exec, -1
    s_endpgm
F_COMP:
    s_barrier
F_COMP2:
    v_lshrrev_b32 v5, 2, v3
    v_bfe_u32 v6, v3, 1, 1
    v_bfe_u32 v7, v3, 3, 1
    v_and_b32 v8, 1, v4
    v_lshl_or_b32 v7, v8, 1, v7
    v_lshl_or_b32 v9, v6, 2, v7
    v_xor_b32 v9, s3, v9
    v_lshlrev_b32 v9, 4, v9
    v_lshl_add_u32 v9, v5, 7, v9
    v_lshl_add_u32 v9, v6, 10, v9
    v_lshl_add_u32 v9, v4, 11, v9
    v_and_b32 v8, 1, v3
    v_lshl_add_u32 v9, v8, 3, v9
    v_add_u32 v10, 49408, v9
    s_and_b32 s12, s3, 3
    v_xor_b32 v13, s12, v7
    v_lshlrev_b32 v13, 5, v13
    v_lshl_add_u32 v13, v5, 7, v13
    v_lshl_add_u32 v13, v4, 10, v13
    v_and_b32 v8, 3, v3
    v_lshl_add_u32 v13, v8, 3, v13
    s_lshr_b32 s13, s3, 2
    s_lshl_b32 s13, s13, 13
    s_add_u32 s13, s13, 73984
    v_add_u32 v13, s13, v13
    v_add_u32 v14, 32768, v13
    v_and_b32 v5, 7, v3
    v_and_b32 v6, 6, v3
    v_xor_b32 v6, v6, v4
    v_lshlrev_b32 v6, 4, v6
    v_lshl_add_u32 v6, v5, 7, v6
    v_add_u32 v15, 147712, v6
    v_xor_b32 v156, 64, v15
    v_and_b32 v6, 1, v4
    v_lshlrev_b32 v6, 2, v6
    v_lshrrev_b32 v7, 1, v4
    v_add_u32 v6, v6, v7
    v_bfe_u32 v7, v3, 3, 1
    v_lshl_add_u32 v6, v7, 1, v6
    s_lshl_b32 s12, s3, 3
    v_add_lshl_u32 v6, v6, s12, 1
    v_mul_u32_u24 v7, 144, v5
    v_add_u32 v7, 156928, v7
    v_add_u32 v157, v6, v7
    v_lshl_add_u32 v158, v4, 4, v7
    s_lshl_b32 s12, s3, 2
    v_add_u32 v6, s12, v4
    v_mul_u32_u24 v6, 9216, v6
    s_lshl_b32 s12, s7, 7
    s_add_u32 s12, s12, 32768
    v_lshl_add_u32 v7, v5, 4, s12
    v_add_u32 v159, v6, v7
    v_bfe_u32 v7, v3, 3, 1
    v_mul_u32_u24 v7, 294912, v7
    v_add_u32 v161, v159, v7
    s_waitcnt lgkmcnt(0)
    s_mov_b32 s52, s50
    s_mov_b32 s53, s51
    s_mov_b32 s54, 268435456
    s_mov_b32 s55, 0x20000
    s_mov_b32 s9, 0
SP_14:
    ds_read_b32 v8, v1 offset:16
    s_waitcnt lgkmcnt(0)
    v_readfirstlane_b32 s8, v8
    s_add_u32 s9, s9, 1
    s_cmp_ge_u32 s8, 3
    s_cbranch_scc1 SP_14_D
    s_sleep 1
    s_cmp_lt_u32 s9, 524288
    s_cbranch_scc1 SP_14
SP_14_D:
    ds_read_b64_tr_b16 v[16:17], v9 offset:256
    ds_read_b64_tr_b16 v[18:19], v9 offset:768
    ds_read_b64_tr_b16 v[20:21], v9 offset:8448
    ds_read_b64_tr_b16 v[22:23], v9 offset:8960
    ds_read_b64_tr_b16 v[24:25], v9 offset:16640
    ds_read_b64_tr_b16 v[26:27], v9 offset:17152
    s_waitcnt lgkmcnt(0)
    v_mov_b32 v8, 1
    s_mov_b64 exec, 1
    ds_add_u32 v1, v8 offset:48
    s_mov_b64 exec, -1
    s_mov_b32 s9, 0
SP_15:
    ds_read_b32 v8, v1 offset:20
    s_waitcnt lgkmcnt(0)
    v_readfirstlane_b32 s8, v8
    s_add_u32 s9, s9, 1
    s_cmp_ge_u32 s8, 3
    s_cbranch_scc1 SP_15_D
    s_sleep 1
    s_cmp_lt_u32 s9, 524288
    s_cbranch_scc1 SP_15
SP_15_D:
    ds_read_b64_tr_b16 v[28:29], v9 offset:24832
    ds_read_b64_tr_b16 v[30:31], v9 offset:25344
    ds_read_b64_tr_b16 v[32:33], v9 offset:33024
    ds_read_b64_tr_b16 v[34:35], v9 offset:33536
    ds_read_b64_tr_b16 v[36:37], v9 offset:41216
    ds_read_b64_tr_b16 v[38:39], v9 offset:41728
    s_waitcnt lgkmcnt(0)
    v_mov_b32 v8, 1
    s_mov_b64 exec, 1
    ds_add_u32 v1, v8 offset:52
    s_mov_b64 exec, -1
    s_mov_b32 s9, 0
SP_16:
    ds_read_b32 v8, v1 offset:24
    s_waitcnt lgkmcnt(0)
    v_readfirstlane_b32 s8, v8
    s_add_u32 s9, s9, 1
    s_cmp_ge_u32 s8, 3
    s_cbranch_scc1 SP_16_D
    s_sleep 1
    s_cmp_lt_u32 s9, 524288
    s_cbranch_scc1 SP_16
SP_16_D:
    ds_read_b64_tr_b16 v[40:41], v10 offset:0
    ds_read_b64_tr_b16 v[42:43], v10 offset:512
    ds_read_b64_tr_b16 v[44:45], v10 offset:8192
    ds_read_b64_tr_b16 v[46:47], v10 offset:8704
    ds_read_b64_tr_b16 v[48:49], v10 offset:16384
    ds_read_b64_tr_b16 v[50:51], v10 offset:16896
    s_waitcnt lgkmcnt(0)
    v_mov_b32 v8, 1
    s_mov_b64 exec, 1
    ds_add_u32 v1, v8 offset:56
    s_mov_b64 exec, -1
    s_mov_b32 s9, 0
SP_17:
    ds_read_b32 v8, v1 offset:28
    s_waitcnt lgkmcnt(0)
    v_readfirstlane_b32 s8, v8
    s_add_u32 s9, s9, 1
    s_cmp_ge_u32 s8, 3
    s_cbranch_scc1 SP_17_D
    s_sleep 1
    s_cmp_lt_u32 s9, 524288
    s_cbranch_scc1 SP_17
SP_17_D:
    ds_read_b64_tr_b16 v[52:53], v9 offset:256
    ds_read_b64_tr_b16 v[54:55], v9 offset:768
    ds_read_b64_tr_b16 v[56:57], v9 offset:8448
    ds_read_b64_tr_b16 v[58:59], v9 offset:8960
    ds_read_b64_tr_b16 v[60:61], v9 offset:16640
    ds_read_b64_tr_b16 v[62:63], v9 offset:17152
    s_mov_b32 s9, 0
SP_18:
    ds_read_b32 v8, v1 offset:32
    s_waitcnt lgkmcnt(0)
    v_readfirstlane_b32 s8, v8
    s_add_u32 s9, s9, 1
    s_cmp_ge_u32 s8, 3
    s_cbranch_scc1 SP_18_D
    s_sleep 1
    s_cmp_lt_u32 s9, 524288
    s_cbranch_scc1 SP_18
SP_18_D:
    ds_read_b64_tr_b16 v[64:65], v9 offset:24832
    ds_read_b64_tr_b16 v[66:67], v9 offset:25344
    ds_read_b64_tr_b16 v[68:69], v9 offset:33024
    ds_read_b64_tr_b16 v[70:71], v9 offset:33536
    ds_read_b64_tr_b16 v[72:73], v9 offset:41216
    ds_read_b64_tr_b16 v[74:75], v9 offset:41728
    s_mov_b32 s9, 0
SP_19:
    ds_read_b32 v8, v1 offset:36
    s_waitcnt lgkmcnt(0)
    v_readfirstlane_b32 s8, v8
    s_add_u32 s9, s9, 1
    s_cmp_ge_u32 s8, 3
    s_cbranch_scc1 SP_19_D
    s_sleep 1
    s_cmp_lt_u32 s9, 524288
    s_cbranch_scc1 SP_19
SP_19_D:
    ds_read_b64_tr_b16 v[76:77], v10 offset:0
    ds_read_b64_tr_b16 v[78:79], v10 offset:512
    ds_read_b64_tr_b16 v[80:81], v10 offset:8192
    ds_read_b64_tr_b16 v[82:83], v10 offset:8704
    ds_read_b64_tr_b16 v[84:85], v10 offset:16384
    ds_read_b64_tr_b16 v[86:87], v10 offset:16896
    s_mov_b32 s56, 0xff00ff00
    s_mov_b32 s57, 0xff00ff00
    s_mov_b32 s60, 0x7060500
    s_mov_b32 s61, 0x7060501
    s_mov_b32 s62, 0x7060502
    s_mov_b32 s63, 0x7060503
    s_mov_b32 s9, 0
    s_mov_b32 s13, 0
F_W:
    ds_read_b64 v[162:163], v1 offset:80
    s_waitcnt lgkmcnt(0)
    v_readfirstlane_b32 s8, v163
    v_readfirstlane_b32 s12, v162
    s_add_u32 s9, s9, 1
    s_cmp_lg_u32 s8, 0
    s_cbranch_scc1 F_WX
    s_cmp_ge_u32 s12, 3
    s_cbranch_scc1 F_WD
    s_cmp_lt_u32 s9, 524288
    s_cbranch_scc1 F_W
F_WD:
    ds_read_b64_tr_b16 v[88:89], v13 offset:0
    ds_read_b64_tr_b16 v[90:91], v13 offset:512
    ds_read_b64_tr_b16 v[92:93], v13 offset:4096
    ds_read_b64_tr_b16 v[94:95], v13 offset:4608
    ds_read_b64_tr_b16 v[96:97], v13 offset:16384
    ds_read_b64_tr_b16 v[98:99], v13 offset:16896
    ds_read_b64_tr_b16 v[100:101], v13 offset:20480
    ds_read_b64_tr_b16 v[102:103], v13 offset:20992
    ds_read_b64_tr_b16 v[104:105], v13 offset:32768
    ds_read_b64_tr_b16 v[106:107], v13 offset:33280
    ds_read_b64_tr_b16 v[108:109], v13 offset:36864
    ds_read_b64_tr_b16 v[110:111], v13 offset:37376
    ds_read_b64_tr_b16 v[112:113], v13 offset:49152
    ds_read_b64_tr_b16 v[114:115], v13 offset:49664
    ds_read_b64_tr_b16 v[116:117], v13 offset:53248
    ds_read_b64_tr_b16 v[118:119], v13 offset:53760
    ds_read_b64_tr_b16 v[120:121], v14 offset:32768
    ds_read_b64_tr_b16 v[122:123], v14 offset:33280
    ds_read_b64_tr_b16 v[124:125], v14 offset:36864
    ds_read_b64_tr_b16 v[126:127], v14 offset:37376
    s_mov_b32 s13, 1
    s_mov_b32 s9, 0
SP_20:
    ds_read_b32 v8, v1 offset:84
    s_waitcnt lgkmcnt(0)
    v_readfirstlane_b32 s8, v8
    s_add_u32 s9, s9, 1
    s_cmp_ge_u32 s8, 1
    s_cbranch_scc1 SP_20_D
    s_cmp_lt_u32 s9, 524288
    s_cbranch_scc1 SP_20
SP_20_D:
F_WX:
    ds_read_b128 v[128:131], v15 offset:0
    ds_read_b128 v[132:135], v156 offset:0
    ds_read_b128 v[136:139], v15 offset:1024
    ds_read_b128 v[140:143], v156 offset:1024
    ds_read_b128 v[144:147], v15 offset:2048
    ds_read_b128 v[148:151], v156 offset:2048
    ds_read_b32 v160, v1 offset:8
    s_waitcnt lgkmcnt(6)
    v_mfma_f32_16x16x32_bf16 v[152:155], v[16:19], v[128:131], 0
    ds_read_b128 v[128:131], v15 offset:3072
    s_waitcnt lgkmcnt(6)
    v_mfma_f32_16x16x32_bf16 v[152:155], v[20:23], v[132:135], v[152:155]
    ds_read_b128 v[132:135], v156 offset:3072
    s_waitcnt lgkmcnt(6)
    v_mfma_f32_16x16x32_bf16 v[152:155], v[24:27], v[136:139], v[152:155]
    ds_read_b128 v[136:139], v15 offset:4096
    s_waitcnt lgkmcnt(6)
    v_mfma_f32_16x16x32_bf16 v[152:155], v[28:31], v[140:143], v[152:155]
    ds_read_b128 v[140:143], v156 offset:4096
    s_waitcnt lgkmcnt(6)
    v_mfma_f32_16x16x32_bf16 v[152:155], v[32:35], v[144:147], v[152:155]
    ds_read_b128 v[144:147], v15 offset:5120
    s_waitcnt lgkmcnt(6)
    v_mfma_f32_16x16x32_bf16 v[152:155], v[36:39], v[148:151], v[152:155]
    ds_read_b128 v[148:151], v156 offset:5120
    s_waitcnt lgkmcnt(5)
    v_mfma_f32_16x16x32_bf16 v[152:155], v[40:43], v[128:131], v[152:155]
    ds_read_b128 v[128:131], v15 offset:6144
    s_waitcnt lgkmcnt(5)
    v_mfma_f32_16x16x32_bf16 v[152:155], v[44:47], v[132:135], v[152:155]
    ds_read_b128 v[132:135], v156 offset:6144
    s_waitcnt lgkmcnt(5)
    v_mfma_f32_16x16x32_bf16 v[152:155], v[48:51], v[136:139], v[152:155]
    ds_read_b128 v[136:139], v15 offset:7168
    s_waitcnt lgkmcnt(5)
    v_mfma_f32_16x16x32_bf16 v[152:155], v[52:55], v[140:143], v[152:155]
    ds_read_b128 v[140:143], v156 offset:7168
    s_waitcnt lgkmcnt(5)
    v_mfma_f32_16x16x32_bf16 v[152:155], v[56:59], v[144:147], v[152:155]
    ds_read_b128 v[144:147], v15 offset:8192
    s_waitcnt lgkmcnt(5)
    v_mfma_f32_16x16x32_bf16 v[152:155], v[60:63], v[148:151], v[152:155]
    ds_read_b128 v[148:151], v156 offset:8192
    s_waitcnt lgkmcnt(5)
    v_mfma_f32_16x16x32_bf16 v[152:155], v[64:67], v[128:131], v[152:155]
    s_waitcnt lgkmcnt(4)
    v_mfma_f32_16x16x32_bf16 v[152:155], v[68:71], v[132:135], v[152:155]
    s_waitcnt lgkmcnt(3)
    v_mfma_f32_16x16x32_bf16 v[152:155], v[72:75], v[136:139], v[152:155]
    s_waitcnt lgkmcnt(2)
    v_mfma_f32_16x16x32_bf16 v[152:155], v[76:79], v[140:143], v[152:155]
    s_waitcnt lgkmcnt(1)
    v_mfma_f32_16x16x32_bf16 v[152:155], v[80:83], v[144:147], v[152:155]
    s_waitcnt lgkmcnt(0)
    v_mfma_f32_16x16x32_bf16 v[152:155], v[84:87], v[148:151], v[152:155]
    s_nop 7
    v_permlane32_swap_b32 v152, v153
    v_permlane32_swap_b32 v154, v155
    v_cndmask_b32 v152, v152, v154, s[56:57]
    v_cndmask_b32 v153, v153, v155, s[56:57]
    v_cvt_pk_bf16_f32 v153, v152, v153
    v_lshlrev_b32 v152, 16, v153
    v_mul_f32 v154, 0xbfb8aa3b, v152
    v_exp_f32 v154, v154
    v_and_b32 v153, 0xffff0000, v153
    v_add_f32 v154, 1.0, v154
    v_rcp_f32 v154, v154
    s_nop 0
    v_mul_f32 v152, v152, v154
    v_cvt_pk_bf16_f32 v152, v152, v152
    v_and_b32 v152, 0xffff0000, v152
    v_mul_f32 v152, v152, v153
    v_cvt_pk_bf16_f32 v152, v152, v152
    ds_write_b16 v157, v152
    v_mov_b32 v8, 1
    s_mov_b64 exec, 1
    ds_add_u32 v1, v8 offset:88
    s_mov_b64 exec, -1
    s_cmp_lg_u32 s13, 0
    s_cbranch_scc1 F_HD
    s_mov_b32 s9, 0
SP_21:
    ds_read_b32 v8, v1 offset:80
    s_waitcnt lgkmcnt(0)
    v_readfirstlane_b32 s8, v8
    s_add_u32 s9, s9, 1
    s_cmp_ge_u32 s8, 3
    s_cbranch_scc1 SP_21_D
    s_cmp_lt_u32 s9, 524288
    s_cbranch_scc1 SP_21
SP_21_D:
    ds_read_b64_tr_b16 v[88:89], v13 offset:0
    ds_read_b64_tr_b16 v[90:91], v13 offset:512
    ds_read_b64_tr_b16 v[92:93], v13 offset:4096
    ds_read_b64_tr_b16 v[94:95], v13 offset:4608
    ds_read_b64_tr_b16 v[96:97], v13 offset:16384
    ds_read_b64_tr_b16 v[98:99], v13 offset:16896
    ds_read_b64_tr_b16 v[100:101], v13 offset:20480
    ds_read_b64_tr_b16 v[102:103], v13 offset:20992
    ds_read_b64_tr_b16 v[104:105], v13 offset:32768
    ds_read_b64_tr_b16 v[106:107], v13 offset:33280
    ds_read_b64_tr_b16 v[108:109], v13 offset:36864
    ds_read_b64_tr_b16 v[110:111], v13 offset:37376
    ds_read_b64_tr_b16 v[112:113], v13 offset:49152
    ds_read_b64_tr_b16 v[114:115], v13 offset:49664
    ds_read_b64_tr_b16 v[116:117], v13 offset:53248
    ds_read_b64_tr_b16 v[118:119], v13 offset:53760
    ds_read_b64_tr_b16 v[120:121], v14 offset:32768
    ds_read_b64_tr_b16 v[122:123], v14 offset:33280
    ds_read_b64_tr_b16 v[124:125], v14 offset:36864
    ds_read_b64_tr_b16 v[126:127], v14 offset:37376
F_HD:
    s_mov_b32 s9, 0
SP_22:
    ds_read_b32 v8, v1 offset:88
    s_waitcnt lgkmcnt(0)
    v_readfirstlane_b32 s8, v8
    s_add_u32 s9, s9, 1
    s_cmp_ge_u32 s8, 8
    s_cbranch_scc1 SP_22_D
    s_cmp_lt_u32 s9, 524288
    s_cbranch_scc1 SP_22
SP_22_D:
    ds_read_b128 v[128:131], v158 offset:0
    ds_read_b128 v[132:135], v158 offset:64
    s_waitcnt lgkmcnt(1)
    v_mfma_f32_16x16x32_bf16 v[16:19], v[88:91], v[128:131], 0
    s_waitcnt lgkmcnt(0)
    v_mfma_f32_16x16x32_bf16 v[16:19], v[92:95], v[132:135], v[16:19]
    v_mfma_f32_16x16x32_bf16 v[20:23], v[96:99], v[128:131], 0
    v_mfma_f32_16x16x32_bf16 v[20:23], v[100:103], v[132:135], v[20:23]
    v_mfma_f32_16x16x32_bf16 v[24:27], v[104:107], v[128:131], 0
    v_mfma_f32_16x16x32_bf16 v[24:27], v[108:111], v[132:135], v[24:27]
    v_mfma_f32_16x16x32_bf16 v[28:31], v[112:115], v[128:131], 0
    v_mfma_f32_16x16x32_bf16 v[28:31], v[116:119], v[132:135], v[28:31]
    v_mfma_f32_16x16x32_bf16 v[32:35], v[120:123], v[128:131], 0
    v_mfma_f32_16x16x32_bf16 v[32:35], v[124:127], v[132:135], v[32:35]
    s_nop 1
    v_cndmask_b32 v16, v16, v20, s[56:57]
    v_cndmask_b32 v17, v17, v21, s[56:57]
    v_cndmask_b32 v18, v18, v22, s[56:57]
    v_cndmask_b32 v19, v19, v23, s[56:57]
    v_perm_b32 v16, v16, v160, s60
    v_perm_b32 v17, v17, v160, s61
    v_perm_b32 v18, v18, v160, s62
    v_perm_b32 v19, v19, v160, s63
    s_mov_b32 s12, 0
    buffer_store_dwordx4 v[16:19], v161, s[52:55], s12 offen sc1
    v_cndmask_b32 v24, v24, v28, s[56:57]
    v_cndmask_b32 v25, v25, v29, s[56:57]
    v_cndmask_b32 v26, v26, v30, s[56:57]
    v_cndmask_b32 v27, v27, v31, s[56:57]
    v_perm_b32 v24, v24, v160, s60
    v_perm_b32 v25, v25, v160, s61
    v_perm_b32 v26, v26, v160, s62
    v_perm_b32 v27, v27, v160, s63
    s_mov_b32 s12, 589824
    buffer_store_dwordx4 v[24:27], v161, s[52:55], s12 offen sc1
    s_cmp_ge_u32 s3, 4
    s_cbranch_scc1 F_DONE
    s_not_b64 exec, s[56:57]
    v_perm_b32 v32, v32, v160, s60
    v_perm_b32 v33, v33, v160, s61
    v_perm_b32 v34, v34, v160, s62
    v_perm_b32 v35, v35, v160, s63
    s_mov_b32 s12, 1179648
    buffer_store_dwordx4 v[32:35], v159, s[52:55], s12 offen sc1
F_DONE:
    s_mov_b64 exec, -1
    s_endpgm
HELPER:
    s_cmp_ge_u32 s3, 6
    s_cbranch_scc1 K_END
    s_and_b32 s12, s3, 1
    s_sub_u32 s13, s3, 2
    s_lshr_b32 s13, s13, 1
    s_mul_i32 s13, s13, 5
    s_add_u32 s13, s13, s5
    s_add_u32 s13, s13, 34
    v_mul_u32_u24 v5, 57, v2
    v_lshrrev_b32 v5, 9, v5
    v_mul_u32_u24 v6, 9, v5
    v_sub_u32 v6, v2, v6
    s_waitcnt lgkmcnt(0)
    s_cmp_eq_u32 s12, 1
    s_cselect_b32 s52, s40, s38
    s_cselect_b32 s53, s41, s39
    s_mov_b32 s54, 5308416
    s_mov_b32 s55, 0x20000
    v_mul_u32_u24 v5, 9216, v5
    v_lshl_add_u32 v5, v6, 7, v5
    s_mul_i32 s8, s4, 1152
    s_mul_i32 s13, s13, 64512
    s_add_u32 s13, s13, s8
    s_barrier
    buffer_load_dword v8, v5, s[52:55], s13 offen
    s_add_u32 s13, s13, 645120
    s_waitcnt vmcnt(0)
    buffer_load_dword v8, v5, s[52:55], s13 offen
    s_add_u32 s13, s13, 645120
    s_waitcnt vmcnt(0)
    buffer_load_dword v8, v5, s[52:55], s13 offen
    s_add_u32 s13, s13, 645120
    s_waitcnt vmcnt(0)
    buffer_load_dword v8, v5, s[52:55], s13 offen
    s_add_u32 s13, s13, 645120
    s_endpgm
C_KGEN:
    s_and_b32 s12, s3, 3
    s_lshr_b32 s13, s3, 2
    s_lshl_b32 s14, s7, 2
    s_add_u32 s14, s14, s12
    s_lshl_b32 s8, s14, 8
    s_lshl_b32 s9, s13, 7
    s_add_u32 s8, s8, s9
    v_lshl_add_u32 v5, v2, 1, s8
    v_mov_b32 v16, 0
    v_mov_b32 v17, 0
    v_mov_b32 v18, 0
    v_mov_b32 v19, 0
    v_mov_b32 v20, 0
    v_mov_b32 v21, 0
    s_lshl_b32 s55, s7, 3
    s_setprio 2
    s_mul_i32 s15, s3, 4608
    s_add_u32 s15, s15, 256
    s_mul_i32 s52, s12, 8960
    s_add_u32 s52, s52, 37120
    s_mul_i32 s53, s12, 4672
    s_add_u32 s53, s53, 72960
    v_mul_u32_u24 v7, 288, v3
    v_lshl_add_u32 v7, v4, 4, v7
    v_add_u32 v7, s15, v7
    s_mov_b32 m0, s15
    s_waitcnt lgkmcnt(0)
    s_load_dwordx2 s[58:59], s[30:31], s55
    s_load_dwordx2 s[68:69], s[32:33], s55
    global_load_short_d16_hi v16, v5, s[18:19]
    global_load_short_d16_hi v17, v5, s[20:21]
    global_load_short_d16_hi v18, v5, s[22:23]
    global_load_short_d16_hi v19, v5, s[24:25]
    global_load_short_d16_hi v20, v5, s[26:27]
    global_load_short_d16_hi v21, v5, s[28:29]
    s_barrier
    v_and_b32 v8, 3, v3
    v_sub_u32 v8, 3, v8
    v_mul_u32_u24 v8, 2240, v8
    v_lshrrev_b32 v13, 2, v3
    v_lshl_add_u32 v13, v4, 1, v13
    v_lshl_add_u32 v8, v13, 3, v8
    v_add3_u32 v5, v8, s52, 8
    v_lshlrev_b32 v8, 1, v3
    v_sub_u32 v8, v4, v8
    v_lshlrev_b32 v8, 4, v8
    s_add_u32 s8, s53, 480
    v_add_u32 v6, s8, v8
    v_lshl_add_u32 v8, v3, 2, v4
    s_mul_i32 s8, s12, 4160
    s_add_u32 s8, s8, 100344
    v_lshlrev_b32 v8, 3, v8
    v_sub_u32 v140, s8, v8
    s_mul_i32 s14, s12, 3
    s_add_u32 s14, s14, 21
    s_min_u32 s14, s14, 29
    s_lshl_b32 s8, s14, 8
    s_add_u32 s8, s8, 8192
    v_xor_b32 v166, 63, v2
    v_lshrrev_b32 v166, 1, v166
    v_lshl_add_u32 v166, v166, 3, s8
    s_cmp_eq_u32 s13, 0
    s_cbranch_scc1 C_SETA
    v_mov_b32 v24, 0
    v_mov_b32 v25, 0
    v_mov_b32 v26, 0
    v_mov_b32 v27, 0
    v_bfe_u32 v8, v2, 2, 2
    v_mul_u32_u24 v8, 2240, v8
    v_and_b32 v9, 3, v2
    v_lshl_add_u32 v10, v9, 4, v8
    v_add_u32 v10, s52, v10
    ds_write_b128 v10, v[24:27] offset:2096
    v_and_b32 v9, 1, v2
    v_lshl_add_u32 v10, v9, 4, v8
    v_add_u32 v10, s52, v10
    ds_write_b128 v10, v[24:27]
    v_min_u32 v9, 29, v2
    v_lshl_add_u32 v10, v9, 4, s53
    ds_write_b128 v10, v[24:27] offset:4096
    s_branch C_SETD
C_SETA:
    v_lshl_add_u32 v8, v4, 3, v3
    v_sub_u32 v8, 39, v8
    s_mov_b32 s8, 0x3f800000
    v_mov_b32 v10, 127
    v_mov_b32 v11, 0
    v_lshlrev_b64 v[10:11], v8, v[10:11]
    v_alignbit_b32 v10, v11, v10, 19
    v_bfe_i32 v11, v10, 0, 1
    v_bfe_i32 v12, v10, 1, 1
    v_and_b32 v11, 0x3f80, v11
    v_and_or_b32 v142, v12, s8, v11
    v_bfe_i32 v11, v10, 2, 1
    v_bfe_i32 v12, v10, 3, 1
    v_and_b32 v11, 0x3f80, v11
    v_and_or_b32 v143, v12, s8, v11
    v_bfe_i32 v11, v10, 4, 1
    v_bfe_i32 v12, v10, 5, 1
    v_and_b32 v11, 0x3f80, v11
    v_and_or_b32 v144, v12, s8, v11
    v_bfe_i32 v11, v10, 6, 1
    v_bfe_i32 v12, v10, 7, 1
    v_and_b32 v11, 0x3f80, v11
    v_and_or_b32 v145, v12, s8, v11
    v_mov_b32 v10, 511
    v_mov_b32 v11, 0
    v_lshlrev_b64 v[10:11], v8, v[10:11]
    v_alignbit_b32 v10, v11, v10, 20
    v_bfe_i32 v11, v10, 0, 1
    v_bfe_i32 v12, v10, 1, 1
    v_and_b32 v11, 0x3f80, v11
    v_and_or_b32 v146, v12, s8, v11
    v_bfe_i32 v11, v10, 2, 1
    v_bfe_i32 v12, v10, 3, 1
    v_and_b32 v11, 0x3f80, v11
    v_and_or_b32 v147, v12, s8, v11
    v_bfe_i32 v11, v10, 4, 1
    v_bfe_i32 v12, v10, 5, 1
    v_and_b32 v11, 0x3f80, v11
    v_and_or_b32 v148, v12, s8, v11
    v_bfe_i32 v11, v10, 6, 1
    v_bfe_i32 v12, v10, 7, 1
    v_and_b32 v11, 0x3f80, v11
    v_and_or_b32 v149, v12, s8, v11
    v_lshrrev_b32 v116, 1, v4
    v_and_b32 v117, 1, v4
    v_lshlrev_b32 v116, 8, v116
    v_lshl_add_u32 v116, v117, 3, v116
    v_lshl_add_u32 v116, v3, 4, v116
    v_add_u32 v116, s15, v116
    v_cmp_gt_u32 vcc, 2, v4
    v_lshlrev_b32 v117, 2, v3
    v_lshlrev_b32 v118, 3, v3
    v_cndmask_b32 v117, v117, v118, vcc
    v_lshl_add_u32 v117, v4, 7, v117
    v_add_u32 v117, s15, v117
    v_mov_b32 v118, 64
    v_cndmask_b32 v118, v118, 4, vcc
    v_add_u32 v118, v118, v117
    v_lshlrev_b32 v119, 1, v3
    v_lshl_add_u32 v119, v4, 7, v119
    v_add_u32 v119, s15, v119
    v_lshlrev_b32 v120, 5, v2
    v_lshlrev_b32 v121, 4, v2
    v_add_u32 v121, 256, v121
    v_min_u32 v120, v120, v121
    v_lshlrev_b32 v121, 3, v2
    v_add_u32 v121, 512, v121
    v_min_u32 v120, v120, v121
    v_add_u32 v120, s15, v120
    v_min_u32 v121, 15, v2
    v_lshl_add_u32 v121, v121, 2, s15
    v_lshlrev_b32 v122, 2, v4
    v_sub_u32 v122, v3, v122
    v_lshl_add_u32 v122, v122, 2, s15
    v_add_u32 v122, 2100, v122
    v_lshl_add_u32 v123, v2, 5, s52
    s_mov_b32 s56, 0x01000100
    s_mov_b32 s57, 0x03020302
C_SETD:
    s_waitcnt lgkmcnt(0)
    s_lshl_b32 s8, s12, 4
    s_lshr_b64 s[58:59], s[58:59], s8
    s_lshl_b32 s8, s58, 16
    v_mov_b32 v44, s8
    v_mul_f32 v45, 0x3fb8aa3b, v44
    v_mov_b32 v46, 0x3fb8aa3b
    v_fma_f32 v46, v44, v46, -v45
    v_mov_b32 v47, 0x32a57060
    v_fma_f32 v46, v44, v47, v46
    v_exp_f32 v45, v45
    v_mul_f32 v46, 0x3f317218, v46
    v_fma_f32 v45, v45, v46, v45
    v_cvt_pk_bf16_f32 v45, v45, v45
    v_and_b32 v36, 0xffff0000, v45
    v_mul_f32 v37, 0x3fb8aa3b, v36
    v_mul_f32 v38, 0x3e22f983, v36
    s_waitcnt vmcnt(0)
    v_mul_f32 v40, v16, v37
    v_mul_f32 v41, v17, v38
    v_exp_f32 v24, v40
    v_fract_f32 v47, v41
    v_cos_f32 v46, v47
    v_sin_f32 v47, v47
    v_mul_f32 v46, v24, v46
    v_mul_f32 v47, v24, v47
    v_mul_f32 v18, v18, v36
    v_mul_f32 v19, v19, v36
    v_pk_mul_f32 v[42:43], v[20:21], v[18:19] op_sel:[0,0] op_sel_hi:[0,1]
    v_pk_fma_f32 v[42:43], v[20:21], v[18:19], v[42:43] op_sel:[1,1,0] op_sel_hi:[1,0,1] neg_lo:[0,1,0]
    v_max_f32 v39, |v42|, |v43|
    v_pk_mul_f32 v[48:49], v[46:47], v[46:47] op_sel:[0,0] op_sel_hi:[0,1]
    v_pk_fma_f32 v[48:49], v[46:47], v[46:47], v[48:49] op_sel:[1,1,0] op_sel_hi:[1,0,1] neg_lo:[0,1,0]
    v_pk_mul_f32 v[52:53], v[48:49], v[48:49] op_sel:[0,0] op_sel_hi:[0,1]
    v_pk_fma_f32 v[52:53], v[48:49], v[48:49], v[52:53] op_sel:[1,1,0] op_sel_hi:[1,0,1] neg_lo:[0,1,0]
    v_pk_mul_f32 v[60:61], v[52:53], v[52:53] op_sel:[0,0] op_sel_hi:[0,1]
    v_pk_fma_f32 v[60:61], v[52:53], v[52:53], v[60:61] op_sel:[1,1,0] op_sel_hi:[1,0,1] neg_lo:[0,1,0]
    v_mov_b32 v30, 0x3c00
    v_xor_b32 v61, 0x80000000, v61
    ds_write_addtid_b32 v30
    v_cvt_pk_f16_f32 v26, v60, v61
    v_pk_mul_f32 v[62:63], v[60:61], v[60:61] op_sel:[0,0] op_sel_hi:[0,1]
    v_pk_fma_f32 v[62:63], v[60:61], v[60:61], v[62:63] op_sel:[1,1,0] op_sel_hi:[1,0,1] neg_lo:[0,1,0]
    v_max_u32_dpp v39, v39, v39 row_shr:1 row_mask:0xf bank_mask:0xf
    ds_write_addtid_b32 v26 offset:288
    v_cvt_pk_f16_f32 v27, v62, v63
    v_pk_mul_f32 v[64:65], v[62:63], v[60:61] op_sel:[0,0] op_sel_hi:[0,1]
    v_pk_fma_f32 v[64:65], v[62:63], v[60:61], v[64:65] op_sel:[1,1,0] op_sel_hi:[1,0,1] neg_lo:[0,1,0]
    v_max_u32_dpp v39, v39, v39 row_shr:2 row_mask:0xf bank_mask:0xf
    ds_write_addtid_b32 v27 offset:576
    v_cvt_pk_f16_f32 v28, v64, v65
    v_pk_mul_f32 v[62:63], v[64:65], v[60:61] op_sel:[0,0] op_sel_hi:[0,1]
    v_pk_fma_f32 v[62:63], v[64:65], v[60:61], v[62:63] op_sel:[1,1,0] op_sel_hi:[1,0,1] neg_lo:[0,1,0]
    v_max_u32_dpp v39, v39, v39 row_shr:4 row_mask:0xf bank_mask:0xf
    ds_write_addtid_b32 v28 offset:864
    v_cvt_pk_f16_f32 v29, v62, v63
    v_pk_mul_f32 v[64:65], v[62:63], v[60:61] op_sel:[0,0] op_sel_hi:[0,1]
    v_pk_fma_f32 v[64:65], v[62:63], v[60:61], v[64:65] op_sel:[1,1,0] op_sel_hi:[1,0,1] neg_lo:[0,1,0]
    v_max_u32_dpp v39, v39, v39 row_shr:8 row_mask:0xf bank_mask:0xf
    ds_write_addtid_b32 v29 offset:1152
    v_cvt_pk_f16_f32 v26, v64, v65
    v_pk_mul_f32 v[62:63], v[64:65], v[60:61] op_sel:[0,0] op_sel_hi:[0,1]
    v_pk_fma_f32 v[62:63], v[64:65], v[60:61], v[62:63] op_sel:[1,1,0] op_sel_hi:[1,0,1] neg_lo:[0,1,0]
    v_max_u32_dpp v39, v39, v39 row_bcast:15 row_mask:0xa bank_mask:0xf
    ds_write_addtid_b32 v26 offset:1440
    v_cvt_pk_f16_f32 v27, v62, v63
    v_pk_mul_f32 v[64:65], v[62:63], v[60:61] op_sel:[0,0] op_sel_hi:[0,1]
    v_pk_fma_f32 v[64:65], v[62:63], v[60:61], v[64:65] op_sel:[1,1,0] op_sel_hi:[1,0,1] neg_lo:[0,1,0]
    v_max_u32_dpp v39, v39, v39 row_bcast:31 row_mask:0xc bank_mask:0xf
    ds_write_addtid_b32 v27 offset:1728
    v_cvt_pk_f16_f32 v28, v64, v65
    v_pk_mul_f32 v[62:63], v[64:65], v[60:61] op_sel:[0,0] op_sel_hi:[0,1]
    v_pk_fma_f32 v[62:63], v[64:65], v[60:61], v[62:63] op_sel:[1,1,0] op_sel_hi:[1,0,1] neg_lo:[0,1,0]
    v_readlane_b32 s8, v39, 63
    ds_write_addtid_b32 v28 offset:2016
    v_cvt_pk_f16_f32 v29, v62, v63
    v_pk_mul_f32 v[64:65], v[62:63], v[60:61] op_sel:[0,0] op_sel_hi:[0,1]
    v_pk_fma_f32 v[64:65], v[62:63], v[60:61], v[64:65] op_sel:[1,1,0] op_sel_hi:[1,0,1] neg_lo:[0,1,0]
    ds_write_addtid_b32 v29 offset:2304
    v_cvt_pk_f16_f32 v26, v64, v65
    v_pk_mul_f32 v[62:63], v[64:65], v[60:61] op_sel:[0,0] op_sel_hi:[0,1]
    v_pk_fma_f32 v[62:63], v[64:65], v[60:61], v[62:63] op_sel:[1,1,0] op_sel_hi:[1,0,1] neg_lo:[0,1,0]
    ds_write_addtid_b32 v26 offset:2592
    v_cvt_pk_f16_f32 v27, v62, v63
    v_pk_mul_f32 v[64:65], v[62:63], v[60:61] op_sel:[0,0] op_sel_hi:[0,1]
    v_pk_fma_f32 v[64:65], v[62:63], v[60:61], v[64:65] op_sel:[1,1,0] op_sel_hi:[1,0,1] neg_lo:[0,1,0]
    ds_write_addtid_b32 v27 offset:2880
    v_cvt_pk_f16_f32 v28, v64, v65
    v_pk_mul_f32 v[62:63], v[64:65], v[60:61] op_sel:[0,0] op_sel_hi:[0,1]
    v_pk_fma_f32 v[62:63], v[64:65], v[60:61], v[62:63] op_sel:[1,1,0] op_sel_hi:[1,0,1] neg_lo:[0,1,0]
    ds_write_addtid_b32 v28 offset:3168
    v_cvt_pk_f16_f32 v29, v62, v63
    v_pk_mul_f32 v[64:65], v[62:63], v[60:61] op_sel:[0,0] op_sel_hi:[0,1]
    v_pk_fma_f32 v[64:65], v[62:63], v[60:61], v[64:65] op_sel:[1,1,0] op_sel_hi:[1,0,1] neg_lo:[0,1,0]
    ds_write_addtid_b32 v29 offset:3456
    v_cvt_pk_f16_f32 v26, v64, v65
    v_pk_mul_f32 v[62:63], v[64:65], v[60:61] op_sel:[0,0] op_sel_hi:[0,1]
    v_pk_fma_f32 v[62:63], v[64:65], v[60:61], v[62:63] op_sel:[1,1,0] op_sel_hi:[1,0,1] neg_lo:[0,1,0]
    ds_write_addtid_b32 v26 offset:3744
    v_cvt_pk_f16_f32 v27, v62, v63
    v_pk_mul_f32 v[64:65], v[62:63], v[60:61] op_sel:[0,0] op_sel_hi:[0,1]
    v_pk_fma_f32 v[64:65], v[62:63], v[60:61], v[64:65] op_sel:[1,1,0] op_sel_hi:[1,0,1] neg_lo:[0,1,0]
    ds_write_addtid_b32 v27 offset:4032
    v_cvt_pk_f16_f32 v28, v64, v65
    s_lshr_b32 s8, s8, 23
    s_sub_u32 s8, 258, s8
    s_min_u32 s54, s8, 253
    s_lshl_b32 s8, s54, 23
    v_mul_f32 v42, s8, v42
    v_mul_f32 v43, s8, v43
    ds_write_addtid_b32 v28 offset:4320
    ds_read_b128 v[72:75], v7 offset:0
    ds_read_b128 v[76:79], v7 offset:64
    ds_read_b128 v[80:83], v7 offset:128
    ds_read_b128 v[84:87], v7 offset:192
    v_mul_f32 v44, 0x43000000, v40
    v_mul_f32 v45, 0x43000000, v41
    v_exp_f32 v24, v44
    v_fract_f32 v45, v45
    v_cos_f32 v44, v45
    v_sin_f32 v45, v45
    v_mul_f32 v44, v24, v44
    v_mul_f32 v45, v24, v45
    v_pk_mul_f32 v[50:51], v[48:49], v[46:47] op_sel:[0,0] op_sel_hi:[0,1]
    v_pk_fma_f32 v[50:51], v[48:49], v[46:47], v[50:51] op_sel:[1,1,0] op_sel_hi:[1,0,1] neg_lo:[0,1,0]
    v_pk_mul_f32 v[54:55], v[52:53], v[46:47] op_sel:[0,0] op_sel_hi:[0,1]
    v_pk_fma_f32 v[54:55], v[52:53], v[46:47], v[54:55] op_sel:[1,1,0] op_sel_hi:[1,0,1] neg_lo:[0,1,0]
    v_pk_mul_f32 v[56:57], v[50:51], v[50:51] op_sel:[0,0] op_sel_hi:[0,1]
    v_pk_fma_f32 v[56:57], v[50:51], v[50:51], v[56:57] op_sel:[1,1,0] op_sel_hi:[1,0,1] neg_lo:[0,1,0]
    v_pk_mul_f32 v[58:59], v[56:57], v[46:47] op_sel:[0,0] op_sel_hi:[0,1]
    v_pk_fma_f32 v[58:59], v[56:57], v[46:47], v[58:59] op_sel:[1,1,0] op_sel_hi:[1,0,1] neg_lo:[0,1,0]
    v_cvt_pk_f16_f32 v29, v42, v43
    v_pk_mul_f32 v[60:61], v[42:43], v[46:47] op_sel:[0,0] op_sel_hi:[0,1]
    v_pk_fma_f32 v[60:61], v[42:43], v[46:47], v[60:61] op_sel:[1,1,0] op_sel_hi:[1,0,1] neg_lo:[0,1,0]
    ds_write_addtid_b32 v29 offset:0
    v_cvt_pk_f16_f32 v26, v60, v61
    v_pk_mul_f32 v[62:63], v[42:43], v[48:49] op_sel:[0,0] op_sel_hi:[0,1]
    v_pk_fma_f32 v[62:63], v[42:43], v[48:49], v[62:63] op_sel:[1,1,0] op_sel_hi:[1,0,1] neg_lo:[0,1,0]
    ds_write_addtid_b32 v26 offset:288
    v_cvt_pk_f16_f32 v27, v62, v63
    v_pk_mul_f32 v[60:61], v[42:43], v[50:51] op_sel:[0,0] op_sel_hi:[0,1]
    v_pk_fma_f32 v[60:61], v[42:43], v[50:51], v[60:61] op_sel:[1,1,0] op_sel_hi:[1,0,1] neg_lo:[0,1,0]
    ds_write_addtid_b32 v27 offset:576
    v_cvt_pk_f16_f32 v28, v60, v61
    v_pk_mul_f32 v[62:63], v[42:43], v[52:53] op_sel:[0,0] op_sel_hi:[0,1]
    v_pk_fma_f32 v[62:63], v[42:43], v[52:53], v[62:63] op_sel:[1,1,0] op_sel_hi:[1,0,1] neg_lo:[0,1,0]
    ds_write_addtid_b32 v28 offset:864
    v_cvt_pk_f16_f32 v29, v62, v63
    v_pk_mul_f32 v[60:61], v[42:43], v[54:55] op_sel:[0,0] op_sel_hi:[0,1]
    v_pk_fma_f32 v[60:61], v[42:43], v[54:55], v[60:61] op_sel:[1,1,0] op_sel_hi:[1,0,1] neg_lo:[0,1,0]
    ds_write_addtid_b32 v29 offset:1152
    v_cvt_pk_f16_f32 v26, v60, v61
    v_pk_mul_f32 v[62:63], v[42:43], v[56:57] op_sel:[0,0] op_sel_hi:[0,1]
    v_pk_fma_f32 v[62:63], v[42:43], v[56:57], v[62:63] op_sel:[1,1,0] op_sel_hi:[1,0,1] neg_lo:[0,1,0]
    ds_write_addtid_b32 v26 offset:1440
    v_cvt_pk_f16_f32 v27, v62, v63
    v_pk_mul_f32 v[60:61], v[42:43], v[58:59] op_sel:[0,0] op_sel_hi:[0,1]
    v_pk_fma_f32 v[60:61], v[42:43], v[58:59], v[60:61] op_sel:[1,1,0] op_sel_hi:[1,0,1] neg_lo:[0,1,0]
    ds_write_addtid_b32 v27 offset:1728
    v_cvt_pk_f16_f32 v28, v60, v61
    v_pk_mul_f32 v[66:67], v[42:43], v[44:45] op_sel:[0,0] op_sel_hi:[0,1]
    v_pk_fma_f32 v[66:67], v[42:43], v[44:45], v[66:67] op_sel:[1,1,0] op_sel_hi:[1,0,1] neg_lo:[0,1,0]
    ds_write_addtid_b32 v28 offset:2016
    v_cvt_pk_f16_f32 v29, v66, v67
    v_pk_mul_f32 v[62:63], v[66:67], v[46:47] op_sel:[0,0] op_sel_hi:[0,1]
    v_pk_fma_f32 v[62:63], v[66:67], v[46:47], v[62:63] op_sel:[1,1,0] op_sel_hi:[1,0,1] neg_lo:[0,1,0]
    ds_write_addtid_b32 v29 offset:2304
    v_cvt_pk_f16_f32 v26, v62, v63
    v_pk_mul_f32 v[60:61], v[66:67], v[48:49] op_sel:[0,0] op_sel_hi:[0,1]
    v_pk_fma_f32 v[60:61], v[66:67], v[48:49], v[60:61] op_sel:[1,1,0] op_sel_hi:[1,0,1] neg_lo:[0,1,0]
    ds_write_addtid_b32 v26 offset:2592
    v_cvt_pk_f16_f32 v27, v60, v61
    v_pk_mul_f32 v[62:63], v[66:67], v[50:51] op_sel:[0,0] op_sel_hi:[0,1]
    v_pk_fma_f32 v[62:63], v[66:67], v[50:51], v[62:63] op_sel:[1,1,0] op_sel_hi:[1,0,1] neg_lo:[0,1,0]
    ds_write_addtid_b32 v27 offset:2880
    v_cvt_pk_f16_f32 v28, v62, v63
    v_pk_mul_f32 v[60:61], v[66:67], v[52:53] op_sel:[0,0] op_sel_hi:[0,1]
    v_pk_fma_f32 v[60:61], v[66:67], v[52:53], v[60:61] op_sel:[1,1,0] op_sel_hi:[1,0,1] neg_lo:[0,1,0]
    ds_write_addtid_b32 v28 offset:3168
    v_cvt_pk_f16_f32 v29, v60, v61
    v_pk_mul_f32 v[62:63], v[66:67], v[54:55] op_sel:[0,0] op_sel_hi:[0,1]
    v_pk_fma_f32 v[62:63], v[66:67], v[54:55], v[62:63] op_sel:[1,1,0] op_sel_hi:[1,0,1] neg_lo:[0,1,0]
    ds_write_addtid_b32 v29 offset:3456
    v_cvt_pk_f16_f32 v26, v62, v63
    v_pk_mul_f32 v[60:61], v[66:67], v[56:57] op_sel:[0,0] op_sel_hi:[0,1]
    v_pk_fma_f32 v[60:61], v[66:67], v[56:57], v[60:61] op_sel:[1,1,0] op_sel_hi:[1,0,1] neg_lo:[0,1,0]
    ds_write_addtid_b32 v26 offset:3744
    v_cvt_pk_f16_f32 v27, v60, v61
    v_pk_mul_f32 v[62:63], v[66:67], v[58:59] op_sel:[0,0] op_sel_hi:[0,1]
    v_pk_fma_f32 v[62:63], v[66:67], v[58:59], v[62:63] op_sel:[1,1,0] op_sel_hi:[1,0,1] neg_lo:[0,1,0]
    ds_write_addtid_b32 v27 offset:4032
    v_cvt_pk_f16_f32 v28, v62, v63
    v_pk_mul_f32 v[68:69], v[66:67], v[44:45] op_sel:[0,0] op_sel_hi:[0,1]
    v_pk_fma_f32 v[68:69], v[66:67], v[44:45], v[68:69] op_sel:[1,1,0] op_sel_hi:[1,0,1] neg_lo:[0,1,0]
    ds_write_addtid_b32 v28 offset:4320
    ds_read_b128 v[88:91], v7 offset:0
    ds_read_b128 v[92:95], v7 offset:64
    ds_read_b128 v[96:99], v7 offset:128
    ds_read_b128 v[100:103], v7 offset:192
    v_cvt_pk_f16_f32 v29, v68, v69
    v_pk_mul_f32 v[60:61], v[68:69], v[48:49] op_sel:[0,0] op_sel_hi:[0,1]
    v_pk_fma_f32 v[60:61], v[68:69], v[48:49], v[60:61] op_sel:[1,1,0] op_sel_hi:[1,0,1] neg_lo:[0,1,0]
    ds_write_addtid_b32 v29 offset:0
    v_cvt_pk_f16_f32 v26, v60, v61
    v_pk_mul_f32 v[62:63], v[68:69], v[52:53] op_sel:[0,0] op_sel_hi:[0,1]
    v_pk_fma_f32 v[62:63], v[68:69], v[52:53], v[62:63] op_sel:[1,1,0] op_sel_hi:[1,0,1] neg_lo:[0,1,0]
    ds_write_addtid_b32 v26 offset:288
    v_cvt_pk_f16_f32 v27, v62, v63
    v_pk_mul_f32 v[60:61], v[68:69], v[56:57] op_sel:[0,0] op_sel_hi:[0,1]
    v_pk_fma_f32 v[60:61], v[68:69], v[56:57], v[60:61] op_sel:[1,1,0] op_sel_hi:[1,0,1] neg_lo:[0,1,0]
    ds_write_addtid_b32 v27 offset:576
    v_cvt_pk_f16_f32 v28, v60, v61
    v_pk_mul_f32 v[66:67], v[68:69], v[44:45] op_sel:[0,0] op_sel_hi:[0,1]
    v_pk_fma_f32 v[66:67], v[68:69], v[44:45], v[66:67] op_sel:[1,1,0] op_sel_hi:[1,0,1] neg_lo:[0,1,0]
    ds_write_addtid_b32 v28 offset:864
    v_cvt_pk_f16_f32 v29, v66, v67
    s_waitcnt lgkmcnt(7)
    v_mfma_f32_16x16x32_f16 v[104:107], v[88:91], v[72:75], 0
    v_pk_mul_f32 v[62:63], v[66:67], v[48:49] op_sel:[0,0] op_sel_hi:[0,1]
    v_pk_fma_f32 v[62:63], v[66:67], v[48:49], v[62:63] op_sel:[1,1,0] op_sel_hi:[1,0,1] neg_lo:[0,1,0]
    ds_write_addtid_b32 v29 offset:1152
    v_cvt_pk_f16_f32 v26, v62, v63
    s_waitcnt lgkmcnt(7)
    v_mfma_f32_16x16x32_f16 v[104:107], v[92:95], v[76:79], v[104:107]
    v_pk_mul_f32 v[60:61], v[66:67], v[52:53] op_sel:[0,0] op_sel_hi:[0,1]
    v_pk_fma_f32 v[60:61], v[66:67], v[52:53], v[60:61] op_sel:[1,1,0] op_sel_hi:[1,0,1] neg_lo:[0,1,0]
    ds_write_addtid_b32 v26 offset:1440
    v_cvt_pk_f16_f32 v27, v60, v61
    s_waitcnt lgkmcnt(7)
    v_mfma_f32_16x16x32_f16 v[104:107], v[96:99], v[80:83], v[104:107]
    v_pk_mul_f32 v[62:63], v[66:67], v[56:57] op_sel:[0,0] op_sel_hi:[0,1]
    v_pk_fma_f32 v[62:63], v[66:67], v[56:57], v[62:63] op_sel:[1,1,0] op_sel_hi:[1,0,1] neg_lo:[0,1,0]
    ds_write_addtid_b32 v27 offset:1728
    v_cvt_pk_f16_f32 v28, v62, v63
    s_waitcnt lgkmcnt(7)
    v_mfma_f32_16x16x32_f16 v[104:107], v[100:103], v[84:87], v[104:107]
    v_pk_mul_f32 v[68:69], v[66:67], v[44:45] op_sel:[0,0] op_sel_hi:[0,1]
    v_pk_fma_f32 v[68:69], v[66:67], v[44:45], v[68:69] op_sel:[1,1,0] op_sel_hi:[1,0,1] neg_lo:[0,1,0]
    ds_write_addtid_b32 v28 offset:2016
    v_cvt_pk_f16_f32 v29, v68, v69
    v_pk_mul_f32 v[60:61], v[68:69], v[52:53] op_sel:[0,0] op_sel_hi:[0,1]
    v_pk_fma_f32 v[60:61], v[68:69], v[52:53], v[60:61] op_sel:[1,1,0] op_sel_hi:[1,0,1] neg_lo:[0,1,0]
    ds_write_addtid_b32 v29 offset:2304
    v_cvt_pk_f16_f32 v26, v60, v61
    v_pk_mul_f32 v[66:67], v[68:69], v[44:45] op_sel:[0,0] op_sel_hi:[0,1]
    v_pk_fma_f32 v[66:67], v[68:69], v[44:45], v[66:67] op_sel:[1,1,0] op_sel_hi:[1,0,1] neg_lo:[0,1,0]
    ds_write_addtid_b32 v26 offset:2592
    v_cvt_pk_f16_f32 v27, v66, v67
    v_pk_mul_f32 v[62:63], v[66:67], v[52:53] op_sel:[0,0] op_sel_hi:[0,1]
    v_pk_fma_f32 v[62:63], v[66:67], v[52:53], v[62:63] op_sel:[1,1,0] op_sel_hi:[1,0,1] neg_lo:[0,1,0]
    ds_write_addtid_b32 v27 offset:2880
    v_cvt_pk_f16_f32 v28, v62, v63
    v_pk_mul_f32 v[68:69], v[66:67], v[44:45] op_sel:[0,0] op_sel_hi:[0,1]
    v_pk_fma_f32 v[68:69], v[66:67], v[44:45], v[68:69] op_sel:[1,1,0] op_sel_hi:[1,0,1] neg_lo:[0,1,0]
    ds_write_addtid_b32 v28 offset:3168
    v_cvt_pk_f16_f32 v29, v68, v69
    v_pk_mul_f32 v[60:61], v[68:69], v[52:53] op_sel:[0,0] op_sel_hi:[0,1]
    v_pk_fma_f32 v[60:61], v[68:69], v[52:53], v[60:61] op_sel:[1,1,0] op_sel_hi:[1,0,1] neg_lo:[0,1,0]
    ds_write_addtid_b32 v29 offset:3456
    v_cvt_pk_f16_f32 v26, v60, v61
    v_pk_mul_f32 v[66:67], v[68:69], v[44:45] op_sel:[0,0] op_sel_hi:[0,1]
    v_pk_fma_f32 v[66:67], v[68:69], v[44:45], v[66:67] op_sel:[1,1,0] op_sel_hi:[1,0,1] neg_lo:[0,1,0]
    ds_write_addtid_b32 v26 offset:3744
    v_cvt_pk_f16_f32 v27, v66, v67
    v_pk_mul_f32 v[62:63], v[66:67], v[52:53] op_sel:[0,0] op_sel_hi:[0,1]
    v_pk_fma_f32 v[62:63], v[66:67], v[52:53], v[62:63] op_sel:[1,1,0] op_sel_hi:[1,0,1] neg_lo:[0,1,0]
    ds_write_addtid_b32 v27 offset:4032
    v_cvt_pk_f16_f32 v28, v62, v63
    v_pk_mul_f32 v[68:69], v[66:67], v[44:45] op_sel:[0,0] op_sel_hi:[0,1]
    v_pk_fma_f32 v[68:69], v[66:67], v[44:45], v[68:69] op_sel:[1,1,0] op_sel_hi:[1,0,1] neg_lo:[0,1,0]
    ds_write_addtid_b32 v28 offset:4320
    ds_read_b128 v[88:91], v7 offset:0
    ds_read_b128 v[92:95], v7 offset:64
    ds_read_b128 v[96:99], v7 offset:128
    ds_read_b128 v[100:103], v7 offset:192
    v_cvt_pk_f16_f32 v29, v68, v69
    v_pk_mul_f32 v[66:67], v[68:69], v[44:45] op_sel:[0,0] op_sel_hi:[0,1]
    v_pk_fma_f32 v[66:67], v[68:69], v[44:45], v[66:67] op_sel:[1,1,0] op_sel_hi:[1,0,1] neg_lo:[0,1,0]
    ds_write_addtid_b32 v29 offset:0
    v_cvt_pk_f16_f32 v26, v66, v67
    v_pk_mul_f32 v[68:69], v[66:67], v[44:45] op_sel:[0,0] op_sel_hi:[0,1]
    v_pk_fma_f32 v[68:69], v[66:67], v[44:45], v[68:69] op_sel:[1,1,0] op_sel_hi:[1,0,1] neg_lo:[0,1,0]
    ds_write_addtid_b32 v26 offset:288
    v_cvt_pk_f16_f32 v27, v68, v69
    v_pk_mul_f32 v[66:67], v[68:69], v[44:45] op_sel:[0,0] op_sel_hi:[0,1]
    v_pk_fma_f32 v[66:67], v[68:69], v[44:45], v[66:67] op_sel:[1,1,0] op_sel_hi:[1,0,1] neg_lo:[0,1,0]
    ds_write_addtid_b32 v27 offset:576
    v_cvt_pk_f16_f32 v28, v66, v67
    v_pk_mul_f32 v[68:69], v[66:67], v[44:45] op_sel:[0,0] op_sel_hi:[0,1]
    v_pk_fma_f32 v[68:69], v[66:67], v[44:45], v[68:69] op_sel:[1,1,0] op_sel_hi:[1,0,1] neg_lo:[0,1,0]
    ds_write_addtid_b32 v28 offset:864
    v_cvt_pk_f16_f32 v29, v68, v69
    v_pk_mul_f32 v[66:67], v[68:69], v[44:45] op_sel:[0,0] op_sel_hi:[0,1]
    v_pk_fma_f32 v[66:67], v[68:69], v[44:45], v[66:67] op_sel:[1,1,0] op_sel_hi:[1,0,1] neg_lo:[0,1,0]
    s_waitcnt lgkmcnt(7)
    v_mfma_f32_16x16x32_f16 v[108:111], v[88:91], v[72:75], 0
    ds_write_addtid_b32 v29 offset:1152
    v_cvt_pk_f16_f32 v26, v66, v67
    v_pk_mul_f32 v[68:69], v[66:67], v[44:45] op_sel:[0,0] op_sel_hi:[0,1]
    v_pk_fma_f32 v[68:69], v[66:67], v[44:45], v[68:69] op_sel:[1,1,0] op_sel_hi:[1,0,1] neg_lo:[0,1,0]
    s_waitcnt lgkmcnt(7)
    v_mfma_f32_16x16x32_f16 v[108:111], v[92:95], v[76:79], v[108:111]
    ds_write_addtid_b32 v26 offset:1440
    v_cvt_pk_f16_f32 v27, v68, v69
    v_pk_mul_f32 v[66:67], v[68:69], v[44:45] op_sel:[0,0] op_sel_hi:[0,1]
    v_pk_fma_f32 v[66:67], v[68:69], v[44:45], v[66:67] op_sel:[1,1,0] op_sel_hi:[1,0,1] neg_lo:[0,1,0]
    s_waitcnt lgkmcnt(7)
    v_mfma_f32_16x16x32_f16 v[108:111], v[96:99], v[80:83], v[108:111]
    ds_write_addtid_b32 v27 offset:1728
    v_cvt_pk_f16_f32 v28, v66, v67
    v_pk_mul_f32 v[68:69], v[66:67], v[44:45] op_sel:[0,0] op_sel_hi:[0,1]
    v_pk_fma_f32 v[68:69], v[66:67], v[44:45], v[68:69] op_sel:[1,1,0] op_sel_hi:[1,0,1] neg_lo:[0,1,0]
    s_waitcnt lgkmcnt(7)
    v_mfma_f32_16x16x32_f16 v[108:111], v[100:103], v[84:87], v[108:111]
    ds_write_addtid_b32 v28 offset:2016
    v_cvt_pk_f16_f32 v29, v68, v69
    ds_write_addtid_b32 v29 offset:2304
    ds_read_b128 v[88:91], v7 offset:0
    ds_read_b128 v[92:95], v7 offset:64
    ds_read_b128 v[96:99], v7 offset:128
    ds_read_b128 v[100:103], v7 offset:192
    v_lshl_add_u32 v8, v2, 4, s15
    s_waitcnt lgkmcnt(3)
    v_mfma_f32_16x16x32_f16 v[112:115], v[88:91], v[72:75], 0
    s_waitcnt lgkmcnt(2)
    v_mfma_f32_16x16x32_f16 v[112:115], v[92:95], v[76:79], v[112:115]
    s_waitcnt lgkmcnt(1)
    v_mfma_f32_16x16x32_f16 v[112:115], v[96:99], v[80:83], v[112:115]
    s_waitcnt lgkmcnt(0)
    v_mfma_f32_16x16x32_f16 v[112:115], v[100:103], v[84:87], v[112:115]
    s_lshl_b32 s8, s12, 2
    s_add_u32 s8, s8, 16
    v_mov_b32 v9, s8
    s_cmp_eq_u32 s13, 0
    s_cbranch_scc1 C_KA
    ds_write_b128 v8, v[104:107] offset:0
    ds_write_b128 v8, v[108:111] offset:1024
    s_nop 0
    ds_write_b128 v8, v[112:115] offset:2048
    v_mov_b32 v10, s54
    ds_write_b32 v9, v10
    v_add_u32 v9, 48, v9
    s_setprio 0
    s_mov_b32 s9, 0
SP_23:
    ds_read_b32 v10, v9
    s_waitcnt lgkmcnt(0)
    v_readfirstlane_b32 s8, v10
    s_add_u32 s9, s9, 1
    s_cmp_lg_u32 s8, 0
    s_cbranch_scc1 SP_23_D
    s_sleep 1
    s_cmp_lt_u32 s9, 524288
    s_cbranch_scc1 SP_23
SP_23_D:
    s_setprio 2
    s_branch C_KDONE
C_KA:
    s_lshl_b32 s8, s12, 4
    s_lshr_b64 s[68:69], s[68:69], s8
    s_lshl_b32 s68, s68, 16
    s_sub_u32 s58, 254, s54
    s_lshl_b32 s58, s58, 23
    v_mul_f32 v104, s58, v104
    v_mul_f32 v105, s58, v105
    v_mul_f32 v106, s58, v106
    v_mul_f32 v107, s58, v107
    v_mul_f32 v108, s58, v108
    v_mul_f32 v109, s58, v109
    v_mul_f32 v110, s58, v110
    v_mul_f32 v111, s58, v111
    v_mul_f32 v112, s58, v112
    v_mul_f32 v113, s58, v113
    v_mul_f32 v114, s58, v114
    v_mul_f32 v115, s58, v115
    s_mov_b64 exec, 1
    v_add_f32 v104, s68, v104
    s_mov_b64 exec, -1
    s_setprio 0
    s_mov_b32 s9, 0
SP_24:
    ds_read_b32 v18, v9
    s_waitcnt lgkmcnt(0)
    v_readfirstlane_b32 s8, v18
    s_add_u32 s9, s9, 1
    s_cmp_lg_u32 s8, 0
    s_cbranch_scc1 SP_24_D
    s_cmp_lt_u32 s9, 524288
    s_cbranch_scc1 SP_24
SP_24_D:
    s_setprio 2
    s_sub_u32 s60, 254, s8
    s_lshl_b32 s60, s60, 23
    ds_read_b128 v[88:91], v8 offset:18432
    ds_read_b128 v[92:95], v8 offset:19456
    ds_read_b128 v[96:99], v8 offset:20480
    s_waitcnt lgkmcnt(2)
    v_pk_fma_f32 v[104:105], v[88:89], s[60:61], v[104:105] op_sel_hi:[1,0,1]
    v_cvt_pk_bf16_f32 v20, v104, v105
    v_pk_fma_f32 v[106:107], v[90:91], s[60:61], v[106:107] op_sel_hi:[1,0,1]
    v_cvt_pk_bf16_f32 v21, v106, v107
    ds_write_b64 v116, v[20:21]
    s_waitcnt lgkmcnt(2)
    v_pk_fma_f32 v[108:109], v[92:93], s[60:61], v[108:109] op_sel_hi:[1,0,1]
    v_cvt_pk_bf16_f32 v22, v108, v109
    v_pk_fma_f32 v[110:111], v[94:95], s[60:61], v[110:111] op_sel_hi:[1,0,1]
    v_cvt_pk_bf16_f32 v23, v110, v111
    ds_write_b32 v117, v22 offset:512
    ds_write_b32 v118, v23 offset:512
    s_waitcnt lgkmcnt(3)
    v_pk_fma_f32 v[112:113], v[96:97], s[60:61], v[112:113] op_sel_hi:[1,0,1]
    v_cvt_pk_bf16_f32 v24, v112, v113
    v_pk_fma_f32 v[114:115], v[98:99], s[60:61], v[114:115] op_sel_hi:[1,0,1]
    v_cvt_pk_bf16_f32 v25, v114, v115
    ds_write_b16 v119, v24 offset:1024
    ds_read_b64 v[32:33], v120 offset:0
    ds_read_b64 v[34:35], v120 offset:8
    ds_read_b64 v[36:37], v120 offset:16
    ds_read_b64 v[38:39], v120 offset:24
    ds_write_b16 v119, v24 offset:2110
    ds_write_b16_d16_hi v119, v24 offset:2142
    ds_write_b16 v119, v25 offset:2174
    ds_write_b16_d16_hi v119, v25 offset:2206
    ds_write_b32 v121, v1 offset:2048
    ds_read2_b32 v[150:151], v122 offset0:3 offset1:2
    ds_read2_b32 v[152:153], v122 offset0:1 offset1:0
    ds_read2_b32 v[154:155], v122 offset0:19 offset1:18
    ds_read2_b32 v[156:157], v122 offset0:17 offset1:16
    ds_read2_b32 v[158:159], v122 offset0:35 offset1:34
    ds_read2_b32 v[160:161], v122 offset0:33 offset1:32
    ds_read2_b32 v[162:163], v122 offset0:51 offset1:50
    ds_read2_b32 v[164:165], v122 offset0:49 offset1:48
    s_mov_b32 exec_lo, 0xffff0000
    s_mov_b32 exec_hi, 0
    s_waitcnt lgkmcnt(13)
    v_alignbit_b32 v39, v36, v35, 16
    v_perm_b32 v38, v35, v35, s56
    v_alignbit_b32 v37, v35, v34, 16
    v_perm_b32 v36, v34, v34, s56
    v_alignbit_b32 v35, v34, v33, 16
    v_perm_b32 v34, v33, v33, s56
    v_alignbit_b32 v33, v33, v32, 16
    v_perm_b32 v32, v32, v32, s56
    s_mov_b32 exec_lo, 0
    s_mov_b32 exec_hi, -1
    v_perm_b32 v39, v34, v34, s56
    v_perm_b32 v38, v33, v33, s57
    v_mov_b32 v37, v33
    v_perm_b32 v36, v33, v33, s56
    v_perm_b32 v35, v33, v33, s56
    v_perm_b32 v34, v32, v32, s57
    v_mov_b32 v33, v32
    v_perm_b32 v32, v32, v32, s56
    s_mov_b64 exec, -1
    ds_write_b128 v123, v[32:35] offset:32
    ds_write_b128 v123, v[36:39] offset:48
    v_mov_b32_dpp v30, v38 wave_shr:1 row_mask:0xf bank_mask:0xf bound_ctrl:0
    v_mov_b32_dpp v31, v39 wave_shr:1 row_mask:0xf bank_mask:0xf bound_ctrl:0
    v_alignbit_b32 v44, v32, v31, 16
    v_alignbit_b32 v45, v33, v32, 16
    v_alignbit_b32 v46, v34, v33, 16
    v_alignbit_b32 v47, v35, v34, 16
    ds_write_b128 v123, v[44:47] offset:2272
    v_alignbit_b32 v48, v36, v35, 16
    v_alignbit_b32 v49, v37, v36, 16
    v_alignbit_b32 v50, v38, v37, 16
    v_alignbit_b32 v51, v39, v38, 16
    ds_write_b128 v123, v[48:51] offset:2288
    v_pk_mov_b32 v[52:53], v[30:31], v[32:33] op_sel:[1,0]
    v_pk_mov_b32 v[54:55], v[32:33], v[34:35] op_sel:[1,0]
    ds_write_b128 v123, v[52:55] offset:4512
    v_pk_mov_b32 v[56:57], v[34:35], v[36:37] op_sel:[1,0]
    v_pk_mov_b32 v[58:59], v[36:37], v[38:39] op_sel:[1,0]
    ds_write_b128 v123, v[56:59] offset:4528
    v_alignbit_b32 v60, v31, v30, 16
    v_alignbit_b32 v61, v32, v31, 16
    v_alignbit_b32 v62, v33, v32, 16
    v_alignbit_b32 v63, v34, v33, 16
    ds_write_b128 v123, v[60:63] offset:6752
    v_alignbit_b32 v64, v35, v34, 16
    v_alignbit_b32 v65, v36, v35, 16
    v_alignbit_b32 v66, v37, v36, 16
    v_alignbit_b32 v67, v38, v37, 16
    ds_write_b128 v123, v[64:67] offset:6768
    v_alignbit_b32 v72, v39, v38, 16
    v_mov_b32 v73, v39
    v_mov_b32 v74, v39
    v_mov_b32 v75, v39
    v_mov_b32 v78, v39
    v_mov_b32 v79, v39
    v_mov_b32 v80, v39
    v_mov_b32 v82, v39
    v_mov_b32 v83, v39
    v_mov_b32 v84, v39
    v_and_b32 v76, 0xffff, v39
    v_and_b32 v81, 0xffff, v39
    v_mov_b32 v77, 0
    v_mov_b32 v85, 0
    s_mov_b32 exec_lo, 0
    s_mov_b32 exec_hi, 0x80000000
    ds_write_b128 v123, v[72:75] offset:6784
    ds_write_b128 v123, v[74:77] offset:64
    ds_write_b128 v123, v[78:81] offset:4544
    ds_write_b128 v123, v[82:85] offset:2304
    s_mov_b64 exec, -1
    v_mov_b32 v10, s54
    ds_write_b32 v9, v10 offset:48
C_KDONE:
    s_setprio 0
    s_mov_b32 s9, 0
SP_25:
    ds_read_b32 v10, v1 offset:80
    s_waitcnt lgkmcnt(0)
    v_readfirstlane_b32 s8, v10
    s_add_u32 s9, s9, 1
    s_cmp_ge_u32 s8, 1
    s_cbranch_scc1 SP_25_D
    s_sleep 1
    s_cmp_lt_u32 s9, 524288
    s_cbranch_scc1 SP_25
SP_25_D:
    s_setprio 2
    s_cmp_eq_u32 s13, 0
    s_cbranch_scc1 C_G1
    s_cmp_lt_u32 s3, 5
    s_cbranch_scc1 C_NOG
    global_load_dwordx2 v[150:151], v166, s[50:51] offset:0 sc1
    global_load_dwordx2 v[152:153], v166, s[50:51] offset:256 sc1
    global_load_dwordx2 v[154:155], v166, s[50:51] offset:512 sc1
C_NOG:
    s_setprio 2
    ds_read_b64 v[32:33], v5 offset:0
    ds_read_b64 v[34:35], v5 offset:8
    ds_read_b128 v[60:63], v6 offset:2048
    ds_read_b128 v[56:59], v6 offset:2560
    ds_read_b128 v[52:55], v6 offset:3072
    ds_read_b128 v[48:51], v6 offset:3584
    ds_read_b64 v[36:37], v5 offset:512
    ds_read_b64 v[38:39], v5 offset:520
    ds_read_b64 v[40:41], v5 offset:1024
    ds_read_b64 v[42:43], v5 offset:1032
    ds_read_b64 v[44:45], v5 offset:1536
    ds_read_b64 v[46:47], v5 offset:1544
    s_waitcnt lgkmcnt(9)
    v_mfma_f32_16x16x32_bf16 v[28:31], v[32:35], v[60:63], 0
    ds_read_b64 v[64:65], v5 offset:64
    ds_read_b64 v[66:67], v5 offset:72
    s_waitcnt lgkmcnt(10)
    v_mfma_f32_16x16x32_bf16 v[24:27], v[32:35], v[56:59], 0
    ds_read_b128 v[92:95], v6 offset:2112
    s_waitcnt lgkmcnt(10)
    v_mfma_f32_16x16x32_bf16 v[20:23], v[32:35], v[52:55], 0
    ds_read_b128 v[88:91], v6 offset:2624
    s_waitcnt lgkmcnt(10)
    v_mfma_f32_16x16x32_bf16 v[16:19], v[32:35], v[48:51], 0
    ds_read_b128 v[84:87], v6 offset:3136
    s_waitcnt lgkmcnt(9)
    v_mfma_f32_16x16x32_bf16 v[28:31], v[36:39], v[56:59], v[28:31]
    ds_read_b128 v[80:83], v6 offset:3648
    v_mfma_f32_16x16x32_bf16 v[24:27], v[36:39], v[52:55], v[24:27]
    ds_read_b64 v[68:69], v5 offset:576
    ds_read_b64 v[70:71], v5 offset:584
    v_mfma_f32_16x16x32_bf16 v[20:23], v[36:39], v[48:51], v[20:23]
    ds_read_b64 v[72:73], v5 offset:1088
    s_waitcnt lgkmcnt(11)
    v_mfma_f32_16x16x32_bf16 v[28:31], v[40:43], v[52:55], v[28:31]
    ds_read_b64 v[74:75], v5 offset:1096
    v_mfma_f32_16x16x32_bf16 v[24:27], v[40:43], v[48:51], v[24:27]
    ds_read_b64 v[76:77], v5 offset:1600
    s_waitcnt lgkmcnt(11)
    v_mfma_f32_16x16x32_bf16 v[28:31], v[44:47], v[48:51], v[28:31]
    ds_read_b64 v[78:79], v5 offset:1608
    s_waitcnt lgkmcnt(6)
    v_mfma_f32_16x16x32_bf16 v[28:31], v[64:67], v[92:95], v[28:31]
    ds_read_b64 v[32:33], v5 offset:128
    ds_read_b64 v[34:35], v5 offset:136
    v_mfma_f32_16x16x32_bf16 v[24:27], v[64:67], v[88:91], v[24:27]
    ds_read_b128 v[60:63], v6 offset:2176
    v_mfma_f32_16x16x32_bf16 v[20:23], v[64:67], v[84:87], v[20:23]
    ds_read_b128 v[56:59], v6 offset:2688
    v_mfma_f32_16x16x32_bf16 v[16:19], v[64:67], v[80:83], v[16:19]
    ds_read_b128 v[52:55], v6 offset:3200
    s_waitcnt lgkmcnt(9)
    v_mfma_f32_16x16x32_bf16 v[28:31], v[68:71], v[88:91], v[28:31]
    ds_read_b128 v[48:51], v6 offset:3712
    v_mfma_f32_16x16x32_bf16 v[24:27], v[68:71], v[84:87], v[24:27]
    ds_read_b64 v[36:37], v5 offset:640
    ds_read_b64 v[38:39], v5 offset:648
    v_mfma_f32_16x16x32_bf16 v[20:23], v[68:71], v[80:83], v[20:23]
    ds_read_b64 v[40:41], v5 offset:1152
    s_waitcnt lgkmcnt(11)
    v_mfma_f32_16x16x32_bf16 v[28:31], v[72:75], v[84:87], v[28:31]
    ds_read_b64 v[42:43], v5 offset:1160
    v_mfma_f32_16x16x32_bf16 v[24:27], v[72:75], v[80:83], v[24:27]
    ds_read_b64 v[44:45], v5 offset:1664
    s_waitcnt lgkmcnt(11)
    v_mfma_f32_16x16x32_bf16 v[28:31], v[76:79], v[80:83], v[28:31]
    ds_read_b64 v[46:47], v5 offset:1672
    s_waitcnt lgkmcnt(6)
    v_mfma_f32_16x16x32_bf16 v[28:31], v[32:35], v[60:63], v[28:31]
    ds_read_b64 v[64:65], v5 offset:192
    ds_read_b64 v[66:67], v5 offset:200
    v_mfma_f32_16x16x32_bf16 v[24:27], v[32:35], v[56:59], v[24:27]
    ds_read_b128 v[92:95], v6 offset:2240
    v_mfma_f32_16x16x32_bf16 v[20:23], v[32:35], v[52:55], v[20:23]
    ds_read_b128 v[88:91], v6 offset:2752
    v_mfma_f32_16x16x32_bf16 v[16:19], v[32:35], v[48:51], v[16:19]
    ds_read_b128 v[84:87], v6 offset:3264
    s_waitcnt lgkmcnt(9)
    v_mfma_f32_16x16x32_bf16 v[28:31], v[36:39], v[56:59], v[28:31]
    ds_read_b128 v[80:83], v6 offset:3776
    v_mfma_f32_16x16x32_bf16 v[24:27], v[36:39], v[52:55], v[24:27]
    ds_read_b64 v[68:69], v5 offset:704
    ds_read_b64 v[70:71], v5 offset:712
    v_mfma_f32_16x16x32_bf16 v[20:23], v[36:39], v[48:51], v[20:23]
    ds_read_b64 v[72:73], v5 offset:1216
    s_waitcnt lgkmcnt(11)
    v_mfma_f32_16x16x32_bf16 v[28:31], v[40:43], v[52:55], v[28:31]
    ds_read_b64 v[74:75], v5 offset:1224
    v_mfma_f32_16x16x32_bf16 v[24:27], v[40:43], v[48:51], v[24:27]
    ds_read_b64 v[76:77], v5 offset:1728
    s_waitcnt lgkmcnt(11)
    v_mfma_f32_16x16x32_bf16 v[28:31], v[44:47], v[48:51], v[28:31]
    ds_read_b64 v[78:79], v5 offset:1736
    s_waitcnt lgkmcnt(6)
    v_mfma_f32_16x16x32_bf16 v[28:31], v[64:67], v[92:95], v[28:31]
    ds_read_b64 v[32:33], v5 offset:256
    ds_read_b64 v[34:35], v5 offset:264
    v_mfma_f32_16x16x32_bf16 v[24:27], v[64:67], v[88:91], v[24:27]
    ds_read_b128 v[60:63], v6 offset:2304
    v_mfma_f32_16x16x32_bf16 v[20:23], v[64:67], v[84:87], v[20:23]
    ds_read_b128 v[56:59], v6 offset:2816
    v_mfma_f32_16x16x32_bf16 v[16:19], v[64:67], v[80:83], v[16:19]
    ds_read_b128 v[52:55], v6 offset:3328
    s_waitcnt lgkmcnt(9)
    v_mfma_f32_16x16x32_bf16 v[28:31], v[68:71], v[88:91], v[28:31]
    ds_read_b128 v[48:51], v6 offset:3840
    v_mfma_f32_16x16x32_bf16 v[24:27], v[68:71], v[84:87], v[24:27]
    ds_read_b64 v[36:37], v5 offset:768
    ds_read_b64 v[38:39], v5 offset:776
    v_mfma_f32_16x16x32_bf16 v[20:23], v[68:71], v[80:83], v[20:23]
    ds_read_b64 v[40:41], v5 offset:1280
    s_waitcnt lgkmcnt(11)
    v_mfma_f32_16x16x32_bf16 v[28:31], v[72:75], v[84:87], v[28:31]
    ds_read_b64 v[42:43], v5 offset:1288
    v_mfma_f32_16x16x32_bf16 v[24:27], v[72:75], v[80:83], v[24:27]
    ds_read_b64 v[44:45], v5 offset:1792
    s_waitcnt lgkmcnt(11)
    v_mfma_f32_16x16x32_bf16 v[28:31], v[76:79], v[80:83], v[28:31]
    ds_read_b64 v[46:47], v5 offset:1800
    s_waitcnt lgkmcnt(6)
    v_mfma_f32_16x16x32_bf16 v[28:31], v[32:35], v[60:63], v[28:31]
    ds_read_b64 v[64:65], v5 offset:320
    ds_read_b64 v[66:67], v5 offset:328
    v_mfma_f32_16x16x32_bf16 v[24:27], v[32:35], v[56:59], v[24:27]
    ds_read_b128 v[92:95], v6 offset:2368
    v_mfma_f32_16x16x32_bf16 v[20:23], v[32:35], v[52:55], v[20:23]
    ds_read_b128 v[88:91], v6 offset:2880
    v_mfma_f32_16x16x32_bf16 v[16:19], v[32:35], v[48:51], v[16:19]
    ds_read_b128 v[84:87], v6 offset:3392
    s_waitcnt lgkmcnt(9)
    v_mfma_f32_16x16x32_bf16 v[28:31], v[36:39], v[56:59], v[28:31]
    ds_read_b128 v[80:83], v6 offset:3904
    v_mfma_f32_16x16x32_bf16 v[24:27], v[36:39], v[52:55], v[24:27]
    ds_read_b64 v[68:69], v5 offset:832
    ds_read_b64 v[70:71], v5 offset:840
    v_mfma_f32_16x16x32_bf16 v[20:23], v[36:39], v[48:51], v[20:23]
    ds_read_b64 v[72:73], v5 offset:1344
    s_waitcnt lgkmcnt(11)
    v_mfma_f32_16x16x32_bf16 v[28:31], v[40:43], v[52:55], v[28:31]
    ds_read_b64 v[74:75], v5 offset:1352
    v_mfma_f32_16x16x32_bf16 v[24:27], v[40:43], v[48:51], v[24:27]
    ds_read_b64 v[76:77], v5 offset:1856
    s_waitcnt lgkmcnt(11)
    v_mfma_f32_16x16x32_bf16 v[28:31], v[44:47], v[48:51], v[28:31]
    ds_read_b64 v[78:79], v5 offset:1864
    s_waitcnt lgkmcnt(6)
    v_mfma_f32_16x16x32_bf16 v[28:31], v[64:67], v[92:95], v[28:31]
    ds_read_b64 v[32:33], v5 offset:384
    ds_read_b64 v[34:35], v5 offset:392
    v_mfma_f32_16x16x32_bf16 v[24:27], v[64:67], v[88:91], v[24:27]
    ds_read_b128 v[60:63], v6 offset:2432
    v_mfma_f32_16x16x32_bf16 v[20:23], v[64:67], v[84:87], v[20:23]
    ds_read_b128 v[56:59], v6 offset:2944
    v_mfma_f32_16x16x32_bf16 v[16:19], v[64:67], v[80:83], v[16:19]
    ds_read_b128 v[52:55], v6 offset:3456
    s_waitcnt lgkmcnt(9)
    v_mfma_f32_16x16x32_bf16 v[28:31], v[68:71], v[88:91], v[28:31]
    ds_read_b128 v[48:51], v6 offset:3968
    v_mfma_f32_16x16x32_bf16 v[24:27], v[68:71], v[84:87], v[24:27]
    ds_read_b64 v[36:37], v5 offset:896
    ds_read_b64 v[38:39], v5 offset:904
    v_mfma_f32_16x16x32_bf16 v[20:23], v[68:71], v[80:83], v[20:23]
    ds_read_b64 v[40:41], v5 offset:1408
    s_waitcnt lgkmcnt(11)
    v_mfma_f32_16x16x32_bf16 v[28:31], v[72:75], v[84:87], v[28:31]
    ds_read_b64 v[42:43], v5 offset:1416
    v_mfma_f32_16x16x32_bf16 v[24:27], v[72:75], v[80:83], v[24:27]
    ds_read_b64 v[44:45], v5 offset:1920
    s_waitcnt lgkmcnt(11)
    v_mfma_f32_16x16x32_bf16 v[28:31], v[76:79], v[80:83], v[28:31]
    ds_read_b64 v[46:47], v5 offset:1928
    s_waitcnt lgkmcnt(6)
    v_mfma_f32_16x16x32_bf16 v[28:31], v[32:35], v[60:63], v[28:31]
    ds_read_b64 v[64:65], v5 offset:448
    ds_read_b64 v[66:67], v5 offset:456
    v_mfma_f32_16x16x32_bf16 v[24:27], v[32:35], v[56:59], v[24:27]
    ds_read_b128 v[92:95], v6 offset:2496
    v_mfma_f32_16x16x32_bf16 v[20:23], v[32:35], v[52:55], v[20:23]
    ds_read_b128 v[88:91], v6 offset:3008
    v_mfma_f32_16x16x32_bf16 v[16:19], v[32:35], v[48:51], v[16:19]
    ds_read_b128 v[84:87], v6 offset:3520
    s_waitcnt lgkmcnt(9)
    v_mfma_f32_16x16x32_bf16 v[28:31], v[36:39], v[56:59], v[28:31]
    ds_read_b128 v[80:83], v6 offset:4032
    v_mfma_f32_16x16x32_bf16 v[24:27], v[36:39], v[52:55], v[24:27]
    ds_read_b64 v[68:69], v5 offset:960
    ds_read_b64 v[70:71], v5 offset:968
    v_mfma_f32_16x16x32_bf16 v[20:23], v[36:39], v[48:51], v[20:23]
    ds_read_b64 v[72:73], v5 offset:1472
    s_waitcnt lgkmcnt(11)
    v_mfma_f32_16x16x32_bf16 v[28:31], v[40:43], v[52:55], v[28:31]
    ds_read_b64 v[74:75], v5 offset:1480
    v_mfma_f32_16x16x32_bf16 v[24:27], v[40:43], v[48:51], v[24:27]
    ds_read_b64 v[76:77], v5 offset:1984
    s_waitcnt lgkmcnt(11)
    v_mfma_f32_16x16x32_bf16 v[28:31], v[44:47], v[48:51], v[28:31]
    ds_read_b64 v[78:79], v5 offset:1992
    s_waitcnt lgkmcnt(6)
    v_mfma_f32_16x16x32_bf16 v[28:31], v[64:67], v[92:95], v[28:31]
    v_mfma_f32_16x16x32_bf16 v[24:27], v[64:67], v[88:91], v[24:27]
    v_mfma_f32_16x16x32_bf16 v[20:23], v[64:67], v[84:87], v[20:23]
    v_mfma_f32_16x16x32_bf16 v[16:19], v[64:67], v[80:83], v[16:19]
    s_waitcnt lgkmcnt(4)
    v_mfma_f32_16x16x32_bf16 v[28:31], v[68:71], v[88:91], v[28:31]
    v_mfma_f32_16x16x32_bf16 v[24:27], v[68:71], v[84:87], v[24:27]
    v_mfma_f32_16x16x32_bf16 v[20:23], v[68:71], v[80:83], v[20:23]
    s_waitcnt lgkmcnt(2)
    v_mfma_f32_16x16x32_bf16 v[28:31], v[72:75], v[84:87], v[28:31]
    v_mfma_f32_16x16x32_bf16 v[24:27], v[72:75], v[80:83], v[24:27]
    s_waitcnt lgkmcnt(0)
    v_mfma_f32_16x16x32_bf16 v[28:31], v[76:79], v[80:83], v[28:31]
    v_cvt_pk_bf16_f32 v32, v19, v18
    v_cvt_pk_bf16_f32 v33, v17, v16
    ds_write_b64 v140, v[32:33] offset:3584
    v_cvt_pk_bf16_f32 v34, v23, v22
    v_cvt_pk_bf16_f32 v35, v21, v20
    ds_write_b64 v140, v[34:35] offset:3072
    v_cvt_pk_bf16_f32 v36, v27, v26
    v_cvt_pk_bf16_f32 v37, v25, v24
    ds_write_b64 v140, v[36:37] offset:2560
    v_cvt_pk_bf16_f32 v38, v31, v30
    v_cvt_pk_bf16_f32 v39, v29, v28
    ds_write_b64 v140, v[38:39] offset:2048
    v_mov_b32 v8, 1
    s_mov_b64 exec, 1
    ds_add_u32 v1, v8 offset:32
    s_mov_b64 exec, -1
    ds_read_b32 v10, v1 offset:0
    s_cmp_eq_u32 s3, 4
    s_cbranch_scc1 C_FIN
    s_mov_b32 s60, s46
    s_mov_b32 s61, s47
    s_mov_b32 s62, 2359296
    s_mov_b32 s63, 0x20000
    s_setprio 0
    s_mov_b32 s9, 0
SP_26:
    ds_read_b32 v12, v1 offset:84
    s_waitcnt lgkmcnt(0)
    v_readfirstlane_b32 s8, v12
    s_add_u32 s9, s9, 1
    s_cmp_ge_u32 s8, 1
    s_cbranch_scc1 SP_26_D
    s_sleep 1
    s_cmp_lt_u32 s9, 524288
    s_cbranch_scc1 SP_26
SP_26_D:
    s_setprio 3
    v_bfe_u32 v12, v2, 2, 2
    v_mul_u32_u24 v12, 4672, v12
    v_and_b32 v13, 3, v2
    v_lshl_add_u32 v13, v4, 2, v13
    v_lshl_add_u32 v12, v13, 3, v12
    s_lshl_b32 s8, s14, 7
    s_sub_u32 s8, 76672, s8
    v_add_u32 v12, s8, v12
    ds_read_b64_tr_b16 v[44:45], v12 offset:256
    ds_read_b64_tr_b16 v[50:51], v12 offset:128
    ds_read_b64_tr_b16 v[56:57], v12 offset:0
    s_waitcnt lgkmcnt(0)
    v_lshlrev_b32 v40, 16, v44
    v_and_b32 v41, 0xffff0000, v44
    v_lshlrev_b32 v42, 16, v45
    v_and_b32 v43, 0xffff0000, v45
    v_lshlrev_b32 v46, 16, v50
    v_and_b32 v47, 0xffff0000, v50
    v_lshlrev_b32 v48, 16, v51
    v_and_b32 v49, 0xffff0000, v51
    v_lshlrev_b32 v52, 16, v56
    v_and_b32 v53, 0xffff0000, v56
    v_lshlrev_b32 v54, 16, v57
    v_and_b32 v55, 0xffff0000, v57
    s_mov_b32 s9, 0
GP_27:
    s_waitcnt vmcnt(0)
    v_xor_b32 v14, v151, v10
    v_bitop3_b32 v14, v14, v153, v10 bitop3:0xf6
    v_bitop3_b32 v14, v14, v155, v10 bitop3:0xf6
    v_cmp_ne_u32 vcc, 0, v14
    s_add_u32 s9, s9, 1
    s_cmp_eq_u64 vcc, 0
    s_cbranch_scc1 GP_27_D
    s_cmp_ge_u32 s9, 131072
    s_cbranch_scc1 GP_27_D
    global_load_dwordx2 v[150:151], v166, s[50:51] offset:0 sc1
    global_load_dwordx2 v[152:153], v166, s[50:51] offset:256 sc1
    global_load_dwordx2 v[154:155], v166, s[50:51] offset:512 sc1
    s_branch GP_27
GP_27_D:
    v_and_b32 v11, 1, v2
    v_lshlrev_b32 v11, 4, v11
    s_lshl_b32 s8, s14, 8
    s_add_u32 s8, s8, 91648
    v_xor_b32 v12, 63, v2
    v_lshl_add_u32 v12, v12, 2, s8
    v_lshlrev_b32 v44, v11, v150
    v_lshlrev_b32 v50, v11, v152
    v_lshlrev_b32 v56, v11, v154
    v_and_b32 v44, 0xffff0000, v44
    v_and_b32 v50, 0xffff0000, v50
    v_and_b32 v56, 0xffff0000, v56
    v_sub_f32 v45, 1.0, v44
    v_sub_f32 v51, 1.0, v50
    v_sub_f32 v57, 1.0, v56
    v_cvt_pk_bf16_f32 v45, v45, v45
    v_cvt_pk_bf16_f32 v51, v51, v51
    v_cvt_pk_bf16_f32 v57, v57, v57
    v_and_b32 v45, 0xffff0000, v45
    v_and_b32 v51, 0xffff0000, v51
    v_and_b32 v57, 0xffff0000, v57
    v_mul_f32 v40, v40, v45
    v_mul_f32 v41, v41, v45
    v_mul_f32 v42, v42, v45
    v_mul_f32 v43, v43, v45
    ds_write_b32 v12, v44 offset:0
    v_mul_f32 v46, v46, v51
    v_mul_f32 v47, v47, v51
    v_mul_f32 v48, v48, v51
    v_mul_f32 v49, v49, v51
    ds_write_b32 v12, v50 offset:256
    v_mul_f32 v52, v52, v57
    v_mul_f32 v53, v53, v57
    v_mul_f32 v54, v54, v57
    v_mul_f32 v55, v55, v57
    ds_write_b32 v12, v56 offset:512
    v_bfe_u32 v12, v2, 2, 2
    v_mul_u32_u24 v12, 4160, v12
    v_and_b32 v13, 3, v2
    v_lshl_add_u32 v13, v4, 2, v13
    v_lshl_add_u32 v12, v13, 3, v12
    s_lshl_b32 s8, s14, 7
    s_sub_u32 s8, 103552, s8
    v_add_u32 v12, s8, v12
    v_xor_b32 v14, 63, v2
    v_mul_u32_u24 v14, 1152, v14
    v_add_u32 v14, s55, v14
    s_mul_i32 s15, s14, 73728
    s_setprio 0
    s_mov_b32 s9, 0
SP_28:
    ds_read_b32 v15, v1 offset:36
    s_waitcnt lgkmcnt(0)
    v_readfirstlane_b32 s8, v15
    s_add_u32 s9, s9, 1
    s_cmp_ge_u32 s8, 4
    s_cbranch_scc1 SP_28_D
    s_sleep 2
    s_cmp_lt_u32 s9, 524288
    s_cbranch_scc1 SP_28
SP_28_D:
    s_setprio 3
    ds_read_b64_tr_b16 v[16:17], v12 offset:256
    ds_read_b64_tr_b16 v[18:19], v12 offset:128
    ds_read_b64_tr_b16 v[20:21], v12 offset:0
    s_waitcnt lgkmcnt(2)
    v_lshlrev_b32 v24, 16, v16
    v_and_b32 v25, 0xffff0000, v16
    v_lshlrev_b32 v26, 16, v17
    v_and_b32 v27, 0xffff0000, v17
    v_fmac_f32 v40, v24, v44
    v_fmac_f32 v41, v25, v44
    v_fmac_f32 v42, v26, v44
    v_fmac_f32 v43, v27, v44
    v_cvt_pk_bf16_f32 v40, v40, v41
    v_cvt_pk_bf16_f32 v41, v42, v43
    buffer_store_dwordx2 v[40:41], v14, s[60:63], s15 offen
    s_add_u32 s15, s15, 73728
    s_waitcnt lgkmcnt(1)
    v_lshlrev_b32 v28, 16, v18
    v_and_b32 v29, 0xffff0000, v18
    v_lshlrev_b32 v30, 16, v19
    v_and_b32 v31, 0xffff0000, v19
    v_fmac_f32 v46, v28, v50
    v_fmac_f32 v47, v29, v50
    v_fmac_f32 v48, v30, v50
    v_fmac_f32 v49, v31, v50
    v_cvt_pk_bf16_f32 v46, v46, v47
    v_cvt_pk_bf16_f32 v47, v48, v49
    buffer_store_dwordx2 v[46:47], v14, s[60:63], s15 offen
    s_add_u32 s15, s15, 73728
    s_waitcnt lgkmcnt(0)
    v_lshlrev_b32 v32, 16, v20
    v_and_b32 v33, 0xffff0000, v20
    v_lshlrev_b32 v34, 16, v21
    v_and_b32 v35, 0xffff0000, v21
    v_fmac_f32 v52, v32, v56
    v_fmac_f32 v53, v33, v56
    v_fmac_f32 v54, v34, v56
    v_fmac_f32 v55, v35, v56
    v_cvt_pk_bf16_f32 v52, v52, v53
    v_cvt_pk_bf16_f32 v53, v54, v55
    buffer_store_dwordx2 v[52:53], v14, s[60:63], s15 offen
    s_add_u32 s15, s15, 73728
    s_waitcnt vmcnt(0)
    v_mov_b32 v8, 1
    s_mov_b64 exec, 1
    ds_add_u32 v1, v8 offset:40
    s_mov_b64 exec, -1
    s_endpgm
C_G1:
    s_setprio 1
    ds_read_b128 v[64:67], v6 offset:3584
    ds_read_b128 v[80:83], v6 offset:3600
    ds_read_b128 v[68:71], v6 offset:3072
    ds_read_b128 v[84:87], v6 offset:3088
    ds_read_b128 v[72:75], v6 offset:2560
    ds_read_b128 v[88:91], v6 offset:2576
    ds_read_b128 v[76:79], v6 offset:2048
    ds_read_b128 v[92:95], v6 offset:2064
    ds_read_b64 v[8:9], v5 offset:2048
    ds_read_b64 v[10:11], v5 offset:2056
    s_waitcnt lgkmcnt(9)
    v_mfma_f32_16x16x32_bf16 v[96:99], v[64:67], v[142:145], 0
    s_waitcnt lgkmcnt(8)
    v_mfma_f32_16x16x32_bf16 v[112:115], v[80:83], v[146:149], 0
    s_waitcnt lgkmcnt(7)
    v_mfma_f32_16x16x32_bf16 v[100:103], v[68:71], v[142:145], 0
    s_waitcnt lgkmcnt(6)
    v_mfma_f32_16x16x32_bf16 v[116:119], v[84:87], v[146:149], 0
    s_waitcnt lgkmcnt(5)
    v_mfma_f32_16x16x32_bf16 v[104:107], v[72:75], v[142:145], 0
    s_waitcnt lgkmcnt(4)
    v_mfma_f32_16x16x32_bf16 v[120:123], v[88:91], v[146:149], 0
    s_waitcnt lgkmcnt(3)
    v_mfma_f32_16x16x32_bf16 v[108:111], v[76:79], v[142:145], 0
    s_waitcnt lgkmcnt(2)
    v_mfma_f32_16x16x32_bf16 v[124:127], v[92:95], v[146:149], 0
    s_waitcnt lgkmcnt(0)
    v_mfma_f32_16x16x32_bf16 v[16:19], v[8:11], v[64:67], 0
    ds_read_b64 v[44:45], v5 offset:1536
    v_cvt_pk_bf16_f32 v96, v96, v112
    v_cvt_pk_bf16_f32 v97, v97, v113
    v_cvt_pk_bf16_f32 v98, v98, v114
    v_cvt_pk_bf16_f32 v99, v99, v115
    v_mfma_f32_16x16x32_bf16 v[20:23], v[8:11], v[68:71], 0
    ds_read_b64 v[46:47], v5 offset:1544
    v_cvt_pk_bf16_f32 v100, v100, v116
    v_cvt_pk_bf16_f32 v101, v101, v117
    v_cvt_pk_bf16_f32 v102, v102, v118
    v_cvt_pk_bf16_f32 v103, v103, v119
    v_mfma_f32_16x16x32_bf16 v[24:27], v[8:11], v[72:75], 0
    ds_read_b128 v[60:63], v6 offset:2048
    v_cvt_pk_bf16_f32 v104, v104, v120
    v_cvt_pk_bf16_f32 v105, v105, v121
    v_cvt_pk_bf16_f32 v106, v106, v122
    v_cvt_pk_bf16_f32 v107, v107, v123
    v_mfma_f32_16x16x32_bf16 v[28:31], v[8:11], v[76:79], 0
    ds_read_b128 v[56:59], v6 offset:2560
    v_cvt_pk_bf16_f32 v108, v108, v124
    v_cvt_pk_bf16_f32 v109, v109, v125
    v_cvt_pk_bf16_f32 v110, v110, v126
    v_cvt_pk_bf16_f32 v111, v111, v127
    v_mfma_f32_16x16x32_bf16 v[28:31], v[96:99], v[162:165], v[28:31]
    ds_read_b128 v[52:55], v6 offset:3072
    v_mfma_f32_16x16x32_bf16 v[24:27], v[96:99], v[158:161], v[24:27]
    ds_read_b64 v[40:41], v5 offset:1024
    v_mfma_f32_16x16x32_bf16 v[20:23], v[96:99], v[154:157], v[20:23]
    ds_read_b64 v[42:43], v5 offset:1032
    v_mfma_f32_16x16x32_bf16 v[16:19], v[96:99], v[150:153], v[16:19]
    ds_read_b64 v[36:37], v5 offset:512
    v_mfma_f32_16x16x32_bf16 v[28:31], v[100:103], v[158:161], v[28:31]
    ds_read_b64 v[38:39], v5 offset:520
    v_mfma_f32_16x16x32_bf16 v[24:27], v[100:103], v[154:157], v[24:27]
    v_mfma_f32_16x16x32_bf16 v[20:23], v[100:103], v[150:153], v[20:23]
    v_mfma_f32_16x16x32_bf16 v[28:31], v[104:107], v[154:157], v[28:31]
    v_mfma_f32_16x16x32_bf16 v[24:27], v[104:107], v[150:153], v[24:27]
    v_mfma_f32_16x16x32_bf16 v[28:31], v[108:111], v[150:153], v[28:31]
    s_waitcnt lgkmcnt(4)
    v_mfma_f32_16x16x32_bf16 v[24:27], v[44:47], v[60:63], v[24:27]
    ds_read_b64 v[76:77], v5 offset:1600
    ds_read_b64 v[78:79], v5 offset:1608
    v_mfma_f32_16x16x32_bf16 v[20:23], v[44:47], v[56:59], v[20:23]
    ds_read_b128 v[92:95], v6 offset:2112
    v_mfma_f32_16x16x32_bf16 v[16:19], v[44:47], v[52:55], v[16:19]
    ds_read_b128 v[88:91], v6 offset:2624
    ds_read_b128 v[84:87], v6 offset:3136
    s_waitcnt lgkmcnt(7)
    v_mfma_f32_16x16x32_bf16 v[20:23], v[40:43], v[60:63], v[20:23]
    ds_read_b64 v[72:73], v5 offset:1088
    v_mfma_f32_16x16x32_bf16 v[16:19], v[40:43], v[56:59], v[16:19]
    ds_read_b64 v[74:75], v5 offset:1096
    ds_read_b64 v[68:69], v5 offset:576
    s_waitcnt lgkmcnt(8)
    v_mfma_f32_16x16x32_bf16 v[16:19], v[36:39], v[60:63], v[16:19]
    ds_read_b64 v[70:71], v5 offset:584
    s_waitcnt lgkmcnt(4)
    v_mfma_f32_16x16x32_bf16 v[24:27], v[76:79], v[92:95], v[24:27]
    ds_read_b64 v[44:45], v5 offset:1664
    ds_read_b64 v[46:47], v5 offset:1672
    v_mfma_f32_16x16x32_bf16 v[20:23], v[76:79], v[88:91], v[20:23]
    ds_read_b128 v[60:63], v6 offset:2176
    v_mfma_f32_16x16x32_bf16 v[16:19], v[76:79], v[84:87], v[16:19]
    ds_read_b128 v[56:59], v6 offset:2688
    ds_read_b128 v[52:55], v6 offset:3200
    s_waitcnt lgkmcnt(7)
    v_mfma_f32_16x16x32_bf16 v[20:23], v[72:75], v[92:95], v[20:23]
    ds_read_b64 v[40:41], v5 offset:1152
    v_mfma_f32_16x16x32_bf16 v[16:19], v[72:75], v[88:91], v[16:19]
    ds_read_b64 v[42:43], v5 offset:1160
    ds_read_b64 v[36:37], v5 offset:640
    s_waitcnt lgkmcnt(8)
    v_mfma_f32_16x16x32_bf16 v[16:19], v[68:71], v[92:95], v[16:19]
    ds_read_b64 v[38:39], v5 offset:648
    s_waitcnt lgkmcnt(4)
    v_mfma_f32_16x16x32_bf16 v[24:27], v[44:47], v[60:63], v[24:27]
    ds_read_b64 v[76:77], v5 offset:1728
    ds_read_b64 v[78:79], v5 offset:1736
    v_mfma_f32_16x16x32_bf16 v[20:23], v[44:47], v[56:59], v[20:23]
    ds_read_b128 v[92:95], v6 offset:2240
    v_mfma_f32_16x16x32_bf16 v[16:19], v[44:47], v[52:55], v[16:19]
    ds_read_b128 v[88:91], v6 offset:2752
    ds_read_b128 v[84:87], v6 offset:3264
    s_waitcnt lgkmcnt(7)
    v_mfma_f32_16x16x32_bf16 v[20:23], v[40:43], v[60:63], v[20:23]
    ds_read_b64 v[72:73], v5 offset:1216
    v_mfma_f32_16x16x32_bf16 v[16:19], v[40:43], v[56:59], v[16:19]
    ds_read_b64 v[74:75], v5 offset:1224
    ds_read_b64 v[68:69], v5 offset:704
    s_waitcnt lgkmcnt(8)
    v_mfma_f32_16x16x32_bf16 v[16:19], v[36:39], v[60:63], v[16:19]
    ds_read_b64 v[70:71], v5 offset:712
    s_waitcnt lgkmcnt(4)
    v_mfma_f32_16x16x32_bf16 v[24:27], v[76:79], v[92:95], v[24:27]
    ds_read_b64 v[44:45], v5 offset:1792
    ds_read_b64 v[46:47], v5 offset:1800
    v_mfma_f32_16x16x32_bf16 v[20:23], v[76:79], v[88:91], v[20:23]
    ds_read_b128 v[60:63], v6 offset:2304
    v_mfma_f32_16x16x32_bf16 v[16:19], v[76:79], v[84:87], v[16:19]
    ds_read_b128 v[56:59], v6 offset:2816
    ds_read_b128 v[52:55], v6 offset:3328
    s_waitcnt lgkmcnt(7)
    v_mfma_f32_16x16x32_bf16 v[20:23], v[72:75], v[92:95], v[20:23]
    ds_read_b64 v[40:41], v5 offset:1280
    v_mfma_f32_16x16x32_bf16 v[16:19], v[72:75], v[88:91], v[16:19]
    ds_read_b64 v[42:43], v5 offset:1288
    ds_read_b64 v[36:37], v5 offset:768
    s_waitcnt lgkmcnt(8)
    v_mfma_f32_16x16x32_bf16 v[16:19], v[68:71], v[92:95], v[16:19]
    ds_read_b64 v[38:39], v5 offset:776
    s_waitcnt lgkmcnt(4)
    v_mfma_f32_16x16x32_bf16 v[24:27], v[44:47], v[60:63], v[24:27]
    ds_read_b64 v[76:77], v5 offset:1856
    ds_read_b64 v[78:79], v5 offset:1864
    v_mfma_f32_16x16x32_bf16 v[20:23], v[44:47], v[56:59], v[20:23]
    ds_read_b128 v[92:95], v6 offset:2368
    v_mfma_f32_16x16x32_bf16 v[16:19], v[44:47], v[52:55], v[16:19]
    ds_read_b128 v[88:91], v6 offset:2880
    ds_read_b128 v[84:87], v6 offset:3392
    s_waitcnt lgkmcnt(7)
    v_mfma_f32_16x16x32_bf16 v[20:23], v[40:43], v[60:63], v[20:23]
    ds_read_b64 v[72:73], v5 offset:1344
    v_mfma_f32_16x16x32_bf16 v[16:19], v[40:43], v[56:59], v[16:19]
    ds_read_b64 v[74:75], v5 offset:1352
    ds_read_b64 v[68:69], v5 offset:832
    s_waitcnt lgkmcnt(8)
    v_mfma_f32_16x16x32_bf16 v[16:19], v[36:39], v[60:63], v[16:19]
    ds_read_b64 v[70:71], v5 offset:840
    s_waitcnt lgkmcnt(4)
    v_mfma_f32_16x16x32_bf16 v[24:27], v[76:79], v[92:95], v[24:27]
    ds_read_b64 v[44:45], v5 offset:1920
    ds_read_b64 v[46:47], v5 offset:1928
    v_mfma_f32_16x16x32_bf16 v[20:23], v[76:79], v[88:91], v[20:23]
    ds_read_b128 v[60:63], v6 offset:2432
    v_mfma_f32_16x16x32_bf16 v[16:19], v[76:79], v[84:87], v[16:19]
    ds_read_b128 v[56:59], v6 offset:2944
    ds_read_b128 v[52:55], v6 offset:3456
    s_waitcnt lgkmcnt(7)
    v_mfma_f32_16x16x32_bf16 v[20:23], v[72:75], v[92:95], v[20:23]
    ds_read_b64 v[40:41], v5 offset:1408
    v_mfma_f32_16x16x32_bf16 v[16:19], v[72:75], v[88:91], v[16:19]
    ds_read_b64 v[42:43], v5 offset:1416
    ds_read_b64 v[36:37], v5 offset:896
    s_waitcnt lgkmcnt(8)
    v_mfma_f32_16x16x32_bf16 v[16:19], v[68:71], v[92:95], v[16:19]
    ds_read_b64 v[38:39], v5 offset:904
    s_waitcnt lgkmcnt(4)
    v_mfma_f32_16x16x32_bf16 v[24:27], v[44:47], v[60:63], v[24:27]
    ds_read_b64 v[76:77], v5 offset:1984
    ds_read_b64 v[78:79], v5 offset:1992
    v_mfma_f32_16x16x32_bf16 v[20:23], v[44:47], v[56:59], v[20:23]
    ds_read_b128 v[92:95], v6 offset:2496
    v_mfma_f32_16x16x32_bf16 v[16:19], v[44:47], v[52:55], v[16:19]
    ds_read_b128 v[88:91], v6 offset:3008
    ds_read_b128 v[84:87], v6 offset:3520
    s_waitcnt lgkmcnt(7)
    v_mfma_f32_16x16x32_bf16 v[20:23], v[40:43], v[60:63], v[20:23]
    ds_read_b64 v[72:73], v5 offset:1472
    v_mfma_f32_16x16x32_bf16 v[16:19], v[40:43], v[56:59], v[16:19]
    ds_read_b64 v[74:75], v5 offset:1480
    ds_read_b64 v[68:69], v5 offset:960
    s_waitcnt lgkmcnt(8)
    v_mfma_f32_16x16x32_bf16 v[16:19], v[36:39], v[60:63], v[16:19]
    ds_read_b64 v[70:71], v5 offset:968
    s_waitcnt lgkmcnt(4)
    v_mfma_f32_16x16x32_bf16 v[24:27], v[76:79], v[92:95], v[24:27]
    v_mfma_f32_16x16x32_bf16 v[20:23], v[76:79], v[88:91], v[20:23]
    v_mfma_f32_16x16x32_bf16 v[16:19], v[76:79], v[84:87], v[16:19]
    s_waitcnt lgkmcnt(2)
    v_mfma_f32_16x16x32_bf16 v[20:23], v[72:75], v[92:95], v[20:23]
    v_mfma_f32_16x16x32_bf16 v[16:19], v[72:75], v[88:91], v[16:19]
    s_waitcnt lgkmcnt(0)
    v_mfma_f32_16x16x32_bf16 v[16:19], v[68:71], v[92:95], v[16:19]
    s_setprio 0
    s_mov_b32 s9, 0
SP_29:
    ds_read_b32 v10, v1 offset:84
    s_waitcnt lgkmcnt(0)
    v_readfirstlane_b32 s8, v10
    s_add_u32 s9, s9, 1
    s_cmp_ge_u32 s8, 1
    s_cbranch_scc1 SP_29_D
    s_cmp_lt_u32 s9, 524288
    s_cbranch_scc1 SP_29
SP_29_D:
    s_setprio 2
    ds_read_b64 v[32:33], v5 offset:0
    ds_read_b64 v[34:35], v5 offset:8
    ds_read_b128 v[60:63], v6 offset:0
    ds_read_b128 v[56:59], v6 offset:512
    ds_read_b128 v[52:55], v6 offset:1024
    ds_read_b128 v[48:51], v6 offset:1536
    ds_read_b64 v[36:37], v5 offset:512
    ds_read_b64 v[38:39], v5 offset:520
    ds_read_b64 v[40:41], v5 offset:1024
    ds_read_b64 v[42:43], v5 offset:1032
    ds_read_b64 v[44:45], v5 offset:1536
    ds_read_b64 v[46:47], v5 offset:1544
    s_waitcnt lgkmcnt(9)
    v_mfma_f32_16x16x32_bf16 v[28:31], v[32:35], v[60:63], v[28:31]
    ds_read_b64 v[64:65], v5 offset:64
    ds_read_b64 v[66:67], v5 offset:72
    s_waitcnt lgkmcnt(10)
    v_mfma_f32_16x16x32_bf16 v[24:27], v[32:35], v[56:59], v[24:27]
    ds_read_b128 v[92:95], v6 offset:64
    s_waitcnt lgkmcnt(10)
    v_mfma_f32_16x16x32_bf16 v[20:23], v[32:35], v[52:55], v[20:23]
    ds_read_b128 v[88:91], v6 offset:576
    s_waitcnt lgkmcnt(10)
    v_mfma_f32_16x16x32_bf16 v[16:19], v[32:35], v[48:51], v[16:19]
    ds_read_b128 v[84:87], v6 offset:1088
    s_waitcnt lgkmcnt(9)
    v_mfma_f32_16x16x32_bf16 v[28:31], v[36:39], v[56:59], v[28:31]
    ds_read_b128 v[80:83], v6 offset:1600
    v_mfma_f32_16x16x32_bf16 v[24:27], v[36:39], v[52:55], v[24:27]
    ds_read_b64 v[68:69], v5 offset:576
    ds_read_b64 v[70:71], v5 offset:584
    v_mfma_f32_16x16x32_bf16 v[20:23], v[36:39], v[48:51], v[20:23]
    ds_read_b64 v[72:73], v5 offset:1088
    s_waitcnt lgkmcnt(11)
    v_mfma_f32_16x16x32_bf16 v[28:31], v[40:43], v[52:55], v[28:31]
    ds_read_b64 v[74:75], v5 offset:1096
    v_mfma_f32_16x16x32_bf16 v[24:27], v[40:43], v[48:51], v[24:27]
    ds_read_b64 v[76:77], v5 offset:1600
    s_waitcnt lgkmcnt(11)
    v_mfma_f32_16x16x32_bf16 v[28:31], v[44:47], v[48:51], v[28:31]
    ds_read_b64 v[78:79], v5 offset:1608
    s_waitcnt lgkmcnt(6)
    v_mfma_f32_16x16x32_bf16 v[28:31], v[64:67], v[92:95], v[28:31]
    ds_read_b64 v[32:33], v5 offset:128
    ds_read_b64 v[34:35], v5 offset:136
    v_mfma_f32_16x16x32_bf16 v[24:27], v[64:67], v[88:91], v[24:27]
    ds_read_b128 v[60:63], v6 offset:128
    v_mfma_f32_16x16x32_bf16 v[20:23], v[64:67], v[84:87], v[20:23]
    ds_read_b128 v[56:59], v6 offset:640
    v_mfma_f32_16x16x32_bf16 v[16:19], v[64:67], v[80:83], v[16:19]
    ds_read_b128 v[52:55], v6 offset:1152
    s_waitcnt lgkmcnt(9)
    v_mfma_f32_16x16x32_bf16 v[28:31], v[68:71], v[88:91], v[28:31]
    ds_read_b128 v[48:51], v6 offset:1664
    v_mfma_f32_16x16x32_bf16 v[24:27], v[68:71], v[84:87], v[24:27]
    ds_read_b64 v[36:37], v5 offset:640
    ds_read_b64 v[38:39], v5 offset:648
    v_mfma_f32_16x16x32_bf16 v[20:23], v[68:71], v[80:83], v[20:23]
    ds_read_b64 v[40:41], v5 offset:1152
    s_waitcnt lgkmcnt(11)
    v_mfma_f32_16x16x32_bf16 v[28:31], v[72:75], v[84:87], v[28:31]
    ds_read_b64 v[42:43], v5 offset:1160
    v_mfma_f32_16x16x32_bf16 v[24:27], v[72:75], v[80:83], v[24:27]
    ds_read_b64 v[44:45], v5 offset:1664
    s_waitcnt lgkmcnt(11)
    v_mfma_f32_16x16x32_bf16 v[28:31], v[76:79], v[80:83], v[28:31]
    ds_read_b64 v[46:47], v5 offset:1672
    s_waitcnt lgkmcnt(6)
    v_mfma_f32_16x16x32_bf16 v[28:31], v[32:35], v[60:63], v[28:31]
    ds_read_b64 v[64:65], v5 offset:192
    ds_read_b64 v[66:67], v5 offset:200
    v_mfma_f32_16x16x32_bf16 v[24:27], v[32:35], v[56:59], v[24:27]
    ds_read_b128 v[92:95], v6 offset:192
    v_mfma_f32_16x16x32_bf16 v[20:23], v[32:35], v[52:55], v[20:23]
    ds_read_b128 v[88:91], v6 offset:704
    v_mfma_f32_16x16x32_bf16 v[16:19], v[32:35], v[48:51], v[16:19]
    ds_read_b128 v[84:87], v6 offset:1216
    s_waitcnt lgkmcnt(9)
    v_mfma_f32_16x16x32_bf16 v[28:31], v[36:39], v[56:59], v[28:31]
    ds_read_b128 v[80:83], v6 offset:1728
    v_mfma_f32_16x16x32_bf16 v[24:27], v[36:39], v[52:55], v[24:27]
    ds_read_b64 v[68:69], v5 offset:704
    ds_read_b64 v[70:71], v5 offset:712
    v_mfma_f32_16x16x32_bf16 v[20:23], v[36:39], v[48:51], v[20:23]
    ds_read_b64 v[72:73], v5 offset:1216
    s_waitcnt lgkmcnt(11)
    v_mfma_f32_16x16x32_bf16 v[28:31], v[40:43], v[52:55], v[28:31]
    ds_read_b64 v[74:75], v5 offset:1224
    v_mfma_f32_16x16x32_bf16 v[24:27], v[40:43], v[48:51], v[24:27]
    ds_read_b64 v[76:77], v5 offset:1728
    s_waitcnt lgkmcnt(11)
    v_mfma_f32_16x16x32_bf16 v[28:31], v[44:47], v[48:51], v[28:31]
    ds_read_b64 v[78:79], v5 offset:1736
    s_waitcnt lgkmcnt(6)
    v_mfma_f32_16x16x32_bf16 v[28:31], v[64:67], v[92:95], v[28:31]
    ds_read_b64 v[32:33], v5 offset:256
    ds_read_b64 v[34:35], v5 offset:264
    v_mfma_f32_16x16x32_bf16 v[24:27], v[64:67], v[88:91], v[24:27]
    ds_read_b128 v[60:63], v6 offset:256
    v_mfma_f32_16x16x32_bf16 v[20:23], v[64:67], v[84:87], v[20:23]
    ds_read_b128 v[56:59], v6 offset:768
    v_mfma_f32_16x16x32_bf16 v[16:19], v[64:67], v[80:83], v[16:19]
    ds_read_b128 v[52:55], v6 offset:1280
    s_waitcnt lgkmcnt(9)
    v_mfma_f32_16x16x32_bf16 v[28:31], v[68:71], v[88:91], v[28:31]
    ds_read_b128 v[48:51], v6 offset:1792
    v_mfma_f32_16x16x32_bf16 v[24:27], v[68:71], v[84:87], v[24:27]
    ds_read_b64 v[36:37], v5 offset:768
    ds_read_b64 v[38:39], v5 offset:776
    v_mfma_f32_16x16x32_bf16 v[20:23], v[68:71], v[80:83], v[20:23]
    ds_read_b64 v[40:41], v5 offset:1280
    s_waitcnt lgkmcnt(11)
    v_mfma_f32_16x16x32_bf16 v[28:31], v[72:75], v[84:87], v[28:31]
    ds_read_b64 v[42:43], v5 offset:1288
    v_mfma_f32_16x16x32_bf16 v[24:27], v[72:75], v[80:83], v[24:27]
    ds_read_b64 v[44:45], v5 offset:1792
    s_waitcnt lgkmcnt(11)
    v_mfma_f32_16x16x32_bf16 v[28:31], v[76:79], v[80:83], v[28:31]
    ds_read_b64 v[46:47], v5 offset:1800
    s_waitcnt lgkmcnt(6)
    v_mfma_f32_16x16x32_bf16 v[28:31], v[32:35], v[60:63], v[28:31]
    ds_read_b64 v[64:65], v5 offset:320
    ds_read_b64 v[66:67], v5 offset:328
    v_mfma_f32_16x16x32_bf16 v[24:27], v[32:35], v[56:59], v[24:27]
    ds_read_b128 v[92:95], v6 offset:320
    v_mfma_f32_16x16x32_bf16 v[20:23], v[32:35], v[52:55], v[20:23]
    ds_read_b128 v[88:91], v6 offset:832
    v_mfma_f32_16x16x32_bf16 v[16:19], v[32:35], v[48:51], v[16:19]
    ds_read_b128 v[84:87], v6 offset:1344
    s_waitcnt lgkmcnt(9)
    v_mfma_f32_16x16x32_bf16 v[28:31], v[36:39], v[56:59], v[28:31]
    ds_read_b128 v[80:83], v6 offset:1856
    v_mfma_f32_16x16x32_bf16 v[24:27], v[36:39], v[52:55], v[24:27]
    ds_read_b64 v[68:69], v5 offset:832
    ds_read_b64 v[70:71], v5 offset:840
    v_mfma_f32_16x16x32_bf16 v[20:23], v[36:39], v[48:51], v[20:23]
    ds_read_b64 v[72:73], v5 offset:1344
    s_waitcnt lgkmcnt(11)
    v_mfma_f32_16x16x32_bf16 v[28:31], v[40:43], v[52:55], v[28:31]
    ds_read_b64 v[74:75], v5 offset:1352
    v_mfma_f32_16x16x32_bf16 v[24:27], v[40:43], v[48:51], v[24:27]
    ds_read_b64 v[76:77], v5 offset:1856
    s_waitcnt lgkmcnt(11)
    v_mfma_f32_16x16x32_bf16 v[28:31], v[44:47], v[48:51], v[28:31]
    ds_read_b64 v[78:79], v5 offset:1864
    s_waitcnt lgkmcnt(6)
    v_mfma_f32_16x16x32_bf16 v[28:31], v[64:67], v[92:95], v[28:31]
    ds_read_b64 v[32:33], v5 offset:384
    ds_read_b64 v[34:35], v5 offset:392
    v_mfma_f32_16x16x32_bf16 v[24:27], v[64:67], v[88:91], v[24:27]
    ds_read_b128 v[60:63], v6 offset:384
    v_mfma_f32_16x16x32_bf16 v[20:23], v[64:67], v[84:87], v[20:23]
    ds_read_b128 v[56:59], v6 offset:896
    v_mfma_f32_16x16x32_bf16 v[16:19], v[64:67], v[80:83], v[16:19]
    ds_read_b128 v[52:55], v6 offset:1408
    s_waitcnt lgkmcnt(9)
    v_mfma_f32_16x16x32_bf16 v[28:31], v[68:71], v[88:91], v[28:31]
    ds_read_b128 v[48:51], v6 offset:1920
    v_mfma_f32_16x16x32_bf16 v[24:27], v[68:71], v[84:87], v[24:27]
    ds_read_b64 v[36:37], v5 offset:896
    ds_read_b64 v[38:39], v5 offset:904
    v_mfma_f32_16x16x32_bf16 v[20:23], v[68:71], v[80:83], v[20:23]
    ds_read_b64 v[40:41], v5 offset:1408
    s_waitcnt lgkmcnt(11)
    v_mfma_f32_16x16x32_bf16 v[28:31], v[72:75], v[84:87], v[28:31]
    ds_read_b64 v[42:43], v5 offset:1416
    v_mfma_f32_16x16x32_bf16 v[24:27], v[72:75], v[80:83], v[24:27]
    ds_read_b64 v[44:45], v5 offset:1920
    s_waitcnt lgkmcnt(11)
    v_mfma_f32_16x16x32_bf16 v[28:31], v[76:79], v[80:83], v[28:31]
    ds_read_b64 v[46:47], v5 offset:1928
    s_waitcnt lgkmcnt(6)
    v_mfma_f32_16x16x32_bf16 v[28:31], v[32:35], v[60:63], v[28:31]
    ds_read_b64 v[64:65], v5 offset:448
    ds_read_b64 v[66:67], v5 offset:456
    v_mfma_f32_16x16x32_bf16 v[24:27], v[32:35], v[56:59], v[24:27]
    ds_read_b128 v[92:95], v6 offset:448
    v_mfma_f32_16x16x32_bf16 v[20:23], v[32:35], v[52:55], v[20:23]
    ds_read_b128 v[88:91], v6 offset:960
    v_mfma_f32_16x16x32_bf16 v[16:19], v[32:35], v[48:51], v[16:19]
    ds_read_b128 v[84:87], v6 offset:1472
    s_waitcnt lgkmcnt(9)
    v_mfma_f32_16x16x32_bf16 v[28:31], v[36:39], v[56:59], v[28:31]
    ds_read_b128 v[80:83], v6 offset:1984
    v_mfma_f32_16x16x32_bf16 v[24:27], v[36:39], v[52:55], v[24:27]
    ds_read_b64 v[68:69], v5 offset:960
    ds_read_b64 v[70:71], v5 offset:968
    v_mfma_f32_16x16x32_bf16 v[20:23], v[36:39], v[48:51], v[20:23]
    ds_read_b64 v[72:73], v5 offset:1472
    s_waitcnt lgkmcnt(11)
    v_mfma_f32_16x16x32_bf16 v[28:31], v[40:43], v[52:55], v[28:31]
    ds_read_b64 v[74:75], v5 offset:1480
    v_mfma_f32_16x16x32_bf16 v[24:27], v[40:43], v[48:51], v[24:27]
    ds_read_b64 v[76:77], v5 offset:1984
    s_waitcnt lgkmcnt(11)
    v_mfma_f32_16x16x32_bf16 v[28:31], v[44:47], v[48:51], v[28:31]
    ds_read_b64 v[78:79], v5 offset:1992
    s_waitcnt lgkmcnt(6)
    v_mfma_f32_16x16x32_bf16 v[28:31], v[64:67], v[92:95], v[28:31]
    v_mfma_f32_16x16x32_bf16 v[24:27], v[64:67], v[88:91], v[24:27]
    v_mfma_f32_16x16x32_bf16 v[20:23], v[64:67], v[84:87], v[20:23]
    v_mfma_f32_16x16x32_bf16 v[16:19], v[64:67], v[80:83], v[16:19]
    s_waitcnt lgkmcnt(4)
    v_mfma_f32_16x16x32_bf16 v[28:31], v[68:71], v[88:91], v[28:31]
    v_mfma_f32_16x16x32_bf16 v[24:27], v[68:71], v[84:87], v[24:27]
    v_mfma_f32_16x16x32_bf16 v[20:23], v[68:71], v[80:83], v[20:23]
    s_waitcnt lgkmcnt(2)
    v_mfma_f32_16x16x32_bf16 v[28:31], v[72:75], v[84:87], v[28:31]
    v_mfma_f32_16x16x32_bf16 v[24:27], v[72:75], v[80:83], v[24:27]
    s_waitcnt lgkmcnt(0)
    v_mfma_f32_16x16x32_bf16 v[28:31], v[76:79], v[80:83], v[28:31]
    v_cvt_pk_bf16_f32 v32, v19, v18
    v_cvt_pk_bf16_f32 v33, v17, v16
    ds_write_b64 v140, v[32:33] offset:1536
    v_cvt_pk_bf16_f32 v34, v23, v22
    v_cvt_pk_bf16_f32 v35, v21, v20
    ds_write_b64 v140, v[34:35] offset:1024
    v_cvt_pk_bf16_f32 v36, v27, v26
    v_cvt_pk_bf16_f32 v37, v25, v24
    ds_write_b64 v140, v[36:37] offset:512
    v_cvt_pk_bf16_f32 v38, v31, v30
    v_cvt_pk_bf16_f32 v39, v29, v28
    ds_write_b64 v140, v[38:39] offset:0
    v_mov_b32 v8, 1
    s_mov_b64 exec, 1
    ds_add_u32 v1, v8 offset:36
    s_mov_b64 exec, -1
    s_endpgm
K_END:
    s_endpgm
CODE_END:
.section .rodata,"a"
.p2align 6
.amdhsa_kernel k1_kernel
  .amdhsa_next_free_vgpr 168
  .amdhsa_next_free_sgpr 102
  .amdhsa_accum_offset 168
  .amdhsa_group_segment_fixed_size 0
  .amdhsa_kernarg_size 144
  .amdhsa_user_sgpr_count 2
  .amdhsa_user_sgpr_kernarg_segment_ptr 1
  .amdhsa_system_sgpr_workgroup_id_x 1
.end_amdhsa_kernel
```

```asm
; @launch kernel=k1_kernel grid=(256,1,1) block=(768,1,1) lds=163840
.amdgcn_target "amdgcn-amd-amdhsa--gfx950"
.text
.p2align 8
.globl k1_kernel
.type k1_kernel,@function
k1_kernel:
    v_lshrrev_b32 v1, 6, v0
    s_cmp_ge_u32 s2, 256
    v_readfirstlane_b32 s3, v1
    s_cbranch_scc1 K_END
    v_and_b32 v2, 63, v0
    v_mov_b32 v1, 0
    s_cmp_lg_u32 s3, 1
    s_cbranch_scc1 K_NOZ
    v_lshlrev_b32 v3, 2, v2
    ds_write_b32 v3, v1
    s_waitcnt lgkmcnt(0)
K_NOZ:
    s_load_dwordx16 s[16:31], s[0:1], 0
    s_load_dwordx16 s[32:47], s[0:1], 64
    s_load_dwordx4 s[48:51], s[0:1], 128
    s_lshr_b32 s5, s2, 3
    s_lshl_b32 s8, s3, 8
    s_add_u32 s8, s8, s5
    s_cmp_lg_u32 s8, 9
    s_cbranch_scc1 K_NOCPF
    s_getpc_b64 s[8:9]
    s_and_b32 s8, s8, 0xffffff00
    v_lshlrev_b32 v8, 7, v2
    v_min_u32 v9, CODE_END-k1_kernel-4, v8
    global_load_dword v160, v9, s[8:9]
    v_add_u32 v8, 8192, v8
    v_min_u32 v9, CODE_END-k1_kernel-4, v8
    global_load_dword v161, v9, s[8:9]
    v_add_u32 v8, 8192, v8
    v_min_u32 v9, CODE_END-k1_kernel-4, v8
    global_load_dword v162, v9, s[8:9]
    v_add_u32 v8, 8192, v8
    v_min_u32 v9, CODE_END-k1_kernel-4, v8
    global_load_dword v163, v9, s[8:9]
    v_add_u32 v8, 8192, v8
K_NOCPF:
    v_and_b32 v3, 15, v2
    v_lshrrev_b32 v4, 4, v2
    s_and_b32 s4, s2, 7
    s_barrier
    s_cmp_eq_u32 s3, 8
    s_cbranch_scc1 ROUTER
    s_cmp_lt_u32 s5, 14
    s_cbranch_scc1 K_OTHER
    s_mul_i32 s7, s4, 18
    s_add_u32 s7, s7, s5
    s_sub_u32 s7, s7, 14
    s_cmp_ge_u32 s3, 8
    s_cbranch_scc1 K_CIO
C_KGEN:
    s_and_b32 s12, s3, 3
    s_lshr_b32 s13, s3, 2
    s_lshl_b32 s14, s7, 2
    s_add_u32 s14, s14, s12
    s_lshl_b32 s8, s14, 8
    s_lshl_b32 s9, s13, 7
    s_add_u32 s8, s8, s9
    v_lshl_add_u32 v5, v2, 1, s8
    v_mov_b32 v16, 0
    v_mov_b32 v17, 0
    v_mov_b32 v18, 0
    v_mov_b32 v19, 0
    v_mov_b32 v20, 0
    v_mov_b32 v21, 0
    s_lshl_b32 s55, s7, 3
    s_setprio 2
    s_mul_i32 s15, s3, 4608
    s_add_u32 s15, s15, 256
    s_mul_i32 s52, s12, 8960
    s_add_u32 s52, s52, 37120
    s_mul_i32 s53, s12, 4672
    s_add_u32 s53, s53, 72960
    v_mul_u32_u24 v7, 288, v3
    v_lshl_add_u32 v7, v4, 4, v7
    v_add_u32 v7, s15, v7
    s_mov_b32 m0, s15
    s_waitcnt lgkmcnt(0)
    s_load_dwordx2 s[58:59], s[30:31], s55
    global_load_short_d16_hi v16, v5, s[18:19]
    global_load_short_d16_hi v17, v5, s[20:21]
    global_load_short_d16_hi v18, v5, s[22:23]
    global_load_short_d16_hi v19, v5, s[24:25]
    global_load_short_d16_hi v20, v5, s[26:27]
    global_load_short_d16_hi v21, v5, s[28:29]
    s_load_dwordx2 s[68:69], s[32:33], s55
    s_branch C_KBODY
ROUTER:
    s_setprio 3
    v_lshrrev_b32 v5, 3, v2
    v_and_b32 v6, 7, v2
    v_lshlrev_b32 v9, 4, v6
    v_mul_u32_u24 v8, 1152, v5
    s_mul_i32 s8, s2, 9216
    v_add3_u32 v8, v8, v9, s8
    v_lshlrev_b32 v7, 4, v2
    v_min_u32 v10, 7, v2
    v_lshlrev_b32 v10, 4, v10
    s_mov_b32 m0, 147712
    s_waitcnt lgkmcnt(0)
    s_load_dword s10, s[50:51], 16640
    global_load_lds_dwordx4 v8, s[16:17] offset:0
    s_mov_b32 m0, 148608
    s_nop 0
    global_load_lds_dwordx4 v8, s[16:17] offset:128
    s_mov_b32 m0, 149504
    s_nop 0
    global_load_lds_dwordx4 v8, s[16:17] offset:256
    s_mov_b32 m0, 150400
    s_nop 0
    global_load_lds_dwordx4 v8, s[16:17] offset:384
    s_mov_b32 m0, 151296
    s_nop 0
    global_load_lds_dwordx4 v8, s[16:17] offset:512
    s_mov_b32 m0, 152192
    s_nop 0
    global_load_lds_dwordx4 v8, s[16:17] offset:640
    s_mov_b32 m0, 153088
    s_nop 0
    global_load_lds_dwordx4 v8, s[16:17] offset:768
    s_mov_b32 m0, 153984
    s_nop 0
    global_load_lds_dwordx4 v8, s[16:17] offset:896
    s_mov_b32 m0, 154880
    s_nop 0
    global_load_lds_dwordx4 v8, s[16:17] offset:1024
    s_mov_b32 m0, 158080
    s_nop 0
    global_load_lds_dwordx4 v7, s[44:45]
    global_load_lds_dwordx4 v10, s[44:45] offset:1024
    global_load_dwordx4 v[52:55], v9, s[36:37] offset:0
    global_load_dwordx4 v[56:59], v9, s[36:37] offset:128
    global_load_dwordx4 v[60:63], v9, s[36:37] offset:256
    global_load_dwordx4 v[64:67], v9, s[36:37] offset:384
    global_load_dwordx4 v[68:71], v9, s[36:37] offset:512
    global_load_dwordx4 v[72:75], v9, s[36:37] offset:640
    global_load_dwordx4 v[76:79], v9, s[36:37] offset:768
    global_load_dwordx4 v[80:83], v9, s[36:37] offset:896
    global_load_dwordx4 v[84:87], v9, s[36:37] offset:1024
    v_mov_b32 v11, 1
    ds_write_b32 v1, v11 offset:4
    v_add_u32 v7, 147712, v7
    s_lshl_b32 s8, s2, 5
    v_lshl_add_u32 v15, v4, 3, s8
    s_mov_b32 s11, 0xffff
    v_mov_b32 v8, 0
    v_mov_b32 v9, 0
    v_mov_b32 v10, 0
    v_mov_b32 v11, 0
    s_waitcnt lgkmcnt(0)
    s_add_u32 s10, s10, 1
    s_addc_u32 s10, s10, 0
    v_mov_b32 v14, s10
    v_mov_b32 v13, s10
    s_waitcnt vmcnt(9)
    ds_read_b128 v[16:19], v7 offset:0
    ds_read_b128 v[20:23], v7 offset:1024
    ds_read_b128 v[24:27], v7 offset:2048
    ds_read_b128 v[28:31], v7 offset:3072
    ds_read_b128 v[32:35], v7 offset:4096
    ds_read_b128 v[36:39], v7 offset:5120
    ds_read_b128 v[40:43], v7 offset:6144
    ds_read_b128 v[44:47], v7 offset:7168
    ds_read_b128 v[48:51], v7 offset:8192
    ds_write_b32 v1, v14 offset:8
    s_waitcnt vmcnt(8) lgkmcnt(9)
    v_dot2c_f32_bf16 v8, v16, v52
    v_dot2c_f32_bf16 v9, v17, v53
    v_dot2c_f32_bf16 v10, v18, v54
    v_dot2c_f32_bf16 v11, v19, v55
    s_waitcnt vmcnt(7) lgkmcnt(8)
    v_dot2c_f32_bf16 v8, v20, v56
    v_dot2c_f32_bf16 v9, v21, v57
    v_dot2c_f32_bf16 v10, v22, v58
    v_dot2c_f32_bf16 v11, v23, v59
    s_waitcnt vmcnt(6) lgkmcnt(7)
    v_dot2c_f32_bf16 v8, v24, v60
    v_dot2c_f32_bf16 v9, v25, v61
    v_dot2c_f32_bf16 v10, v26, v62
    v_dot2c_f32_bf16 v11, v27, v63
    s_waitcnt vmcnt(5) lgkmcnt(6)
    v_dot2c_f32_bf16 v8, v28, v64
    v_dot2c_f32_bf16 v9, v29, v65
    v_dot2c_f32_bf16 v10, v30, v66
    v_dot2c_f32_bf16 v11, v31, v67
    s_waitcnt vmcnt(4) lgkmcnt(5)
    v_dot2c_f32_bf16 v8, v32, v68
    v_dot2c_f32_bf16 v9, v33, v69
    v_dot2c_f32_bf16 v10, v34, v70
    v_dot2c_f32_bf16 v11, v35, v71
    s_waitcnt vmcnt(3) lgkmcnt(4)
    v_dot2c_f32_bf16 v8, v36, v72
    v_dot2c_f32_bf16 v9, v37, v73
    v_dot2c_f32_bf16 v10, v38, v74
    v_dot2c_f32_bf16 v11, v39, v75
    s_waitcnt vmcnt(2) lgkmcnt(3)
    v_dot2c_f32_bf16 v8, v40, v76
    v_dot2c_f32_bf16 v9, v41, v77
    v_dot2c_f32_bf16 v10, v42, v78
    v_dot2c_f32_bf16 v11, v43, v79
    s_waitcnt vmcnt(1) lgkmcnt(2)
    v_dot2c_f32_bf16 v8, v44, v80
    v_dot2c_f32_bf16 v9, v45, v81
    v_dot2c_f32_bf16 v10, v46, v82
    v_dot2c_f32_bf16 v11, v47, v83
    s_waitcnt vmcnt(0) lgkmcnt(1)
    v_dot2c_f32_bf16 v8, v48, v84
    v_dot2c_f32_bf16 v9, v49, v85
    v_dot2c_f32_bf16 v10, v50, v86
    v_dot2c_f32_bf16 v11, v51, v87
    s_nop 0
    v_add_f32 v8, v8, v9
    s_nop 0
    v_add_f32 v10, v10, v11
    v_add_f32 v8, v8, v10
    s_nop 1
    v_add_f32_dpp v8, v8, v8 quad_perm:[1,0,3,2] row_mask:0xf bank_mask:0xf
    s_nop 1
    v_add_f32_dpp v8, v8, v8 quad_perm:[2,3,0,1] row_mask:0xf bank_mask:0xf
    s_nop 1
    v_add_f32_dpp v8, v8, v8 row_half_mirror row_mask:0xf bank_mask:0xf
    v_cvt_pk_bf16_f32 v8, v8, v8
    v_ashrrev_i32 v9, 31, v8
    v_or_b32 v9, 0x80008000, v9
    v_xor_b32 v8, v8, v9
    s_nop 1
    v_mov_b32_dpp v9, v8 row_ror:8 row_mask:0xf bank_mask:0xf
    s_mov_b32 exec_lo, 0x00010001
    s_mov_b32 exec_hi, 0x00010001
    v_bfi_b32 v12, s11, v8, v9
    global_store_dwordx2 v15, v[12:13], s[50:51] sc1
    s_mov_b64 exec, -1
    ds_write_b32 v1, v14 offset:0
    s_cmp_ge_u32 s5, 14
    s_cbranch_scc1 C_IO
    s_cmp_lt_u32 s5, 9
    s_cbranch_scc1 SELECT
    s_endpgm
K_OTHER:
    s_mul_i32 s7, s4, 9
    s_add_u32 s7, s7, s5
    s_mov_b32 s12, s3
    s_cmp_lt_u32 s3, 2
    s_cbranch_scc1 GATE
    s_cmp_ge_u32 s5, 9
    s_cbranch_scc1 HELPER
    s_cmp_lt_u32 s3, 8
    s_cbranch_scc1 F_COMP
F_LOAD:
    s_setprio 3
    s_sub_u32 s12, s3, 9
    v_lshrrev_b32 v5, 3, v2
    v_bfe_u32 v6, v2, 4, 1
    v_xor_b32 v6, v6, v2
    v_and_b32 v6, 7, v6
    s_movk_i32 s8, 9216
    v_mul_lo_u32 v7, v5, s8
    v_lshl_add_u32 v8, v6, 4, v7
    v_xor_b32 v9, 32, v8
    v_xor_b32 v10, 64, v8
    v_xor_b32 v11, 96, v8
    v_bfe_u32 v6, v2, 4, 1
    v_lshlrev_b32 v6, 1, v6
    v_xor_b32 v6, v6, v2
    v_and_b32 v6, 7, v6
    v_mul_u32_u24 v7, 1152, v5
    v_lshl_add_u32 v12, v6, 4, v7
    v_xor_b32 v13, 64, v12
    s_mul_i32 s13, s12, 294912
    s_lshl_b32 s8, s7, 7
    s_add_u32 s13, s13, s8
    s_lshl_b32 s15, s12, 13
    s_add_u32 s15, s15, 256
    s_mul_i32 s14, s12, 24576
    s_add_u32 s14, s14, 73984
    s_mul_i32 s11, s7, 73728
    s_mul_i32 s8, s12, 384
    s_add_u32 s11, s11, s8
    s_waitcnt lgkmcnt(0)
    s_mov_b32 s52, s38
    s_mov_b32 s53, s39
    s_mov_b32 s54, 5308416
    s_mov_b32 s55, 0x20000
    s_mov_b32 s56, s40
    s_mov_b32 s57, s41
    s_mov_b32 s58, 5308416
    s_mov_b32 s59, 0x20000
    s_mov_b32 s60, s42
    s_mov_b32 s61, s43
    s_mov_b32 s62, 5308416
    s_mov_b32 s63, 0x20000
    s_mov_b32 s9, 0
SP_1:
    ds_read_b32 v14, v1 offset:4
    s_waitcnt lgkmcnt(0)
    v_readfirstlane_b32 s8, v14
    s_add_u32 s9, s9, 1
    s_cmp_ge_u32 s8, 1
    s_cbranch_scc1 SP_1_D
    s_cmp_lt_u32 s9, 524288
    s_cbranch_scc1 SP_1
SP_1_D:
    s_add_u32 m0, s15, 0
    s_nop 0
    buffer_load_dwordx4 v8, s[52:55], s13 offen  lds
    s_add_u32 m0, s15, 1024
    s_nop 0
    buffer_load_dwordx4 v10, s[56:59], s13 offen  lds
    s_add_u32 s13, s13, 73728
    s_add_u32 m0, s15, 2048
    s_nop 0
    buffer_load_dwordx4 v9, s[52:55], s13 offen  lds
    s_add_u32 m0, s15, 3072
    s_nop 0
    buffer_load_dwordx4 v11, s[56:59], s13 offen  lds
    s_add_u32 s13, s13, 73728
    s_add_u32 m0, s15, 4096
    s_nop 0
    buffer_load_dwordx4 v8, s[52:55], s13 offen  lds
    s_add_u32 m0, s15, 5120
    s_nop 0
    buffer_load_dwordx4 v10, s[56:59], s13 offen  lds
    s_add_u32 s13, s13, 73728
    s_add_u32 m0, s15, 6144
    s_nop 0
    buffer_load_dwordx4 v9, s[52:55], s13 offen  lds
    s_add_u32 m0, s15, 7168
    s_nop 0
    buffer_load_dwordx4 v11, s[56:59], s13 offen  lds
    s_add_u32 s13, s13, 663552
    s_add_u32 m0, s15, 24576
    s_nop 0
    buffer_load_dwordx4 v8, s[52:55], s13 offen  lds
    s_add_u32 m0, s15, 25600
    s_nop 0
    buffer_load_dwordx4 v10, s[56:59], s13 offen  lds
    s_add_u32 s13, s13, 73728
    s_waitcnt vmcnt(9)
    s_add_u32 m0, s15, 26624
    s_nop 0
    buffer_load_dwordx4 v9, s[52:55], s13 offen  lds
    s_waitcnt vmcnt(9)
    s_add_u32 m0, s15, 27648
    s_nop 0
    buffer_load_dwordx4 v11, s[56:59], s13 offen  lds
    s_add_u32 s13, s13, 73728
    s_waitcnt vmcnt(9)
    s_add_u32 m0, s15, 28672
    s_nop 0
    buffer_load_dwordx4 v8, s[52:55], s13 offen  lds
    s_waitcnt vmcnt(9)
    s_add_u32 m0, s15, 29696
    s_nop 0
    buffer_load_dwordx4 v10, s[56:59], s13 offen  lds
    s_add_u32 s13, s13, 73728
    s_waitcnt vmcnt(9)
    s_add_u32 m0, s15, 30720
    s_nop 0
    buffer_load_dwordx4 v9, s[52:55], s13 offen  lds
    s_waitcnt vmcnt(9)
    s_add_u32 m0, s15, 31744
    s_nop 0
    buffer_load_dwordx4 v11, s[56:59], s13 offen  lds
    s_add_u32 s13, s13, 663552
    s_waitcnt vmcnt(9)
    s_add_u32 m0, s15, 49152
    s_nop 0
    buffer_load_dwordx4 v8, s[52:55], s13 offen  lds
    s_waitcnt vmcnt(9)
    v_mov_b32 v14, 1
    s_mov_b64 exec, 1
    ds_add_u32 v1, v14 offset:16
    s_mov_b64 exec, -1
    s_add_u32 m0, s15, 50176
    s_nop 0
    buffer_load_dwordx4 v10, s[56:59], s13 offen  lds
    s_add_u32 s13, s13, 73728
    s_waitcnt vmcnt(9)
    s_add_u32 m0, s15, 51200
    s_nop 0
    buffer_load_dwordx4 v9, s[52:55], s13 offen  lds
    s_waitcnt vmcnt(9)
    s_add_u32 m0, s15, 52224
    s_nop 0
    buffer_load_dwordx4 v11, s[56:59], s13 offen  lds
    s_add_u32 s13, s13, 73728
    s_waitcnt vmcnt(9)
    s_add_u32 m0, s15, 53248
    s_nop 0
    buffer_load_dwordx4 v8, s[52:55], s13 offen  lds
    s_waitcnt vmcnt(9)
    s_add_u32 m0, s15, 54272
    s_nop 0
    buffer_load_dwordx4 v10, s[56:59], s13 offen  lds
    s_add_u32 s13, s13, 73728
    s_waitcnt vmcnt(9)
    s_add_u32 m0, s15, 55296
    s_nop 0
    buffer_load_dwordx4 v9, s[52:55], s13 offen  lds
    s_waitcnt vmcnt(9)
    s_add_u32 m0, s15, 56320
    s_nop 0
    buffer_load_dwordx4 v11, s[56:59], s13 offen  lds
    s_add_u32 s13, s13, 663552
    s_mov_b32 s9, 0
SP_2:
    ds_read_b32 v14, v1 offset:48
    s_waitcnt lgkmcnt(0)
    v_readfirstlane_b32 s8, v14
    s_add_u32 s9, s9, 1
    s_cmp_ge_u32 s8, 4
    s_cbranch_scc1 SP_2_D
    s_cmp_lt_u32 s9, 524288
    s_cbranch_scc1 SP_2
SP_2_D:
    s_waitcnt vmcnt(9)
    s_add_u32 m0, s15, 0
    s_nop 0
    buffer_load_dwordx4 v8, s[52:55], s13 offen  lds
    s_waitcnt vmcnt(9)
    v_mov_b32 v14, 1
    s_mov_b64 exec, 1
    ds_add_u32 v1, v14 offset:20
    s_mov_b64 exec, -1
    s_add_u32 m0, s15, 1024
    s_nop 0
    buffer_load_dwordx4 v10, s[56:59], s13 offen  lds
    s_add_u32 s13, s13, 73728
    s_waitcnt vmcnt(9)
    s_add_u32 m0, s15, 2048
    s_nop 0
    buffer_load_dwordx4 v9, s[52:55], s13 offen  lds
    s_waitcnt vmcnt(9)
    s_add_u32 m0, s15, 3072
    s_nop 0
    buffer_load_dwordx4 v11, s[56:59], s13 offen  lds
    s_add_u32 s13, s13, 73728
    s_waitcnt vmcnt(9)
    s_add_u32 m0, s15, 4096
    s_nop 0
    buffer_load_dwordx4 v8, s[52:55], s13 offen  lds
    s_waitcnt vmcnt(9)
    s_add_u32 m0, s15, 5120
    s_nop 0
    buffer_load_dwordx4 v10, s[56:59], s13 offen  lds
    s_add_u32 s13, s13, 73728
    s_waitcnt vmcnt(9)
    s_add_u32 m0, s15, 6144
    s_nop 0
    buffer_load_dwordx4 v9, s[52:55], s13 offen  lds
    s_waitcnt vmcnt(9)
    s_add_u32 m0, s15, 7168
    s_nop 0
    buffer_load_dwordx4 v11, s[56:59], s13 offen  lds
    s_add_u32 s13, s13, 663552
    s_mov_b32 s9, 0
SP_3:
    ds_read_b32 v14, v1 offset:52
    s_waitcnt lgkmcnt(0)
    v_readfirstlane_b32 s8, v14
    s_add_u32 s9, s9, 1
    s_cmp_ge_u32 s8, 4
    s_cbranch_scc1 SP_3_D
    s_cmp_lt_u32 s9, 524288
    s_cbranch_scc1 SP_3
SP_3_D:
    s_waitcnt vmcnt(9)
    s_add_u32 m0, s15, 24576
    s_nop 0
    buffer_load_dwordx4 v8, s[52:55], s13 offen  lds
    s_waitcnt vmcnt(9)
    v_mov_b32 v14, 1
    s_mov_b64 exec, 1
    ds_add_u32 v1, v14 offset:24
    s_mov_b64 exec, -1
    s_add_u32 m0, s15, 25600
    s_nop 0
    buffer_load_dwordx4 v10, s[56:59], s13 offen  lds
    s_add_u32 s13, s13, 73728
    s_waitcnt vmcnt(9)
    s_add_u32 m0, s15, 26624
    s_nop 0
    buffer_load_dwordx4 v9, s[52:55], s13 offen  lds
    s_waitcnt vmcnt(9)
    s_add_u32 m0, s15, 27648
    s_nop 0
    buffer_load_dwordx4 v11, s[56:59], s13 offen  lds
    s_add_u32 s13, s13, 73728
    s_waitcnt vmcnt(9)
    s_add_u32 m0, s15, 28672
    s_nop 0
    buffer_load_dwordx4 v8, s[52:55], s13 offen  lds
    s_waitcnt vmcnt(9)
    s_add_u32 m0, s15, 29696
    s_nop 0
    buffer_load_dwordx4 v10, s[56:59], s13 offen  lds
    s_add_u32 s13, s13, 73728
    s_waitcnt vmcnt(9)
    s_add_u32 m0, s15, 30720
    s_nop 0
    buffer_load_dwordx4 v9, s[52:55], s13 offen  lds
    s_waitcnt vmcnt(9)
    s_add_u32 m0, s15, 31744
    s_nop 0
    buffer_load_dwordx4 v11, s[56:59], s13 offen  lds
    s_add_u32 s13, s13, 663552
    s_mov_b32 s9, 0
SP_4:
    ds_read_b32 v14, v1 offset:56
    s_waitcnt lgkmcnt(0)
    v_readfirstlane_b32 s8, v14
    s_add_u32 s9, s9, 1
    s_cmp_ge_u32 s8, 4
    s_cbranch_scc1 SP_4_D
    s_cmp_lt_u32 s9, 524288
    s_cbranch_scc1 SP_4
SP_4_D:
    s_waitcnt vmcnt(9)
    s_add_u32 m0, s15, 49152
    s_nop 0
    buffer_load_dwordx4 v8, s[52:55], s13 offen  lds
    s_waitcnt vmcnt(9)
    v_mov_b32 v14, 1
    s_mov_b64 exec, 1
    ds_add_u32 v1, v14 offset:28
    s_mov_b64 exec, -1
    s_add_u32 m0, s15, 50176
    s_nop 0
    buffer_load_dwordx4 v10, s[56:59], s13 offen  lds
    s_add_u32 s13, s13, 73728
    s_waitcnt vmcnt(9)
    s_add_u32 m0, s15, 51200
    s_nop 0
    buffer_load_dwordx4 v9, s[52:55], s13 offen  lds
    s_waitcnt vmcnt(9)
    s_add_u32 m0, s15, 52224
    s_nop 0
    buffer_load_dwordx4 v11, s[56:59], s13 offen  lds
    s_add_u32 s13, s13, 73728
    s_waitcnt vmcnt(9)
    s_add_u32 m0, s15, 53248
    s_nop 0
    buffer_load_dwordx4 v8, s[52:55], s13 offen  lds
    s_waitcnt vmcnt(9)
    s_add_u32 m0, s15, 54272
    s_nop 0
    buffer_load_dwordx4 v10, s[56:59], s13 offen  lds
    s_add_u32 s13, s13, 73728
    s_waitcnt vmcnt(9)
    s_add_u32 m0, s15, 55296
    s_nop 0
    buffer_load_dwordx4 v9, s[52:55], s13 offen  lds
    s_waitcnt vmcnt(9)
    s_add_u32 m0, s15, 56320
    s_nop 0
    buffer_load_dwordx4 v11, s[56:59], s13 offen  lds
    s_add_u32 s13, s13, 663552
    s_waitcnt vmcnt(9)
    s_add_u32 m0, s14, 0
    s_nop 0
    buffer_load_dwordx4 v12, s[60:63], s11 offen  lds
    s_add_u32 s11, s11, 9216
    s_waitcnt vmcnt(9)
    v_mov_b32 v14, 1
    s_mov_b64 exec, 1
    ds_add_u32 v1, v14 offset:32
    s_mov_b64 exec, -1
    s_add_u32 m0, s14, 1024
    s_nop 0
    buffer_load_dwordx4 v13, s[60:63], s11 offen  lds
    s_add_u32 s11, s11, 9216
    s_waitcnt vmcnt(9)
    s_add_u32 m0, s14, 2048
    s_nop 0
    buffer_load_dwordx4 v12, s[60:63], s11 offen  lds
    s_add_u32 s11, s11, 9216
    s_waitcnt vmcnt(9)
    s_add_u32 m0, s14, 3072
    s_nop 0
    buffer_load_dwordx4 v13, s[60:63], s11 offen  lds
    s_add_u32 s11, s11, 4294939776
    s_waitcnt vmcnt(9)
    s_add_u32 m0, s14, 8192
    s_nop 0
    buffer_load_dwordx4 v12, s[60:63], s11 offen  lds
    s_add_u32 s11, s11, 9216
    s_waitcnt vmcnt(9)
    s_add_u32 m0, s14, 9216
    s_nop 0
    buffer_load_dwordx4 v13, s[60:63], s11 offen  lds
    s_add_u32 s11, s11, 9216
    s_waitcnt vmcnt(9)
    s_add_u32 m0, s14, 10240
    s_nop 0
    buffer_load_dwordx4 v12, s[60:63], s11 offen  lds
    s_add_u32 s11, s11, 9216
    s_waitcnt vmcnt(9)
    s_add_u32 m0, s14, 11264
    s_nop 0
    buffer_load_dwordx4 v13, s[60:63], s11 offen  lds
    s_add_u32 s11, s11, 4294939776
    s_waitcnt vmcnt(9)
    s_add_u32 m0, s14, 16384
    s_nop 0
    buffer_load_dwordx4 v12, s[60:63], s11 offen  lds
    s_add_u32 s11, s11, 9216
    s_waitcnt vmcnt(9)
    v_mov_b32 v14, 1
    s_mov_b64 exec, 1
    ds_add_u32 v1, v14 offset:36
    s_mov_b64 exec, -1
    s_add_u32 m0, s14, 17408
    s_nop 0
    buffer_load_dwordx4 v13, s[60:63], s11 offen  lds
    s_add_u32 s11, s11, 9216
    s_waitcnt vmcnt(9)
    s_add_u32 m0, s14, 18432
    s_nop 0
    buffer_load_dwordx4 v12, s[60:63], s11 offen  lds
    s_add_u32 s11, s11, 9216
    s_waitcnt vmcnt(9)
    s_add_u32 m0, s14, 19456
    s_nop 0
    buffer_load_dwordx4 v13, s[60:63], s11 offen  lds
    s_add_u32 s11, s11, 8960
    s_waitcnt vmcnt(9)
    s_add_u32 m0, s14, 4096
    s_nop 0
    buffer_load_dwordx4 v12, s[60:63], s11 offen  lds
    s_add_u32 s11, s11, 9216
    s_waitcnt vmcnt(9)
    s_add_u32 m0, s14, 5120
    s_nop 0
    buffer_load_dwordx4 v13, s[60:63], s11 offen  lds
    s_add_u32 s11, s11, 9216
    s_waitcnt vmcnt(9)
    s_add_u32 m0, s14, 6144
    s_nop 0
    buffer_load_dwordx4 v12, s[60:63], s11 offen  lds
    s_add_u32 s11, s11, 9216
    s_waitcnt vmcnt(9)
    s_add_u32 m0, s14, 7168
    s_nop 0
    buffer_load_dwordx4 v13, s[60:63], s11 offen  lds
    s_add_u32 s11, s11, 4294939776
    s_waitcnt vmcnt(9)
    s_add_u32 m0, s14, 12288
    s_nop 0
    buffer_load_dwordx4 v12, s[60:63], s11 offen  lds
    s_add_u32 s11, s11, 9216
    s_waitcnt vmcnt(9)
    s_add_u32 m0, s14, 13312
    s_nop 0
    buffer_load_dwordx4 v13, s[60:63], s11 offen  lds
    s_add_u32 s11, s11, 9216
    s_waitcnt vmcnt(9)
    s_add_u32 m0, s14, 14336
    s_nop 0
    buffer_load_dwordx4 v12, s[60:63], s11 offen  lds
    s_add_u32 s11, s11, 9216
    s_waitcnt vmcnt(9)
    s_add_u32 m0, s14, 15360
    s_nop 0
    buffer_load_dwordx4 v13, s[60:63], s11 offen  lds
    s_add_u32 s11, s11, 4294939776
    s_waitcnt vmcnt(9)
    s_add_u32 m0, s14, 20480
    s_nop 0
    buffer_load_dwordx4 v12, s[60:63], s11 offen  lds
    s_add_u32 s11, s11, 9216
    s_waitcnt vmcnt(9)
    v_mov_b32 v14, 1
    s_mov_b64 exec, 1
    ds_add_u32 v1, v14 offset:40
    s_mov_b64 exec, -1
    s_add_u32 m0, s14, 21504
    s_nop 0
    buffer_load_dwordx4 v13, s[60:63], s11 offen  lds
    s_add_u32 s11, s11, 9216
    s_waitcnt vmcnt(9)
    s_add_u32 m0, s14, 22528
    s_nop 0
    buffer_load_dwordx4 v12, s[60:63], s11 offen  lds
    s_add_u32 s11, s11, 9216
    s_waitcnt vmcnt(9)
    s_add_u32 m0, s14, 23552
    s_nop 0
    buffer_load_dwordx4 v13, s[60:63], s11 offen  lds
    s_add_u32 s11, s11, 8960
    s_waitcnt vmcnt(0)
    v_mov_b32 v14, 1
    s_mov_b64 exec, 1
    ds_add_u32 v1, v14 offset:44
    s_mov_b64 exec, -1
    s_endpgm
K_CIO:
    s_sub_u32 s12, s3, 9
    s_cmp_eq_u32 s3, 11
    s_cbranch_scc1 C_LOAD
    s_branch GATE
C_LOAD:
    s_setprio 3
    s_sub_u32 s13, s5, 14
    s_mul_i32 s8, s13, 73728
    s_lshl_b32 s9, s4, 7
    s_add_u32 s8, s8, s9
    v_mul_u32_u24 v9, 1152, v2
    v_add_u32 v9, s8, v9
    s_add_u32 s8, s13, 18
    s_min_u32 s8, s8, 31
    s_sub_u32 s8, s8, s13
    s_mul_i32 s8, s8, 73728
    v_add_u32 v8, s8, v9
    v_mul_u32_u24 v6, 4608, v2
    s_lshl_b32 s8, s7, 3
    v_add_u32 v6, s8, v6
    v_lshlrev_b32 v7, 3, v2
    v_sub_u32 v7, 73464, v7
    s_mov_b32 s56, 0x05040100
    s_mov_b32 s58, 0x07060302
    s_mul_i32 s8, s4, 663552
    s_mul_i32 s9, s13, 36864
    s_add_u32 s8, s8, s9
    v_lshl_add_u32 v14, v2, 7, s8
    v_min_u32 v15, 31, v2
    v_lshl_add_u32 v15, v15, 7, s8
    s_mov_b32 s57, s13
    s_waitcnt lgkmcnt(0)
    s_mov_b32 s72, s16
    s_mov_b32 s73, s17
    s_mov_b32 s74, 2359296
    s_mov_b32 s75, 0x20000
    s_mov_b32 s9, 0
SP_5:
    ds_read_b32 v12, v1 offset:4
    s_waitcnt lgkmcnt(0)
    v_readfirstlane_b32 s8, v12
    s_add_u32 s9, s9, 1
    s_cmp_ge_u32 s8, 1
    s_cbranch_scc1 SP_5_D
    s_cmp_lt_u32 s9, 524288
    s_cbranch_scc1 SP_5
SP_5_D:
    global_load_dword v10, v9, s[16:17]
    global_load_dword v11, v9, s[16:17] offset:128
    global_load_dword v10, v8, s[16:17]
    global_load_dword v11, v8, s[16:17] offset:128
    s_mul_i32 s7, s4, 18
    s_add_u32 s7, s7, s5
    s_sub_u32 s7, s7, 14
    s_lshl_b32 s55, s7, 3
    s_sub_u32 s12, s3, 8
    s_mov_b32 s60, s46
    s_mov_b32 s61, s47
    s_mov_b32 s62, 2359296
    s_mov_b32 s63, 0x20000
    v_mov_b32 v24, 0
    v_mov_b32 v25, 0
    v_mov_b32 v26, 0
    v_mov_b32 v27, 0
    v_lshrrev_b32 v28, 2, v2
    v_mul_u32_u24 v28, 2240, v28
    v_add_u32 v28, 37120, v28
    v_and_b32 v29, 3, v2
    v_lshl_add_u32 v30, v29, 4, v28
    ds_write_b128 v30, v[24:27] offset:2096
    v_and_b32 v29, 1, v2
    v_lshl_add_u32 v30, v29, 4, v28
    ds_write_b128 v30, v[24:27]
    v_lshrrev_b32 v28, 5, v2
    v_mul_u32_u24 v28, 4672, v28
    v_and_b32 v29, 31, v2
    v_lshl_add_u32 v30, v29, 4, v28
    v_add_u32 v30, 77056, v30
    ds_write_b128 v30, v[24:27]
    ds_write_b128 v30, v[24:27] offset:9344
    s_mov_b32 s15, 0
    v_mov_b32 v12, 1
    s_waitcnt vmcnt(2)
    buffer_load_dwordx2 v[104:105], v6, s[72:75], s15 offen offset:0
    buffer_load_dwordx2 v[106:107], v6, s[72:75], s15 offen offset:1152
    buffer_load_dwordx2 v[108:109], v6, s[72:75], s15 offen offset:2304
    buffer_load_dwordx2 v[110:111], v6, s[72:75], s15 offen offset:3456
    s_add_u32 s15, s15, 294912
    buffer_load_dwordx2 v[112:113], v6, s[72:75], s15 offen offset:0
    s_waitcnt vmcnt(4)
    buffer_load_dwordx2 v[114:115], v6, s[72:75], s15 offen offset:1152
    s_waitcnt vmcnt(4)
    buffer_load_dwordx2 v[116:117], v6, s[72:75], s15 offen offset:2304
    s_waitcnt vmcnt(4)
    buffer_load_dwordx2 v[118:119], v6, s[72:75], s15 offen offset:3456
    s_add_u32 s15, s15, 294912
    s_waitcnt vmcnt(4)
    buffer_load_dwordx2 v[120:121], v6, s[72:75], s15 offen offset:0
    v_perm_b32 v16, v108, v110, s56
    v_perm_b32 v17, v104, v106, s56
    ds_write_b64 v7, v[16:17] offset:3584
    v_perm_b32 v18, v108, v110, s58
    v_perm_b32 v19, v104, v106, s58
    ds_write_b64 v7, v[18:19] offset:8256
    v_perm_b32 v20, v109, v111, s56
    v_perm_b32 v21, v105, v107, s56
    ds_write_b64 v7, v[20:21] offset:12928
    v_perm_b32 v22, v109, v111, s58
    v_perm_b32 v23, v105, v107, s58
    ds_write_b64 v7, v[22:23] offset:17600
    s_waitcnt vmcnt(4)
    buffer_load_dwordx2 v[122:123], v6, s[72:75], s15 offen offset:1152
    s_waitcnt vmcnt(4)
    buffer_load_dwordx2 v[124:125], v6, s[72:75], s15 offen offset:2304
    s_waitcnt vmcnt(4)
    buffer_load_dwordx2 v[126:127], v6, s[72:75], s15 offen offset:3456
    s_add_u32 s15, s15, 294912
    s_waitcnt vmcnt(4)
    buffer_load_dwordx2 v[128:129], v6, s[72:75], s15 offen offset:0
    v_perm_b32 v24, v116, v118, s56
    v_perm_b32 v25, v112, v114, s56
    ds_write_b64 v7, v[24:25] offset:3072
    v_perm_b32 v26, v116, v118, s58
    v_perm_b32 v27, v112, v114, s58
    ds_write_b64 v7, v[26:27] offset:7744
    v_perm_b32 v28, v117, v119, s56
    v_perm_b32 v29, v113, v115, s56
    ds_write_b64 v7, v[28:29] offset:12416
    v_perm_b32 v30, v117, v119, s58
    v_perm_b32 v31, v113, v115, s58
    ds_write_b64 v7, v[30:31] offset:17088
    s_waitcnt vmcnt(4)
    buffer_load_dwordx2 v[130:131], v6, s[72:75], s15 offen offset:1152
    s_waitcnt vmcnt(4)
    buffer_load_dwordx2 v[132:133], v6, s[72:75], s15 offen offset:2304
    s_waitcnt vmcnt(4)
    buffer_load_dwordx2 v[134:135], v6, s[72:75], s15 offen offset:3456
    s_add_u32 s15, s15, 294912
    s_waitcnt vmcnt(4)
    buffer_load_dwordx2 v[136:137], v6, s[72:75], s15 offen offset:0
    v_perm_b32 v16, v124, v126, s56
    v_perm_b32 v17, v120, v122, s56
    ds_write_b64 v7, v[16:17] offset:2560
    v_perm_b32 v18, v124, v126, s58
    v_perm_b32 v19, v120, v122, s58
    ds_write_b64 v7, v[18:19] offset:7232
    v_perm_b32 v20, v125, v127, s56
    v_perm_b32 v21, v121, v123, s56
    ds_write_b64 v7, v[20:21] offset:11904
    v_perm_b32 v22, v125, v127, s58
    v_perm_b32 v23, v121, v123, s58
    ds_write_b64 v7, v[22:23] offset:16576
    s_waitcnt vmcnt(4)
    buffer_load_dwordx2 v[138:139], v6, s[72:75], s15 offen offset:1152
    s_waitcnt vmcnt(4)
    buffer_load_dwordx2 v[140:141], v6, s[72:75], s15 offen offset:2304
    s_waitcnt vmcnt(4)
    buffer_load_dwordx2 v[142:143], v6, s[72:75], s15 offen offset:3456
    s_add_u32 s15, s15, 294912
    s_waitcnt vmcnt(4)
    buffer_load_dwordx2 v[144:145], v6, s[72:75], s15 offen offset:0
    v_perm_b32 v24, v132, v134, s56
    v_perm_b32 v25, v128, v130, s56
    ds_write_b64 v7, v[24:25] offset:2048
    v_perm_b32 v26, v132, v134, s58
    v_perm_b32 v27, v128, v130, s58
    ds_write_b64 v7, v[26:27] offset:6720
    v_perm_b32 v28, v133, v135, s56
    v_perm_b32 v29, v129, v131, s56
    ds_write_b64 v7, v[28:29] offset:11392
    v_perm_b32 v30, v133, v135, s58
    v_perm_b32 v31, v129, v131, s58
    ds_write_b64 v7, v[30:31] offset:16064
    ds_write_b32 v1, v12 offset:80
    s_waitcnt vmcnt(4)
    buffer_load_dwordx2 v[146:147], v6, s[72:75], s15 offen offset:1152
    s_waitcnt vmcnt(4)
    buffer_load_dwordx2 v[148:149], v6, s[72:75], s15 offen offset:2304
    s_waitcnt vmcnt(4)
    buffer_load_dwordx2 v[150:151], v6, s[72:75], s15 offen offset:3456
    s_add_u32 s15, s15, 294912
    s_waitcnt vmcnt(4)
    buffer_load_dwordx2 v[152:153], v6, s[72:75], s15 offen offset:0
    v_perm_b32 v16, v140, v142, s56
    v_perm_b32 v17, v136, v138, s56
    ds_write_b64 v7, v[16:17] offset:1536
    v_perm_b32 v18, v140, v142, s58
    v_perm_b32 v19, v136, v138, s58
    ds_write_b64 v7, v[18:19] offset:6208
    v_perm_b32 v20, v141, v143, s56
    v_perm_b32 v21, v137, v139, s56
    ds_write_b64 v7, v[20:21] offset:10880
    v_perm_b32 v22, v141, v143, s58
    v_perm_b32 v23, v137, v139, s58
    ds_write_b64 v7, v[22:23] offset:15552
    s_waitcnt vmcnt(4)
    buffer_load_dwordx2 v[154:155], v6, s[72:75], s15 offen offset:1152
    s_waitcnt vmcnt(4)
    buffer_load_dwordx2 v[156:157], v6, s[72:75], s15 offen offset:2304
    s_waitcnt vmcnt(4)
    buffer_load_dwordx2 v[158:159], v6, s[72:75], s15 offen offset:3456
    s_add_u32 s15, s15, 294912
    s_waitcnt vmcnt(4)
    buffer_load_dwordx2 v[160:161], v6, s[72:75], s15 offen offset:0
    v_perm_b32 v24, v148, v150, s56
    v_perm_b32 v25, v144, v146, s56
    ds_write_b64 v7, v[24:25] offset:1024
    v_perm_b32 v26, v148, v150, s58
    v_perm_b32 v27, v144, v146, s58
    ds_write_b64 v7, v[26:27] offset:5696
    v_perm_b32 v28, v149, v151, s56
    v_perm_b32 v29, v145, v147, s56
    ds_write_b64 v7, v[28:29] offset:10368
    v_perm_b32 v30, v149, v151, s58
    v_perm_b32 v31, v145, v147, s58
    ds_write_b64 v7, v[30:31] offset:15040
    s_waitcnt vmcnt(4)
    buffer_load_dwordx2 v[162:163], v6, s[72:75], s15 offen offset:1152
    s_waitcnt vmcnt(4)
    buffer_load_dwordx2 v[164:165], v6, s[72:75], s15 offen offset:2304
    s_waitcnt vmcnt(4)
    buffer_load_dwordx2 v[166:167], v6, s[72:75], s15 offen offset:3456
    s_add_u32 s15, s15, 294912
    v_add_u32 v88, 0, v14
    global_load_dword v96, v88, s[42:43]
    v_add_u32 v89, 8192, v14
    global_load_dword v97, v89, s[42:43]
    v_add_u32 v90, 16384, v14
    global_load_dword v98, v90, s[42:43]
    v_add_u32 v91, 24576, v14
    global_load_dword v99, v91, s[42:43]
    v_add_u32 v92, 32768, v15
    global_load_dword v100, v92, s[42:43]
    s_waitcnt vmcnt(9)
    v_perm_b32 v16, v156, v158, s56
    v_perm_b32 v17, v152, v154, s56
    ds_write_b64 v7, v[16:17] offset:512
    v_perm_b32 v18, v156, v158, s58
    v_perm_b32 v19, v152, v154, s58
    ds_write_b64 v7, v[18:19] offset:5184
    v_perm_b32 v20, v157, v159, s56
    v_perm_b32 v21, v153, v155, s56
    ds_write_b64 v7, v[20:21] offset:9856
    v_perm_b32 v22, v157, v159, s58
    v_perm_b32 v23, v153, v155, s58
    ds_write_b64 v7, v[22:23] offset:14528
    s_waitcnt vmcnt(8)
    s_waitcnt vmcnt(7)
    s_waitcnt vmcnt(6)
    s_waitcnt vmcnt(5)
    v_perm_b32 v24, v164, v166, s56
    v_perm_b32 v25, v160, v162, s56
    ds_write_b64 v7, v[24:25] offset:0
    v_perm_b32 v26, v164, v166, s58
    v_perm_b32 v27, v160, v162, s58
    ds_write_b64 v7, v[26:27] offset:4672
    v_perm_b32 v28, v165, v167, s56
    v_perm_b32 v29, v161, v163, s56
    ds_write_b64 v7, v[28:29] offset:9344
    v_perm_b32 v30, v165, v167, s58
    v_perm_b32 v31, v161, v163, s58
    ds_write_b64 v7, v[30:31] offset:14016
    ds_write_b32 v1, v12 offset:84
    s_branch C_IO2
C_IO:
    s_mul_i32 s7, s4, 18
    s_add_u32 s7, s7, s5
    s_sub_u32 s7, s7, 14
    s_lshl_b32 s55, s7, 3
    s_sub_u32 s12, s3, 8
    s_mov_b32 s60, s46
    s_mov_b32 s61, s47
    s_mov_b32 s62, 2359296
    s_mov_b32 s63, 0x20000
C_IO2:
    s_lshl_b32 s14, s12, 2
    s_lshl_b32 s8, s14, 8
    s_add_u32 s8, s8, 8192
    v_xor_b32 v5, 63, v2
    v_lshrrev_b32 v5, 1, v5
    v_lshl_add_u32 v5, v5, 3, s8
    v_add_u32 v6, 4096, v5
    s_mov_b32 s9, 0
SP_6:
    ds_read_b32 v10, v1 offset:8
    s_waitcnt lgkmcnt(0)
    v_readfirstlane_b32 s8, v10
    s_add_u32 s9, s9, 1
    s_cmp_lg_u32 s8, 0
    s_cbranch_scc1 SP_6_D
    s_cmp_lt_u32 s9, 524288
    s_cbranch_scc1 SP_6
SP_6_D:
    s_setprio 3
    s_mov_b32 s9, 0
SP_7:
    ds_read_b32 v12, v1 offset:80
    s_waitcnt lgkmcnt(0)
    v_readfirstlane_b32 s8, v12
    s_add_u32 s9, s9, 1
    s_cmp_ge_u32 s8, 1
    s_cbranch_scc1 SP_7_D
    s_sleep 2
    s_cmp_lt_u32 s9, 524288
    s_cbranch_scc1 SP_7
SP_7_D:
    s_setprio 3
    global_load_dwordx2 v[104:105], v5, s[50:51] offset:0 sc1
    global_load_dwordx2 v[106:107], v5, s[50:51] offset:256 sc1
    global_load_dwordx2 v[108:109], v5, s[50:51] offset:512 sc1
    global_load_dwordx2 v[110:111], v5, s[50:51] offset:768 sc1
    global_load_dwordx2 v[112:113], v6, s[50:51] offset:0 sc1
    global_load_dwordx2 v[114:115], v6, s[50:51] offset:256 sc1
    global_load_dwordx2 v[116:117], v6, s[50:51] offset:512 sc1
    global_load_dwordx2 v[118:119], v6, s[50:51] offset:768 sc1
    v_bfe_u32 v12, v2, 2, 2
    v_mul_u32_u24 v12, 4672, v12
    v_and_b32 v13, 3, v2
    v_lshl_add_u32 v13, v4, 2, v13
    v_lshl_add_u32 v12, v13, 3, v12
    s_lshl_b32 s8, s14, 7
    s_sub_u32 s8, 76544, s8
    v_add_u32 v12, s8, v12
    ds_read_b64_tr_b16 v[44:45], v12 offset:384
    ds_read_b64_tr_b16 v[50:51], v12 offset:256
    ds_read_b64_tr_b16 v[56:57], v12 offset:128
    ds_read_b64_tr_b16 v[62:63], v12 offset:0
    s_waitcnt lgkmcnt(0)
    v_lshlrev_b32 v40, 16, v44
    v_and_b32 v41, 0xffff0000, v44
    v_lshlrev_b32 v42, 16, v45
    v_and_b32 v43, 0xffff0000, v45
    v_lshlrev_b32 v46, 16, v50
    v_and_b32 v47, 0xffff0000, v50
    v_lshlrev_b32 v48, 16, v51
    v_and_b32 v49, 0xffff0000, v51
    v_lshlrev_b32 v52, 16, v56
    v_and_b32 v53, 0xffff0000, v56
    v_lshlrev_b32 v54, 16, v57
    v_and_b32 v55, 0xffff0000, v57
    v_lshlrev_b32 v58, 16, v62
    v_and_b32 v59, 0xffff0000, v62
    v_lshlrev_b32 v60, 16, v63
    v_and_b32 v61, 0xffff0000, v63
    s_mov_b32 s9, 0
GP_8:
    s_waitcnt vmcnt(0)
    v_xor_b32 v14, v105, v10
    v_bitop3_b32 v14, v14, v107, v10 bitop3:0xf6
    v_bitop3_b32 v14, v14, v109, v10 bitop3:0xf6
    v_bitop3_b32 v14, v14, v111, v10 bitop3:0xf6
    v_bitop3_b32 v14, v14, v113, v10 bitop3:0xf6
    v_bitop3_b32 v14, v14, v115, v10 bitop3:0xf6
    v_bitop3_b32 v14, v14, v117, v10 bitop3:0xf6
    v_bitop3_b32 v14, v14, v119, v10 bitop3:0xf6
    v_cmp_ne_u32 vcc, 0, v14
    s_add_u32 s9, s9, 1
    s_cmp_eq_u64 vcc, 0
    s_cbranch_scc1 GP_8_D
    s_cmp_ge_u32 s9, 131072
    s_cbranch_scc1 GP_8_D
    global_load_dwordx2 v[104:105], v5, s[50:51] offset:0 sc1
    global_load_dwordx2 v[106:107], v5, s[50:51] offset:256 sc1
    global_load_dwordx2 v[108:109], v5, s[50:51] offset:512 sc1
    global_load_dwordx2 v[110:111], v5, s[50:51] offset:768 sc1
    global_load_dwordx2 v[112:113], v6, s[50:51] offset:0 sc1
    global_load_dwordx2 v[114:115], v6, s[50:51] offset:256 sc1
    global_load_dwordx2 v[116:117], v6, s[50:51] offset:512 sc1
    global_load_dwordx2 v[118:119], v6, s[50:51] offset:768 sc1
    s_branch GP_8
GP_8_D:
    v_and_b32 v11, 1, v2
    v_lshlrev_b32 v11, 4, v11
    s_lshl_b32 s8, s14, 8
    s_add_u32 s8, s8, 91648
    v_xor_b32 v12, 63, v2
    v_lshl_add_u32 v12, v12, 2, s8
    v_lshlrev_b32 v44, v11, v104
    v_lshlrev_b32 v50, v11, v106
    v_lshlrev_b32 v56, v11, v108
    v_lshlrev_b32 v62, v11, v110
    v_and_b32 v44, 0xffff0000, v44
    v_and_b32 v50, 0xffff0000, v50
    v_and_b32 v56, 0xffff0000, v56
    v_and_b32 v62, 0xffff0000, v62
    v_sub_f32 v45, 1.0, v44
    v_sub_f32 v51, 1.0, v50
    v_sub_f32 v57, 1.0, v56
    v_sub_f32 v63, 1.0, v62
    v_cvt_pk_bf16_f32 v45, v45, v45
    v_cvt_pk_bf16_f32 v51, v51, v51
    v_cvt_pk_bf16_f32 v57, v57, v57
    v_cvt_pk_bf16_f32 v63, v63, v63
    v_and_b32 v45, 0xffff0000, v45
    v_and_b32 v51, 0xffff0000, v51
    v_and_b32 v57, 0xffff0000, v57
    v_and_b32 v63, 0xffff0000, v63
    v_mul_f32 v40, v40, v45
    v_mul_f32 v41, v41, v45
    v_mul_f32 v42, v42, v45
    v_mul_f32 v43, v43, v45
    ds_write_b32 v12, v44 offset:0
    v_mul_f32 v46, v46, v51
    v_mul_f32 v47, v47, v51
    v_mul_f32 v48, v48, v51
    v_mul_f32 v49, v49, v51
    ds_write_b32 v12, v50 offset:256
    v_mul_f32 v52, v52, v57
    v_mul_f32 v53, v53, v57
    v_mul_f32 v54, v54, v57
    v_mul_f32 v55, v55, v57
    ds_write_b32 v12, v56 offset:512
    v_mul_f32 v58, v58, v63
    v_mul_f32 v59, v59, v63
    v_mul_f32 v60, v60, v63
    v_mul_f32 v61, v61, v63
    ds_write_b32 v12, v62 offset:768
    v_bfe_u32 v12, v2, 2, 2
    v_mul_u32_u24 v12, 4160, v12
    v_and_b32 v13, 3, v2
    v_lshl_add_u32 v13, v4, 2, v13
    v_lshl_add_u32 v12, v13, 3, v12
    s_lshl_b32 s8, s14, 7
    s_sub_u32 s8, 103424, s8
    v_add_u32 v12, s8, v12
    v_xor_b32 v14, 63, v2
    v_mul_u32_u24 v14, 1152, v14
    v_add_u32 v14, s55, v14
    s_mul_i32 s15, s14, 73728
    s_setprio 3
    s_mov_b32 s9, 0
SP_9:
    ds_read_b32 v15, v1 offset:96
    s_waitcnt lgkmcnt(0)
    v_readfirstlane_b32 s8, v15
    s_add_u32 s9, s9, 1
    s_cmp_ge_u32 s8, 4
    s_cbranch_scc1 SP_9_D
    s_sleep 1
    s_cmp_lt_u32 s9, 524288
    s_cbranch_scc1 SP_9
SP_9_D:
    s_setprio 3
    ds_read_b64_tr_b16 v[16:17], v12 offset:384
    ds_read_b64_tr_b16 v[18:19], v12 offset:256
    ds_read_b64_tr_b16 v[20:21], v12 offset:128
    ds_read_b64_tr_b16 v[22:23], v12 offset:0
    s_waitcnt lgkmcnt(3)
    v_lshlrev_b32 v24, 16, v16
    v_and_b32 v25, 0xffff0000, v16
    v_lshlrev_b32 v26, 16, v17
    v_and_b32 v27, 0xffff0000, v17
    v_fmac_f32 v40, v24, v44
    v_fmac_f32 v41, v25, v44
    v_fmac_f32 v42, v26, v44
    v_fmac_f32 v43, v27, v44
    v_cvt_pk_bf16_f32 v40, v40, v41
    v_cvt_pk_bf16_f32 v41, v42, v43
    buffer_store_dwordx2 v[40:41], v14, s[60:63], s15 offen
    s_add_u32 s15, s15, 73728
    s_waitcnt lgkmcnt(2)
    v_lshlrev_b32 v28, 16, v18
    v_and_b32 v29, 0xffff0000, v18
    v_lshlrev_b32 v30, 16, v19
    v_and_b32 v31, 0xffff0000, v19
    v_fmac_f32 v46, v28, v50
    v_fmac_f32 v47, v29, v50
    v_fmac_f32 v48, v30, v50
    v_fmac_f32 v49, v31, v50
    v_cvt_pk_bf16_f32 v46, v46, v47
    v_cvt_pk_bf16_f32 v47, v48, v49
    buffer_store_dwordx2 v[46:47], v14, s[60:63], s15 offen
    s_add_u32 s15, s15, 73728
    s_waitcnt lgkmcnt(1)
    v_lshlrev_b32 v32, 16, v20
    v_and_b32 v33, 0xffff0000, v20
    v_lshlrev_b32 v34, 16, v21
    v_and_b32 v35, 0xffff0000, v21
    v_fmac_f32 v52, v32, v56
    v_fmac_f32 v53, v33, v56
    v_fmac_f32 v54, v34, v56
    v_fmac_f32 v55, v35, v56
    v_cvt_pk_bf16_f32 v52, v52, v53
    v_cvt_pk_bf16_f32 v53, v54, v55
    buffer_store_dwordx2 v[52:53], v14, s[60:63], s15 offen
    s_add_u32 s15, s15, 73728
    s_waitcnt lgkmcnt(0)
    v_lshlrev_b32 v36, 16, v22
    v_and_b32 v37, 0xffff0000, v22
    v_lshlrev_b32 v38, 16, v23
    v_and_b32 v39, 0xffff0000, v23
    v_fmac_f32 v58, v36, v62
    v_fmac_f32 v59, v37, v62
    v_fmac_f32 v60, v38, v62
    v_fmac_f32 v61, v39, v62
    v_cvt_pk_bf16_f32 v58, v58, v59
    v_cvt_pk_bf16_f32 v59, v60, v61
    buffer_store_dwordx2 v[58:59], v14, s[60:63], s15 offen
    s_add_u32 s15, s15, 73728
    s_setprio 3
    s_mov_b32 s9, 0
SP_10:
    ds_read_b32 v12, v1 offset:84
    s_waitcnt lgkmcnt(0)
    v_readfirstlane_b32 s8, v12
    s_add_u32 s9, s9, 1
    s_cmp_ge_u32 s8, 1
    s_cbranch_scc1 SP_10_D
    s_sleep 2
    s_cmp_lt_u32 s9, 524288
    s_cbranch_scc1 SP_10
SP_10_D:
    s_setprio 3
    s_add_u32 s14, s14, 16
    v_bfe_u32 v12, v2, 2, 2
    v_mul_u32_u24 v12, 4672, v12
    v_and_b32 v13, 3, v2
    v_lshl_add_u32 v13, v4, 2, v13
    v_lshl_add_u32 v12, v13, 3, v12
    s_lshl_b32 s8, s14, 7
    s_sub_u32 s8, 76544, s8
    v_add_u32 v12, s8, v12
    ds_read_b64_tr_b16 v[68:69], v12 offset:384
    ds_read_b64_tr_b16 v[74:75], v12 offset:256
    ds_read_b64_tr_b16 v[80:81], v12 offset:128
    ds_read_b64_tr_b16 v[86:87], v12 offset:0
    s_waitcnt lgkmcnt(0)
    v_lshlrev_b32 v64, 16, v68
    v_and_b32 v65, 0xffff0000, v68
    v_lshlrev_b32 v66, 16, v69
    v_and_b32 v67, 0xffff0000, v69
    v_lshlrev_b32 v70, 16, v74
    v_and_b32 v71, 0xffff0000, v74
    v_lshlrev_b32 v72, 16, v75
    v_and_b32 v73, 0xffff0000, v75
    v_lshlrev_b32 v76, 16, v80
    v_and_b32 v77, 0xffff0000, v80
    v_lshlrev_b32 v78, 16, v81
    v_and_b32 v79, 0xffff0000, v81
    v_lshlrev_b32 v82, 16, v86
    v_and_b32 v83, 0xffff0000, v86
    v_lshlrev_b32 v84, 16, v87
    v_and_b32 v85, 0xffff0000, v87
    v_and_b32 v11, 1, v2
    v_lshlrev_b32 v11, 4, v11
    s_lshl_b32 s8, s14, 8
    s_add_u32 s8, s8, 91648
    v_xor_b32 v12, 63, v2
    v_lshl_add_u32 v12, v12, 2, s8
    v_lshlrev_b32 v68, v11, v112
    v_lshlrev_b32 v74, v11, v114
    v_lshlrev_b32 v80, v11, v116
    v_lshlrev_b32 v86, v11, v118
    v_and_b32 v68, 0xffff0000, v68
    v_and_b32 v74, 0xffff0000, v74
    v_and_b32 v80, 0xffff0000, v80
    v_and_b32 v86, 0xffff0000, v86
    v_sub_f32 v69, 1.0, v68
    v_sub_f32 v75, 1.0, v74
    v_sub_f32 v81, 1.0, v80
    v_sub_f32 v87, 1.0, v86
    v_cvt_pk_bf16_f32 v69, v69, v69
    v_cvt_pk_bf16_f32 v75, v75, v75
    v_cvt_pk_bf16_f32 v81, v81, v81
    v_cvt_pk_bf16_f32 v87, v87, v87
    v_and_b32 v69, 0xffff0000, v69
    v_and_b32 v75, 0xffff0000, v75
    v_and_b32 v81, 0xffff0000, v81
    v_and_b32 v87, 0xffff0000, v87
    v_mul_f32 v64, v64, v69
    v_mul_f32 v65, v65, v69
    v_mul_f32 v66, v66, v69
    v_mul_f32 v67, v67, v69
    ds_write_b32 v12, v68 offset:0
    v_mul_f32 v70, v70, v75
    v_mul_f32 v71, v71, v75
    v_mul_f32 v72, v72, v75
    v_mul_f32 v73, v73, v75
    ds_write_b32 v12, v74 offset:256
    v_mul_f32 v76, v76, v81
    v_mul_f32 v77, v77, v81
    v_mul_f32 v78, v78, v81
    v_mul_f32 v79, v79, v81
    ds_write_b32 v12, v80 offset:512
    v_mul_f32 v82, v82, v87
    v_mul_f32 v83, v83, v87
    v_mul_f32 v84, v84, v87
    v_mul_f32 v85, v85, v87
    ds_write_b32 v12, v86 offset:768
    v_bfe_u32 v12, v2, 2, 2
    v_mul_u32_u24 v12, 4160, v12
    v_and_b32 v13, 3, v2
    v_lshl_add_u32 v13, v4, 2, v13
    v_lshl_add_u32 v12, v13, 3, v12
    s_lshl_b32 s8, s14, 7
    s_sub_u32 s8, 103424, s8
    v_add_u32 v12, s8, v12
    v_xor_b32 v14, 63, v2
    v_mul_u32_u24 v14, 1152, v14
    v_add_u32 v14, s55, v14
    s_mul_i32 s15, s14, 73728
    s_setprio 3
    s_mov_b32 s9, 0
SP_11:
    ds_read_b32 v15, v1 offset:100
    s_waitcnt lgkmcnt(0)
    v_readfirstlane_b32 s8, v15
    s_add_u32 s9, s9, 1
    s_cmp_ge_u32 s8, 4
    s_cbranch_scc1 SP_11_D
    s_sleep 1
    s_cmp_lt_u32 s9, 524288
    s_cbranch_scc1 SP_11
SP_11_D:
    s_setprio 3
    ds_read_b64_tr_b16 v[16:17], v12 offset:384
    ds_read_b64_tr_b16 v[18:19], v12 offset:256
    ds_read_b64_tr_b16 v[20:21], v12 offset:128
    ds_read_b64_tr_b16 v[22:23], v12 offset:0
    s_waitcnt lgkmcnt(3)
    v_lshlrev_b32 v24, 16, v16
    v_and_b32 v25, 0xffff0000, v16
    v_lshlrev_b32 v26, 16, v17
    v_and_b32 v27, 0xffff0000, v17
    v_fmac_f32 v64, v24, v68
    v_fmac_f32 v65, v25, v68
    v_fmac_f32 v66, v26, v68
    v_fmac_f32 v67, v27, v68
    v_cvt_pk_bf16_f32 v64, v64, v65
    v_cvt_pk_bf16_f32 v65, v66, v67
    buffer_store_dwordx2 v[64:65], v14, s[60:63], s15 offen
    s_add_u32 s15, s15, 73728
    s_waitcnt lgkmcnt(2)
    v_lshlrev_b32 v28, 16, v18
    v_and_b32 v29, 0xffff0000, v18
    v_lshlrev_b32 v30, 16, v19
    v_and_b32 v31, 0xffff0000, v19
    v_fmac_f32 v70, v28, v74
    v_fmac_f32 v71, v29, v74
    v_fmac_f32 v72, v30, v74
    v_fmac_f32 v73, v31, v74
    v_cvt_pk_bf16_f32 v70, v70, v71
    v_cvt_pk_bf16_f32 v71, v72, v73
    buffer_store_dwordx2 v[70:71], v14, s[60:63], s15 offen
    s_add_u32 s15, s15, 73728
    s_waitcnt lgkmcnt(1)
    v_lshlrev_b32 v32, 16, v20
    v_and_b32 v33, 0xffff0000, v20
    v_lshlrev_b32 v34, 16, v21
    v_and_b32 v35, 0xffff0000, v21
    v_fmac_f32 v76, v32, v80
    v_fmac_f32 v77, v33, v80
    v_fmac_f32 v78, v34, v80
    v_fmac_f32 v79, v35, v80
    v_cvt_pk_bf16_f32 v76, v76, v77
    v_cvt_pk_bf16_f32 v77, v78, v79
    buffer_store_dwordx2 v[76:77], v14, s[60:63], s15 offen
    s_add_u32 s15, s15, 73728
    s_waitcnt lgkmcnt(0)
    v_lshlrev_b32 v36, 16, v22
    v_and_b32 v37, 0xffff0000, v22
    v_lshlrev_b32 v38, 16, v23
    v_and_b32 v39, 0xffff0000, v23
    v_fmac_f32 v82, v36, v86
    v_fmac_f32 v83, v37, v86
    v_fmac_f32 v84, v38, v86
    v_fmac_f32 v85, v39, v86
    v_cvt_pk_bf16_f32 v82, v82, v83
    v_cvt_pk_bf16_f32 v83, v84, v85
    buffer_store_dwordx2 v[82:83], v14, s[60:63], s15 offen
    s_add_u32 s15, s15, 73728
    s_waitcnt vmcnt(0)
    v_mov_b32 v8, 1
    s_mov_b64 exec, 1
    ds_add_u32 v1, v8 offset:40
    s_mov_b64 exec, -1
    s_endpgm
C_FIN:
    s_setprio 0
    v_and_b32 v8, 7, v2
    v_lshlrev_b32 v8, 3, v8
    v_add_u32 v8, 16384, v8
    s_mul_i32 s8, s7, 9216
    s_add_u32 s8, s8, 32768
    v_lshl_add_u32 v5, v2, 4, s8
    v_add_u32 v6, 0x1000, v5
    v_add_u32 v7, 0x2000, v5
    s_waitcnt lgkmcnt(0)
    v_lshrrev_b32 v110, 0, v10
    v_lshrrev_b32 v111, 8, v10
    v_lshrrev_b32 v112, 16, v10
    v_lshrrev_b32 v113, 24, v10
    s_mov_b32 s9, 0
C_SPOLL:
    global_load_dwordx2 v[16:17], v8, s[50:51] sc1
    s_waitcnt vmcnt(0)
    v_cmp_ne_u32 vcc, v17, v10
    s_add_u32 s9, s9, 1
    s_cmp_eq_u64 vcc, 0
    s_cbranch_scc1 C_SOK
    s_sleep 4
    s_cmp_lt_u32 s9, 131072
    s_cbranch_scc1 C_SPOLL
C_SOK:
    s_setprio 3
    s_mov_b32 s9, 0
SP_12:
    ds_read_b32 v12, v1 offset:84
    s_waitcnt lgkmcnt(0)
    v_readfirstlane_b32 s8, v12
    s_add_u32 s9, s9, 1
    s_cmp_ge_u32 s8, 1
    s_cbranch_scc1 SP_12_D
    s_sleep 2
    s_cmp_lt_u32 s9, 524288
    s_cbranch_scc1 SP_12
SP_12_D:
    s_setprio 3
    v_and_b32 v18, 0x7ff, v16
    v_sub_u32 v18, 2047, v18
    v_and_b32 v19, 1, v4
    v_lshrrev_b32 v20, 1, v4
    v_lshl_or_b32 v19, v19, 1, v20
    v_lshlrev_b32 v19, 1, v19
    v_and_b32 v22, 0x7ff, v16
    v_mul_u32_u24 v23, 2336, v19
    v_lshl_add_u32 v23, v22, 1, v23
    v_add_u32 v23, 72960, v23
    ds_read_u16 v105, v23
    v_and_b32 v20, 0xffff0000, v16
    v_ashrrev_i32 v21, 31, v20
    v_not_b32 v21, v21
    v_or_b32 v21, 0x80000000, v21
    v_and_b32 v21, 0xffff0000, v21
    v_xor_b32 v20, v20, v21
    v_mul_f32 v21, 0xbfb8aa3b, v20
    v_exp_f32 v21, v21
    s_nop 0
    v_add_f32 v21, 1.0, v21
    v_rcp_f32 v104, v21
    s_nop 0
    v_cvt_pk_bf16_f32 v104, v104, v104
    v_and_b32 v104, 0xffff0000, v104
    v_lshlrev_b32 v106, 2, v18
    v_add_u32 v106, 91648, v106
    v_mul_u32_u24 v107, 2080, v19
    v_lshl_add_u32 v107, v22, 1, v107
    v_add_u32 v107, 99840, v107
    v_mul_u32_u24 v108, 1152, v18
    v_add3_u32 v108, v108, v19, s55
    s_waitcnt lgkmcnt(0)
    v_lshlrev_b32 v105, 16, v105
    s_mov_b32 s9, 0
    s_setprio 0
    s_mov_b64 exec, 1
C_M1:
    global_load_dword v26, v5, s[50:51] sc1
    s_waitcnt vmcnt(0)
    v_xor_b32 v26, v26, v10
    v_and_b32 v26, 0xff, v26
    v_cmp_ne_u32 vcc, 0, v26
    s_add_u32 s9, s9, 1
    s_cmp_eq_u64 vcc, 0
    s_cbranch_scc1 C_M1D
    s_cmp_lt_u32 s9, 131072
    s_cbranch_scc1 C_M1
C_M1D:
    s_mov_b64 exec, -1
    s_setprio 3
    s_mov_b32 s9, 0
C_MPOLL:
    global_load_dwordx4 v[120:123], v5, s[50:51] offset:0 sc1
    global_load_dwordx4 v[124:127], v5, s[50:51] offset:1024 sc1
    global_load_dwordx4 v[128:131], v5, s[50:51] offset:2048 sc1
    global_load_dwordx4 v[132:135], v5, s[50:51] offset:3072 sc1
    global_load_dwordx4 v[136:139], v6, s[50:51] offset:0 sc1
    global_load_dwordx4 v[140:143], v6, s[50:51] offset:1024 sc1
    global_load_dwordx4 v[144:147], v6, s[50:51] offset:2048 sc1
    global_load_dwordx4 v[148:151], v6, s[50:51] offset:3072 sc1
    global_load_dwordx4 v[152:155], v7, s[50:51] offset:0 sc1
    s_waitcnt vmcnt(8)
    v_xor_b32 v26, v120, v10
    v_bitop3_b32 v26, v26, v121, v111 bitop3:0xf6
    v_bitop3_b32 v26, v26, v122, v112 bitop3:0xf6
    v_bitop3_b32 v26, v26, v123, v113 bitop3:0xf6
    s_waitcnt vmcnt(7)
    v_bitop3_b32 v26, v26, v124, v110 bitop3:0xf6
    v_bitop3_b32 v26, v26, v125, v111 bitop3:0xf6
    v_bitop3_b32 v26, v26, v126, v112 bitop3:0xf6
    v_bitop3_b32 v26, v26, v127, v113 bitop3:0xf6
    v_pk_add_f32 v[28:29], v[120:121], v[124:125]
    v_pk_add_f32 v[30:31], v[122:123], v[126:127]
    s_waitcnt vmcnt(6)
    v_bitop3_b32 v26, v26, v128, v110 bitop3:0xf6
    v_bitop3_b32 v26, v26, v129, v111 bitop3:0xf6
    v_bitop3_b32 v26, v26, v130, v112 bitop3:0xf6
    v_bitop3_b32 v26, v26, v131, v113 bitop3:0xf6
    v_pk_add_f32 v[28:29], v[28:29], v[128:129]
    v_pk_add_f32 v[30:31], v[30:31], v[130:131]
    s_waitcnt vmcnt(5)
    v_bitop3_b32 v26, v26, v132, v110 bitop3:0xf6
    v_bitop3_b32 v26, v26, v133, v111 bitop3:0xf6
    v_bitop3_b32 v26, v26, v134, v112 bitop3:0xf6
    v_bitop3_b32 v26, v26, v135, v113 bitop3:0xf6
    v_pk_add_f32 v[28:29], v[28:29], v[132:133]
    v_pk_add_f32 v[30:31], v[30:31], v[134:135]
    s_waitcnt vmcnt(4)
    v_bitop3_b32 v26, v26, v136, v110 bitop3:0xf6
    v_bitop3_b32 v26, v26, v137, v111 bitop3:0xf6
    v_bitop3_b32 v26, v26, v138, v112 bitop3:0xf6
    v_bitop3_b32 v26, v26, v139, v113 bitop3:0xf6
    v_pk_add_f32 v[28:29], v[28:29], v[136:137]
    v_pk_add_f32 v[30:31], v[30:31], v[138:139]
    s_waitcnt vmcnt(3)
    v_bitop3_b32 v26, v26, v140, v110 bitop3:0xf6
    v_bitop3_b32 v26, v26, v141, v111 bitop3:0xf6
    v_bitop3_b32 v26, v26, v142, v112 bitop3:0xf6
    v_bitop3_b32 v26, v26, v143, v113 bitop3:0xf6
    v_pk_add_f32 v[28:29], v[28:29], v[140:141]
    v_pk_add_f32 v[30:31], v[30:31], v[142:143]
    s_waitcnt vmcnt(2)
    v_bitop3_b32 v26, v26, v144, v110 bitop3:0xf6
    v_bitop3_b32 v26, v26, v145, v111 bitop3:0xf6
    v_bitop3_b32 v26, v26, v146, v112 bitop3:0xf6
    v_bitop3_b32 v26, v26, v147, v113 bitop3:0xf6
    v_pk_add_f32 v[28:29], v[28:29], v[144:145]
    v_pk_add_f32 v[30:31], v[30:31], v[146:147]
    s_waitcnt vmcnt(1)
    v_bitop3_b32 v26, v26, v148, v110 bitop3:0xf6
    v_bitop3_b32 v26, v26, v149, v111 bitop3:0xf6
    v_bitop3_b32 v26, v26, v150, v112 bitop3:0xf6
    v_bitop3_b32 v26, v26, v151, v113 bitop3:0xf6
    v_pk_add_f32 v[28:29], v[28:29], v[148:149]
    v_pk_add_f32 v[30:31], v[30:31], v[150:151]
    s_waitcnt vmcnt(0)
    v_bitop3_b32 v26, v26, v152, v110 bitop3:0xf6
    v_bitop3_b32 v26, v26, v153, v111 bitop3:0xf6
    v_bitop3_b32 v26, v26, v154, v112 bitop3:0xf6
    v_bitop3_b32 v26, v26, v155, v113 bitop3:0xf6
    v_pk_add_f32 v[28:29], v[28:29], v[152:153]
    v_pk_add_f32 v[30:31], v[30:31], v[154:155]
    v_and_b32 v26, 0xff, v26
    v_cmp_ne_u32 vcc, 0, v26
    s_add_u32 s9, s9, 1
    s_cmp_eq_u64 vcc, 0
    s_cbranch_scc1 C_MOK
    s_sleep 2
    s_cmp_lt_u32 s9, 131072
    s_cbranch_scc1 C_MPOLL
C_MOK:
    v_permlane32_swap_b32 v28, v29
    v_permlane32_swap_b32 v30, v31
    v_add_f32 v28, v28, v29
    v_add_f32 v30, v30, v31
    s_nop 1
    v_permlane16_swap_b32 v28, v30
    v_add_f32 v28, v28, v30
    s_nop 1
    v_add_f32_dpp v28, v28, v28 row_ror:8 row_mask:0xf bank_mask:0xf
    v_cvt_pk_bf16_f32 v28, v28, v28
    v_and_b32 v28, 0xffff0000, v28
    v_mul_f32 v28, v28, v104
    v_cvt_pk_bf16_f32 v28, v28, v28
    v_and_b32 v28, 0xffff0000, v28
    v_add_f32 v28, v28, v105
    v_cvt_pk_bf16_f32 v28, v28, v28
    v_and_b32 v28, 0xffff0000, v28
    s_setprio 0
    s_mov_b32 s9, 0
SP_13:
    ds_read_b32 v27, v1 offset:40
    s_waitcnt lgkmcnt(0)
    v_readfirstlane_b32 s8, v27
    s_add_u32 s9, s9, 1
    s_cmp_ge_u32 s8, 4
    s_cbranch_scc1 SP_13_D
    s_cmp_lt_u32 s9, 524288
    s_cbranch_scc1 SP_13
SP_13_D:
    s_setprio 3
    ds_read_b32 v25, v106
    ds_read_u16 v24, v107
    s_waitcnt lgkmcnt(0)
    v_sub_f32 v26, 1.0, v25
    v_lshlrev_b32 v24, 16, v24
    v_cvt_pk_bf16_f32 v26, v26, v26
    v_and_b32 v26, 0xffff0000, v26
    v_mul_f32 v28, v28, v26
    v_fmac_f32 v28, v24, v25
    v_cvt_pk_bf16_f32 v28, v28, v28
    s_mov_b32 exec_lo, 0x00ff00ff
    s_mov_b32 exec_hi, 0x00ff00ff
    global_store_short v108, v28, s[46:47]
    s_mov_b64 exec, -1
    s_endpgm
HELPER:
    s_cmp_ge_u32 s3, 6
    s_cbranch_scc1 K_END
    s_and_b32 s12, s3, 1
    s_sub_u32 s13, s3, 2
    s_lshr_b32 s13, s13, 1
    s_mul_i32 s13, s13, 5
    s_add_u32 s13, s13, s5
    s_add_u32 s13, s13, 34
    v_mul_u32_u24 v5, 57, v2
    v_lshrrev_b32 v5, 9, v5
    v_mul_u32_u24 v6, 9, v5
    v_sub_u32 v6, v2, v6
    s_waitcnt lgkmcnt(0)
    s_cmp_eq_u32 s12, 1
    s_cselect_b32 s52, s40, s38
    s_cselect_b32 s53, s41, s39
    s_mov_b32 s54, 5308416
    s_mov_b32 s55, 0x20000
    v_mul_u32_u24 v5, 9216, v5
    v_lshl_add_u32 v5, v6, 7, v5
    s_mul_i32 s8, s4, 1152
    s_sub_u32 s14, s13, 43
    s_lshr_b32 s9, s52, 7
    s_add_u32 s9, s9, s4
    s_sub_u32 s9, 3, s9
    s_and_b32 s9, s9, 7
    s_lshl_b32 s15, s9, 7
    s_add_u32 s15, s15, s8
    s_mul_i32 s14, s14, 258048
    s_add_u32 s15, s15, s14
    s_add_u32 s15, s15, 193536
    s_cmp_eq_u32 s9, 0
    s_cselect_b32 s9, 1024, 0
    v_and_b32 v7, 31, v2
    v_min_u32 v7, 27, v7
    v_mul_u32_u24 v7, 9216, v7
    v_lshrrev_b32 v9, 5, v2
    v_mul_u32_u24 v9, s9, v9
    v_add_u32 v7, v7, v9
    s_mul_i32 s13, s13, 64512
    s_add_u32 s13, s13, s8
    s_mov_b32 s9, 0
SP_14:
    ds_read_b32 v13, v1 offset:4
    s_waitcnt lgkmcnt(0)
    v_readfirstlane_b32 s8, v13
    s_add_u32 s9, s9, 1
    s_cmp_ge_u32 s8, 1
    s_cbranch_scc1 SP_14_D
    s_cmp_lt_u32 s9, 524288
    s_cbranch_scc1 SP_14
SP_14_D:
    buffer_load_dword v8, v7, s[52:55], s15 offen
    s_waitcnt vmcnt(0)
    buffer_load_dword v8, v5, s[52:55], s13 offen
    s_add_u32 s13, s13, 645120
    s_waitcnt vmcnt(0)
    buffer_load_dword v8, v5, s[52:55], s13 offen
    s_add_u32 s13, s13, 645120
    s_waitcnt vmcnt(0)
    buffer_load_dword v8, v5, s[52:55], s13 offen
    s_add_u32 s13, s13, 645120
    s_waitcnt vmcnt(0)
    buffer_load_dword v8, v5, s[52:55], s13 offen
    s_add_u32 s13, s13, 645120
    s_endpgm
GATE:
    s_lshl_b32 s8, s12, 9
    s_add_u32 s8, s8, 147712
    v_lshl_add_u32 v5, v2, 2, s8
    v_and_b32 v6, 31, v2
    v_lshlrev_b32 v6, 2, v6
    v_add_u32 v6, 158080, v6
    s_lshl_b32 s8, s2, 1
    s_add_u32 s8, s8, s12
    v_mov_b32 v8, 0
    v_mov_b32 v9, 0
    v_mov_b32 v10, 0x3f803f80
    s_lshl_b32 s8, s8, 4
    s_add_u32 s8, s8, 8192
    v_lshrrev_b32 v7, 5, v2
    v_lshl_add_u32 v7, v7, 3, s8
    s_mov_b32 s9, 0
SP_15:
    ds_read_b32 v13, v1 offset:8
    s_waitcnt lgkmcnt(0)
    v_readfirstlane_b32 s8, v13
    s_add_u32 s9, s9, 1
    s_cmp_lg_u32 s8, 0
    s_cbranch_scc1 SP_15_D
    s_sleep 1
    s_cmp_lt_u32 s9, 524288
    s_cbranch_scc1 SP_15
SP_15_D:
    ds_read2_b32 v[34:35], v6 offset0:0 offset1:32
    ds_read2_b32 v[36:37], v6 offset0:64 offset1:96
    ds_read2_b32 v[38:39], v6 offset0:128 offset1:160
    ds_read2_b32 v[40:41], v6 offset0:192 offset1:224
    ds_read_b32 v42, v6 offset:1024
    ds_read2st64_b32 v[16:17], v5 offset0:0 offset1:1
    ds_read2st64_b32 v[18:19], v5 offset0:4 offset1:5
    ds_read2st64_b32 v[20:21], v5 offset0:8 offset1:9
    ds_read2st64_b32 v[22:23], v5 offset0:12 offset1:13
    ds_read2st64_b32 v[24:25], v5 offset0:16 offset1:17
    ds_read2st64_b32 v[26:27], v5 offset0:20 offset1:21
    ds_read2st64_b32 v[28:29], v5 offset0:24 offset1:25
    ds_read2st64_b32 v[30:31], v5 offset0:28 offset1:29
    ds_read2st64_b32 v[32:33], v5 offset0:32 offset1:33
    s_waitcnt lgkmcnt(13)
    v_and_b32 v44, 0xffff, v34
    v_and_b32 v34, 0xffff0000, v34
    v_and_b32 v45, 0xffff, v35
    v_and_b32 v35, 0xffff0000, v35
    s_waitcnt lgkmcnt(12)
    v_and_b32 v46, 0xffff, v36
    v_and_b32 v36, 0xffff0000, v36
    v_and_b32 v47, 0xffff, v37
    v_and_b32 v37, 0xffff0000, v37
    s_waitcnt lgkmcnt(11)
    v_and_b32 v48, 0xffff, v38
    v_and_b32 v38, 0xffff0000, v38
    v_and_b32 v49, 0xffff, v39
    v_and_b32 v39, 0xffff0000, v39
    s_waitcnt lgkmcnt(10)
    v_and_b32 v50, 0xffff, v40
    v_and_b32 v40, 0xffff0000, v40
    v_and_b32 v51, 0xffff, v41
    v_and_b32 v41, 0xffff0000, v41
    s_waitcnt lgkmcnt(9)
    v_and_b32 v52, 0xffff, v42
    v_and_b32 v42, 0xffff0000, v42
    s_waitcnt lgkmcnt(8)
    v_dot2_f32_bf16 v56, v16, v44, 0
    v_dot2_f32_bf16 v57, v16, v34, 0
    v_dot2_f32_bf16 v58, v17, v44, 0
    v_dot2_f32_bf16 v59, v17, v34, 0
    s_waitcnt lgkmcnt(7)
    v_dot2_f32_bf16 v60, v18, v45, 0
    v_dot2_f32_bf16 v61, v18, v35, 0
    v_dot2_f32_bf16 v62, v19, v45, 0
    v_dot2_f32_bf16 v63, v19, v35, 0
    v_cvt_pk_bf16_f32 v56, v56, v57
    v_cvt_pk_bf16_f32 v58, v58, v59
    v_dot2c_f32_bf16 v8, v56, v10
    v_dot2c_f32_bf16 v9, v58, v10
    s_waitcnt lgkmcnt(6)
    v_dot2_f32_bf16 v56, v20, v46, 0
    v_dot2_f32_bf16 v57, v20, v36, 0
    v_dot2_f32_bf16 v58, v21, v46, 0
    v_dot2_f32_bf16 v59, v21, v36, 0
    v_cvt_pk_bf16_f32 v60, v60, v61
    v_cvt_pk_bf16_f32 v62, v62, v63
    v_dot2c_f32_bf16 v8, v60, v10
    v_dot2c_f32_bf16 v9, v62, v10
    s_waitcnt lgkmcnt(5)
    v_dot2_f32_bf16 v60, v22, v47, 0
    v_dot2_f32_bf16 v61, v22, v37, 0
    v_dot2_f32_bf16 v62, v23, v47, 0
    v_dot2_f32_bf16 v63, v23, v37, 0
    v_cvt_pk_bf16_f32 v56, v56, v57
    v_cvt_pk_bf16_f32 v58, v58, v59
    v_dot2c_f32_bf16 v8, v56, v10
    v_dot2c_f32_bf16 v9, v58, v10
    s_waitcnt lgkmcnt(4)
    v_dot2_f32_bf16 v56, v24, v48, 0
    v_dot2_f32_bf16 v57, v24, v38, 0
    v_dot2_f32_bf16 v58, v25, v48, 0
    v_dot2_f32_bf16 v59, v25, v38, 0
    v_cvt_pk_bf16_f32 v60, v60, v61
    v_cvt_pk_bf16_f32 v62, v62, v63
    v_dot2c_f32_bf16 v8, v60, v10
    v_dot2c_f32_bf16 v9, v62, v10
    s_waitcnt lgkmcnt(3)
    v_dot2_f32_bf16 v60, v26, v49, 0
    v_dot2_f32_bf16 v61, v26, v39, 0
    v_dot2_f32_bf16 v62, v27, v49, 0
    v_dot2_f32_bf16 v63, v27, v39, 0
    v_cvt_pk_bf16_f32 v56, v56, v57
    v_cvt_pk_bf16_f32 v58, v58, v59
    v_dot2c_f32_bf16 v8, v56, v10
    v_dot2c_f32_bf16 v9, v58, v10
    s_waitcnt lgkmcnt(2)
    v_dot2_f32_bf16 v56, v28, v50, 0
    v_dot2_f32_bf16 v57, v28, v40, 0
    v_dot2_f32_bf16 v58, v29, v50, 0
    v_dot2_f32_bf16 v59, v29, v40, 0
    v_cvt_pk_bf16_f32 v60, v60, v61
    v_cvt_pk_bf16_f32 v62, v62, v63
    v_dot2c_f32_bf16 v8, v60, v10
    v_dot2c_f32_bf16 v9, v62, v10
    s_waitcnt lgkmcnt(1)
    v_dot2_f32_bf16 v60, v30, v51, 0
    v_dot2_f32_bf16 v61, v30, v41, 0
    v_dot2_f32_bf16 v62, v31, v51, 0
    v_dot2_f32_bf16 v63, v31, v41, 0
    v_cvt_pk_bf16_f32 v56, v56, v57
    v_cvt_pk_bf16_f32 v58, v58, v59
    v_dot2c_f32_bf16 v8, v56, v10
    v_dot2c_f32_bf16 v9, v58, v10
    s_waitcnt lgkmcnt(0)
    v_dot2_f32_bf16 v56, v32, v52, 0
    v_dot2_f32_bf16 v57, v32, v42, 0
    v_dot2_f32_bf16 v58, v33, v52, 0
    v_dot2_f32_bf16 v59, v33, v42, 0
    v_cvt_pk_bf16_f32 v60, v60, v61
    v_cvt_pk_bf16_f32 v62, v62, v63
    v_dot2c_f32_bf16 v8, v60, v10
    v_dot2c_f32_bf16 v9, v62, v10
    v_cvt_pk_bf16_f32 v56, v56, v57
    v_cvt_pk_bf16_f32 v58, v58, v59
    v_dot2c_f32_bf16 v8, v56, v10
    v_dot2c_f32_bf16 v9, v58, v10
    v_mov_b32 v11, 1
    s_mov_b64 exec, 1
    ds_add_u32 v1, v11 offset:12
    s_mov_b64 exec, -1
    v_permlane16_swap_b32 v8, v9
    v_add_f32 v8, v8, v9
    s_nop 1
    v_add_f32_dpp v8, v8, v8 row_ror:8 row_mask:0xf bank_mask:0xf
    s_nop 1
    v_add_f32_dpp v8, v8, v8 row_ror:4 row_mask:0xf bank_mask:0xf
    s_nop 1
    v_add_f32_dpp v8, v8, v8 row_ror:2 row_mask:0xf bank_mask:0xf
    s_nop 1
    v_add_f32_dpp v8, v8, v8 row_ror:1 row_mask:0xf bank_mask:0xf
    v_cvt_pk_bf16_f32 v8, v8, v8
    v_and_b32 v8, 0xffff0000, v8
    v_mul_f32 v9, 0xbfb8aa3b, v8
    v_exp_f32 v9, v9
    s_nop 0
    v_add_f32 v9, 1.0, v9
    v_rcp_f32 v8, v9
    s_nop 0
    v_cvt_pk_bf16_f32 v8, v8, v8
    s_mov_b32 s11, 0xffff
    v_mov_b32 v9, v8
    v_lshl_add_u32 v7, v4, 3, v7
    s_nop 0
    v_permlane32_swap_b32 v8, v9
    v_bfi_b32 v12, s11, v8, v9
    s_mov_b64 exec, 0x00010001
    global_store_dwordx2 v7, v[12:13], s[50:51] sc1
    s_mov_b64 exec, -1
    s_cmp_lt_u32 s5, 9
    s_cbranch_scc1 F_COMP2
    s_cmp_ge_u32 s5, 14
    s_cbranch_scc1 C_IO
    s_endpgm
C_KBODY:
C_SETD:
    s_waitcnt lgkmcnt(0)
    s_lshl_b32 s8, s12, 4
    s_lshr_b64 s[58:59], s[58:59], s8
    s_lshl_b32 s8, s58, 16
    v_mov_b32 v44, s8
    v_mul_f32 v45, 0x3fb8aa3b, v44
    v_mov_b32 v46, 0x3fb8aa3b
    v_fma_f32 v46, v44, v46, -v45
    v_mov_b32 v47, 0x32a57060
    v_fma_f32 v46, v44, v47, v46
    v_exp_f32 v45, v45
    v_mul_f32 v46, 0x3f317218, v46
    v_fma_f32 v45, v45, v46, v45
    v_cvt_pk_bf16_f32 v45, v45, v45
    v_and_b32 v36, 0xffff0000, v45
    v_mul_f32 v37, 0x3fb8aa3b, v36
    v_mul_f32 v38, 0x3e22f983, v36
    s_waitcnt vmcnt(0)
    v_mul_f32 v40, v16, v37
    v_mul_f32 v41, v17, v38
    v_exp_f32 v24, v40
    v_fract_f32 v47, v41
    v_cos_f32 v46, v47
    v_sin_f32 v47, v47
    v_mul_f32 v46, v24, v46
    v_mul_f32 v47, v24, v47
    v_mul_f32 v18, v18, v36
    v_mul_f32 v19, v19, v36
    v_pk_mul_f32 v[42:43], v[20:21], v[18:19] op_sel:[0,0] op_sel_hi:[0,1]
    v_pk_fma_f32 v[42:43], v[20:21], v[18:19], v[42:43] op_sel:[1,1,0] op_sel_hi:[1,0,1] neg_lo:[0,1,0]
    v_max_f32 v39, |v42|, |v43|
    v_pk_mul_f32 v[48:49], v[46:47], v[46:47] op_sel:[0,0] op_sel_hi:[0,1]
    v_pk_fma_f32 v[48:49], v[46:47], v[46:47], v[48:49] op_sel:[1,1,0] op_sel_hi:[1,0,1] neg_lo:[0,1,0]
    v_pk_mul_f32 v[52:53], v[48:49], v[48:49] op_sel:[0,0] op_sel_hi:[0,1]
    v_pk_fma_f32 v[52:53], v[48:49], v[48:49], v[52:53] op_sel:[1,1,0] op_sel_hi:[1,0,1] neg_lo:[0,1,0]
    v_pk_mul_f32 v[60:61], v[52:53], v[52:53] op_sel:[0,0] op_sel_hi:[0,1]
    v_pk_fma_f32 v[60:61], v[52:53], v[52:53], v[60:61] op_sel:[1,1,0] op_sel_hi:[1,0,1] neg_lo:[0,1,0]
    v_mov_b32 v30, 0x3c00
    v_xor_b32 v61, 0x80000000, v61
    ds_write_addtid_b32 v30
    v_cvt_pk_f16_f32 v26, v60, v61
    v_pk_mul_f32 v[62:63], v[60:61], v[60:61] op_sel:[0,0] op_sel_hi:[0,1]
    v_pk_fma_f32 v[62:63], v[60:61], v[60:61], v[62:63] op_sel:[1,1,0] op_sel_hi:[1,0,1] neg_lo:[0,1,0]
    v_max_u32_dpp v39, v39, v39 row_shr:1 row_mask:0xf bank_mask:0xf
    ds_write_addtid_b32 v26 offset:288
    v_cvt_pk_f16_f32 v27, v62, v63
    v_pk_mul_f32 v[64:65], v[62:63], v[60:61] op_sel:[0,0] op_sel_hi:[0,1]
    v_pk_fma_f32 v[64:65], v[62:63], v[60:61], v[64:65] op_sel:[1,1,0] op_sel_hi:[1,0,1] neg_lo:[0,1,0]
    v_max_u32_dpp v39, v39, v39 row_shr:2 row_mask:0xf bank_mask:0xf
    ds_write_addtid_b32 v27 offset:576
    v_cvt_pk_f16_f32 v28, v64, v65
    v_pk_mul_f32 v[62:63], v[64:65], v[60:61] op_sel:[0,0] op_sel_hi:[0,1]
    v_pk_fma_f32 v[62:63], v[64:65], v[60:61], v[62:63] op_sel:[1,1,0] op_sel_hi:[1,0,1] neg_lo:[0,1,0]
    v_max_u32_dpp v39, v39, v39 row_shr:4 row_mask:0xf bank_mask:0xf
    ds_write_addtid_b32 v28 offset:864
    v_cvt_pk_f16_f32 v29, v62, v63
    v_pk_mul_f32 v[64:65], v[62:63], v[60:61] op_sel:[0,0] op_sel_hi:[0,1]
    v_pk_fma_f32 v[64:65], v[62:63], v[60:61], v[64:65] op_sel:[1,1,0] op_sel_hi:[1,0,1] neg_lo:[0,1,0]
    v_max_u32_dpp v39, v39, v39 row_shr:8 row_mask:0xf bank_mask:0xf
    ds_write_addtid_b32 v29 offset:1152
    v_cvt_pk_f16_f32 v26, v64, v65
    v_pk_mul_f32 v[62:63], v[64:65], v[60:61] op_sel:[0,0] op_sel_hi:[0,1]
    v_pk_fma_f32 v[62:63], v[64:65], v[60:61], v[62:63] op_sel:[1,1,0] op_sel_hi:[1,0,1] neg_lo:[0,1,0]
    v_max_u32_dpp v39, v39, v39 row_bcast:15 row_mask:0xa bank_mask:0xf
    ds_write_addtid_b32 v26 offset:1440
    v_cvt_pk_f16_f32 v27, v62, v63
    v_pk_mul_f32 v[64:65], v[62:63], v[60:61] op_sel:[0,0] op_sel_hi:[0,1]
    v_pk_fma_f32 v[64:65], v[62:63], v[60:61], v[64:65] op_sel:[1,1,0] op_sel_hi:[1,0,1] neg_lo:[0,1,0]
    v_max_u32_dpp v39, v39, v39 row_bcast:31 row_mask:0xc bank_mask:0xf
    ds_write_addtid_b32 v27 offset:1728
    v_cvt_pk_f16_f32 v28, v64, v65
    v_pk_mul_f32 v[62:63], v[64:65], v[60:61] op_sel:[0,0] op_sel_hi:[0,1]
    v_pk_fma_f32 v[62:63], v[64:65], v[60:61], v[62:63] op_sel:[1,1,0] op_sel_hi:[1,0,1] neg_lo:[0,1,0]
    v_readlane_b32 s8, v39, 63
    ds_write_addtid_b32 v28 offset:2016
    v_cvt_pk_f16_f32 v29, v62, v63
    v_pk_mul_f32 v[64:65], v[62:63], v[60:61] op_sel:[0,0] op_sel_hi:[0,1]
    v_pk_fma_f32 v[64:65], v[62:63], v[60:61], v[64:65] op_sel:[1,1,0] op_sel_hi:[1,0,1] neg_lo:[0,1,0]
    ds_write_addtid_b32 v29 offset:2304
    v_cvt_pk_f16_f32 v26, v64, v65
    v_pk_mul_f32 v[62:63], v[64:65], v[60:61] op_sel:[0,0] op_sel_hi:[0,1]
    v_pk_fma_f32 v[62:63], v[64:65], v[60:61], v[62:63] op_sel:[1,1,0] op_sel_hi:[1,0,1] neg_lo:[0,1,0]
    ds_write_addtid_b32 v26 offset:2592
    v_cvt_pk_f16_f32 v27, v62, v63
    v_pk_mul_f32 v[64:65], v[62:63], v[60:61] op_sel:[0,0] op_sel_hi:[0,1]
    v_pk_fma_f32 v[64:65], v[62:63], v[60:61], v[64:65] op_sel:[1,1,0] op_sel_hi:[1,0,1] neg_lo:[0,1,0]
    ds_write_addtid_b32 v27 offset:2880
    v_cvt_pk_f16_f32 v28, v64, v65
    v_pk_mul_f32 v[62:63], v[64:65], v[60:61] op_sel:[0,0] op_sel_hi:[0,1]
    v_pk_fma_f32 v[62:63], v[64:65], v[60:61], v[62:63] op_sel:[1,1,0] op_sel_hi:[1,0,1] neg_lo:[0,1,0]
    ds_write_addtid_b32 v28 offset:3168
    v_cvt_pk_f16_f32 v29, v62, v63
    v_pk_mul_f32 v[64:65], v[62:63], v[60:61] op_sel:[0,0] op_sel_hi:[0,1]
    v_pk_fma_f32 v[64:65], v[62:63], v[60:61], v[64:65] op_sel:[1,1,0] op_sel_hi:[1,0,1] neg_lo:[0,1,0]
    ds_write_addtid_b32 v29 offset:3456
    v_cvt_pk_f16_f32 v26, v64, v65
    v_pk_mul_f32 v[62:63], v[64:65], v[60:61] op_sel:[0,0] op_sel_hi:[0,1]
    v_pk_fma_f32 v[62:63], v[64:65], v[60:61], v[62:63] op_sel:[1,1,0] op_sel_hi:[1,0,1] neg_lo:[0,1,0]
    ds_write_addtid_b32 v26 offset:3744
    v_cvt_pk_f16_f32 v27, v62, v63
    v_pk_mul_f32 v[64:65], v[62:63], v[60:61] op_sel:[0,0] op_sel_hi:[0,1]
    v_pk_fma_f32 v[64:65], v[62:63], v[60:61], v[64:65] op_sel:[1,1,0] op_sel_hi:[1,0,1] neg_lo:[0,1,0]
    ds_write_addtid_b32 v27 offset:4032
    v_cvt_pk_f16_f32 v28, v64, v65
    s_lshr_b32 s8, s8, 23
    s_sub_u32 s8, 258, s8
    s_min_u32 s54, s8, 253
    s_lshl_b32 s8, s54, 23
    v_mul_f32 v42, s8, v42
    v_mul_f32 v43, s8, v43
    ds_write_addtid_b32 v28 offset:4320
    ds_read_b128 v[72:75], v7 offset:0
    ds_read_b128 v[76:79], v7 offset:64
    ds_read_b128 v[80:83], v7 offset:128
    ds_read_b128 v[84:87], v7 offset:192
    v_mul_f32 v44, 0x43000000, v40
    v_mul_f32 v45, 0x43000000, v41
    v_exp_f32 v24, v44
    v_fract_f32 v45, v45
    v_cos_f32 v44, v45
    v_sin_f32 v45, v45
    v_mul_f32 v44, v24, v44
    v_mul_f32 v45, v24, v45
    v_pk_mul_f32 v[50:51], v[48:49], v[46:47] op_sel:[0,0] op_sel_hi:[0,1]
    v_pk_fma_f32 v[50:51], v[48:49], v[46:47], v[50:51] op_sel:[1,1,0] op_sel_hi:[1,0,1] neg_lo:[0,1,0]
    v_pk_mul_f32 v[54:55], v[52:53], v[46:47] op_sel:[0,0] op_sel_hi:[0,1]
    v_pk_fma_f32 v[54:55], v[52:53], v[46:47], v[54:55] op_sel:[1,1,0] op_sel_hi:[1,0,1] neg_lo:[0,1,0]
    v_pk_mul_f32 v[56:57], v[50:51], v[50:51] op_sel:[0,0] op_sel_hi:[0,1]
    v_pk_fma_f32 v[56:57], v[50:51], v[50:51], v[56:57] op_sel:[1,1,0] op_sel_hi:[1,0,1] neg_lo:[0,1,0]
    v_pk_mul_f32 v[58:59], v[56:57], v[46:47] op_sel:[0,0] op_sel_hi:[0,1]
    v_pk_fma_f32 v[58:59], v[56:57], v[46:47], v[58:59] op_sel:[1,1,0] op_sel_hi:[1,0,1] neg_lo:[0,1,0]
    v_cvt_pk_f16_f32 v29, v42, v43
    v_pk_mul_f32 v[60:61], v[42:43], v[46:47] op_sel:[0,0] op_sel_hi:[0,1]
    v_pk_fma_f32 v[60:61], v[42:43], v[46:47], v[60:61] op_sel:[1,1,0] op_sel_hi:[1,0,1] neg_lo:[0,1,0]
    ds_write_addtid_b32 v29 offset:0
    v_cvt_pk_f16_f32 v26, v60, v61
    v_pk_mul_f32 v[62:63], v[42:43], v[48:49] op_sel:[0,0] op_sel_hi:[0,1]
    v_pk_fma_f32 v[62:63], v[42:43], v[48:49], v[62:63] op_sel:[1,1,0] op_sel_hi:[1,0,1] neg_lo:[0,1,0]
    ds_write_addtid_b32 v26 offset:288
    v_cvt_pk_f16_f32 v27, v62, v63
    v_pk_mul_f32 v[60:61], v[42:43], v[50:51] op_sel:[0,0] op_sel_hi:[0,1]
    v_pk_fma_f32 v[60:61], v[42:43], v[50:51], v[60:61] op_sel:[1,1,0] op_sel_hi:[1,0,1] neg_lo:[0,1,0]
    ds_write_addtid_b32 v27 offset:576
    v_cvt_pk_f16_f32 v28, v60, v61
    v_pk_mul_f32 v[62:63], v[42:43], v[52:53] op_sel:[0,0] op_sel_hi:[0,1]
    v_pk_fma_f32 v[62:63], v[42:43], v[52:53], v[62:63] op_sel:[1,1,0] op_sel_hi:[1,0,1] neg_lo:[0,1,0]
    ds_write_addtid_b32 v28 offset:864
    v_cvt_pk_f16_f32 v29, v62, v63
    v_pk_mul_f32 v[60:61], v[42:43], v[54:55] op_sel:[0,0] op_sel_hi:[0,1]
    v_pk_fma_f32 v[60:61], v[42:43], v[54:55], v[60:61] op_sel:[1,1,0] op_sel_hi:[1,0,1] neg_lo:[0,1,0]
    ds_write_addtid_b32 v29 offset:1152
    v_cvt_pk_f16_f32 v26, v60, v61
    v_pk_mul_f32 v[62:63], v[42:43], v[56:57] op_sel:[0,0] op_sel_hi:[0,1]
    v_pk_fma_f32 v[62:63], v[42:43], v[56:57], v[62:63] op_sel:[1,1,0] op_sel_hi:[1,0,1] neg_lo:[0,1,0]
    ds_write_addtid_b32 v26 offset:1440
    v_cvt_pk_f16_f32 v27, v62, v63
    v_pk_mul_f32 v[60:61], v[42:43], v[58:59] op_sel:[0,0] op_sel_hi:[0,1]
    v_pk_fma_f32 v[60:61], v[42:43], v[58:59], v[60:61] op_sel:[1,1,0] op_sel_hi:[1,0,1] neg_lo:[0,1,0]
    ds_write_addtid_b32 v27 offset:1728
    v_cvt_pk_f16_f32 v28, v60, v61
    v_pk_mul_f32 v[66:67], v[42:43], v[44:45] op_sel:[0,0] op_sel_hi:[0,1]
    v_pk_fma_f32 v[66:67], v[42:43], v[44:45], v[66:67] op_sel:[1,1,0] op_sel_hi:[1,0,1] neg_lo:[0,1,0]
    ds_write_addtid_b32 v28 offset:2016
    v_cvt_pk_f16_f32 v29, v66, v67
    v_pk_mul_f32 v[62:63], v[66:67], v[46:47] op_sel:[0,0] op_sel_hi:[0,1]
    v_pk_fma_f32 v[62:63], v[66:67], v[46:47], v[62:63] op_sel:[1,1,0] op_sel_hi:[1,0,1] neg_lo:[0,1,0]
    ds_write_addtid_b32 v29 offset:2304
    v_cvt_pk_f16_f32 v26, v62, v63
    v_pk_mul_f32 v[60:61], v[66:67], v[48:49] op_sel:[0,0] op_sel_hi:[0,1]
    v_pk_fma_f32 v[60:61], v[66:67], v[48:49], v[60:61] op_sel:[1,1,0] op_sel_hi:[1,0,1] neg_lo:[0,1,0]
    ds_write_addtid_b32 v26 offset:2592
    v_cvt_pk_f16_f32 v27, v60, v61
    v_pk_mul_f32 v[62:63], v[66:67], v[50:51] op_sel:[0,0] op_sel_hi:[0,1]
    v_pk_fma_f32 v[62:63], v[66:67], v[50:51], v[62:63] op_sel:[1,1,0] op_sel_hi:[1,0,1] neg_lo:[0,1,0]
    ds_write_addtid_b32 v27 offset:2880
    v_cvt_pk_f16_f32 v28, v62, v63
    v_pk_mul_f32 v[60:61], v[66:67], v[52:53] op_sel:[0,0] op_sel_hi:[0,1]
    v_pk_fma_f32 v[60:61], v[66:67], v[52:53], v[60:61] op_sel:[1,1,0] op_sel_hi:[1,0,1] neg_lo:[0,1,0]
    ds_write_addtid_b32 v28 offset:3168
    v_cvt_pk_f16_f32 v29, v60, v61
    v_pk_mul_f32 v[62:63], v[66:67], v[54:55] op_sel:[0,0] op_sel_hi:[0,1]
    v_pk_fma_f32 v[62:63], v[66:67], v[54:55], v[62:63] op_sel:[1,1,0] op_sel_hi:[1,0,1] neg_lo:[0,1,0]
    ds_write_addtid_b32 v29 offset:3456
    v_cvt_pk_f16_f32 v26, v62, v63
    v_pk_mul_f32 v[60:61], v[66:67], v[56:57] op_sel:[0,0] op_sel_hi:[0,1]
    v_pk_fma_f32 v[60:61], v[66:67], v[56:57], v[60:61] op_sel:[1,1,0] op_sel_hi:[1,0,1] neg_lo:[0,1,0]
    ds_write_addtid_b32 v26 offset:3744
    v_cvt_pk_f16_f32 v27, v60, v61
    v_pk_mul_f32 v[62:63], v[66:67], v[58:59] op_sel:[0,0] op_sel_hi:[0,1]
    v_pk_fma_f32 v[62:63], v[66:67], v[58:59], v[62:63] op_sel:[1,1,0] op_sel_hi:[1,0,1] neg_lo:[0,1,0]
    ds_write_addtid_b32 v27 offset:4032
    v_cvt_pk_f16_f32 v28, v62, v63
    v_pk_mul_f32 v[68:69], v[66:67], v[44:45] op_sel:[0,0] op_sel_hi:[0,1]
    v_pk_fma_f32 v[68:69], v[66:67], v[44:45], v[68:69] op_sel:[1,1,0] op_sel_hi:[1,0,1] neg_lo:[0,1,0]
    ds_write_addtid_b32 v28 offset:4320
    ds_read_b128 v[88:91], v7 offset:0
    ds_read_b128 v[92:95], v7 offset:64
    ds_read_b128 v[96:99], v7 offset:128
    ds_read_b128 v[100:103], v7 offset:192
    v_cvt_pk_f16_f32 v29, v68, v69
    v_pk_mul_f32 v[60:61], v[68:69], v[48:49] op_sel:[0,0] op_sel_hi:[0,1]
    v_pk_fma_f32 v[60:61], v[68:69], v[48:49], v[60:61] op_sel:[1,1,0] op_sel_hi:[1,0,1] neg_lo:[0,1,0]
    ds_write_addtid_b32 v29 offset:0
    v_cvt_pk_f16_f32 v26, v60, v61
    v_pk_mul_f32 v[62:63], v[68:69], v[52:53] op_sel:[0,0] op_sel_hi:[0,1]
    v_pk_fma_f32 v[62:63], v[68:69], v[52:53], v[62:63] op_sel:[1,1,0] op_sel_hi:[1,0,1] neg_lo:[0,1,0]
    ds_write_addtid_b32 v26 offset:288
    v_cvt_pk_f16_f32 v27, v62, v63
    v_pk_mul_f32 v[60:61], v[68:69], v[56:57] op_sel:[0,0] op_sel_hi:[0,1]
    v_pk_fma_f32 v[60:61], v[68:69], v[56:57], v[60:61] op_sel:[1,1,0] op_sel_hi:[1,0,1] neg_lo:[0,1,0]
    ds_write_addtid_b32 v27 offset:576
    v_cvt_pk_f16_f32 v28, v60, v61
    v_pk_mul_f32 v[66:67], v[68:69], v[44:45] op_sel:[0,0] op_sel_hi:[0,1]
    v_pk_fma_f32 v[66:67], v[68:69], v[44:45], v[66:67] op_sel:[1,1,0] op_sel_hi:[1,0,1] neg_lo:[0,1,0]
    ds_write_addtid_b32 v28 offset:864
    v_cvt_pk_f16_f32 v29, v66, v67
    s_waitcnt lgkmcnt(7)
    v_mfma_f32_16x16x32_f16 v[104:107], v[88:91], v[72:75], 0
    v_pk_mul_f32 v[62:63], v[66:67], v[48:49] op_sel:[0,0] op_sel_hi:[0,1]
    v_pk_fma_f32 v[62:63], v[66:67], v[48:49], v[62:63] op_sel:[1,1,0] op_sel_hi:[1,0,1] neg_lo:[0,1,0]
    ds_write_addtid_b32 v29 offset:1152
    v_cvt_pk_f16_f32 v26, v62, v63
    s_waitcnt lgkmcnt(7)
    v_mfma_f32_16x16x32_f16 v[104:107], v[92:95], v[76:79], v[104:107]
    v_pk_mul_f32 v[60:61], v[66:67], v[52:53] op_sel:[0,0] op_sel_hi:[0,1]
    v_pk_fma_f32 v[60:61], v[66:67], v[52:53], v[60:61] op_sel:[1,1,0] op_sel_hi:[1,0,1] neg_lo:[0,1,0]
    ds_write_addtid_b32 v26 offset:1440
    v_cvt_pk_f16_f32 v27, v60, v61
    s_waitcnt lgkmcnt(7)
    v_mfma_f32_16x16x32_f16 v[104:107], v[96:99], v[80:83], v[104:107]
    v_pk_mul_f32 v[62:63], v[66:67], v[56:57] op_sel:[0,0] op_sel_hi:[0,1]
    v_pk_fma_f32 v[62:63], v[66:67], v[56:57], v[62:63] op_sel:[1,1,0] op_sel_hi:[1,0,1] neg_lo:[0,1,0]
    ds_write_addtid_b32 v27 offset:1728
    v_cvt_pk_f16_f32 v28, v62, v63
    s_waitcnt lgkmcnt(7)
    v_mfma_f32_16x16x32_f16 v[104:107], v[100:103], v[84:87], v[104:107]
    v_pk_mul_f32 v[68:69], v[66:67], v[44:45] op_sel:[0,0] op_sel_hi:[0,1]
    v_pk_fma_f32 v[68:69], v[66:67], v[44:45], v[68:69] op_sel:[1,1,0] op_sel_hi:[1,0,1] neg_lo:[0,1,0]
    ds_write_addtid_b32 v28 offset:2016
    v_cvt_pk_f16_f32 v29, v68, v69
    v_pk_mul_f32 v[60:61], v[68:69], v[52:53] op_sel:[0,0] op_sel_hi:[0,1]
    v_pk_fma_f32 v[60:61], v[68:69], v[52:53], v[60:61] op_sel:[1,1,0] op_sel_hi:[1,0,1] neg_lo:[0,1,0]
    ds_write_addtid_b32 v29 offset:2304
    v_cvt_pk_f16_f32 v26, v60, v61
    v_pk_mul_f32 v[66:67], v[68:69], v[44:45] op_sel:[0,0] op_sel_hi:[0,1]
    v_pk_fma_f32 v[66:67], v[68:69], v[44:45], v[66:67] op_sel:[1,1,0] op_sel_hi:[1,0,1] neg_lo:[0,1,0]
    ds_write_addtid_b32 v26 offset:2592
    v_cvt_pk_f16_f32 v27, v66, v67
    v_pk_mul_f32 v[62:63], v[66:67], v[52:53] op_sel:[0,0] op_sel_hi:[0,1]
    v_pk_fma_f32 v[62:63], v[66:67], v[52:53], v[62:63] op_sel:[1,1,0] op_sel_hi:[1,0,1] neg_lo:[0,1,0]
    ds_write_addtid_b32 v27 offset:2880
    v_cvt_pk_f16_f32 v28, v62, v63
    v_pk_mul_f32 v[68:69], v[66:67], v[44:45] op_sel:[0,0] op_sel_hi:[0,1]
    v_pk_fma_f32 v[68:69], v[66:67], v[44:45], v[68:69] op_sel:[1,1,0] op_sel_hi:[1,0,1] neg_lo:[0,1,0]
    ds_write_addtid_b32 v28 offset:3168
    v_cvt_pk_f16_f32 v29, v68, v69
    v_pk_mul_f32 v[60:61], v[68:69], v[52:53] op_sel:[0,0] op_sel_hi:[0,1]
    v_pk_fma_f32 v[60:61], v[68:69], v[52:53], v[60:61] op_sel:[1,1,0] op_sel_hi:[1,0,1] neg_lo:[0,1,0]
    ds_write_addtid_b32 v29 offset:3456
    v_cvt_pk_f16_f32 v26, v60, v61
    v_pk_mul_f32 v[66:67], v[68:69], v[44:45] op_sel:[0,0] op_sel_hi:[0,1]
    v_pk_fma_f32 v[66:67], v[68:69], v[44:45], v[66:67] op_sel:[1,1,0] op_sel_hi:[1,0,1] neg_lo:[0,1,0]
    ds_write_addtid_b32 v26 offset:3744
    v_cvt_pk_f16_f32 v27, v66, v67
    v_pk_mul_f32 v[62:63], v[66:67], v[52:53] op_sel:[0,0] op_sel_hi:[0,1]
    v_pk_fma_f32 v[62:63], v[66:67], v[52:53], v[62:63] op_sel:[1,1,0] op_sel_hi:[1,0,1] neg_lo:[0,1,0]
    ds_write_addtid_b32 v27 offset:4032
    v_cvt_pk_f16_f32 v28, v62, v63
    v_pk_mul_f32 v[68:69], v[66:67], v[44:45] op_sel:[0,0] op_sel_hi:[0,1]
    v_pk_fma_f32 v[68:69], v[66:67], v[44:45], v[68:69] op_sel:[1,1,0] op_sel_hi:[1,0,1] neg_lo:[0,1,0]
    ds_write_addtid_b32 v28 offset:4320
    ds_read_b128 v[88:91], v7 offset:0
    ds_read_b128 v[92:95], v7 offset:64
    ds_read_b128 v[96:99], v7 offset:128
    ds_read_b128 v[100:103], v7 offset:192
    v_cvt_pk_f16_f32 v29, v68, v69
    v_pk_mul_f32 v[66:67], v[68:69], v[44:45] op_sel:[0,0] op_sel_hi:[0,1]
    v_pk_fma_f32 v[66:67], v[68:69], v[44:45], v[66:67] op_sel:[1,1,0] op_sel_hi:[1,0,1] neg_lo:[0,1,0]
    ds_write_addtid_b32 v29 offset:0
    v_cvt_pk_f16_f32 v26, v66, v67
    v_pk_mul_f32 v[68:69], v[66:67], v[44:45] op_sel:[0,0] op_sel_hi:[0,1]
    v_pk_fma_f32 v[68:69], v[66:67], v[44:45], v[68:69] op_sel:[1,1,0] op_sel_hi:[1,0,1] neg_lo:[0,1,0]
    ds_write_addtid_b32 v26 offset:288
    v_cvt_pk_f16_f32 v27, v68, v69
    v_pk_mul_f32 v[66:67], v[68:69], v[44:45] op_sel:[0,0] op_sel_hi:[0,1]
    v_pk_fma_f32 v[66:67], v[68:69], v[44:45], v[66:67] op_sel:[1,1,0] op_sel_hi:[1,0,1] neg_lo:[0,1,0]
    ds_write_addtid_b32 v27 offset:576
    v_cvt_pk_f16_f32 v28, v66, v67
    v_pk_mul_f32 v[68:69], v[66:67], v[44:45] op_sel:[0,0] op_sel_hi:[0,1]
    v_pk_fma_f32 v[68:69], v[66:67], v[44:45], v[68:69] op_sel:[1,1,0] op_sel_hi:[1,0,1] neg_lo:[0,1,0]
    ds_write_addtid_b32 v28 offset:864
    v_cvt_pk_f16_f32 v29, v68, v69
    v_pk_mul_f32 v[66:67], v[68:69], v[44:45] op_sel:[0,0] op_sel_hi:[0,1]
    v_pk_fma_f32 v[66:67], v[68:69], v[44:45], v[66:67] op_sel:[1,1,0] op_sel_hi:[1,0,1] neg_lo:[0,1,0]
    s_waitcnt lgkmcnt(7)
    v_mfma_f32_16x16x32_f16 v[108:111], v[88:91], v[72:75], 0
    ds_write_addtid_b32 v29 offset:1152
    v_cvt_pk_f16_f32 v26, v66, v67
    v_pk_mul_f32 v[68:69], v[66:67], v[44:45] op_sel:[0,0] op_sel_hi:[0,1]
    v_pk_fma_f32 v[68:69], v[66:67], v[44:45], v[68:69] op_sel:[1,1,0] op_sel_hi:[1,0,1] neg_lo:[0,1,0]
    s_waitcnt lgkmcnt(7)
    v_mfma_f32_16x16x32_f16 v[108:111], v[92:95], v[76:79], v[108:111]
    ds_write_addtid_b32 v26 offset:1440
    v_cvt_pk_f16_f32 v27, v68, v69
    v_pk_mul_f32 v[66:67], v[68:69], v[44:45] op_sel:[0,0] op_sel_hi:[0,1]
    v_pk_fma_f32 v[66:67], v[68:69], v[44:45], v[66:67] op_sel:[1,1,0] op_sel_hi:[1,0,1] neg_lo:[0,1,0]
    s_waitcnt lgkmcnt(7)
    v_mfma_f32_16x16x32_f16 v[108:111], v[96:99], v[80:83], v[108:111]
    ds_write_addtid_b32 v27 offset:1728
    v_cvt_pk_f16_f32 v28, v66, v67
    v_pk_mul_f32 v[68:69], v[66:67], v[44:45] op_sel:[0,0] op_sel_hi:[0,1]
    v_pk_fma_f32 v[68:69], v[66:67], v[44:45], v[68:69] op_sel:[1,1,0] op_sel_hi:[1,0,1] neg_lo:[0,1,0]
    s_waitcnt lgkmcnt(7)
    v_mfma_f32_16x16x32_f16 v[108:111], v[100:103], v[84:87], v[108:111]
    ds_write_addtid_b32 v28 offset:2016
    v_cvt_pk_f16_f32 v29, v68, v69
    ds_write_addtid_b32 v29 offset:2304
    ds_read_b128 v[88:91], v7 offset:0
    ds_read_b128 v[92:95], v7 offset:64
    ds_read_b128 v[96:99], v7 offset:128
    ds_read_b128 v[100:103], v7 offset:192
    v_lshl_add_u32 v8, v2, 4, s15
    s_waitcnt lgkmcnt(3)
    v_mfma_f32_16x16x32_f16 v[112:115], v[88:91], v[72:75], 0
    s_waitcnt lgkmcnt(2)
    v_mfma_f32_16x16x32_f16 v[112:115], v[92:95], v[76:79], v[112:115]
    s_waitcnt lgkmcnt(1)
    v_mfma_f32_16x16x32_f16 v[112:115], v[96:99], v[80:83], v[112:115]
    s_waitcnt lgkmcnt(0)
    v_mfma_f32_16x16x32_f16 v[112:115], v[100:103], v[84:87], v[112:115]
    s_lshl_b32 s8, s12, 2
    s_add_u32 s8, s8, 16
    v_mov_b32 v9, s8
    s_cmp_eq_u32 s13, 0
    s_cbranch_scc1 C_KA
    ds_write_b128 v8, v[104:107] offset:0
    ds_write_b128 v8, v[108:111] offset:1024
    s_nop 0
    ds_write_b128 v8, v[112:115] offset:2048
    v_mov_b32 v10, s54
    ds_write_b32 v9, v10
    s_setprio 0
    v_and_b32 v14, 3, v3
    v_sub_u32 v14, 3, v14
    v_mul_u32_u24 v14, 2240, v14
    v_lshrrev_b32 v13, 2, v3
    v_lshl_add_u32 v13, v4, 1, v13
    v_lshl_add_u32 v14, v13, 3, v14
    v_add3_u32 v5, v14, s52, 8
    v_lshlrev_b32 v14, 1, v3
    v_sub_u32 v14, v4, v14
    v_lshlrev_b32 v14, 4, v14
    s_add_u32 s8, s53, 480
    v_add_u32 v6, s8, v14
    v_lshl_add_u32 v14, v3, 2, v4
    s_mul_i32 s8, s12, 4160
    s_add_u32 s8, s8, 100344
    v_lshlrev_b32 v14, 3, v14
    v_sub_u32 v140, s8, v14
    s_setprio 3
    s_mov_b32 s9, 0
SP_16:
    ds_read_b32 v10, v1 offset:80
    s_waitcnt lgkmcnt(0)
    v_readfirstlane_b32 s8, v10
    s_add_u32 s9, s9, 1
    s_cmp_ge_u32 s8, 1
    s_cbranch_scc1 SP_16_D
    s_sleep 1
    s_cmp_lt_u32 s9, 524288
    s_cbranch_scc1 SP_16
SP_16_D:
    s_setprio 0
    s_mov_b32 s9, 0
SP_17:
    ds_read_b32 v10, v9 offset:48
    s_waitcnt lgkmcnt(0)
    v_readfirstlane_b32 s8, v10
    s_add_u32 s9, s9, 1
    s_cmp_lg_u32 s8, 0
    s_cbranch_scc1 SP_17_D
    s_cmp_lt_u32 s9, 524288
    s_cbranch_scc1 SP_17
SP_17_D:
    s_setprio 2
    ds_read_b64 v[32:33], v5 offset:0
    ds_read_b64 v[34:35], v5 offset:8
    ds_read_b128 v[60:63], v6 offset:2048
    ds_read_b128 v[56:59], v6 offset:2560
    ds_read_b128 v[52:55], v6 offset:3072
    ds_read_b128 v[48:51], v6 offset:3584
    ds_read_b64 v[36:37], v5 offset:512
    ds_read_b64 v[38:39], v5 offset:520
    ds_read_b64 v[40:41], v5 offset:1024
    ds_read_b64 v[42:43], v5 offset:1032
    ds_read_b64 v[44:45], v5 offset:1536
    ds_read_b64 v[46:47], v5 offset:1544
    s_waitcnt lgkmcnt(9)
    v_mfma_f32_16x16x32_bf16 v[28:31], v[32:35], v[60:63], 0
    ds_read_b64 v[76:77], v5 offset:64
    ds_read_b64 v[78:79], v5 offset:72
    s_waitcnt lgkmcnt(10)
    v_mfma_f32_16x16x32_bf16 v[24:27], v[32:35], v[56:59], 0
    ds_read_b128 v[104:107], v6 offset:2112
    s_waitcnt lgkmcnt(10)
    v_mfma_f32_16x16x32_bf16 v[20:23], v[32:35], v[52:55], 0
    ds_read_b128 v[100:103], v6 offset:2624
    s_waitcnt lgkmcnt(10)
    v_mfma_f32_16x16x32_bf16 v[16:19], v[32:35], v[48:51], 0
    ds_read_b128 v[96:99], v6 offset:3136
    s_waitcnt lgkmcnt(9)
    v_mfma_f32_16x16x32_bf16 v[28:31], v[36:39], v[56:59], v[28:31]
    ds_read_b128 v[92:95], v6 offset:3648
    v_mfma_f32_16x16x32_bf16 v[24:27], v[36:39], v[52:55], v[24:27]
    ds_read_b64 v[80:81], v5 offset:576
    ds_read_b64 v[82:83], v5 offset:584
    v_mfma_f32_16x16x32_bf16 v[20:23], v[36:39], v[48:51], v[20:23]
    ds_read_b64 v[84:85], v5 offset:1088
    s_waitcnt lgkmcnt(11)
    v_mfma_f32_16x16x32_bf16 v[28:31], v[40:43], v[52:55], v[28:31]
    ds_read_b64 v[86:87], v5 offset:1096
    v_mfma_f32_16x16x32_bf16 v[24:27], v[40:43], v[48:51], v[24:27]
    ds_read_b64 v[88:89], v5 offset:1600
    s_waitcnt lgkmcnt(11)
    v_mfma_f32_16x16x32_bf16 v[28:31], v[44:47], v[48:51], v[28:31]
    ds_read_b64 v[90:91], v5 offset:1608
    s_waitcnt lgkmcnt(4)
    v_mfma_f32_16x16x32_bf16 v[28:31], v[76:79], v[104:107], v[28:31]
    ds_read_b64 v[32:33], v5 offset:128
    ds_read_b64 v[34:35], v5 offset:136
    v_mfma_f32_16x16x32_bf16 v[24:27], v[76:79], v[100:103], v[24:27]
    ds_read_b128 v[60:63], v6 offset:2176
    v_mfma_f32_16x16x32_bf16 v[20:23], v[76:79], v[96:99], v[20:23]
    ds_read_b128 v[56:59], v6 offset:2688
    v_mfma_f32_16x16x32_bf16 v[16:19], v[76:79], v[92:95], v[16:19]
    ds_read_b128 v[52:55], v6 offset:3200
    v_mfma_f32_16x16x32_bf16 v[28:31], v[80:83], v[100:103], v[28:31]
    ds_read_b128 v[48:51], v6 offset:3712
    s_waitcnt lgkmcnt(6)
    v_mfma_f32_16x16x32_bf16 v[24:27], v[80:83], v[96:99], v[24:27]
    ds_read_b64 v[36:37], v5 offset:640
    ds_read_b64 v[38:39], v5 offset:648
    v_mfma_f32_16x16x32_bf16 v[20:23], v[80:83], v[92:95], v[20:23]
    ds_read_b64 v[40:41], v5 offset:1152
    v_mfma_f32_16x16x32_bf16 v[28:31], v[84:87], v[96:99], v[28:31]
    ds_read_b64 v[42:43], v5 offset:1160
    v_mfma_f32_16x16x32_bf16 v[24:27], v[84:87], v[92:95], v[24:27]
    ds_read_b64 v[44:45], v5 offset:1664
    v_mfma_f32_16x16x32_bf16 v[28:31], v[88:91], v[92:95], v[28:31]
    ds_read_b64 v[46:47], v5 offset:1672
    s_waitcnt lgkmcnt(4)
    v_mfma_f32_16x16x32_bf16 v[28:31], v[32:35], v[60:63], v[28:31]
    ds_read_b64 v[76:77], v5 offset:192
    ds_read_b64 v[78:79], v5 offset:200
    v_mfma_f32_16x16x32_bf16 v[24:27], v[32:35], v[56:59], v[24:27]
    ds_read_b128 v[104:107], v6 offset:2240
    v_mfma_f32_16x16x32_bf16 v[20:23], v[32:35], v[52:55], v[20:23]
    ds_read_b128 v[100:103], v6 offset:2752
    v_mfma_f32_16x16x32_bf16 v[16:19], v[32:35], v[48:51], v[16:19]
    ds_read_b128 v[96:99], v6 offset:3264
    v_mfma_f32_16x16x32_bf16 v[28:31], v[36:39], v[56:59], v[28:31]
    ds_read_b128 v[92:95], v6 offset:3776
    s_waitcnt lgkmcnt(6)
    v_mfma_f32_16x16x32_bf16 v[24:27], v[36:39], v[52:55], v[24:27]
    ds_read_b64 v[80:81], v5 offset:704
    ds_read_b64 v[82:83], v5 offset:712
    v_mfma_f32_16x16x32_bf16 v[20:23], v[36:39], v[48:51], v[20:23]
    ds_read_b64 v[84:85], v5 offset:1216
    v_mfma_f32_16x16x32_bf16 v[28:31], v[40:43], v[52:55], v[28:31]
    ds_read_b64 v[86:87], v5 offset:1224
    v_mfma_f32_16x16x32_bf16 v[24:27], v[40:43], v[48:51], v[24:27]
    ds_read_b64 v[88:89], v5 offset:1728
    v_mfma_f32_16x16x32_bf16 v[28:31], v[44:47], v[48:51], v[28:31]
    ds_read_b64 v[90:91], v5 offset:1736
    s_waitcnt lgkmcnt(4)
    v_mfma_f32_16x16x32_bf16 v[28:31], v[76:79], v[104:107], v[28:31]
    ds_read_b64 v[32:33], v5 offset:256
    ds_read_b64 v[34:35], v5 offset:264
    v_mfma_f32_16x16x32_bf16 v[24:27], v[76:79], v[100:103], v[24:27]
    ds_read_b128 v[60:63], v6 offset:2304
    v_mfma_f32_16x16x32_bf16 v[20:23], v[76:79], v[96:99], v[20:23]
    ds_read_b128 v[56:59], v6 offset:2816
    v_mfma_f32_16x16x32_bf16 v[16:19], v[76:79], v[92:95], v[16:19]
    ds_read_b128 v[52:55], v6 offset:3328
    v_mfma_f32_16x16x32_bf16 v[28:31], v[80:83], v[100:103], v[28:31]
    ds_read_b128 v[48:51], v6 offset:3840
    s_waitcnt lgkmcnt(6)
    v_mfma_f32_16x16x32_bf16 v[24:27], v[80:83], v[96:99], v[24:27]
    ds_read_b64 v[36:37], v5 offset:768
    ds_read_b64 v[38:39], v5 offset:776
    v_mfma_f32_16x16x32_bf16 v[20:23], v[80:83], v[92:95], v[20:23]
    ds_read_b64 v[40:41], v5 offset:1280
    v_mfma_f32_16x16x32_bf16 v[28:31], v[84:87], v[96:99], v[28:31]
    ds_read_b64 v[42:43], v5 offset:1288
    v_mfma_f32_16x16x32_bf16 v[24:27], v[84:87], v[92:95], v[24:27]
    ds_read_b64 v[44:45], v5 offset:1792
    v_mfma_f32_16x16x32_bf16 v[28:31], v[88:91], v[92:95], v[28:31]
    ds_read_b64 v[46:47], v5 offset:1800
    s_waitcnt lgkmcnt(4)
    v_mfma_f32_16x16x32_bf16 v[28:31], v[32:35], v[60:63], v[28:31]
    ds_read_b64 v[76:77], v5 offset:320
    ds_read_b64 v[78:79], v5 offset:328
    v_mfma_f32_16x16x32_bf16 v[24:27], v[32:35], v[56:59], v[24:27]
    ds_read_b128 v[104:107], v6 offset:2368
    v_mfma_f32_16x16x32_bf16 v[20:23], v[32:35], v[52:55], v[20:23]
    ds_read_b128 v[100:103], v6 offset:2880
    v_mfma_f32_16x16x32_bf16 v[16:19], v[32:35], v[48:51], v[16:19]
    ds_read_b128 v[96:99], v6 offset:3392
    v_mfma_f32_16x16x32_bf16 v[28:31], v[36:39], v[56:59], v[28:31]
    ds_read_b128 v[92:95], v6 offset:3904
    s_waitcnt lgkmcnt(6)
    v_mfma_f32_16x16x32_bf16 v[24:27], v[36:39], v[52:55], v[24:27]
    ds_read_b64 v[80:81], v5 offset:832
    ds_read_b64 v[82:83], v5 offset:840
    v_mfma_f32_16x16x32_bf16 v[20:23], v[36:39], v[48:51], v[20:23]
    ds_read_b64 v[84:85], v5 offset:1344
    v_mfma_f32_16x16x32_bf16 v[28:31], v[40:43], v[52:55], v[28:31]
    ds_read_b64 v[86:87], v5 offset:1352
    v_mfma_f32_16x16x32_bf16 v[24:27], v[40:43], v[48:51], v[24:27]
    ds_read_b64 v[88:89], v5 offset:1856
    v_mfma_f32_16x16x32_bf16 v[28:31], v[44:47], v[48:51], v[28:31]
    ds_read_b64 v[90:91], v5 offset:1864
    s_waitcnt lgkmcnt(4)
    v_mfma_f32_16x16x32_bf16 v[28:31], v[76:79], v[104:107], v[28:31]
    ds_read_b64 v[32:33], v5 offset:384
    ds_read_b64 v[34:35], v5 offset:392
    v_mfma_f32_16x16x32_bf16 v[24:27], v[76:79], v[100:103], v[24:27]
    ds_read_b128 v[60:63], v6 offset:2432
    v_mfma_f32_16x16x32_bf16 v[20:23], v[76:79], v[96:99], v[20:23]
    ds_read_b128 v[56:59], v6 offset:2944
    v_mfma_f32_16x16x32_bf16 v[16:19], v[76:79], v[92:95], v[16:19]
    ds_read_b128 v[52:55], v6 offset:3456
    v_mfma_f32_16x16x32_bf16 v[28:31], v[80:83], v[100:103], v[28:31]
    ds_read_b128 v[48:51], v6 offset:3968
    s_waitcnt lgkmcnt(6)
    v_mfma_f32_16x16x32_bf16 v[24:27], v[80:83], v[96:99], v[24:27]
    ds_read_b64 v[36:37], v5 offset:896
    ds_read_b64 v[38:39], v5 offset:904
    v_mfma_f32_16x16x32_bf16 v[20:23], v[80:83], v[92:95], v[20:23]
    ds_read_b64 v[40:41], v5 offset:1408
    v_mfma_f32_16x16x32_bf16 v[28:31], v[84:87], v[96:99], v[28:31]
    ds_read_b64 v[42:43], v5 offset:1416
    v_mfma_f32_16x16x32_bf16 v[24:27], v[84:87], v[92:95], v[24:27]
    ds_read_b64 v[44:45], v5 offset:1920
    v_mfma_f32_16x16x32_bf16 v[28:31], v[88:91], v[92:95], v[28:31]
    ds_read_b64 v[46:47], v5 offset:1928
    s_waitcnt lgkmcnt(4)
    v_mfma_f32_16x16x32_bf16 v[28:31], v[32:35], v[60:63], v[28:31]
    ds_read_b64 v[76:77], v5 offset:448
    ds_read_b64 v[78:79], v5 offset:456
    v_mfma_f32_16x16x32_bf16 v[24:27], v[32:35], v[56:59], v[24:27]
    ds_read_b128 v[104:107], v6 offset:2496
    v_mfma_f32_16x16x32_bf16 v[20:23], v[32:35], v[52:55], v[20:23]
    ds_read_b128 v[100:103], v6 offset:3008
    v_mfma_f32_16x16x32_bf16 v[16:19], v[32:35], v[48:51], v[16:19]
    ds_read_b128 v[96:99], v6 offset:3520
    v_mfma_f32_16x16x32_bf16 v[28:31], v[36:39], v[56:59], v[28:31]
    ds_read_b128 v[92:95], v6 offset:4032
    s_waitcnt lgkmcnt(6)
    v_mfma_f32_16x16x32_bf16 v[24:27], v[36:39], v[52:55], v[24:27]
    ds_read_b64 v[80:81], v5 offset:960
    ds_read_b64 v[82:83], v5 offset:968
    v_mfma_f32_16x16x32_bf16 v[20:23], v[36:39], v[48:51], v[20:23]
    ds_read_b64 v[84:85], v5 offset:1472
    v_mfma_f32_16x16x32_bf16 v[28:31], v[40:43], v[52:55], v[28:31]
    ds_read_b64 v[86:87], v5 offset:1480
    v_mfma_f32_16x16x32_bf16 v[24:27], v[40:43], v[48:51], v[24:27]
    ds_read_b64 v[88:89], v5 offset:1984
    v_mfma_f32_16x16x32_bf16 v[28:31], v[44:47], v[48:51], v[28:31]
    ds_read_b64 v[90:91], v5 offset:1992
    s_waitcnt lgkmcnt(4)
    v_mfma_f32_16x16x32_bf16 v[28:31], v[76:79], v[104:107], v[28:31]
    v_mfma_f32_16x16x32_bf16 v[24:27], v[76:79], v[100:103], v[24:27]
    v_mfma_f32_16x16x32_bf16 v[20:23], v[76:79], v[96:99], v[20:23]
    v_mfma_f32_16x16x32_bf16 v[16:19], v[76:79], v[92:95], v[16:19]
    v_mfma_f32_16x16x32_bf16 v[28:31], v[80:83], v[100:103], v[28:31]
    s_waitcnt lgkmcnt(0)
    v_mfma_f32_16x16x32_bf16 v[24:27], v[80:83], v[96:99], v[24:27]
    v_mfma_f32_16x16x32_bf16 v[20:23], v[80:83], v[92:95], v[20:23]
    v_mfma_f32_16x16x32_bf16 v[28:31], v[84:87], v[96:99], v[28:31]
    v_mfma_f32_16x16x32_bf16 v[24:27], v[84:87], v[92:95], v[24:27]
    v_mfma_f32_16x16x32_bf16 v[28:31], v[88:91], v[92:95], v[28:31]
    s_nop 0
    v_cvt_pk_bf16_f32 v124, v19, v18
    v_cvt_pk_bf16_f32 v125, v17, v16
    ds_write_b64 v140, v[124:125] offset:3584
    s_nop 0
    v_cvt_pk_bf16_f32 v126, v23, v22
    v_cvt_pk_bf16_f32 v127, v21, v20
    ds_write_b64 v140, v[126:127] offset:3072
    v_cvt_pk_bf16_f32 v128, v27, v26
    v_cvt_pk_bf16_f32 v129, v25, v24
    ds_write_b64 v140, v[128:129] offset:2560
    v_cvt_pk_bf16_f32 v130, v31, v30
    v_cvt_pk_bf16_f32 v131, v29, v28
    ds_write_b64 v140, v[130:131] offset:2048
    v_mov_b32 v12, 1
    s_mov_b64 exec, 1
    ds_add_u32 v1, v12 offset:96
    s_mov_b64 exec, -1
    ds_read_b32 v10, v1 offset:8
    s_cmp_eq_u32 s3, 4
    s_cbranch_scc1 C_FIN
    s_endpgm
C_KA:
    s_setprio 1
    v_lshrrev_b32 v116, 1, v4
    v_and_b32 v117, 1, v4
    v_lshlrev_b32 v116, 8, v116
    v_lshl_add_u32 v116, v117, 3, v116
    v_lshl_add_u32 v116, v3, 4, v116
    v_add_u32 v116, s15, v116
    v_cmp_gt_u32 vcc, 2, v4
    v_lshlrev_b32 v117, 2, v3
    v_lshlrev_b32 v118, 3, v3
    v_cndmask_b32 v117, v117, v118, vcc
    v_lshl_add_u32 v117, v4, 7, v117
    v_add_u32 v117, s15, v117
    v_mov_b32 v118, 64
    v_cndmask_b32 v118, v118, 4, vcc
    v_add_u32 v118, v118, v117
    v_lshlrev_b32 v119, 1, v3
    v_lshl_add_u32 v119, v4, 7, v119
    v_add_u32 v119, s15, v119
    v_lshlrev_b32 v120, 5, v2
    v_lshlrev_b32 v121, 4, v2
    v_add_u32 v121, 256, v121
    v_min_u32 v120, v120, v121
    v_lshlrev_b32 v121, 3, v2
    v_add_u32 v121, 512, v121
    v_min_u32 v120, v120, v121
    v_add_u32 v120, s15, v120
    v_min_u32 v121, 15, v2
    v_lshl_add_u32 v121, v121, 2, s15
    v_lshlrev_b32 v122, 2, v4
    v_sub_u32 v122, v3, v122
    v_lshl_add_u32 v122, v122, 2, s15
    v_add_u32 v122, 2100, v122
    v_lshl_add_u32 v123, v2, 5, s52
    s_mov_b32 s56, 0x01000100
    s_mov_b32 s57, 0x03020302
    v_and_b32 v14, 3, v3
    v_sub_u32 v14, 3, v14
    v_mul_u32_u24 v14, 2240, v14
    v_lshrrev_b32 v13, 2, v3
    v_lshl_add_u32 v13, v4, 1, v13
    v_lshl_add_u32 v14, v13, 3, v14
    v_add3_u32 v5, v14, s52, 8
    v_lshlrev_b32 v14, 1, v3
    v_sub_u32 v14, v4, v14
    v_lshlrev_b32 v14, 4, v14
    s_add_u32 s8, s53, 480
    v_add_u32 v6, s8, v14
    v_lshl_add_u32 v14, v3, 2, v4
    s_mul_i32 s8, s12, 4160
    s_add_u32 s8, s8, 100344
    v_lshlrev_b32 v14, 3, v14
    v_sub_u32 v140, s8, v14
    v_lshl_add_u32 v14, v4, 3, v3
    v_sub_u32 v14, 39, v14
    s_mov_b32 s8, 0x3f800000
    v_mov_b32 v10, 127
    v_mov_b32 v11, 0
    v_lshlrev_b64 v[10:11], v14, v[10:11]
    v_alignbit_b32 v10, v11, v10, 19
    v_bfe_i32 v11, v10, 0, 1
    v_bfe_i32 v12, v10, 1, 1
    v_and_b32 v11, 0x3f80, v11
    v_and_or_b32 v142, v12, s8, v11
    v_bfe_i32 v11, v10, 2, 1
    v_bfe_i32 v12, v10, 3, 1
    v_and_b32 v11, 0x3f80, v11
    v_and_or_b32 v143, v12, s8, v11
    v_bfe_i32 v11, v10, 4, 1
    v_bfe_i32 v12, v10, 5, 1
    v_and_b32 v11, 0x3f80, v11
    v_and_or_b32 v144, v12, s8, v11
    v_bfe_i32 v11, v10, 6, 1
    v_bfe_i32 v12, v10, 7, 1
    v_and_b32 v11, 0x3f80, v11
    v_and_or_b32 v145, v12, s8, v11
    v_mov_b32 v10, 511
    v_mov_b32 v11, 0
    v_lshlrev_b64 v[10:11], v14, v[10:11]
    v_alignbit_b32 v10, v11, v10, 20
    v_bfe_i32 v11, v10, 0, 1
    v_bfe_i32 v12, v10, 1, 1
    v_and_b32 v11, 0x3f80, v11
    v_and_or_b32 v146, v12, s8, v11
    v_bfe_i32 v11, v10, 2, 1
    v_bfe_i32 v12, v10, 3, 1
    v_and_b32 v11, 0x3f80, v11
    v_and_or_b32 v147, v12, s8, v11
    v_bfe_i32 v11, v10, 4, 1
    v_bfe_i32 v12, v10, 5, 1
    v_and_b32 v11, 0x3f80, v11
    v_and_or_b32 v148, v12, s8, v11
    v_bfe_i32 v11, v10, 6, 1
    v_bfe_i32 v12, v10, 7, 1
    v_and_b32 v11, 0x3f80, v11
    v_and_or_b32 v149, v12, s8, v11
    s_lshl_b32 s8, s12, 4
    s_lshr_b64 s[68:69], s[68:69], s8
    s_lshl_b32 s68, s68, 16
    s_sub_u32 s58, 254, s54
    s_lshl_b32 s58, s58, 23
    v_mul_f32 v104, s58, v104
    v_mul_f32 v105, s58, v105
    v_mul_f32 v106, s58, v106
    v_mul_f32 v107, s58, v107
    v_mul_f32 v108, s58, v108
    v_mul_f32 v109, s58, v109
    v_mul_f32 v110, s58, v110
    v_mul_f32 v111, s58, v111
    v_mul_f32 v112, s58, v112
    v_mul_f32 v113, s58, v113
    v_mul_f32 v114, s58, v114
    v_mul_f32 v115, s58, v115
    s_mov_b64 exec, 1
    v_add_f32 v104, s68, v104
    s_mov_b64 exec, -1
    s_setprio 0
    s_mov_b32 s9, 0
SP_18:
    ds_read_b32 v18, v9
    s_waitcnt lgkmcnt(0)
    v_readfirstlane_b32 s8, v18
    s_add_u32 s9, s9, 1
    s_cmp_lg_u32 s8, 0
    s_cbranch_scc1 SP_18_D
    s_cmp_lt_u32 s9, 524288
    s_cbranch_scc1 SP_18
SP_18_D:
    s_setprio 2
    s_sub_u32 s60, 254, s8
    s_lshl_b32 s60, s60, 23
    ds_read_b128 v[88:91], v8 offset:18432
    ds_read_b128 v[92:95], v8 offset:19456
    ds_read_b128 v[96:99], v8 offset:20480
    s_waitcnt lgkmcnt(2)
    v_pk_fma_f32 v[104:105], v[88:89], s[60:61], v[104:105] op_sel_hi:[1,0,1]
    v_cvt_pk_bf16_f32 v20, v104, v105
    v_pk_fma_f32 v[106:107], v[90:91], s[60:61], v[106:107] op_sel_hi:[1,0,1]
    v_cvt_pk_bf16_f32 v21, v106, v107
    ds_write_b64 v116, v[20:21]
    s_waitcnt lgkmcnt(2)
    v_pk_fma_f32 v[108:109], v[92:93], s[60:61], v[108:109] op_sel_hi:[1,0,1]
    v_cvt_pk_bf16_f32 v22, v108, v109
    v_pk_fma_f32 v[110:111], v[94:95], s[60:61], v[110:111] op_sel_hi:[1,0,1]
    v_cvt_pk_bf16_f32 v23, v110, v111
    ds_write_b32 v117, v22 offset:512
    ds_write_b32 v118, v23 offset:512
    s_waitcnt lgkmcnt(3)
    v_pk_fma_f32 v[112:113], v[96:97], s[60:61], v[112:113] op_sel_hi:[1,0,1]
    v_cvt_pk_bf16_f32 v24, v112, v113
    v_pk_fma_f32 v[114:115], v[98:99], s[60:61], v[114:115] op_sel_hi:[1,0,1]
    v_cvt_pk_bf16_f32 v25, v114, v115
    ds_write_b16 v119, v24 offset:1024
    ds_read_b64 v[32:33], v120 offset:0
    ds_read_b64 v[34:35], v120 offset:8
    ds_read_b64 v[36:37], v120 offset:16
    ds_read_b64 v[38:39], v120 offset:24
    s_mov_b32 exec_lo, 0xffff0000
    s_mov_b32 exec_hi, 0
    s_waitcnt lgkmcnt(0)
    v_alignbit_b32 v39, v36, v35, 16
    v_perm_b32 v38, v35, v35, s56
    v_alignbit_b32 v37, v35, v34, 16
    v_perm_b32 v36, v34, v34, s56
    v_alignbit_b32 v35, v34, v33, 16
    v_perm_b32 v34, v33, v33, s56
    v_alignbit_b32 v33, v33, v32, 16
    v_perm_b32 v32, v32, v32, s56
    s_mov_b32 exec_lo, 0
    s_mov_b32 exec_hi, -1
    v_perm_b32 v39, v34, v34, s56
    v_perm_b32 v38, v33, v33, s57
    v_mov_b32 v37, v33
    v_perm_b32 v36, v33, v33, s56
    v_perm_b32 v35, v33, v33, s56
    v_perm_b32 v34, v32, v32, s57
    v_mov_b32 v33, v32
    v_perm_b32 v32, v32, v32, s56
    s_mov_b64 exec, -1
    ds_write_b128 v123, v[32:35] offset:32
    ds_write_b128 v123, v[36:39] offset:48
    v_mov_b32_dpp v30, v38 wave_shr:1 row_mask:0xf bank_mask:0xf bound_ctrl:0
    v_mov_b32_dpp v31, v39 wave_shr:1 row_mask:0xf bank_mask:0xf bound_ctrl:0
    v_alignbit_b32 v44, v32, v31, 16
    v_alignbit_b32 v45, v33, v32, 16
    v_alignbit_b32 v46, v34, v33, 16
    v_alignbit_b32 v47, v35, v34, 16
    ds_write_b128 v123, v[44:47] offset:2272
    v_alignbit_b32 v48, v36, v35, 16
    v_alignbit_b32 v49, v37, v36, 16
    v_alignbit_b32 v50, v38, v37, 16
    v_alignbit_b32 v51, v39, v38, 16
    ds_write_b128 v123, v[48:51] offset:2288
    v_pk_mov_b32 v[52:53], v[30:31], v[32:33] op_sel:[1,0]
    v_pk_mov_b32 v[54:55], v[32:33], v[34:35] op_sel:[1,0]
    ds_write_b128 v123, v[52:55] offset:4512
    v_pk_mov_b32 v[56:57], v[34:35], v[36:37] op_sel:[1,0]
    v_pk_mov_b32 v[58:59], v[36:37], v[38:39] op_sel:[1,0]
    ds_write_b128 v123, v[56:59] offset:4528
    v_alignbit_b32 v60, v31, v30, 16
    v_alignbit_b32 v61, v32, v31, 16
    v_alignbit_b32 v62, v33, v32, 16
    v_alignbit_b32 v63, v34, v33, 16
    ds_write_b128 v123, v[60:63] offset:6752
    v_alignbit_b32 v64, v35, v34, 16
    v_alignbit_b32 v65, v36, v35, 16
    v_alignbit_b32 v66, v37, v36, 16
    v_alignbit_b32 v67, v38, v37, 16
    ds_write_b128 v123, v[64:67] offset:6768
    v_mov_b32 v10, 1
    ds_write_b32 v9, v10 offset:48
    s_setprio 3
    ds_write_b16 v119, v24 offset:2110
    ds_write_b16_d16_hi v119, v24 offset:2142
    ds_write_b16 v119, v25 offset:2174
    ds_write_b16_d16_hi v119, v25 offset:2206
    ds_write_b32 v121, v1 offset:2048
    ds_read2_b32 v[150:151], v122 offset0:3 offset1:2
    ds_read2_b32 v[152:153], v122 offset0:1 offset1:0
    ds_read2_b32 v[154:155], v122 offset0:19 offset1:18
    ds_read2_b32 v[156:157], v122 offset0:17 offset1:16
    ds_read2_b32 v[158:159], v122 offset0:35 offset1:34
    ds_read2_b32 v[160:161], v122 offset0:33 offset1:32
    ds_read2_b32 v[162:163], v122 offset0:51 offset1:50
    ds_read2_b32 v[164:165], v122 offset0:49 offset1:48
    v_alignbit_b32 v72, v39, v38, 16
    v_mov_b32 v73, v39
    v_mov_b32 v74, v39
    v_mov_b32 v75, v39
    v_mov_b32 v78, v39
    v_mov_b32 v79, v39
    v_mov_b32 v80, v39
    v_mov_b32 v82, v39
    v_mov_b32 v83, v39
    v_mov_b32 v84, v39
    v_and_b32 v76, 0xffff, v39
    v_and_b32 v81, 0xffff, v39
    v_mov_b32 v77, 0
    v_mov_b32 v85, 0
    s_mov_b32 exec_lo, 0
    s_mov_b32 exec_hi, 0x80000000
    ds_write_b128 v123, v[72:75] offset:6784
    ds_write_b128 v123, v[74:77] offset:64
    ds_write_b128 v123, v[78:81] offset:4544
    ds_write_b128 v123, v[82:85] offset:2304
    s_mov_b64 exec, -1
    s_mov_b32 s9, 0
SP_19:
    ds_read_b32 v10, v1 offset:80
    s_waitcnt lgkmcnt(0)
    v_readfirstlane_b32 s8, v10
    s_add_u32 s9, s9, 1
    s_cmp_ge_u32 s8, 1
    s_cbranch_scc1 SP_19_D
    s_sleep 1
    s_cmp_lt_u32 s9, 524288
    s_cbranch_scc1 SP_19
SP_19_D:
    s_setprio 3
    ds_read_b128 v[32:35], v6 offset:3584
    ds_read_b128 v[48:51], v6 offset:3600
    ds_read_b128 v[36:39], v6 offset:3072
    ds_read_b128 v[52:55], v6 offset:3088
    ds_read_b128 v[40:43], v6 offset:2560
    ds_read_b128 v[56:59], v6 offset:2576
    ds_read_b128 v[44:47], v6 offset:2048
    ds_read_b128 v[60:63], v6 offset:2064
    ds_read_b64 v[96:97], v5 offset:2048
    ds_read_b64 v[98:99], v5 offset:2056
    s_waitcnt lgkmcnt(9)
    v_mfma_f32_16x16x32_bf16 v[64:67], v[32:35], v[142:145], 0
    s_waitcnt lgkmcnt(8)
    v_mfma_f32_16x16x32_bf16 v[80:83], v[48:51], v[146:149], 0
    s_waitcnt lgkmcnt(7)
    v_mfma_f32_16x16x32_bf16 v[68:71], v[36:39], v[142:145], 0
    s_waitcnt lgkmcnt(6)
    v_mfma_f32_16x16x32_bf16 v[84:87], v[52:55], v[146:149], 0
    s_waitcnt lgkmcnt(5)
    v_mfma_f32_16x16x32_bf16 v[72:75], v[40:43], v[142:145], 0
    s_waitcnt lgkmcnt(4)
    v_mfma_f32_16x16x32_bf16 v[88:91], v[56:59], v[146:149], 0
    s_waitcnt lgkmcnt(3)
    v_mfma_f32_16x16x32_bf16 v[76:79], v[44:47], v[142:145], 0
    s_waitcnt lgkmcnt(2)
    v_mfma_f32_16x16x32_bf16 v[92:95], v[60:63], v[146:149], 0
    s_waitcnt lgkmcnt(0)
    v_mfma_f32_16x16x32_bf16 v[16:19], v[96:99], v[32:35], 0
    v_cvt_pk_bf16_f32 v64, v64, v80
    v_cvt_pk_bf16_f32 v65, v65, v81
    v_cvt_pk_bf16_f32 v66, v66, v82
    v_cvt_pk_bf16_f32 v67, v67, v83
    v_mfma_f32_16x16x32_bf16 v[20:23], v[96:99], v[36:39], 0
    v_cvt_pk_bf16_f32 v68, v68, v84
    v_cvt_pk_bf16_f32 v69, v69, v85
    v_cvt_pk_bf16_f32 v70, v70, v86
    v_cvt_pk_bf16_f32 v71, v71, v87
    v_mfma_f32_16x16x32_bf16 v[24:27], v[96:99], v[40:43], 0
    v_cvt_pk_bf16_f32 v72, v72, v88
    v_cvt_pk_bf16_f32 v73, v73, v89
    v_cvt_pk_bf16_f32 v74, v74, v90
    v_cvt_pk_bf16_f32 v75, v75, v91
    v_mfma_f32_16x16x32_bf16 v[28:31], v[96:99], v[44:47], 0
    v_cvt_pk_bf16_f32 v76, v76, v92
    v_cvt_pk_bf16_f32 v77, v77, v93
    v_cvt_pk_bf16_f32 v78, v78, v94
    v_cvt_pk_bf16_f32 v79, v79, v95
    v_mfma_f32_16x16x32_bf16 v[16:19], v[64:67], v[150:153], v[16:19]
    v_mfma_f32_16x16x32_bf16 v[20:23], v[64:67], v[154:157], v[20:23]
    v_mfma_f32_16x16x32_bf16 v[20:23], v[68:71], v[150:153], v[20:23]
    v_mfma_f32_16x16x32_bf16 v[24:27], v[64:67], v[158:161], v[24:27]
    v_mfma_f32_16x16x32_bf16 v[24:27], v[68:71], v[154:157], v[24:27]
    v_mfma_f32_16x16x32_bf16 v[24:27], v[72:75], v[150:153], v[24:27]
    v_mfma_f32_16x16x32_bf16 v[28:31], v[64:67], v[162:165], v[28:31]
    v_mfma_f32_16x16x32_bf16 v[28:31], v[68:71], v[158:161], v[28:31]
    v_mfma_f32_16x16x32_bf16 v[28:31], v[72:75], v[154:157], v[28:31]
    v_mfma_f32_16x16x32_bf16 v[28:31], v[76:79], v[150:153], v[28:31]
    s_setprio 3
    s_mov_b32 s9, 0
SP_20:
    ds_read_b32 v10, v1 offset:84
    s_waitcnt lgkmcnt(0)
    v_readfirstlane_b32 s8, v10
    s_add_u32 s9, s9, 1
    s_cmp_ge_u32 s8, 1
    s_cbranch_scc1 SP_20_D
    s_sleep 1
    s_cmp_lt_u32 s9, 524288
    s_cbranch_scc1 SP_20
SP_20_D:
    s_setprio 1
    ds_read_b64 v[32:33], v5 offset:0
    ds_read_b64 v[34:35], v5 offset:8
    ds_read_b128 v[48:51], v6 offset:0
    ds_read_b128 v[72:75], v6 offset:512
    ds_read_b128 v[68:71], v6 offset:1024
    ds_read_b128 v[64:67], v6 offset:1536
    ds_read_b64 v[36:37], v5 offset:512
    ds_read_b64 v[38:39], v5 offset:520
    ds_read_b128 v[60:63], v6 offset:2048
    ds_read_b64 v[40:41], v5 offset:1024
    ds_read_b64 v[42:43], v5 offset:1032
    ds_read_b128 v[56:59], v6 offset:2560
    ds_read_b64 v[44:45], v5 offset:1536
    ds_read_b64 v[46:47], v5 offset:1544
    ds_read_b128 v[52:55], v6 offset:3072
    s_waitcnt lgkmcnt(12)
    v_mfma_f32_16x16x32_bf16 v[28:31], v[32:35], v[48:51], v[28:31]
    ds_read_b64 v[76:77], v5 offset:64
    s_waitcnt lgkmcnt(12)
    v_mfma_f32_16x16x32_bf16 v[24:27], v[32:35], v[72:75], v[24:27]
    ds_read_b64 v[78:79], v5 offset:72
    s_waitcnt lgkmcnt(12)
    v_mfma_f32_16x16x32_bf16 v[20:23], v[32:35], v[68:71], v[20:23]
    ds_read_b128 v[92:95], v6 offset:64
    s_waitcnt lgkmcnt(12)
    v_mfma_f32_16x16x32_bf16 v[16:19], v[32:35], v[64:67], v[16:19]
    ds_read_b128 v[116:119], v6 offset:576
    s_waitcnt lgkmcnt(11)
    v_mfma_f32_16x16x32_bf16 v[28:31], v[36:39], v[72:75], v[28:31]
    ds_read_b128 v[112:115], v6 offset:1088
    v_mfma_f32_16x16x32_bf16 v[24:27], v[36:39], v[68:71], v[24:27]
    ds_read_b128 v[108:111], v6 offset:1600
    v_mfma_f32_16x16x32_bf16 v[20:23], v[36:39], v[64:67], v[20:23]
    ds_read_b64 v[80:81], v5 offset:576
    s_waitcnt lgkmcnt(13)
    v_mfma_f32_16x16x32_bf16 v[16:19], v[36:39], v[60:63], v[16:19]
    ds_read_b64 v[82:83], v5 offset:584
    s_waitcnt lgkmcnt(12)
    v_mfma_f32_16x16x32_bf16 v[28:31], v[40:43], v[68:71], v[28:31]
    ds_read_b128 v[104:107], v6 offset:2112
    v_mfma_f32_16x16x32_bf16 v[24:27], v[40:43], v[64:67], v[24:27]
    ds_read_b64 v[84:85], v5 offset:1088
    v_mfma_f32_16x16x32_bf16 v[20:23], v[40:43], v[60:63], v[20:23]
    ds_read_b64 v[86:87], v5 offset:1096
    s_waitcnt lgkmcnt(14)
    v_mfma_f32_16x16x32_bf16 v[16:19], v[40:43], v[56:59], v[16:19]
    ds_read_b128 v[100:103], v6 offset:2624
    s_waitcnt lgkmcnt(13)
    v_mfma_f32_16x16x32_bf16 v[28:31], v[44:47], v[64:67], v[28:31]
    ds_read_b64 v[88:89], v5 offset:1600
    v_mfma_f32_16x16x32_bf16 v[24:27], v[44:47], v[60:63], v[24:27]
    ds_read_b64 v[90:91], v5 offset:1608
    v_mfma_f32_16x16x32_bf16 v[20:23], v[44:47], v[56:59], v[20:23]
    ds_read_b128 v[96:99], v6 offset:3136
    s_waitcnt lgkmcnt(15)
    v_mfma_f32_16x16x32_bf16 v[16:19], v[44:47], v[52:55], v[16:19]
    s_waitcnt lgkmcnt(6)
    v_mfma_f32_16x16x32_bf16 v[28:31], v[76:79], v[92:95], v[28:31]
    ds_read_b64 v[32:33], v5 offset:128
    v_mfma_f32_16x16x32_bf16 v[24:27], v[76:79], v[116:119], v[24:27]
    ds_read_b64 v[34:35], v5 offset:136
    v_mfma_f32_16x16x32_bf16 v[20:23], v[76:79], v[112:115], v[20:23]
    ds_read_b128 v[48:51], v6 offset:128
    v_mfma_f32_16x16x32_bf16 v[16:19], v[76:79], v[108:111], v[16:19]
    ds_read_b128 v[72:75], v6 offset:640
    v_mfma_f32_16x16x32_bf16 v[28:31], v[80:83], v[116:119], v[28:31]
    ds_read_b128 v[68:71], v6 offset:1152
    v_mfma_f32_16x16x32_bf16 v[24:27], v[80:83], v[112:115], v[24:27]
    ds_read_b128 v[64:67], v6 offset:1664
    v_mfma_f32_16x16x32_bf16 v[20:23], v[80:83], v[108:111], v[20:23]
    ds_read_b64 v[36:37], v5 offset:640
    v_mfma_f32_16x16x32_bf16 v[16:19], v[80:83], v[104:107], v[16:19]
    ds_read_b64 v[38:39], v5 offset:648
    s_waitcnt lgkmcnt(8)
    v_mfma_f32_16x16x32_bf16 v[28:31], v[84:87], v[112:115], v[28:31]
    ds_read_b128 v[60:63], v6 offset:2176
    v_mfma_f32_16x16x32_bf16 v[24:27], v[84:87], v[108:111], v[24:27]
    ds_read_b64 v[40:41], v5 offset:1152
    v_mfma_f32_16x16x32_bf16 v[20:23], v[84:87], v[104:107], v[20:23]
    ds_read_b64 v[42:43], v5 offset:1160
    v_mfma_f32_16x16x32_bf16 v[16:19], v[84:87], v[100:103], v[16:19]
    ds_read_b128 v[56:59], v6 offset:2688
    v_mfma_f32_16x16x32_bf16 v[28:31], v[88:91], v[108:111], v[28:31]
    ds_read_b64 v[44:45], v5 offset:1664
    v_mfma_f32_16x16x32_bf16 v[24:27], v[88:91], v[104:107], v[24:27]
    ds_read_b64 v[46:47], v5 offset:1672
    v_mfma_f32_16x16x32_bf16 v[20:23], v[88:91], v[100:103], v[20:23]
    ds_read_b128 v[52:55], v6 offset:3200
    v_mfma_f32_16x16x32_bf16 v[16:19], v[88:91], v[96:99], v[16:19]
    s_waitcnt lgkmcnt(6)
    v_mfma_f32_16x16x32_bf16 v[28:31], v[32:35], v[48:51], v[28:31]
    ds_read_b64 v[76:77], v5 offset:192
    v_mfma_f32_16x16x32_bf16 v[24:27], v[32:35], v[72:75], v[24:27]
    ds_read_b64 v[78:79], v5 offset:200
    v_mfma_f32_16x16x32_bf16 v[20:23], v[32:35], v[68:71], v[20:23]
    ds_read_b128 v[92:95], v6 offset:192
    v_mfma_f32_16x16x32_bf16 v[16:19], v[32:35], v[64:67], v[16:19]
    ds_read_b128 v[116:119], v6 offset:704
    v_mfma_f32_16x16x32_bf16 v[28:31], v[36:39], v[72:75], v[28:31]
    ds_read_b128 v[112:115], v6 offset:1216
    v_mfma_f32_16x16x32_bf16 v[24:27], v[36:39], v[68:71], v[24:27]
    ds_read_b128 v[108:111], v6 offset:1728
    v_mfma_f32_16x16x32_bf16 v[20:23], v[36:39], v[64:67], v[20:23]
    ds_read_b64 v[80:81], v5 offset:704
    v_mfma_f32_16x16x32_bf16 v[16:19], v[36:39], v[60:63], v[16:19]
    ds_read_b64 v[82:83], v5 offset:712
    s_waitcnt lgkmcnt(8)
    v_mfma_f32_16x16x32_bf16 v[28:31], v[40:43], v[68:71], v[28:31]
    ds_read_b128 v[104:107], v6 offset:2240
    v_mfma_f32_16x16x32_bf16 v[24:27], v[40:43], v[64:67], v[24:27]
    ds_read_b64 v[84:85], v5 offset:1216
    v_mfma_f32_16x16x32_bf16 v[20:23], v[40:43], v[60:63], v[20:23]
    ds_read_b64 v[86:87], v5 offset:1224
    v_mfma_f32_16x16x32_bf16 v[16:19], v[40:43], v[56:59], v[16:19]
    ds_read_b128 v[100:103], v6 offset:2752
    v_mfma_f32_16x16x32_bf16 v[28:31], v[44:47], v[64:67], v[28:31]
    ds_read_b64 v[88:89], v5 offset:1728
    v_mfma_f32_16x16x32_bf16 v[24:27], v[44:47], v[60:63], v[24:27]
    ds_read_b64 v[90:91], v5 offset:1736
    v_mfma_f32_16x16x32_bf16 v[20:23], v[44:47], v[56:59], v[20:23]
    ds_read_b128 v[96:99], v6 offset:3264
    v_mfma_f32_16x16x32_bf16 v[16:19], v[44:47], v[52:55], v[16:19]
    s_waitcnt lgkmcnt(6)
    v_mfma_f32_16x16x32_bf16 v[28:31], v[76:79], v[92:95], v[28:31]
    ds_read_b64 v[32:33], v5 offset:256
    v_mfma_f32_16x16x32_bf16 v[24:27], v[76:79], v[116:119], v[24:27]
    ds_read_b64 v[34:35], v5 offset:264
    v_mfma_f32_16x16x32_bf16 v[20:23], v[76:79], v[112:115], v[20:23]
    ds_read_b128 v[48:51], v6 offset:256
    v_mfma_f32_16x16x32_bf16 v[16:19], v[76:79], v[108:111], v[16:19]
    ds_read_b128 v[72:75], v6 offset:768
    v_mfma_f32_16x16x32_bf16 v[28:31], v[80:83], v[116:119], v[28:31]
    ds_read_b128 v[68:71], v6 offset:1280
    v_mfma_f32_16x16x32_bf16 v[24:27], v[80:83], v[112:115], v[24:27]
    ds_read_b128 v[64:67], v6 offset:1792
    v_mfma_f32_16x16x32_bf16 v[20:23], v[80:83], v[108:111], v[20:23]
    ds_read_b64 v[36:37], v5 offset:768
    v_mfma_f32_16x16x32_bf16 v[16:19], v[80:83], v[104:107], v[16:19]
    ds_read_b64 v[38:39], v5 offset:776
    s_waitcnt lgkmcnt(8)
    v_mfma_f32_16x16x32_bf16 v[28:31], v[84:87], v[112:115], v[28:31]
    ds_read_b128 v[60:63], v6 offset:2304
    v_mfma_f32_16x16x32_bf16 v[24:27], v[84:87], v[108:111], v[24:27]
    ds_read_b64 v[40:41], v5 offset:1280
    v_mfma_f32_16x16x32_bf16 v[20:23], v[84:87], v[104:107], v[20:23]
    ds_read_b64 v[42:43], v5 offset:1288
    v_mfma_f32_16x16x32_bf16 v[16:19], v[84:87], v[100:103], v[16:19]
    ds_read_b128 v[56:59], v6 offset:2816
    v_mfma_f32_16x16x32_bf16 v[28:31], v[88:91], v[108:111], v[28:31]
    ds_read_b64 v[44:45], v5 offset:1792
    v_mfma_f32_16x16x32_bf16 v[24:27], v[88:91], v[104:107], v[24:27]
    ds_read_b64 v[46:47], v5 offset:1800
    v_mfma_f32_16x16x32_bf16 v[20:23], v[88:91], v[100:103], v[20:23]
    ds_read_b128 v[52:55], v6 offset:3328
    v_mfma_f32_16x16x32_bf16 v[16:19], v[88:91], v[96:99], v[16:19]
    s_waitcnt lgkmcnt(6)
    v_mfma_f32_16x16x32_bf16 v[28:31], v[32:35], v[48:51], v[28:31]
    ds_read_b64 v[76:77], v5 offset:320
    v_mfma_f32_16x16x32_bf16 v[24:27], v[32:35], v[72:75], v[24:27]
    ds_read_b64 v[78:79], v5 offset:328
    v_mfma_f32_16x16x32_bf16 v[20:23], v[32:35], v[68:71], v[20:23]
    ds_read_b128 v[92:95], v6 offset:320
    v_mfma_f32_16x16x32_bf16 v[16:19], v[32:35], v[64:67], v[16:19]
    ds_read_b128 v[116:119], v6 offset:832
    v_mfma_f32_16x16x32_bf16 v[28:31], v[36:39], v[72:75], v[28:31]
    ds_read_b128 v[112:115], v6 offset:1344
    v_mfma_f32_16x16x32_bf16 v[24:27], v[36:39], v[68:71], v[24:27]
    ds_read_b128 v[108:111], v6 offset:1856
    v_mfma_f32_16x16x32_bf16 v[20:23], v[36:39], v[64:67], v[20:23]
    ds_read_b64 v[80:81], v5 offset:832
    v_mfma_f32_16x16x32_bf16 v[16:19], v[36:39], v[60:63], v[16:19]
    ds_read_b64 v[82:83], v5 offset:840
    s_waitcnt lgkmcnt(8)
    v_mfma_f32_16x16x32_bf16 v[28:31], v[40:43], v[68:71], v[28:31]
    ds_read_b128 v[104:107], v6 offset:2368
    v_mfma_f32_16x16x32_bf16 v[24:27], v[40:43], v[64:67], v[24:27]
    ds_read_b64 v[84:85], v5 offset:1344
    v_mfma_f32_16x16x32_bf16 v[20:23], v[40:43], v[60:63], v[20:23]
    ds_read_b64 v[86:87], v5 offset:1352
    v_mfma_f32_16x16x32_bf16 v[16:19], v[40:43], v[56:59], v[16:19]
    ds_read_b128 v[100:103], v6 offset:2880
    v_mfma_f32_16x16x32_bf16 v[28:31], v[44:47], v[64:67], v[28:31]
    ds_read_b64 v[88:89], v5 offset:1856
    v_mfma_f32_16x16x32_bf16 v[24:27], v[44:47], v[60:63], v[24:27]
    ds_read_b64 v[90:91], v5 offset:1864
    v_mfma_f32_16x16x32_bf16 v[20:23], v[44:47], v[56:59], v[20:23]
    ds_read_b128 v[96:99], v6 offset:3392
    v_mfma_f32_16x16x32_bf16 v[16:19], v[44:47], v[52:55], v[16:19]
    s_waitcnt lgkmcnt(6)
    v_mfma_f32_16x16x32_bf16 v[28:31], v[76:79], v[92:95], v[28:31]
    ds_read_b64 v[32:33], v5 offset:384
    v_mfma_f32_16x16x32_bf16 v[24:27], v[76:79], v[116:119], v[24:27]
    ds_read_b64 v[34:35], v5 offset:392
    v_mfma_f32_16x16x32_bf16 v[20:23], v[76:79], v[112:115], v[20:23]
    ds_read_b128 v[48:51], v6 offset:384
    v_mfma_f32_16x16x32_bf16 v[16:19], v[76:79], v[108:111], v[16:19]
    ds_read_b128 v[72:75], v6 offset:896
    v_mfma_f32_16x16x32_bf16 v[28:31], v[80:83], v[116:119], v[28:31]
    ds_read_b128 v[68:71], v6 offset:1408
    v_mfma_f32_16x16x32_bf16 v[24:27], v[80:83], v[112:115], v[24:27]
    ds_read_b128 v[64:67], v6 offset:1920
    v_mfma_f32_16x16x32_bf16 v[20:23], v[80:83], v[108:111], v[20:23]
    ds_read_b64 v[36:37], v5 offset:896
    v_mfma_f32_16x16x32_bf16 v[16:19], v[80:83], v[104:107], v[16:19]
    ds_read_b64 v[38:39], v5 offset:904
    s_waitcnt lgkmcnt(8)
    v_mfma_f32_16x16x32_bf16 v[28:31], v[84:87], v[112:115], v[28:31]
    ds_read_b128 v[60:63], v6 offset:2432
    v_mfma_f32_16x16x32_bf16 v[24:27], v[84:87], v[108:111], v[24:27]
    ds_read_b64 v[40:41], v5 offset:1408
    v_mfma_f32_16x16x32_bf16 v[20:23], v[84:87], v[104:107], v[20:23]
    ds_read_b64 v[42:43], v5 offset:1416
    v_mfma_f32_16x16x32_bf16 v[16:19], v[84:87], v[100:103], v[16:19]
    ds_read_b128 v[56:59], v6 offset:2944
    v_mfma_f32_16x16x32_bf16 v[28:31], v[88:91], v[108:111], v[28:31]
    ds_read_b64 v[44:45], v5 offset:1920
    v_mfma_f32_16x16x32_bf16 v[24:27], v[88:91], v[104:107], v[24:27]
    ds_read_b64 v[46:47], v5 offset:1928
    v_mfma_f32_16x16x32_bf16 v[20:23], v[88:91], v[100:103], v[20:23]
    ds_read_b128 v[52:55], v6 offset:3456
    v_mfma_f32_16x16x32_bf16 v[16:19], v[88:91], v[96:99], v[16:19]
    s_waitcnt lgkmcnt(6)
    v_mfma_f32_16x16x32_bf16 v[28:31], v[32:35], v[48:51], v[28:31]
    ds_read_b64 v[76:77], v5 offset:448
    v_mfma_f32_16x16x32_bf16 v[24:27], v[32:35], v[72:75], v[24:27]
    ds_read_b64 v[78:79], v5 offset:456
    v_mfma_f32_16x16x32_bf16 v[20:23], v[32:35], v[68:71], v[20:23]
    ds_read_b128 v[92:95], v6 offset:448
    v_mfma_f32_16x16x32_bf16 v[16:19], v[32:35], v[64:67], v[16:19]
    ds_read_b128 v[116:119], v6 offset:960
    v_mfma_f32_16x16x32_bf16 v[28:31], v[36:39], v[72:75], v[28:31]
    ds_read_b128 v[112:115], v6 offset:1472
    v_mfma_f32_16x16x32_bf16 v[24:27], v[36:39], v[68:71], v[24:27]
    ds_read_b128 v[108:111], v6 offset:1984
    v_mfma_f32_16x16x32_bf16 v[20:23], v[36:39], v[64:67], v[20:23]
    ds_read_b64 v[80:81], v5 offset:960
    v_mfma_f32_16x16x32_bf16 v[16:19], v[36:39], v[60:63], v[16:19]
    ds_read_b64 v[82:83], v5 offset:968
    s_waitcnt lgkmcnt(8)
    v_mfma_f32_16x16x32_bf16 v[28:31], v[40:43], v[68:71], v[28:31]
    ds_read_b128 v[104:107], v6 offset:2496
    v_mfma_f32_16x16x32_bf16 v[24:27], v[40:43], v[64:67], v[24:27]
    ds_read_b64 v[84:85], v5 offset:1472
    v_mfma_f32_16x16x32_bf16 v[20:23], v[40:43], v[60:63], v[20:23]
    ds_read_b64 v[86:87], v5 offset:1480
    v_mfma_f32_16x16x32_bf16 v[16:19], v[40:43], v[56:59], v[16:19]
    ds_read_b128 v[100:103], v6 offset:3008
    v_mfma_f32_16x16x32_bf16 v[28:31], v[44:47], v[64:67], v[28:31]
    ds_read_b64 v[88:89], v5 offset:1984
    v_mfma_f32_16x16x32_bf16 v[24:27], v[44:47], v[60:63], v[24:27]
    ds_read_b64 v[90:91], v5 offset:1992
    v_mfma_f32_16x16x32_bf16 v[20:23], v[44:47], v[56:59], v[20:23]
    ds_read_b128 v[96:99], v6 offset:3520
    v_mfma_f32_16x16x32_bf16 v[16:19], v[44:47], v[52:55], v[16:19]
    s_waitcnt lgkmcnt(6)
    v_mfma_f32_16x16x32_bf16 v[28:31], v[76:79], v[92:95], v[28:31]
    v_mfma_f32_16x16x32_bf16 v[24:27], v[76:79], v[116:119], v[24:27]
    v_mfma_f32_16x16x32_bf16 v[20:23], v[76:79], v[112:115], v[20:23]
    v_mfma_f32_16x16x32_bf16 v[16:19], v[76:79], v[108:111], v[16:19]
    v_mfma_f32_16x16x32_bf16 v[28:31], v[80:83], v[116:119], v[28:31]
    v_mfma_f32_16x16x32_bf16 v[24:27], v[80:83], v[112:115], v[24:27]
    v_mfma_f32_16x16x32_bf16 v[20:23], v[80:83], v[108:111], v[20:23]
    v_mfma_f32_16x16x32_bf16 v[16:19], v[80:83], v[104:107], v[16:19]
    s_waitcnt lgkmcnt(0)
    v_mfma_f32_16x16x32_bf16 v[28:31], v[84:87], v[112:115], v[28:31]
    v_mfma_f32_16x16x32_bf16 v[24:27], v[84:87], v[108:111], v[24:27]
    v_mfma_f32_16x16x32_bf16 v[20:23], v[84:87], v[104:107], v[20:23]
    v_mfma_f32_16x16x32_bf16 v[16:19], v[84:87], v[100:103], v[16:19]
    v_mfma_f32_16x16x32_bf16 v[28:31], v[88:91], v[108:111], v[28:31]
    v_mfma_f32_16x16x32_bf16 v[24:27], v[88:91], v[104:107], v[24:27]
    v_mfma_f32_16x16x32_bf16 v[20:23], v[88:91], v[100:103], v[20:23]
    v_mfma_f32_16x16x32_bf16 v[16:19], v[88:91], v[96:99], v[16:19]
    s_nop 4
    v_cvt_pk_bf16_f32 v124, v31, v30
    v_cvt_pk_bf16_f32 v125, v29, v28
    ds_write_b64 v140, v[124:125] offset:0
    v_cvt_pk_bf16_f32 v126, v27, v26
    v_cvt_pk_bf16_f32 v127, v25, v24
    ds_write_b64 v140, v[126:127] offset:512
    v_cvt_pk_bf16_f32 v128, v23, v22
    v_cvt_pk_bf16_f32 v129, v21, v20
    ds_write_b64 v140, v[128:129] offset:1024
    v_cvt_pk_bf16_f32 v130, v19, v18
    v_cvt_pk_bf16_f32 v131, v17, v16
    ds_write_b64 v140, v[130:131] offset:1536
    v_mov_b32 v12, 1
    s_mov_b64 exec, 1
    ds_add_u32 v1, v12 offset:100
    s_mov_b64 exec, -1
    s_endpgm
SELECT:
    s_mov_b32 s52, s16
    s_mov_b32 s53, s17
    s_mov_b32 s54, 2359296
    s_mov_b32 s55, 0x20000
    v_lshlrev_b32 v7, 4, v2
    v_add_u32 v15, 0x1000, v7
    v_lshlrev_b32 v8, 2, v2
    v_sub_u32 v8, 2047, v8
    v_subrev_u32 v48, 0, v8
    v_subrev_u32 v49, 1, v8
    v_subrev_u32 v50, 2, v8
    v_subrev_u32 v51, 3, v8
    v_subrev_u32 v52, 256, v8
    v_subrev_u32 v53, 257, v8
    v_subrev_u32 v54, 258, v8
    v_subrev_u32 v55, 259, v8
    v_subrev_u32 v56, 512, v8
    v_subrev_u32 v57, 513, v8
    v_subrev_u32 v58, 514, v8
    v_subrev_u32 v59, 515, v8
    v_subrev_u32 v60, 768, v8
    v_subrev_u32 v61, 769, v8
    v_subrev_u32 v62, 770, v8
    v_subrev_u32 v63, 771, v8
    v_subrev_u32 v64, 1024, v8
    v_subrev_u32 v65, 1025, v8
    v_subrev_u32 v66, 1026, v8
    v_subrev_u32 v67, 1027, v8
    v_subrev_u32 v68, 1280, v8
    v_subrev_u32 v69, 1281, v8
    v_subrev_u32 v70, 1282, v8
    v_subrev_u32 v71, 1283, v8
    v_subrev_u32 v72, 1536, v8
    v_subrev_u32 v73, 1537, v8
    v_subrev_u32 v74, 1538, v8
    v_subrev_u32 v75, 1539, v8
    v_subrev_u32 v76, 1792, v8
    v_subrev_u32 v77, 1793, v8
    v_subrev_u32 v78, 1794, v8
    v_subrev_u32 v79, 1795, v8
    v_lshrrev_b32 v9, 3, v2
    v_and_b32 v9, 6, v9
    v_xor_b32 v9, v9, v2
    v_and_b32 v9, 7, v9
    v_lshlrev_b32 v5, 4, v9
    v_mov_b32 v12, 0
    v_mov_b32 v6, 0
    s_mov_b32 s11, 0xffff0000
    s_mov_b32 s9, 0
SP_21:
    ds_read_b32 v13, v1 offset:12
    s_waitcnt lgkmcnt(0)
    v_readfirstlane_b32 s8, v13
    s_add_u32 s9, s9, 1
    s_cmp_ge_u32 s8, 2
    s_cbranch_scc1 SP_21_D
    s_cmp_lt_u32 s9, 524288
    s_cbranch_scc1 SP_21
SP_21_D:
    s_mov_b32 s9, 0
    s_waitcnt vmcnt(0)
    s_sleep 20
SEL_POLL:
    global_load_dwordx4 v[16:19], v7, s[50:51] offset:0 sc1
    global_load_dwordx4 v[20:23], v7, s[50:51] offset:1024 sc1
    global_load_dwordx4 v[24:27], v7, s[50:51] offset:2048 sc1
    global_load_dwordx4 v[28:31], v7, s[50:51] offset:3072 sc1
    global_load_dwordx4 v[32:35], v15, s[50:51] offset:0 sc1
    global_load_dwordx4 v[36:39], v15, s[50:51] offset:1024 sc1
    global_load_dwordx4 v[40:43], v15, s[50:51] offset:2048 sc1
    global_load_dwordx4 v[44:47], v15, s[50:51] offset:3072 sc1
    s_waitcnt vmcnt(7)
    v_xor_b32 v13, v17, v14
    v_bitop3_b32 v13, v13, v19, v14 bitop3:0xf6
    s_waitcnt vmcnt(6)
    v_bitop3_b32 v13, v13, v21, v14 bitop3:0xf6
    v_bitop3_b32 v13, v13, v23, v14 bitop3:0xf6
    s_waitcnt vmcnt(5)
    v_bitop3_b32 v13, v13, v25, v14 bitop3:0xf6
    v_bitop3_b32 v13, v13, v27, v14 bitop3:0xf6
    s_waitcnt vmcnt(4)
    v_bitop3_b32 v13, v13, v29, v14 bitop3:0xf6
    v_bitop3_b32 v13, v13, v31, v14 bitop3:0xf6
    s_waitcnt vmcnt(3)
    v_bitop3_b32 v13, v13, v33, v14 bitop3:0xf6
    v_bitop3_b32 v13, v13, v35, v14 bitop3:0xf6
    s_waitcnt vmcnt(2)
    v_bitop3_b32 v13, v13, v37, v14 bitop3:0xf6
    v_bitop3_b32 v13, v13, v39, v14 bitop3:0xf6
    s_waitcnt vmcnt(1)
    v_bitop3_b32 v13, v13, v41, v14 bitop3:0xf6
    v_bitop3_b32 v13, v13, v43, v14 bitop3:0xf6
    s_waitcnt vmcnt(0)
    v_bitop3_b32 v13, v13, v45, v14 bitop3:0xf6
    v_bitop3_b32 v13, v13, v47, v14 bitop3:0xf6
    v_cmp_ne_u32 vcc, 0, v13
    s_add_u32 s9, s9, 1
    s_cmp_eq_u64 vcc, 0
    s_cbranch_scc1 SEL_GOT
    s_cmp_lt_u32 s9, 131072
    s_cbranch_scc1 SEL_POLL
SEL_GOT:
    v_lshl_or_b32 v80, v16, 16, v48
    v_and_or_b32 v81, v16, s11, v49
    v_lshl_or_b32 v82, v18, 16, v50
    v_and_or_b32 v83, v18, s11, v51
    v_min_u32 v9, v80, v81
    v_max_u32 v8, v80, v81
    v_med3_u32 v9, v8, v9, v82
    v_max_u32 v8, v8, v82
    v_med3_u32 v9, v8, v9, v83
    v_max_u32 v8, v8, v83
    v_lshl_or_b32 v84, v20, 16, v52
    v_and_or_b32 v85, v20, s11, v53
    v_lshl_or_b32 v86, v22, 16, v54
    v_and_or_b32 v87, v22, s11, v55
    v_med3_u32 v9, v8, v9, v84
    v_max_u32 v8, v8, v84
    v_med3_u32 v9, v8, v9, v85
    v_max_u32 v8, v8, v85
    v_med3_u32 v9, v8, v9, v86
    v_max_u32 v8, v8, v86
    v_med3_u32 v9, v8, v9, v87
    v_max_u32 v8, v8, v87
    v_lshl_or_b32 v88, v24, 16, v56
    v_and_or_b32 v89, v24, s11, v57
    v_lshl_or_b32 v90, v26, 16, v58
    v_and_or_b32 v91, v26, s11, v59
    v_med3_u32 v9, v8, v9, v88
    v_max_u32 v8, v8, v88
    v_med3_u32 v9, v8, v9, v89
    v_max_u32 v8, v8, v89
    v_med3_u32 v9, v8, v9, v90
    v_max_u32 v8, v8, v90
    v_med3_u32 v9, v8, v9, v91
    v_max_u32 v8, v8, v91
    v_lshl_or_b32 v92, v28, 16, v60
    v_and_or_b32 v93, v28, s11, v61
    v_lshl_or_b32 v94, v30, 16, v62
    v_and_or_b32 v95, v30, s11, v63
    v_med3_u32 v9, v8, v9, v92
    v_max_u32 v8, v8, v92
    v_med3_u32 v9, v8, v9, v93
    v_max_u32 v8, v8, v93
    v_med3_u32 v9, v8, v9, v94
    v_max_u32 v8, v8, v94
    v_med3_u32 v9, v8, v9, v95
    v_max_u32 v8, v8, v95
    v_lshl_or_b32 v96, v32, 16, v64
    v_and_or_b32 v97, v32, s11, v65
    v_lshl_or_b32 v98, v34, 16, v66
    v_and_or_b32 v99, v34, s11, v67
    v_med3_u32 v9, v8, v9, v96
    v_max_u32 v8, v8, v96
    v_med3_u32 v9, v8, v9, v97
    v_max_u32 v8, v8, v97
    v_med3_u32 v9, v8, v9, v98
    v_max_u32 v8, v8, v98
    v_med3_u32 v9, v8, v9, v99
    v_max_u32 v8, v8, v99
    v_lshl_or_b32 v100, v36, 16, v68
    v_and_or_b32 v101, v36, s11, v69
    v_lshl_or_b32 v102, v38, 16, v70
    v_and_or_b32 v103, v38, s11, v71
    v_med3_u32 v9, v8, v9, v100
    v_max_u32 v8, v8, v100
    v_med3_u32 v9, v8, v9, v101
    v_max_u32 v8, v8, v101
    v_med3_u32 v9, v8, v9, v102
    v_max_u32 v8, v8, v102
    v_med3_u32 v9, v8, v9, v103
    v_max_u32 v8, v8, v103
    v_lshl_or_b32 v104, v40, 16, v72
    v_and_or_b32 v105, v40, s11, v73
    v_lshl_or_b32 v106, v42, 16, v74
    v_and_or_b32 v107, v42, s11, v75
    v_med3_u32 v9, v8, v9, v104
    v_max_u32 v8, v8, v104
    v_med3_u32 v9, v8, v9, v105
    v_max_u32 v8, v8, v105
    v_med3_u32 v9, v8, v9, v106
    v_max_u32 v8, v8, v106
    v_med3_u32 v9, v8, v9, v107
    v_max_u32 v8, v8, v107
    v_lshl_or_b32 v108, v44, 16, v76
    v_and_or_b32 v109, v44, s11, v77
    v_lshl_or_b32 v110, v46, 16, v78
    v_and_or_b32 v111, v46, s11, v79
    v_med3_u32 v9, v8, v9, v108
    v_max_u32 v8, v8, v108
    v_med3_u32 v9, v8, v9, v109
    v_max_u32 v8, v8, v109
    v_med3_u32 v9, v8, v9, v110
    v_max_u32 v8, v8, v110
    v_med3_u32 v9, v8, v9, v111
    v_max_u32 v8, v8, v111
    v_mov_b32 v10, v8
    s_nop 1
    v_max_u32_dpp v10, v10, v10 row_shr:1 row_mask:0xf bank_mask:0xf
    s_nop 1
    v_max_u32_dpp v10, v10, v10 row_shr:2 row_mask:0xf bank_mask:0xf
    s_nop 1
    v_max_u32_dpp v10, v10, v10 row_shr:4 row_mask:0xf bank_mask:0xf
    s_nop 1
    v_max_u32_dpp v10, v10, v10 row_shr:8 row_mask:0xf bank_mask:0xf
    s_nop 1
    v_max_u32_dpp v10, v10, v10 row_bcast:15 row_mask:0xa bank_mask:0xf
    s_nop 1
    v_max_u32_dpp v10, v10, v10 row_bcast:31 row_mask:0xc bank_mask:0xf
    s_nop 0
    v_readlane_b32 s8, v10, 63
    s_mov_b32 s12, s8
    v_subrev_u32 v10, s12, v8
    v_subrev_u32 v11, s12, v9
    v_max_u32 v10, v10, v11
    s_and_b32 s13, s12, 0x7ff
    s_sub_u32 s13, 2047, s13
    v_max_u32_dpp v10, v10, v10 row_shr:1 row_mask:0xf bank_mask:0xf
    s_mul_i32 s13, s13, 1152
    s_nop 0
    v_max_u32_dpp v10, v10, v10 row_shr:2 row_mask:0xf bank_mask:0xf
    s_mov_b32 exec_lo, 0xff
    s_mov_b32 exec_hi, 0x0
    v_add_u32 v12, s13, v5
    v_mov_b32 v6, s12
    s_mov_b64 exec, -1
    v_max_u32_dpp v10, v10, v10 row_shr:4 row_mask:0xf bank_mask:0xf
    s_nop 1
    v_max_u32_dpp v10, v10, v10 row_shr:8 row_mask:0xf bank_mask:0xf
    s_nop 1
    v_max_u32_dpp v10, v10, v10 row_bcast:15 row_mask:0xa bank_mask:0xf
    s_nop 1
    v_max_u32_dpp v10, v10, v10 row_bcast:31 row_mask:0xc bank_mask:0xf
    s_nop 0
    v_readlane_b32 s8, v10, 63
    s_add_u32 s12, s12, s8
    v_subrev_u32 v10, s12, v8
    v_subrev_u32 v11, s12, v9
    v_max_u32 v10, v10, v11
    s_and_b32 s13, s12, 0x7ff
    s_sub_u32 s13, 2047, s13
    v_max_u32_dpp v10, v10, v10 row_shr:1 row_mask:0xf bank_mask:0xf
    s_mul_i32 s13, s13, 1152
    s_nop 0
    v_max_u32_dpp v10, v10, v10 row_shr:2 row_mask:0xf bank_mask:0xf
    s_mov_b32 exec_lo, 0xff00
    s_mov_b32 exec_hi, 0x0
    v_add_u32 v12, s13, v5
    v_mov_b32 v6, s12
    s_mov_b64 exec, -1
    v_max_u32_dpp v10, v10, v10 row_shr:4 row_mask:0xf bank_mask:0xf
    s_nop 1
    v_max_u32_dpp v10, v10, v10 row_shr:8 row_mask:0xf bank_mask:0xf
    s_nop 1
    v_max_u32_dpp v10, v10, v10 row_bcast:15 row_mask:0xa bank_mask:0xf
    s_nop 1
    v_max_u32_dpp v10, v10, v10 row_bcast:31 row_mask:0xc bank_mask:0xf
    s_nop 0
    v_readlane_b32 s8, v10, 63
    s_add_u32 s12, s12, s8
    v_subrev_u32 v10, s12, v8
    v_subrev_u32 v11, s12, v9
    v_max_u32 v10, v10, v11
    s_and_b32 s13, s12, 0x7ff
    s_sub_u32 s13, 2047, s13
    v_max_u32_dpp v10, v10, v10 row_shr:1 row_mask:0xf bank_mask:0xf
    s_mul_i32 s13, s13, 1152
    s_nop 0
    v_max_u32_dpp v10, v10, v10 row_shr:2 row_mask:0xf bank_mask:0xf
    s_mov_b32 exec_lo, 0xff0000
    s_mov_b32 exec_hi, 0x0
    v_add_u32 v12, s13, v5
    v_mov_b32 v6, s12
    s_mov_b64 exec, -1
    v_max_u32_dpp v10, v10, v10 row_shr:4 row_mask:0xf bank_mask:0xf
    s_nop 1
    v_max_u32_dpp v10, v10, v10 row_shr:8 row_mask:0xf bank_mask:0xf
    s_nop 1
    v_max_u32_dpp v10, v10, v10 row_bcast:15 row_mask:0xa bank_mask:0xf
    s_nop 1
    v_max_u32_dpp v10, v10, v10 row_bcast:31 row_mask:0xc bank_mask:0xf
    s_nop 0
    v_readlane_b32 s8, v10, 63
    s_add_u32 s12, s12, s8
    v_subrev_u32 v10, s12, v8
    v_subrev_u32 v11, s12, v9
    v_max_u32 v10, v10, v11
    s_and_b32 s13, s12, 0x7ff
    s_sub_u32 s13, 2047, s13
    v_max_u32_dpp v10, v10, v10 row_shr:1 row_mask:0xf bank_mask:0xf
    s_mul_i32 s13, s13, 1152
    s_nop 0
    v_max_u32_dpp v10, v10, v10 row_shr:2 row_mask:0xf bank_mask:0xf
    s_mov_b32 exec_lo, 0xff000000
    s_mov_b32 exec_hi, 0x0
    v_add_u32 v12, s13, v5
    v_mov_b32 v6, s12
    s_mov_b64 exec, -1
    v_max_u32_dpp v10, v10, v10 row_shr:4 row_mask:0xf bank_mask:0xf
    s_nop 1
    v_max_u32_dpp v10, v10, v10 row_shr:8 row_mask:0xf bank_mask:0xf
    s_nop 1
    v_max_u32_dpp v10, v10, v10 row_bcast:15 row_mask:0xa bank_mask:0xf
    s_nop 1
    v_max_u32_dpp v10, v10, v10 row_bcast:31 row_mask:0xc bank_mask:0xf
    s_nop 0
    v_readlane_b32 s8, v10, 63
    s_add_u32 s12, s12, s8
    v_subrev_u32 v10, s12, v8
    v_subrev_u32 v11, s12, v9
    v_max_u32 v10, v10, v11
    s_and_b32 s13, s12, 0x7ff
    s_sub_u32 s13, 2047, s13
    v_max_u32_dpp v10, v10, v10 row_shr:1 row_mask:0xf bank_mask:0xf
    s_mul_i32 s13, s13, 1152
    s_nop 0
    v_max_u32_dpp v10, v10, v10 row_shr:2 row_mask:0xf bank_mask:0xf
    s_mov_b32 exec_lo, 0x0
    s_mov_b32 exec_hi, 0xff
    v_add_u32 v12, s13, v5
    v_mov_b32 v6, s12
    s_mov_b64 exec, -1
    v_max_u32_dpp v10, v10, v10 row_shr:4 row_mask:0xf bank_mask:0xf
    s_nop 1
    v_max_u32_dpp v10, v10, v10 row_shr:8 row_mask:0xf bank_mask:0xf
    s_nop 1
    v_max_u32_dpp v10, v10, v10 row_bcast:15 row_mask:0xa bank_mask:0xf
    s_nop 1
    v_max_u32_dpp v10, v10, v10 row_bcast:31 row_mask:0xc bank_mask:0xf
    s_nop 0
    v_readlane_b32 s8, v10, 63
    s_add_u32 s12, s12, s8
    v_subrev_u32 v10, s12, v8
    v_subrev_u32 v11, s12, v9
    v_max_u32 v10, v10, v11
    s_and_b32 s13, s12, 0x7ff
    s_sub_u32 s13, 2047, s13
    v_max_u32_dpp v10, v10, v10 row_shr:1 row_mask:0xf bank_mask:0xf
    s_mul_i32 s13, s13, 1152
    s_nop 0
    v_max_u32_dpp v10, v10, v10 row_shr:2 row_mask:0xf bank_mask:0xf
    s_mov_b32 exec_lo, 0x0
    s_mov_b32 exec_hi, 0xff00
    v_add_u32 v12, s13, v5
    v_mov_b32 v6, s12
    s_mov_b64 exec, -1
    v_max_u32_dpp v10, v10, v10 row_shr:4 row_mask:0xf bank_mask:0xf
    s_nop 1
    v_max_u32_dpp v10, v10, v10 row_shr:8 row_mask:0xf bank_mask:0xf
    s_nop 1
    v_max_u32_dpp v10, v10, v10 row_bcast:15 row_mask:0xa bank_mask:0xf
    s_nop 1
    v_max_u32_dpp v10, v10, v10 row_bcast:31 row_mask:0xc bank_mask:0xf
    s_nop 0
    v_readlane_b32 s8, v10, 63
    s_add_u32 s12, s12, s8
    v_subrev_u32 v10, s12, v8
    v_subrev_u32 v11, s12, v9
    v_max_u32 v10, v10, v11
    s_and_b32 s13, s12, 0x7ff
    s_sub_u32 s13, 2047, s13
    v_max_u32_dpp v10, v10, v10 row_shr:1 row_mask:0xf bank_mask:0xf
    s_mul_i32 s13, s13, 1152
    s_nop 0
    v_max_u32_dpp v10, v10, v10 row_shr:2 row_mask:0xf bank_mask:0xf
    s_mov_b32 exec_lo, 0x0
    s_mov_b32 exec_hi, 0xff0000
    v_add_u32 v12, s13, v5
    v_mov_b32 v6, s12
    s_mov_b64 exec, -1
    v_max_u32_dpp v10, v10, v10 row_shr:4 row_mask:0xf bank_mask:0xf
    s_nop 1
    v_max_u32_dpp v10, v10, v10 row_shr:8 row_mask:0xf bank_mask:0xf
    s_nop 1
    v_max_u32_dpp v10, v10, v10 row_bcast:15 row_mask:0xa bank_mask:0xf
    s_nop 1
    v_max_u32_dpp v10, v10, v10 row_bcast:31 row_mask:0xc bank_mask:0xf
    s_nop 0
    v_readlane_b32 s8, v10, 63
    s_add_u32 s12, s12, s8
    s_and_b32 s13, s12, 0x7ff
    s_sub_u32 s13, 2047, s13
    s_mul_i32 s13, s13, 1152
    s_mov_b32 exec_lo, 0x0
    s_mov_b32 exec_hi, 0xff000000
    v_add_u32 v12, s13, v5
    v_mov_b32 v6, s12
    s_mov_b64 exec, -1
    s_mov_b32 s14, 0
SEL_GATHER:
    s_mov_b32 m0, 147712
    s_nop 0
    buffer_load_dwordx4 v12, s[52:55], 0 offen offset:0 lds
    s_mov_b32 m0, 148608
    s_nop 0
    buffer_load_dwordx4 v12, s[52:55], 0 offen offset:128 lds
    s_mov_b32 m0, 149504
    s_nop 0
    buffer_load_dwordx4 v12, s[52:55], 0 offen offset:256 lds
    s_mov_b32 m0, 150400
    s_nop 0
    buffer_load_dwordx4 v12, s[52:55], 0 offen offset:384 lds
    s_mov_b32 m0, 151296
    s_nop 0
    buffer_load_dwordx4 v12, s[52:55], 0 offen offset:512 lds
    s_mov_b32 m0, 152192
    s_nop 0
    buffer_load_dwordx4 v12, s[52:55], 0 offen offset:640 lds
    s_mov_b32 m0, 153088
    s_nop 0
    buffer_load_dwordx4 v12, s[52:55], 0 offen offset:768 lds
    s_mov_b32 m0, 153984
    s_nop 0
    buffer_load_dwordx4 v12, s[52:55], 0 offen offset:896 lds
    s_mov_b32 m0, 154880
    s_nop 0
    buffer_load_dwordx4 v12, s[52:55], 0 offen offset:1024 lds
    s_cmp_lg_u32 s14, 0
    s_cbranch_scc1 SEL_OK
    v_sub_u32 v16, v80, v9
    v_sub_u32 v17, v81, v9
    v_sub_u32 v18, v82, v9
    v_sub_u32 v19, v83, v9
    v_sub_u32 v20, v84, v9
    v_sub_u32 v21, v85, v9
    v_sub_u32 v22, v86, v9
    v_sub_u32 v23, v87, v9
    v_sub_u32 v24, v88, v9
    v_sub_u32 v25, v89, v9
    v_sub_u32 v26, v90, v9
    v_sub_u32 v27, v91, v9
    v_sub_u32 v28, v92, v9
    v_sub_u32 v29, v93, v9
    v_sub_u32 v30, v94, v9
    v_sub_u32 v31, v95, v9
    v_sub_u32 v32, v96, v9
    v_sub_u32 v33, v97, v9
    v_sub_u32 v34, v98, v9
    v_sub_u32 v35, v99, v9
    v_sub_u32 v36, v100, v9
    v_sub_u32 v37, v101, v9
    v_sub_u32 v38, v102, v9
    v_sub_u32 v39, v103, v9
    v_sub_u32 v40, v104, v9
    v_sub_u32 v41, v105, v9
    v_sub_u32 v42, v106, v9
    v_sub_u32 v43, v107, v9
    v_sub_u32 v44, v108, v9
    v_sub_u32 v45, v109, v9
    v_sub_u32 v46, v110, v9
    v_sub_u32 v47, v111, v9
    v_max3_u32 v16, v16, v17, v18
    v_max3_u32 v19, v19, v20, v21
    v_max3_u32 v22, v22, v23, v24
    v_max3_u32 v25, v25, v26, v27
    v_max3_u32 v28, v28, v29, v30
    v_max3_u32 v31, v31, v32, v33
    v_max3_u32 v34, v34, v35, v36
    v_max3_u32 v37, v37, v38, v39
    v_max3_u32 v40, v40, v41, v42
    v_max3_u32 v43, v43, v44, v45
    v_max3_u32 v16, v16, v19, v22
    v_max3_u32 v25, v25, v28, v31
    v_max3_u32 v34, v34, v37, v40
    v_max3_u32 v43, v43, v46, v47
    v_max3_u32 v16, v16, v25, v34
    v_max_u32 v16, v16, v43
    v_add_u32 v16, v16, v9
    v_cmp_lt_u32 vcc, s12, v16
    s_cmp_eq_u64 vcc, 0
    s_cbranch_scc1 SEL_OK
    s_waitcnt vmcnt(0)
    s_mov_b32 s12, 0
    s_mov_b64 s[56:57], 0xff
SEL_SLOW:
    v_subrev_u32 v16, s12, v80
    v_subrev_u32 v17, s12, v81
    v_subrev_u32 v18, s12, v82
    v_subrev_u32 v19, s12, v83
    v_subrev_u32 v20, s12, v84
    v_subrev_u32 v21, s12, v85
    v_subrev_u32 v22, s12, v86
    v_subrev_u32 v23, s12, v87
    v_subrev_u32 v24, s12, v88
    v_subrev_u32 v25, s12, v89
    v_subrev_u32 v26, s12, v90
    v_subrev_u32 v27, s12, v91
    v_subrev_u32 v28, s12, v92
    v_subrev_u32 v29, s12, v93
    v_subrev_u32 v30, s12, v94
    v_subrev_u32 v31, s12, v95
    v_subrev_u32 v32, s12, v96
    v_subrev_u32 v33, s12, v97
    v_subrev_u32 v34, s12, v98
    v_subrev_u32 v35, s12, v99
    v_subrev_u32 v36, s12, v100
    v_subrev_u32 v37, s12, v101
    v_subrev_u32 v38, s12, v102
    v_subrev_u32 v39, s12, v103
    v_subrev_u32 v40, s12, v104
    v_subrev_u32 v41, s12, v105
    v_subrev_u32 v42, s12, v106
    v_subrev_u32 v43, s12, v107
    v_subrev_u32 v44, s12, v108
    v_subrev_u32 v45, s12, v109
    v_subrev_u32 v46, s12, v110
    v_subrev_u32 v47, s12, v111
    v_max3_u32 v16, v16, v17, v18
    v_max3_u32 v19, v19, v20, v21
    v_max3_u32 v22, v22, v23, v24
    v_max3_u32 v25, v25, v26, v27
    v_max3_u32 v28, v28, v29, v30
    v_max3_u32 v31, v31, v32, v33
    v_max3_u32 v34, v34, v35, v36
    v_max3_u32 v37, v37, v38, v39
    v_max3_u32 v40, v40, v41, v42
    v_max3_u32 v43, v43, v44, v45
    v_max3_u32 v16, v16, v19, v22
    v_max3_u32 v25, v25, v28, v31
    v_max3_u32 v34, v34, v37, v40
    v_max3_u32 v43, v43, v46, v47
    v_max3_u32 v16, v16, v25, v34
    v_max_u32 v16, v16, v43
    s_nop 1
    v_max_u32_dpp v16, v16, v16 row_shr:1 row_mask:0xf bank_mask:0xf
    s_nop 1
    v_max_u32_dpp v16, v16, v16 row_shr:2 row_mask:0xf bank_mask:0xf
    s_nop 1
    v_max_u32_dpp v16, v16, v16 row_shr:4 row_mask:0xf bank_mask:0xf
    s_nop 1
    v_max_u32_dpp v16, v16, v16 row_shr:8 row_mask:0xf bank_mask:0xf
    s_nop 1
    v_max_u32_dpp v16, v16, v16 row_bcast:15 row_mask:0xa bank_mask:0xf
    s_nop 1
    v_max_u32_dpp v16, v16, v16 row_bcast:31 row_mask:0xc bank_mask:0xf
    s_nop 0
    v_readlane_b32 s8, v16, 63
    s_add_u32 s12, s12, s8
    s_and_b32 s13, s12, 0x7ff
    s_sub_u32 s13, 2047, s13
    s_mul_i32 s13, s13, 1152
    s_mov_b64 exec, s[56:57]
    v_add_u32 v12, s13, v5
    v_mov_b32 v6, s12
    s_mov_b64 exec, -1
    s_lshl_b64 s[56:57], s[56:57], 8
    s_add_u32 s14, s14, 1
    s_cmp_lt_u32 s14, 8
    s_cbranch_scc1 SEL_SLOW
    s_branch SEL_GATHER
SEL_OK:
    s_cmp_lg_u32 s2, 0
    s_cbranch_scc1 SEL_NOPUB
    v_mov_b32 v7, v14
    v_add_u32 v8, 16384, v2
    s_mov_b32 exec_lo, 0x01010101
    s_mov_b32 exec_hi, 0x01010101
    global_store_dwordx2 v8, v[6:7], s[50:51] sc1
    s_mov_b64 exec, 1
    global_store_dword v8, v14, s[50:51] offset:256 sc1
    s_mov_b64 exec, -1
    s_waitcnt vmcnt(2)
    s_branch SEL_END
SEL_NOPUB:
    s_waitcnt vmcnt(0)
SEL_END:
    v_mov_b32 v8, 3
    ds_write_b32 v1, v8 offset:84
    s_endpgm
F_COMP:
F_COMP2:
    s_and_b32 s12, s3, 3
    v_lshrrev_b32 v5, 2, v3
    v_bfe_u32 v7, v3, 3, 1
    v_and_b32 v13, 1, v4
    v_lshl_or_b32 v14, v13, 1, v7
    v_and_b32 v15, 7, v3
    v_mul_u32_u24 v16, 144, v15
    v_add_u32 v16, 156928, v16
    s_mov_b32 s56, 0xff00ff00
    s_mov_b32 s57, 0xff00ff00
    s_cmp_lt_u32 s3, 4
    s_cbranch_scc1 F_DOWN
    v_bfe_u32 v6, v3, 1, 1
    v_lshl_or_b32 v8, v6, 2, v14
    v_xor_b32 v8, s12, v8
    v_lshlrev_b32 v8, 4, v8
    v_lshl_add_u32 v8, v5, 7, v8
    v_lshl_add_u32 v8, v6, 10, v8
    v_lshl_add_u32 v8, v4, 11, v8
    v_and_b32 v9, 1, v3
    v_lshl_add_u32 v8, v9, 3, v8
    v_xor_b32 v9, 64, v8
    v_add_u32 v10, 49408, v8
    v_add_u32 v11, 49408, v9
    v_lshlrev_b32 v6, 2, v13
    v_lshrrev_b32 v5, 1, v4
    v_add_u32 v6, v6, v5
    v_lshl_add_u32 v6, v7, 5, v6
    s_lshl_b32 s8, s12, 3
    v_add_lshl_u32 v6, v6, s8, 1
    v_add_u32 v5, v6, v16
    v_and_b32 v6, 6, v3
    v_xor_b32 v6, v6, v4
    v_lshlrev_b32 v6, 4, v6
    v_lshl_add_u32 v6, v15, 7, v6
    v_add_u32 v6, 147712, v6
    v_xor_b32 v7, 64, v6
    s_mov_b32 s9, 0
SP_22:
    ds_read_b32 v12, v1 offset:16
    s_waitcnt lgkmcnt(0)
    v_readfirstlane_b32 s8, v12
    s_add_u32 s9, s9, 1
    s_cmp_ge_u32 s8, 3
    s_cbranch_scc1 SP_22_D
    s_sleep 1
    s_cmp_lt_u32 s9, 524288
    s_cbranch_scc1 SP_22
SP_22_D:
    ds_read_b64_tr_b16 v[24:25], v8 offset:256
    ds_read_b64_tr_b16 v[26:27], v8 offset:768
    ds_read_b64_tr_b16 v[28:29], v9 offset:256
    ds_read_b64_tr_b16 v[30:31], v9 offset:768
    ds_read_b64_tr_b16 v[32:33], v8 offset:8448
    ds_read_b64_tr_b16 v[34:35], v8 offset:8960
    ds_read_b64_tr_b16 v[36:37], v9 offset:8448
    ds_read_b64_tr_b16 v[38:39], v9 offset:8960
    ds_read_b64_tr_b16 v[40:41], v8 offset:16640
    ds_read_b64_tr_b16 v[42:43], v8 offset:17152
    ds_read_b64_tr_b16 v[44:45], v9 offset:16640
    ds_read_b64_tr_b16 v[46:47], v9 offset:17152
    s_waitcnt lgkmcnt(0)
    v_mov_b32 v12, 1
    s_mov_b64 exec, 1
    ds_add_u32 v1, v12 offset:48
    s_mov_b64 exec, -1
    s_mov_b32 s9, 0
SP_23:
    ds_read_b32 v12, v1 offset:20
    s_waitcnt lgkmcnt(0)
    v_readfirstlane_b32 s8, v12
    s_add_u32 s9, s9, 1
    s_cmp_ge_u32 s8, 3
    s_cbranch_scc1 SP_23_D
    s_sleep 1
    s_cmp_lt_u32 s9, 524288
    s_cbranch_scc1 SP_23
SP_23_D:
    ds_read_b64_tr_b16 v[48:49], v8 offset:24832
    ds_read_b64_tr_b16 v[50:51], v8 offset:25344
    ds_read_b64_tr_b16 v[52:53], v9 offset:24832
    ds_read_b64_tr_b16 v[54:55], v9 offset:25344
    ds_read_b64_tr_b16 v[56:57], v8 offset:33024
    ds_read_b64_tr_b16 v[58:59], v8 offset:33536
    ds_read_b64_tr_b16 v[60:61], v9 offset:33024
    ds_read_b64_tr_b16 v[62:63], v9 offset:33536
    ds_read_b64_tr_b16 v[64:65], v8 offset:41216
    ds_read_b64_tr_b16 v[66:67], v8 offset:41728
    ds_read_b64_tr_b16 v[68:69], v9 offset:41216
    ds_read_b64_tr_b16 v[70:71], v9 offset:41728
    s_waitcnt lgkmcnt(0)
    v_mov_b32 v12, 1
    s_mov_b64 exec, 1
    ds_add_u32 v1, v12 offset:52
    s_mov_b64 exec, -1
    s_mov_b32 s9, 0
SP_24:
    ds_read_b32 v12, v1 offset:24
    s_waitcnt lgkmcnt(0)
    v_readfirstlane_b32 s8, v12
    s_add_u32 s9, s9, 1
    s_cmp_ge_u32 s8, 3
    s_cbranch_scc1 SP_24_D
    s_sleep 1
    s_cmp_lt_u32 s9, 524288
    s_cbranch_scc1 SP_24
SP_24_D:
    ds_read_b64_tr_b16 v[72:73], v10 offset:0
    ds_read_b64_tr_b16 v[74:75], v10 offset:512
    ds_read_b64_tr_b16 v[76:77], v11 offset:0
    ds_read_b64_tr_b16 v[78:79], v11 offset:512
    ds_read_b64_tr_b16 v[80:81], v10 offset:8192
    ds_read_b64_tr_b16 v[82:83], v10 offset:8704
    ds_read_b64_tr_b16 v[84:85], v11 offset:8192
    ds_read_b64_tr_b16 v[86:87], v11 offset:8704
    ds_read_b64_tr_b16 v[88:89], v10 offset:16384
    ds_read_b64_tr_b16 v[90:91], v10 offset:16896
    ds_read_b64_tr_b16 v[92:93], v11 offset:16384
    ds_read_b64_tr_b16 v[94:95], v11 offset:16896
    s_waitcnt lgkmcnt(0)
    v_mov_b32 v12, 1
    s_mov_b64 exec, 1
    ds_add_u32 v1, v12 offset:56
    s_mov_b64 exec, -1
    s_mov_b32 s9, 0
SP_25:
    ds_read_b32 v12, v1 offset:28
    s_waitcnt lgkmcnt(0)
    v_readfirstlane_b32 s8, v12
    s_add_u32 s9, s9, 1
    s_cmp_ge_u32 s8, 3
    s_cbranch_scc1 SP_25_D
    s_sleep 1
    s_cmp_lt_u32 s9, 524288
    s_cbranch_scc1 SP_25
SP_25_D:
    ds_read_b64_tr_b16 v[96:97], v8 offset:256
    ds_read_b64_tr_b16 v[98:99], v8 offset:768
    ds_read_b64_tr_b16 v[100:101], v9 offset:256
    ds_read_b64_tr_b16 v[102:103], v9 offset:768
    ds_read_b64_tr_b16 v[104:105], v8 offset:8448
    ds_read_b64_tr_b16 v[106:107], v8 offset:8960
    ds_read_b64_tr_b16 v[108:109], v9 offset:8448
    ds_read_b64_tr_b16 v[110:111], v9 offset:8960
    ds_read_b64_tr_b16 v[112:113], v8 offset:16640
    ds_read_b64_tr_b16 v[114:115], v8 offset:17152
    ds_read_b64_tr_b16 v[116:117], v9 offset:16640
    ds_read_b64_tr_b16 v[118:119], v9 offset:17152
    s_mov_b32 s9, 0
SP_26:
    ds_read_b32 v12, v1 offset:32
    s_waitcnt lgkmcnt(0)
    v_readfirstlane_b32 s8, v12
    s_add_u32 s9, s9, 1
    s_cmp_ge_u32 s8, 3
    s_cbranch_scc1 SP_26_D
    s_sleep 1
    s_cmp_lt_u32 s9, 524288
    s_cbranch_scc1 SP_26
SP_26_D:
    ds_read_b64_tr_b16 v[120:121], v8 offset:24832
    ds_read_b64_tr_b16 v[122:123], v8 offset:25344
    ds_read_b64_tr_b16 v[124:125], v9 offset:24832
    ds_read_b64_tr_b16 v[126:127], v9 offset:25344
    ds_read_b64_tr_b16 v[128:129], v8 offset:33024
    ds_read_b64_tr_b16 v[130:131], v8 offset:33536
    ds_read_b64_tr_b16 v[132:133], v9 offset:33024
    ds_read_b64_tr_b16 v[134:135], v9 offset:33536
    ds_read_b64_tr_b16 v[136:137], v8 offset:41216
    ds_read_b64_tr_b16 v[138:139], v8 offset:41728
    ds_read_b64_tr_b16 v[140:141], v9 offset:41216
    ds_read_b64_tr_b16 v[142:143], v9 offset:41728
    s_mov_b32 s9, 0
SP_27:
    ds_read_b32 v12, v1 offset:36
    s_waitcnt lgkmcnt(0)
    v_readfirstlane_b32 s8, v12
    s_add_u32 s9, s9, 1
    s_cmp_ge_u32 s8, 3
    s_cbranch_scc1 SP_27_D
    s_sleep 1
    s_cmp_lt_u32 s9, 524288
    s_cbranch_scc1 SP_27
SP_27_D:
    ds_read_b64_tr_b16 v[144:145], v10 offset:0
    ds_read_b64_tr_b16 v[146:147], v10 offset:512
    ds_read_b64_tr_b16 v[148:149], v11 offset:0
    ds_read_b64_tr_b16 v[150:151], v11 offset:512
    ds_read_b64_tr_b16 v[152:153], v10 offset:8192
    ds_read_b64_tr_b16 v[154:155], v10 offset:8704
    ds_read_b64_tr_b16 v[156:157], v11 offset:8192
    ds_read_b64_tr_b16 v[158:159], v11 offset:8704
    ds_read_b64_tr_b16 v[160:161], v10 offset:16384
    ds_read_b64_tr_b16 v[162:163], v10 offset:16896
    ds_read_b64_tr_b16 v[164:165], v11 offset:16384
    ds_read_b64_tr_b16 v[166:167], v11 offset:16896
    s_setprio 3
    s_mov_b32 s9, 0
SP_28:
    ds_read_b32 v12, v1 offset:84
    s_waitcnt lgkmcnt(0)
    v_readfirstlane_b32 s8, v12
    s_add_u32 s9, s9, 1
    s_cmp_ge_u32 s8, 1
    s_cbranch_scc1 SP_28_D
    s_cmp_lt_u32 s9, 524288
    s_cbranch_scc1 SP_28
SP_28_D:
    ds_read_b128 v[16:19], v6 offset:0
    ds_read_b128 v[20:23], v7 offset:0
    s_waitcnt lgkmcnt(1)
    v_mfma_f32_16x16x32_bf16 v[8:11], v[24:27], v[16:19], 0
    ds_read_b128 v[24:27], v6 offset:1024
    v_mfma_f32_16x16x32_bf16 v[12:15], v[28:31], v[16:19], 0
    ds_read_b128 v[28:31], v7 offset:1024
    s_waitcnt lgkmcnt(2)
    v_mfma_f32_16x16x32_bf16 v[8:11], v[32:35], v[20:23], v[8:11]
    ds_read_b128 v[32:35], v6 offset:2048
    v_mfma_f32_16x16x32_bf16 v[12:15], v[36:39], v[20:23], v[12:15]
    ds_read_b128 v[36:39], v7 offset:2048
    s_waitcnt lgkmcnt(3)
    v_mfma_f32_16x16x32_bf16 v[8:11], v[40:43], v[24:27], v[8:11]
    ds_read_b128 v[40:43], v6 offset:3072
    v_mfma_f32_16x16x32_bf16 v[12:15], v[44:47], v[24:27], v[12:15]
    ds_read_b128 v[44:47], v7 offset:3072
    s_waitcnt lgkmcnt(4)
    v_mfma_f32_16x16x32_bf16 v[8:11], v[48:51], v[28:31], v[8:11]
    ds_read_b128 v[48:51], v6 offset:4096
    v_mfma_f32_16x16x32_bf16 v[12:15], v[52:55], v[28:31], v[12:15]
    ds_read_b128 v[52:55], v7 offset:4096
    s_waitcnt lgkmcnt(5)
    v_mfma_f32_16x16x32_bf16 v[8:11], v[56:59], v[32:35], v[8:11]
    ds_read_b128 v[56:59], v6 offset:5120
    v_mfma_f32_16x16x32_bf16 v[12:15], v[60:63], v[32:35], v[12:15]
    ds_read_b128 v[60:63], v7 offset:5120
    s_waitcnt lgkmcnt(6)
    v_mfma_f32_16x16x32_bf16 v[8:11], v[64:67], v[36:39], v[8:11]
    ds_read_b128 v[64:67], v6 offset:6144
    v_mfma_f32_16x16x32_bf16 v[12:15], v[68:71], v[36:39], v[12:15]
    ds_read_b128 v[68:71], v7 offset:6144
    s_waitcnt lgkmcnt(7)
    v_mfma_f32_16x16x32_bf16 v[8:11], v[72:75], v[40:43], v[8:11]
    ds_read_b128 v[72:75], v6 offset:7168
    v_mfma_f32_16x16x32_bf16 v[12:15], v[76:79], v[40:43], v[12:15]
    ds_read_b128 v[76:79], v7 offset:7168
    s_waitcnt lgkmcnt(8)
    v_mfma_f32_16x16x32_bf16 v[8:11], v[80:83], v[44:47], v[8:11]
    ds_read_b128 v[80:83], v6 offset:8192
    v_mfma_f32_16x16x32_bf16 v[12:15], v[84:87], v[44:47], v[12:15]
    ds_read_b128 v[84:87], v7 offset:8192
    s_waitcnt lgkmcnt(9)
    v_mfma_f32_16x16x32_bf16 v[8:11], v[88:91], v[48:51], v[8:11]
    v_mfma_f32_16x16x32_bf16 v[12:15], v[92:95], v[48:51], v[12:15]
    s_waitcnt lgkmcnt(8)
    v_mfma_f32_16x16x32_bf16 v[8:11], v[96:99], v[52:55], v[8:11]
    v_mfma_f32_16x16x32_bf16 v[12:15], v[100:103], v[52:55], v[12:15]
    s_waitcnt lgkmcnt(7)
    v_mfma_f32_16x16x32_bf16 v[8:11], v[104:107], v[56:59], v[8:11]
    v_mfma_f32_16x16x32_bf16 v[12:15], v[108:111], v[56:59], v[12:15]
    s_waitcnt lgkmcnt(6)
    v_mfma_f32_16x16x32_bf16 v[8:11], v[112:115], v[60:63], v[8:11]
    v_mfma_f32_16x16x32_bf16 v[12:15], v[116:119], v[60:63], v[12:15]
    s_waitcnt lgkmcnt(5)
    v_mfma_f32_16x16x32_bf16 v[8:11], v[120:123], v[64:67], v[8:11]
    v_mfma_f32_16x16x32_bf16 v[12:15], v[124:127], v[64:67], v[12:15]
    s_waitcnt lgkmcnt(4)
    v_mfma_f32_16x16x32_bf16 v[8:11], v[128:131], v[68:71], v[8:11]
    v_mfma_f32_16x16x32_bf16 v[12:15], v[132:135], v[68:71], v[12:15]
    s_waitcnt lgkmcnt(3)
    v_mfma_f32_16x16x32_bf16 v[8:11], v[136:139], v[72:75], v[8:11]
    v_mfma_f32_16x16x32_bf16 v[12:15], v[140:143], v[72:75], v[12:15]
    s_waitcnt lgkmcnt(2)
    v_mfma_f32_16x16x32_bf16 v[8:11], v[144:147], v[76:79], v[8:11]
    v_mfma_f32_16x16x32_bf16 v[12:15], v[148:151], v[76:79], v[12:15]
    s_waitcnt lgkmcnt(1)
    v_mfma_f32_16x16x32_bf16 v[8:11], v[152:155], v[80:83], v[8:11]
    v_mfma_f32_16x16x32_bf16 v[12:15], v[156:159], v[80:83], v[12:15]
    s_waitcnt lgkmcnt(0)
    v_mfma_f32_16x16x32_bf16 v[8:11], v[160:163], v[84:87], v[8:11]
    v_mfma_f32_16x16x32_bf16 v[12:15], v[164:167], v[84:87], v[12:15]
    s_nop 7
    v_cndmask_b32 v8, v8, v12, s[56:57]
    v_cndmask_b32 v9, v9, v13, s[56:57]
    v_cndmask_b32 v10, v10, v14, s[56:57]
    v_cndmask_b32 v11, v11, v15, s[56:57]
    v_permlane32_swap_b32 v8, v9
    s_nop 0
    v_permlane32_swap_b32 v10, v11
    v_cvt_pk_bf16_f32 v9, v8, v9
    v_cvt_pk_bf16_f32 v11, v10, v11
    v_lshlrev_b32 v8, 16, v9
    v_lshlrev_b32 v10, 16, v11
    v_mul_f32 v12, 0xbfb8aa3b, v8
    v_mul_f32 v13, 0xbfb8aa3b, v10
    v_exp_f32 v12, v12
    v_exp_f32 v13, v13
    v_and_b32 v9, 0xffff0000, v9
    v_and_b32 v11, 0xffff0000, v11
    v_add_f32 v12, 1.0, v12
    v_add_f32 v13, 1.0, v13
    v_rcp_f32 v12, v12
    v_rcp_f32 v13, v13
    v_mul_f32 v8, v8, v12
    v_mul_f32 v10, v10, v13
    v_cvt_pk_bf16_f32 v8, v8, v8
    v_cvt_pk_bf16_f32 v10, v10, v10
    v_and_b32 v8, 0xffff0000, v8
    v_and_b32 v10, 0xffff0000, v10
    v_mul_f32 v8, v8, v9
    v_mul_f32 v10, v10, v11
    v_cvt_pk_bf16_f32 v8, v8, v10
    ds_write_b16 v5, v8
    ds_write_b16_d16_hi v5, v8 offset:4
    s_waitcnt lgkmcnt(0)
    s_barrier
    s_endpgm
F_DOWN:
    v_xor_b32 v8, s12, v14
    v_lshlrev_b32 v8, 5, v8
    v_lshl_add_u32 v8, v5, 7, v8
    v_lshl_add_u32 v8, v4, 10, v8
    v_and_b32 v9, 3, v3
    v_lshl_add_u32 v8, v9, 3, v8
    v_add_u32 v8, 73984, v8
    v_add_u32 v9, 32768, v8
    v_lshl_add_u32 v10, v4, 4, v16
    s_lshl_b32 s8, s12, 2
    v_add_u32 v6, s8, v4
    v_lshl_add_u32 v6, v7, 4, v6
    v_mul_u32_u24 v6, 9216, v6
    s_lshl_b32 s8, s7, 7
    s_add_u32 s8, s8, 32768
    v_lshl_add_u32 v11, v15, 4, s8
    v_add_u32 v11, v6, v11
    s_mov_b32 s60, 0x7060500
    s_mov_b32 s61, 0x7060501
    s_mov_b32 s62, 0x7060502
    s_mov_b32 s63, 0x7060503
    s_waitcnt lgkmcnt(0)
    s_mov_b32 s52, s50
    s_mov_b32 s53, s51
    s_mov_b32 s54, 268435456
    s_mov_b32 s55, 0x20000
    s_mov_b32 s9, 0
SP_29:
    ds_read_b32 v17, v1 offset:8
    s_waitcnt lgkmcnt(0)
    v_readfirstlane_b32 s8, v17
    s_add_u32 s9, s9, 1
    s_cmp_lg_u32 s8, 0
    s_cbranch_scc1 SP_29_D
    s_sleep 2
    s_cmp_lt_u32 s9, 524288
    s_cbranch_scc1 SP_29
SP_29_D:
    s_mov_b32 s9, 0
SP_30:
    ds_read_b32 v12, v1 offset:40
    s_waitcnt lgkmcnt(0)
    v_readfirstlane_b32 s8, v12
    s_add_u32 s9, s9, 1
    s_cmp_ge_u32 s8, 3
    s_cbranch_scc1 SP_30_D
    s_sleep 2
    s_cmp_lt_u32 s9, 524288
    s_cbranch_scc1 SP_30
SP_30_D:
    ds_read_b64_tr_b16 v[24:25], v8 offset:0
    ds_read_b64_tr_b16 v[26:27], v8 offset:512
    ds_read_b64_tr_b16 v[32:33], v8 offset:8192
    ds_read_b64_tr_b16 v[34:35], v8 offset:8704
    ds_read_b64_tr_b16 v[40:41], v8 offset:16384
    ds_read_b64_tr_b16 v[42:43], v8 offset:16896
    ds_read_b64_tr_b16 v[48:49], v8 offset:24576
    ds_read_b64_tr_b16 v[50:51], v8 offset:25088
    ds_read_b64_tr_b16 v[56:57], v9 offset:0
    ds_read_b64_tr_b16 v[58:59], v9 offset:512
    ds_read_b64_tr_b16 v[64:65], v9 offset:8192
    ds_read_b64_tr_b16 v[66:67], v9 offset:8704
    ds_read_b64_tr_b16 v[72:73], v9 offset:16384
    ds_read_b64_tr_b16 v[74:75], v9 offset:16896
    ds_read_b64_tr_b16 v[80:81], v9 offset:24576
    ds_read_b64_tr_b16 v[82:83], v9 offset:25088
    ds_read_b64_tr_b16 v[88:89], v9 offset:32768
    ds_read_b64_tr_b16 v[90:91], v9 offset:33280
    s_mov_b32 s9, 0
SP_31:
    ds_read_b32 v12, v1 offset:44
    s_waitcnt lgkmcnt(0)
    v_readfirstlane_b32 s8, v12
    s_add_u32 s9, s9, 1
    s_cmp_ge_u32 s8, 3
    s_cbranch_scc1 SP_31_D
    s_sleep 1
    s_cmp_lt_u32 s9, 524288
    s_cbranch_scc1 SP_31
SP_31_D:
    ds_read_b64_tr_b16 v[28:29], v8 offset:4096
    ds_read_b64_tr_b16 v[30:31], v8 offset:4608
    ds_read_b64_tr_b16 v[36:37], v8 offset:12288
    ds_read_b64_tr_b16 v[38:39], v8 offset:12800
    ds_read_b64_tr_b16 v[44:45], v8 offset:20480
    ds_read_b64_tr_b16 v[46:47], v8 offset:20992
    ds_read_b64_tr_b16 v[52:53], v8 offset:28672
    ds_read_b64_tr_b16 v[54:55], v8 offset:29184
    ds_read_b64_tr_b16 v[60:61], v9 offset:4096
    ds_read_b64_tr_b16 v[62:63], v9 offset:4608
    ds_read_b64_tr_b16 v[68:69], v9 offset:12288
    ds_read_b64_tr_b16 v[70:71], v9 offset:12800
    ds_read_b64_tr_b16 v[76:77], v9 offset:20480
    ds_read_b64_tr_b16 v[78:79], v9 offset:20992
    ds_read_b64_tr_b16 v[84:85], v9 offset:28672
    ds_read_b64_tr_b16 v[86:87], v9 offset:29184
    ds_read_b64_tr_b16 v[92:93], v9 offset:36864
    ds_read_b64_tr_b16 v[94:95], v9 offset:37376
    s_barrier
    ds_read_b128 v[132:135], v10 offset:0
    ds_read_b128 v[136:139], v10 offset:64
    s_waitcnt lgkmcnt(0)
    v_mfma_f32_16x16x32_bf16 v[96:99], v[24:27], v[132:135], 0
    v_mfma_f32_16x16x32_bf16 v[96:99], v[28:31], v[136:139], v[96:99]
    v_mfma_f32_16x16x32_bf16 v[100:103], v[32:35], v[132:135], 0
    v_mfma_f32_16x16x32_bf16 v[100:103], v[36:39], v[136:139], v[100:103]
    v_mfma_f32_16x16x32_bf16 v[104:107], v[40:43], v[132:135], 0
    v_mfma_f32_16x16x32_bf16 v[104:107], v[44:47], v[136:139], v[104:107]
    v_mfma_f32_16x16x32_bf16 v[108:111], v[48:51], v[132:135], 0
    v_mfma_f32_16x16x32_bf16 v[108:111], v[52:55], v[136:139], v[108:111]
    s_nop 3
    v_cndmask_b32 v96, v96, v100, s[56:57]
    v_cndmask_b32 v97, v97, v101, s[56:57]
    v_cndmask_b32 v98, v98, v102, s[56:57]
    v_mfma_f32_16x16x32_bf16 v[112:115], v[56:59], v[132:135], 0
    v_cndmask_b32 v99, v99, v103, s[56:57]
    v_perm_b32 v96, v96, v17, s60
    v_perm_b32 v97, v97, v17, s61
    v_mfma_f32_16x16x32_bf16 v[112:115], v[60:63], v[136:139], v[112:115]
    v_perm_b32 v98, v98, v17, s62
    v_perm_b32 v99, v99, v17, s63
    s_mov_b32 s12, 0
    v_mfma_f32_16x16x32_bf16 v[116:119], v[64:67], v[132:135], 0
    buffer_store_dwordx4 v[96:99], v11, s[52:55], s12 offen sc1
    v_cndmask_b32 v104, v104, v108, s[56:57]
    v_cndmask_b32 v105, v105, v109, s[56:57]
    v_mfma_f32_16x16x32_bf16 v[116:119], v[68:71], v[136:139], v[116:119]
    v_cndmask_b32 v106, v106, v110, s[56:57]
    v_cndmask_b32 v107, v107, v111, s[56:57]
    v_perm_b32 v104, v104, v17, s60
    v_mfma_f32_16x16x32_bf16 v[120:123], v[72:75], v[132:135], 0
    v_perm_b32 v105, v105, v17, s61
    v_perm_b32 v106, v106, v17, s62
    v_perm_b32 v107, v107, v17, s63
    v_mfma_f32_16x16x32_bf16 v[120:123], v[76:79], v[136:139], v[120:123]
    s_mov_b32 s12, 294912
    buffer_store_dwordx4 v[104:107], v11, s[52:55], s12 offen sc1
    v_cndmask_b32 v112, v112, v116, s[56:57]
    v_mfma_f32_16x16x32_bf16 v[124:127], v[80:83], v[132:135], 0
    v_cndmask_b32 v113, v113, v117, s[56:57]
    v_cndmask_b32 v114, v114, v118, s[56:57]
    v_cndmask_b32 v115, v115, v119, s[56:57]
    v_mfma_f32_16x16x32_bf16 v[124:127], v[84:87], v[136:139], v[124:127]
    v_perm_b32 v112, v112, v17, s60
    v_perm_b32 v113, v113, v17, s61
    v_perm_b32 v114, v114, v17, s62
    v_mfma_f32_16x16x32_bf16 v[128:131], v[88:91], v[132:135], 0
    v_perm_b32 v115, v115, v17, s63
    s_mov_b32 s12, 589824
    buffer_store_dwordx4 v[112:115], v11, s[52:55], s12 offen sc1
    v_mfma_f32_16x16x32_bf16 v[128:131], v[92:95], v[136:139], v[128:131]
    v_cndmask_b32 v120, v120, v124, s[56:57]
    v_cndmask_b32 v121, v121, v125, s[56:57]
    v_cndmask_b32 v122, v122, v126, s[56:57]
    v_cndmask_b32 v123, v123, v127, s[56:57]
    v_perm_b32 v120, v120, v17, s60
    v_perm_b32 v121, v121, v17, s61
    v_perm_b32 v122, v122, v17, s62
    v_perm_b32 v123, v123, v17, s63
    s_mov_b32 s12, 884736
    buffer_store_dwordx4 v[120:123], v11, s[52:55], s12 offen sc1
    s_not_b64 exec, s[56:57]
    v_perm_b32 v128, v128, v17, s60
    v_perm_b32 v129, v129, v17, s61
    v_perm_b32 v130, v130, v17, s62
    v_perm_b32 v131, v131, v17, s63
    s_mov_b32 s12, 1179648
    buffer_store_dwordx4 v[128:131], v11, s[52:55], s12 offen sc1
    s_mov_b64 exec, -1
    s_endpgm
K_END:
    s_endpgm
CODE_END:
.section .rodata,"a"
.p2align 6
.amdhsa_kernel k1_kernel
  .amdhsa_next_free_vgpr 168
  .amdhsa_next_free_sgpr 102
  .amdhsa_accum_offset 168
  .amdhsa_group_segment_fixed_size 0
  .amdhsa_kernarg_size 144
  .amdhsa_user_sgpr_count 2
  .amdhsa_user_sgpr_kernarg_segment_ptr 1
  .amdhsa_system_sgpr_workgroup_id_x 1
.end_amdhsa_kernel
```

```asm
; @launch kernel=k1_kernel grid=(256,1,1) block=(768,1,1) lds=163840
.amdgcn_target "amdgcn-amd-amdhsa--gfx950"
.text
.p2align 8
.globl k1_kernel
.type k1_kernel,@function
k1_kernel:
    v_lshrrev_b32 v1, 6, v0
    s_cmp_ge_u32 s2, 256
    v_readfirstlane_b32 s3, v1
    s_cbranch_scc1 K_END
    v_and_b32 v2, 63, v0
    v_mov_b32 v1, 0
    s_cmp_lg_u32 s3, 1
    s_cbranch_scc1 K_NOZ
    v_lshlrev_b32 v3, 2, v2
    ds_write_b32 v3, v1
    s_waitcnt lgkmcnt(0)
K_NOZ:
    s_load_dwordx16 s[16:31], s[0:1], 0
    s_load_dwordx16 s[32:47], s[0:1], 64
    s_load_dwordx4 s[48:51], s[0:1], 128
    s_lshr_b32 s5, s2, 3
    s_lshl_b32 s8, s3, 8
    s_add_u32 s8, s8, s5
    s_cmp_lg_u32 s8, 9
    s_cbranch_scc1 K_NOCPF
    s_getpc_b64 s[8:9]
    s_and_b32 s8, s8, 0xffffff00
    v_lshlrev_b32 v8, 7, v2
    v_min_u32 v9, CODE_END-k1_kernel-4, v8
    global_load_dword v160, v9, s[8:9]
    v_add_u32 v8, 8192, v8
    v_min_u32 v9, CODE_END-k1_kernel-4, v8
    global_load_dword v161, v9, s[8:9]
    v_add_u32 v8, 8192, v8
    v_min_u32 v9, CODE_END-k1_kernel-4, v8
    global_load_dword v162, v9, s[8:9]
    v_add_u32 v8, 8192, v8
    v_min_u32 v9, CODE_END-k1_kernel-4, v8
    global_load_dword v163, v9, s[8:9]
    v_add_u32 v8, 8192, v8
K_NOCPF:
    v_and_b32 v3, 15, v2
    v_lshrrev_b32 v4, 4, v2
    s_and_b32 s4, s2, 7
    s_barrier
    s_cmp_eq_u32 s3, 8
    s_cbranch_scc1 ROUTER
    s_cmp_lt_u32 s5, 14
    s_cbranch_scc1 K_OTHER
    s_mul_i32 s7, s4, 18
    s_add_u32 s7, s7, s5
    s_sub_u32 s7, s7, 14
    s_cmp_ge_u32 s3, 8
    s_cbranch_scc1 K_CIO
C_KGEN:
    s_and_b32 s12, s3, 3
    s_lshr_b32 s13, s3, 2
    s_lshl_b32 s14, s7, 2
    s_add_u32 s14, s14, s12
    s_lshl_b32 s8, s14, 8
    s_lshl_b32 s9, s13, 7
    s_add_u32 s8, s8, s9
    v_lshl_add_u32 v5, v2, 1, s8
    v_mov_b32 v16, 0
    v_mov_b32 v17, 0
    v_mov_b32 v18, 0
    v_mov_b32 v19, 0
    v_mov_b32 v20, 0
    v_mov_b32 v21, 0
    s_lshl_b32 s55, s7, 3
    s_setprio 2
    s_mul_i32 s15, s3, 4608
    s_add_u32 s15, s15, 256
    s_mul_i32 s52, s12, 8960
    s_add_u32 s52, s52, 37120
    s_mul_i32 s53, s12, 4672
    s_add_u32 s53, s53, 72960
    v_mul_u32_u24 v7, 288, v3
    v_lshl_add_u32 v7, v4, 4, v7
    v_add_u32 v7, s15, v7
    s_mov_b32 m0, s15
    s_waitcnt lgkmcnt(0)
    s_load_dwordx2 s[58:59], s[30:31], s55
    global_load_short_d16_hi v16, v5, s[18:19]
    global_load_short_d16_hi v17, v5, s[20:21]
    global_load_short_d16_hi v18, v5, s[22:23]
    global_load_short_d16_hi v19, v5, s[24:25]
    global_load_short_d16_hi v20, v5, s[26:27]
    global_load_short_d16_hi v21, v5, s[28:29]
    s_load_dwordx2 s[68:69], s[32:33], s55
    s_branch C_KBODY
ROUTER:
    s_setprio 3
    v_lshrrev_b32 v5, 3, v2
    v_and_b32 v6, 7, v2
    v_lshlrev_b32 v9, 4, v6
    v_mul_u32_u24 v8, 1152, v5
    s_mul_i32 s8, s2, 9216
    v_add3_u32 v8, v8, v9, s8
    v_lshlrev_b32 v7, 4, v2
    v_min_u32 v10, 7, v2
    v_lshlrev_b32 v10, 4, v10
    s_mov_b32 m0, 147712
    s_waitcnt lgkmcnt(0)
    s_load_dword s10, s[50:51], 16640
    global_load_lds_dwordx4 v8, s[16:17] offset:0
    s_mov_b32 m0, 148608
    s_nop 0
    global_load_lds_dwordx4 v8, s[16:17] offset:128
    s_mov_b32 m0, 149504
    s_nop 0
    global_load_lds_dwordx4 v8, s[16:17] offset:256
    s_mov_b32 m0, 150400
    s_nop 0
    global_load_lds_dwordx4 v8, s[16:17] offset:384
    s_mov_b32 m0, 151296
    s_nop 0
    global_load_lds_dwordx4 v8, s[16:17] offset:512
    s_mov_b32 m0, 152192
    s_nop 0
    global_load_lds_dwordx4 v8, s[16:17] offset:640
    s_mov_b32 m0, 153088
    s_nop 0
    global_load_lds_dwordx4 v8, s[16:17] offset:768
    s_mov_b32 m0, 153984
    s_nop 0
    global_load_lds_dwordx4 v8, s[16:17] offset:896
    s_mov_b32 m0, 154880
    s_nop 0
    global_load_lds_dwordx4 v8, s[16:17] offset:1024
    s_mov_b32 m0, 158080
    s_nop 0
    global_load_lds_dwordx4 v7, s[44:45]
    global_load_lds_dwordx4 v10, s[44:45] offset:1024
    global_load_dwordx4 v[52:55], v9, s[36:37] offset:0
    global_load_dwordx4 v[56:59], v9, s[36:37] offset:128
    global_load_dwordx4 v[60:63], v9, s[36:37] offset:256
    global_load_dwordx4 v[64:67], v9, s[36:37] offset:384
    global_load_dwordx4 v[68:71], v9, s[36:37] offset:512
    global_load_dwordx4 v[72:75], v9, s[36:37] offset:640
    global_load_dwordx4 v[76:79], v9, s[36:37] offset:768
    global_load_dwordx4 v[80:83], v9, s[36:37] offset:896
    global_load_dwordx4 v[84:87], v9, s[36:37] offset:1024
    v_mov_b32 v11, 1
    ds_write_b32 v1, v11 offset:4
    v_add_u32 v7, 147712, v7
    s_lshl_b32 s8, s2, 5
    v_lshl_add_u32 v15, v4, 3, s8
    s_mov_b32 s11, 0xffff
    v_mov_b32 v8, 0
    v_mov_b32 v9, 0
    v_mov_b32 v10, 0
    v_mov_b32 v11, 0
    s_waitcnt lgkmcnt(0)
    s_add_u32 s10, s10, 1
    s_addc_u32 s10, s10, 0
    v_mov_b32 v14, s10
    v_mov_b32 v13, s10
    s_waitcnt vmcnt(9)
    ds_read_b128 v[16:19], v7 offset:0
    ds_read_b128 v[20:23], v7 offset:1024
    ds_read_b128 v[24:27], v7 offset:2048
    ds_read_b128 v[28:31], v7 offset:3072
    ds_read_b128 v[32:35], v7 offset:4096
    ds_read_b128 v[36:39], v7 offset:5120
    ds_read_b128 v[40:43], v7 offset:6144
    ds_read_b128 v[44:47], v7 offset:7168
    ds_read_b128 v[48:51], v7 offset:8192
    ds_write_b32 v1, v14 offset:8
    s_waitcnt vmcnt(8) lgkmcnt(9)
    v_dot2c_f32_bf16 v8, v16, v52
    v_dot2c_f32_bf16 v9, v17, v53
    v_dot2c_f32_bf16 v10, v18, v54
    v_dot2c_f32_bf16 v11, v19, v55
    s_waitcnt vmcnt(7) lgkmcnt(8)
    v_dot2c_f32_bf16 v8, v20, v56
    v_dot2c_f32_bf16 v9, v21, v57
    v_dot2c_f32_bf16 v10, v22, v58
    v_dot2c_f32_bf16 v11, v23, v59
    s_waitcnt vmcnt(6) lgkmcnt(7)
    v_dot2c_f32_bf16 v8, v24, v60
    v_dot2c_f32_bf16 v9, v25, v61
    v_dot2c_f32_bf16 v10, v26, v62
    v_dot2c_f32_bf16 v11, v27, v63
    s_waitcnt vmcnt(5) lgkmcnt(6)
    v_dot2c_f32_bf16 v8, v28, v64
    v_dot2c_f32_bf16 v9, v29, v65
    v_dot2c_f32_bf16 v10, v30, v66
    v_dot2c_f32_bf16 v11, v31, v67
    s_waitcnt vmcnt(4) lgkmcnt(5)
    v_dot2c_f32_bf16 v8, v32, v68
    v_dot2c_f32_bf16 v9, v33, v69
    v_dot2c_f32_bf16 v10, v34, v70
    v_dot2c_f32_bf16 v11, v35, v71
    s_waitcnt vmcnt(3) lgkmcnt(4)
    v_dot2c_f32_bf16 v8, v36, v72
    v_dot2c_f32_bf16 v9, v37, v73
    v_dot2c_f32_bf16 v10, v38, v74
    v_dot2c_f32_bf16 v11, v39, v75
    s_waitcnt vmcnt(2) lgkmcnt(3)
    v_dot2c_f32_bf16 v8, v40, v76
    v_dot2c_f32_bf16 v9, v41, v77
    v_dot2c_f32_bf16 v10, v42, v78
    v_dot2c_f32_bf16 v11, v43, v79
    s_waitcnt vmcnt(1) lgkmcnt(2)
    v_dot2c_f32_bf16 v8, v44, v80
    v_dot2c_f32_bf16 v9, v45, v81
    v_dot2c_f32_bf16 v10, v46, v82
    v_dot2c_f32_bf16 v11, v47, v83
    s_waitcnt vmcnt(0) lgkmcnt(1)
    v_dot2c_f32_bf16 v8, v48, v84
    v_dot2c_f32_bf16 v9, v49, v85
    v_dot2c_f32_bf16 v10, v50, v86
    v_dot2c_f32_bf16 v11, v51, v87
    s_nop 0
    v_add_f32 v8, v8, v9
    s_nop 0
    v_add_f32 v10, v10, v11
    v_add_f32 v8, v8, v10
    s_nop 1
    v_add_f32_dpp v8, v8, v8 quad_perm:[1,0,3,2] row_mask:0xf bank_mask:0xf
    s_nop 1
    v_add_f32_dpp v8, v8, v8 quad_perm:[2,3,0,1] row_mask:0xf bank_mask:0xf
    s_nop 1
    v_add_f32_dpp v8, v8, v8 row_half_mirror row_mask:0xf bank_mask:0xf
    v_cvt_pk_bf16_f32 v8, v8, v8
    v_ashrrev_i32 v9, 31, v8
    v_or_b32 v9, 0x80008000, v9
    v_xor_b32 v8, v8, v9
    s_nop 1
    v_mov_b32_dpp v9, v8 row_ror:8 row_mask:0xf bank_mask:0xf
    s_mov_b32 exec_lo, 0x00010001
    s_mov_b32 exec_hi, 0x00010001
    v_bfi_b32 v12, s11, v8, v9
    global_store_dwordx2 v15, v[12:13], s[50:51] sc1
    s_mov_b64 exec, -1
    ds_write_b32 v1, v14 offset:0
    s_cmp_ge_u32 s5, 14
    s_cbranch_scc1 C_IO
    s_cmp_lt_u32 s5, 9
    s_cbranch_scc1 SELECT
    s_endpgm
K_OTHER:
    s_mul_i32 s7, s4, 9
    s_add_u32 s7, s7, s5
    s_mov_b32 s12, s3
    s_cmp_lt_u32 s3, 2
    s_cbranch_scc1 GATE
    s_cmp_ge_u32 s5, 9
    s_cbranch_scc1 HELPER
    s_cmp_lt_u32 s3, 8
    s_cbranch_scc1 F_COMP
F_LOAD:
    s_setprio 3
    s_sub_u32 s12, s3, 9
    v_lshrrev_b32 v5, 3, v2
    v_bfe_u32 v6, v2, 4, 1
    v_xor_b32 v6, v6, v2
    v_and_b32 v6, 7, v6
    s_movk_i32 s8, 9216
    v_mul_lo_u32 v7, v5, s8
    v_lshl_add_u32 v8, v6, 4, v7
    v_xor_b32 v9, 32, v8
    v_xor_b32 v10, 64, v8
    v_xor_b32 v11, 96, v8
    v_bfe_u32 v6, v2, 4, 1
    v_lshlrev_b32 v6, 1, v6
    v_xor_b32 v6, v6, v2
    v_and_b32 v6, 7, v6
    v_mul_u32_u24 v7, 1152, v5
    v_lshl_add_u32 v12, v6, 4, v7
    v_xor_b32 v13, 64, v12
    s_mul_i32 s13, s12, 294912
    s_lshl_b32 s8, s7, 7
    s_add_u32 s13, s13, s8
    s_lshl_b32 s15, s12, 13
    s_add_u32 s15, s15, 256
    s_mul_i32 s14, s12, 24576
    s_add_u32 s14, s14, 73984
    s_mul_i32 s11, s7, 73728
    s_mul_i32 s8, s12, 384
    s_add_u32 s11, s11, s8
    s_waitcnt lgkmcnt(0)
    s_mov_b32 s52, s38
    s_mov_b32 s53, s39
    s_mov_b32 s54, 5308416
    s_mov_b32 s55, 0x20000
    s_mov_b32 s56, s40
    s_mov_b32 s57, s41
    s_mov_b32 s58, 5308416
    s_mov_b32 s59, 0x20000
    s_mov_b32 s60, s42
    s_mov_b32 s61, s43
    s_mov_b32 s62, 5308416
    s_mov_b32 s63, 0x20000
    s_mov_b32 s9, 0
SP_1:
    ds_read_b32 v14, v1 offset:4
    s_waitcnt lgkmcnt(0)
    v_readfirstlane_b32 s8, v14
    s_add_u32 s9, s9, 1
    s_cmp_ge_u32 s8, 1
    s_cbranch_scc1 SP_1_D
    s_cmp_lt_u32 s9, 524288
    s_cbranch_scc1 SP_1
SP_1_D:
    s_add_u32 m0, s15, 0
    s_nop 0
    buffer_load_dwordx4 v8, s[52:55], s13 offen  lds
    s_add_u32 m0, s15, 1024
    s_nop 0
    buffer_load_dwordx4 v10, s[56:59], s13 offen  lds
    s_add_u32 s13, s13, 73728
    s_add_u32 m0, s15, 2048
    s_nop 0
    buffer_load_dwordx4 v9, s[52:55], s13 offen  lds
    s_add_u32 m0, s15, 3072
    s_nop 0
    buffer_load_dwordx4 v11, s[56:59], s13 offen  lds
    s_add_u32 s13, s13, 73728
    s_add_u32 m0, s15, 4096
    s_nop 0
    buffer_load_dwordx4 v8, s[52:55], s13 offen  lds
    s_add_u32 m0, s15, 5120
    s_nop 0
    buffer_load_dwordx4 v10, s[56:59], s13 offen  lds
    s_add_u32 s13, s13, 73728
    s_add_u32 m0, s15, 6144
    s_nop 0
    buffer_load_dwordx4 v9, s[52:55], s13 offen  lds
    s_add_u32 m0, s15, 7168
    s_nop 0
    buffer_load_dwordx4 v11, s[56:59], s13 offen  lds
    s_add_u32 s13, s13, 663552
    s_add_u32 m0, s15, 24576
    s_nop 0
    buffer_load_dwordx4 v8, s[52:55], s13 offen  lds
    s_add_u32 m0, s15, 25600
    s_nop 0
    buffer_load_dwordx4 v10, s[56:59], s13 offen  lds
    s_add_u32 s13, s13, 73728
    s_waitcnt vmcnt(9)
    s_add_u32 m0, s15, 26624
    s_nop 0
    buffer_load_dwordx4 v9, s[52:55], s13 offen  lds
    s_waitcnt vmcnt(9)
    s_add_u32 m0, s15, 27648
    s_nop 0
    buffer_load_dwordx4 v11, s[56:59], s13 offen  lds
    s_add_u32 s13, s13, 73728
    s_waitcnt vmcnt(9)
    s_add_u32 m0, s15, 28672
    s_nop 0
    buffer_load_dwordx4 v8, s[52:55], s13 offen  lds
    s_waitcnt vmcnt(9)
    s_add_u32 m0, s15, 29696
    s_nop 0
    buffer_load_dwordx4 v10, s[56:59], s13 offen  lds
    s_add_u32 s13, s13, 73728
    s_waitcnt vmcnt(9)
    s_add_u32 m0, s15, 30720
    s_nop 0
    buffer_load_dwordx4 v9, s[52:55], s13 offen  lds
    s_waitcnt vmcnt(9)
    s_add_u32 m0, s15, 31744
    s_nop 0
    buffer_load_dwordx4 v11, s[56:59], s13 offen  lds
    s_add_u32 s13, s13, 663552
    s_waitcnt vmcnt(9)
    s_add_u32 m0, s15, 49152
    s_nop 0
    buffer_load_dwordx4 v8, s[52:55], s13 offen  lds
    s_waitcnt vmcnt(9)
    v_mov_b32 v14, 1
    s_mov_b64 exec, 1
    ds_add_u32 v1, v14 offset:16
    s_mov_b64 exec, -1
    s_add_u32 m0, s15, 50176
    s_nop 0
    buffer_load_dwordx4 v10, s[56:59], s13 offen  lds
    s_add_u32 s13, s13, 73728
    s_waitcnt vmcnt(9)
    s_add_u32 m0, s15, 51200
    s_nop 0
    buffer_load_dwordx4 v9, s[52:55], s13 offen  lds
    s_waitcnt vmcnt(9)
    s_add_u32 m0, s15, 52224
    s_nop 0
    buffer_load_dwordx4 v11, s[56:59], s13 offen  lds
    s_add_u32 s13, s13, 73728
    s_waitcnt vmcnt(9)
    s_add_u32 m0, s15, 53248
    s_nop 0
    buffer_load_dwordx4 v8, s[52:55], s13 offen  lds
    s_waitcnt vmcnt(9)
    s_add_u32 m0, s15, 54272
    s_nop 0
    buffer_load_dwordx4 v10, s[56:59], s13 offen  lds
    s_add_u32 s13, s13, 73728
    s_waitcnt vmcnt(9)
    s_add_u32 m0, s15, 55296
    s_nop 0
    buffer_load_dwordx4 v9, s[52:55], s13 offen  lds
    s_waitcnt vmcnt(9)
    s_add_u32 m0, s15, 56320
    s_nop 0
    buffer_load_dwordx4 v11, s[56:59], s13 offen  lds
    s_add_u32 s13, s13, 663552
    s_mov_b32 s9, 0
SP_2:
    ds_read_b32 v14, v1 offset:48
    s_waitcnt lgkmcnt(0)
    v_readfirstlane_b32 s8, v14
    s_add_u32 s9, s9, 1
    s_cmp_ge_u32 s8, 4
    s_cbranch_scc1 SP_2_D
    s_cmp_lt_u32 s9, 524288
    s_cbranch_scc1 SP_2
SP_2_D:
    s_waitcnt vmcnt(9)
    s_add_u32 m0, s15, 0
    s_nop 0
    buffer_load_dwordx4 v8, s[52:55], s13 offen  lds
    s_waitcnt vmcnt(9)
    v_mov_b32 v14, 1
    s_mov_b64 exec, 1
    ds_add_u32 v1, v14 offset:20
    s_mov_b64 exec, -1
    s_add_u32 m0, s15, 1024
    s_nop 0
    buffer_load_dwordx4 v10, s[56:59], s13 offen  lds
    s_add_u32 s13, s13, 73728
    s_waitcnt vmcnt(9)
    s_add_u32 m0, s15, 2048
    s_nop 0
    buffer_load_dwordx4 v9, s[52:55], s13 offen  lds
    s_waitcnt vmcnt(9)
    s_add_u32 m0, s15, 3072
    s_nop 0
    buffer_load_dwordx4 v11, s[56:59], s13 offen  lds
    s_add_u32 s13, s13, 73728
    s_waitcnt vmcnt(9)
    s_add_u32 m0, s15, 4096
    s_nop 0
    buffer_load_dwordx4 v8, s[52:55], s13 offen  lds
    s_waitcnt vmcnt(9)
    s_add_u32 m0, s15, 5120
    s_nop 0
    buffer_load_dwordx4 v10, s[56:59], s13 offen  lds
    s_add_u32 s13, s13, 73728
    s_waitcnt vmcnt(9)
    s_add_u32 m0, s15, 6144
    s_nop 0
    buffer_load_dwordx4 v9, s[52:55], s13 offen  lds
    s_waitcnt vmcnt(9)
    s_add_u32 m0, s15, 7168
    s_nop 0
    buffer_load_dwordx4 v11, s[56:59], s13 offen  lds
    s_add_u32 s13, s13, 663552
    s_mov_b32 s9, 0
SP_3:
    ds_read_b32 v14, v1 offset:52
    s_waitcnt lgkmcnt(0)
    v_readfirstlane_b32 s8, v14
    s_add_u32 s9, s9, 1
    s_cmp_ge_u32 s8, 4
    s_cbranch_scc1 SP_3_D
    s_cmp_lt_u32 s9, 524288
    s_cbranch_scc1 SP_3
SP_3_D:
    s_waitcnt vmcnt(9)
    s_add_u32 m0, s15, 24576
    s_nop 0
    buffer_load_dwordx4 v8, s[52:55], s13 offen  lds
    s_waitcnt vmcnt(9)
    v_mov_b32 v14, 1
    s_mov_b64 exec, 1
    ds_add_u32 v1, v14 offset:24
    s_mov_b64 exec, -1
    s_add_u32 m0, s15, 25600
    s_nop 0
    buffer_load_dwordx4 v10, s[56:59], s13 offen  lds
    s_add_u32 s13, s13, 73728
    s_waitcnt vmcnt(9)
    s_add_u32 m0, s15, 26624
    s_nop 0
    buffer_load_dwordx4 v9, s[52:55], s13 offen  lds
    s_waitcnt vmcnt(9)
    s_add_u32 m0, s15, 27648
    s_nop 0
    buffer_load_dwordx4 v11, s[56:59], s13 offen  lds
    s_add_u32 s13, s13, 73728
    s_waitcnt vmcnt(9)
    s_add_u32 m0, s15, 28672
    s_nop 0
    buffer_load_dwordx4 v8, s[52:55], s13 offen  lds
    s_waitcnt vmcnt(9)
    s_add_u32 m0, s15, 29696
    s_nop 0
    buffer_load_dwordx4 v10, s[56:59], s13 offen  lds
    s_add_u32 s13, s13, 73728
    s_waitcnt vmcnt(9)
    s_add_u32 m0, s15, 30720
    s_nop 0
    buffer_load_dwordx4 v9, s[52:55], s13 offen  lds
    s_waitcnt vmcnt(9)
    s_add_u32 m0, s15, 31744
    s_nop 0
    buffer_load_dwordx4 v11, s[56:59], s13 offen  lds
    s_add_u32 s13, s13, 663552
    s_mov_b32 s9, 0
SP_4:
    ds_read_b32 v14, v1 offset:56
    s_waitcnt lgkmcnt(0)
    v_readfirstlane_b32 s8, v14
    s_add_u32 s9, s9, 1
    s_cmp_ge_u32 s8, 4
    s_cbranch_scc1 SP_4_D
    s_cmp_lt_u32 s9, 524288
    s_cbranch_scc1 SP_4
SP_4_D:
    s_waitcnt vmcnt(9)
    s_add_u32 m0, s15, 49152
    s_nop 0
    buffer_load_dwordx4 v8, s[52:55], s13 offen  lds
    s_waitcnt vmcnt(9)
    v_mov_b32 v14, 1
    s_mov_b64 exec, 1
    ds_add_u32 v1, v14 offset:28
    s_mov_b64 exec, -1
    s_add_u32 m0, s15, 50176
    s_nop 0
    buffer_load_dwordx4 v10, s[56:59], s13 offen  lds
    s_add_u32 s13, s13, 73728
    s_waitcnt vmcnt(9)
    s_add_u32 m0, s15, 51200
    s_nop 0
    buffer_load_dwordx4 v9, s[52:55], s13 offen  lds
    s_waitcnt vmcnt(9)
    s_add_u32 m0, s15, 52224
    s_nop 0
    buffer_load_dwordx4 v11, s[56:59], s13 offen  lds
    s_add_u32 s13, s13, 73728
    s_waitcnt vmcnt(9)
    s_add_u32 m0, s15, 53248
    s_nop 0
    buffer_load_dwordx4 v8, s[52:55], s13 offen  lds
    s_waitcnt vmcnt(9)
    s_add_u32 m0, s15, 54272
    s_nop 0
    buffer_load_dwordx4 v10, s[56:59], s13 offen  lds
    s_add_u32 s13, s13, 73728
    s_waitcnt vmcnt(9)
    s_add_u32 m0, s15, 55296
    s_nop 0
    buffer_load_dwordx4 v9, s[52:55], s13 offen  lds
    s_waitcnt vmcnt(9)
    s_add_u32 m0, s15, 56320
    s_nop 0
    buffer_load_dwordx4 v11, s[56:59], s13 offen  lds
    s_add_u32 s13, s13, 663552
    v_mov_b32 v14, 1
    s_mov_b64 exec, 1
    ds_add_u32 v1, v14 offset:40
    s_mov_b64 exec, -1
    s_waitcnt vmcnt(8)
    v_mov_b32 v14, 1
    s_mov_b64 exec, 1
    ds_add_u32 v1, v14 offset:32
    s_mov_b64 exec, -1
    s_waitcnt vmcnt(0)
    v_mov_b32 v14, 1
    s_mov_b64 exec, 1
    ds_add_u32 v1, v14 offset:36
    s_mov_b64 exec, -1
    s_cmp_eq_u32 s3, 9
    s_cbranch_scc1 F_COMP2
    s_endpgm
K_CIO:
    s_sub_u32 s12, s3, 9
    s_cmp_eq_u32 s3, 11
    s_cbranch_scc1 C_LOAD
    s_branch GATE
C_LOAD:
    s_setprio 3
    s_sub_u32 s13, s5, 14
    s_mul_i32 s8, s13, 73728
    s_lshl_b32 s9, s4, 7
    s_add_u32 s8, s8, s9
    v_mul_u32_u24 v9, 1152, v2
    v_add_u32 v9, s8, v9
    s_add_u32 s8, s13, 18
    s_min_u32 s8, s8, 31
    s_sub_u32 s8, s8, s13
    s_mul_i32 s8, s8, 73728
    v_add_u32 v8, s8, v9
    v_mul_u32_u24 v6, 4608, v2
    s_lshl_b32 s8, s7, 3
    v_add_u32 v6, s8, v6
    v_lshlrev_b32 v7, 3, v2
    v_sub_u32 v7, 73464, v7
    s_mov_b32 s56, 0x05040100
    s_mov_b32 s58, 0x07060302
    s_mov_b32 s57, s13
    s_waitcnt lgkmcnt(0)
    s_mov_b32 s72, s16
    s_mov_b32 s73, s17
    s_mov_b32 s74, 2359296
    s_mov_b32 s75, 0x20000
    s_mov_b32 s9, 0
SP_5:
    ds_read_b32 v12, v1 offset:4
    s_waitcnt lgkmcnt(0)
    v_readfirstlane_b32 s8, v12
    s_add_u32 s9, s9, 1
    s_cmp_ge_u32 s8, 1
    s_cbranch_scc1 SP_5_D
    s_cmp_lt_u32 s9, 524288
    s_cbranch_scc1 SP_5
SP_5_D:
    global_load_dword v10, v9, s[16:17]
    global_load_dword v11, v9, s[16:17] offset:128
    global_load_dword v10, v8, s[16:17]
    global_load_dword v11, v8, s[16:17] offset:128
    s_mul_i32 s7, s4, 18
    s_add_u32 s7, s7, s5
    s_sub_u32 s7, s7, 14
    s_lshl_b32 s55, s7, 3
    s_sub_u32 s12, s3, 8
    s_mov_b32 s60, s46
    s_mov_b32 s61, s47
    s_mov_b32 s62, 2359296
    s_mov_b32 s63, 0x20000
    s_sub_u32 s9, s5, 14
    s_lshl_b32 s9, s9, 2
    s_add_u32 s9, s9, s12
    s_mul_i32 s9, s9, 9216
    s_mul_i32 s8, s4, 663552
    s_add_u32 s8, s8, s9
    v_lshl_add_u32 v88, v2, 7, s8
    v_min_u32 v89, 7, v2
    v_lshl_add_u32 v89, v89, 7, s8
    v_add_u32 v89, 8192, v89
    v_mov_b32 v24, 0
    v_mov_b32 v25, 0
    v_mov_b32 v26, 0
    v_mov_b32 v27, 0
    v_lshrrev_b32 v28, 2, v2
    v_mul_u32_u24 v28, 2240, v28
    v_add_u32 v28, 37120, v28
    v_and_b32 v29, 3, v2
    v_lshl_add_u32 v30, v29, 4, v28
    ds_write_b128 v30, v[24:27] offset:2096
    v_and_b32 v29, 1, v2
    v_lshl_add_u32 v30, v29, 4, v28
    ds_write_b128 v30, v[24:27]
    v_lshrrev_b32 v28, 5, v2
    v_mul_u32_u24 v28, 4672, v28
    v_and_b32 v29, 31, v2
    v_lshl_add_u32 v30, v29, 4, v28
    v_add_u32 v30, 77056, v30
    ds_write_b128 v30, v[24:27]
    ds_write_b128 v30, v[24:27] offset:9344
    s_lshl_b32 s14, s12, 1
    s_add_u32 s14, s14, 16
    s_lshl_b32 s8, s14, 8
    s_add_u32 s8, s8, 8192
    v_xor_b32 v13, 63, v2
    v_lshrrev_b32 v13, 1, v13
    v_lshl_add_u32 v13, v13, 3, s8
    v_add_u32 v9, 2048, v13
    s_lshl_b32 s14, s12, 2
    s_lshl_b32 s8, s14, 8
    s_add_u32 s8, s8, 8192
    v_xor_b32 v5, 63, v2
    v_lshrrev_b32 v5, 1, v5
    v_lshl_add_u32 v5, v5, 3, s8
    s_mov_b32 s15, 0
    s_add_u32 s8, s57, 0
    s_and_b32 s8, s8, 3
    s_mul_i32 s76, s8, 294912
    s_add_u32 s64, s76, 1179648
    s_lshl_b32 s8, s8, 9
    v_subrev_u32 v32, s8, v7
    s_add_u32 s8, s57, 1
    s_and_b32 s8, s8, 3
    s_mul_i32 s77, s8, 294912
    s_add_u32 s65, s77, 1179648
    s_lshl_b32 s8, s8, 9
    v_subrev_u32 v33, s8, v7
    s_add_u32 s8, s57, 2
    s_and_b32 s8, s8, 3
    s_mul_i32 s78, s8, 294912
    s_add_u32 s66, s78, 1179648
    s_lshl_b32 s8, s8, 9
    v_subrev_u32 v34, s8, v7
    s_add_u32 s8, s57, 3
    s_and_b32 s8, s8, 3
    s_mul_i32 s79, s8, 294912
    s_add_u32 s67, s79, 1179648
    s_lshl_b32 s8, s8, 9
    v_subrev_u32 v35, s8, v7
    v_mov_b32 v12, 1
    s_waitcnt vmcnt(2)
    buffer_load_dwordx2 v[104:105], v6, s[72:75], s76 offen offset:0
    buffer_load_dwordx2 v[106:107], v6, s[72:75], s76 offen offset:1152
    buffer_load_dwordx2 v[108:109], v6, s[72:75], s76 offen offset:2304
    buffer_load_dwordx2 v[110:111], v6, s[72:75], s76 offen offset:3456
    s_add_u32 s15, s15, 294912
    buffer_load_dwordx2 v[112:113], v6, s[72:75], s77 offen offset:0
    s_waitcnt vmcnt(4)
    buffer_load_dwordx2 v[114:115], v6, s[72:75], s77 offen offset:1152
    s_waitcnt vmcnt(4)
    buffer_load_dwordx2 v[116:117], v6, s[72:75], s77 offen offset:2304
    s_waitcnt vmcnt(4)
    buffer_load_dwordx2 v[118:119], v6, s[72:75], s77 offen offset:3456
    s_add_u32 s15, s15, 294912
    s_waitcnt vmcnt(4)
    buffer_load_dwordx2 v[120:121], v6, s[72:75], s78 offen offset:0
    v_perm_b32 v16, v108, v110, s56
    v_perm_b32 v17, v104, v106, s56
    ds_write_b64 v32, v[16:17] offset:3584
    v_perm_b32 v18, v108, v110, s58
    v_perm_b32 v19, v104, v106, s58
    ds_write_b64 v32, v[18:19] offset:8256
    v_perm_b32 v20, v109, v111, s56
    v_perm_b32 v21, v105, v107, s56
    ds_write_b64 v32, v[20:21] offset:12928
    v_perm_b32 v22, v109, v111, s58
    v_perm_b32 v23, v105, v107, s58
    ds_write_b64 v32, v[22:23] offset:17600
    s_waitcnt vmcnt(4)
    buffer_load_dwordx2 v[122:123], v6, s[72:75], s78 offen offset:1152
    s_waitcnt vmcnt(4)
    buffer_load_dwordx2 v[124:125], v6, s[72:75], s78 offen offset:2304
    s_waitcnt vmcnt(4)
    buffer_load_dwordx2 v[126:127], v6, s[72:75], s78 offen offset:3456
    s_add_u32 s15, s15, 294912
    s_waitcnt vmcnt(4)
    buffer_load_dwordx2 v[128:129], v6, s[72:75], s79 offen offset:0
    v_perm_b32 v24, v116, v118, s56
    v_perm_b32 v25, v112, v114, s56
    ds_write_b64 v33, v[24:25] offset:3584
    v_perm_b32 v26, v116, v118, s58
    v_perm_b32 v27, v112, v114, s58
    ds_write_b64 v33, v[26:27] offset:8256
    v_perm_b32 v28, v117, v119, s56
    v_perm_b32 v29, v113, v115, s56
    ds_write_b64 v33, v[28:29] offset:12928
    v_perm_b32 v30, v117, v119, s58
    v_perm_b32 v31, v113, v115, s58
    ds_write_b64 v33, v[30:31] offset:17600
    s_waitcnt vmcnt(4)
    buffer_load_dwordx2 v[130:131], v6, s[72:75], s79 offen offset:1152
    s_waitcnt vmcnt(4)
    buffer_load_dwordx2 v[132:133], v6, s[72:75], s79 offen offset:2304
    s_waitcnt vmcnt(4)
    buffer_load_dwordx2 v[134:135], v6, s[72:75], s79 offen offset:3456
    s_add_u32 s15, s15, 294912
    s_waitcnt vmcnt(4)
    buffer_load_dwordx2 v[136:137], v6, s[72:75], s64 offen offset:0
    v_perm_b32 v16, v124, v126, s56
    v_perm_b32 v17, v120, v122, s56
    ds_write_b64 v34, v[16:17] offset:3584
    v_perm_b32 v18, v124, v126, s58
    v_perm_b32 v19, v120, v122, s58
    ds_write_b64 v34, v[18:19] offset:8256
    v_perm_b32 v20, v125, v127, s56
    v_perm_b32 v21, v121, v123, s56
    ds_write_b64 v34, v[20:21] offset:12928
    v_perm_b32 v22, v125, v127, s58
    v_perm_b32 v23, v121, v123, s58
    ds_write_b64 v34, v[22:23] offset:17600
    s_waitcnt vmcnt(4)
    buffer_load_dwordx2 v[138:139], v6, s[72:75], s64 offen offset:1152
    s_waitcnt vmcnt(4)
    buffer_load_dwordx2 v[140:141], v6, s[72:75], s64 offen offset:2304
    s_waitcnt vmcnt(4)
    buffer_load_dwordx2 v[142:143], v6, s[72:75], s64 offen offset:3456
    s_add_u32 s15, s15, 294912
    s_waitcnt vmcnt(4)
    buffer_load_dwordx2 v[144:145], v6, s[72:75], s65 offen offset:0
    v_perm_b32 v24, v132, v134, s56
    v_perm_b32 v25, v128, v130, s56
    ds_write_b64 v35, v[24:25] offset:3584
    v_perm_b32 v26, v132, v134, s58
    v_perm_b32 v27, v128, v130, s58
    ds_write_b64 v35, v[26:27] offset:8256
    v_perm_b32 v28, v133, v135, s56
    v_perm_b32 v29, v129, v131, s56
    ds_write_b64 v35, v[28:29] offset:12928
    v_perm_b32 v30, v133, v135, s58
    v_perm_b32 v31, v129, v131, s58
    ds_write_b64 v35, v[30:31] offset:17600
    ds_write_b32 v1, v12 offset:80
    s_waitcnt vmcnt(4)
    buffer_load_dwordx2 v[146:147], v6, s[72:75], s65 offen offset:1152
    s_waitcnt vmcnt(4)
    buffer_load_dwordx2 v[148:149], v6, s[72:75], s65 offen offset:2304
    s_waitcnt vmcnt(4)
    buffer_load_dwordx2 v[150:151], v6, s[72:75], s65 offen offset:3456
    s_add_u32 s15, s15, 294912
    s_waitcnt vmcnt(4)
    buffer_load_dwordx2 v[152:153], v6, s[72:75], s66 offen offset:0
    v_perm_b32 v16, v140, v142, s56
    v_perm_b32 v17, v136, v138, s56
    ds_write_b64 v32, v[16:17] offset:1536
    v_perm_b32 v18, v140, v142, s58
    v_perm_b32 v19, v136, v138, s58
    ds_write_b64 v32, v[18:19] offset:6208
    v_perm_b32 v20, v141, v143, s56
    v_perm_b32 v21, v137, v139, s56
    ds_write_b64 v32, v[20:21] offset:10880
    v_perm_b32 v22, v141, v143, s58
    v_perm_b32 v23, v137, v139, s58
    ds_write_b64 v32, v[22:23] offset:15552
    s_waitcnt vmcnt(4)
    buffer_load_dwordx2 v[154:155], v6, s[72:75], s66 offen offset:1152
    s_waitcnt vmcnt(4)
    buffer_load_dwordx2 v[156:157], v6, s[72:75], s66 offen offset:2304
    s_waitcnt vmcnt(4)
    buffer_load_dwordx2 v[158:159], v6, s[72:75], s66 offen offset:3456
    s_add_u32 s15, s15, 294912
    s_waitcnt vmcnt(4)
    buffer_load_dwordx2 v[160:161], v6, s[72:75], s67 offen offset:0
    v_perm_b32 v24, v148, v150, s56
    v_perm_b32 v25, v144, v146, s56
    ds_write_b64 v33, v[24:25] offset:1536
    v_perm_b32 v26, v148, v150, s58
    v_perm_b32 v27, v144, v146, s58
    ds_write_b64 v33, v[26:27] offset:6208
    v_perm_b32 v28, v149, v151, s56
    v_perm_b32 v29, v145, v147, s56
    ds_write_b64 v33, v[28:29] offset:10880
    v_perm_b32 v30, v149, v151, s58
    v_perm_b32 v31, v145, v147, s58
    ds_write_b64 v33, v[30:31] offset:15552
    s_waitcnt vmcnt(4)
    buffer_load_dwordx2 v[162:163], v6, s[72:75], s67 offen offset:1152
    s_waitcnt vmcnt(4)
    buffer_load_dwordx2 v[164:165], v6, s[72:75], s67 offen offset:2304
    s_waitcnt vmcnt(4)
    buffer_load_dwordx2 v[166:167], v6, s[72:75], s67 offen offset:3456
    s_add_u32 s15, s15, 294912
    ds_write_b32 v1, v12 offset:88
    global_load_dwordx2 v[104:105], v5, s[50:51] offset:0 sc1
    global_load_dwordx2 v[106:107], v5, s[50:51] offset:256 sc1
    global_load_dwordx2 v[108:109], v5, s[50:51] offset:512 sc1
    global_load_dwordx2 v[110:111], v5, s[50:51] offset:768 sc1
    global_load_dwordx2 v[112:113], v13, s[50:51] offset:0 sc1
    global_load_dwordx2 v[114:115], v13, s[50:51] offset:256 sc1
    global_load_dwordx2 v[116:117], v9, s[50:51] offset:0 sc1
    global_load_dwordx2 v[118:119], v9, s[50:51] offset:256 sc1
    global_load_dword v96, v88, s[42:43]
    global_load_dword v97, v89, s[42:43]
    s_waitcnt vmcnt(14)
    v_perm_b32 v16, v156, v158, s56
    v_perm_b32 v17, v152, v154, s56
    ds_write_b64 v34, v[16:17] offset:1536
    v_perm_b32 v18, v156, v158, s58
    v_perm_b32 v19, v152, v154, s58
    ds_write_b64 v34, v[18:19] offset:6208
    v_perm_b32 v20, v157, v159, s56
    v_perm_b32 v21, v153, v155, s56
    ds_write_b64 v34, v[20:21] offset:10880
    v_perm_b32 v22, v157, v159, s58
    v_perm_b32 v23, v153, v155, s58
    ds_write_b64 v34, v[22:23] offset:15552
    s_waitcnt vmcnt(13)
    s_waitcnt vmcnt(12)
    s_waitcnt vmcnt(11)
    s_waitcnt vmcnt(10)
    v_perm_b32 v24, v164, v166, s56
    v_perm_b32 v25, v160, v162, s56
    ds_write_b64 v35, v[24:25] offset:1536
    v_perm_b32 v26, v164, v166, s58
    v_perm_b32 v27, v160, v162, s58
    ds_write_b64 v35, v[26:27] offset:6208
    v_perm_b32 v28, v165, v167, s56
    v_perm_b32 v29, v161, v163, s56
    ds_write_b64 v35, v[28:29] offset:10880
    v_perm_b32 v30, v165, v167, s58
    v_perm_b32 v31, v161, v163, s58
    ds_write_b64 v35, v[30:31] offset:15552
    ds_write_b32 v1, v12 offset:84
    v_mov_b32 v6, v13
    s_mov_b32 s9, 0
SP_6:
    ds_read_b32 v10, v1 offset:8
    s_waitcnt lgkmcnt(0)
    v_readfirstlane_b32 s8, v10
    s_add_u32 s9, s9, 1
    s_cmp_lg_u32 s8, 0
    s_cbranch_scc1 SP_6_D
    s_cmp_lt_u32 s9, 524288
    s_cbranch_scc1 SP_6
SP_6_D:
    v_bfe_u32 v12, v2, 2, 2
    v_mul_u32_u24 v12, 4672, v12
    v_and_b32 v13, 3, v2
    v_lshl_add_u32 v13, v4, 2, v13
    v_lshl_add_u32 v12, v13, 3, v12
    s_lshl_b32 s8, s14, 7
    s_sub_u32 s8, 76544, s8
    v_add_u32 v12, s8, v12
    ds_read_b64_tr_b16 v[44:45], v12 offset:384
    ds_read_b64_tr_b16 v[50:51], v12 offset:256
    ds_read_b64_tr_b16 v[56:57], v12 offset:128
    ds_read_b64_tr_b16 v[62:63], v12 offset:0
    s_waitcnt lgkmcnt(0)
    v_lshlrev_b32 v40, 16, v44
    v_and_b32 v41, 0xffff0000, v44
    v_lshlrev_b32 v42, 16, v45
    v_and_b32 v43, 0xffff0000, v45
    v_lshlrev_b32 v46, 16, v50
    v_and_b32 v47, 0xffff0000, v50
    v_lshlrev_b32 v48, 16, v51
    v_and_b32 v49, 0xffff0000, v51
    v_lshlrev_b32 v52, 16, v56
    v_and_b32 v53, 0xffff0000, v56
    v_lshlrev_b32 v54, 16, v57
    v_and_b32 v55, 0xffff0000, v57
    v_lshlrev_b32 v58, 16, v62
    v_and_b32 v59, 0xffff0000, v62
    v_lshlrev_b32 v60, 16, v63
    v_and_b32 v61, 0xffff0000, v63
    s_branch C_IO3
C_IO:
    s_mul_i32 s7, s4, 18
    s_add_u32 s7, s7, s5
    s_sub_u32 s7, s7, 14
    s_lshl_b32 s55, s7, 3
    s_sub_u32 s12, s3, 8
    s_mov_b32 s60, s46
    s_mov_b32 s61, s47
    s_mov_b32 s62, 2359296
    s_mov_b32 s63, 0x20000
    s_sub_u32 s9, s5, 14
    s_lshl_b32 s9, s9, 2
    s_add_u32 s9, s9, s12
    s_mul_i32 s9, s9, 9216
    s_mul_i32 s8, s4, 663552
    s_add_u32 s8, s8, s9
    v_lshl_add_u32 v88, v2, 7, s8
    v_min_u32 v89, 7, v2
    v_lshl_add_u32 v89, v89, 7, s8
    v_add_u32 v89, 8192, v89
    s_lshl_b32 s14, s12, 1
    s_add_u32 s14, s14, 16
    s_lshl_b32 s8, s14, 8
    s_add_u32 s8, s8, 8192
    v_xor_b32 v6, 63, v2
    v_lshrrev_b32 v6, 1, v6
    v_lshl_add_u32 v6, v6, 3, s8
    v_add_u32 v9, 2048, v6
    s_lshl_b32 s14, s12, 2
    s_lshl_b32 s8, s14, 8
    s_add_u32 s8, s8, 8192
    v_xor_b32 v5, 63, v2
    v_lshrrev_b32 v5, 1, v5
    v_lshl_add_u32 v5, v5, 3, s8
    s_mov_b32 s9, 0
SP_7:
    ds_read_b32 v10, v1 offset:8
    s_waitcnt lgkmcnt(0)
    v_readfirstlane_b32 s8, v10
    s_add_u32 s9, s9, 1
    s_cmp_lg_u32 s8, 0
    s_cbranch_scc1 SP_7_D
    s_cmp_lt_u32 s9, 524288
    s_cbranch_scc1 SP_7
SP_7_D:
    s_setprio 3
    s_mov_b32 s9, 0
SP_8:
    ds_read_b32 v12, v1 offset:80
    s_waitcnt lgkmcnt(0)
    v_readfirstlane_b32 s8, v12
    s_add_u32 s9, s9, 1
    s_cmp_ge_u32 s8, 1
    s_cbranch_scc1 SP_8_D
    s_sleep 2
    s_cmp_lt_u32 s9, 524288
    s_cbranch_scc1 SP_8
SP_8_D:
    s_setprio 3
    v_bfe_u32 v12, v2, 2, 2
    v_mul_u32_u24 v12, 4672, v12
    v_and_b32 v13, 3, v2
    v_lshl_add_u32 v13, v4, 2, v13
    v_lshl_add_u32 v12, v13, 3, v12
    s_lshl_b32 s8, s14, 7
    s_sub_u32 s8, 76544, s8
    v_add_u32 v12, s8, v12
    ds_read_b64_tr_b16 v[44:45], v12 offset:384
    ds_read_b64_tr_b16 v[50:51], v12 offset:256
    ds_read_b64_tr_b16 v[56:57], v12 offset:128
    ds_read_b64_tr_b16 v[62:63], v12 offset:0
    s_waitcnt lgkmcnt(0)
    v_lshlrev_b32 v40, 16, v44
    v_and_b32 v41, 0xffff0000, v44
    v_lshlrev_b32 v42, 16, v45
    v_and_b32 v43, 0xffff0000, v45
    v_lshlrev_b32 v46, 16, v50
    v_and_b32 v47, 0xffff0000, v50
    v_lshlrev_b32 v48, 16, v51
    v_and_b32 v49, 0xffff0000, v51
    v_lshlrev_b32 v52, 16, v56
    v_and_b32 v53, 0xffff0000, v56
    v_lshlrev_b32 v54, 16, v57
    v_and_b32 v55, 0xffff0000, v57
    v_lshlrev_b32 v58, 16, v62
    v_and_b32 v59, 0xffff0000, v62
    v_lshlrev_b32 v60, 16, v63
    v_and_b32 v61, 0xffff0000, v63
    s_setprio 3
    s_mov_b32 s9, 0
SP_9:
    ds_read_b32 v12, v1 offset:88
    s_waitcnt lgkmcnt(0)
    v_readfirstlane_b32 s8, v12
    s_add_u32 s9, s9, 1
    s_cmp_ge_u32 s8, 1
    s_cbranch_scc1 SP_9_D
    s_sleep 1
    s_cmp_lt_u32 s9, 524288
    s_cbranch_scc1 SP_9
SP_9_D:
    s_setprio 3
    global_load_dwordx2 v[104:105], v5, s[50:51] offset:0 sc1
    global_load_dwordx2 v[106:107], v5, s[50:51] offset:256 sc1
    global_load_dwordx2 v[108:109], v5, s[50:51] offset:512 sc1
    global_load_dwordx2 v[110:111], v5, s[50:51] offset:768 sc1
    global_load_dwordx2 v[112:113], v6, s[50:51] offset:0 sc1
    global_load_dwordx2 v[114:115], v6, s[50:51] offset:256 sc1
    global_load_dwordx2 v[116:117], v9, s[50:51] offset:0 sc1
    global_load_dwordx2 v[118:119], v9, s[50:51] offset:256 sc1
    global_load_dword v96, v88, s[42:43]
    global_load_dword v97, v89, s[42:43]
C_IO3:
    s_waitcnt vmcnt(2)
    s_mov_b32 s9, 0
GP_10:
    v_xor_b32 v14, v105, v10
    v_bitop3_b32 v14, v14, v107, v10 bitop3:0xf6
    v_bitop3_b32 v14, v14, v109, v10 bitop3:0xf6
    v_bitop3_b32 v14, v14, v111, v10 bitop3:0xf6
    v_bitop3_b32 v14, v14, v113, v10 bitop3:0xf6
    v_bitop3_b32 v14, v14, v115, v10 bitop3:0xf6
    v_bitop3_b32 v14, v14, v117, v10 bitop3:0xf6
    v_bitop3_b32 v14, v14, v119, v10 bitop3:0xf6
    v_cmp_ne_u32 vcc, 0, v14
    s_add_u32 s9, s9, 1
    s_cmp_eq_u64 vcc, 0
    s_cbranch_scc1 GP_10_D
    s_cmp_ge_u32 s9, 131072
    s_cbranch_scc1 GP_10_D
    global_load_dwordx2 v[104:105], v5, s[50:51] offset:0 sc1
    global_load_dwordx2 v[106:107], v5, s[50:51] offset:256 sc1
    global_load_dwordx2 v[108:109], v5, s[50:51] offset:512 sc1
    global_load_dwordx2 v[110:111], v5, s[50:51] offset:768 sc1
    global_load_dwordx2 v[112:113], v6, s[50:51] offset:0 sc1
    global_load_dwordx2 v[114:115], v6, s[50:51] offset:256 sc1
    global_load_dwordx2 v[116:117], v9, s[50:51] offset:0 sc1
    global_load_dwordx2 v[118:119], v9, s[50:51] offset:256 sc1
    s_waitcnt vmcnt(0)
    s_branch GP_10
GP_10_D:
    v_and_b32 v11, 1, v2
    v_lshlrev_b32 v11, 4, v11
    s_lshl_b32 s8, s14, 8
    s_add_u32 s8, s8, 91648
    v_xor_b32 v12, 63, v2
    v_lshl_add_u32 v12, v12, 2, s8
    v_lshlrev_b32 v44, v11, v104
    v_lshlrev_b32 v50, v11, v106
    v_lshlrev_b32 v56, v11, v108
    v_lshlrev_b32 v62, v11, v110
    v_and_b32 v44, 0xffff0000, v44
    v_and_b32 v50, 0xffff0000, v50
    v_and_b32 v56, 0xffff0000, v56
    v_and_b32 v62, 0xffff0000, v62
    v_sub_f32 v45, 1.0, v44
    v_sub_f32 v51, 1.0, v50
    v_sub_f32 v57, 1.0, v56
    v_sub_f32 v63, 1.0, v62
    v_cvt_pk_bf16_f32 v45, v45, v45
    v_cvt_pk_bf16_f32 v51, v51, v51
    v_cvt_pk_bf16_f32 v57, v57, v57
    v_cvt_pk_bf16_f32 v63, v63, v63
    v_and_b32 v45, 0xffff0000, v45
    v_and_b32 v51, 0xffff0000, v51
    v_and_b32 v57, 0xffff0000, v57
    v_and_b32 v63, 0xffff0000, v63
    v_mul_f32 v40, v40, v45
    v_mul_f32 v41, v41, v45
    v_mul_f32 v42, v42, v45
    v_mul_f32 v43, v43, v45
    ds_write_b32 v12, v44 offset:0
    v_mul_f32 v46, v46, v51
    v_mul_f32 v47, v47, v51
    v_mul_f32 v48, v48, v51
    v_mul_f32 v49, v49, v51
    ds_write_b32 v12, v50 offset:256
    v_mul_f32 v52, v52, v57
    v_mul_f32 v53, v53, v57
    v_mul_f32 v54, v54, v57
    v_mul_f32 v55, v55, v57
    ds_write_b32 v12, v56 offset:512
    v_mul_f32 v58, v58, v63
    v_mul_f32 v59, v59, v63
    v_mul_f32 v60, v60, v63
    v_mul_f32 v61, v61, v63
    ds_write_b32 v12, v62 offset:768
    v_bfe_u32 v12, v2, 2, 2
    v_mul_u32_u24 v12, 4160, v12
    v_and_b32 v13, 3, v2
    v_lshl_add_u32 v13, v4, 2, v13
    v_lshl_add_u32 v12, v13, 3, v12
    s_lshl_b32 s8, s14, 7
    s_sub_u32 s8, 103424, s8
    v_add_u32 v12, s8, v12
    v_xor_b32 v14, 63, v2
    v_mul_u32_u24 v14, 1152, v14
    v_add_u32 v14, s55, v14
    s_mul_i32 s15, s14, 73728
    s_setprio 3
    s_mov_b32 s9, 0
SP_11:
    ds_read_b32 v15, v1 offset:96
    s_waitcnt lgkmcnt(0)
    v_readfirstlane_b32 s8, v15
    s_add_u32 s9, s9, 1
    s_cmp_ge_u32 s8, 4
    s_cbranch_scc1 SP_11_D
    s_sleep 1
    s_cmp_lt_u32 s9, 524288
    s_cbranch_scc1 SP_11
SP_11_D:
    s_setprio 3
    ds_read_b64_tr_b16 v[16:17], v12 offset:384
    ds_read_b64_tr_b16 v[18:19], v12 offset:256
    ds_read_b64_tr_b16 v[20:21], v12 offset:128
    ds_read_b64_tr_b16 v[22:23], v12 offset:0
    s_waitcnt lgkmcnt(3)
    v_lshlrev_b32 v24, 16, v16
    v_and_b32 v25, 0xffff0000, v16
    v_lshlrev_b32 v26, 16, v17
    v_and_b32 v27, 0xffff0000, v17
    v_fmac_f32 v40, v24, v44
    v_fmac_f32 v41, v25, v44
    v_fmac_f32 v42, v26, v44
    v_fmac_f32 v43, v27, v44
    v_cvt_pk_bf16_f32 v40, v40, v41
    v_cvt_pk_bf16_f32 v41, v42, v43
    buffer_store_dwordx2 v[40:41], v14, s[60:63], s15 offen
    s_add_u32 s15, s15, 73728
    s_waitcnt lgkmcnt(2)
    v_lshlrev_b32 v28, 16, v18
    v_and_b32 v29, 0xffff0000, v18
    v_lshlrev_b32 v30, 16, v19
    v_and_b32 v31, 0xffff0000, v19
    v_fmac_f32 v46, v28, v50
    v_fmac_f32 v47, v29, v50
    v_fmac_f32 v48, v30, v50
    v_fmac_f32 v49, v31, v50
    v_cvt_pk_bf16_f32 v46, v46, v47
    v_cvt_pk_bf16_f32 v47, v48, v49
    buffer_store_dwordx2 v[46:47], v14, s[60:63], s15 offen
    s_add_u32 s15, s15, 73728
    s_waitcnt lgkmcnt(1)
    v_lshlrev_b32 v32, 16, v20
    v_and_b32 v33, 0xffff0000, v20
    v_lshlrev_b32 v34, 16, v21
    v_and_b32 v35, 0xffff0000, v21
    v_fmac_f32 v52, v32, v56
    v_fmac_f32 v53, v33, v56
    v_fmac_f32 v54, v34, v56
    v_fmac_f32 v55, v35, v56
    v_cvt_pk_bf16_f32 v52, v52, v53
    v_cvt_pk_bf16_f32 v53, v54, v55
    buffer_store_dwordx2 v[52:53], v14, s[60:63], s15 offen
    s_add_u32 s15, s15, 73728
    s_waitcnt lgkmcnt(0)
    v_lshlrev_b32 v36, 16, v22
    v_and_b32 v37, 0xffff0000, v22
    v_lshlrev_b32 v38, 16, v23
    v_and_b32 v39, 0xffff0000, v23
    v_fmac_f32 v58, v36, v62
    v_fmac_f32 v59, v37, v62
    v_fmac_f32 v60, v38, v62
    v_fmac_f32 v61, v39, v62
    v_cvt_pk_bf16_f32 v58, v58, v59
    v_cvt_pk_bf16_f32 v59, v60, v61
    buffer_store_dwordx2 v[58:59], v14, s[60:63], s15 offen
    s_add_u32 s15, s15, 73728
    s_setprio 3
    s_mov_b32 s9, 0
SP_12:
    ds_read_b32 v12, v1 offset:84
    s_waitcnt lgkmcnt(0)
    v_readfirstlane_b32 s8, v12
    s_add_u32 s9, s9, 1
    s_cmp_ge_u32 s8, 1
    s_cbranch_scc1 SP_12_D
    s_sleep 2
    s_cmp_lt_u32 s9, 524288
    s_cbranch_scc1 SP_12
SP_12_D:
    s_setprio 3
    s_lshl_b32 s14, s12, 1
    s_add_u32 s14, s14, 24
    v_bfe_u32 v12, v2, 2, 2
    v_mul_u32_u24 v12, 4672, v12
    v_and_b32 v13, 3, v2
    v_lshl_add_u32 v13, v4, 2, v13
    v_lshl_add_u32 v12, v13, 3, v12
    s_lshl_b32 s8, s14, 7
    s_sub_u32 s8, 76800, s8
    v_add_u32 v12, s8, v12
    ds_read_b64_tr_b16 v[80:81], v12 offset:128
    ds_read_b64_tr_b16 v[86:87], v12 offset:0
    s_lshl_b32 s14, s12, 1
    s_add_u32 s14, s14, 16
    v_bfe_u32 v12, v2, 2, 2
    v_mul_u32_u24 v12, 4672, v12
    v_and_b32 v13, 3, v2
    v_lshl_add_u32 v13, v4, 2, v13
    v_lshl_add_u32 v12, v13, 3, v12
    s_lshl_b32 s8, s14, 7
    s_sub_u32 s8, 76800, s8
    v_add_u32 v12, s8, v12
    ds_read_b64_tr_b16 v[68:69], v12 offset:128
    ds_read_b64_tr_b16 v[74:75], v12 offset:0
    s_waitcnt lgkmcnt(0)
    v_lshlrev_b32 v64, 16, v68
    v_and_b32 v65, 0xffff0000, v68
    v_lshlrev_b32 v66, 16, v69
    v_and_b32 v67, 0xffff0000, v69
    v_lshlrev_b32 v70, 16, v74
    v_and_b32 v71, 0xffff0000, v74
    v_lshlrev_b32 v72, 16, v75
    v_and_b32 v73, 0xffff0000, v75
    v_lshlrev_b32 v76, 16, v80
    v_and_b32 v77, 0xffff0000, v80
    v_lshlrev_b32 v78, 16, v81
    v_and_b32 v79, 0xffff0000, v81
    v_lshlrev_b32 v82, 16, v86
    v_and_b32 v83, 0xffff0000, v86
    v_lshlrev_b32 v84, 16, v87
    v_and_b32 v85, 0xffff0000, v87
    s_lshl_b32 s14, s12, 1
    s_add_u32 s14, s14, 24
    v_and_b32 v11, 1, v2
    v_lshlrev_b32 v11, 4, v11
    s_lshl_b32 s8, s14, 8
    s_add_u32 s8, s8, 91648
    v_xor_b32 v12, 63, v2
    v_lshl_add_u32 v12, v12, 2, s8
    v_lshlrev_b32 v80, v11, v116
    v_lshlrev_b32 v86, v11, v118
    v_and_b32 v80, 0xffff0000, v80
    v_and_b32 v86, 0xffff0000, v86
    v_sub_f32 v81, 1.0, v80
    v_sub_f32 v87, 1.0, v86
    v_cvt_pk_bf16_f32 v81, v81, v81
    v_cvt_pk_bf16_f32 v87, v87, v87
    v_and_b32 v81, 0xffff0000, v81
    v_and_b32 v87, 0xffff0000, v87
    v_mul_f32 v76, v76, v81
    v_mul_f32 v77, v77, v81
    v_mul_f32 v78, v78, v81
    v_mul_f32 v79, v79, v81
    ds_write_b32 v12, v80 offset:0
    v_mul_f32 v82, v82, v87
    v_mul_f32 v83, v83, v87
    v_mul_f32 v84, v84, v87
    v_mul_f32 v85, v85, v87
    ds_write_b32 v12, v86 offset:256
    s_lshl_b32 s14, s12, 1
    s_add_u32 s14, s14, 16
    v_and_b32 v11, 1, v2
    v_lshlrev_b32 v11, 4, v11
    s_lshl_b32 s8, s14, 8
    s_add_u32 s8, s8, 91648
    v_xor_b32 v12, 63, v2
    v_lshl_add_u32 v12, v12, 2, s8
    v_lshlrev_b32 v68, v11, v112
    v_lshlrev_b32 v74, v11, v114
    v_and_b32 v68, 0xffff0000, v68
    v_and_b32 v74, 0xffff0000, v74
    v_sub_f32 v69, 1.0, v68
    v_sub_f32 v75, 1.0, v74
    v_cvt_pk_bf16_f32 v69, v69, v69
    v_cvt_pk_bf16_f32 v75, v75, v75
    v_and_b32 v69, 0xffff0000, v69
    v_and_b32 v75, 0xffff0000, v75
    v_mul_f32 v64, v64, v69
    v_mul_f32 v65, v65, v69
    v_mul_f32 v66, v66, v69
    v_mul_f32 v67, v67, v69
    ds_write_b32 v12, v68 offset:0
    v_mul_f32 v70, v70, v75
    v_mul_f32 v71, v71, v75
    v_mul_f32 v72, v72, v75
    v_mul_f32 v73, v73, v75
    ds_write_b32 v12, v74 offset:256
    v_bfe_u32 v12, v2, 2, 2
    v_mul_u32_u24 v12, 4160, v12
    v_and_b32 v13, 3, v2
    v_lshl_add_u32 v13, v4, 2, v13
    v_lshl_add_u32 v12, v13, 3, v12
    s_lshl_b32 s8, s14, 7
    s_sub_u32 s8, 103680, s8
    v_add_u32 v12, s8, v12
    v_xor_b32 v14, 63, v2
    v_mul_u32_u24 v14, 1152, v14
    v_add_u32 v14, s55, v14
    s_mul_i32 s15, s14, 73728
    s_setprio 3
    s_mov_b32 s9, 0
SP_13:
    ds_read_b32 v15, v1 offset:100
    s_waitcnt lgkmcnt(0)
    v_readfirstlane_b32 s8, v15
    s_add_u32 s9, s9, 1
    s_cmp_ge_u32 s8, 4
    s_cbranch_scc1 SP_13_D
    s_sleep 1
    s_cmp_lt_u32 s9, 524288
    s_cbranch_scc1 SP_13
SP_13_D:
    s_setprio 3
    ds_read_b64_tr_b16 v[16:17], v12 offset:128
    ds_read_b64_tr_b16 v[18:19], v12 offset:0
    s_waitcnt lgkmcnt(1)
    v_lshlrev_b32 v24, 16, v16
    v_and_b32 v25, 0xffff0000, v16
    v_lshlrev_b32 v26, 16, v17
    v_and_b32 v27, 0xffff0000, v17
    v_fmac_f32 v64, v24, v68
    v_fmac_f32 v65, v25, v68
    v_fmac_f32 v66, v26, v68
    v_fmac_f32 v67, v27, v68
    v_cvt_pk_bf16_f32 v64, v64, v65
    v_cvt_pk_bf16_f32 v65, v66, v67
    buffer_store_dwordx2 v[64:65], v14, s[60:63], s15 offen
    s_add_u32 s15, s15, 73728
    s_waitcnt lgkmcnt(0)
    v_lshlrev_b32 v28, 16, v18
    v_and_b32 v29, 0xffff0000, v18
    v_lshlrev_b32 v30, 16, v19
    v_and_b32 v31, 0xffff0000, v19
    v_fmac_f32 v70, v28, v74
    v_fmac_f32 v71, v29, v74
    v_fmac_f32 v72, v30, v74
    v_fmac_f32 v73, v31, v74
    v_cvt_pk_bf16_f32 v70, v70, v71
    v_cvt_pk_bf16_f32 v71, v72, v73
    buffer_store_dwordx2 v[70:71], v14, s[60:63], s15 offen
    s_add_u32 s15, s15, 73728
    s_lshl_b32 s14, s12, 1
    s_add_u32 s14, s14, 24
    v_bfe_u32 v12, v2, 2, 2
    v_mul_u32_u24 v12, 4160, v12
    v_and_b32 v13, 3, v2
    v_lshl_add_u32 v13, v4, 2, v13
    v_lshl_add_u32 v12, v13, 3, v12
    s_lshl_b32 s8, s14, 7
    s_sub_u32 s8, 103680, s8
    v_add_u32 v12, s8, v12
    v_xor_b32 v14, 63, v2
    v_mul_u32_u24 v14, 1152, v14
    v_add_u32 v14, s55, v14
    s_mul_i32 s15, s14, 73728
    s_setprio 3
    s_mov_b32 s9, 0
SP_14:
    ds_read_b32 v15, v1 offset:104
    s_waitcnt lgkmcnt(0)
    v_readfirstlane_b32 s8, v15
    s_add_u32 s9, s9, 1
    s_cmp_ge_u32 s8, 4
    s_cbranch_scc1 SP_14_D
    s_sleep 1
    s_cmp_lt_u32 s9, 524288
    s_cbranch_scc1 SP_14
SP_14_D:
    s_setprio 3
    ds_read_b64_tr_b16 v[16:17], v12 offset:128
    ds_read_b64_tr_b16 v[18:19], v12 offset:0
    s_waitcnt lgkmcnt(1)
    v_lshlrev_b32 v24, 16, v16
    v_and_b32 v25, 0xffff0000, v16
    v_lshlrev_b32 v26, 16, v17
    v_and_b32 v27, 0xffff0000, v17
    v_fmac_f32 v76, v24, v80
    v_fmac_f32 v77, v25, v80
    v_fmac_f32 v78, v26, v80
    v_fmac_f32 v79, v27, v80
    v_cvt_pk_bf16_f32 v76, v76, v77
    v_cvt_pk_bf16_f32 v77, v78, v79
    buffer_store_dwordx2 v[76:77], v14, s[60:63], s15 offen
    s_add_u32 s15, s15, 73728
    s_waitcnt lgkmcnt(0)
    v_lshlrev_b32 v28, 16, v18
    v_and_b32 v29, 0xffff0000, v18
    v_lshlrev_b32 v30, 16, v19
    v_and_b32 v31, 0xffff0000, v19
    v_fmac_f32 v82, v28, v86
    v_fmac_f32 v83, v29, v86
    v_fmac_f32 v84, v30, v86
    v_fmac_f32 v85, v31, v86
    v_cvt_pk_bf16_f32 v82, v82, v83
    v_cvt_pk_bf16_f32 v83, v84, v85
    buffer_store_dwordx2 v[82:83], v14, s[60:63], s15 offen
    s_add_u32 s15, s15, 73728
    v_mov_b32 v8, 1
    s_mov_b64 exec, 1
    ds_add_u32 v1, v8 offset:44
    s_mov_b64 exec, -1
    s_waitcnt vmcnt(0)
    v_mov_b32 v8, 1
    s_mov_b64 exec, 1
    ds_add_u32 v1, v8 offset:40
    s_mov_b64 exec, -1
    s_endpgm
C_FIN:
    s_setprio 0
    v_and_b32 v8, 7, v2
    v_lshlrev_b32 v8, 3, v8
    v_add_u32 v8, 16384, v8
    s_mul_i32 s8, s7, 9216
    s_add_u32 s8, s8, 32768
    v_lshl_add_u32 v5, v2, 4, s8
    v_add_u32 v6, 0x1000, v5
    v_add_u32 v7, 0x2000, v5
    s_waitcnt lgkmcnt(0)
    v_lshrrev_b32 v110, 0, v10
    v_lshrrev_b32 v111, 8, v10
    v_lshrrev_b32 v112, 16, v10
    v_lshrrev_b32 v113, 24, v10
    s_mov_b32 s9, 0
C_SPOLL:
    global_load_dwordx2 v[16:17], v8, s[50:51] sc1
    s_waitcnt vmcnt(0)
    v_cmp_ne_u32 vcc, v17, v10
    s_add_u32 s9, s9, 1
    s_cmp_eq_u64 vcc, 0
    s_cbranch_scc1 C_SOK
    s_sleep 4
    s_cmp_lt_u32 s9, 131072
    s_cbranch_scc1 C_SPOLL
C_SOK:
    s_setprio 3
    s_mov_b32 s9, 0
SP_15:
    ds_read_b32 v12, v1 offset:84
    s_waitcnt lgkmcnt(0)
    v_readfirstlane_b32 s8, v12
    s_add_u32 s9, s9, 1
    s_cmp_ge_u32 s8, 1
    s_cbranch_scc1 SP_15_D
    s_sleep 2
    s_cmp_lt_u32 s9, 524288
    s_cbranch_scc1 SP_15
SP_15_D:
    s_setprio 3
    v_and_b32 v18, 0x7ff, v16
    v_sub_u32 v18, 2047, v18
    v_and_b32 v19, 1, v4
    v_lshrrev_b32 v20, 1, v4
    v_lshl_or_b32 v19, v19, 1, v20
    v_lshlrev_b32 v19, 1, v19
    v_and_b32 v22, 0x7ff, v16
    v_mul_u32_u24 v23, 2336, v19
    v_lshl_add_u32 v23, v22, 1, v23
    v_add_u32 v23, 72960, v23
    ds_read_u16 v105, v23
    v_and_b32 v20, 0xffff0000, v16
    v_ashrrev_i32 v21, 31, v20
    v_not_b32 v21, v21
    v_or_b32 v21, 0x80000000, v21
    v_and_b32 v21, 0xffff0000, v21
    v_xor_b32 v20, v20, v21
    v_mul_f32 v21, 0xbfb8aa3b, v20
    v_exp_f32 v21, v21
    s_nop 0
    v_add_f32 v21, 1.0, v21
    v_rcp_f32 v104, v21
    s_nop 0
    v_cvt_pk_bf16_f32 v104, v104, v104
    v_and_b32 v104, 0xffff0000, v104
    v_lshlrev_b32 v106, 2, v18
    v_add_u32 v106, 91648, v106
    v_mul_u32_u24 v107, 2080, v19
    v_lshl_add_u32 v107, v22, 1, v107
    v_add_u32 v107, 99840, v107
    v_mul_u32_u24 v108, 1152, v18
    v_add3_u32 v108, v108, v19, s55
    s_waitcnt lgkmcnt(0)
    v_lshlrev_b32 v105, 16, v105
    s_mov_b32 s9, 0
    s_setprio 0
    s_mov_b64 exec, 1
C_M1:
    ds_read_b32 v26, v1 offset:100
    s_waitcnt lgkmcnt(0)
    v_readfirstlane_b32 s8, v26
    s_cmp_ge_u32 s8, 1
    s_cbranch_scc1 C_M1S
    global_load_dword v26, v5, s[50:51] sc1
    s_waitcnt vmcnt(0)
    v_xor_b32 v26, v26, v10
    v_and_b32 v26, 0xff, v26
    v_cmp_ne_u32 vcc, 0, v26
    s_add_u32 s9, s9, 1
    s_cmp_eq_u64 vcc, 0
    s_cbranch_scc1 C_M1D
    s_cmp_lt_u32 s9, 131072
    s_cbranch_scc1 C_M1
C_M1S:
    s_mov_b32 s9, 0
SP_16:
    ds_read_b32 v26, v1 offset:44
    s_waitcnt lgkmcnt(0)
    v_readfirstlane_b32 s8, v26
    s_add_u32 s9, s9, 1
    s_cmp_ge_u32 s8, 4
    s_cbranch_scc1 SP_16_D
    s_sleep 1
    s_cmp_lt_u32 s9, 524288
    s_cbranch_scc1 SP_16
SP_16_D:
C_M1D:
    s_mov_b64 exec, -1
    s_setprio 3
    s_mov_b32 s9, 0
C_MPOLL:
    global_load_dwordx4 v[120:123], v5, s[50:51] offset:0 sc1
    global_load_dwordx4 v[124:127], v5, s[50:51] offset:1024 sc1
    global_load_dwordx4 v[128:131], v5, s[50:51] offset:2048 sc1
    global_load_dwordx4 v[132:135], v5, s[50:51] offset:3072 sc1
    global_load_dwordx4 v[136:139], v6, s[50:51] offset:0 sc1
    global_load_dwordx4 v[140:143], v6, s[50:51] offset:1024 sc1
    global_load_dwordx4 v[144:147], v6, s[50:51] offset:2048 sc1
    global_load_dwordx4 v[148:151], v6, s[50:51] offset:3072 sc1
    global_load_dwordx4 v[152:155], v7, s[50:51] offset:0 sc1
    s_waitcnt vmcnt(8)
    v_xor_b32 v26, v120, v10
    v_bitop3_b32 v26, v26, v121, v111 bitop3:0xf6
    v_bitop3_b32 v26, v26, v122, v112 bitop3:0xf6
    v_bitop3_b32 v26, v26, v123, v113 bitop3:0xf6
    s_waitcnt vmcnt(7)
    v_bitop3_b32 v26, v26, v124, v110 bitop3:0xf6
    v_bitop3_b32 v26, v26, v125, v111 bitop3:0xf6
    v_bitop3_b32 v26, v26, v126, v112 bitop3:0xf6
    v_bitop3_b32 v26, v26, v127, v113 bitop3:0xf6
    v_pk_add_f32 v[28:29], v[120:121], v[124:125]
    v_pk_add_f32 v[30:31], v[122:123], v[126:127]
    s_waitcnt vmcnt(6)
    v_bitop3_b32 v26, v26, v128, v110 bitop3:0xf6
    v_bitop3_b32 v26, v26, v129, v111 bitop3:0xf6
    v_bitop3_b32 v26, v26, v130, v112 bitop3:0xf6
    v_bitop3_b32 v26, v26, v131, v113 bitop3:0xf6
    v_pk_add_f32 v[28:29], v[28:29], v[128:129]
    v_pk_add_f32 v[30:31], v[30:31], v[130:131]
    s_waitcnt vmcnt(5)
    v_bitop3_b32 v26, v26, v132, v110 bitop3:0xf6
    v_bitop3_b32 v26, v26, v133, v111 bitop3:0xf6
    v_bitop3_b32 v26, v26, v134, v112 bitop3:0xf6
    v_bitop3_b32 v26, v26, v135, v113 bitop3:0xf6
    v_pk_add_f32 v[28:29], v[28:29], v[132:133]
    v_pk_add_f32 v[30:31], v[30:31], v[134:135]
    s_waitcnt vmcnt(4)
    v_bitop3_b32 v26, v26, v136, v110 bitop3:0xf6
    v_bitop3_b32 v26, v26, v137, v111 bitop3:0xf6
    v_bitop3_b32 v26, v26, v138, v112 bitop3:0xf6
    v_bitop3_b32 v26, v26, v139, v113 bitop3:0xf6
    v_pk_add_f32 v[28:29], v[28:29], v[136:137]
    v_pk_add_f32 v[30:31], v[30:31], v[138:139]
    s_waitcnt vmcnt(3)
    v_bitop3_b32 v26, v26, v140, v110 bitop3:0xf6
    v_bitop3_b32 v26, v26, v141, v111 bitop3:0xf6
    v_bitop3_b32 v26, v26, v142, v112 bitop3:0xf6
    v_bitop3_b32 v26, v26, v143, v113 bitop3:0xf6
    v_pk_add_f32 v[28:29], v[28:29], v[140:141]
    v_pk_add_f32 v[30:31], v[30:31], v[142:143]
    s_waitcnt vmcnt(2)
    v_bitop3_b32 v26, v26, v144, v110 bitop3:0xf6
    v_bitop3_b32 v26, v26, v145, v111 bitop3:0xf6
    v_bitop3_b32 v26, v26, v146, v112 bitop3:0xf6
    v_bitop3_b32 v26, v26, v147, v113 bitop3:0xf6
    v_pk_add_f32 v[28:29], v[28:29], v[144:145]
    v_pk_add_f32 v[30:31], v[30:31], v[146:147]
    s_waitcnt vmcnt(1)
    v_bitop3_b32 v26, v26, v148, v110 bitop3:0xf6
    v_bitop3_b32 v26, v26, v149, v111 bitop3:0xf6
    v_bitop3_b32 v26, v26, v150, v112 bitop3:0xf6
    v_bitop3_b32 v26, v26, v151, v113 bitop3:0xf6
    v_pk_add_f32 v[28:29], v[28:29], v[148:149]
    v_pk_add_f32 v[30:31], v[30:31], v[150:151]
    s_waitcnt vmcnt(0)
    v_bitop3_b32 v26, v26, v152, v110 bitop3:0xf6
    v_bitop3_b32 v26, v26, v153, v111 bitop3:0xf6
    v_bitop3_b32 v26, v26, v154, v112 bitop3:0xf6
    v_bitop3_b32 v26, v26, v155, v113 bitop3:0xf6
    v_pk_add_f32 v[28:29], v[28:29], v[152:153]
    v_pk_add_f32 v[30:31], v[30:31], v[154:155]
    v_and_b32 v26, 0xff, v26
    v_cmp_ne_u32 vcc, 0, v26
    s_add_u32 s9, s9, 1
    s_cmp_eq_u64 vcc, 0
    s_cbranch_scc1 C_MOK
    s_sleep 2
    s_cmp_lt_u32 s9, 131072
    s_cbranch_scc1 C_MPOLL
C_MOK:
    v_permlane32_swap_b32 v28, v29
    v_permlane32_swap_b32 v30, v31
    v_add_f32 v28, v28, v29
    v_add_f32 v30, v30, v31
    s_nop 1
    v_permlane16_swap_b32 v28, v30
    v_add_f32 v28, v28, v30
    s_nop 1
    v_add_f32_dpp v28, v28, v28 row_ror:8 row_mask:0xf bank_mask:0xf
    v_cvt_pk_bf16_f32 v28, v28, v28
    v_and_b32 v28, 0xffff0000, v28
    v_mul_f32 v28, v28, v104
    v_cvt_pk_bf16_f32 v28, v28, v28
    v_and_b32 v28, 0xffff0000, v28
    v_add_f32 v28, v28, v105
    v_cvt_pk_bf16_f32 v28, v28, v28
    v_and_b32 v28, 0xffff0000, v28
    s_setprio 0
    s_mov_b32 s9, 0
SP_17:
    ds_read_b32 v27, v1 offset:40
    s_waitcnt lgkmcnt(0)
    v_readfirstlane_b32 s8, v27
    s_add_u32 s9, s9, 1
    s_cmp_ge_u32 s8, 4
    s_cbranch_scc1 SP_17_D
    s_cmp_lt_u32 s9, 524288
    s_cbranch_scc1 SP_17
SP_17_D:
    s_setprio 3
    ds_read_b32 v25, v106
    ds_read_u16 v24, v107
    s_waitcnt lgkmcnt(0)
    v_sub_f32 v26, 1.0, v25
    v_lshlrev_b32 v24, 16, v24
    v_cvt_pk_bf16_f32 v26, v26, v26
    v_and_b32 v26, 0xffff0000, v26
    v_mul_f32 v28, v28, v26
    v_fmac_f32 v28, v24, v25
    v_cvt_pk_bf16_f32 v28, v28, v28
    s_mov_b32 exec_lo, 0x00ff00ff
    s_mov_b32 exec_hi, 0x00ff00ff
    global_store_short v108, v28, s[46:47]
    s_mov_b64 exec, -1
    s_endpgm
HELPER:
    s_cmp_ge_u32 s3, 6
    s_cbranch_scc1 K_END
    s_and_b32 s12, s3, 1
    s_sub_u32 s13, s3, 2
    s_lshr_b32 s13, s13, 1
    s_mul_i32 s13, s13, 5
    s_add_u32 s13, s13, s5
    s_add_u32 s13, s13, 44
    v_mul_u32_u24 v5, 57, v2
    v_lshrrev_b32 v5, 9, v5
    v_mul_u32_u24 v6, 9, v5
    v_sub_u32 v6, v2, v6
    s_waitcnt lgkmcnt(0)
    s_cmp_eq_u32 s12, 1
    s_cselect_b32 s52, s40, s38
    s_cselect_b32 s53, s41, s39
    s_mov_b32 s54, 5308416
    s_mov_b32 s55, 0x20000
    v_mul_u32_u24 v5, 9216, v5
    v_lshl_add_u32 v5, v6, 7, v5
    s_mul_i32 s8, s4, 1152
    s_sub_u32 s14, s13, 53
    s_lshr_b32 s9, s52, 7
    s_add_u32 s9, s9, s4
    s_sub_u32 s9, 3, s9
    s_and_b32 s9, s9, 7
    s_lshl_b32 s15, s9, 7
    s_add_u32 s15, s15, s8
    s_mul_i32 s14, s14, 258048
    s_add_u32 s15, s15, s14
    s_add_u32 s15, s15, 838656
    s_cmp_eq_u32 s9, 0
    s_cselect_b32 s9, 1024, 0
    v_and_b32 v7, 31, v2
    v_min_u32 v7, 27, v7
    v_mul_u32_u24 v7, 9216, v7
    v_lshrrev_b32 v9, 5, v2
    v_mul_u32_u24 v9, s9, v9
    v_add_u32 v7, v7, v9
    s_mul_i32 s13, s13, 64512
    s_add_u32 s13, s13, s8
    s_mov_b32 s9, 0
SP_18:
    ds_read_b32 v13, v1 offset:4
    s_waitcnt lgkmcnt(0)
    v_readfirstlane_b32 s8, v13
    s_add_u32 s9, s9, 1
    s_cmp_ge_u32 s8, 1
    s_cbranch_scc1 SP_18_D
    s_cmp_lt_u32 s9, 524288
    s_cbranch_scc1 SP_18
SP_18_D:
    buffer_load_dword v8, v7, s[52:55], s15 offen
    s_waitcnt vmcnt(0)
    buffer_load_dword v8, v5, s[52:55], s13 offen
    s_add_u32 s13, s13, 645120
    s_waitcnt vmcnt(0)
    buffer_load_dword v8, v5, s[52:55], s13 offen
    s_add_u32 s13, s13, 645120
    s_waitcnt vmcnt(0)
    buffer_load_dword v8, v5, s[52:55], s13 offen
    s_add_u32 s13, s13, 645120
    s_endpgm
GATE:
    s_lshl_b32 s8, s12, 9
    s_add_u32 s8, s8, 147712
    v_lshl_add_u32 v5, v2, 2, s8
    v_and_b32 v6, 31, v2
    v_lshlrev_b32 v6, 2, v6
    v_add_u32 v6, 158080, v6
    s_lshl_b32 s8, s2, 1
    s_add_u32 s8, s8, s12
    v_mov_b32 v8, 0
    v_mov_b32 v9, 0
    v_mov_b32 v10, 0x3f803f80
    s_lshl_b32 s8, s8, 4
    s_add_u32 s8, s8, 8192
    v_lshrrev_b32 v7, 5, v2
    v_lshl_add_u32 v7, v7, 3, s8
    s_mov_b32 s9, 0
SP_19:
    ds_read_b32 v13, v1 offset:8
    s_waitcnt lgkmcnt(0)
    v_readfirstlane_b32 s8, v13
    s_add_u32 s9, s9, 1
    s_cmp_lg_u32 s8, 0
    s_cbranch_scc1 SP_19_D
    s_sleep 1
    s_cmp_lt_u32 s9, 524288
    s_cbranch_scc1 SP_19
SP_19_D:
    ds_read2_b32 v[34:35], v6 offset0:0 offset1:32
    ds_read2_b32 v[36:37], v6 offset0:64 offset1:96
    ds_read2_b32 v[38:39], v6 offset0:128 offset1:160
    ds_read2_b32 v[40:41], v6 offset0:192 offset1:224
    ds_read_b32 v42, v6 offset:1024
    ds_read2st64_b32 v[16:17], v5 offset0:0 offset1:1
    ds_read2st64_b32 v[18:19], v5 offset0:4 offset1:5
    ds_read2st64_b32 v[20:21], v5 offset0:8 offset1:9
    ds_read2st64_b32 v[22:23], v5 offset0:12 offset1:13
    ds_read2st64_b32 v[24:25], v5 offset0:16 offset1:17
    ds_read2st64_b32 v[26:27], v5 offset0:20 offset1:21
    ds_read2st64_b32 v[28:29], v5 offset0:24 offset1:25
    ds_read2st64_b32 v[30:31], v5 offset0:28 offset1:29
    ds_read2st64_b32 v[32:33], v5 offset0:32 offset1:33
    s_waitcnt lgkmcnt(13)
    v_and_b32 v44, 0xffff, v34
    v_and_b32 v34, 0xffff0000, v34
    v_and_b32 v45, 0xffff, v35
    v_and_b32 v35, 0xffff0000, v35
    s_waitcnt lgkmcnt(12)
    v_and_b32 v46, 0xffff, v36
    v_and_b32 v36, 0xffff0000, v36
    v_and_b32 v47, 0xffff, v37
    v_and_b32 v37, 0xffff0000, v37
    s_waitcnt lgkmcnt(11)
    v_and_b32 v48, 0xffff, v38
    v_and_b32 v38, 0xffff0000, v38
    v_and_b32 v49, 0xffff, v39
    v_and_b32 v39, 0xffff0000, v39
    s_waitcnt lgkmcnt(10)
    v_and_b32 v50, 0xffff, v40
    v_and_b32 v40, 0xffff0000, v40
    v_and_b32 v51, 0xffff, v41
    v_and_b32 v41, 0xffff0000, v41
    s_waitcnt lgkmcnt(9)
    v_and_b32 v52, 0xffff, v42
    v_and_b32 v42, 0xffff0000, v42
    s_waitcnt lgkmcnt(8)
    v_dot2_f32_bf16 v56, v16, v44, 0
    v_dot2_f32_bf16 v57, v16, v34, 0
    v_dot2_f32_bf16 v58, v17, v44, 0
    v_dot2_f32_bf16 v59, v17, v34, 0
    s_waitcnt lgkmcnt(7)
    v_dot2_f32_bf16 v60, v18, v45, 0
    v_dot2_f32_bf16 v61, v18, v35, 0
    v_dot2_f32_bf16 v62, v19, v45, 0
    v_dot2_f32_bf16 v63, v19, v35, 0
    v_cvt_pk_bf16_f32 v56, v56, v57
    v_cvt_pk_bf16_f32 v58, v58, v59
    v_dot2c_f32_bf16 v8, v56, v10
    v_dot2c_f32_bf16 v9, v58, v10
    s_waitcnt lgkmcnt(6)
    v_dot2_f32_bf16 v56, v20, v46, 0
    v_dot2_f32_bf16 v57, v20, v36, 0
    v_dot2_f32_bf16 v58, v21, v46, 0
    v_dot2_f32_bf16 v59, v21, v36, 0
    v_cvt_pk_bf16_f32 v60, v60, v61
    v_cvt_pk_bf16_f32 v62, v62, v63
    v_dot2c_f32_bf16 v8, v60, v10
    v_dot2c_f32_bf16 v9, v62, v10
    s_waitcnt lgkmcnt(5)
    v_dot2_f32_bf16 v60, v22, v47, 0
    v_dot2_f32_bf16 v61, v22, v37, 0
    v_dot2_f32_bf16 v62, v23, v47, 0
    v_dot2_f32_bf16 v63, v23, v37, 0
    v_cvt_pk_bf16_f32 v56, v56, v57
    v_cvt_pk_bf16_f32 v58, v58, v59
    v_dot2c_f32_bf16 v8, v56, v10
    v_dot2c_f32_bf16 v9, v58, v10
    s_waitcnt lgkmcnt(4)
    v_dot2_f32_bf16 v56, v24, v48, 0
    v_dot2_f32_bf16 v57, v24, v38, 0
    v_dot2_f32_bf16 v58, v25, v48, 0
    v_dot2_f32_bf16 v59, v25, v38, 0
    v_cvt_pk_bf16_f32 v60, v60, v61
    v_cvt_pk_bf16_f32 v62, v62, v63
    v_dot2c_f32_bf16 v8, v60, v10
    v_dot2c_f32_bf16 v9, v62, v10
    s_waitcnt lgkmcnt(3)
    v_dot2_f32_bf16 v60, v26, v49, 0
    v_dot2_f32_bf16 v61, v26, v39, 0
    v_dot2_f32_bf16 v62, v27, v49, 0
    v_dot2_f32_bf16 v63, v27, v39, 0
    v_cvt_pk_bf16_f32 v56, v56, v57
    v_cvt_pk_bf16_f32 v58, v58, v59
    v_dot2c_f32_bf16 v8, v56, v10
    v_dot2c_f32_bf16 v9, v58, v10
    s_waitcnt lgkmcnt(2)
    v_dot2_f32_bf16 v56, v28, v50, 0
    v_dot2_f32_bf16 v57, v28, v40, 0
    v_dot2_f32_bf16 v58, v29, v50, 0
    v_dot2_f32_bf16 v59, v29, v40, 0
    v_cvt_pk_bf16_f32 v60, v60, v61
    v_cvt_pk_bf16_f32 v62, v62, v63
    v_dot2c_f32_bf16 v8, v60, v10
    v_dot2c_f32_bf16 v9, v62, v10
    s_waitcnt lgkmcnt(1)
    v_dot2_f32_bf16 v60, v30, v51, 0
    v_dot2_f32_bf16 v61, v30, v41, 0
    v_dot2_f32_bf16 v62, v31, v51, 0
    v_dot2_f32_bf16 v63, v31, v41, 0
    v_cvt_pk_bf16_f32 v56, v56, v57
    v_cvt_pk_bf16_f32 v58, v58, v59
    v_dot2c_f32_bf16 v8, v56, v10
    v_dot2c_f32_bf16 v9, v58, v10
    s_waitcnt lgkmcnt(0)
    v_dot2_f32_bf16 v56, v32, v52, 0
    v_dot2_f32_bf16 v57, v32, v42, 0
    v_dot2_f32_bf16 v58, v33, v52, 0
    v_dot2_f32_bf16 v59, v33, v42, 0
    v_cvt_pk_bf16_f32 v60, v60, v61
    v_cvt_pk_bf16_f32 v62, v62, v63
    v_dot2c_f32_bf16 v8, v60, v10
    v_dot2c_f32_bf16 v9, v62, v10
    v_cvt_pk_bf16_f32 v56, v56, v57
    v_cvt_pk_bf16_f32 v58, v58, v59
    v_dot2c_f32_bf16 v8, v56, v10
    v_dot2c_f32_bf16 v9, v58, v10
    v_mov_b32 v11, 1
    s_mov_b64 exec, 1
    ds_add_u32 v1, v11 offset:12
    s_mov_b64 exec, -1
    v_permlane16_swap_b32 v8, v9
    v_add_f32 v8, v8, v9
    s_nop 1
    v_add_f32_dpp v8, v8, v8 row_ror:8 row_mask:0xf bank_mask:0xf
    s_nop 1
    v_add_f32_dpp v8, v8, v8 row_ror:4 row_mask:0xf bank_mask:0xf
    s_nop 1
    v_add_f32_dpp v8, v8, v8 row_ror:2 row_mask:0xf bank_mask:0xf
    s_nop 1
    v_add_f32_dpp v8, v8, v8 row_ror:1 row_mask:0xf bank_mask:0xf
    v_cvt_pk_bf16_f32 v8, v8, v8
    v_and_b32 v8, 0xffff0000, v8
    v_mul_f32 v9, 0xbfb8aa3b, v8
    v_exp_f32 v9, v9
    s_nop 0
    v_add_f32 v9, 1.0, v9
    v_rcp_f32 v8, v9
    s_nop 0
    v_cvt_pk_bf16_f32 v8, v8, v8
    s_mov_b32 s11, 0xffff
    v_mov_b32 v9, v8
    v_lshl_add_u32 v7, v4, 3, v7
    s_nop 0
    v_permlane32_swap_b32 v8, v9
    v_bfi_b32 v12, s11, v8, v9
    s_mov_b64 exec, 0x00010001
    global_store_dwordx2 v7, v[12:13], s[50:51] sc1
    s_mov_b64 exec, -1
    s_cmp_lt_u32 s5, 9
    s_cbranch_scc1 F_COMP2
    s_cmp_ge_u32 s5, 14
    s_cbranch_scc1 C_IO
    s_endpgm
C_KBODY:
C_SETD:
    s_waitcnt lgkmcnt(0)
    s_lshl_b32 s8, s12, 4
    s_lshr_b64 s[58:59], s[58:59], s8
    s_lshl_b32 s8, s58, 16
    v_mov_b32 v44, s8
    v_mul_f32 v45, 0x3fb8aa3b, v44
    v_mov_b32 v46, 0x3fb8aa3b
    v_fma_f32 v46, v44, v46, -v45
    v_mov_b32 v47, 0x32a57060
    v_fma_f32 v46, v44, v47, v46
    v_exp_f32 v45, v45
    v_mul_f32 v46, 0x3f317218, v46
    v_fma_f32 v45, v45, v46, v45
    v_cvt_pk_bf16_f32 v45, v45, v45
    v_and_b32 v36, 0xffff0000, v45
    v_mul_f32 v37, 0x3fb8aa3b, v36
    v_mul_f32 v38, 0x3e22f983, v36
    s_waitcnt vmcnt(0)
    v_mul_f32 v40, v16, v37
    v_mul_f32 v41, v17, v38
    v_exp_f32 v24, v40
    v_fract_f32 v47, v41
    v_cos_f32 v46, v47
    v_sin_f32 v47, v47
    v_mul_f32 v46, v24, v46
    v_mul_f32 v47, v24, v47
    v_mul_f32 v18, v18, v36
    v_mul_f32 v19, v19, v36
    v_pk_mul_f32 v[42:43], v[20:21], v[18:19] op_sel:[0,0] op_sel_hi:[0,1]
    v_pk_fma_f32 v[42:43], v[20:21], v[18:19], v[42:43] op_sel:[1,1,0] op_sel_hi:[1,0,1] neg_lo:[0,1,0]
    v_max_f32 v39, |v42|, |v43|
    v_pk_mul_f32 v[48:49], v[46:47], v[46:47] op_sel:[0,0] op_sel_hi:[0,1]
    v_pk_fma_f32 v[48:49], v[46:47], v[46:47], v[48:49] op_sel:[1,1,0] op_sel_hi:[1,0,1] neg_lo:[0,1,0]
    v_pk_mul_f32 v[52:53], v[48:49], v[48:49] op_sel:[0,0] op_sel_hi:[0,1]
    v_pk_fma_f32 v[52:53], v[48:49], v[48:49], v[52:53] op_sel:[1,1,0] op_sel_hi:[1,0,1] neg_lo:[0,1,0]
    v_pk_mul_f32 v[60:61], v[52:53], v[52:53] op_sel:[0,0] op_sel_hi:[0,1]
    v_pk_fma_f32 v[60:61], v[52:53], v[52:53], v[60:61] op_sel:[1,1,0] op_sel_hi:[1,0,1] neg_lo:[0,1,0]
    v_mov_b32 v30, 0x3c00
    v_xor_b32 v61, 0x80000000, v61
    ds_write_addtid_b32 v30
    v_cvt_pk_f16_f32 v26, v60, v61
    v_pk_mul_f32 v[62:63], v[60:61], v[60:61] op_sel:[0,0] op_sel_hi:[0,1]
    v_pk_fma_f32 v[62:63], v[60:61], v[60:61], v[62:63] op_sel:[1,1,0] op_sel_hi:[1,0,1] neg_lo:[0,1,0]
    v_max_u32_dpp v39, v39, v39 row_shr:1 row_mask:0xf bank_mask:0xf
    ds_write_addtid_b32 v26 offset:288
    v_cvt_pk_f16_f32 v27, v62, v63
    v_pk_mul_f32 v[64:65], v[62:63], v[60:61] op_sel:[0,0] op_sel_hi:[0,1]
    v_pk_fma_f32 v[64:65], v[62:63], v[60:61], v[64:65] op_sel:[1,1,0] op_sel_hi:[1,0,1] neg_lo:[0,1,0]
    v_max_u32_dpp v39, v39, v39 row_shr:2 row_mask:0xf bank_mask:0xf
    ds_write_addtid_b32 v27 offset:576
    v_cvt_pk_f16_f32 v28, v64, v65
    v_pk_mul_f32 v[62:63], v[64:65], v[60:61] op_sel:[0,0] op_sel_hi:[0,1]
    v_pk_fma_f32 v[62:63], v[64:65], v[60:61], v[62:63] op_sel:[1,1,0] op_sel_hi:[1,0,1] neg_lo:[0,1,0]
    v_max_u32_dpp v39, v39, v39 row_shr:4 row_mask:0xf bank_mask:0xf
    ds_write_addtid_b32 v28 offset:864
    v_cvt_pk_f16_f32 v29, v62, v63
    v_pk_mul_f32 v[64:65], v[62:63], v[60:61] op_sel:[0,0] op_sel_hi:[0,1]
    v_pk_fma_f32 v[64:65], v[62:63], v[60:61], v[64:65] op_sel:[1,1,0] op_sel_hi:[1,0,1] neg_lo:[0,1,0]
    v_max_u32_dpp v39, v39, v39 row_shr:8 row_mask:0xf bank_mask:0xf
    ds_write_addtid_b32 v29 offset:1152
    v_cvt_pk_f16_f32 v26, v64, v65
    v_pk_mul_f32 v[62:63], v[64:65], v[60:61] op_sel:[0,0] op_sel_hi:[0,1]
    v_pk_fma_f32 v[62:63], v[64:65], v[60:61], v[62:63] op_sel:[1,1,0] op_sel_hi:[1,0,1] neg_lo:[0,1,0]
    v_max_u32_dpp v39, v39, v39 row_bcast:15 row_mask:0xa bank_mask:0xf
    ds_write_addtid_b32 v26 offset:1440
    v_cvt_pk_f16_f32 v27, v62, v63
    v_pk_mul_f32 v[64:65], v[62:63], v[60:61] op_sel:[0,0] op_sel_hi:[0,1]
    v_pk_fma_f32 v[64:65], v[62:63], v[60:61], v[64:65] op_sel:[1,1,0] op_sel_hi:[1,0,1] neg_lo:[0,1,0]
    v_max_u32_dpp v39, v39, v39 row_bcast:31 row_mask:0xc bank_mask:0xf
    ds_write_addtid_b32 v27 offset:1728
    v_cvt_pk_f16_f32 v28, v64, v65
    v_pk_mul_f32 v[62:63], v[64:65], v[60:61] op_sel:[0,0] op_sel_hi:[0,1]
    v_pk_fma_f32 v[62:63], v[64:65], v[60:61], v[62:63] op_sel:[1,1,0] op_sel_hi:[1,0,1] neg_lo:[0,1,0]
    v_readlane_b32 s8, v39, 63
    ds_write_addtid_b32 v28 offset:2016
    v_cvt_pk_f16_f32 v29, v62, v63
    v_pk_mul_f32 v[64:65], v[62:63], v[60:61] op_sel:[0,0] op_sel_hi:[0,1]
    v_pk_fma_f32 v[64:65], v[62:63], v[60:61], v[64:65] op_sel:[1,1,0] op_sel_hi:[1,0,1] neg_lo:[0,1,0]
    ds_write_addtid_b32 v29 offset:2304
    v_cvt_pk_f16_f32 v26, v64, v65
    v_pk_mul_f32 v[62:63], v[64:65], v[60:61] op_sel:[0,0] op_sel_hi:[0,1]
    v_pk_fma_f32 v[62:63], v[64:65], v[60:61], v[62:63] op_sel:[1,1,0] op_sel_hi:[1,0,1] neg_lo:[0,1,0]
    ds_write_addtid_b32 v26 offset:2592
    v_cvt_pk_f16_f32 v27, v62, v63
    v_pk_mul_f32 v[64:65], v[62:63], v[60:61] op_sel:[0,0] op_sel_hi:[0,1]
    v_pk_fma_f32 v[64:65], v[62:63], v[60:61], v[64:65] op_sel:[1,1,0] op_sel_hi:[1,0,1] neg_lo:[0,1,0]
    ds_write_addtid_b32 v27 offset:2880
    v_cvt_pk_f16_f32 v28, v64, v65
    v_pk_mul_f32 v[62:63], v[64:65], v[60:61] op_sel:[0,0] op_sel_hi:[0,1]
    v_pk_fma_f32 v[62:63], v[64:65], v[60:61], v[62:63] op_sel:[1,1,0] op_sel_hi:[1,0,1] neg_lo:[0,1,0]
    ds_write_addtid_b32 v28 offset:3168
    v_cvt_pk_f16_f32 v29, v62, v63
    v_pk_mul_f32 v[64:65], v[62:63], v[60:61] op_sel:[0,0] op_sel_hi:[0,1]
    v_pk_fma_f32 v[64:65], v[62:63], v[60:61], v[64:65] op_sel:[1,1,0] op_sel_hi:[1,0,1] neg_lo:[0,1,0]
    ds_write_addtid_b32 v29 offset:3456
    v_cvt_pk_f16_f32 v26, v64, v65
    v_pk_mul_f32 v[62:63], v[64:65], v[60:61] op_sel:[0,0] op_sel_hi:[0,1]
    v_pk_fma_f32 v[62:63], v[64:65], v[60:61], v[62:63] op_sel:[1,1,0] op_sel_hi:[1,0,1] neg_lo:[0,1,0]
    ds_write_addtid_b32 v26 offset:3744
    v_cvt_pk_f16_f32 v27, v62, v63
    v_pk_mul_f32 v[64:65], v[62:63], v[60:61] op_sel:[0,0] op_sel_hi:[0,1]
    v_pk_fma_f32 v[64:65], v[62:63], v[60:61], v[64:65] op_sel:[1,1,0] op_sel_hi:[1,0,1] neg_lo:[0,1,0]
    ds_write_addtid_b32 v27 offset:4032
    v_cvt_pk_f16_f32 v28, v64, v65
    s_lshr_b32 s8, s8, 23
    s_sub_u32 s8, 258, s8
    s_min_u32 s54, s8, 253
    s_lshl_b32 s8, s54, 23
    v_mul_f32 v42, s8, v42
    v_mul_f32 v43, s8, v43
    ds_write_addtid_b32 v28 offset:4320
    ds_read_b128 v[72:75], v7 offset:0
    ds_read_b128 v[76:79], v7 offset:64
    ds_read_b128 v[80:83], v7 offset:128
    ds_read_b128 v[84:87], v7 offset:192
    v_mul_f32 v44, 0x43000000, v40
    v_mul_f32 v45, 0x43000000, v41
    v_exp_f32 v24, v44
    v_fract_f32 v45, v45
    v_cos_f32 v44, v45
    v_sin_f32 v45, v45
    v_mul_f32 v44, v24, v44
    v_mul_f32 v45, v24, v45
    v_pk_mul_f32 v[50:51], v[48:49], v[46:47] op_sel:[0,0] op_sel_hi:[0,1]
    v_pk_fma_f32 v[50:51], v[48:49], v[46:47], v[50:51] op_sel:[1,1,0] op_sel_hi:[1,0,1] neg_lo:[0,1,0]
    v_pk_mul_f32 v[54:55], v[52:53], v[46:47] op_sel:[0,0] op_sel_hi:[0,1]
    v_pk_fma_f32 v[54:55], v[52:53], v[46:47], v[54:55] op_sel:[1,1,0] op_sel_hi:[1,0,1] neg_lo:[0,1,0]
    v_pk_mul_f32 v[56:57], v[50:51], v[50:51] op_sel:[0,0] op_sel_hi:[0,1]
    v_pk_fma_f32 v[56:57], v[50:51], v[50:51], v[56:57] op_sel:[1,1,0] op_sel_hi:[1,0,1] neg_lo:[0,1,0]
    v_pk_mul_f32 v[58:59], v[56:57], v[46:47] op_sel:[0,0] op_sel_hi:[0,1]
    v_pk_fma_f32 v[58:59], v[56:57], v[46:47], v[58:59] op_sel:[1,1,0] op_sel_hi:[1,0,1] neg_lo:[0,1,0]
    v_cvt_pk_f16_f32 v29, v42, v43
    v_pk_mul_f32 v[60:61], v[42:43], v[46:47] op_sel:[0,0] op_sel_hi:[0,1]
    v_pk_fma_f32 v[60:61], v[42:43], v[46:47], v[60:61] op_sel:[1,1,0] op_sel_hi:[1,0,1] neg_lo:[0,1,0]
    ds_write_addtid_b32 v29 offset:0
    v_cvt_pk_f16_f32 v26, v60, v61
    v_pk_mul_f32 v[62:63], v[42:43], v[48:49] op_sel:[0,0] op_sel_hi:[0,1]
    v_pk_fma_f32 v[62:63], v[42:43], v[48:49], v[62:63] op_sel:[1,1,0] op_sel_hi:[1,0,1] neg_lo:[0,1,0]
    ds_write_addtid_b32 v26 offset:288
    v_cvt_pk_f16_f32 v27, v62, v63
    v_pk_mul_f32 v[60:61], v[42:43], v[50:51] op_sel:[0,0] op_sel_hi:[0,1]
    v_pk_fma_f32 v[60:61], v[42:43], v[50:51], v[60:61] op_sel:[1,1,0] op_sel_hi:[1,0,1] neg_lo:[0,1,0]
    ds_write_addtid_b32 v27 offset:576
    v_cvt_pk_f16_f32 v28, v60, v61
    v_pk_mul_f32 v[62:63], v[42:43], v[52:53] op_sel:[0,0] op_sel_hi:[0,1]
    v_pk_fma_f32 v[62:63], v[42:43], v[52:53], v[62:63] op_sel:[1,1,0] op_sel_hi:[1,0,1] neg_lo:[0,1,0]
    ds_write_addtid_b32 v28 offset:864
    v_cvt_pk_f16_f32 v29, v62, v63
    v_pk_mul_f32 v[60:61], v[42:43], v[54:55] op_sel:[0,0] op_sel_hi:[0,1]
    v_pk_fma_f32 v[60:61], v[42:43], v[54:55], v[60:61] op_sel:[1,1,0] op_sel_hi:[1,0,1] neg_lo:[0,1,0]
    ds_write_addtid_b32 v29 offset:1152
    v_cvt_pk_f16_f32 v26, v60, v61
    v_pk_mul_f32 v[62:63], v[42:43], v[56:57] op_sel:[0,0] op_sel_hi:[0,1]
    v_pk_fma_f32 v[62:63], v[42:43], v[56:57], v[62:63] op_sel:[1,1,0] op_sel_hi:[1,0,1] neg_lo:[0,1,0]
    ds_write_addtid_b32 v26 offset:1440
    v_cvt_pk_f16_f32 v27, v62, v63
    v_pk_mul_f32 v[60:61], v[42:43], v[58:59] op_sel:[0,0] op_sel_hi:[0,1]
    v_pk_fma_f32 v[60:61], v[42:43], v[58:59], v[60:61] op_sel:[1,1,0] op_sel_hi:[1,0,1] neg_lo:[0,1,0]
    ds_write_addtid_b32 v27 offset:1728
    v_cvt_pk_f16_f32 v28, v60, v61
    v_pk_mul_f32 v[66:67], v[42:43], v[44:45] op_sel:[0,0] op_sel_hi:[0,1]
    v_pk_fma_f32 v[66:67], v[42:43], v[44:45], v[66:67] op_sel:[1,1,0] op_sel_hi:[1,0,1] neg_lo:[0,1,0]
    ds_write_addtid_b32 v28 offset:2016
    v_cvt_pk_f16_f32 v29, v66, v67
    v_pk_mul_f32 v[62:63], v[66:67], v[46:47] op_sel:[0,0] op_sel_hi:[0,1]
    v_pk_fma_f32 v[62:63], v[66:67], v[46:47], v[62:63] op_sel:[1,1,0] op_sel_hi:[1,0,1] neg_lo:[0,1,0]
    ds_write_addtid_b32 v29 offset:2304
    v_cvt_pk_f16_f32 v26, v62, v63
    v_pk_mul_f32 v[60:61], v[66:67], v[48:49] op_sel:[0,0] op_sel_hi:[0,1]
    v_pk_fma_f32 v[60:61], v[66:67], v[48:49], v[60:61] op_sel:[1,1,0] op_sel_hi:[1,0,1] neg_lo:[0,1,0]
    ds_write_addtid_b32 v26 offset:2592
    v_cvt_pk_f16_f32 v27, v60, v61
    v_pk_mul_f32 v[62:63], v[66:67], v[50:51] op_sel:[0,0] op_sel_hi:[0,1]
    v_pk_fma_f32 v[62:63], v[66:67], v[50:51], v[62:63] op_sel:[1,1,0] op_sel_hi:[1,0,1] neg_lo:[0,1,0]
    ds_write_addtid_b32 v27 offset:2880
    v_cvt_pk_f16_f32 v28, v62, v63
    v_pk_mul_f32 v[60:61], v[66:67], v[52:53] op_sel:[0,0] op_sel_hi:[0,1]
    v_pk_fma_f32 v[60:61], v[66:67], v[52:53], v[60:61] op_sel:[1,1,0] op_sel_hi:[1,0,1] neg_lo:[0,1,0]
    ds_write_addtid_b32 v28 offset:3168
    v_cvt_pk_f16_f32 v29, v60, v61
    v_pk_mul_f32 v[62:63], v[66:67], v[54:55] op_sel:[0,0] op_sel_hi:[0,1]
    v_pk_fma_f32 v[62:63], v[66:67], v[54:55], v[62:63] op_sel:[1,1,0] op_sel_hi:[1,0,1] neg_lo:[0,1,0]
    ds_write_addtid_b32 v29 offset:3456
    v_cvt_pk_f16_f32 v26, v62, v63
    v_pk_mul_f32 v[60:61], v[66:67], v[56:57] op_sel:[0,0] op_sel_hi:[0,1]
    v_pk_fma_f32 v[60:61], v[66:67], v[56:57], v[60:61] op_sel:[1,1,0] op_sel_hi:[1,0,1] neg_lo:[0,1,0]
    ds_write_addtid_b32 v26 offset:3744
    v_cvt_pk_f16_f32 v27, v60, v61
    v_pk_mul_f32 v[62:63], v[66:67], v[58:59] op_sel:[0,0] op_sel_hi:[0,1]
    v_pk_fma_f32 v[62:63], v[66:67], v[58:59], v[62:63] op_sel:[1,1,0] op_sel_hi:[1,0,1] neg_lo:[0,1,0]
    ds_write_addtid_b32 v27 offset:4032
    v_cvt_pk_f16_f32 v28, v62, v63
    v_pk_mul_f32 v[68:69], v[66:67], v[44:45] op_sel:[0,0] op_sel_hi:[0,1]
    v_pk_fma_f32 v[68:69], v[66:67], v[44:45], v[68:69] op_sel:[1,1,0] op_sel_hi:[1,0,1] neg_lo:[0,1,0]
    ds_write_addtid_b32 v28 offset:4320
    ds_read_b128 v[88:91], v7 offset:0
    ds_read_b128 v[92:95], v7 offset:64
    ds_read_b128 v[96:99], v7 offset:128
    ds_read_b128 v[100:103], v7 offset:192
    v_cvt_pk_f16_f32 v29, v68, v69
    v_pk_mul_f32 v[60:61], v[68:69], v[48:49] op_sel:[0,0] op_sel_hi:[0,1]
    v_pk_fma_f32 v[60:61], v[68:69], v[48:49], v[60:61] op_sel:[1,1,0] op_sel_hi:[1,0,1] neg_lo:[0,1,0]
    ds_write_addtid_b32 v29 offset:0
    v_cvt_pk_f16_f32 v26, v60, v61
    v_pk_mul_f32 v[62:63], v[68:69], v[52:53] op_sel:[0,0] op_sel_hi:[0,1]
    v_pk_fma_f32 v[62:63], v[68:69], v[52:53], v[62:63] op_sel:[1,1,0] op_sel_hi:[1,0,1] neg_lo:[0,1,0]
    ds_write_addtid_b32 v26 offset:288
    v_cvt_pk_f16_f32 v27, v62, v63
    v_pk_mul_f32 v[60:61], v[68:69], v[56:57] op_sel:[0,0] op_sel_hi:[0,1]
    v_pk_fma_f32 v[60:61], v[68:69], v[56:57], v[60:61] op_sel:[1,1,0] op_sel_hi:[1,0,1] neg_lo:[0,1,0]
    ds_write_addtid_b32 v27 offset:576
    v_cvt_pk_f16_f32 v28, v60, v61
    v_pk_mul_f32 v[66:67], v[68:69], v[44:45] op_sel:[0,0] op_sel_hi:[0,1]
    v_pk_fma_f32 v[66:67], v[68:69], v[44:45], v[66:67] op_sel:[1,1,0] op_sel_hi:[1,0,1] neg_lo:[0,1,0]
    ds_write_addtid_b32 v28 offset:864
    v_cvt_pk_f16_f32 v29, v66, v67
    s_waitcnt lgkmcnt(7)
    v_mfma_f32_16x16x32_f16 v[104:107], v[88:91], v[72:75], 0
    v_pk_mul_f32 v[62:63], v[66:67], v[48:49] op_sel:[0,0] op_sel_hi:[0,1]
    v_pk_fma_f32 v[62:63], v[66:67], v[48:49], v[62:63] op_sel:[1,1,0] op_sel_hi:[1,0,1] neg_lo:[0,1,0]
    ds_write_addtid_b32 v29 offset:1152
    v_cvt_pk_f16_f32 v26, v62, v63
    s_waitcnt lgkmcnt(7)
    v_mfma_f32_16x16x32_f16 v[104:107], v[92:95], v[76:79], v[104:107]
    v_pk_mul_f32 v[60:61], v[66:67], v[52:53] op_sel:[0,0] op_sel_hi:[0,1]
    v_pk_fma_f32 v[60:61], v[66:67], v[52:53], v[60:61] op_sel:[1,1,0] op_sel_hi:[1,0,1] neg_lo:[0,1,0]
    ds_write_addtid_b32 v26 offset:1440
    v_cvt_pk_f16_f32 v27, v60, v61
    s_waitcnt lgkmcnt(7)
    v_mfma_f32_16x16x32_f16 v[104:107], v[96:99], v[80:83], v[104:107]
    v_pk_mul_f32 v[62:63], v[66:67], v[56:57] op_sel:[0,0] op_sel_hi:[0,1]
    v_pk_fma_f32 v[62:63], v[66:67], v[56:57], v[62:63] op_sel:[1,1,0] op_sel_hi:[1,0,1] neg_lo:[0,1,0]
    ds_write_addtid_b32 v27 offset:1728
    v_cvt_pk_f16_f32 v28, v62, v63
    s_waitcnt lgkmcnt(7)
    v_mfma_f32_16x16x32_f16 v[104:107], v[100:103], v[84:87], v[104:107]
    v_pk_mul_f32 v[68:69], v[66:67], v[44:45] op_sel:[0,0] op_sel_hi:[0,1]
    v_pk_fma_f32 v[68:69], v[66:67], v[44:45], v[68:69] op_sel:[1,1,0] op_sel_hi:[1,0,1] neg_lo:[0,1,0]
    ds_write_addtid_b32 v28 offset:2016
    v_cvt_pk_f16_f32 v29, v68, v69
    v_pk_mul_f32 v[60:61], v[68:69], v[52:53] op_sel:[0,0] op_sel_hi:[0,1]
    v_pk_fma_f32 v[60:61], v[68:69], v[52:53], v[60:61] op_sel:[1,1,0] op_sel_hi:[1,0,1] neg_lo:[0,1,0]
    ds_write_addtid_b32 v29 offset:2304
    v_cvt_pk_f16_f32 v26, v60, v61
    v_pk_mul_f32 v[66:67], v[68:69], v[44:45] op_sel:[0,0] op_sel_hi:[0,1]
    v_pk_fma_f32 v[66:67], v[68:69], v[44:45], v[66:67] op_sel:[1,1,0] op_sel_hi:[1,0,1] neg_lo:[0,1,0]
    ds_write_addtid_b32 v26 offset:2592
    v_cvt_pk_f16_f32 v27, v66, v67
    v_pk_mul_f32 v[62:63], v[66:67], v[52:53] op_sel:[0,0] op_sel_hi:[0,1]
    v_pk_fma_f32 v[62:63], v[66:67], v[52:53], v[62:63] op_sel:[1,1,0] op_sel_hi:[1,0,1] neg_lo:[0,1,0]
    ds_write_addtid_b32 v27 offset:2880
    v_cvt_pk_f16_f32 v28, v62, v63
    v_pk_mul_f32 v[68:69], v[66:67], v[44:45] op_sel:[0,0] op_sel_hi:[0,1]
    v_pk_fma_f32 v[68:69], v[66:67], v[44:45], v[68:69] op_sel:[1,1,0] op_sel_hi:[1,0,1] neg_lo:[0,1,0]
    ds_write_addtid_b32 v28 offset:3168
    v_cvt_pk_f16_f32 v29, v68, v69
    v_pk_mul_f32 v[60:61], v[68:69], v[52:53] op_sel:[0,0] op_sel_hi:[0,1]
    v_pk_fma_f32 v[60:61], v[68:69], v[52:53], v[60:61] op_sel:[1,1,0] op_sel_hi:[1,0,1] neg_lo:[0,1,0]
    ds_write_addtid_b32 v29 offset:3456
    v_cvt_pk_f16_f32 v26, v60, v61
    v_pk_mul_f32 v[66:67], v[68:69], v[44:45] op_sel:[0,0] op_sel_hi:[0,1]
    v_pk_fma_f32 v[66:67], v[68:69], v[44:45], v[66:67] op_sel:[1,1,0] op_sel_hi:[1,0,1] neg_lo:[0,1,0]
    ds_write_addtid_b32 v26 offset:3744
    v_cvt_pk_f16_f32 v27, v66, v67
    v_pk_mul_f32 v[62:63], v[66:67], v[52:53] op_sel:[0,0] op_sel_hi:[0,1]
    v_pk_fma_f32 v[62:63], v[66:67], v[52:53], v[62:63] op_sel:[1,1,0] op_sel_hi:[1,0,1] neg_lo:[0,1,0]
    ds_write_addtid_b32 v27 offset:4032
    v_cvt_pk_f16_f32 v28, v62, v63
    v_pk_mul_f32 v[68:69], v[66:67], v[44:45] op_sel:[0,0] op_sel_hi:[0,1]
    v_pk_fma_f32 v[68:69], v[66:67], v[44:45], v[68:69] op_sel:[1,1,0] op_sel_hi:[1,0,1] neg_lo:[0,1,0]
    ds_write_addtid_b32 v28 offset:4320
    ds_read_b128 v[88:91], v7 offset:0
    ds_read_b128 v[92:95], v7 offset:64
    ds_read_b128 v[96:99], v7 offset:128
    ds_read_b128 v[100:103], v7 offset:192
    v_cvt_pk_f16_f32 v29, v68, v69
    v_pk_mul_f32 v[66:67], v[68:69], v[44:45] op_sel:[0,0] op_sel_hi:[0,1]
    v_pk_fma_f32 v[66:67], v[68:69], v[44:45], v[66:67] op_sel:[1,1,0] op_sel_hi:[1,0,1] neg_lo:[0,1,0]
    ds_write_addtid_b32 v29 offset:0
    v_cvt_pk_f16_f32 v26, v66, v67
    v_pk_mul_f32 v[68:69], v[66:67], v[44:45] op_sel:[0,0] op_sel_hi:[0,1]
    v_pk_fma_f32 v[68:69], v[66:67], v[44:45], v[68:69] op_sel:[1,1,0] op_sel_hi:[1,0,1] neg_lo:[0,1,0]
    ds_write_addtid_b32 v26 offset:288
    v_cvt_pk_f16_f32 v27, v68, v69
    v_pk_mul_f32 v[66:67], v[68:69], v[44:45] op_sel:[0,0] op_sel_hi:[0,1]
    v_pk_fma_f32 v[66:67], v[68:69], v[44:45], v[66:67] op_sel:[1,1,0] op_sel_hi:[1,0,1] neg_lo:[0,1,0]
    ds_write_addtid_b32 v27 offset:576
    v_cvt_pk_f16_f32 v28, v66, v67
    v_pk_mul_f32 v[68:69], v[66:67], v[44:45] op_sel:[0,0] op_sel_hi:[0,1]
    v_pk_fma_f32 v[68:69], v[66:67], v[44:45], v[68:69] op_sel:[1,1,0] op_sel_hi:[1,0,1] neg_lo:[0,1,0]
    ds_write_addtid_b32 v28 offset:864
    v_cvt_pk_f16_f32 v29, v68, v69
    v_pk_mul_f32 v[66:67], v[68:69], v[44:45] op_sel:[0,0] op_sel_hi:[0,1]
    v_pk_fma_f32 v[66:67], v[68:69], v[44:45], v[66:67] op_sel:[1,1,0] op_sel_hi:[1,0,1] neg_lo:[0,1,0]
    s_waitcnt lgkmcnt(7)
    v_mfma_f32_16x16x32_f16 v[108:111], v[88:91], v[72:75], 0
    ds_write_addtid_b32 v29 offset:1152
    v_cvt_pk_f16_f32 v26, v66, v67
    v_pk_mul_f32 v[68:69], v[66:67], v[44:45] op_sel:[0,0] op_sel_hi:[0,1]
    v_pk_fma_f32 v[68:69], v[66:67], v[44:45], v[68:69] op_sel:[1,1,0] op_sel_hi:[1,0,1] neg_lo:[0,1,0]
    s_waitcnt lgkmcnt(7)
    v_mfma_f32_16x16x32_f16 v[108:111], v[92:95], v[76:79], v[108:111]
    ds_write_addtid_b32 v26 offset:1440
    v_cvt_pk_f16_f32 v27, v68, v69
    v_pk_mul_f32 v[66:67], v[68:69], v[44:45] op_sel:[0,0] op_sel_hi:[0,1]
    v_pk_fma_f32 v[66:67], v[68:69], v[44:45], v[66:67] op_sel:[1,1,0] op_sel_hi:[1,0,1] neg_lo:[0,1,0]
    s_waitcnt lgkmcnt(7)
    v_mfma_f32_16x16x32_f16 v[108:111], v[96:99], v[80:83], v[108:111]
    ds_write_addtid_b32 v27 offset:1728
    v_cvt_pk_f16_f32 v28, v66, v67
    v_pk_mul_f32 v[68:69], v[66:67], v[44:45] op_sel:[0,0] op_sel_hi:[0,1]
    v_pk_fma_f32 v[68:69], v[66:67], v[44:45], v[68:69] op_sel:[1,1,0] op_sel_hi:[1,0,1] neg_lo:[0,1,0]
    s_waitcnt lgkmcnt(7)
    v_mfma_f32_16x16x32_f16 v[108:111], v[100:103], v[84:87], v[108:111]
    ds_write_addtid_b32 v28 offset:2016
    v_cvt_pk_f16_f32 v29, v68, v69
    ds_write_addtid_b32 v29 offset:2304
    ds_read_b128 v[88:91], v7 offset:0
    ds_read_b128 v[92:95], v7 offset:64
    ds_read_b128 v[96:99], v7 offset:128
    ds_read_b128 v[100:103], v7 offset:192
    v_lshl_add_u32 v8, v2, 4, s15
    s_waitcnt lgkmcnt(3)
    v_mfma_f32_16x16x32_f16 v[112:115], v[88:91], v[72:75], 0
    s_waitcnt lgkmcnt(2)
    v_mfma_f32_16x16x32_f16 v[112:115], v[92:95], v[76:79], v[112:115]
    s_waitcnt lgkmcnt(1)
    v_mfma_f32_16x16x32_f16 v[112:115], v[96:99], v[80:83], v[112:115]
    s_waitcnt lgkmcnt(0)
    v_mfma_f32_16x16x32_f16 v[112:115], v[100:103], v[84:87], v[112:115]
    s_lshl_b32 s8, s12, 2
    s_add_u32 s8, s8, 16
    v_mov_b32 v9, s8
    s_cmp_eq_u32 s13, 0
    s_cbranch_scc1 C_KA
    ds_write_b128 v8, v[104:107] offset:0
    ds_write_b128 v8, v[108:111] offset:1024
    s_nop 0
    ds_write_b128 v8, v[112:115] offset:2048
    v_mov_b32 v10, s54
    ds_write_b32 v9, v10
    s_setprio 0
    v_and_b32 v14, 3, v3
    v_sub_u32 v14, 3, v14
    v_mul_u32_u24 v14, 2240, v14
    v_lshrrev_b32 v13, 2, v3
    v_lshl_add_u32 v13, v4, 1, v13
    v_lshl_add_u32 v14, v13, 3, v14
    v_add3_u32 v5, v14, s52, 8
    v_lshlrev_b32 v14, 1, v3
    v_sub_u32 v14, v4, v14
    v_lshlrev_b32 v14, 4, v14
    s_add_u32 s8, s53, 480
    v_add_u32 v6, s8, v14
    v_lshl_add_u32 v14, v3, 2, v4
    s_mul_i32 s8, s12, 4160
    s_add_u32 s8, s8, 100344
    v_lshlrev_b32 v14, 3, v14
    v_sub_u32 v140, s8, v14
    s_setprio 3
    s_mov_b32 s9, 0
SP_20:
    ds_read_b32 v10, v1 offset:80
    s_waitcnt lgkmcnt(0)
    v_readfirstlane_b32 s8, v10
    s_add_u32 s9, s9, 1
    s_cmp_ge_u32 s8, 1
    s_cbranch_scc1 SP_20_D
    s_sleep 1
    s_cmp_lt_u32 s9, 524288
    s_cbranch_scc1 SP_20
SP_20_D:
    s_setprio 0
    s_mov_b32 s9, 0
SP_21:
    ds_read_b32 v10, v9 offset:48
    s_waitcnt lgkmcnt(0)
    v_readfirstlane_b32 s8, v10
    s_add_u32 s9, s9, 1
    s_cmp_lg_u32 s8, 0
    s_cbranch_scc1 SP_21_D
    s_cmp_lt_u32 s9, 524288
    s_cbranch_scc1 SP_21
SP_21_D:
    s_setprio 2
    ds_read_b64 v[32:33], v5 offset:0
    ds_read_b64 v[34:35], v5 offset:8
    ds_read_b128 v[60:63], v6 offset:2048
    ds_read_b128 v[56:59], v6 offset:2560
    ds_read_b128 v[52:55], v6 offset:3072
    ds_read_b128 v[48:51], v6 offset:3584
    ds_read_b64 v[36:37], v5 offset:512
    ds_read_b64 v[38:39], v5 offset:520
    ds_read_b64 v[40:41], v5 offset:1024
    ds_read_b64 v[42:43], v5 offset:1032
    ds_read_b64 v[44:45], v5 offset:1536
    ds_read_b64 v[46:47], v5 offset:1544
    s_waitcnt lgkmcnt(9)
    v_mfma_f32_16x16x32_bf16 v[28:31], v[32:35], v[60:63], 0
    ds_read_b64 v[76:77], v5 offset:64
    ds_read_b64 v[78:79], v5 offset:72
    s_waitcnt lgkmcnt(10)
    v_mfma_f32_16x16x32_bf16 v[24:27], v[32:35], v[56:59], 0
    ds_read_b128 v[104:107], v6 offset:2112
    s_waitcnt lgkmcnt(10)
    v_mfma_f32_16x16x32_bf16 v[20:23], v[32:35], v[52:55], 0
    ds_read_b128 v[100:103], v6 offset:2624
    s_waitcnt lgkmcnt(10)
    v_mfma_f32_16x16x32_bf16 v[16:19], v[32:35], v[48:51], 0
    ds_read_b128 v[96:99], v6 offset:3136
    s_waitcnt lgkmcnt(9)
    v_mfma_f32_16x16x32_bf16 v[28:31], v[36:39], v[56:59], v[28:31]
    ds_read_b128 v[92:95], v6 offset:3648
    v_mfma_f32_16x16x32_bf16 v[24:27], v[36:39], v[52:55], v[24:27]
    ds_read_b64 v[80:81], v5 offset:576
    ds_read_b64 v[82:83], v5 offset:584
    v_mfma_f32_16x16x32_bf16 v[20:23], v[36:39], v[48:51], v[20:23]
    ds_read_b64 v[84:85], v5 offset:1088
    s_waitcnt lgkmcnt(11)
    v_mfma_f32_16x16x32_bf16 v[28:31], v[40:43], v[52:55], v[28:31]
    ds_read_b64 v[86:87], v5 offset:1096
    v_mfma_f32_16x16x32_bf16 v[24:27], v[40:43], v[48:51], v[24:27]
    ds_read_b64 v[88:89], v5 offset:1600
    s_waitcnt lgkmcnt(11)
    v_mfma_f32_16x16x32_bf16 v[28:31], v[44:47], v[48:51], v[28:31]
    ds_read_b64 v[90:91], v5 offset:1608
    s_waitcnt lgkmcnt(4)
    v_mfma_f32_16x16x32_bf16 v[28:31], v[76:79], v[104:107], v[28:31]
    ds_read_b64 v[32:33], v5 offset:128
    ds_read_b64 v[34:35], v5 offset:136
    v_mfma_f32_16x16x32_bf16 v[24:27], v[76:79], v[100:103], v[24:27]
    ds_read_b128 v[60:63], v6 offset:2176
    v_mfma_f32_16x16x32_bf16 v[20:23], v[76:79], v[96:99], v[20:23]
    ds_read_b128 v[56:59], v6 offset:2688
    v_mfma_f32_16x16x32_bf16 v[16:19], v[76:79], v[92:95], v[16:19]
    ds_read_b128 v[52:55], v6 offset:3200
    v_mfma_f32_16x16x32_bf16 v[28:31], v[80:83], v[100:103], v[28:31]
    ds_read_b128 v[48:51], v6 offset:3712
    s_waitcnt lgkmcnt(6)
    v_mfma_f32_16x16x32_bf16 v[24:27], v[80:83], v[96:99], v[24:27]
    ds_read_b64 v[36:37], v5 offset:640
    ds_read_b64 v[38:39], v5 offset:648
    v_mfma_f32_16x16x32_bf16 v[20:23], v[80:83], v[92:95], v[20:23]
    ds_read_b64 v[40:41], v5 offset:1152
    v_mfma_f32_16x16x32_bf16 v[28:31], v[84:87], v[96:99], v[28:31]
    ds_read_b64 v[42:43], v5 offset:1160
    v_mfma_f32_16x16x32_bf16 v[24:27], v[84:87], v[92:95], v[24:27]
    ds_read_b64 v[44:45], v5 offset:1664
    v_mfma_f32_16x16x32_bf16 v[28:31], v[88:91], v[92:95], v[28:31]
    ds_read_b64 v[46:47], v5 offset:1672
    s_waitcnt lgkmcnt(4)
    v_mfma_f32_16x16x32_bf16 v[28:31], v[32:35], v[60:63], v[28:31]
    ds_read_b64 v[76:77], v5 offset:192
    ds_read_b64 v[78:79], v5 offset:200
    v_mfma_f32_16x16x32_bf16 v[24:27], v[32:35], v[56:59], v[24:27]
    ds_read_b128 v[104:107], v6 offset:2240
    v_mfma_f32_16x16x32_bf16 v[20:23], v[32:35], v[52:55], v[20:23]
    ds_read_b128 v[100:103], v6 offset:2752
    v_mfma_f32_16x16x32_bf16 v[16:19], v[32:35], v[48:51], v[16:19]
    ds_read_b128 v[96:99], v6 offset:3264
    v_mfma_f32_16x16x32_bf16 v[28:31], v[36:39], v[56:59], v[28:31]
    ds_read_b128 v[92:95], v6 offset:3776
    s_waitcnt lgkmcnt(6)
    v_mfma_f32_16x16x32_bf16 v[24:27], v[36:39], v[52:55], v[24:27]
    ds_read_b64 v[80:81], v5 offset:704
    ds_read_b64 v[82:83], v5 offset:712
    v_mfma_f32_16x16x32_bf16 v[20:23], v[36:39], v[48:51], v[20:23]
    ds_read_b64 v[84:85], v5 offset:1216
    v_mfma_f32_16x16x32_bf16 v[28:31], v[40:43], v[52:55], v[28:31]
    ds_read_b64 v[86:87], v5 offset:1224
    v_mfma_f32_16x16x32_bf16 v[24:27], v[40:43], v[48:51], v[24:27]
    ds_read_b64 v[88:89], v5 offset:1728
    v_mfma_f32_16x16x32_bf16 v[28:31], v[44:47], v[48:51], v[28:31]
    ds_read_b64 v[90:91], v5 offset:1736
    s_waitcnt lgkmcnt(4)
    v_mfma_f32_16x16x32_bf16 v[28:31], v[76:79], v[104:107], v[28:31]
    ds_read_b64 v[32:33], v5 offset:256
    ds_read_b64 v[34:35], v5 offset:264
    v_mfma_f32_16x16x32_bf16 v[24:27], v[76:79], v[100:103], v[24:27]
    ds_read_b128 v[60:63], v6 offset:2304
    v_mfma_f32_16x16x32_bf16 v[20:23], v[76:79], v[96:99], v[20:23]
    ds_read_b128 v[56:59], v6 offset:2816
    v_mfma_f32_16x16x32_bf16 v[16:19], v[76:79], v[92:95], v[16:19]
    ds_read_b128 v[52:55], v6 offset:3328
    v_mfma_f32_16x16x32_bf16 v[28:31], v[80:83], v[100:103], v[28:31]
    ds_read_b128 v[48:51], v6 offset:3840
    s_waitcnt lgkmcnt(6)
    v_mfma_f32_16x16x32_bf16 v[24:27], v[80:83], v[96:99], v[24:27]
    ds_read_b64 v[36:37], v5 offset:768
    ds_read_b64 v[38:39], v5 offset:776
    v_mfma_f32_16x16x32_bf16 v[20:23], v[80:83], v[92:95], v[20:23]
    ds_read_b64 v[40:41], v5 offset:1280
    v_mfma_f32_16x16x32_bf16 v[28:31], v[84:87], v[96:99], v[28:31]
    ds_read_b64 v[42:43], v5 offset:1288
    v_mfma_f32_16x16x32_bf16 v[24:27], v[84:87], v[92:95], v[24:27]
    ds_read_b64 v[44:45], v5 offset:1792
    v_mfma_f32_16x16x32_bf16 v[28:31], v[88:91], v[92:95], v[28:31]
    ds_read_b64 v[46:47], v5 offset:1800
    s_waitcnt lgkmcnt(4)
    v_mfma_f32_16x16x32_bf16 v[28:31], v[32:35], v[60:63], v[28:31]
    ds_read_b64 v[76:77], v5 offset:320
    ds_read_b64 v[78:79], v5 offset:328
    v_mfma_f32_16x16x32_bf16 v[24:27], v[32:35], v[56:59], v[24:27]
    ds_read_b128 v[104:107], v6 offset:2368
    v_mfma_f32_16x16x32_bf16 v[20:23], v[32:35], v[52:55], v[20:23]
    ds_read_b128 v[100:103], v6 offset:2880
    v_mfma_f32_16x16x32_bf16 v[16:19], v[32:35], v[48:51], v[16:19]
    ds_read_b128 v[96:99], v6 offset:3392
    v_mfma_f32_16x16x32_bf16 v[28:31], v[36:39], v[56:59], v[28:31]
    ds_read_b128 v[92:95], v6 offset:3904
    s_waitcnt lgkmcnt(6)
    v_mfma_f32_16x16x32_bf16 v[24:27], v[36:39], v[52:55], v[24:27]
    ds_read_b64 v[80:81], v5 offset:832
    ds_read_b64 v[82:83], v5 offset:840
    v_mfma_f32_16x16x32_bf16 v[20:23], v[36:39], v[48:51], v[20:23]
    ds_read_b64 v[84:85], v5 offset:1344
    v_mfma_f32_16x16x32_bf16 v[28:31], v[40:43], v[52:55], v[28:31]
    ds_read_b64 v[86:87], v5 offset:1352
    v_mfma_f32_16x16x32_bf16 v[24:27], v[40:43], v[48:51], v[24:27]
    ds_read_b64 v[88:89], v5 offset:1856
    v_mfma_f32_16x16x32_bf16 v[28:31], v[44:47], v[48:51], v[28:31]
    ds_read_b64 v[90:91], v5 offset:1864
    s_waitcnt lgkmcnt(4)
    v_mfma_f32_16x16x32_bf16 v[28:31], v[76:79], v[104:107], v[28:31]
    ds_read_b64 v[32:33], v5 offset:384
    ds_read_b64 v[34:35], v5 offset:392
    v_mfma_f32_16x16x32_bf16 v[24:27], v[76:79], v[100:103], v[24:27]
    ds_read_b128 v[60:63], v6 offset:2432
    v_mfma_f32_16x16x32_bf16 v[20:23], v[76:79], v[96:99], v[20:23]
    ds_read_b128 v[56:59], v6 offset:2944
    v_mfma_f32_16x16x32_bf16 v[16:19], v[76:79], v[92:95], v[16:19]
    ds_read_b128 v[52:55], v6 offset:3456
    v_mfma_f32_16x16x32_bf16 v[28:31], v[80:83], v[100:103], v[28:31]
    ds_read_b128 v[48:51], v6 offset:3968
    s_waitcnt lgkmcnt(6)
    v_mfma_f32_16x16x32_bf16 v[24:27], v[80:83], v[96:99], v[24:27]
    ds_read_b64 v[36:37], v5 offset:896
    ds_read_b64 v[38:39], v5 offset:904
    v_mfma_f32_16x16x32_bf16 v[20:23], v[80:83], v[92:95], v[20:23]
    ds_read_b64 v[40:41], v5 offset:1408
    v_mfma_f32_16x16x32_bf16 v[28:31], v[84:87], v[96:99], v[28:31]
    ds_read_b64 v[42:43], v5 offset:1416
    v_mfma_f32_16x16x32_bf16 v[24:27], v[84:87], v[92:95], v[24:27]
    ds_read_b64 v[44:45], v5 offset:1920
    v_mfma_f32_16x16x32_bf16 v[28:31], v[88:91], v[92:95], v[28:31]
    ds_read_b64 v[46:47], v5 offset:1928
    s_waitcnt lgkmcnt(4)
    v_mfma_f32_16x16x32_bf16 v[28:31], v[32:35], v[60:63], v[28:31]
    ds_read_b64 v[76:77], v5 offset:448
    ds_read_b64 v[78:79], v5 offset:456
    v_mfma_f32_16x16x32_bf16 v[24:27], v[32:35], v[56:59], v[24:27]
    ds_read_b128 v[104:107], v6 offset:2496
    v_mfma_f32_16x16x32_bf16 v[20:23], v[32:35], v[52:55], v[20:23]
    ds_read_b128 v[100:103], v6 offset:3008
    v_mfma_f32_16x16x32_bf16 v[16:19], v[32:35], v[48:51], v[16:19]
    ds_read_b128 v[96:99], v6 offset:3520
    v_mfma_f32_16x16x32_bf16 v[28:31], v[36:39], v[56:59], v[28:31]
    ds_read_b128 v[92:95], v6 offset:4032
    s_waitcnt lgkmcnt(6)
    v_mfma_f32_16x16x32_bf16 v[24:27], v[36:39], v[52:55], v[24:27]
    ds_read_b64 v[80:81], v5 offset:960
    ds_read_b64 v[82:83], v5 offset:968
    v_mfma_f32_16x16x32_bf16 v[20:23], v[36:39], v[48:51], v[20:23]
    ds_read_b64 v[84:85], v5 offset:1472
    v_mfma_f32_16x16x32_bf16 v[28:31], v[40:43], v[52:55], v[28:31]
    ds_read_b64 v[86:87], v5 offset:1480
    v_mfma_f32_16x16x32_bf16 v[24:27], v[40:43], v[48:51], v[24:27]
    ds_read_b64 v[88:89], v5 offset:1984
    v_mfma_f32_16x16x32_bf16 v[28:31], v[44:47], v[48:51], v[28:31]
    ds_read_b64 v[90:91], v5 offset:1992
    s_waitcnt lgkmcnt(4)
    v_mfma_f32_16x16x32_bf16 v[28:31], v[76:79], v[104:107], v[28:31]
    v_mfma_f32_16x16x32_bf16 v[24:27], v[76:79], v[100:103], v[24:27]
    v_mfma_f32_16x16x32_bf16 v[20:23], v[76:79], v[96:99], v[20:23]
    v_mfma_f32_16x16x32_bf16 v[16:19], v[76:79], v[92:95], v[16:19]
    v_mfma_f32_16x16x32_bf16 v[28:31], v[80:83], v[100:103], v[28:31]
    s_waitcnt lgkmcnt(0)
    v_mfma_f32_16x16x32_bf16 v[24:27], v[80:83], v[96:99], v[24:27]
    v_mfma_f32_16x16x32_bf16 v[20:23], v[80:83], v[92:95], v[20:23]
    v_mfma_f32_16x16x32_bf16 v[28:31], v[84:87], v[96:99], v[28:31]
    v_mfma_f32_16x16x32_bf16 v[24:27], v[84:87], v[92:95], v[24:27]
    v_mfma_f32_16x16x32_bf16 v[28:31], v[88:91], v[92:95], v[28:31]
    s_nop 0
    v_cvt_pk_bf16_f32 v124, v19, v18
    v_cvt_pk_bf16_f32 v125, v17, v16
    ds_write_b64 v140, v[124:125] offset:3584
    s_nop 0
    v_cvt_pk_bf16_f32 v126, v23, v22
    v_cvt_pk_bf16_f32 v127, v21, v20
    ds_write_b64 v140, v[126:127] offset:3072
    v_cvt_pk_bf16_f32 v128, v27, v26
    v_cvt_pk_bf16_f32 v129, v25, v24
    ds_write_b64 v140, v[128:129] offset:2560
    v_cvt_pk_bf16_f32 v130, v31, v30
    v_cvt_pk_bf16_f32 v131, v29, v28
    ds_write_b64 v140, v[130:131] offset:2048
    v_mov_b32 v12, 1
    s_mov_b64 exec, 1
    ds_add_u32 v1, v12 offset:96
    s_mov_b64 exec, -1
    ds_read_b32 v10, v1 offset:8
    s_cmp_eq_u32 s3, 4
    s_cbranch_scc1 C_FIN
    s_endpgm
C_KA:
    s_setprio 1
    v_lshrrev_b32 v116, 1, v4
    v_and_b32 v117, 1, v4
    v_lshlrev_b32 v116, 8, v116
    v_lshl_add_u32 v116, v117, 3, v116
    v_lshl_add_u32 v116, v3, 4, v116
    v_add_u32 v116, s15, v116
    v_cmp_gt_u32 vcc, 2, v4
    v_lshlrev_b32 v117, 2, v3
    v_lshlrev_b32 v118, 3, v3
    v_cndmask_b32 v117, v117, v118, vcc
    v_lshl_add_u32 v117, v4, 7, v117
    v_add_u32 v117, s15, v117
    v_mov_b32 v118, 64
    v_cndmask_b32 v118, v118, 4, vcc
    v_add_u32 v118, v118, v117
    v_lshlrev_b32 v119, 1, v3
    v_lshl_add_u32 v119, v4, 7, v119
    v_add_u32 v119, s15, v119
    v_lshlrev_b32 v120, 5, v2
    v_lshlrev_b32 v121, 4, v2
    v_add_u32 v121, 256, v121
    v_min_u32 v120, v120, v121
    v_lshlrev_b32 v121, 3, v2
    v_add_u32 v121, 512, v121
    v_min_u32 v120, v120, v121
    v_add_u32 v120, s15, v120
    v_min_u32 v121, 15, v2
    v_lshl_add_u32 v121, v121, 2, s15
    v_lshlrev_b32 v122, 2, v4
    v_sub_u32 v122, v3, v122
    v_lshl_add_u32 v122, v122, 2, s15
    v_add_u32 v122, 2100, v122
    v_lshl_add_u32 v123, v2, 5, s52
    s_mov_b32 s56, 0x01000100
    s_mov_b32 s57, 0x03020302
    v_and_b32 v14, 3, v3
    v_sub_u32 v14, 3, v14
    v_mul_u32_u24 v14, 2240, v14
    v_lshrrev_b32 v13, 2, v3
    v_lshl_add_u32 v13, v4, 1, v13
    v_lshl_add_u32 v14, v13, 3, v14
    v_add3_u32 v5, v14, s52, 8
    v_lshlrev_b32 v14, 1, v3
    v_sub_u32 v14, v4, v14
    v_lshlrev_b32 v14, 4, v14
    s_add_u32 s8, s53, 480
    v_add_u32 v6, s8, v14
    v_lshl_add_u32 v14, v3, 2, v4
    s_mul_i32 s8, s12, 4160
    s_add_u32 s8, s8, 100344
    v_lshlrev_b32 v14, 3, v14
    v_sub_u32 v140, s8, v14
    v_lshl_add_u32 v14, v4, 3, v3
    v_sub_u32 v14, 39, v14
    s_mov_b32 s8, 0x3f800000
    v_mov_b32 v10, 127
    v_mov_b32 v11, 0
    v_lshlrev_b64 v[10:11], v14, v[10:11]
    v_alignbit_b32 v10, v11, v10, 19
    v_bfe_i32 v11, v10, 0, 1
    v_bfe_i32 v12, v10, 1, 1
    v_and_b32 v11, 0x3f80, v11
    v_and_or_b32 v142, v12, s8, v11
    v_bfe_i32 v11, v10, 2, 1
    v_bfe_i32 v12, v10, 3, 1
    v_and_b32 v11, 0x3f80, v11
    v_and_or_b32 v143, v12, s8, v11
    v_bfe_i32 v11, v10, 4, 1
    v_bfe_i32 v12, v10, 5, 1
    v_and_b32 v11, 0x3f80, v11
    v_and_or_b32 v144, v12, s8, v11
    v_bfe_i32 v11, v10, 6, 1
    v_bfe_i32 v12, v10, 7, 1
    v_and_b32 v11, 0x3f80, v11
    v_and_or_b32 v145, v12, s8, v11
    v_mov_b32 v10, 511
    v_mov_b32 v11, 0
    v_lshlrev_b64 v[10:11], v14, v[10:11]
    v_alignbit_b32 v10, v11, v10, 20
    v_bfe_i32 v11, v10, 0, 1
    v_bfe_i32 v12, v10, 1, 1
    v_and_b32 v11, 0x3f80, v11
    v_and_or_b32 v146, v12, s8, v11
    v_bfe_i32 v11, v10, 2, 1
    v_bfe_i32 v12, v10, 3, 1
    v_and_b32 v11, 0x3f80, v11
    v_and_or_b32 v147, v12, s8, v11
    v_bfe_i32 v11, v10, 4, 1
    v_bfe_i32 v12, v10, 5, 1
    v_and_b32 v11, 0x3f80, v11
    v_and_or_b32 v148, v12, s8, v11
    v_bfe_i32 v11, v10, 6, 1
    v_bfe_i32 v12, v10, 7, 1
    v_and_b32 v11, 0x3f80, v11
    v_and_or_b32 v149, v12, s8, v11
    s_lshl_b32 s8, s12, 4
    s_lshr_b64 s[68:69], s[68:69], s8
    s_lshl_b32 s68, s68, 16
    s_sub_u32 s58, 254, s54
    s_lshl_b32 s58, s58, 23
    v_mul_f32 v104, s58, v104
    v_mul_f32 v105, s58, v105
    v_mul_f32 v106, s58, v106
    v_mul_f32 v107, s58, v107
    v_mul_f32 v108, s58, v108
    v_mul_f32 v109, s58, v109
    v_mul_f32 v110, s58, v110
    v_mul_f32 v111, s58, v111
    v_mul_f32 v112, s58, v112
    v_mul_f32 v113, s58, v113
    v_mul_f32 v114, s58, v114
    v_mul_f32 v115, s58, v115
    s_mov_b64 exec, 1
    v_add_f32 v104, s68, v104
    s_mov_b64 exec, -1
    s_setprio 0
    s_mov_b32 s9, 0
SP_22:
    ds_read_b32 v18, v9
    s_waitcnt lgkmcnt(0)
    v_readfirstlane_b32 s8, v18
    s_add_u32 s9, s9, 1
    s_cmp_lg_u32 s8, 0
    s_cbranch_scc1 SP_22_D
    s_cmp_lt_u32 s9, 524288
    s_cbranch_scc1 SP_22
SP_22_D:
    s_setprio 2
    s_sub_u32 s60, 254, s8
    s_lshl_b32 s60, s60, 23
    ds_read_b128 v[88:91], v8 offset:18432
    ds_read_b128 v[92:95], v8 offset:19456
    ds_read_b128 v[96:99], v8 offset:20480
    s_waitcnt lgkmcnt(2)
    v_pk_fma_f32 v[104:105], v[88:89], s[60:61], v[104:105] op_sel_hi:[1,0,1]
    v_cvt_pk_bf16_f32 v20, v104, v105
    v_pk_fma_f32 v[106:107], v[90:91], s[60:61], v[106:107] op_sel_hi:[1,0,1]
    v_cvt_pk_bf16_f32 v21, v106, v107
    ds_write_b64 v116, v[20:21]
    s_waitcnt lgkmcnt(2)
    v_pk_fma_f32 v[108:109], v[92:93], s[60:61], v[108:109] op_sel_hi:[1,0,1]
    v_cvt_pk_bf16_f32 v22, v108, v109
    v_pk_fma_f32 v[110:111], v[94:95], s[60:61], v[110:111] op_sel_hi:[1,0,1]
    v_cvt_pk_bf16_f32 v23, v110, v111
    ds_write_b32 v117, v22 offset:512
    ds_write_b32 v118, v23 offset:512
    s_waitcnt lgkmcnt(3)
    v_pk_fma_f32 v[112:113], v[96:97], s[60:61], v[112:113] op_sel_hi:[1,0,1]
    v_cvt_pk_bf16_f32 v24, v112, v113
    v_pk_fma_f32 v[114:115], v[98:99], s[60:61], v[114:115] op_sel_hi:[1,0,1]
    v_cvt_pk_bf16_f32 v25, v114, v115
    ds_write_b16 v119, v24 offset:1024
    ds_read_b64 v[32:33], v120 offset:0
    ds_read_b64 v[34:35], v120 offset:8
    ds_read_b64 v[36:37], v120 offset:16
    ds_read_b64 v[38:39], v120 offset:24
    s_mov_b32 exec_lo, 0xffff0000
    s_mov_b32 exec_hi, 0
    s_waitcnt lgkmcnt(0)
    v_alignbit_b32 v39, v36, v35, 16
    v_perm_b32 v38, v35, v35, s56
    v_alignbit_b32 v37, v35, v34, 16
    v_perm_b32 v36, v34, v34, s56
    v_alignbit_b32 v35, v34, v33, 16
    v_perm_b32 v34, v33, v33, s56
    v_alignbit_b32 v33, v33, v32, 16
    v_perm_b32 v32, v32, v32, s56
    s_mov_b32 exec_lo, 0
    s_mov_b32 exec_hi, -1
    v_perm_b32 v39, v34, v34, s56
    v_perm_b32 v38, v33, v33, s57
    v_mov_b32 v37, v33
    v_perm_b32 v36, v33, v33, s56
    v_perm_b32 v35, v33, v33, s56
    v_perm_b32 v34, v32, v32, s57
    v_mov_b32 v33, v32
    v_perm_b32 v32, v32, v32, s56
    s_mov_b64 exec, -1
    ds_write_b128 v123, v[32:35] offset:32
    ds_write_b128 v123, v[36:39] offset:48
    v_mov_b32_dpp v30, v38 wave_shr:1 row_mask:0xf bank_mask:0xf bound_ctrl:0
    v_mov_b32_dpp v31, v39 wave_shr:1 row_mask:0xf bank_mask:0xf bound_ctrl:0
    v_alignbit_b32 v44, v32, v31, 16
    v_alignbit_b32 v45, v33, v32, 16
    v_alignbit_b32 v46, v34, v33, 16
    v_alignbit_b32 v47, v35, v34, 16
    ds_write_b128 v123, v[44:47] offset:2272
    v_alignbit_b32 v48, v36, v35, 16
    v_alignbit_b32 v49, v37, v36, 16
    v_alignbit_b32 v50, v38, v37, 16
    v_alignbit_b32 v51, v39, v38, 16
    ds_write_b128 v123, v[48:51] offset:2288
    v_pk_mov_b32 v[52:53], v[30:31], v[32:33] op_sel:[1,0]
    v_pk_mov_b32 v[54:55], v[32:33], v[34:35] op_sel:[1,0]
    ds_write_b128 v123, v[52:55] offset:4512
    v_pk_mov_b32 v[56:57], v[34:35], v[36:37] op_sel:[1,0]
    v_pk_mov_b32 v[58:59], v[36:37], v[38:39] op_sel:[1,0]
    ds_write_b128 v123, v[56:59] offset:4528
    v_alignbit_b32 v60, v31, v30, 16
    v_alignbit_b32 v61, v32, v31, 16
    v_alignbit_b32 v62, v33, v32, 16
    v_alignbit_b32 v63, v34, v33, 16
    ds_write_b128 v123, v[60:63] offset:6752
    v_alignbit_b32 v64, v35, v34, 16
    v_alignbit_b32 v65, v36, v35, 16
    v_alignbit_b32 v66, v37, v36, 16
    v_alignbit_b32 v67, v38, v37, 16
    ds_write_b128 v123, v[64:67] offset:6768
    v_mov_b32 v10, 1
    ds_write_b32 v9, v10 offset:48
    s_setprio 3
    ds_write_b16 v119, v24 offset:2110
    ds_write_b16_d16_hi v119, v24 offset:2142
    ds_write_b16 v119, v25 offset:2174
    ds_write_b16_d16_hi v119, v25 offset:2206
    ds_write_b32 v121, v1 offset:2048
    ds_read2_b32 v[150:151], v122 offset0:3 offset1:2
    ds_read2_b32 v[152:153], v122 offset0:1 offset1:0
    ds_read2_b32 v[154:155], v122 offset0:19 offset1:18
    ds_read2_b32 v[156:157], v122 offset0:17 offset1:16
    ds_read2_b32 v[158:159], v122 offset0:35 offset1:34
    ds_read2_b32 v[160:161], v122 offset0:33 offset1:32
    ds_read2_b32 v[162:163], v122 offset0:51 offset1:50
    ds_read2_b32 v[164:165], v122 offset0:49 offset1:48
    v_alignbit_b32 v72, v39, v38, 16
    v_mov_b32 v73, v39
    v_mov_b32 v74, v39
    v_mov_b32 v75, v39
    v_mov_b32 v78, v39
    v_mov_b32 v79, v39
    v_mov_b32 v80, v39
    v_mov_b32 v82, v39
    v_mov_b32 v83, v39
    v_mov_b32 v84, v39
    v_and_b32 v76, 0xffff, v39
    v_and_b32 v81, 0xffff, v39
    v_mov_b32 v77, 0
    v_mov_b32 v85, 0
    s_mov_b32 exec_lo, 0
    s_mov_b32 exec_hi, 0x80000000
    ds_write_b128 v123, v[72:75] offset:6784
    ds_write_b128 v123, v[74:77] offset:64
    ds_write_b128 v123, v[78:81] offset:4544
    ds_write_b128 v123, v[82:85] offset:2304
    s_mov_b64 exec, -1
    s_mov_b32 s9, 0
SP_23:
    ds_read_b32 v10, v1 offset:80
    s_waitcnt lgkmcnt(0)
    v_readfirstlane_b32 s8, v10
    s_add_u32 s9, s9, 1
    s_cmp_ge_u32 s8, 1
    s_cbranch_scc1 SP_23_D
    s_sleep 1
    s_cmp_lt_u32 s9, 524288
    s_cbranch_scc1 SP_23
SP_23_D:
    s_setprio 3
    ds_read_b128 v[32:35], v6 offset:3584
    ds_read_b128 v[48:51], v6 offset:3600
    ds_read_b128 v[36:39], v6 offset:3072
    ds_read_b128 v[52:55], v6 offset:3088
    ds_read_b128 v[40:43], v6 offset:2560
    ds_read_b128 v[56:59], v6 offset:2576
    ds_read_b128 v[44:47], v6 offset:2048
    ds_read_b128 v[60:63], v6 offset:2064
    ds_read_b64 v[96:97], v5 offset:2048
    ds_read_b64 v[98:99], v5 offset:2056
    s_waitcnt lgkmcnt(9)
    v_mfma_f32_16x16x32_bf16 v[64:67], v[32:35], v[142:145], 0
    s_waitcnt lgkmcnt(8)
    v_mfma_f32_16x16x32_bf16 v[80:83], v[48:51], v[146:149], 0
    s_waitcnt lgkmcnt(7)
    v_mfma_f32_16x16x32_bf16 v[68:71], v[36:39], v[142:145], 0
    s_waitcnt lgkmcnt(6)
    v_mfma_f32_16x16x32_bf16 v[84:87], v[52:55], v[146:149], 0
    s_waitcnt lgkmcnt(5)
    v_mfma_f32_16x16x32_bf16 v[72:75], v[40:43], v[142:145], 0
    s_waitcnt lgkmcnt(4)
    v_mfma_f32_16x16x32_bf16 v[88:91], v[56:59], v[146:149], 0
    s_waitcnt lgkmcnt(3)
    v_mfma_f32_16x16x32_bf16 v[76:79], v[44:47], v[142:145], 0
    s_waitcnt lgkmcnt(2)
    v_mfma_f32_16x16x32_bf16 v[92:95], v[60:63], v[146:149], 0
    s_waitcnt lgkmcnt(0)
    v_mfma_f32_16x16x32_bf16 v[16:19], v[96:99], v[32:35], 0
    v_cvt_pk_bf16_f32 v64, v64, v80
    v_cvt_pk_bf16_f32 v65, v65, v81
    v_cvt_pk_bf16_f32 v66, v66, v82
    v_cvt_pk_bf16_f32 v67, v67, v83
    v_mfma_f32_16x16x32_bf16 v[20:23], v[96:99], v[36:39], 0
    v_cvt_pk_bf16_f32 v68, v68, v84
    v_cvt_pk_bf16_f32 v69, v69, v85
    v_cvt_pk_bf16_f32 v70, v70, v86
    v_cvt_pk_bf16_f32 v71, v71, v87
    v_mfma_f32_16x16x32_bf16 v[24:27], v[96:99], v[40:43], 0
    v_cvt_pk_bf16_f32 v72, v72, v88
    v_cvt_pk_bf16_f32 v73, v73, v89
    v_cvt_pk_bf16_f32 v74, v74, v90
    v_cvt_pk_bf16_f32 v75, v75, v91
    v_mfma_f32_16x16x32_bf16 v[28:31], v[96:99], v[44:47], 0
    v_cvt_pk_bf16_f32 v76, v76, v92
    v_cvt_pk_bf16_f32 v77, v77, v93
    v_cvt_pk_bf16_f32 v78, v78, v94
    v_cvt_pk_bf16_f32 v79, v79, v95
    v_mfma_f32_16x16x32_bf16 v[16:19], v[64:67], v[150:153], v[16:19]
    v_mfma_f32_16x16x32_bf16 v[20:23], v[64:67], v[154:157], v[20:23]
    v_mfma_f32_16x16x32_bf16 v[20:23], v[68:71], v[150:153], v[20:23]
    v_mfma_f32_16x16x32_bf16 v[24:27], v[64:67], v[158:161], v[24:27]
    v_mfma_f32_16x16x32_bf16 v[24:27], v[68:71], v[154:157], v[24:27]
    v_mfma_f32_16x16x32_bf16 v[24:27], v[72:75], v[150:153], v[24:27]
    v_mfma_f32_16x16x32_bf16 v[28:31], v[64:67], v[162:165], v[28:31]
    v_mfma_f32_16x16x32_bf16 v[28:31], v[68:71], v[158:161], v[28:31]
    v_mfma_f32_16x16x32_bf16 v[28:31], v[72:75], v[154:157], v[28:31]
    v_mfma_f32_16x16x32_bf16 v[28:31], v[76:79], v[150:153], v[28:31]
    s_setprio 3
    s_mov_b32 s9, 0
SP_24:
    ds_read_b32 v10, v1 offset:84
    s_waitcnt lgkmcnt(0)
    v_readfirstlane_b32 s8, v10
    s_add_u32 s9, s9, 1
    s_cmp_ge_u32 s8, 1
    s_cbranch_scc1 SP_24_D
    s_sleep 1
    s_cmp_lt_u32 s9, 524288
    s_cbranch_scc1 SP_24
SP_24_D:
    s_setprio 1
    v_cmp_eq_u32 vcc, 0, v2
    v_mov_b32 v13, 100
    s_nop 0
    v_cndmask_b32 v12, 0, 1, vcc
    v_lshl_add_u32 v14, v2, 2, s15
    v_cndmask_b32 v13, v14, v13, vcc
    ds_read_b64 v[32:33], v5 offset:0
    ds_read_b64 v[34:35], v5 offset:8
    ds_read_b128 v[48:51], v6 offset:0
    ds_read_b128 v[72:75], v6 offset:512
    ds_read_b128 v[68:71], v6 offset:1024
    ds_read_b128 v[64:67], v6 offset:1536
    ds_read_b64 v[36:37], v5 offset:512
    ds_read_b64 v[38:39], v5 offset:520
    ds_read_b128 v[60:63], v6 offset:2048
    ds_read_b64 v[40:41], v5 offset:1024
    ds_read_b64 v[42:43], v5 offset:1032
    ds_read_b128 v[56:59], v6 offset:2560
    ds_read_b64 v[44:45], v5 offset:1536
    ds_read_b64 v[46:47], v5 offset:1544
    ds_read_b128 v[52:55], v6 offset:3072
    s_waitcnt lgkmcnt(12)
    v_mfma_f32_16x16x32_bf16 v[28:31], v[32:35], v[48:51], v[28:31]
    ds_read_b64 v[76:77], v5 offset:64
    s_waitcnt lgkmcnt(12)
    v_mfma_f32_16x16x32_bf16 v[24:27], v[32:35], v[72:75], v[24:27]
    ds_read_b64 v[78:79], v5 offset:72
    s_waitcnt lgkmcnt(12)
    v_mfma_f32_16x16x32_bf16 v[20:23], v[32:35], v[68:71], v[20:23]
    ds_read_b128 v[92:95], v6 offset:64
    s_waitcnt lgkmcnt(12)
    v_mfma_f32_16x16x32_bf16 v[16:19], v[32:35], v[64:67], v[16:19]
    ds_read_b128 v[116:119], v6 offset:576
    s_waitcnt lgkmcnt(11)
    v_mfma_f32_16x16x32_bf16 v[28:31], v[36:39], v[72:75], v[28:31]
    ds_read_b128 v[112:115], v6 offset:1088
    v_mfma_f32_16x16x32_bf16 v[24:27], v[36:39], v[68:71], v[24:27]
    ds_read_b128 v[108:111], v6 offset:1600
    v_mfma_f32_16x16x32_bf16 v[20:23], v[36:39], v[64:67], v[20:23]
    ds_read_b64 v[80:81], v5 offset:576
    s_waitcnt lgkmcnt(13)
    v_mfma_f32_16x16x32_bf16 v[16:19], v[36:39], v[60:63], v[16:19]
    ds_read_b64 v[82:83], v5 offset:584
    s_waitcnt lgkmcnt(12)
    v_mfma_f32_16x16x32_bf16 v[28:31], v[40:43], v[68:71], v[28:31]
    ds_read_b128 v[104:107], v6 offset:2112
    v_mfma_f32_16x16x32_bf16 v[24:27], v[40:43], v[64:67], v[24:27]
    ds_read_b64 v[84:85], v5 offset:1088
    v_mfma_f32_16x16x32_bf16 v[20:23], v[40:43], v[60:63], v[20:23]
    ds_read_b64 v[86:87], v5 offset:1096
    s_waitcnt lgkmcnt(14)
    v_mfma_f32_16x16x32_bf16 v[16:19], v[40:43], v[56:59], v[16:19]
    ds_read_b128 v[100:103], v6 offset:2624
    s_waitcnt lgkmcnt(13)
    v_mfma_f32_16x16x32_bf16 v[28:31], v[44:47], v[64:67], v[28:31]
    ds_read_b64 v[88:89], v5 offset:1600
    v_mfma_f32_16x16x32_bf16 v[24:27], v[44:47], v[60:63], v[24:27]
    ds_read_b64 v[90:91], v5 offset:1608
    v_mfma_f32_16x16x32_bf16 v[20:23], v[44:47], v[56:59], v[20:23]
    ds_read_b128 v[96:99], v6 offset:3136
    s_waitcnt lgkmcnt(15)
    v_mfma_f32_16x16x32_bf16 v[16:19], v[44:47], v[52:55], v[16:19]
    s_waitcnt lgkmcnt(6)
    v_mfma_f32_16x16x32_bf16 v[28:31], v[76:79], v[92:95], v[28:31]
    ds_read_b64 v[32:33], v5 offset:128
    v_mfma_f32_16x16x32_bf16 v[24:27], v[76:79], v[116:119], v[24:27]
    ds_read_b64 v[34:35], v5 offset:136
    v_mfma_f32_16x16x32_bf16 v[20:23], v[76:79], v[112:115], v[20:23]
    ds_read_b128 v[48:51], v6 offset:128
    v_mfma_f32_16x16x32_bf16 v[16:19], v[76:79], v[108:111], v[16:19]
    ds_read_b128 v[72:75], v6 offset:640
    v_mfma_f32_16x16x32_bf16 v[28:31], v[80:83], v[116:119], v[28:31]
    ds_read_b128 v[68:71], v6 offset:1152
    v_mfma_f32_16x16x32_bf16 v[24:27], v[80:83], v[112:115], v[24:27]
    ds_read_b128 v[64:67], v6 offset:1664
    v_mfma_f32_16x16x32_bf16 v[20:23], v[80:83], v[108:111], v[20:23]
    ds_read_b64 v[36:37], v5 offset:640
    v_mfma_f32_16x16x32_bf16 v[16:19], v[80:83], v[104:107], v[16:19]
    ds_read_b64 v[38:39], v5 offset:648
    s_waitcnt lgkmcnt(8)
    v_mfma_f32_16x16x32_bf16 v[28:31], v[84:87], v[112:115], v[28:31]
    ds_read_b128 v[60:63], v6 offset:2176
    v_mfma_f32_16x16x32_bf16 v[24:27], v[84:87], v[108:111], v[24:27]
    ds_read_b64 v[40:41], v5 offset:1152
    v_mfma_f32_16x16x32_bf16 v[20:23], v[84:87], v[104:107], v[20:23]
    ds_read_b64 v[42:43], v5 offset:1160
    v_mfma_f32_16x16x32_bf16 v[16:19], v[84:87], v[100:103], v[16:19]
    ds_read_b128 v[56:59], v6 offset:2688
    v_mfma_f32_16x16x32_bf16 v[28:31], v[88:91], v[108:111], v[28:31]
    ds_read_b64 v[44:45], v5 offset:1664
    v_mfma_f32_16x16x32_bf16 v[24:27], v[88:91], v[104:107], v[24:27]
    ds_read_b64 v[46:47], v5 offset:1672
    v_mfma_f32_16x16x32_bf16 v[20:23], v[88:91], v[100:103], v[20:23]
    ds_read_b128 v[52:55], v6 offset:3200
    v_mfma_f32_16x16x32_bf16 v[16:19], v[88:91], v[96:99], v[16:19]
    s_waitcnt lgkmcnt(6)
    v_mfma_f32_16x16x32_bf16 v[28:31], v[32:35], v[48:51], v[28:31]
    ds_read_b64 v[76:77], v5 offset:192
    v_mfma_f32_16x16x32_bf16 v[24:27], v[32:35], v[72:75], v[24:27]
    ds_read_b64 v[78:79], v5 offset:200
    v_mfma_f32_16x16x32_bf16 v[20:23], v[32:35], v[68:71], v[20:23]
    ds_read_b128 v[92:95], v6 offset:192
    v_mfma_f32_16x16x32_bf16 v[16:19], v[32:35], v[64:67], v[16:19]
    ds_read_b128 v[116:119], v6 offset:704
    v_mfma_f32_16x16x32_bf16 v[28:31], v[36:39], v[72:75], v[28:31]
    ds_read_b128 v[112:115], v6 offset:1216
    v_mfma_f32_16x16x32_bf16 v[24:27], v[36:39], v[68:71], v[24:27]
    ds_read_b128 v[108:111], v6 offset:1728
    v_mfma_f32_16x16x32_bf16 v[20:23], v[36:39], v[64:67], v[20:23]
    ds_read_b64 v[80:81], v5 offset:704
    v_mfma_f32_16x16x32_bf16 v[16:19], v[36:39], v[60:63], v[16:19]
    ds_read_b64 v[82:83], v5 offset:712
    s_waitcnt lgkmcnt(8)
    v_mfma_f32_16x16x32_bf16 v[28:31], v[40:43], v[68:71], v[28:31]
    ds_read_b128 v[104:107], v6 offset:2240
    v_mfma_f32_16x16x32_bf16 v[24:27], v[40:43], v[64:67], v[24:27]
    ds_read_b64 v[84:85], v5 offset:1216
    v_mfma_f32_16x16x32_bf16 v[20:23], v[40:43], v[60:63], v[20:23]
    ds_read_b64 v[86:87], v5 offset:1224
    v_mfma_f32_16x16x32_bf16 v[16:19], v[40:43], v[56:59], v[16:19]
    ds_read_b128 v[100:103], v6 offset:2752
    v_mfma_f32_16x16x32_bf16 v[28:31], v[44:47], v[64:67], v[28:31]
    ds_read_b64 v[88:89], v5 offset:1728
    v_mfma_f32_16x16x32_bf16 v[24:27], v[44:47], v[60:63], v[24:27]
    ds_read_b64 v[90:91], v5 offset:1736
    v_mfma_f32_16x16x32_bf16 v[20:23], v[44:47], v[56:59], v[20:23]
    ds_read_b128 v[96:99], v6 offset:3264
    v_mfma_f32_16x16x32_bf16 v[16:19], v[44:47], v[52:55], v[16:19]
    s_waitcnt lgkmcnt(6)
    v_mfma_f32_16x16x32_bf16 v[28:31], v[76:79], v[92:95], v[28:31]
    ds_read_b64 v[32:33], v5 offset:256
    v_mfma_f32_16x16x32_bf16 v[24:27], v[76:79], v[116:119], v[24:27]
    ds_read_b64 v[34:35], v5 offset:264
    v_mfma_f32_16x16x32_bf16 v[20:23], v[76:79], v[112:115], v[20:23]
    ds_read_b128 v[48:51], v6 offset:256
    v_mfma_f32_16x16x32_bf16 v[16:19], v[76:79], v[108:111], v[16:19]
    ds_read_b128 v[72:75], v6 offset:768
    v_mfma_f32_16x16x32_bf16 v[28:31], v[80:83], v[116:119], v[28:31]
    ds_read_b128 v[68:71], v6 offset:1280
    v_mfma_f32_16x16x32_bf16 v[24:27], v[80:83], v[112:115], v[24:27]
    ds_read_b128 v[64:67], v6 offset:1792
    v_mfma_f32_16x16x32_bf16 v[20:23], v[80:83], v[108:111], v[20:23]
    ds_read_b64 v[36:37], v5 offset:768
    v_mfma_f32_16x16x32_bf16 v[16:19], v[80:83], v[104:107], v[16:19]
    ds_read_b64 v[38:39], v5 offset:776
    s_waitcnt lgkmcnt(8)
    v_mfma_f32_16x16x32_bf16 v[28:31], v[84:87], v[112:115], v[28:31]
    ds_read_b128 v[60:63], v6 offset:2304
    v_mfma_f32_16x16x32_bf16 v[24:27], v[84:87], v[108:111], v[24:27]
    ds_read_b64 v[40:41], v5 offset:1280
    v_mfma_f32_16x16x32_bf16 v[20:23], v[84:87], v[104:107], v[20:23]
    ds_read_b64 v[42:43], v5 offset:1288
    v_mfma_f32_16x16x32_bf16 v[16:19], v[84:87], v[100:103], v[16:19]
    ds_read_b128 v[56:59], v6 offset:2816
    v_mfma_f32_16x16x32_bf16 v[28:31], v[88:91], v[108:111], v[28:31]
    ds_read_b64 v[44:45], v5 offset:1792
    v_mfma_f32_16x16x32_bf16 v[24:27], v[88:91], v[104:107], v[24:27]
    ds_read_b64 v[46:47], v5 offset:1800
    v_mfma_f32_16x16x32_bf16 v[20:23], v[88:91], v[100:103], v[20:23]
    ds_read_b128 v[52:55], v6 offset:3328
    v_mfma_f32_16x16x32_bf16 v[16:19], v[88:91], v[96:99], v[16:19]
    s_waitcnt lgkmcnt(6)
    v_mfma_f32_16x16x32_bf16 v[28:31], v[32:35], v[48:51], v[28:31]
    ds_read_b64 v[76:77], v5 offset:320
    v_mfma_f32_16x16x32_bf16 v[24:27], v[32:35], v[72:75], v[24:27]
    ds_read_b64 v[78:79], v5 offset:328
    v_mfma_f32_16x16x32_bf16 v[20:23], v[32:35], v[68:71], v[20:23]
    ds_read_b128 v[92:95], v6 offset:320
    v_mfma_f32_16x16x32_bf16 v[16:19], v[32:35], v[64:67], v[16:19]
    ds_read_b128 v[116:119], v6 offset:832
    v_mfma_f32_16x16x32_bf16 v[28:31], v[36:39], v[72:75], v[28:31]
    ds_read_b128 v[112:115], v6 offset:1344
    v_mfma_f32_16x16x32_bf16 v[24:27], v[36:39], v[68:71], v[24:27]
    ds_read_b128 v[108:111], v6 offset:1856
    v_mfma_f32_16x16x32_bf16 v[20:23], v[36:39], v[64:67], v[20:23]
    ds_read_b64 v[80:81], v5 offset:832
    v_mfma_f32_16x16x32_bf16 v[16:19], v[36:39], v[60:63], v[16:19]
    ds_read_b64 v[82:83], v5 offset:840
    s_waitcnt lgkmcnt(8)
    v_mfma_f32_16x16x32_bf16 v[28:31], v[40:43], v[68:71], v[28:31]
    ds_read_b128 v[104:107], v6 offset:2368
    v_mfma_f32_16x16x32_bf16 v[24:27], v[40:43], v[64:67], v[24:27]
    ds_read_b64 v[84:85], v5 offset:1344
    v_mfma_f32_16x16x32_bf16 v[20:23], v[40:43], v[60:63], v[20:23]
    ds_read_b64 v[86:87], v5 offset:1352
    v_mfma_f32_16x16x32_bf16 v[16:19], v[40:43], v[56:59], v[16:19]
    ds_read_b128 v[100:103], v6 offset:2880
    v_mfma_f32_16x16x32_bf16 v[28:31], v[44:47], v[64:67], v[28:31]
    ds_read_b64 v[88:89], v5 offset:1856
    v_mfma_f32_16x16x32_bf16 v[24:27], v[44:47], v[60:63], v[24:27]
    ds_read_b64 v[90:91], v5 offset:1864
    v_mfma_f32_16x16x32_bf16 v[20:23], v[44:47], v[56:59], v[20:23]
    ds_read_b128 v[96:99], v6 offset:3392
    v_mfma_f32_16x16x32_bf16 v[16:19], v[44:47], v[52:55], v[16:19]
    s_waitcnt lgkmcnt(6)
    v_mfma_f32_16x16x32_bf16 v[28:31], v[76:79], v[92:95], v[28:31]
    ds_read_b64 v[32:33], v5 offset:384
    v_mfma_f32_16x16x32_bf16 v[24:27], v[76:79], v[116:119], v[24:27]
    ds_read_b64 v[34:35], v5 offset:392
    v_mfma_f32_16x16x32_bf16 v[20:23], v[76:79], v[112:115], v[20:23]
    ds_read_b128 v[68:71], v6 offset:1408
    v_mfma_f32_16x16x32_bf16 v[16:19], v[76:79], v[108:111], v[16:19]
    ds_read_b128 v[64:67], v6 offset:1920
    v_mfma_f32_16x16x32_bf16 v[28:31], v[80:83], v[116:119], v[28:31]
    ds_read_b64 v[36:37], v5 offset:896
    v_mfma_f32_16x16x32_bf16 v[24:27], v[80:83], v[112:115], v[24:27]
    v_mfma_f32_16x16x32_bf16 v[20:23], v[80:83], v[108:111], v[20:23]
    ds_read_b64 v[38:39], v5 offset:904
    v_mfma_f32_16x16x32_bf16 v[16:19], v[80:83], v[104:107], v[16:19]
    ds_read_b128 v[60:63], v6 offset:2432
    s_waitcnt lgkmcnt(7)
    v_mfma_f32_16x16x32_bf16 v[28:31], v[84:87], v[112:115], v[28:31]
    ds_read_b64 v[40:41], v5 offset:1408
    v_mfma_f32_16x16x32_bf16 v[24:27], v[84:87], v[108:111], v[24:27]
    ds_read_b64 v[42:43], v5 offset:1416
    v_mfma_f32_16x16x32_bf16 v[20:23], v[84:87], v[104:107], v[20:23]
    v_mfma_f32_16x16x32_bf16 v[16:19], v[84:87], v[100:103], v[16:19]
    ds_read_b128 v[56:59], v6 offset:2944
    v_mfma_f32_16x16x32_bf16 v[28:31], v[88:91], v[108:111], v[28:31]
    ds_read_b64 v[44:45], v5 offset:1920
    v_mfma_f32_16x16x32_bf16 v[24:27], v[88:91], v[104:107], v[24:27]
    ds_read_b64 v[46:47], v5 offset:1928
    v_mfma_f32_16x16x32_bf16 v[20:23], v[88:91], v[100:103], v[20:23]
    ds_read_b128 v[52:55], v6 offset:3456
    v_mfma_f32_16x16x32_bf16 v[16:19], v[88:91], v[96:99], v[16:19]
    s_waitcnt lgkmcnt(6)
    v_mfma_f32_16x16x32_bf16 v[20:23], v[32:35], v[68:71], v[20:23]
    ds_read_b64 v[76:77], v5 offset:448
    ds_read_b64 v[78:79], v5 offset:456
    v_mfma_f32_16x16x32_bf16 v[16:19], v[32:35], v[64:67], v[16:19]
    ds_read_b128 v[112:115], v6 offset:1472
    ds_read_b128 v[108:111], v6 offset:1984
    v_mfma_f32_16x16x32_bf16 v[20:23], v[36:39], v[64:67], v[20:23]
    ds_read_b64 v[80:81], v5 offset:960
    v_mfma_f32_16x16x32_bf16 v[16:19], v[36:39], v[60:63], v[16:19]
    ds_read_b64 v[82:83], v5 offset:968
    ds_read_b128 v[104:107], v6 offset:2496
    s_waitcnt lgkmcnt(7)
    v_mfma_f32_16x16x32_bf16 v[20:23], v[40:43], v[60:63], v[20:23]
    ds_read_b64 v[84:85], v5 offset:1472
    ds_read_b64 v[86:87], v5 offset:1480
    v_mfma_f32_16x16x32_bf16 v[16:19], v[40:43], v[56:59], v[16:19]
    ds_read_b128 v[100:103], v6 offset:3008
    v_mfma_f32_16x16x32_bf16 v[20:23], v[44:47], v[56:59], v[20:23]
    ds_read_b64 v[88:89], v5 offset:1984
    ds_read_b64 v[90:91], v5 offset:1992
    v_mfma_f32_16x16x32_bf16 v[16:19], v[44:47], v[52:55], v[16:19]
    ds_read_b128 v[96:99], v6 offset:3520
    s_waitcnt lgkmcnt(6)
    v_mfma_f32_16x16x32_bf16 v[20:23], v[76:79], v[112:115], v[20:23]
    ds_read_b64 v[32:33], v5 offset:384
    ds_read_b64 v[34:35], v5 offset:392
    v_mfma_f32_16x16x32_bf16 v[16:19], v[76:79], v[108:111], v[16:19]
    ds_read_b128 v[48:51], v6 offset:384
    ds_read_b128 v[72:75], v6 offset:896
    v_mfma_f32_16x16x32_bf16 v[20:23], v[80:83], v[108:111], v[20:23]
    ds_read_b64 v[36:37], v5 offset:896
    v_mfma_f32_16x16x32_bf16 v[16:19], v[80:83], v[104:107], v[16:19]
    ds_read_b64 v[38:39], v5 offset:904
    ds_read_b128 v[68:71], v6 offset:1408
    s_waitcnt lgkmcnt(7)
    v_mfma_f32_16x16x32_bf16 v[20:23], v[84:87], v[104:107], v[20:23]
    ds_read_b64 v[40:41], v5 offset:1408
    ds_read_b64 v[42:43], v5 offset:1416
    v_mfma_f32_16x16x32_bf16 v[16:19], v[84:87], v[100:103], v[16:19]
    ds_read_b128 v[64:67], v6 offset:1920
    v_mfma_f32_16x16x32_bf16 v[20:23], v[88:91], v[100:103], v[20:23]
    ds_read_b64 v[44:45], v5 offset:1920
    ds_read_b64 v[46:47], v5 offset:1928
    v_mfma_f32_16x16x32_bf16 v[16:19], v[88:91], v[96:99], v[16:19]
    ds_read_b128 v[60:63], v6 offset:2432
    s_waitcnt lgkmcnt(6)
    v_mfma_f32_16x16x32_bf16 v[28:31], v[32:35], v[48:51], v[28:31]
    ds_read_b64 v[76:77], v5 offset:448
    ds_read_b64 v[78:79], v5 offset:456
    ds_read_b128 v[92:95], v6 offset:448
    v_mfma_f32_16x16x32_bf16 v[24:27], v[32:35], v[72:75], v[24:27]
    ds_read_b128 v[116:119], v6 offset:960
    ds_read_b64 v[80:81], v5 offset:960
    v_mfma_f32_16x16x32_bf16 v[28:31], v[36:39], v[72:75], v[28:31]
    ds_read_b64 v[82:83], v5 offset:968
    ds_read_b128 v[112:115], v6 offset:1472
    ds_read_b64 v[84:85], v5 offset:1472
    v_mfma_f32_16x16x32_bf16 v[24:27], v[36:39], v[68:71], v[24:27]
    ds_read_b64 v[86:87], v5 offset:1480
    ds_read_b128 v[108:111], v6 offset:1984
    s_waitcnt lgkmcnt(10)
    v_mfma_f32_16x16x32_bf16 v[28:31], v[40:43], v[68:71], v[28:31]
    ds_read_b64 v[88:89], v5 offset:1984
    ds_read_b64 v[90:91], v5 offset:1992
    ds_read_b128 v[104:107], v6 offset:2496
    v_mfma_f32_16x16x32_bf16 v[24:27], v[40:43], v[64:67], v[24:27]
    v_cvt_pk_bf16_f32 v124, v23, v22
    v_cvt_pk_bf16_f32 v125, v21, v20
    v_mfma_f32_16x16x32_bf16 v[28:31], v[44:47], v[64:67], v[28:31]
    ds_write_b64 v140, v[124:125] offset:1024
    v_cvt_pk_bf16_f32 v126, v19, v18
    v_cvt_pk_bf16_f32 v127, v17, v16
    v_mfma_f32_16x16x32_bf16 v[24:27], v[44:47], v[60:63], v[24:27]
    ds_write_b64 v140, v[126:127] offset:1536
    ds_add_u32 v13, v12
    s_waitcnt lgkmcnt(9)
    v_mfma_f32_16x16x32_bf16 v[28:31], v[76:79], v[92:95], v[28:31]
    v_mfma_f32_16x16x32_bf16 v[24:27], v[76:79], v[116:119], v[24:27]
    v_mfma_f32_16x16x32_bf16 v[28:31], v[80:83], v[116:119], v[28:31]
    v_mfma_f32_16x16x32_bf16 v[24:27], v[80:83], v[112:115], v[24:27]
    s_waitcnt lgkmcnt(3)
    v_mfma_f32_16x16x32_bf16 v[28:31], v[84:87], v[112:115], v[28:31]
    v_mfma_f32_16x16x32_bf16 v[24:27], v[84:87], v[108:111], v[24:27]
    v_mfma_f32_16x16x32_bf16 v[28:31], v[88:91], v[108:111], v[28:31]
    v_mfma_f32_16x16x32_bf16 v[24:27], v[88:91], v[104:107], v[24:27]
    s_nop 6
    v_cvt_pk_bf16_f32 v124, v31, v30
    v_cvt_pk_bf16_f32 v125, v29, v28
    ds_write_b64 v140, v[124:125] offset:0
    v_cvt_pk_bf16_f32 v126, v27, v26
    v_cvt_pk_bf16_f32 v127, v25, v24
    ds_write_b64 v140, v[126:127] offset:512
    v_mov_b32 v12, 1
    s_mov_b64 exec, 1
    ds_add_u32 v1, v12 offset:104
    s_mov_b64 exec, -1
    s_endpgm
SELECT:
    s_mov_b32 s52, s16
    s_mov_b32 s53, s17
    s_mov_b32 s54, 2359296
    s_mov_b32 s55, 0x20000
    v_lshlrev_b32 v7, 4, v2
    v_add_u32 v15, 0x1000, v7
    v_lshlrev_b32 v8, 2, v2
    v_sub_u32 v8, 2047, v8
    v_subrev_u32 v48, 0, v8
    v_subrev_u32 v49, 1, v8
    v_subrev_u32 v50, 2, v8
    v_subrev_u32 v51, 3, v8
    v_subrev_u32 v52, 256, v8
    v_subrev_u32 v53, 257, v8
    v_subrev_u32 v54, 258, v8
    v_subrev_u32 v55, 259, v8
    v_subrev_u32 v56, 512, v8
    v_subrev_u32 v57, 513, v8
    v_subrev_u32 v58, 514, v8
    v_subrev_u32 v59, 515, v8
    v_subrev_u32 v60, 768, v8
    v_subrev_u32 v61, 769, v8
    v_subrev_u32 v62, 770, v8
    v_subrev_u32 v63, 771, v8
    v_subrev_u32 v64, 1024, v8
    v_subrev_u32 v65, 1025, v8
    v_subrev_u32 v66, 1026, v8
    v_subrev_u32 v67, 1027, v8
    v_subrev_u32 v68, 1280, v8
    v_subrev_u32 v69, 1281, v8
    v_subrev_u32 v70, 1282, v8
    v_subrev_u32 v71, 1283, v8
    v_subrev_u32 v72, 1536, v8
    v_subrev_u32 v73, 1537, v8
    v_subrev_u32 v74, 1538, v8
    v_subrev_u32 v75, 1539, v8
    v_subrev_u32 v76, 1792, v8
    v_subrev_u32 v77, 1793, v8
    v_subrev_u32 v78, 1794, v8
    v_subrev_u32 v79, 1795, v8
    v_lshrrev_b32 v9, 3, v2
    v_and_b32 v9, 6, v9
    v_xor_b32 v9, v9, v2
    v_and_b32 v9, 7, v9
    v_lshlrev_b32 v5, 4, v9
    v_mov_b32 v12, 0
    v_mov_b32 v6, 0
    s_mov_b32 s11, 0xffff0000
    s_mov_b32 s9, 0
SP_25:
    ds_read_b32 v13, v1 offset:12
    s_waitcnt lgkmcnt(0)
    v_readfirstlane_b32 s8, v13
    s_add_u32 s9, s9, 1
    s_cmp_ge_u32 s8, 2
    s_cbranch_scc1 SP_25_D
    s_cmp_lt_u32 s9, 524288
    s_cbranch_scc1 SP_25
SP_25_D:
    s_mov_b32 s9, 0
    s_waitcnt vmcnt(0)
    s_sleep 18
SEL_POLL:
    global_load_dwordx4 v[16:19], v7, s[50:51] offset:0 sc1
    global_load_dwordx4 v[20:23], v7, s[50:51] offset:1024 sc1
    global_load_dwordx4 v[24:27], v7, s[50:51] offset:2048 sc1
    global_load_dwordx4 v[28:31], v7, s[50:51] offset:3072 sc1
    global_load_dwordx4 v[32:35], v15, s[50:51] offset:0 sc1
    global_load_dwordx4 v[36:39], v15, s[50:51] offset:1024 sc1
    global_load_dwordx4 v[40:43], v15, s[50:51] offset:2048 sc1
    global_load_dwordx4 v[44:47], v15, s[50:51] offset:3072 sc1
    s_waitcnt vmcnt(7)
    v_xor_b32 v13, v17, v14
    v_bitop3_b32 v13, v13, v19, v14 bitop3:0xf6
    s_waitcnt vmcnt(6)
    v_bitop3_b32 v13, v13, v21, v14 bitop3:0xf6
    v_bitop3_b32 v13, v13, v23, v14 bitop3:0xf6
    s_waitcnt vmcnt(5)
    v_bitop3_b32 v13, v13, v25, v14 bitop3:0xf6
    v_bitop3_b32 v13, v13, v27, v14 bitop3:0xf6
    s_waitcnt vmcnt(4)
    v_bitop3_b32 v13, v13, v29, v14 bitop3:0xf6
    v_bitop3_b32 v13, v13, v31, v14 bitop3:0xf6
    s_waitcnt vmcnt(3)
    v_bitop3_b32 v13, v13, v33, v14 bitop3:0xf6
    v_bitop3_b32 v13, v13, v35, v14 bitop3:0xf6
    s_waitcnt vmcnt(2)
    v_bitop3_b32 v13, v13, v37, v14 bitop3:0xf6
    v_bitop3_b32 v13, v13, v39, v14 bitop3:0xf6
    s_waitcnt vmcnt(1)
    v_bitop3_b32 v13, v13, v41, v14 bitop3:0xf6
    v_bitop3_b32 v13, v13, v43, v14 bitop3:0xf6
    s_waitcnt vmcnt(0)
    v_bitop3_b32 v13, v13, v45, v14 bitop3:0xf6
    v_bitop3_b32 v13, v13, v47, v14 bitop3:0xf6
    v_cmp_ne_u32 vcc, 0, v13
    s_add_u32 s9, s9, 1
    s_cmp_eq_u64 vcc, 0
    s_cbranch_scc1 SEL_GOT
    s_cmp_lt_u32 s9, 131072
    s_cbranch_scc1 SEL_POLL
SEL_GOT:
    v_lshl_or_b32 v80, v16, 16, v48
    v_and_or_b32 v81, v16, s11, v49
    v_lshl_or_b32 v82, v18, 16, v50
    v_and_or_b32 v83, v18, s11, v51
    v_min_u32 v9, v80, v81
    v_max_u32 v8, v80, v81
    v_med3_u32 v9, v8, v9, v82
    v_max_u32 v8, v8, v82
    v_med3_u32 v9, v8, v9, v83
    v_max_u32 v8, v8, v83
    v_lshl_or_b32 v84, v20, 16, v52
    v_and_or_b32 v85, v20, s11, v53
    v_lshl_or_b32 v86, v22, 16, v54
    v_and_or_b32 v87, v22, s11, v55
    v_med3_u32 v9, v8, v9, v84
    v_max_u32 v8, v8, v84
    v_med3_u32 v9, v8, v9, v85
    v_max_u32 v8, v8, v85
    v_med3_u32 v9, v8, v9, v86
    v_max_u32 v8, v8, v86
    v_med3_u32 v9, v8, v9, v87
    v_max_u32 v8, v8, v87
    v_lshl_or_b32 v88, v24, 16, v56
    v_and_or_b32 v89, v24, s11, v57
    v_lshl_or_b32 v90, v26, 16, v58
    v_and_or_b32 v91, v26, s11, v59
    v_med3_u32 v9, v8, v9, v88
    v_max_u32 v8, v8, v88
    v_med3_u32 v9, v8, v9, v89
    v_max_u32 v8, v8, v89
    v_med3_u32 v9, v8, v9, v90
    v_max_u32 v8, v8, v90
    v_med3_u32 v9, v8, v9, v91
    v_max_u32 v8, v8, v91
    v_lshl_or_b32 v92, v28, 16, v60
    v_and_or_b32 v93, v28, s11, v61
    v_lshl_or_b32 v94, v30, 16, v62
    v_and_or_b32 v95, v30, s11, v63
    v_med3_u32 v9, v8, v9, v92
    v_max_u32 v8, v8, v92
    v_med3_u32 v9, v8, v9, v93
    v_max_u32 v8, v8, v93
    v_med3_u32 v9, v8, v9, v94
    v_max_u32 v8, v8, v94
    v_med3_u32 v9, v8, v9, v95
    v_max_u32 v8, v8, v95
    v_lshl_or_b32 v96, v32, 16, v64
    v_and_or_b32 v97, v32, s11, v65
    v_lshl_or_b32 v98, v34, 16, v66
    v_and_or_b32 v99, v34, s11, v67
    v_med3_u32 v9, v8, v9, v96
    v_max_u32 v8, v8, v96
    v_med3_u32 v9, v8, v9, v97
    v_max_u32 v8, v8, v97
    v_med3_u32 v9, v8, v9, v98
    v_max_u32 v8, v8, v98
    v_med3_u32 v9, v8, v9, v99
    v_max_u32 v8, v8, v99
    v_lshl_or_b32 v100, v36, 16, v68
    v_and_or_b32 v101, v36, s11, v69
    v_lshl_or_b32 v102, v38, 16, v70
    v_and_or_b32 v103, v38, s11, v71
    v_med3_u32 v9, v8, v9, v100
    v_max_u32 v8, v8, v100
    v_med3_u32 v9, v8, v9, v101
    v_max_u32 v8, v8, v101
    v_med3_u32 v9, v8, v9, v102
    v_max_u32 v8, v8, v102
    v_med3_u32 v9, v8, v9, v103
    v_max_u32 v8, v8, v103
    v_lshl_or_b32 v104, v40, 16, v72
    v_and_or_b32 v105, v40, s11, v73
    v_lshl_or_b32 v106, v42, 16, v74
    v_and_or_b32 v107, v42, s11, v75
    v_med3_u32 v9, v8, v9, v104
    v_max_u32 v8, v8, v104
    v_med3_u32 v9, v8, v9, v105
    v_max_u32 v8, v8, v105
    v_med3_u32 v9, v8, v9, v106
    v_max_u32 v8, v8, v106
    v_med3_u32 v9, v8, v9, v107
    v_max_u32 v8, v8, v107
    v_lshl_or_b32 v108, v44, 16, v76
    v_and_or_b32 v109, v44, s11, v77
    v_lshl_or_b32 v110, v46, 16, v78
    v_and_or_b32 v111, v46, s11, v79
    v_med3_u32 v9, v8, v9, v108
    v_max_u32 v8, v8, v108
    v_med3_u32 v9, v8, v9, v109
    v_max_u32 v8, v8, v109
    v_med3_u32 v9, v8, v9, v110
    v_max_u32 v8, v8, v110
    v_med3_u32 v9, v8, v9, v111
    v_max_u32 v8, v8, v111
    v_mov_b32 v10, v8
    s_nop 1
    v_max_u32_dpp v10, v10, v10 row_shr:1 row_mask:0xf bank_mask:0xf
    s_nop 1
    v_max_u32_dpp v10, v10, v10 row_shr:2 row_mask:0xf bank_mask:0xf
    s_nop 1
    v_max_u32_dpp v10, v10, v10 row_shr:4 row_mask:0xf bank_mask:0xf
    s_nop 1
    v_max_u32_dpp v10, v10, v10 row_shr:8 row_mask:0xf bank_mask:0xf
    s_nop 1
    v_max_u32_dpp v10, v10, v10 row_bcast:15 row_mask:0xa bank_mask:0xf
    s_nop 1
    v_max_u32_dpp v10, v10, v10 row_bcast:31 row_mask:0xc bank_mask:0xf
    s_nop 0
    v_readlane_b32 s8, v10, 63
    s_mov_b32 s12, s8
    v_subrev_u32 v10, s12, v8
    v_subrev_u32 v11, s12, v9
    v_max_u32 v10, v10, v11
    s_and_b32 s13, s12, 0x7ff
    s_sub_u32 s13, 2047, s13
    v_max_u32_dpp v10, v10, v10 row_shr:1 row_mask:0xf bank_mask:0xf
    s_mul_i32 s13, s13, 1152
    s_nop 0
    v_max_u32_dpp v10, v10, v10 row_shr:2 row_mask:0xf bank_mask:0xf
    s_mov_b32 exec_lo, 0xff
    s_mov_b32 exec_hi, 0x0
    v_add_u32 v12, s13, v5
    v_mov_b32 v6, s12
    s_mov_b64 exec, -1
    v_max_u32_dpp v10, v10, v10 row_shr:4 row_mask:0xf bank_mask:0xf
    s_nop 1
    v_max_u32_dpp v10, v10, v10 row_shr:8 row_mask:0xf bank_mask:0xf
    s_nop 1
    v_max_u32_dpp v10, v10, v10 row_bcast:15 row_mask:0xa bank_mask:0xf
    s_nop 1
    v_max_u32_dpp v10, v10, v10 row_bcast:31 row_mask:0xc bank_mask:0xf
    s_nop 0
    v_readlane_b32 s8, v10, 63
    s_add_u32 s12, s12, s8
    v_subrev_u32 v10, s12, v8
    v_subrev_u32 v11, s12, v9
    v_max_u32 v10, v10, v11
    s_and_b32 s13, s12, 0x7ff
    s_sub_u32 s13, 2047, s13
    v_max_u32_dpp v10, v10, v10 row_shr:1 row_mask:0xf bank_mask:0xf
    s_mul_i32 s13, s13, 1152
    s_nop 0
    v_max_u32_dpp v10, v10, v10 row_shr:2 row_mask:0xf bank_mask:0xf
    s_mov_b32 exec_lo, 0xff00
    s_mov_b32 exec_hi, 0x0
    v_add_u32 v12, s13, v5
    v_mov_b32 v6, s12
    s_mov_b64 exec, -1
    v_max_u32_dpp v10, v10, v10 row_shr:4 row_mask:0xf bank_mask:0xf
    s_nop 1
    v_max_u32_dpp v10, v10, v10 row_shr:8 row_mask:0xf bank_mask:0xf
    s_nop 1
    v_max_u32_dpp v10, v10, v10 row_bcast:15 row_mask:0xa bank_mask:0xf
    s_nop 1
    v_max_u32_dpp v10, v10, v10 row_bcast:31 row_mask:0xc bank_mask:0xf
    s_nop 0
    v_readlane_b32 s8, v10, 63
    s_add_u32 s12, s12, s8
    v_subrev_u32 v10, s12, v8
    v_subrev_u32 v11, s12, v9
    v_max_u32 v10, v10, v11
    s_and_b32 s13, s12, 0x7ff
    s_sub_u32 s13, 2047, s13
    v_max_u32_dpp v10, v10, v10 row_shr:1 row_mask:0xf bank_mask:0xf
    s_mul_i32 s13, s13, 1152
    s_nop 0
    v_max_u32_dpp v10, v10, v10 row_shr:2 row_mask:0xf bank_mask:0xf
    s_mov_b32 exec_lo, 0xff0000
    s_mov_b32 exec_hi, 0x0
    v_add_u32 v12, s13, v5
    v_mov_b32 v6, s12
    s_mov_b64 exec, -1
    v_max_u32_dpp v10, v10, v10 row_shr:4 row_mask:0xf bank_mask:0xf
    s_nop 1
    v_max_u32_dpp v10, v10, v10 row_shr:8 row_mask:0xf bank_mask:0xf
    s_nop 1
    v_max_u32_dpp v10, v10, v10 row_bcast:15 row_mask:0xa bank_mask:0xf
    s_nop 1
    v_max_u32_dpp v10, v10, v10 row_bcast:31 row_mask:0xc bank_mask:0xf
    s_nop 0
    v_readlane_b32 s8, v10, 63
    s_add_u32 s12, s12, s8
    v_subrev_u32 v10, s12, v8
    v_subrev_u32 v11, s12, v9
    v_max_u32 v10, v10, v11
    s_and_b32 s13, s12, 0x7ff
    s_sub_u32 s13, 2047, s13
    v_max_u32_dpp v10, v10, v10 row_shr:1 row_mask:0xf bank_mask:0xf
    s_mul_i32 s13, s13, 1152
    s_nop 0
    v_max_u32_dpp v10, v10, v10 row_shr:2 row_mask:0xf bank_mask:0xf
    s_mov_b32 exec_lo, 0xff000000
    s_mov_b32 exec_hi, 0x0
    v_add_u32 v12, s13, v5
    v_mov_b32 v6, s12
    s_mov_b64 exec, -1
    v_max_u32_dpp v10, v10, v10 row_shr:4 row_mask:0xf bank_mask:0xf
    s_nop 1
    v_max_u32_dpp v10, v10, v10 row_shr:8 row_mask:0xf bank_mask:0xf
    s_nop 1
    v_max_u32_dpp v10, v10, v10 row_bcast:15 row_mask:0xa bank_mask:0xf
    s_nop 1
    v_max_u32_dpp v10, v10, v10 row_bcast:31 row_mask:0xc bank_mask:0xf
    s_nop 0
    v_readlane_b32 s8, v10, 63
    s_add_u32 s12, s12, s8
    v_subrev_u32 v10, s12, v8
    v_subrev_u32 v11, s12, v9
    v_max_u32 v10, v10, v11
    s_and_b32 s13, s12, 0x7ff
    s_sub_u32 s13, 2047, s13
    v_max_u32_dpp v10, v10, v10 row_shr:1 row_mask:0xf bank_mask:0xf
    s_mul_i32 s13, s13, 1152
    s_nop 0
    v_max_u32_dpp v10, v10, v10 row_shr:2 row_mask:0xf bank_mask:0xf
    s_mov_b32 exec_lo, 0x0
    s_mov_b32 exec_hi, 0xff
    v_add_u32 v12, s13, v5
    v_mov_b32 v6, s12
    s_mov_b64 exec, -1
    v_max_u32_dpp v10, v10, v10 row_shr:4 row_mask:0xf bank_mask:0xf
    s_nop 1
    v_max_u32_dpp v10, v10, v10 row_shr:8 row_mask:0xf bank_mask:0xf
    s_nop 1
    v_max_u32_dpp v10, v10, v10 row_bcast:15 row_mask:0xa bank_mask:0xf
    s_nop 1
    v_max_u32_dpp v10, v10, v10 row_bcast:31 row_mask:0xc bank_mask:0xf
    s_nop 0
    v_readlane_b32 s8, v10, 63
    s_add_u32 s12, s12, s8
    v_subrev_u32 v10, s12, v8
    v_subrev_u32 v11, s12, v9
    v_max_u32 v10, v10, v11
    s_and_b32 s13, s12, 0x7ff
    s_sub_u32 s13, 2047, s13
    v_max_u32_dpp v10, v10, v10 row_shr:1 row_mask:0xf bank_mask:0xf
    s_mul_i32 s13, s13, 1152
    s_nop 0
    v_max_u32_dpp v10, v10, v10 row_shr:2 row_mask:0xf bank_mask:0xf
    s_mov_b32 exec_lo, 0x0
    s_mov_b32 exec_hi, 0xff00
    v_add_u32 v12, s13, v5
    v_mov_b32 v6, s12
    s_mov_b64 exec, -1
    v_max_u32_dpp v10, v10, v10 row_shr:4 row_mask:0xf bank_mask:0xf
    s_nop 1
    v_max_u32_dpp v10, v10, v10 row_shr:8 row_mask:0xf bank_mask:0xf
    s_nop 1
    v_max_u32_dpp v10, v10, v10 row_bcast:15 row_mask:0xa bank_mask:0xf
    s_nop 1
    v_max_u32_dpp v10, v10, v10 row_bcast:31 row_mask:0xc bank_mask:0xf
    s_nop 0
    v_readlane_b32 s8, v10, 63
    s_add_u32 s12, s12, s8
    v_subrev_u32 v10, s12, v8
    v_subrev_u32 v11, s12, v9
    v_max_u32 v10, v10, v11
    s_and_b32 s13, s12, 0x7ff
    s_sub_u32 s13, 2047, s13
    v_max_u32_dpp v10, v10, v10 row_shr:1 row_mask:0xf bank_mask:0xf
    s_mul_i32 s13, s13, 1152
    s_nop 0
    v_max_u32_dpp v10, v10, v10 row_shr:2 row_mask:0xf bank_mask:0xf
    s_mov_b32 exec_lo, 0x0
    s_mov_b32 exec_hi, 0xff0000
    v_add_u32 v12, s13, v5
    v_mov_b32 v6, s12
    s_mov_b64 exec, -1
    v_max_u32_dpp v10, v10, v10 row_shr:4 row_mask:0xf bank_mask:0xf
    s_nop 1
    v_max_u32_dpp v10, v10, v10 row_shr:8 row_mask:0xf bank_mask:0xf
    s_nop 1
    v_max_u32_dpp v10, v10, v10 row_bcast:15 row_mask:0xa bank_mask:0xf
    s_nop 1
    v_max_u32_dpp v10, v10, v10 row_bcast:31 row_mask:0xc bank_mask:0xf
    s_nop 0
    v_readlane_b32 s8, v10, 63
    s_add_u32 s12, s12, s8
    s_and_b32 s13, s12, 0x7ff
    s_sub_u32 s13, 2047, s13
    s_mul_i32 s13, s13, 1152
    s_mov_b32 exec_lo, 0x0
    s_mov_b32 exec_hi, 0xff000000
    v_add_u32 v12, s13, v5
    v_mov_b32 v6, s12
    s_mov_b64 exec, -1
    s_mov_b32 s14, 0
SEL_GATHER:
    s_mov_b32 m0, 147712
    s_nop 0
    buffer_load_dwordx4 v12, s[52:55], 0 offen offset:0 lds
    s_mov_b32 m0, 148608
    s_nop 0
    buffer_load_dwordx4 v12, s[52:55], 0 offen offset:128 lds
    s_mov_b32 m0, 149504
    s_nop 0
    buffer_load_dwordx4 v12, s[52:55], 0 offen offset:256 lds
    s_mov_b32 m0, 150400
    s_nop 0
    buffer_load_dwordx4 v12, s[52:55], 0 offen offset:384 lds
    s_mov_b32 m0, 151296
    s_nop 0
    buffer_load_dwordx4 v12, s[52:55], 0 offen offset:512 lds
    s_mov_b32 m0, 152192
    s_nop 0
    buffer_load_dwordx4 v12, s[52:55], 0 offen offset:640 lds
    s_mov_b32 m0, 153088
    s_nop 0
    buffer_load_dwordx4 v12, s[52:55], 0 offen offset:768 lds
    s_mov_b32 m0, 153984
    s_nop 0
    buffer_load_dwordx4 v12, s[52:55], 0 offen offset:896 lds
    s_mov_b32 m0, 154880
    s_nop 0
    buffer_load_dwordx4 v12, s[52:55], 0 offen offset:1024 lds
    v_mov_b32 v13, 1
    s_mov_b64 exec, 1
    ds_add_u32 v1, v13 offset:40
    s_mov_b64 exec, -1
    s_cmp_lg_u32 s14, 0
    s_cbranch_scc1 SEL_OK
    v_sub_u32 v16, v80, v9
    v_sub_u32 v17, v81, v9
    v_sub_u32 v18, v82, v9
    v_sub_u32 v19, v83, v9
    v_sub_u32 v20, v84, v9
    v_sub_u32 v21, v85, v9
    v_sub_u32 v22, v86, v9
    v_sub_u32 v23, v87, v9
    v_sub_u32 v24, v88, v9
    v_sub_u32 v25, v89, v9
    v_sub_u32 v26, v90, v9
    v_sub_u32 v27, v91, v9
    v_sub_u32 v28, v92, v9
    v_sub_u32 v29, v93, v9
    v_sub_u32 v30, v94, v9
    v_sub_u32 v31, v95, v9
    v_sub_u32 v32, v96, v9
    v_sub_u32 v33, v97, v9
    v_sub_u32 v34, v98, v9
    v_sub_u32 v35, v99, v9
    v_sub_u32 v36, v100, v9
    v_sub_u32 v37, v101, v9
    v_sub_u32 v38, v102, v9
    v_sub_u32 v39, v103, v9
    v_sub_u32 v40, v104, v9
    v_sub_u32 v41, v105, v9
    v_sub_u32 v42, v106, v9
    v_sub_u32 v43, v107, v9
    v_sub_u32 v44, v108, v9
    v_sub_u32 v45, v109, v9
    v_sub_u32 v46, v110, v9
    v_sub_u32 v47, v111, v9
    v_max3_u32 v16, v16, v17, v18
    v_max3_u32 v19, v19, v20, v21
    v_max3_u32 v22, v22, v23, v24
    v_max3_u32 v25, v25, v26, v27
    v_max3_u32 v28, v28, v29, v30
    v_max3_u32 v31, v31, v32, v33
    v_max3_u32 v34, v34, v35, v36
    v_max3_u32 v37, v37, v38, v39
    v_max3_u32 v40, v40, v41, v42
    v_max3_u32 v43, v43, v44, v45
    v_max3_u32 v16, v16, v19, v22
    v_max3_u32 v25, v25, v28, v31
    v_max3_u32 v34, v34, v37, v40
    v_max3_u32 v43, v43, v46, v47
    v_max3_u32 v16, v16, v25, v34
    v_max_u32 v16, v16, v43
    v_add_u32 v16, v16, v9
    v_cmp_lt_u32 vcc, s12, v16
    s_cmp_eq_u64 vcc, 0
    s_cbranch_scc1 SEL_OK
    s_waitcnt vmcnt(0)
    s_mov_b32 s12, 0
    s_mov_b64 s[56:57], 0xff
SEL_SLOW:
    v_subrev_u32 v16, s12, v80
    v_subrev_u32 v17, s12, v81
    v_subrev_u32 v18, s12, v82
    v_subrev_u32 v19, s12, v83
    v_subrev_u32 v20, s12, v84
    v_subrev_u32 v21, s12, v85
    v_subrev_u32 v22, s12, v86
    v_subrev_u32 v23, s12, v87
    v_subrev_u32 v24, s12, v88
    v_subrev_u32 v25, s12, v89
    v_subrev_u32 v26, s12, v90
    v_subrev_u32 v27, s12, v91
    v_subrev_u32 v28, s12, v92
    v_subrev_u32 v29, s12, v93
    v_subrev_u32 v30, s12, v94
    v_subrev_u32 v31, s12, v95
    v_subrev_u32 v32, s12, v96
    v_subrev_u32 v33, s12, v97
    v_subrev_u32 v34, s12, v98
    v_subrev_u32 v35, s12, v99
    v_subrev_u32 v36, s12, v100
    v_subrev_u32 v37, s12, v101
    v_subrev_u32 v38, s12, v102
    v_subrev_u32 v39, s12, v103
    v_subrev_u32 v40, s12, v104
    v_subrev_u32 v41, s12, v105
    v_subrev_u32 v42, s12, v106
    v_subrev_u32 v43, s12, v107
    v_subrev_u32 v44, s12, v108
    v_subrev_u32 v45, s12, v109
    v_subrev_u32 v46, s12, v110
    v_subrev_u32 v47, s12, v111
    v_max3_u32 v16, v16, v17, v18
    v_max3_u32 v19, v19, v20, v21
    v_max3_u32 v22, v22, v23, v24
    v_max3_u32 v25, v25, v26, v27
    v_max3_u32 v28, v28, v29, v30
    v_max3_u32 v31, v31, v32, v33
    v_max3_u32 v34, v34, v35, v36
    v_max3_u32 v37, v37, v38, v39
    v_max3_u32 v40, v40, v41, v42
    v_max3_u32 v43, v43, v44, v45
    v_max3_u32 v16, v16, v19, v22
    v_max3_u32 v25, v25, v28, v31
    v_max3_u32 v34, v34, v37, v40
    v_max3_u32 v43, v43, v46, v47
    v_max3_u32 v16, v16, v25, v34
    v_max_u32 v16, v16, v43
    s_nop 1
    v_max_u32_dpp v16, v16, v16 row_shr:1 row_mask:0xf bank_mask:0xf
    s_nop 1
    v_max_u32_dpp v16, v16, v16 row_shr:2 row_mask:0xf bank_mask:0xf
    s_nop 1
    v_max_u32_dpp v16, v16, v16 row_shr:4 row_mask:0xf bank_mask:0xf
    s_nop 1
    v_max_u32_dpp v16, v16, v16 row_shr:8 row_mask:0xf bank_mask:0xf
    s_nop 1
    v_max_u32_dpp v16, v16, v16 row_bcast:15 row_mask:0xa bank_mask:0xf
    s_nop 1
    v_max_u32_dpp v16, v16, v16 row_bcast:31 row_mask:0xc bank_mask:0xf
    s_nop 0
    v_readlane_b32 s8, v16, 63
    s_add_u32 s12, s12, s8
    s_and_b32 s13, s12, 0x7ff
    s_sub_u32 s13, 2047, s13
    s_mul_i32 s13, s13, 1152
    s_mov_b64 exec, s[56:57]
    v_add_u32 v12, s13, v5
    v_mov_b32 v6, s12
    s_mov_b64 exec, -1
    s_lshl_b64 s[56:57], s[56:57], 8
    s_add_u32 s14, s14, 1
    s_cmp_lt_u32 s14, 8
    s_cbranch_scc1 SEL_SLOW
    s_branch SEL_GATHER
SEL_OK:
    s_cmp_lg_u32 s2, 0
    s_cbranch_scc1 SEL_NOPUB
    v_mov_b32 v7, v14
    v_add_u32 v8, 16384, v2
    s_mov_b32 exec_lo, 0x01010101
    s_mov_b32 exec_hi, 0x01010101
    global_store_dwordx2 v8, v[6:7], s[50:51] sc1
    s_mov_b64 exec, 1
    global_store_dword v8, v14, s[50:51] offset:256 sc1
    s_mov_b64 exec, -1
    s_waitcnt vmcnt(2)
    s_branch SEL_END
SEL_NOPUB:
    s_waitcnt vmcnt(0)
SEL_END:
    v_mov_b32 v8, 3
    ds_write_b32 v1, v8 offset:84
    s_endpgm
F_COMP:
F_COMP2:
    s_and_b32 s12, s3, 3
    v_lshrrev_b32 v5, 2, v3
    v_bfe_u32 v7, v3, 3, 1
    v_and_b32 v13, 1, v4
    v_lshl_or_b32 v14, v13, 1, v7
    v_and_b32 v15, 7, v3
    v_mul_u32_u24 v16, 144, v15
    v_add_u32 v16, 156928, v16
    s_mov_b32 s56, 0xff00ff00
    s_mov_b32 s57, 0xff00ff00
    s_lshr_b32 s8, s3, 2
    s_cmp_lg_u32 s8, 1
    s_cbranch_scc1 F_DOWN
    v_bfe_u32 v6, v3, 1, 1
    v_lshl_or_b32 v8, v6, 2, v14
    v_xor_b32 v8, s12, v8
    v_lshlrev_b32 v8, 4, v8
    v_lshl_add_u32 v8, v5, 7, v8
    v_lshl_add_u32 v8, v6, 10, v8
    v_lshl_add_u32 v8, v4, 11, v8
    v_and_b32 v9, 1, v3
    v_lshl_add_u32 v8, v9, 3, v8
    v_xor_b32 v9, 64, v8
    v_add_u32 v10, 49408, v8
    v_add_u32 v11, 49408, v9
    v_lshlrev_b32 v6, 2, v13
    v_lshrrev_b32 v5, 1, v4
    v_add_u32 v6, v6, v5
    v_lshl_add_u32 v6, v7, 5, v6
    s_lshl_b32 s8, s12, 3
    v_add_lshl_u32 v6, v6, s8, 1
    v_add_u32 v5, v6, v16
    v_and_b32 v6, 6, v3
    v_xor_b32 v6, v6, v4
    v_lshlrev_b32 v6, 4, v6
    v_lshl_add_u32 v6, v15, 7, v6
    v_add_u32 v6, 147712, v6
    v_xor_b32 v7, 64, v6
    s_mov_b32 s9, 0
SP_26:
    ds_read_b32 v12, v1 offset:16
    s_waitcnt lgkmcnt(0)
    v_readfirstlane_b32 s8, v12
    s_add_u32 s9, s9, 1
    s_cmp_ge_u32 s8, 3
    s_cbranch_scc1 SP_26_D
    s_sleep 1
    s_cmp_lt_u32 s9, 524288
    s_cbranch_scc1 SP_26
SP_26_D:
    ds_read_b64_tr_b16 v[24:25], v8 offset:256
    ds_read_b64_tr_b16 v[26:27], v8 offset:768
    ds_read_b64_tr_b16 v[28:29], v9 offset:256
    ds_read_b64_tr_b16 v[30:31], v9 offset:768
    ds_read_b64_tr_b16 v[32:33], v8 offset:8448
    ds_read_b64_tr_b16 v[34:35], v8 offset:8960
    ds_read_b64_tr_b16 v[36:37], v9 offset:8448
    ds_read_b64_tr_b16 v[38:39], v9 offset:8960
    ds_read_b64_tr_b16 v[40:41], v8 offset:16640
    ds_read_b64_tr_b16 v[42:43], v8 offset:17152
    ds_read_b64_tr_b16 v[44:45], v9 offset:16640
    ds_read_b64_tr_b16 v[46:47], v9 offset:17152
    s_waitcnt lgkmcnt(0)
    v_mov_b32 v12, 1
    s_mov_b64 exec, 1
    ds_add_u32 v1, v12 offset:48
    s_mov_b64 exec, -1
    s_mov_b32 s9, 0
SP_27:
    ds_read_b32 v12, v1 offset:20
    s_waitcnt lgkmcnt(0)
    v_readfirstlane_b32 s8, v12
    s_add_u32 s9, s9, 1
    s_cmp_ge_u32 s8, 3
    s_cbranch_scc1 SP_27_D
    s_sleep 1
    s_cmp_lt_u32 s9, 524288
    s_cbranch_scc1 SP_27
SP_27_D:
    ds_read_b64_tr_b16 v[48:49], v8 offset:24832
    ds_read_b64_tr_b16 v[50:51], v8 offset:25344
    ds_read_b64_tr_b16 v[52:53], v9 offset:24832
    ds_read_b64_tr_b16 v[54:55], v9 offset:25344
    ds_read_b64_tr_b16 v[56:57], v8 offset:33024
    ds_read_b64_tr_b16 v[58:59], v8 offset:33536
    ds_read_b64_tr_b16 v[60:61], v9 offset:33024
    ds_read_b64_tr_b16 v[62:63], v9 offset:33536
    ds_read_b64_tr_b16 v[64:65], v8 offset:41216
    ds_read_b64_tr_b16 v[66:67], v8 offset:41728
    ds_read_b64_tr_b16 v[68:69], v9 offset:41216
    ds_read_b64_tr_b16 v[70:71], v9 offset:41728
    s_waitcnt lgkmcnt(0)
    v_mov_b32 v12, 1
    s_mov_b64 exec, 1
    ds_add_u32 v1, v12 offset:52
    s_mov_b64 exec, -1
    s_mov_b32 s9, 0
SP_28:
    ds_read_b32 v12, v1 offset:24
    s_waitcnt lgkmcnt(0)
    v_readfirstlane_b32 s8, v12
    s_add_u32 s9, s9, 1
    s_cmp_ge_u32 s8, 3
    s_cbranch_scc1 SP_28_D
    s_sleep 1
    s_cmp_lt_u32 s9, 524288
    s_cbranch_scc1 SP_28
SP_28_D:
    ds_read_b64_tr_b16 v[72:73], v10 offset:0
    ds_read_b64_tr_b16 v[74:75], v10 offset:512
    ds_read_b64_tr_b16 v[76:77], v11 offset:0
    ds_read_b64_tr_b16 v[78:79], v11 offset:512
    ds_read_b64_tr_b16 v[80:81], v10 offset:8192
    ds_read_b64_tr_b16 v[82:83], v10 offset:8704
    ds_read_b64_tr_b16 v[84:85], v11 offset:8192
    ds_read_b64_tr_b16 v[86:87], v11 offset:8704
    ds_read_b64_tr_b16 v[88:89], v10 offset:16384
    ds_read_b64_tr_b16 v[90:91], v10 offset:16896
    ds_read_b64_tr_b16 v[92:93], v11 offset:16384
    ds_read_b64_tr_b16 v[94:95], v11 offset:16896
    s_waitcnt lgkmcnt(0)
    v_mov_b32 v12, 1
    s_mov_b64 exec, 1
    ds_add_u32 v1, v12 offset:56
    s_mov_b64 exec, -1
    s_mov_b32 s9, 0
SP_29:
    ds_read_b32 v12, v1 offset:28
    s_waitcnt lgkmcnt(0)
    v_readfirstlane_b32 s8, v12
    s_add_u32 s9, s9, 1
    s_cmp_ge_u32 s8, 3
    s_cbranch_scc1 SP_29_D
    s_sleep 1
    s_cmp_lt_u32 s9, 524288
    s_cbranch_scc1 SP_29
SP_29_D:
    ds_read_b64_tr_b16 v[96:97], v8 offset:256
    ds_read_b64_tr_b16 v[98:99], v8 offset:768
    ds_read_b64_tr_b16 v[100:101], v9 offset:256
    ds_read_b64_tr_b16 v[102:103], v9 offset:768
    ds_read_b64_tr_b16 v[104:105], v8 offset:8448
    ds_read_b64_tr_b16 v[106:107], v8 offset:8960
    ds_read_b64_tr_b16 v[108:109], v9 offset:8448
    ds_read_b64_tr_b16 v[110:111], v9 offset:8960
    ds_read_b64_tr_b16 v[112:113], v8 offset:16640
    ds_read_b64_tr_b16 v[114:115], v8 offset:17152
    ds_read_b64_tr_b16 v[116:117], v9 offset:16640
    ds_read_b64_tr_b16 v[118:119], v9 offset:17152
    s_mov_b32 s9, 0
SP_30:
    ds_read_b32 v12, v1 offset:32
    s_waitcnt lgkmcnt(0)
    v_readfirstlane_b32 s8, v12
    s_add_u32 s9, s9, 1
    s_cmp_ge_u32 s8, 3
    s_cbranch_scc1 SP_30_D
    s_sleep 1
    s_cmp_lt_u32 s9, 524288
    s_cbranch_scc1 SP_30
SP_30_D:
    ds_read_b64_tr_b16 v[120:121], v8 offset:24832
    ds_read_b64_tr_b16 v[122:123], v8 offset:25344
    ds_read_b64_tr_b16 v[124:125], v9 offset:24832
    ds_read_b64_tr_b16 v[126:127], v9 offset:25344
    ds_read_b64_tr_b16 v[128:129], v8 offset:33024
    ds_read_b64_tr_b16 v[130:131], v8 offset:33536
    ds_read_b64_tr_b16 v[132:133], v9 offset:33024
    ds_read_b64_tr_b16 v[134:135], v9 offset:33536
    ds_read_b64_tr_b16 v[136:137], v8 offset:41216
    ds_read_b64_tr_b16 v[138:139], v8 offset:41728
    ds_read_b64_tr_b16 v[140:141], v9 offset:41216
    ds_read_b64_tr_b16 v[142:143], v9 offset:41728
    s_mov_b32 s9, 0
SP_31:
    ds_read_b32 v12, v1 offset:36
    s_waitcnt lgkmcnt(0)
    v_readfirstlane_b32 s8, v12
    s_add_u32 s9, s9, 1
    s_cmp_ge_u32 s8, 3
    s_cbranch_scc1 SP_31_D
    s_sleep 1
    s_cmp_lt_u32 s9, 524288
    s_cbranch_scc1 SP_31
SP_31_D:
    ds_read_b64_tr_b16 v[144:145], v10 offset:0
    ds_read_b64_tr_b16 v[146:147], v10 offset:512
    ds_read_b64_tr_b16 v[148:149], v11 offset:0
    ds_read_b64_tr_b16 v[150:151], v11 offset:512
    ds_read_b64_tr_b16 v[152:153], v10 offset:8192
    ds_read_b64_tr_b16 v[154:155], v10 offset:8704
    ds_read_b64_tr_b16 v[156:157], v11 offset:8192
    ds_read_b64_tr_b16 v[158:159], v11 offset:8704
    ds_read_b64_tr_b16 v[160:161], v10 offset:16384
    ds_read_b64_tr_b16 v[162:163], v10 offset:16896
    ds_read_b64_tr_b16 v[164:165], v11 offset:16384
    ds_read_b64_tr_b16 v[166:167], v11 offset:16896
    s_setprio 3
    s_mov_b32 s9, 0
SP_32:
    ds_read_b32 v12, v1 offset:84
    s_waitcnt lgkmcnt(0)
    v_readfirstlane_b32 s8, v12
    s_add_u32 s9, s9, 1
    s_cmp_ge_u32 s8, 1
    s_cbranch_scc1 SP_32_D
    s_cmp_lt_u32 s9, 524288
    s_cbranch_scc1 SP_32
SP_32_D:
    ds_read_b128 v[16:19], v6 offset:0
    ds_read_b128 v[20:23], v7 offset:0
    s_waitcnt lgkmcnt(1)
    v_mfma_f32_16x16x32_bf16 v[8:11], v[24:27], v[16:19], 0
    ds_read_b128 v[24:27], v6 offset:1024
    v_mfma_f32_16x16x32_bf16 v[12:15], v[28:31], v[16:19], 0
    ds_read_b128 v[28:31], v7 offset:1024
    s_waitcnt lgkmcnt(2)
    v_mfma_f32_16x16x32_bf16 v[8:11], v[32:35], v[20:23], v[8:11]
    ds_read_b128 v[32:35], v6 offset:2048
    v_mfma_f32_16x16x32_bf16 v[12:15], v[36:39], v[20:23], v[12:15]
    ds_read_b128 v[36:39], v7 offset:2048
    s_waitcnt lgkmcnt(3)
    v_mfma_f32_16x16x32_bf16 v[8:11], v[40:43], v[24:27], v[8:11]
    ds_read_b128 v[40:43], v6 offset:3072
    v_mfma_f32_16x16x32_bf16 v[12:15], v[44:47], v[24:27], v[12:15]
    ds_read_b128 v[44:47], v7 offset:3072
    s_waitcnt lgkmcnt(4)
    v_mfma_f32_16x16x32_bf16 v[8:11], v[48:51], v[28:31], v[8:11]
    ds_read_b128 v[48:51], v6 offset:4096
    v_mfma_f32_16x16x32_bf16 v[12:15], v[52:55], v[28:31], v[12:15]
    ds_read_b128 v[52:55], v7 offset:4096
    s_waitcnt lgkmcnt(5)
    v_mfma_f32_16x16x32_bf16 v[8:11], v[56:59], v[32:35], v[8:11]
    ds_read_b128 v[56:59], v6 offset:5120
    v_mfma_f32_16x16x32_bf16 v[12:15], v[60:63], v[32:35], v[12:15]
    ds_read_b128 v[60:63], v7 offset:5120
    s_waitcnt lgkmcnt(6)
    v_mfma_f32_16x16x32_bf16 v[8:11], v[64:67], v[36:39], v[8:11]
    ds_read_b128 v[64:67], v6 offset:6144
    v_mfma_f32_16x16x32_bf16 v[12:15], v[68:71], v[36:39], v[12:15]
    ds_read_b128 v[68:71], v7 offset:6144
    s_waitcnt lgkmcnt(7)
    v_mfma_f32_16x16x32_bf16 v[8:11], v[72:75], v[40:43], v[8:11]
    ds_read_b128 v[72:75], v6 offset:7168
    v_mfma_f32_16x16x32_bf16 v[12:15], v[76:79], v[40:43], v[12:15]
    ds_read_b128 v[76:79], v7 offset:7168
    s_waitcnt lgkmcnt(8)
    v_mfma_f32_16x16x32_bf16 v[8:11], v[80:83], v[44:47], v[8:11]
    ds_read_b128 v[80:83], v6 offset:8192
    v_mfma_f32_16x16x32_bf16 v[12:15], v[84:87], v[44:47], v[12:15]
    ds_read_b128 v[84:87], v7 offset:8192
    s_waitcnt lgkmcnt(9)
    v_mfma_f32_16x16x32_bf16 v[8:11], v[88:91], v[48:51], v[8:11]
    v_mfma_f32_16x16x32_bf16 v[12:15], v[92:95], v[48:51], v[12:15]
    s_waitcnt lgkmcnt(8)
    v_mfma_f32_16x16x32_bf16 v[8:11], v[96:99], v[52:55], v[8:11]
    v_mfma_f32_16x16x32_bf16 v[12:15], v[100:103], v[52:55], v[12:15]
    s_waitcnt lgkmcnt(7)
    v_mfma_f32_16x16x32_bf16 v[8:11], v[104:107], v[56:59], v[8:11]
    v_mfma_f32_16x16x32_bf16 v[12:15], v[108:111], v[56:59], v[12:15]
    s_waitcnt lgkmcnt(6)
    v_mfma_f32_16x16x32_bf16 v[8:11], v[112:115], v[60:63], v[8:11]
    v_mfma_f32_16x16x32_bf16 v[12:15], v[116:119], v[60:63], v[12:15]
    s_waitcnt lgkmcnt(5)
    v_mfma_f32_16x16x32_bf16 v[8:11], v[120:123], v[64:67], v[8:11]
    v_mfma_f32_16x16x32_bf16 v[12:15], v[124:127], v[64:67], v[12:15]
    s_waitcnt lgkmcnt(4)
    v_mfma_f32_16x16x32_bf16 v[8:11], v[128:131], v[68:71], v[8:11]
    v_mfma_f32_16x16x32_bf16 v[12:15], v[132:135], v[68:71], v[12:15]
    s_waitcnt lgkmcnt(3)
    v_mfma_f32_16x16x32_bf16 v[8:11], v[136:139], v[72:75], v[8:11]
    v_mfma_f32_16x16x32_bf16 v[12:15], v[140:143], v[72:75], v[12:15]
    s_waitcnt lgkmcnt(2)
    v_mfma_f32_16x16x32_bf16 v[8:11], v[144:147], v[76:79], v[8:11]
    v_mfma_f32_16x16x32_bf16 v[12:15], v[148:151], v[76:79], v[12:15]
    s_waitcnt lgkmcnt(1)
    v_mfma_f32_16x16x32_bf16 v[8:11], v[152:155], v[80:83], v[8:11]
    v_mfma_f32_16x16x32_bf16 v[12:15], v[156:159], v[80:83], v[12:15]
    s_waitcnt lgkmcnt(0)
    v_mfma_f32_16x16x32_bf16 v[8:11], v[160:163], v[84:87], v[8:11]
    v_mfma_f32_16x16x32_bf16 v[12:15], v[164:167], v[84:87], v[12:15]
    s_nop 7
    v_cndmask_b32 v8, v8, v12, s[56:57]
    v_cndmask_b32 v9, v9, v13, s[56:57]
    v_cndmask_b32 v10, v10, v14, s[56:57]
    v_cndmask_b32 v11, v11, v15, s[56:57]
    v_permlane32_swap_b32 v8, v9
    s_nop 0
    v_permlane32_swap_b32 v10, v11
    v_cvt_pk_bf16_f32 v9, v8, v9
    v_cvt_pk_bf16_f32 v11, v10, v11
    v_lshlrev_b32 v8, 16, v9
    v_lshlrev_b32 v10, 16, v11
    v_mul_f32 v12, 0xbfb8aa3b, v8
    v_mul_f32 v13, 0xbfb8aa3b, v10
    v_exp_f32 v12, v12
    v_exp_f32 v13, v13
    v_and_b32 v9, 0xffff0000, v9
    v_and_b32 v11, 0xffff0000, v11
    v_add_f32 v12, 1.0, v12
    v_add_f32 v13, 1.0, v13
    v_rcp_f32 v12, v12
    v_rcp_f32 v13, v13
    v_mul_f32 v8, v8, v12
    v_mul_f32 v10, v10, v13
    v_cvt_pk_bf16_f32 v8, v8, v8
    v_cvt_pk_bf16_f32 v10, v10, v10
    v_and_b32 v8, 0xffff0000, v8
    v_and_b32 v10, 0xffff0000, v10
    v_mul_f32 v8, v8, v9
    v_mul_f32 v10, v10, v11
    v_cvt_pk_bf16_f32 v8, v8, v10
    ds_write_b16 v5, v8
    ds_write_b16_d16_hi v5, v8 offset:4
    s_waitcnt lgkmcnt(0)
    s_barrier
    s_endpgm
F_DOWN:
    v_lshl_add_u32 v10, v4, 4, v16
    v_mul_u32_u24 v8, 9216, v4
    s_mul_i32 s13, s7, 73728
    s_mov_b32 s60, 0x7060500
    s_mov_b32 s61, 0x7060501
    s_mov_b32 s62, 0x7060502
    s_mov_b32 s63, 0x7060503
    s_mov_b32 s64, 0x05040100
    s_mov_b32 s65, 0x07060302
    s_lshl_b32 s14, s7, 7
    s_add_u32 s14, s14, 32768
    v_lshl_add_u32 v11, v15, 4, s14
    s_waitcnt lgkmcnt(0)
    s_mov_b32 s52, s50
    s_mov_b32 s53, s51
    s_mov_b32 s54, 268435456
    s_mov_b32 s55, 0x20000
    s_mov_b32 s68, s42
    s_mov_b32 s69, s43
    s_mov_b32 s70, 5308416
    s_mov_b32 s71, 0x20000
    s_cmp_eq_u32 s3, 9
    s_cbranch_scc1 F_DN2
    v_lshl_add_u32 v8, v3, 4, v8
    s_lshl_b32 s8, s3, 8
    s_add_u32 s13, s13, s8
    s_lshl_b32 s8, s3, 5
    v_lshl_add_u32 v6, v4, 3, v7
    v_add_u32 v6, s8, v6
    v_mul_u32_u24 v6, 9216, v6
    v_add_u32 v11, v6, v11
    s_mov_b32 s9, 0
SP_33:
    ds_read_b32 v17, v1 offset:8
    s_waitcnt lgkmcnt(0)
    v_readfirstlane_b32 s8, v17
    s_add_u32 s9, s9, 1
    s_cmp_lg_u32 s8, 0
    s_cbranch_scc1 SP_33_D
    s_sleep 2
    s_cmp_lt_u32 s9, 524288
    s_cbranch_scc1 SP_33
SP_33_D:
    s_mov_b32 s9, 0
SP_34:
    ds_read_b32 v12, v1 offset:40
    s_waitcnt lgkmcnt(0)
    v_readfirstlane_b32 s8, v12
    s_add_u32 s9, s9, 1
    s_cmp_ge_u32 s8, 3
    s_cbranch_scc1 SP_34_D
    s_sleep 1
    s_cmp_lt_u32 s9, 524288
    s_cbranch_scc1 SP_34
SP_34_D:
    s_setprio 2
    buffer_load_dwordx4 v[24:27], v8, s[68:71], s13 offen offset:0
    buffer_load_dwordx4 v[28:31], v8, s[68:71], s13 offen offset:1152
    buffer_load_dwordx4 v[32:35], v8, s[68:71], s13 offen offset:2304
    buffer_load_dwordx4 v[36:39], v8, s[68:71], s13 offen offset:3456
    s_add_u32 s13, s13, 4608
    s_mov_b32 s9, 0
SP_35:
    ds_read_b32 v12, v1 offset:40
    s_waitcnt lgkmcnt(0)
    v_readfirstlane_b32 s8, v12
    s_add_u32 s9, s9, 1
    s_cmp_ge_u32 s8, 4
    s_cbranch_scc1 SP_35_D
    s_sleep 1
    s_cmp_lt_u32 s9, 524288
    s_cbranch_scc1 SP_35
SP_35_D:
    buffer_load_dwordx4 v[40:43], v8, s[68:71], s13 offen offset:0
    buffer_load_dwordx4 v[44:47], v8, s[68:71], s13 offen offset:1152
    buffer_load_dwordx4 v[48:51], v8, s[68:71], s13 offen offset:2304
    buffer_load_dwordx4 v[52:55], v8, s[68:71], s13 offen offset:3456
    s_add_u32 s13, s13, 32256
    buffer_load_dwordx4 v[88:91], v8, s[68:71], s13 offen offset:0
    buffer_load_dwordx4 v[92:95], v8, s[68:71], s13 offen offset:1152
    buffer_load_dwordx4 v[96:99], v8, s[68:71], s13 offen offset:2304
    buffer_load_dwordx4 v[100:103], v8, s[68:71], s13 offen offset:3456
    s_add_u32 s13, s13, 4608
    buffer_load_dwordx4 v[104:107], v8, s[68:71], s13 offen offset:0
    buffer_load_dwordx4 v[108:111], v8, s[68:71], s13 offen offset:1152
    buffer_load_dwordx4 v[112:115], v8, s[68:71], s13 offen offset:2304
    buffer_load_dwordx4 v[116:119], v8, s[68:71], s13 offen offset:3456
    s_add_u32 s13, s13, 32256
    s_waitcnt vmcnt(14)
    v_perm_b32 v56, v28, v24, s64
    v_perm_b32 v60, v28, v24, s65
    v_perm_b32 v64, v29, v25, s64
    v_perm_b32 v68, v29, v25, s65
    v_perm_b32 v72, v30, v26, s64
    v_perm_b32 v76, v30, v26, s65
    v_perm_b32 v80, v31, v27, s64
    v_perm_b32 v84, v31, v27, s65
    s_waitcnt vmcnt(12)
    v_perm_b32 v57, v36, v32, s64
    v_perm_b32 v61, v36, v32, s65
    v_perm_b32 v65, v37, v33, s64
    v_perm_b32 v69, v37, v33, s65
    v_perm_b32 v73, v38, v34, s64
    v_perm_b32 v77, v38, v34, s65
    v_perm_b32 v81, v39, v35, s64
    v_perm_b32 v85, v39, v35, s65
    s_waitcnt vmcnt(10)
    v_perm_b32 v58, v44, v40, s64
    v_perm_b32 v62, v44, v40, s65
    v_perm_b32 v66, v45, v41, s64
    v_perm_b32 v70, v45, v41, s65
    v_perm_b32 v74, v46, v42, s64
    v_perm_b32 v78, v46, v42, s65
    v_perm_b32 v82, v47, v43, s64
    v_perm_b32 v86, v47, v43, s65
    s_waitcnt vmcnt(8)
    v_perm_b32 v59, v52, v48, s64
    v_perm_b32 v63, v52, v48, s65
    v_perm_b32 v67, v53, v49, s64
    v_perm_b32 v71, v53, v49, s65
    v_perm_b32 v75, v54, v50, s64
    v_perm_b32 v79, v54, v50, s65
    v_perm_b32 v83, v55, v51, s64
    v_perm_b32 v87, v55, v51, s65
    s_waitcnt vmcnt(6)
    v_perm_b32 v24, v92, v88, s64
    v_perm_b32 v28, v92, v88, s65
    v_perm_b32 v32, v93, v89, s64
    v_perm_b32 v36, v93, v89, s65
    v_perm_b32 v40, v94, v90, s64
    v_perm_b32 v44, v94, v90, s65
    v_perm_b32 v48, v95, v91, s64
    v_perm_b32 v52, v95, v91, s65
    s_waitcnt vmcnt(4)
    v_perm_b32 v25, v100, v96, s64
    v_perm_b32 v29, v100, v96, s65
    v_perm_b32 v33, v101, v97, s64
    v_perm_b32 v37, v101, v97, s65
    v_perm_b32 v41, v102, v98, s64
    v_perm_b32 v45, v102, v98, s65
    v_perm_b32 v49, v103, v99, s64
    v_perm_b32 v53, v103, v99, s65
    s_waitcnt vmcnt(2)
    v_perm_b32 v26, v108, v104, s64
    v_perm_b32 v30, v108, v104, s65
    v_perm_b32 v34, v109, v105, s64
    v_perm_b32 v38, v109, v105, s65
    v_perm_b32 v42, v110, v106, s64
    v_perm_b32 v46, v110, v106, s65
    v_perm_b32 v50, v111, v107, s64
    v_perm_b32 v54, v111, v107, s65
    s_waitcnt vmcnt(0)
    v_perm_b32 v27, v116, v112, s64
    v_perm_b32 v31, v116, v112, s65
    v_perm_b32 v35, v117, v113, s64
    v_perm_b32 v39, v117, v113, s65
    v_perm_b32 v43, v118, v114, s64
    v_perm_b32 v47, v118, v114, s65
    v_perm_b32 v51, v119, v115, s64
    v_perm_b32 v55, v119, v115, s65
    s_barrier
    ds_read_b128 v[152:155], v10 offset:0
    ds_read_b128 v[156:159], v10 offset:64
    s_waitcnt lgkmcnt(0)
    v_mfma_f32_16x16x32_bf16 v[120:123], v[56:59], v[152:155], 0
    v_mfma_f32_16x16x32_bf16 v[120:123], v[24:27], v[156:159], v[120:123]
    v_mfma_f32_16x16x32_bf16 v[124:127], v[60:63], v[152:155], 0
    v_mfma_f32_16x16x32_bf16 v[124:127], v[28:31], v[156:159], v[124:127]
    v_mfma_f32_16x16x32_bf16 v[128:131], v[64:67], v[152:155], 0
    v_mfma_f32_16x16x32_bf16 v[128:131], v[32:35], v[156:159], v[128:131]
    v_mfma_f32_16x16x32_bf16 v[132:135], v[68:71], v[152:155], 0
    v_mfma_f32_16x16x32_bf16 v[132:135], v[36:39], v[156:159], v[132:135]
    v_mfma_f32_16x16x32_bf16 v[136:139], v[72:75], v[152:155], 0
    v_mfma_f32_16x16x32_bf16 v[136:139], v[40:43], v[156:159], v[136:139]
    v_mfma_f32_16x16x32_bf16 v[140:143], v[76:79], v[152:155], 0
    v_mfma_f32_16x16x32_bf16 v[140:143], v[44:47], v[156:159], v[140:143]
    v_mfma_f32_16x16x32_bf16 v[144:147], v[80:83], v[152:155], 0
    v_mfma_f32_16x16x32_bf16 v[144:147], v[48:51], v[156:159], v[144:147]
    v_mfma_f32_16x16x32_bf16 v[148:151], v[84:87], v[152:155], 0
    v_mfma_f32_16x16x32_bf16 v[148:151], v[52:55], v[156:159], v[148:151]
    s_nop 1
    v_cndmask_b32 v88, v120, v136, s[56:57]
    s_nop 0
    v_cndmask_b32 v89, v124, v140, s[56:57]
    s_nop 0
    v_cndmask_b32 v90, v128, v144, s[56:57]
    s_nop 0
    v_cndmask_b32 v91, v132, v148, s[56:57]
    v_perm_b32 v88, v88, v17, s60
    v_perm_b32 v89, v89, v17, s61
    v_perm_b32 v90, v90, v17, s62
    v_perm_b32 v91, v91, v17, s63
    s_mov_b32 s12, 0
    buffer_store_dwordx4 v[88:91], v11, s[52:55], s12 offen sc1
    v_cndmask_b32 v92, v121, v137, s[56:57]
    v_cndmask_b32 v93, v125, v141, s[56:57]
    v_cndmask_b32 v94, v129, v145, s[56:57]
    v_cndmask_b32 v95, v133, v149, s[56:57]
    v_perm_b32 v92, v92, v17, s60
    v_perm_b32 v93, v93, v17, s61
    v_perm_b32 v94, v94, v17, s62
    v_perm_b32 v95, v95, v17, s63
    s_mov_b32 s12, 18432
    buffer_store_dwordx4 v[92:95], v11, s[52:55], s12 offen sc1
    v_cndmask_b32 v96, v122, v138, s[56:57]
    v_cndmask_b32 v97, v126, v142, s[56:57]
    v_cndmask_b32 v98, v130, v146, s[56:57]
    v_cndmask_b32 v99, v134, v150, s[56:57]
    v_perm_b32 v96, v96, v17, s60
    v_perm_b32 v97, v97, v17, s61
    v_perm_b32 v98, v98, v17, s62
    v_perm_b32 v99, v99, v17, s63
    s_mov_b32 s12, 36864
    buffer_store_dwordx4 v[96:99], v11, s[52:55], s12 offen sc1
    v_cndmask_b32 v100, v123, v139, s[56:57]
    v_cndmask_b32 v101, v127, v143, s[56:57]
    v_cndmask_b32 v102, v131, v147, s[56:57]
    v_cndmask_b32 v103, v135, v151, s[56:57]
    v_perm_b32 v100, v100, v17, s60
    v_perm_b32 v101, v101, v17, s61
    v_perm_b32 v102, v102, v17, s62
    v_perm_b32 v103, v103, v17, s63
    s_mov_b32 s12, 55296
    buffer_store_dwordx4 v[100:103], v11, s[52:55], s12 offen sc1
    s_endpgm
F_DN2:
    v_lshl_add_u32 v8, v3, 3, v8
    s_add_u32 s13, s13, 1024
    v_lshl_add_u32 v6, v4, 2, v7
    v_add_u32 v6, 128, v6
    v_mul_u32_u24 v6, 9216, v6
    v_add_u32 v11, v6, v11
    s_mov_b32 s9, 0
SP_36:
    ds_read_b32 v17, v1 offset:8
    s_waitcnt lgkmcnt(0)
    v_readfirstlane_b32 s8, v17
    s_add_u32 s9, s9, 1
    s_cmp_lg_u32 s8, 0
    s_cbranch_scc1 SP_36_D
    s_cmp_lt_u32 s9, 524288
    s_cbranch_scc1 SP_36
SP_36_D:
    buffer_load_dwordx2 v[24:25], v8, s[68:71], s13 offen offset:0
    buffer_load_dwordx2 v[26:27], v8, s[68:71], s13 offen offset:1152
    buffer_load_dwordx2 v[28:29], v8, s[68:71], s13 offen offset:2304
    buffer_load_dwordx2 v[30:31], v8, s[68:71], s13 offen offset:3456
    s_add_u32 s13, s13, 4608
    buffer_load_dwordx2 v[32:33], v8, s[68:71], s13 offen offset:0
    buffer_load_dwordx2 v[34:35], v8, s[68:71], s13 offen offset:1152
    buffer_load_dwordx2 v[36:37], v8, s[68:71], s13 offen offset:2304
    buffer_load_dwordx2 v[38:39], v8, s[68:71], s13 offen offset:3456
    s_add_u32 s13, s13, 32256
    buffer_load_dwordx2 v[88:89], v8, s[68:71], s13 offen offset:0
    buffer_load_dwordx2 v[90:91], v8, s[68:71], s13 offen offset:1152
    buffer_load_dwordx2 v[92:93], v8, s[68:71], s13 offen offset:2304
    buffer_load_dwordx2 v[94:95], v8, s[68:71], s13 offen offset:3456
    s_add_u32 s13, s13, 4608
    buffer_load_dwordx2 v[96:97], v8, s[68:71], s13 offen offset:0
    buffer_load_dwordx2 v[98:99], v8, s[68:71], s13 offen offset:1152
    buffer_load_dwordx2 v[100:101], v8, s[68:71], s13 offen offset:2304
    buffer_load_dwordx2 v[102:103], v8, s[68:71], s13 offen offset:3456
    s_add_u32 s13, s13, 32256
    s_waitcnt vmcnt(14)
    v_perm_b32 v56, v26, v24, s64
    v_perm_b32 v60, v26, v24, s65
    v_perm_b32 v64, v27, v25, s64
    v_perm_b32 v68, v27, v25, s65
    s_waitcnt vmcnt(12)
    v_perm_b32 v57, v30, v28, s64
    v_perm_b32 v61, v30, v28, s65
    v_perm_b32 v65, v31, v29, s64
    v_perm_b32 v69, v31, v29, s65
    s_waitcnt vmcnt(10)
    v_perm_b32 v58, v34, v32, s64
    v_perm_b32 v62, v34, v32, s65
    v_perm_b32 v66, v35, v33, s64
    v_perm_b32 v70, v35, v33, s65
    s_waitcnt vmcnt(8)
    v_perm_b32 v59, v38, v36, s64
    v_perm_b32 v63, v38, v36, s65
    v_perm_b32 v67, v39, v37, s64
    v_perm_b32 v71, v39, v37, s65
    s_waitcnt vmcnt(6)
    v_perm_b32 v24, v90, v88, s64
    v_perm_b32 v28, v90, v88, s65
    v_perm_b32 v32, v91, v89, s64
    v_perm_b32 v36, v91, v89, s65
    s_waitcnt vmcnt(4)
    v_perm_b32 v25, v94, v92, s64
    v_perm_b32 v29, v94, v92, s65
    v_perm_b32 v33, v95, v93, s64
    v_perm_b32 v37, v95, v93, s65
    s_waitcnt vmcnt(2)
    v_perm_b32 v26, v98, v96, s64
    v_perm_b32 v30, v98, v96, s65
    v_perm_b32 v34, v99, v97, s64
    v_perm_b32 v38, v99, v97, s65
    s_waitcnt vmcnt(0)
    v_perm_b32 v27, v102, v100, s64
    v_perm_b32 v31, v102, v100, s65
    v_perm_b32 v35, v103, v101, s64
    v_perm_b32 v39, v103, v101, s65
    s_barrier
    ds_read_b128 v[152:155], v10 offset:0
    ds_read_b128 v[156:159], v10 offset:64
    s_waitcnt lgkmcnt(0)
    v_mfma_f32_16x16x32_bf16 v[120:123], v[56:59], v[152:155], 0
    v_mfma_f32_16x16x32_bf16 v[120:123], v[24:27], v[156:159], v[120:123]
    v_mfma_f32_16x16x32_bf16 v[124:127], v[60:63], v[152:155], 0
    v_mfma_f32_16x16x32_bf16 v[124:127], v[28:31], v[156:159], v[124:127]
    v_mfma_f32_16x16x32_bf16 v[128:131], v[64:67], v[152:155], 0
    v_mfma_f32_16x16x32_bf16 v[128:131], v[32:35], v[156:159], v[128:131]
    v_mfma_f32_16x16x32_bf16 v[132:135], v[68:71], v[152:155], 0
    v_mfma_f32_16x16x32_bf16 v[132:135], v[36:39], v[156:159], v[132:135]
    s_nop 1
    v_cndmask_b32 v88, v120, v121, s[56:57]
    s_nop 0
    v_cndmask_b32 v89, v124, v125, s[56:57]
    s_nop 0
    v_cndmask_b32 v90, v128, v129, s[56:57]
    s_nop 0
    v_cndmask_b32 v91, v132, v133, s[56:57]
    v_perm_b32 v88, v88, v17, s60
    v_perm_b32 v89, v89, v17, s61
    v_perm_b32 v90, v90, v17, s62
    v_perm_b32 v91, v91, v17, s63
    s_mov_b32 s12, 0
    buffer_store_dwordx4 v[88:91], v11, s[52:55], s12 offen sc1
    v_cndmask_b32 v92, v122, v123, s[56:57]
    v_cndmask_b32 v93, v126, v127, s[56:57]
    v_cndmask_b32 v94, v130, v131, s[56:57]
    v_cndmask_b32 v95, v134, v135, s[56:57]
    v_perm_b32 v92, v92, v17, s60
    v_perm_b32 v93, v93, v17, s61
    v_perm_b32 v94, v94, v17, s62
    v_perm_b32 v95, v95, v17, s63
    s_mov_b32 s12, 18432
    buffer_store_dwordx4 v[92:95], v11, s[52:55], s12 offen sc1
    s_endpgm
K_END:
    s_endpgm
CODE_END:
.section .rodata,"a"
.p2align 6
.amdhsa_kernel k1_kernel
  .amdhsa_next_free_vgpr 168
  .amdhsa_next_free_sgpr 102
  .amdhsa_accum_offset 168
  .amdhsa_group_segment_fixed_size 0
  .amdhsa_kernarg_size 144
  .amdhsa_user_sgpr_count 2
  .amdhsa_user_sgpr_kernarg_segment_ptr 1
  .amdhsa_system_sgpr_workgroup_id_x 1
.end_amdhsa_kernel
```

```asm
; @launch kernel=k1_kernel grid=(256,1,1) block=(768,1,1) lds=163840
.amdgcn_target "amdgcn-amd-amdhsa--gfx950"
.text
.p2align 8
.globl k1_kernel
.type k1_kernel,@function
k1_kernel:
    v_lshrrev_b32 v1, 6, v0
    s_cmp_ge_u32 s2, 256
    v_readfirstlane_b32 s3, v1
    s_cbranch_scc1 K_END
    v_and_b32 v2, 63, v0
    v_mov_b32 v1, 0
    s_cmp_lg_u32 s3, 1
    s_cbranch_scc1 K_NOZ
    v_lshlrev_b32 v3, 2, v2
    ds_write_b32 v3, v1
    s_waitcnt lgkmcnt(0)
K_NOZ:
    s_load_dwordx16 s[16:31], s[0:1], 0
    s_load_dwordx16 s[32:47], s[0:1], 64
    s_load_dwordx4 s[48:51], s[0:1], 128
    s_lshr_b32 s5, s2, 3
    s_lshl_b32 s8, s3, 8
    s_add_u32 s8, s8, s5
    s_cmp_lg_u32 s8, 9
    s_cbranch_scc1 K_NOCPF
    s_getpc_b64 s[8:9]
    s_and_b32 s8, s8, 0xffffff00
    v_lshlrev_b32 v8, 7, v2
    v_min_u32 v9, CODE_END-k1_kernel-4, v8
    global_load_dword v160, v9, s[8:9]
    v_add_u32 v8, 8192, v8
    v_min_u32 v9, CODE_END-k1_kernel-4, v8
    global_load_dword v161, v9, s[8:9]
    v_add_u32 v8, 8192, v8
    v_min_u32 v9, CODE_END-k1_kernel-4, v8
    global_load_dword v162, v9, s[8:9]
    v_add_u32 v8, 8192, v8
    v_min_u32 v9, CODE_END-k1_kernel-4, v8
    global_load_dword v163, v9, s[8:9]
    v_add_u32 v8, 8192, v8
K_NOCPF:
    v_and_b32 v3, 15, v2
    v_lshrrev_b32 v4, 4, v2
    s_and_b32 s4, s2, 7
    s_barrier
    s_cmp_eq_u32 s3, 8
    s_cbranch_scc1 ROUTER
    s_cmp_lt_u32 s5, 14
    s_cbranch_scc1 K_OTHER
    s_mul_i32 s7, s4, 18
    s_add_u32 s7, s7, s5
    s_sub_u32 s7, s7, 14
    s_cmp_ge_u32 s3, 8
    s_cbranch_scc1 K_CIO
C_KGEN:
    s_and_b32 s12, s3, 3
    s_lshr_b32 s13, s3, 2
    s_lshl_b32 s14, s7, 2
    s_add_u32 s14, s14, s12
    s_lshl_b32 s8, s14, 8
    s_lshl_b32 s9, s13, 7
    s_add_u32 s8, s8, s9
    v_lshl_add_u32 v5, v2, 1, s8
    v_mov_b32 v16, 0
    v_mov_b32 v17, 0
    v_mov_b32 v18, 0
    v_mov_b32 v19, 0
    v_mov_b32 v20, 0
    v_mov_b32 v21, 0
    s_lshl_b32 s55, s7, 3
    s_setprio 2
    s_mul_i32 s15, s3, 4608
    s_add_u32 s15, s15, 256
    s_mul_i32 s52, s12, 8960
    s_add_u32 s52, s52, 37120
    s_mul_i32 s53, s12, 4672
    s_add_u32 s53, s53, 72960
    v_mul_u32_u24 v7, 288, v3
    v_lshl_add_u32 v7, v4, 4, v7
    v_add_u32 v7, s15, v7
    s_mov_b32 m0, s15
    s_waitcnt lgkmcnt(0)
    s_load_dwordx2 s[58:59], s[30:31], s55
    global_load_short_d16_hi v16, v5, s[18:19]
    global_load_short_d16_hi v17, v5, s[20:21]
    global_load_short_d16_hi v18, v5, s[22:23]
    global_load_short_d16_hi v19, v5, s[24:25]
    global_load_short_d16_hi v20, v5, s[26:27]
    global_load_short_d16_hi v21, v5, s[28:29]
    s_load_dwordx2 s[68:69], s[32:33], s55
    s_branch C_KBODY
ROUTER:
    s_setprio 3
    v_lshrrev_b32 v5, 3, v2
    v_and_b32 v6, 7, v2
    v_lshlrev_b32 v9, 4, v6
    v_mul_u32_u24 v8, 1152, v5
    s_mul_i32 s8, s2, 9216
    v_add3_u32 v8, v8, v9, s8
    v_lshlrev_b32 v7, 4, v2
    v_min_u32 v10, 7, v2
    v_lshlrev_b32 v10, 4, v10
    s_mov_b32 m0, 147712
    s_waitcnt lgkmcnt(0)
    s_load_dword s10, s[50:51], 16640
    global_load_lds_dwordx4 v8, s[16:17] offset:0
    s_mov_b32 m0, 148608
    s_nop 0
    global_load_lds_dwordx4 v8, s[16:17] offset:128
    s_mov_b32 m0, 149504
    s_nop 0
    global_load_lds_dwordx4 v8, s[16:17] offset:256
    s_mov_b32 m0, 150400
    s_nop 0
    global_load_lds_dwordx4 v8, s[16:17] offset:384
    s_mov_b32 m0, 151296
    s_nop 0
    global_load_lds_dwordx4 v8, s[16:17] offset:512
    s_mov_b32 m0, 152192
    s_nop 0
    global_load_lds_dwordx4 v8, s[16:17] offset:640
    s_mov_b32 m0, 153088
    s_nop 0
    global_load_lds_dwordx4 v8, s[16:17] offset:768
    s_mov_b32 m0, 153984
    s_nop 0
    global_load_lds_dwordx4 v8, s[16:17] offset:896
    s_mov_b32 m0, 154880
    s_nop 0
    global_load_lds_dwordx4 v8, s[16:17] offset:1024
    s_mov_b32 m0, 158080
    s_nop 0
    global_load_lds_dwordx4 v7, s[44:45]
    global_load_lds_dwordx4 v10, s[44:45] offset:1024
    global_load_dwordx4 v[52:55], v9, s[36:37] offset:0
    global_load_dwordx4 v[56:59], v9, s[36:37] offset:128
    global_load_dwordx4 v[60:63], v9, s[36:37] offset:256
    global_load_dwordx4 v[64:67], v9, s[36:37] offset:384
    global_load_dwordx4 v[68:71], v9, s[36:37] offset:512
    global_load_dwordx4 v[72:75], v9, s[36:37] offset:640
    global_load_dwordx4 v[76:79], v9, s[36:37] offset:768
    global_load_dwordx4 v[80:83], v9, s[36:37] offset:896
    global_load_dwordx4 v[84:87], v9, s[36:37] offset:1024
    v_mov_b32 v11, 1
    ds_write_b32 v1, v11 offset:4
    v_add_u32 v7, 147712, v7
    s_lshl_b32 s8, s2, 5
    v_lshl_add_u32 v15, v4, 3, s8
    s_mov_b32 s11, 0xffff
    v_mov_b32 v8, 0
    v_mov_b32 v9, 0
    v_mov_b32 v10, 0
    v_mov_b32 v11, 0
    s_waitcnt lgkmcnt(0)
    s_add_u32 s10, s10, 1
    s_addc_u32 s10, s10, 0
    v_mov_b32 v14, s10
    v_mov_b32 v13, s10
    s_waitcnt vmcnt(9)
    ds_read_b128 v[16:19], v7 offset:0
    ds_read_b128 v[20:23], v7 offset:1024
    ds_read_b128 v[24:27], v7 offset:2048
    ds_read_b128 v[28:31], v7 offset:3072
    ds_read_b128 v[32:35], v7 offset:4096
    ds_read_b128 v[36:39], v7 offset:5120
    ds_read_b128 v[40:43], v7 offset:6144
    ds_read_b128 v[44:47], v7 offset:7168
    ds_read_b128 v[48:51], v7 offset:8192
    ds_write_b32 v1, v14 offset:8
    s_waitcnt vmcnt(8) lgkmcnt(9)
    v_dot2c_f32_bf16 v8, v16, v52
    v_dot2c_f32_bf16 v9, v17, v53
    v_dot2c_f32_bf16 v10, v18, v54
    v_dot2c_f32_bf16 v11, v19, v55
    s_waitcnt vmcnt(7) lgkmcnt(8)
    v_dot2c_f32_bf16 v8, v20, v56
    v_dot2c_f32_bf16 v9, v21, v57
    v_dot2c_f32_bf16 v10, v22, v58
    v_dot2c_f32_bf16 v11, v23, v59
    s_waitcnt vmcnt(6) lgkmcnt(7)
    v_dot2c_f32_bf16 v8, v24, v60
    v_dot2c_f32_bf16 v9, v25, v61
    v_dot2c_f32_bf16 v10, v26, v62
    v_dot2c_f32_bf16 v11, v27, v63
    s_waitcnt vmcnt(5) lgkmcnt(6)
    v_dot2c_f32_bf16 v8, v28, v64
    v_dot2c_f32_bf16 v9, v29, v65
    v_dot2c_f32_bf16 v10, v30, v66
    v_dot2c_f32_bf16 v11, v31, v67
    s_waitcnt vmcnt(4) lgkmcnt(5)
    v_dot2c_f32_bf16 v8, v32, v68
    v_dot2c_f32_bf16 v9, v33, v69
    v_dot2c_f32_bf16 v10, v34, v70
    v_dot2c_f32_bf16 v11, v35, v71
    s_waitcnt vmcnt(3) lgkmcnt(4)
    v_dot2c_f32_bf16 v8, v36, v72
    v_dot2c_f32_bf16 v9, v37, v73
    v_dot2c_f32_bf16 v10, v38, v74
    v_dot2c_f32_bf16 v11, v39, v75
    s_waitcnt vmcnt(2) lgkmcnt(3)
    v_dot2c_f32_bf16 v8, v40, v76
    v_dot2c_f32_bf16 v9, v41, v77
    v_dot2c_f32_bf16 v10, v42, v78
    v_dot2c_f32_bf16 v11, v43, v79
    s_waitcnt vmcnt(1) lgkmcnt(2)
    v_dot2c_f32_bf16 v8, v44, v80
    v_dot2c_f32_bf16 v9, v45, v81
    v_dot2c_f32_bf16 v10, v46, v82
    v_dot2c_f32_bf16 v11, v47, v83
    s_waitcnt vmcnt(0) lgkmcnt(1)
    v_dot2c_f32_bf16 v8, v48, v84
    v_dot2c_f32_bf16 v9, v49, v85
    v_dot2c_f32_bf16 v10, v50, v86
    v_dot2c_f32_bf16 v11, v51, v87
    s_nop 0
    v_add_f32 v8, v8, v9
    s_nop 0
    v_add_f32 v10, v10, v11
    v_add_f32 v8, v8, v10
    s_nop 1
    v_add_f32_dpp v8, v8, v8 quad_perm:[1,0,3,2] row_mask:0xf bank_mask:0xf
    s_nop 1
    v_add_f32_dpp v8, v8, v8 quad_perm:[2,3,0,1] row_mask:0xf bank_mask:0xf
    s_nop 1
    v_add_f32_dpp v8, v8, v8 row_half_mirror row_mask:0xf bank_mask:0xf
    v_cvt_pk_bf16_f32 v8, v8, v8
    v_ashrrev_i32 v9, 31, v8
    v_or_b32 v9, 0x80008000, v9
    v_xor_b32 v8, v8, v9
    s_nop 1
    v_mov_b32_dpp v9, v8 row_ror:8 row_mask:0xf bank_mask:0xf
    s_mov_b32 exec_lo, 0x10001
    s_mov_b32 exec_hi, 0x10001
    v_bfi_b32 v12, s11, v8, v9
    global_store_dwordx2 v15, v[12:13], s[50:51] sc1
    s_mov_b64 exec, -1
    ds_write_b32 v1, v14 offset:0
    s_cmp_ge_u32 s5, 14
    s_cbranch_scc1 C_IO
    s_cmp_lt_u32 s5, 9
    s_cbranch_scc1 SELECT
    s_endpgm
K_OTHER:
    s_mul_i32 s7, s4, 9
    s_add_u32 s7, s7, s5
    s_mov_b32 s12, s3
    s_cmp_lt_u32 s3, 2
    s_cbranch_scc1 GATE
    s_cmp_ge_u32 s5, 9
    s_cbranch_scc1 HELPER
    s_cmp_lt_u32 s3, 8
    s_cbranch_scc1 F_COMP
F_LOAD:
    s_setprio 3
    s_sub_u32 s12, s3, 9
    v_lshrrev_b32 v5, 3, v2
    v_bfe_u32 v6, v2, 4, 1
    v_xor_b32 v6, v6, v2
    v_and_b32 v6, 7, v6
    s_movk_i32 s8, 9216
    v_mul_lo_u32 v7, v5, s8
    v_lshl_add_u32 v8, v6, 4, v7
    v_xor_b32 v9, 32, v8
    v_xor_b32 v10, 64, v8
    v_xor_b32 v11, 96, v8
    v_bfe_u32 v6, v2, 4, 1
    v_lshlrev_b32 v6, 1, v6
    v_xor_b32 v6, v6, v2
    v_and_b32 v6, 7, v6
    v_mul_u32_u24 v7, 1152, v5
    v_lshl_add_u32 v12, v6, 4, v7
    v_xor_b32 v13, 64, v12
    s_mul_i32 s13, s12, 294912
    s_lshl_b32 s8, s7, 7
    s_add_u32 s13, s13, s8
    s_lshl_b32 s15, s12, 13
    s_add_u32 s15, s15, 256
    s_mul_i32 s14, s12, 24576
    s_add_u32 s14, s14, 73984
    s_mul_i32 s11, s7, 73728
    s_mul_i32 s8, s12, 384
    s_add_u32 s11, s11, s8
    s_waitcnt lgkmcnt(0)
    s_mov_b32 s52, s38
    s_mov_b32 s53, s39
    s_mov_b32 s54, 5308416
    s_mov_b32 s55, 0x20000
    s_mov_b32 s56, s40
    s_mov_b32 s57, s41
    s_mov_b32 s58, 5308416
    s_mov_b32 s59, 0x20000
    s_mov_b32 s60, s42
    s_mov_b32 s61, s43
    s_mov_b32 s62, 5308416
    s_mov_b32 s63, 0x20000
    s_mov_b32 s9, 0
SP_1:
    ds_read_b32 v14, v1 offset:4
    s_waitcnt lgkmcnt(0)
    v_readfirstlane_b32 s8, v14
    s_add_u32 s9, s9, 1
    s_cmp_ge_u32 s8, 1
    s_cbranch_scc1 SP_1_D
    s_cmp_lt_u32 s9, 524288
    s_cbranch_scc1 SP_1
SP_1_D:
    s_add_u32 m0, s15, 0
    s_nop 0
    buffer_load_dwordx4 v8, s[52:55], s13 offen  lds
    s_add_u32 m0, s15, 1024
    s_nop 0
    buffer_load_dwordx4 v10, s[56:59], s13 offen  lds
    s_add_u32 s13, s13, 73728
    s_add_u32 m0, s15, 2048
    s_nop 0
    buffer_load_dwordx4 v9, s[52:55], s13 offen  lds
    s_add_u32 m0, s15, 3072
    s_nop 0
    buffer_load_dwordx4 v11, s[56:59], s13 offen  lds
    s_add_u32 s13, s13, 73728
    s_add_u32 m0, s15, 4096
    s_nop 0
    buffer_load_dwordx4 v8, s[52:55], s13 offen  lds
    s_add_u32 m0, s15, 5120
    s_nop 0
    buffer_load_dwordx4 v10, s[56:59], s13 offen  lds
    s_add_u32 s13, s13, 73728
    s_add_u32 m0, s15, 6144
    s_nop 0
    buffer_load_dwordx4 v9, s[52:55], s13 offen  lds
    s_add_u32 m0, s15, 7168
    s_nop 0
    buffer_load_dwordx4 v11, s[56:59], s13 offen  lds
    s_add_u32 s13, s13, 663552
    s_add_u32 m0, s15, 24576
    s_nop 0
    buffer_load_dwordx4 v8, s[52:55], s13 offen  lds
    s_add_u32 m0, s15, 25600
    s_nop 0
    buffer_load_dwordx4 v10, s[56:59], s13 offen  lds
    s_add_u32 s13, s13, 73728
    s_waitcnt vmcnt(9)
    s_add_u32 m0, s15, 26624
    s_nop 0
    buffer_load_dwordx4 v9, s[52:55], s13 offen  lds
    s_waitcnt vmcnt(9)
    s_add_u32 m0, s15, 27648
    s_nop 0
    buffer_load_dwordx4 v11, s[56:59], s13 offen  lds
    s_add_u32 s13, s13, 73728
    s_waitcnt vmcnt(9)
    s_add_u32 m0, s15, 28672
    s_nop 0
    buffer_load_dwordx4 v8, s[52:55], s13 offen  lds
    s_waitcnt vmcnt(9)
    s_add_u32 m0, s15, 29696
    s_nop 0
    buffer_load_dwordx4 v10, s[56:59], s13 offen  lds
    s_add_u32 s13, s13, 73728
    s_waitcnt vmcnt(9)
    s_add_u32 m0, s15, 30720
    s_nop 0
    buffer_load_dwordx4 v9, s[52:55], s13 offen  lds
    s_waitcnt vmcnt(9)
    s_add_u32 m0, s15, 31744
    s_nop 0
    buffer_load_dwordx4 v11, s[56:59], s13 offen  lds
    s_add_u32 s13, s13, 663552
    s_waitcnt vmcnt(9)
    s_add_u32 m0, s15, 49152
    s_nop 0
    buffer_load_dwordx4 v8, s[52:55], s13 offen  lds
    s_waitcnt vmcnt(9)
    v_mov_b32 v14, 1
    s_mov_b64 exec, 1
    ds_add_u32 v1, v14 offset:16
    s_mov_b64 exec, -1
    s_add_u32 m0, s15, 50176
    s_nop 0
    buffer_load_dwordx4 v10, s[56:59], s13 offen  lds
    s_add_u32 s13, s13, 73728
    s_waitcnt vmcnt(9)
    s_add_u32 m0, s15, 51200
    s_nop 0
    buffer_load_dwordx4 v9, s[52:55], s13 offen  lds
    s_waitcnt vmcnt(9)
    s_add_u32 m0, s15, 52224
    s_nop 0
    buffer_load_dwordx4 v11, s[56:59], s13 offen  lds
    s_add_u32 s13, s13, 73728
    s_waitcnt vmcnt(9)
    s_add_u32 m0, s15, 53248
    s_nop 0
    buffer_load_dwordx4 v8, s[52:55], s13 offen  lds
    s_waitcnt vmcnt(9)
    s_add_u32 m0, s15, 54272
    s_nop 0
    buffer_load_dwordx4 v10, s[56:59], s13 offen  lds
    s_add_u32 s13, s13, 73728
    s_waitcnt vmcnt(9)
    s_add_u32 m0, s15, 55296
    s_nop 0
    buffer_load_dwordx4 v9, s[52:55], s13 offen  lds
    s_waitcnt vmcnt(9)
    s_add_u32 m0, s15, 56320
    s_nop 0
    buffer_load_dwordx4 v11, s[56:59], s13 offen  lds
    s_add_u32 s13, s13, 663552
    s_mov_b32 s9, 0
SP_2:
    ds_read_b32 v14, v1 offset:48
    s_waitcnt lgkmcnt(0)
    v_readfirstlane_b32 s8, v14
    s_add_u32 s9, s9, 1
    s_cmp_ge_u32 s8, 4
    s_cbranch_scc1 SP_2_D
    s_cmp_lt_u32 s9, 524288
    s_cbranch_scc1 SP_2
SP_2_D:
    s_waitcnt vmcnt(9)
    s_add_u32 m0, s15, 0
    s_nop 0
    buffer_load_dwordx4 v8, s[52:55], s13 offen  lds
    s_waitcnt vmcnt(9)
    v_mov_b32 v14, 1
    s_mov_b64 exec, 1
    ds_add_u32 v1, v14 offset:20
    s_mov_b64 exec, -1
    s_add_u32 m0, s15, 1024
    s_nop 0
    buffer_load_dwordx4 v10, s[56:59], s13 offen  lds
    s_add_u32 s13, s13, 73728
    s_waitcnt vmcnt(9)
    s_add_u32 m0, s15, 2048
    s_nop 0
    buffer_load_dwordx4 v9, s[52:55], s13 offen  lds
    s_waitcnt vmcnt(9)
    s_add_u32 m0, s15, 3072
    s_nop 0
    buffer_load_dwordx4 v11, s[56:59], s13 offen  lds
    s_add_u32 s13, s13, 73728
    s_waitcnt vmcnt(9)
    s_add_u32 m0, s15, 4096
    s_nop 0
    buffer_load_dwordx4 v8, s[52:55], s13 offen  lds
    s_waitcnt vmcnt(9)
    s_add_u32 m0, s15, 5120
    s_nop 0
    buffer_load_dwordx4 v10, s[56:59], s13 offen  lds
    s_add_u32 s13, s13, 73728
    s_waitcnt vmcnt(9)
    s_add_u32 m0, s15, 6144
    s_nop 0
    buffer_load_dwordx4 v9, s[52:55], s13 offen  lds
    s_waitcnt vmcnt(9)
    s_add_u32 m0, s15, 7168
    s_nop 0
    buffer_load_dwordx4 v11, s[56:59], s13 offen  lds
    s_add_u32 s13, s13, 663552
    s_mov_b32 s9, 0
SP_3:
    ds_read_b32 v14, v1 offset:52
    s_waitcnt lgkmcnt(0)
    v_readfirstlane_b32 s8, v14
    s_add_u32 s9, s9, 1
    s_cmp_ge_u32 s8, 4
    s_cbranch_scc1 SP_3_D
    s_cmp_lt_u32 s9, 524288
    s_cbranch_scc1 SP_3
SP_3_D:
    s_waitcnt vmcnt(9)
    s_add_u32 m0, s15, 24576
    s_nop 0
    buffer_load_dwordx4 v8, s[52:55], s13 offen  lds
    s_waitcnt vmcnt(9)
    v_mov_b32 v14, 1
    s_mov_b64 exec, 1
    ds_add_u32 v1, v14 offset:24
    s_mov_b64 exec, -1
    s_add_u32 m0, s15, 25600
    s_nop 0
    buffer_load_dwordx4 v10, s[56:59], s13 offen  lds
    s_add_u32 s13, s13, 73728
    s_waitcnt vmcnt(9)
    s_add_u32 m0, s15, 26624
    s_nop 0
    buffer_load_dwordx4 v9, s[52:55], s13 offen  lds
    s_waitcnt vmcnt(9)
    s_add_u32 m0, s15, 27648
    s_nop 0
    buffer_load_dwordx4 v11, s[56:59], s13 offen  lds
    s_add_u32 s13, s13, 73728
    s_waitcnt vmcnt(9)
    s_add_u32 m0, s15, 28672
    s_nop 0
    buffer_load_dwordx4 v8, s[52:55], s13 offen  lds
    s_waitcnt vmcnt(9)
    s_add_u32 m0, s15, 29696
    s_nop 0
    buffer_load_dwordx4 v10, s[56:59], s13 offen  lds
    s_add_u32 s13, s13, 73728
    s_waitcnt vmcnt(9)
    s_add_u32 m0, s15, 30720
    s_nop 0
    buffer_load_dwordx4 v9, s[52:55], s13 offen  lds
    s_waitcnt vmcnt(9)
    s_add_u32 m0, s15, 31744
    s_nop 0
    buffer_load_dwordx4 v11, s[56:59], s13 offen  lds
    s_add_u32 s13, s13, 663552
    s_mov_b32 s9, 0
SP_4:
    ds_read_b32 v14, v1 offset:56
    s_waitcnt lgkmcnt(0)
    v_readfirstlane_b32 s8, v14
    s_add_u32 s9, s9, 1
    s_cmp_ge_u32 s8, 4
    s_cbranch_scc1 SP_4_D
    s_cmp_lt_u32 s9, 524288
    s_cbranch_scc1 SP_4
SP_4_D:
    s_waitcnt vmcnt(9)
    s_add_u32 m0, s15, 49152
    s_nop 0
    buffer_load_dwordx4 v8, s[52:55], s13 offen  lds
    s_waitcnt vmcnt(9)
    v_mov_b32 v14, 1
    s_mov_b64 exec, 1
    ds_add_u32 v1, v14 offset:28
    s_mov_b64 exec, -1
    s_add_u32 m0, s15, 50176
    s_nop 0
    buffer_load_dwordx4 v10, s[56:59], s13 offen  lds
    s_add_u32 s13, s13, 73728
    s_waitcnt vmcnt(9)
    s_add_u32 m0, s15, 51200
    s_nop 0
    buffer_load_dwordx4 v9, s[52:55], s13 offen  lds
    s_waitcnt vmcnt(9)
    s_add_u32 m0, s15, 52224
    s_nop 0
    buffer_load_dwordx4 v11, s[56:59], s13 offen  lds
    s_add_u32 s13, s13, 73728
    s_waitcnt vmcnt(9)
    s_add_u32 m0, s15, 53248
    s_nop 0
    buffer_load_dwordx4 v8, s[52:55], s13 offen  lds
    s_waitcnt vmcnt(9)
    s_add_u32 m0, s15, 54272
    s_nop 0
    buffer_load_dwordx4 v10, s[56:59], s13 offen  lds
    s_add_u32 s13, s13, 73728
    s_waitcnt vmcnt(9)
    s_add_u32 m0, s15, 55296
    s_nop 0
    buffer_load_dwordx4 v9, s[52:55], s13 offen  lds
    s_waitcnt vmcnt(9)
    s_add_u32 m0, s15, 56320
    s_nop 0
    buffer_load_dwordx4 v11, s[56:59], s13 offen  lds
    s_add_u32 s13, s13, 663552
    v_mov_b32 v14, 1
    s_mov_b64 exec, 1
    ds_add_u32 v1, v14 offset:40
    s_mov_b64 exec, -1
    s_waitcnt vmcnt(8)
    v_mov_b32 v14, 1
    s_mov_b64 exec, 1
    ds_add_u32 v1, v14 offset:32
    s_mov_b64 exec, -1
    s_waitcnt vmcnt(0)
    v_mov_b32 v14, 1
    s_mov_b64 exec, 1
    ds_add_u32 v1, v14 offset:36
    s_mov_b64 exec, -1
    s_cmp_eq_u32 s3, 9
    s_cbranch_scc1 F_COMP2
    s_endpgm
K_CIO:
    s_sub_u32 s12, s3, 9
    s_cmp_eq_u32 s3, 11
    s_cbranch_scc1 C_LOAD
    s_branch GATE
C_LOAD:
    s_setprio 3
    s_sub_u32 s13, s5, 14
    s_mov_b32 s8, s13
    s_mul_i32 s8, s8, 73728
    s_lshl_b32 s9, s4, 7
    s_add_u32 s8, s8, s9
    v_mul_u32_u24 v9, 1152, v2
    v_add_u32 v9, s8, v9
    s_add_u32 s8, s13, 18
    s_min_u32 s8, s8, 31
    s_sub_u32 s8, s8, s13
    s_mul_i32 s8, s8, 73728
    v_add_u32 v8, s8, v9
    v_mul_u32_u24 v6, 4608, v2
    s_lshl_b32 s8, s7, 3
    v_add_u32 v6, s8, v6
    v_lshlrev_b32 v7, 3, v2
    v_sub_u32 v7, 73464, v7
    s_mov_b32 s56, 0x05040100
    s_mov_b32 s58, 0x07060302
    s_mov_b32 s57, s13
    s_waitcnt lgkmcnt(0)
    s_mov_b32 s72, s16
    s_mov_b32 s73, s17
    s_mov_b32 s74, 2359296
    s_mov_b32 s75, 0x20000
    s_mov_b32 s9, 0
SP_5:
    ds_read_b32 v12, v1 offset:4
    s_waitcnt lgkmcnt(0)
    v_readfirstlane_b32 s8, v12
    s_add_u32 s9, s9, 1
    s_cmp_ge_u32 s8, 1
    s_cbranch_scc1 SP_5_D
    s_cmp_lt_u32 s9, 524288
    s_cbranch_scc1 SP_5
SP_5_D:
    global_load_dword v10, v9, s[16:17]
    global_load_dword v11, v9, s[16:17] offset:128
    global_load_dword v10, v8, s[16:17]
    global_load_dword v11, v8, s[16:17] offset:128
    s_mul_i32 s7, s4, 18
    s_add_u32 s7, s7, s5
    s_sub_u32 s7, s7, 14
    s_lshl_b32 s55, s7, 3
    s_sub_u32 s12, s3, 8
    s_mov_b32 s60, s46
    s_mov_b32 s61, s47
    s_mov_b32 s62, 2359296
    s_mov_b32 s63, 0x20000
    s_sub_u32 s9, s5, 14
    s_lshl_b32 s9, s9, 2
    s_add_u32 s9, s9, s12
    s_mul_i32 s9, s9, 9216
    s_mul_i32 s8, s4, 663552
    s_add_u32 s8, s8, s9
    v_lshl_add_u32 v88, v2, 7, s8
    v_min_u32 v89, 7, v2
    v_lshl_add_u32 v89, v89, 7, s8
    v_add_u32 v89, 8192, v89
    v_mov_b32 v24, 0
    v_mov_b32 v25, 0
    v_mov_b32 v26, 0
    v_mov_b32 v27, 0
    v_lshrrev_b32 v28, 2, v2
    v_mul_u32_u24 v28, 2240, v28
    v_add_u32 v28, 37120, v28
    v_and_b32 v29, 3, v2
    v_lshl_add_u32 v30, v29, 4, v28
    ds_write_b128 v30, v[24:27] offset:2096
    v_and_b32 v29, 1, v2
    v_lshl_add_u32 v30, v29, 4, v28
    ds_write_b128 v30, v[24:27]
    v_lshrrev_b32 v28, 5, v2
    v_mul_u32_u24 v28, 4672, v28
    v_and_b32 v29, 31, v2
    v_lshl_add_u32 v30, v29, 4, v28
    v_add_u32 v30, 77056, v30
    ds_write_b128 v30, v[24:27]
    ds_write_b128 v30, v[24:27] offset:9344
    s_lshl_b32 s14, s12, 1
    s_add_u32 s14, s14, 16
    s_lshl_b32 s8, s14, 8
    s_add_u32 s8, s8, 8192
    v_xor_b32 v13, 63, v2
    v_lshrrev_b32 v13, 1, v13
    v_lshl_add_u32 v13, v13, 3, s8
    v_add_u32 v9, 2048, v13
    s_lshl_b32 s14, s12, 2
    s_lshl_b32 s8, s14, 8
    s_add_u32 s8, s8, 8192
    v_xor_b32 v5, 63, v2
    v_lshrrev_b32 v5, 1, v5
    v_lshl_add_u32 v5, v5, 3, s8
    s_mov_b32 s15, 0
    s_add_u32 s8, s57, 0
    s_and_b32 s8, s8, 3
    s_mul_i32 s76, s8, 294912
    s_add_u32 s64, s76, 1179648
    s_lshl_b32 s8, s8, 9
    v_subrev_u32 v32, s8, v7
    s_add_u32 s8, s57, 1
    s_and_b32 s8, s8, 3
    s_mul_i32 s77, s8, 294912
    s_add_u32 s65, s77, 1179648
    s_lshl_b32 s8, s8, 9
    v_subrev_u32 v33, s8, v7
    s_add_u32 s8, s57, 2
    s_and_b32 s8, s8, 3
    s_mul_i32 s78, s8, 294912
    s_add_u32 s66, s78, 1179648
    s_lshl_b32 s8, s8, 9
    v_subrev_u32 v34, s8, v7
    s_add_u32 s8, s57, 3
    s_and_b32 s8, s8, 3
    s_mul_i32 s79, s8, 294912
    s_add_u32 s67, s79, 1179648
    s_lshl_b32 s8, s8, 9
    v_subrev_u32 v35, s8, v7
    v_mov_b32 v12, 1
    s_waitcnt vmcnt(2)
    buffer_load_dwordx2 v[104:105], v6, s[72:75], s76 offen offset:0
    buffer_load_dwordx2 v[106:107], v6, s[72:75], s76 offen offset:1152
    buffer_load_dwordx2 v[108:109], v6, s[72:75], s76 offen offset:2304
    buffer_load_dwordx2 v[110:111], v6, s[72:75], s76 offen offset:3456
    s_add_u32 s15, s15, 294912
    buffer_load_dwordx2 v[112:113], v6, s[72:75], s77 offen offset:0
    s_waitcnt vmcnt(4)
    buffer_load_dwordx2 v[114:115], v6, s[72:75], s77 offen offset:1152
    s_waitcnt vmcnt(4)
    buffer_load_dwordx2 v[116:117], v6, s[72:75], s77 offen offset:2304
    s_waitcnt vmcnt(4)
    buffer_load_dwordx2 v[118:119], v6, s[72:75], s77 offen offset:3456
    s_add_u32 s15, s15, 294912
    s_waitcnt vmcnt(4)
    buffer_load_dwordx2 v[120:121], v6, s[72:75], s78 offen offset:0
    v_perm_b32 v16, v108, v110, s56
    v_perm_b32 v17, v104, v106, s56
    ds_write_b64 v32, v[16:17] offset:3584
    v_perm_b32 v18, v108, v110, s58
    v_perm_b32 v19, v104, v106, s58
    ds_write_b64 v32, v[18:19] offset:8256
    v_perm_b32 v20, v109, v111, s56
    v_perm_b32 v21, v105, v107, s56
    ds_write_b64 v32, v[20:21] offset:12928
    v_perm_b32 v22, v109, v111, s58
    v_perm_b32 v23, v105, v107, s58
    ds_write_b64 v32, v[22:23] offset:17600
    s_waitcnt vmcnt(4)
    buffer_load_dwordx2 v[122:123], v6, s[72:75], s78 offen offset:1152
    s_waitcnt vmcnt(4)
    buffer_load_dwordx2 v[124:125], v6, s[72:75], s78 offen offset:2304
    s_waitcnt vmcnt(4)
    buffer_load_dwordx2 v[126:127], v6, s[72:75], s78 offen offset:3456
    s_add_u32 s15, s15, 294912
    s_waitcnt vmcnt(4)
    buffer_load_dwordx2 v[128:129], v6, s[72:75], s79 offen offset:0
    v_perm_b32 v24, v116, v118, s56
    v_perm_b32 v25, v112, v114, s56
    ds_write_b64 v33, v[24:25] offset:3584
    v_perm_b32 v26, v116, v118, s58
    v_perm_b32 v27, v112, v114, s58
    ds_write_b64 v33, v[26:27] offset:8256
    v_perm_b32 v28, v117, v119, s56
    v_perm_b32 v29, v113, v115, s56
    ds_write_b64 v33, v[28:29] offset:12928
    v_perm_b32 v30, v117, v119, s58
    v_perm_b32 v31, v113, v115, s58
    ds_write_b64 v33, v[30:31] offset:17600
    s_waitcnt vmcnt(4)
    buffer_load_dwordx2 v[130:131], v6, s[72:75], s79 offen offset:1152
    s_waitcnt vmcnt(4)
    buffer_load_dwordx2 v[132:133], v6, s[72:75], s79 offen offset:2304
    s_waitcnt vmcnt(4)
    buffer_load_dwordx2 v[134:135], v6, s[72:75], s79 offen offset:3456
    s_add_u32 s15, s15, 294912
    s_waitcnt vmcnt(4)
    buffer_load_dwordx2 v[136:137], v6, s[72:75], s64 offen offset:0
    v_perm_b32 v16, v124, v126, s56
    v_perm_b32 v17, v120, v122, s56
    ds_write_b64 v34, v[16:17] offset:3584
    v_perm_b32 v18, v124, v126, s58
    v_perm_b32 v19, v120, v122, s58
    ds_write_b64 v34, v[18:19] offset:8256
    v_perm_b32 v20, v125, v127, s56
    v_perm_b32 v21, v121, v123, s56
    ds_write_b64 v34, v[20:21] offset:12928
    v_perm_b32 v22, v125, v127, s58
    v_perm_b32 v23, v121, v123, s58
    ds_write_b64 v34, v[22:23] offset:17600
    s_waitcnt vmcnt(4)
    buffer_load_dwordx2 v[138:139], v6, s[72:75], s64 offen offset:1152
    s_waitcnt vmcnt(4)
    buffer_load_dwordx2 v[140:141], v6, s[72:75], s64 offen offset:2304
    s_waitcnt vmcnt(4)
    buffer_load_dwordx2 v[142:143], v6, s[72:75], s64 offen offset:3456
    s_add_u32 s15, s15, 294912
    s_waitcnt vmcnt(4)
    buffer_load_dwordx2 v[144:145], v6, s[72:75], s65 offen offset:0
    v_perm_b32 v24, v132, v134, s56
    v_perm_b32 v25, v128, v130, s56
    ds_write_b64 v35, v[24:25] offset:3584
    v_perm_b32 v26, v132, v134, s58
    v_perm_b32 v27, v128, v130, s58
    ds_write_b64 v35, v[26:27] offset:8256
    v_perm_b32 v28, v133, v135, s56
    v_perm_b32 v29, v129, v131, s56
    ds_write_b64 v35, v[28:29] offset:12928
    v_perm_b32 v30, v133, v135, s58
    v_perm_b32 v31, v129, v131, s58
    ds_write_b64 v35, v[30:31] offset:17600
    ds_write_b32 v1, v12 offset:80
    s_waitcnt vmcnt(4)
    buffer_load_dwordx2 v[146:147], v6, s[72:75], s65 offen offset:1152
    s_waitcnt vmcnt(4)
    buffer_load_dwordx2 v[148:149], v6, s[72:75], s65 offen offset:2304
    s_waitcnt vmcnt(4)
    buffer_load_dwordx2 v[150:151], v6, s[72:75], s65 offen offset:3456
    s_add_u32 s15, s15, 294912
    s_waitcnt vmcnt(4)
    buffer_load_dwordx2 v[152:153], v6, s[72:75], s66 offen offset:0
    v_perm_b32 v16, v140, v142, s56
    v_perm_b32 v17, v136, v138, s56
    ds_write_b64 v32, v[16:17] offset:1536
    v_perm_b32 v18, v140, v142, s58
    v_perm_b32 v19, v136, v138, s58
    ds_write_b64 v32, v[18:19] offset:6208
    v_perm_b32 v20, v141, v143, s56
    v_perm_b32 v21, v137, v139, s56
    ds_write_b64 v32, v[20:21] offset:10880
    v_perm_b32 v22, v141, v143, s58
    v_perm_b32 v23, v137, v139, s58
    ds_write_b64 v32, v[22:23] offset:15552
    s_waitcnt vmcnt(4)
    buffer_load_dwordx2 v[154:155], v6, s[72:75], s66 offen offset:1152
    s_waitcnt vmcnt(4)
    buffer_load_dwordx2 v[156:157], v6, s[72:75], s66 offen offset:2304
    s_waitcnt vmcnt(4)
    buffer_load_dwordx2 v[158:159], v6, s[72:75], s66 offen offset:3456
    s_add_u32 s15, s15, 294912
    s_waitcnt vmcnt(4)
    buffer_load_dwordx2 v[160:161], v6, s[72:75], s67 offen offset:0
    v_perm_b32 v24, v148, v150, s56
    v_perm_b32 v25, v144, v146, s56
    ds_write_b64 v33, v[24:25] offset:1536
    v_perm_b32 v26, v148, v150, s58
    v_perm_b32 v27, v144, v146, s58
    ds_write_b64 v33, v[26:27] offset:6208
    v_perm_b32 v28, v149, v151, s56
    v_perm_b32 v29, v145, v147, s56
    ds_write_b64 v33, v[28:29] offset:10880
    v_perm_b32 v30, v149, v151, s58
    v_perm_b32 v31, v145, v147, s58
    ds_write_b64 v33, v[30:31] offset:15552
    s_waitcnt vmcnt(4)
    buffer_load_dwordx2 v[162:163], v6, s[72:75], s67 offen offset:1152
    s_waitcnt vmcnt(4)
    buffer_load_dwordx2 v[164:165], v6, s[72:75], s67 offen offset:2304
    s_waitcnt vmcnt(4)
    buffer_load_dwordx2 v[166:167], v6, s[72:75], s67 offen offset:3456
    s_add_u32 s15, s15, 294912
    ds_write_b32 v1, v12 offset:88
    global_load_dwordx2 v[104:105], v5, s[50:51] offset:0 sc1
    global_load_dwordx2 v[106:107], v5, s[50:51] offset:256 sc1
    global_load_dwordx2 v[108:109], v5, s[50:51] offset:512 sc1
    global_load_dwordx2 v[110:111], v5, s[50:51] offset:768 sc1
    global_load_dwordx2 v[112:113], v13, s[50:51] offset:0 sc1
    global_load_dwordx2 v[114:115], v13, s[50:51] offset:256 sc1
    global_load_dwordx2 v[116:117], v9, s[50:51] offset:0 sc1
    global_load_dwordx2 v[118:119], v9, s[50:51] offset:256 sc1
    global_load_dword v96, v88, s[42:43]
    global_load_dword v97, v89, s[42:43]
    s_waitcnt vmcnt(14)
    v_perm_b32 v16, v156, v158, s56
    v_perm_b32 v17, v152, v154, s56
    ds_write_b64 v34, v[16:17] offset:1536
    v_perm_b32 v18, v156, v158, s58
    v_perm_b32 v19, v152, v154, s58
    ds_write_b64 v34, v[18:19] offset:6208
    v_perm_b32 v20, v157, v159, s56
    v_perm_b32 v21, v153, v155, s56
    ds_write_b64 v34, v[20:21] offset:10880
    v_perm_b32 v22, v157, v159, s58
    v_perm_b32 v23, v153, v155, s58
    ds_write_b64 v34, v[22:23] offset:15552
    s_waitcnt vmcnt(13)
    s_waitcnt vmcnt(12)
    s_waitcnt vmcnt(11)
    s_waitcnt vmcnt(10)
    v_perm_b32 v24, v164, v166, s56
    v_perm_b32 v25, v160, v162, s56
    ds_write_b64 v35, v[24:25] offset:1536
    v_perm_b32 v26, v164, v166, s58
    v_perm_b32 v27, v160, v162, s58
    ds_write_b64 v35, v[26:27] offset:6208
    v_perm_b32 v28, v165, v167, s56
    v_perm_b32 v29, v161, v163, s56
    ds_write_b64 v35, v[28:29] offset:10880
    v_perm_b32 v30, v165, v167, s58
    v_perm_b32 v31, v161, v163, s58
    ds_write_b64 v35, v[30:31] offset:15552
    ds_write_b32 v1, v12 offset:84
    v_mov_b32 v6, v13
    s_mov_b32 s9, 0
SP_6:
    ds_read_b32 v10, v1 offset:8
    s_waitcnt lgkmcnt(0)
    v_readfirstlane_b32 s8, v10
    s_add_u32 s9, s9, 1
    s_cmp_lg_u32 s8, 0
    s_cbranch_scc1 SP_6_D
    s_cmp_lt_u32 s9, 524288
    s_cbranch_scc1 SP_6
SP_6_D:
    v_bfe_u32 v12, v2, 2, 2
    v_mul_u32_u24 v12, 4672, v12
    v_and_b32 v13, 3, v2
    v_lshl_add_u32 v13, v4, 2, v13
    v_lshl_add_u32 v12, v13, 3, v12
    s_lshl_b32 s8, s14, 7
    s_sub_u32 s8, 76544, s8
    v_add_u32 v12, s8, v12
    ds_read_b64_tr_b16 v[44:45], v12 offset:384
    ds_read_b64_tr_b16 v[50:51], v12 offset:256
    ds_read_b64_tr_b16 v[56:57], v12 offset:128
    ds_read_b64_tr_b16 v[62:63], v12 offset:0
    s_waitcnt lgkmcnt(0)
    v_lshlrev_b32 v40, 16, v44
    v_and_b32 v41, 0xffff0000, v44
    v_lshlrev_b32 v42, 16, v45
    v_and_b32 v43, 0xffff0000, v45
    v_lshlrev_b32 v46, 16, v50
    v_and_b32 v47, 0xffff0000, v50
    v_lshlrev_b32 v48, 16, v51
    v_and_b32 v49, 0xffff0000, v51
    v_lshlrev_b32 v52, 16, v56
    v_and_b32 v53, 0xffff0000, v56
    v_lshlrev_b32 v54, 16, v57
    v_and_b32 v55, 0xffff0000, v57
    v_lshlrev_b32 v58, 16, v62
    v_and_b32 v59, 0xffff0000, v62
    v_lshlrev_b32 v60, 16, v63
    v_and_b32 v61, 0xffff0000, v63
    s_branch C_IO3
C_IO:
    s_mul_i32 s7, s4, 18
    s_add_u32 s7, s7, s5
    s_sub_u32 s7, s7, 14
    s_lshl_b32 s55, s7, 3
    s_sub_u32 s12, s3, 8
    s_mov_b32 s60, s46
    s_mov_b32 s61, s47
    s_mov_b32 s62, 2359296
    s_mov_b32 s63, 0x20000
    s_sub_u32 s9, s5, 14
    s_lshl_b32 s9, s9, 2
    s_add_u32 s9, s9, s12
    s_mul_i32 s9, s9, 9216
    s_mul_i32 s8, s4, 663552
    s_add_u32 s8, s8, s9
    v_lshl_add_u32 v88, v2, 7, s8
    v_min_u32 v89, 7, v2
    v_lshl_add_u32 v89, v89, 7, s8
    v_add_u32 v89, 8192, v89
    s_lshl_b32 s14, s12, 1
    s_add_u32 s14, s14, 16
    s_lshl_b32 s8, s14, 8
    s_add_u32 s8, s8, 8192
    v_xor_b32 v6, 63, v2
    v_lshrrev_b32 v6, 1, v6
    v_lshl_add_u32 v6, v6, 3, s8
    v_add_u32 v9, 2048, v6
    s_lshl_b32 s14, s12, 2
    s_lshl_b32 s8, s14, 8
    s_add_u32 s8, s8, 8192
    v_xor_b32 v5, 63, v2
    v_lshrrev_b32 v5, 1, v5
    v_lshl_add_u32 v5, v5, 3, s8
    s_mov_b32 s9, 0
SP_7:
    ds_read_b32 v10, v1 offset:8
    s_waitcnt lgkmcnt(0)
    v_readfirstlane_b32 s8, v10
    s_add_u32 s9, s9, 1
    s_cmp_lg_u32 s8, 0
    s_cbranch_scc1 SP_7_D
    s_cmp_lt_u32 s9, 524288
    s_cbranch_scc1 SP_7
SP_7_D:
    s_setprio 3
    s_mov_b32 s9, 0
SP_8:
    ds_read_b32 v12, v1 offset:80
    s_waitcnt lgkmcnt(0)
    v_readfirstlane_b32 s8, v12
    s_add_u32 s9, s9, 1
    s_cmp_ge_u32 s8, 1
    s_cbranch_scc1 SP_8_D
    s_sleep 2
    s_cmp_lt_u32 s9, 524288
    s_cbranch_scc1 SP_8
SP_8_D:
    s_setprio 3
    v_bfe_u32 v12, v2, 2, 2
    v_mul_u32_u24 v12, 4672, v12
    v_and_b32 v13, 3, v2
    v_lshl_add_u32 v13, v4, 2, v13
    v_lshl_add_u32 v12, v13, 3, v12
    s_lshl_b32 s8, s14, 7
    s_sub_u32 s8, 76544, s8
    v_add_u32 v12, s8, v12
    ds_read_b64_tr_b16 v[44:45], v12 offset:384
    ds_read_b64_tr_b16 v[50:51], v12 offset:256
    ds_read_b64_tr_b16 v[56:57], v12 offset:128
    ds_read_b64_tr_b16 v[62:63], v12 offset:0
    s_waitcnt lgkmcnt(0)
    v_lshlrev_b32 v40, 16, v44
    v_and_b32 v41, 0xffff0000, v44
    v_lshlrev_b32 v42, 16, v45
    v_and_b32 v43, 0xffff0000, v45
    v_lshlrev_b32 v46, 16, v50
    v_and_b32 v47, 0xffff0000, v50
    v_lshlrev_b32 v48, 16, v51
    v_and_b32 v49, 0xffff0000, v51
    v_lshlrev_b32 v52, 16, v56
    v_and_b32 v53, 0xffff0000, v56
    v_lshlrev_b32 v54, 16, v57
    v_and_b32 v55, 0xffff0000, v57
    v_lshlrev_b32 v58, 16, v62
    v_and_b32 v59, 0xffff0000, v62
    v_lshlrev_b32 v60, 16, v63
    v_and_b32 v61, 0xffff0000, v63
    s_setprio 3
    s_mov_b32 s9, 0
SP_9:
    ds_read_b32 v12, v1 offset:88
    s_waitcnt lgkmcnt(0)
    v_readfirstlane_b32 s8, v12
    s_add_u32 s9, s9, 1
    s_cmp_ge_u32 s8, 1
    s_cbranch_scc1 SP_9_D
    s_sleep 1
    s_cmp_lt_u32 s9, 524288
    s_cbranch_scc1 SP_9
SP_9_D:
    s_setprio 3
    global_load_dwordx2 v[104:105], v5, s[50:51] offset:0 sc1
    global_load_dwordx2 v[106:107], v5, s[50:51] offset:256 sc1
    global_load_dwordx2 v[108:109], v5, s[50:51] offset:512 sc1
    global_load_dwordx2 v[110:111], v5, s[50:51] offset:768 sc1
    global_load_dwordx2 v[112:113], v6, s[50:51] offset:0 sc1
    global_load_dwordx2 v[114:115], v6, s[50:51] offset:256 sc1
    global_load_dwordx2 v[116:117], v9, s[50:51] offset:0 sc1
    global_load_dwordx2 v[118:119], v9, s[50:51] offset:256 sc1
    global_load_dword v96, v88, s[42:43]
    global_load_dword v97, v89, s[42:43]
C_IO3:
    s_waitcnt vmcnt(2)
    s_mov_b32 s9, 0
GP_10:
    v_xor_b32 v14, v105, v10
    v_bitop3_b32 v14, v14, v107, v10 bitop3:0xf6
    v_bitop3_b32 v14, v14, v109, v10 bitop3:0xf6
    v_bitop3_b32 v14, v14, v111, v10 bitop3:0xf6
    v_bitop3_b32 v14, v14, v113, v10 bitop3:0xf6
    v_bitop3_b32 v14, v14, v115, v10 bitop3:0xf6
    v_bitop3_b32 v14, v14, v117, v10 bitop3:0xf6
    v_bitop3_b32 v14, v14, v119, v10 bitop3:0xf6
    v_cmp_ne_u32 vcc, 0, v14
    s_add_u32 s9, s9, 1
    s_cmp_eq_u64 vcc, 0
    s_cbranch_scc1 GP_10_D
    s_cmp_ge_u32 s9, 131072
    s_cbranch_scc1 GP_10_D
    global_load_dwordx2 v[104:105], v5, s[50:51] offset:0 sc1
    global_load_dwordx2 v[106:107], v5, s[50:51] offset:256 sc1
    global_load_dwordx2 v[108:109], v5, s[50:51] offset:512 sc1
    global_load_dwordx2 v[110:111], v5, s[50:51] offset:768 sc1
    global_load_dwordx2 v[112:113], v6, s[50:51] offset:0 sc1
    global_load_dwordx2 v[114:115], v6, s[50:51] offset:256 sc1
    global_load_dwordx2 v[116:117], v9, s[50:51] offset:0 sc1
    global_load_dwordx2 v[118:119], v9, s[50:51] offset:256 sc1
    s_waitcnt vmcnt(0)
    s_branch GP_10
GP_10_D:
    v_and_b32 v11, 1, v2
    v_lshlrev_b32 v11, 4, v11
    s_lshl_b32 s8, s14, 8
    s_add_u32 s8, s8, 91648
    v_xor_b32 v12, 63, v2
    v_lshl_add_u32 v12, v12, 2, s8
    v_lshlrev_b32 v44, v11, v104
    v_lshlrev_b32 v50, v11, v106
    v_lshlrev_b32 v56, v11, v108
    v_lshlrev_b32 v62, v11, v110
    v_and_b32 v44, 0xffff0000, v44
    v_and_b32 v50, 0xffff0000, v50
    v_and_b32 v56, 0xffff0000, v56
    v_and_b32 v62, 0xffff0000, v62
    v_sub_f32 v45, 1.0, v44
    v_sub_f32 v51, 1.0, v50
    v_sub_f32 v57, 1.0, v56
    v_sub_f32 v63, 1.0, v62
    v_cvt_pk_bf16_f32 v45, v45, v45
    v_cvt_pk_bf16_f32 v51, v51, v51
    v_cvt_pk_bf16_f32 v57, v57, v57
    v_cvt_pk_bf16_f32 v63, v63, v63
    v_and_b32 v45, 0xffff0000, v45
    v_and_b32 v51, 0xffff0000, v51
    v_and_b32 v57, 0xffff0000, v57
    v_and_b32 v63, 0xffff0000, v63
    v_mul_f32 v40, v40, v45
    v_mul_f32 v41, v41, v45
    v_mul_f32 v42, v42, v45
    v_mul_f32 v43, v43, v45
    ds_write_b32 v12, v44 offset:0
    v_mul_f32 v46, v46, v51
    v_mul_f32 v47, v47, v51
    v_mul_f32 v48, v48, v51
    v_mul_f32 v49, v49, v51
    ds_write_b32 v12, v50 offset:256
    v_mul_f32 v52, v52, v57
    v_mul_f32 v53, v53, v57
    v_mul_f32 v54, v54, v57
    v_mul_f32 v55, v55, v57
    ds_write_b32 v12, v56 offset:512
    v_mul_f32 v58, v58, v63
    v_mul_f32 v59, v59, v63
    v_mul_f32 v60, v60, v63
    v_mul_f32 v61, v61, v63
    ds_write_b32 v12, v62 offset:768
    v_bfe_u32 v12, v2, 2, 2
    v_mul_u32_u24 v12, 4160, v12
    v_and_b32 v13, 3, v2
    v_lshl_add_u32 v13, v4, 2, v13
    v_lshl_add_u32 v12, v13, 3, v12
    s_lshl_b32 s8, s14, 7
    s_sub_u32 s8, 103424, s8
    v_add_u32 v12, s8, v12
    v_xor_b32 v14, 63, v2
    v_mul_u32_u24 v14, 1152, v14
    v_add_u32 v14, s55, v14
    s_mul_i32 s15, s14, 73728
    s_setprio 3
    s_mov_b32 s9, 0
SP_11:
    ds_read_b32 v15, v1 offset:96
    s_waitcnt lgkmcnt(0)
    v_readfirstlane_b32 s8, v15
    s_add_u32 s9, s9, 1
    s_cmp_ge_u32 s8, 4
    s_cbranch_scc1 SP_11_D
    s_sleep 1
    s_cmp_lt_u32 s9, 524288
    s_cbranch_scc1 SP_11
SP_11_D:
    s_setprio 3
    ds_read_b64_tr_b16 v[16:17], v12 offset:384
    ds_read_b64_tr_b16 v[18:19], v12 offset:256
    ds_read_b64_tr_b16 v[20:21], v12 offset:128
    ds_read_b64_tr_b16 v[22:23], v12 offset:0
    s_waitcnt lgkmcnt(3)
    v_lshlrev_b32 v24, 16, v16
    v_and_b32 v25, 0xffff0000, v16
    v_lshlrev_b32 v26, 16, v17
    v_and_b32 v27, 0xffff0000, v17
    v_fmac_f32 v40, v24, v44
    v_fmac_f32 v41, v25, v44
    v_fmac_f32 v42, v26, v44
    v_fmac_f32 v43, v27, v44
    v_cvt_pk_bf16_f32 v40, v40, v41
    v_cvt_pk_bf16_f32 v41, v42, v43
    buffer_store_dwordx2 v[40:41], v14, s[60:63], s15 offen
    s_add_u32 s15, s15, 73728
    s_waitcnt lgkmcnt(2)
    v_lshlrev_b32 v28, 16, v18
    v_and_b32 v29, 0xffff0000, v18
    v_lshlrev_b32 v30, 16, v19
    v_and_b32 v31, 0xffff0000, v19
    v_fmac_f32 v46, v28, v50
    v_fmac_f32 v47, v29, v50
    v_fmac_f32 v48, v30, v50
    v_fmac_f32 v49, v31, v50
    v_cvt_pk_bf16_f32 v46, v46, v47
    v_cvt_pk_bf16_f32 v47, v48, v49
    buffer_store_dwordx2 v[46:47], v14, s[60:63], s15 offen
    s_add_u32 s15, s15, 73728
    s_waitcnt lgkmcnt(1)
    v_lshlrev_b32 v32, 16, v20
    v_and_b32 v33, 0xffff0000, v20
    v_lshlrev_b32 v34, 16, v21
    v_and_b32 v35, 0xffff0000, v21
    v_fmac_f32 v52, v32, v56
    v_fmac_f32 v53, v33, v56
    v_fmac_f32 v54, v34, v56
    v_fmac_f32 v55, v35, v56
    v_cvt_pk_bf16_f32 v52, v52, v53
    v_cvt_pk_bf16_f32 v53, v54, v55
    buffer_store_dwordx2 v[52:53], v14, s[60:63], s15 offen
    s_add_u32 s15, s15, 73728
    s_waitcnt lgkmcnt(0)
    v_lshlrev_b32 v36, 16, v22
    v_and_b32 v37, 0xffff0000, v22
    v_lshlrev_b32 v38, 16, v23
    v_and_b32 v39, 0xffff0000, v23
    v_fmac_f32 v58, v36, v62
    v_fmac_f32 v59, v37, v62
    v_fmac_f32 v60, v38, v62
    v_fmac_f32 v61, v39, v62
    v_cvt_pk_bf16_f32 v58, v58, v59
    v_cvt_pk_bf16_f32 v59, v60, v61
    buffer_store_dwordx2 v[58:59], v14, s[60:63], s15 offen
    s_add_u32 s15, s15, 73728
    s_setprio 3
    s_mov_b32 s9, 0
SP_12:
    ds_read_b32 v12, v1 offset:84
    s_waitcnt lgkmcnt(0)
    v_readfirstlane_b32 s8, v12
    s_add_u32 s9, s9, 1
    s_cmp_ge_u32 s8, 1
    s_cbranch_scc1 SP_12_D
    s_sleep 2
    s_cmp_lt_u32 s9, 524288
    s_cbranch_scc1 SP_12
SP_12_D:
    s_setprio 3
    s_lshl_b32 s14, s12, 1
    s_add_u32 s14, s14, 24
    v_bfe_u32 v12, v2, 2, 2
    v_mul_u32_u24 v12, 4672, v12
    v_and_b32 v13, 3, v2
    v_lshl_add_u32 v13, v4, 2, v13
    v_lshl_add_u32 v12, v13, 3, v12
    s_lshl_b32 s8, s14, 7
    s_sub_u32 s8, 76800, s8
    v_add_u32 v12, s8, v12
    ds_read_b64_tr_b16 v[80:81], v12 offset:128
    ds_read_b64_tr_b16 v[86:87], v12 offset:0
    s_lshl_b32 s14, s12, 1
    s_add_u32 s14, s14, 16
    v_bfe_u32 v12, v2, 2, 2
    v_mul_u32_u24 v12, 4672, v12
    v_and_b32 v13, 3, v2
    v_lshl_add_u32 v13, v4, 2, v13
    v_lshl_add_u32 v12, v13, 3, v12
    s_lshl_b32 s8, s14, 7
    s_sub_u32 s8, 76800, s8
    v_add_u32 v12, s8, v12
    ds_read_b64_tr_b16 v[68:69], v12 offset:128
    ds_read_b64_tr_b16 v[74:75], v12 offset:0
    s_waitcnt lgkmcnt(0)
    v_lshlrev_b32 v64, 16, v68
    v_and_b32 v65, 0xffff0000, v68
    v_lshlrev_b32 v66, 16, v69
    v_and_b32 v67, 0xffff0000, v69
    v_lshlrev_b32 v70, 16, v74
    v_and_b32 v71, 0xffff0000, v74
    v_lshlrev_b32 v72, 16, v75
    v_and_b32 v73, 0xffff0000, v75
    v_lshlrev_b32 v76, 16, v80
    v_and_b32 v77, 0xffff0000, v80
    v_lshlrev_b32 v78, 16, v81
    v_and_b32 v79, 0xffff0000, v81
    v_lshlrev_b32 v82, 16, v86
    v_and_b32 v83, 0xffff0000, v86
    v_lshlrev_b32 v84, 16, v87
    v_and_b32 v85, 0xffff0000, v87
    s_lshl_b32 s14, s12, 1
    s_add_u32 s14, s14, 24
    v_and_b32 v11, 1, v2
    v_lshlrev_b32 v11, 4, v11
    s_lshl_b32 s8, s14, 8
    s_add_u32 s8, s8, 91648
    v_xor_b32 v12, 63, v2
    v_lshl_add_u32 v12, v12, 2, s8
    v_lshlrev_b32 v80, v11, v116
    v_lshlrev_b32 v86, v11, v118
    v_and_b32 v80, 0xffff0000, v80
    v_and_b32 v86, 0xffff0000, v86
    v_sub_f32 v81, 1.0, v80
    v_sub_f32 v87, 1.0, v86
    v_cvt_pk_bf16_f32 v81, v81, v81
    v_cvt_pk_bf16_f32 v87, v87, v87
    v_and_b32 v81, 0xffff0000, v81
    v_and_b32 v87, 0xffff0000, v87
    v_mul_f32 v76, v76, v81
    v_mul_f32 v77, v77, v81
    v_mul_f32 v78, v78, v81
    v_mul_f32 v79, v79, v81
    ds_write_b32 v12, v80 offset:0
    v_mul_f32 v82, v82, v87
    v_mul_f32 v83, v83, v87
    v_mul_f32 v84, v84, v87
    v_mul_f32 v85, v85, v87
    ds_write_b32 v12, v86 offset:256
    s_lshl_b32 s14, s12, 1
    s_add_u32 s14, s14, 16
    v_and_b32 v11, 1, v2
    v_lshlrev_b32 v11, 4, v11
    s_lshl_b32 s8, s14, 8
    s_add_u32 s8, s8, 91648
    v_xor_b32 v12, 63, v2
    v_lshl_add_u32 v12, v12, 2, s8
    v_lshlrev_b32 v68, v11, v112
    v_lshlrev_b32 v74, v11, v114
    v_and_b32 v68, 0xffff0000, v68
    v_and_b32 v74, 0xffff0000, v74
    v_sub_f32 v69, 1.0, v68
    v_sub_f32 v75, 1.0, v74
    v_cvt_pk_bf16_f32 v69, v69, v69
    v_cvt_pk_bf16_f32 v75, v75, v75
    v_and_b32 v69, 0xffff0000, v69
    v_and_b32 v75, 0xffff0000, v75
    v_mul_f32 v64, v64, v69
    v_mul_f32 v65, v65, v69
    v_mul_f32 v66, v66, v69
    v_mul_f32 v67, v67, v69
    ds_write_b32 v12, v68 offset:0
    v_mul_f32 v70, v70, v75
    v_mul_f32 v71, v71, v75
    v_mul_f32 v72, v72, v75
    v_mul_f32 v73, v73, v75
    ds_write_b32 v12, v74 offset:256
    v_bfe_u32 v12, v2, 2, 2
    v_mul_u32_u24 v12, 4160, v12
    v_and_b32 v13, 3, v2
    v_lshl_add_u32 v13, v4, 2, v13
    v_lshl_add_u32 v12, v13, 3, v12
    s_lshl_b32 s8, s14, 7
    s_sub_u32 s8, 103680, s8
    v_add_u32 v12, s8, v12
    v_xor_b32 v14, 63, v2
    v_mul_u32_u24 v14, 1152, v14
    v_add_u32 v14, s55, v14
    s_mul_i32 s15, s14, 73728
    s_setprio 3
    s_mov_b32 s9, 0
SP_13:
    ds_read_b32 v15, v1 offset:100
    s_waitcnt lgkmcnt(0)
    v_readfirstlane_b32 s8, v15
    s_add_u32 s9, s9, 1
    s_cmp_ge_u32 s8, 4
    s_cbranch_scc1 SP_13_D
    s_sleep 1
    s_cmp_lt_u32 s9, 524288
    s_cbranch_scc1 SP_13
SP_13_D:
    s_setprio 3
    ds_read_b64_tr_b16 v[16:17], v12 offset:128
    ds_read_b64_tr_b16 v[18:19], v12 offset:0
    s_waitcnt lgkmcnt(1)
    v_lshlrev_b32 v24, 16, v16
    v_and_b32 v25, 0xffff0000, v16
    v_lshlrev_b32 v26, 16, v17
    v_and_b32 v27, 0xffff0000, v17
    v_fmac_f32 v64, v24, v68
    v_fmac_f32 v65, v25, v68
    v_fmac_f32 v66, v26, v68
    v_fmac_f32 v67, v27, v68
    v_cvt_pk_bf16_f32 v64, v64, v65
    v_cvt_pk_bf16_f32 v65, v66, v67
    buffer_store_dwordx2 v[64:65], v14, s[60:63], s15 offen
    s_add_u32 s15, s15, 73728
    s_waitcnt lgkmcnt(0)
    v_lshlrev_b32 v28, 16, v18
    v_and_b32 v29, 0xffff0000, v18
    v_lshlrev_b32 v30, 16, v19
    v_and_b32 v31, 0xffff0000, v19
    v_fmac_f32 v70, v28, v74
    v_fmac_f32 v71, v29, v74
    v_fmac_f32 v72, v30, v74
    v_fmac_f32 v73, v31, v74
    v_cvt_pk_bf16_f32 v70, v70, v71
    v_cvt_pk_bf16_f32 v71, v72, v73
    buffer_store_dwordx2 v[70:71], v14, s[60:63], s15 offen
    s_add_u32 s15, s15, 73728
    s_lshl_b32 s14, s12, 1
    s_add_u32 s14, s14, 24
    v_bfe_u32 v12, v2, 2, 2
    v_mul_u32_u24 v12, 4160, v12
    v_and_b32 v13, 3, v2
    v_lshl_add_u32 v13, v4, 2, v13
    v_lshl_add_u32 v12, v13, 3, v12
    s_lshl_b32 s8, s14, 7
    s_sub_u32 s8, 103680, s8
    v_add_u32 v12, s8, v12
    v_xor_b32 v14, 63, v2
    v_mul_u32_u24 v14, 1152, v14
    v_add_u32 v14, s55, v14
    s_mul_i32 s15, s14, 73728
    s_setprio 3
    s_mov_b32 s9, 0
SP_14:
    ds_read_b32 v15, v1 offset:104
    s_waitcnt lgkmcnt(0)
    v_readfirstlane_b32 s8, v15
    s_add_u32 s9, s9, 1
    s_cmp_ge_u32 s8, 4
    s_cbranch_scc1 SP_14_D
    s_sleep 1
    s_cmp_lt_u32 s9, 524288
    s_cbranch_scc1 SP_14
SP_14_D:
    s_setprio 3
    ds_read_b64_tr_b16 v[16:17], v12 offset:128
    ds_read_b64_tr_b16 v[18:19], v12 offset:0
    s_waitcnt lgkmcnt(1)
    v_lshlrev_b32 v24, 16, v16
    v_and_b32 v25, 0xffff0000, v16
    v_lshlrev_b32 v26, 16, v17
    v_and_b32 v27, 0xffff0000, v17
    v_fmac_f32 v76, v24, v80
    v_fmac_f32 v77, v25, v80
    v_fmac_f32 v78, v26, v80
    v_fmac_f32 v79, v27, v80
    v_cvt_pk_bf16_f32 v76, v76, v77
    v_cvt_pk_bf16_f32 v77, v78, v79
    buffer_store_dwordx2 v[76:77], v14, s[60:63], s15 offen
    s_add_u32 s15, s15, 73728
    s_waitcnt lgkmcnt(0)
    v_lshlrev_b32 v28, 16, v18
    v_and_b32 v29, 0xffff0000, v18
    v_lshlrev_b32 v30, 16, v19
    v_and_b32 v31, 0xffff0000, v19
    v_fmac_f32 v82, v28, v86
    v_fmac_f32 v83, v29, v86
    v_fmac_f32 v84, v30, v86
    v_fmac_f32 v85, v31, v86
    v_cvt_pk_bf16_f32 v82, v82, v83
    v_cvt_pk_bf16_f32 v83, v84, v85
    buffer_store_dwordx2 v[82:83], v14, s[60:63], s15 offen
    s_add_u32 s15, s15, 73728
    v_mov_b32 v8, 1
    s_mov_b64 exec, 1
    ds_add_u32 v1, v8 offset:44
    s_mov_b64 exec, -1
    s_waitcnt vmcnt(0)
    v_mov_b32 v8, 1
    s_mov_b64 exec, 1
    ds_add_u32 v1, v8 offset:40
    s_mov_b64 exec, -1
    s_endpgm
C_FIN:
    s_setprio 0
    v_and_b32 v8, 7, v2
    v_lshlrev_b32 v8, 3, v8
    v_add_u32 v8, 16384, v8
    s_mul_i32 s8, s7, 9216
    s_add_u32 s8, s8, 32768
    v_lshl_add_u32 v5, v2, 4, s8
    v_add_u32 v6, 0x1000, v5
    v_add_u32 v7, 0x2000, v5
    s_waitcnt lgkmcnt(0)
    v_bfe_u32 v110, v10, 0, 8
    v_bfe_u32 v111, v10, 8, 8
    v_bfe_u32 v112, v10, 16, 8
    v_bfe_u32 v113, v10, 24, 8
    s_mov_b32 s9, 0
C_SPOLL:
    global_load_dwordx2 v[16:17], v8, s[50:51] sc1
    s_waitcnt vmcnt(0)
    v_cmp_ne_u32 vcc, v17, v10
    s_add_u32 s9, s9, 1
    s_cmp_eq_u64 vcc, 0
    s_cbranch_scc1 C_SOK
    s_sleep 4
    s_cmp_lt_u32 s9, 131072
    s_cbranch_scc1 C_SPOLL
C_SOK:
    s_setprio 3
    s_mov_b32 s9, 0
SP_15:
    ds_read_b32 v12, v1 offset:84
    s_waitcnt lgkmcnt(0)
    v_readfirstlane_b32 s8, v12
    s_add_u32 s9, s9, 1
    s_cmp_ge_u32 s8, 1
    s_cbranch_scc1 SP_15_D
    s_sleep 2
    s_cmp_lt_u32 s9, 524288
    s_cbranch_scc1 SP_15
SP_15_D:
    s_setprio 3
    v_and_b32 v18, 0x7ff, v16
    v_sub_u32 v18, 2047, v18
    v_and_b32 v19, 1, v4
    v_lshrrev_b32 v20, 1, v4
    v_lshl_or_b32 v19, v19, 1, v20
    v_lshlrev_b32 v19, 1, v19
    v_and_b32 v22, 0x7ff, v16
    v_mul_u32_u24 v23, 2336, v19
    v_lshl_add_u32 v23, v22, 1, v23
    v_add_u32 v23, 72960, v23
    ds_read_u16 v105, v23
    v_and_b32 v20, 0xffff0000, v16
    v_ashrrev_i32 v21, 31, v20
    v_not_b32 v21, v21
    v_or_b32 v21, 0x80000000, v21
    v_and_b32 v21, 0xffff0000, v21
    v_xor_b32 v20, v20, v21
    v_mul_f32 v21, 0xbfb8aa3b, v20
    v_exp_f32 v21, v21
    s_nop 0
    v_add_f32 v21, 1.0, v21
    v_rcp_f32 v104, v21
    s_nop 0
    v_cvt_pk_bf16_f32 v104, v104, v104
    v_and_b32 v104, 0xffff0000, v104
    v_lshlrev_b32 v106, 2, v18
    v_add_u32 v106, 91648, v106
    v_mul_u32_u24 v107, 2080, v19
    v_lshl_add_u32 v107, v22, 1, v107
    v_add_u32 v107, 99840, v107
    v_mul_u32_u24 v108, 1152, v18
    v_add3_u32 v108, v108, v19, s55
    s_waitcnt lgkmcnt(0)
    v_lshlrev_b32 v105, 16, v105
    s_mov_b32 s9, 0
    s_setprio 0
    s_mov_b64 exec, 1
C_M1:
    ds_read_b32 v26, v1 offset:100
    s_waitcnt lgkmcnt(0)
    v_readfirstlane_b32 s8, v26
    s_cmp_ge_u32 s8, 1
    s_cbranch_scc1 C_M1S
    global_load_dword v26, v5, s[50:51] sc1
    s_waitcnt vmcnt(0)
    v_xor_b32 v26, v26, v10
    v_and_b32 v26, 0xff, v26
    v_cmp_ne_u32 vcc, 0, v26
    s_add_u32 s9, s9, 1
    s_cmp_eq_u64 vcc, 0
    s_cbranch_scc1 C_M1D
    s_cmp_lt_u32 s9, 131072
    s_cbranch_scc1 C_M1
C_M1S:
    s_mov_b32 s9, 0
SP_16:
    ds_read_b32 v26, v1 offset:44
    s_waitcnt lgkmcnt(0)
    v_readfirstlane_b32 s8, v26
    s_add_u32 s9, s9, 1
    s_cmp_ge_u32 s8, 4
    s_cbranch_scc1 SP_16_D
    s_sleep 1
    s_cmp_lt_u32 s9, 524288
    s_cbranch_scc1 SP_16
SP_16_D:
C_M1D:
    s_mov_b64 exec, -1
    s_setprio 3
    s_mov_b32 s9, 0
C_MPOLL:
    global_load_dwordx4 v[120:123], v5, s[50:51] offset:0 sc1
    global_load_dwordx4 v[124:127], v5, s[50:51] offset:1024 sc1
    global_load_dwordx4 v[128:131], v5, s[50:51] offset:2048 sc1
    global_load_dwordx4 v[132:135], v5, s[50:51] offset:3072 sc1
    global_load_dwordx4 v[136:139], v6, s[50:51] offset:0 sc1
    global_load_dwordx4 v[140:143], v6, s[50:51] offset:1024 sc1
    global_load_dwordx4 v[144:147], v6, s[50:51] offset:2048 sc1
    global_load_dwordx4 v[148:151], v6, s[50:51] offset:3072 sc1
    global_load_dwordx4 v[152:155], v7, s[50:51] offset:0 sc1
    s_waitcnt vmcnt(8)
    v_xor_b32 v120, v120, v110
    v_xor_b32 v121, v121, v111
    v_xor_b32 v122, v122, v112
    v_xor_b32 v123, v123, v113
    v_or3_b32 v26, v120, v121, 0
    v_or3_b32 v26, v122, v123, v26
    s_waitcnt vmcnt(7)
    v_xor_b32 v124, v124, v110
    v_xor_b32 v125, v125, v111
    v_xor_b32 v126, v126, v112
    v_xor_b32 v127, v127, v113
    v_or3_b32 v26, v124, v125, v26
    v_or3_b32 v26, v126, v127, v26
    v_pk_add_f32 v[28:29], v[120:121], v[124:125]
    v_pk_add_f32 v[30:31], v[122:123], v[126:127]
    s_waitcnt vmcnt(6)
    v_xor_b32 v128, v128, v110
    v_xor_b32 v129, v129, v111
    v_xor_b32 v130, v130, v112
    v_xor_b32 v131, v131, v113
    v_or3_b32 v26, v128, v129, v26
    v_or3_b32 v26, v130, v131, v26
    v_pk_add_f32 v[28:29], v[28:29], v[128:129]
    v_pk_add_f32 v[30:31], v[30:31], v[130:131]
    s_waitcnt vmcnt(5)
    v_xor_b32 v132, v132, v110
    v_xor_b32 v133, v133, v111
    v_xor_b32 v134, v134, v112
    v_xor_b32 v135, v135, v113
    v_or3_b32 v26, v132, v133, v26
    v_or3_b32 v26, v134, v135, v26
    v_pk_add_f32 v[28:29], v[28:29], v[132:133]
    v_pk_add_f32 v[30:31], v[30:31], v[134:135]
    s_waitcnt vmcnt(4)
    v_xor_b32 v136, v136, v110
    v_xor_b32 v137, v137, v111
    v_xor_b32 v138, v138, v112
    v_xor_b32 v139, v139, v113
    v_or3_b32 v26, v136, v137, v26
    v_or3_b32 v26, v138, v139, v26
    v_pk_add_f32 v[28:29], v[28:29], v[136:137]
    v_pk_add_f32 v[30:31], v[30:31], v[138:139]
    s_waitcnt vmcnt(3)
    v_xor_b32 v140, v140, v110
    v_xor_b32 v141, v141, v111
    v_xor_b32 v142, v142, v112
    v_xor_b32 v143, v143, v113
    v_or3_b32 v26, v140, v141, v26
    v_or3_b32 v26, v142, v143, v26
    v_pk_add_f32 v[28:29], v[28:29], v[140:141]
    v_pk_add_f32 v[30:31], v[30:31], v[142:143]
    s_waitcnt vmcnt(2)
    v_xor_b32 v144, v144, v110
    v_xor_b32 v145, v145, v111
    v_xor_b32 v146, v146, v112
    v_xor_b32 v147, v147, v113
    v_or3_b32 v26, v144, v145, v26
    v_or3_b32 v26, v146, v147, v26
    v_pk_add_f32 v[28:29], v[28:29], v[144:145]
    v_pk_add_f32 v[30:31], v[30:31], v[146:147]
    s_waitcnt vmcnt(1)
    v_xor_b32 v148, v148, v110
    v_xor_b32 v149, v149, v111
    v_xor_b32 v150, v150, v112
    v_xor_b32 v151, v151, v113
    v_or3_b32 v26, v148, v149, v26
    v_or3_b32 v26, v150, v151, v26
    v_pk_add_f32 v[28:29], v[28:29], v[148:149]
    v_pk_add_f32 v[30:31], v[30:31], v[150:151]
    s_waitcnt vmcnt(0)
    v_xor_b32 v152, v152, v110
    v_xor_b32 v153, v153, v111
    v_xor_b32 v154, v154, v112
    v_xor_b32 v155, v155, v113
    v_or3_b32 v26, v152, v153, v26
    v_or3_b32 v26, v154, v155, v26
    v_pk_add_f32 v[28:29], v[28:29], v[152:153]
    v_pk_add_f32 v[30:31], v[30:31], v[154:155]
    v_and_b32 v26, 0xff, v26
    v_cmp_ne_u32 vcc, 0, v26
    s_add_u32 s9, s9, 1
    s_cmp_eq_u64 vcc, 0
    s_cbranch_scc1 C_MOK
    s_sleep 2
    s_cmp_lt_u32 s9, 131072
    s_cbranch_scc1 C_MPOLL
C_MOK:
    v_permlane32_swap_b32 v28, v29
    v_permlane32_swap_b32 v30, v31
    v_add_f32 v28, v28, v29
    v_add_f32 v30, v30, v31
    s_nop 1
    v_permlane16_swap_b32 v28, v30
    v_add_f32 v28, v28, v30
    s_nop 1
    v_add_f32_dpp v28, v28, v28 row_ror:8 row_mask:0xf bank_mask:0xf
    v_cvt_pk_bf16_f32 v28, v28, v28
    v_and_b32 v28, 0xffff0000, v28
    v_mul_f32 v28, v28, v104
    v_cvt_pk_bf16_f32 v28, v28, v28
    v_and_b32 v28, 0xffff0000, v28
    v_add_f32 v28, v28, v105
    v_cvt_pk_bf16_f32 v28, v28, v28
    v_and_b32 v28, 0xffff0000, v28
    s_setprio 0
    s_mov_b32 s9, 0
SP_17:
    ds_read_b32 v27, v1 offset:40
    s_waitcnt lgkmcnt(0)
    v_readfirstlane_b32 s8, v27
    s_add_u32 s9, s9, 1
    s_cmp_ge_u32 s8, 4
    s_cbranch_scc1 SP_17_D
    s_cmp_lt_u32 s9, 524288
    s_cbranch_scc1 SP_17
SP_17_D:
    s_setprio 3
    ds_read_b32 v25, v106
    ds_read_u16 v24, v107
    s_waitcnt lgkmcnt(0)
    v_sub_f32 v26, 1.0, v25
    v_lshlrev_b32 v24, 16, v24
    v_cvt_pk_bf16_f32 v26, v26, v26
    v_and_b32 v26, 0xffff0000, v26
    v_mul_f32 v28, v28, v26
    v_fmac_f32 v28, v24, v25
    v_cvt_pk_bf16_f32 v28, v28, v28
    s_mov_b32 exec_lo, 0x00ff00ff
    s_mov_b32 exec_hi, 0x00ff00ff
    global_store_short v108, v28, s[46:47]
    s_mov_b64 exec, -1
    s_endpgm
HELPER:
    s_cmp_ge_u32 s3, 6
    s_cbranch_scc1 K_END
    s_and_b32 s12, s3, 1
    s_sub_u32 s13, s3, 2
    s_lshr_b32 s13, s13, 1
    s_mul_i32 s13, s13, 5
    s_add_u32 s13, s13, s5
    s_add_u32 s13, s13, 44
    v_mul_u32_u24 v5, 57, v2
    v_lshrrev_b32 v5, 9, v5
    v_mul_u32_u24 v6, 9, v5
    v_sub_u32 v6, v2, v6
    s_waitcnt lgkmcnt(0)
    s_cmp_eq_u32 s12, 1
    s_cselect_b32 s52, s40, s38
    s_cselect_b32 s53, s41, s39
    s_mov_b32 s54, 5308416
    s_mov_b32 s55, 0x20000
    v_mul_u32_u24 v5, 9216, v5
    v_lshl_add_u32 v5, v6, 7, v5
    s_mul_i32 s8, s4, 1152
    s_sub_u32 s14, s13, 53
    s_lshr_b32 s9, s52, 7
    s_add_u32 s9, s9, s4
    s_sub_u32 s9, 3, s9
    s_and_b32 s9, s9, 7
    s_lshl_b32 s15, s9, 7
    s_add_u32 s15, s15, s8
    s_mul_i32 s14, s14, 258048
    s_add_u32 s15, s15, s14
    s_add_u32 s15, s15, 838656
    s_cmp_eq_u32 s9, 0
    s_cselect_b32 s9, 1024, 0
    v_and_b32 v7, 31, v2
    v_min_u32 v7, 27, v7
    v_mul_u32_u24 v7, 9216, v7
    v_lshrrev_b32 v9, 5, v2
    v_mul_u32_u24 v9, s9, v9
    v_add_u32 v7, v7, v9
    s_mul_i32 s13, s13, 64512
    s_add_u32 s13, s13, s8
    s_mov_b32 s9, 0
SP_18:
    ds_read_b32 v13, v1 offset:4
    s_waitcnt lgkmcnt(0)
    v_readfirstlane_b32 s8, v13
    s_add_u32 s9, s9, 1
    s_cmp_ge_u32 s8, 1
    s_cbranch_scc1 SP_18_D
    s_cmp_lt_u32 s9, 524288
    s_cbranch_scc1 SP_18
SP_18_D:
    buffer_load_dword v8, v7, s[52:55], s15 offen
    s_waitcnt vmcnt(0)
    buffer_load_dword v8, v5, s[52:55], s13 offen
    s_add_u32 s13, s13, 645120
    s_waitcnt vmcnt(0)
    buffer_load_dword v8, v5, s[52:55], s13 offen
    s_add_u32 s13, s13, 645120
    s_waitcnt vmcnt(0)
    buffer_load_dword v8, v5, s[52:55], s13 offen
    s_add_u32 s13, s13, 645120
    s_endpgm
GATE:
    s_lshl_b32 s8, s12, 9
    s_add_u32 s8, s8, 147712
    v_lshl_add_u32 v5, v2, 2, s8
    v_and_b32 v6, 31, v2
    v_lshlrev_b32 v6, 2, v6
    v_add_u32 v6, 158080, v6
    s_lshl_b32 s8, s2, 1
    s_add_u32 s8, s8, s12
    v_mov_b32 v8, 0
    v_mov_b32 v9, 0
    v_mov_b32 v10, 0x3f803f80
    s_lshl_b32 s8, s8, 4
    s_add_u32 s8, s8, 8192
    v_lshrrev_b32 v7, 5, v2
    v_lshl_add_u32 v7, v7, 3, s8
    s_mov_b32 s9, 0
SP_19:
    ds_read_b32 v13, v1 offset:8
    s_waitcnt lgkmcnt(0)
    v_readfirstlane_b32 s8, v13
    s_add_u32 s9, s9, 1
    s_cmp_lg_u32 s8, 0
    s_cbranch_scc1 SP_19_D
    s_sleep 1
    s_cmp_lt_u32 s9, 524288
    s_cbranch_scc1 SP_19
SP_19_D:
    ds_read2_b32 v[34:35], v6 offset0:0 offset1:32
    ds_read2_b32 v[36:37], v6 offset0:64 offset1:96
    ds_read2_b32 v[38:39], v6 offset0:128 offset1:160
    ds_read2_b32 v[40:41], v6 offset0:192 offset1:224
    ds_read_b32 v42, v6 offset:1024
    ds_read2st64_b32 v[16:17], v5 offset0:0 offset1:1
    ds_read2st64_b32 v[18:19], v5 offset0:4 offset1:5
    ds_read2st64_b32 v[20:21], v5 offset0:8 offset1:9
    ds_read2st64_b32 v[22:23], v5 offset0:12 offset1:13
    ds_read2st64_b32 v[24:25], v5 offset0:16 offset1:17
    ds_read2st64_b32 v[26:27], v5 offset0:20 offset1:21
    ds_read2st64_b32 v[28:29], v5 offset0:24 offset1:25
    ds_read2st64_b32 v[30:31], v5 offset0:28 offset1:29
    ds_read2st64_b32 v[32:33], v5 offset0:32 offset1:33
    s_waitcnt lgkmcnt(13)
    v_and_b32 v44, 0xffff, v34
    v_and_b32 v34, 0xffff0000, v34
    v_and_b32 v45, 0xffff, v35
    v_and_b32 v35, 0xffff0000, v35
    s_waitcnt lgkmcnt(12)
    v_and_b32 v46, 0xffff, v36
    v_and_b32 v36, 0xffff0000, v36
    v_and_b32 v47, 0xffff, v37
    v_and_b32 v37, 0xffff0000, v37
    s_waitcnt lgkmcnt(11)
    v_and_b32 v48, 0xffff, v38
    v_and_b32 v38, 0xffff0000, v38
    v_and_b32 v49, 0xffff, v39
    v_and_b32 v39, 0xffff0000, v39
    s_waitcnt lgkmcnt(10)
    v_and_b32 v50, 0xffff, v40
    v_and_b32 v40, 0xffff0000, v40
    v_and_b32 v51, 0xffff, v41
    v_and_b32 v41, 0xffff0000, v41
    s_waitcnt lgkmcnt(9)
    v_and_b32 v52, 0xffff, v42
    v_and_b32 v42, 0xffff0000, v42
    s_waitcnt lgkmcnt(8)
    v_dot2_f32_bf16 v56, v16, v44, 0
    v_dot2_f32_bf16 v57, v16, v34, 0
    v_dot2_f32_bf16 v58, v17, v44, 0
    v_dot2_f32_bf16 v59, v17, v34, 0
    s_waitcnt lgkmcnt(7)
    v_dot2_f32_bf16 v60, v18, v45, 0
    v_dot2_f32_bf16 v61, v18, v35, 0
    v_dot2_f32_bf16 v62, v19, v45, 0
    v_dot2_f32_bf16 v63, v19, v35, 0
    v_cvt_pk_bf16_f32 v56, v56, v57
    v_cvt_pk_bf16_f32 v58, v58, v59
    v_dot2c_f32_bf16 v8, v56, v10
    v_dot2c_f32_bf16 v9, v58, v10
    s_waitcnt lgkmcnt(6)
    v_dot2_f32_bf16 v56, v20, v46, 0
    v_dot2_f32_bf16 v57, v20, v36, 0
    v_dot2_f32_bf16 v58, v21, v46, 0
    v_dot2_f32_bf16 v59, v21, v36, 0
    v_cvt_pk_bf16_f32 v60, v60, v61
    v_cvt_pk_bf16_f32 v62, v62, v63
    v_dot2c_f32_bf16 v8, v60, v10
    v_dot2c_f32_bf16 v9, v62, v10
    s_waitcnt lgkmcnt(5)
    v_dot2_f32_bf16 v60, v22, v47, 0
    v_dot2_f32_bf16 v61, v22, v37, 0
    v_dot2_f32_bf16 v62, v23, v47, 0
    v_dot2_f32_bf16 v63, v23, v37, 0
    v_cvt_pk_bf16_f32 v56, v56, v57
    v_cvt_pk_bf16_f32 v58, v58, v59
    v_dot2c_f32_bf16 v8, v56, v10
    v_dot2c_f32_bf16 v9, v58, v10
    s_waitcnt lgkmcnt(4)
    v_dot2_f32_bf16 v56, v24, v48, 0
    v_dot2_f32_bf16 v57, v24, v38, 0
    v_dot2_f32_bf16 v58, v25, v48, 0
    v_dot2_f32_bf16 v59, v25, v38, 0
    v_cvt_pk_bf16_f32 v60, v60, v61
    v_cvt_pk_bf16_f32 v62, v62, v63
    v_dot2c_f32_bf16 v8, v60, v10
    v_dot2c_f32_bf16 v9, v62, v10
    s_waitcnt lgkmcnt(3)
    v_dot2_f32_bf16 v60, v26, v49, 0
    v_dot2_f32_bf16 v61, v26, v39, 0
    v_dot2_f32_bf16 v62, v27, v49, 0
    v_dot2_f32_bf16 v63, v27, v39, 0
    v_cvt_pk_bf16_f32 v56, v56, v57
    v_cvt_pk_bf16_f32 v58, v58, v59
    v_dot2c_f32_bf16 v8, v56, v10
    v_dot2c_f32_bf16 v9, v58, v10
    s_waitcnt lgkmcnt(2)
    v_dot2_f32_bf16 v56, v28, v50, 0
    v_dot2_f32_bf16 v57, v28, v40, 0
    v_dot2_f32_bf16 v58, v29, v50, 0
    v_dot2_f32_bf16 v59, v29, v40, 0
    v_cvt_pk_bf16_f32 v60, v60, v61
    v_cvt_pk_bf16_f32 v62, v62, v63
    v_dot2c_f32_bf16 v8, v60, v10
    v_dot2c_f32_bf16 v9, v62, v10
    s_waitcnt lgkmcnt(1)
    v_dot2_f32_bf16 v60, v30, v51, 0
    v_dot2_f32_bf16 v61, v30, v41, 0
    v_dot2_f32_bf16 v62, v31, v51, 0
    v_dot2_f32_bf16 v63, v31, v41, 0
    v_cvt_pk_bf16_f32 v56, v56, v57
    v_cvt_pk_bf16_f32 v58, v58, v59
    v_dot2c_f32_bf16 v8, v56, v10
    v_dot2c_f32_bf16 v9, v58, v10
    s_waitcnt lgkmcnt(0)
    v_dot2_f32_bf16 v56, v32, v52, 0
    v_dot2_f32_bf16 v57, v32, v42, 0
    v_dot2_f32_bf16 v58, v33, v52, 0
    v_dot2_f32_bf16 v59, v33, v42, 0
    v_cvt_pk_bf16_f32 v60, v60, v61
    v_cvt_pk_bf16_f32 v62, v62, v63
    v_dot2c_f32_bf16 v8, v60, v10
    v_dot2c_f32_bf16 v9, v62, v10
    v_cvt_pk_bf16_f32 v56, v56, v57
    v_cvt_pk_bf16_f32 v58, v58, v59
    v_dot2c_f32_bf16 v8, v56, v10
    v_dot2c_f32_bf16 v9, v58, v10
    v_mov_b32 v11, 1
    s_mov_b64 exec, 1
    ds_add_u32 v1, v11 offset:12
    s_mov_b64 exec, -1
    v_permlane16_swap_b32 v8, v9
    v_add_f32 v8, v8, v9
    s_nop 1
    v_add_f32_dpp v8, v8, v8 row_ror:8 row_mask:0xf bank_mask:0xf
    s_nop 1
    v_add_f32_dpp v8, v8, v8 row_ror:4 row_mask:0xf bank_mask:0xf
    s_nop 1
    v_add_f32_dpp v8, v8, v8 row_ror:2 row_mask:0xf bank_mask:0xf
    s_nop 1
    v_add_f32_dpp v8, v8, v8 row_ror:1 row_mask:0xf bank_mask:0xf
    v_cvt_pk_bf16_f32 v8, v8, v8
    v_and_b32 v8, 0xffff0000, v8
    v_mul_f32 v9, 0xbfb8aa3b, v8
    v_exp_f32 v9, v9
    s_nop 0
    v_add_f32 v9, 1.0, v9
    v_rcp_f32 v8, v9
    s_nop 0
    v_cvt_pk_bf16_f32 v8, v8, v8
    s_mov_b32 s11, 0xffff
    v_mov_b32 v9, v8
    v_lshl_add_u32 v7, v4, 3, v7
    s_nop 0
    v_permlane32_swap_b32 v8, v9
    v_bfi_b32 v12, s11, v8, v9
    s_mov_b64 exec, 0x00010001
    global_store_dwordx2 v7, v[12:13], s[50:51] sc1
    s_mov_b64 exec, -1
    s_cmp_lt_u32 s5, 9
    s_cbranch_scc1 F_COMP2
    s_cmp_ge_u32 s5, 14
    s_cbranch_scc1 C_IO
    s_endpgm
C_KBODY:
C_SETD:
    s_waitcnt lgkmcnt(0)
    s_lshl_b32 s8, s12, 4
    s_lshr_b64 s[58:59], s[58:59], s8
    s_lshl_b32 s8, s58, 16
    v_mov_b32 v44, s8
    v_mul_f32 v45, 0x3fb8aa3b, v44
    v_mov_b32 v46, 0x3fb8aa3b
    v_fma_f32 v46, v44, v46, -v45
    v_mov_b32 v47, 0x32a57060
    v_fma_f32 v46, v44, v47, v46
    v_exp_f32 v45, v45
    v_mul_f32 v46, 0x3f317218, v46
    v_fma_f32 v45, v45, v46, v45
    v_cvt_pk_bf16_f32 v45, v45, v45
    v_and_b32 v36, 0xffff0000, v45
    v_mul_f32 v37, 0x3fb8aa3b, v36
    v_mul_f32 v38, 0x3e22f983, v36
    s_waitcnt vmcnt(0)
    v_mul_f32 v40, v16, v37
    v_mul_f32 v41, v17, v38
    v_exp_f32 v24, v40
    v_fract_f32 v47, v41
    v_cos_f32 v46, v47
    v_sin_f32 v47, v47
    v_mul_f32 v46, v24, v46
    v_mul_f32 v47, v24, v47
    v_mul_f32 v18, v18, v36
    v_mul_f32 v19, v19, v36
    v_pk_mul_f32 v[42:43], v[20:21], v[18:19] op_sel:[0,0] op_sel_hi:[0,1]
    v_pk_fma_f32 v[42:43], v[20:21], v[18:19], v[42:43] op_sel:[1,1,0] op_sel_hi:[1,0,1] neg_lo:[0,1,0]
    v_max_f32 v39, |v42|, |v43|
    v_pk_mul_f32 v[48:49], v[46:47], v[46:47] op_sel:[0,0] op_sel_hi:[0,1]
    v_pk_fma_f32 v[48:49], v[46:47], v[46:47], v[48:49] op_sel:[1,1,0] op_sel_hi:[1,0,1] neg_lo:[0,1,0]
    v_pk_mul_f32 v[52:53], v[48:49], v[48:49] op_sel:[0,0] op_sel_hi:[0,1]
    v_pk_fma_f32 v[52:53], v[48:49], v[48:49], v[52:53] op_sel:[1,1,0] op_sel_hi:[1,0,1] neg_lo:[0,1,0]
    v_pk_mul_f32 v[60:61], v[52:53], v[52:53] op_sel:[0,0] op_sel_hi:[0,1]
    v_pk_fma_f32 v[60:61], v[52:53], v[52:53], v[60:61] op_sel:[1,1,0] op_sel_hi:[1,0,1] neg_lo:[0,1,0]
    v_mov_b32 v30, 0x3c00
    v_xor_b32 v61, 0x80000000, v61
    ds_write_addtid_b32 v30
    v_cvt_pk_f16_f32 v26, v60, v61
    v_pk_mul_f32 v[62:63], v[60:61], v[60:61] op_sel:[0,0] op_sel_hi:[0,1]
    v_pk_fma_f32 v[62:63], v[60:61], v[60:61], v[62:63] op_sel:[1,1,0] op_sel_hi:[1,0,1] neg_lo:[0,1,0]
    v_max_u32_dpp v39, v39, v39 row_shr:1 row_mask:0xf bank_mask:0xf
    ds_write_addtid_b32 v26 offset:288
    v_cvt_pk_f16_f32 v27, v62, v63
    v_pk_mul_f32 v[64:65], v[62:63], v[60:61] op_sel:[0,0] op_sel_hi:[0,1]
    v_pk_fma_f32 v[64:65], v[62:63], v[60:61], v[64:65] op_sel:[1,1,0] op_sel_hi:[1,0,1] neg_lo:[0,1,0]
    v_max_u32_dpp v39, v39, v39 row_shr:2 row_mask:0xf bank_mask:0xf
    ds_write_addtid_b32 v27 offset:576
    v_cvt_pk_f16_f32 v28, v64, v65
    v_pk_mul_f32 v[62:63], v[64:65], v[60:61] op_sel:[0,0] op_sel_hi:[0,1]
    v_pk_fma_f32 v[62:63], v[64:65], v[60:61], v[62:63] op_sel:[1,1,0] op_sel_hi:[1,0,1] neg_lo:[0,1,0]
    v_max_u32_dpp v39, v39, v39 row_shr:4 row_mask:0xf bank_mask:0xf
    ds_write_addtid_b32 v28 offset:864
    v_cvt_pk_f16_f32 v29, v62, v63
    v_pk_mul_f32 v[64:65], v[62:63], v[60:61] op_sel:[0,0] op_sel_hi:[0,1]
    v_pk_fma_f32 v[64:65], v[62:63], v[60:61], v[64:65] op_sel:[1,1,0] op_sel_hi:[1,0,1] neg_lo:[0,1,0]
    v_max_u32_dpp v39, v39, v39 row_shr:8 row_mask:0xf bank_mask:0xf
    ds_write_addtid_b32 v29 offset:1152
    v_cvt_pk_f16_f32 v26, v64, v65
    v_pk_mul_f32 v[62:63], v[64:65], v[60:61] op_sel:[0,0] op_sel_hi:[0,1]
    v_pk_fma_f32 v[62:63], v[64:65], v[60:61], v[62:63] op_sel:[1,1,0] op_sel_hi:[1,0,1] neg_lo:[0,1,0]
    v_max_u32_dpp v39, v39, v39 row_bcast:15 row_mask:0xa bank_mask:0xf
    ds_write_addtid_b32 v26 offset:1440
    v_cvt_pk_f16_f32 v27, v62, v63
    v_pk_mul_f32 v[64:65], v[62:63], v[60:61] op_sel:[0,0] op_sel_hi:[0,1]
    v_pk_fma_f32 v[64:65], v[62:63], v[60:61], v[64:65] op_sel:[1,1,0] op_sel_hi:[1,0,1] neg_lo:[0,1,0]
    v_max_u32_dpp v39, v39, v39 row_bcast:31 row_mask:0xc bank_mask:0xf
    ds_write_addtid_b32 v27 offset:1728
    v_cvt_pk_f16_f32 v28, v64, v65
    v_pk_mul_f32 v[62:63], v[64:65], v[60:61] op_sel:[0,0] op_sel_hi:[0,1]
    v_pk_fma_f32 v[62:63], v[64:65], v[60:61], v[62:63] op_sel:[1,1,0] op_sel_hi:[1,0,1] neg_lo:[0,1,0]
    v_readlane_b32 s8, v39, 63
    ds_write_addtid_b32 v28 offset:2016
    v_cvt_pk_f16_f32 v29, v62, v63
    v_pk_mul_f32 v[64:65], v[62:63], v[60:61] op_sel:[0,0] op_sel_hi:[0,1]
    v_pk_fma_f32 v[64:65], v[62:63], v[60:61], v[64:65] op_sel:[1,1,0] op_sel_hi:[1,0,1] neg_lo:[0,1,0]
    ds_write_addtid_b32 v29 offset:2304
    v_cvt_pk_f16_f32 v26, v64, v65
    v_pk_mul_f32 v[62:63], v[64:65], v[60:61] op_sel:[0,0] op_sel_hi:[0,1]
    v_pk_fma_f32 v[62:63], v[64:65], v[60:61], v[62:63] op_sel:[1,1,0] op_sel_hi:[1,0,1] neg_lo:[0,1,0]
    ds_write_addtid_b32 v26 offset:2592
    v_cvt_pk_f16_f32 v27, v62, v63
    v_pk_mul_f32 v[64:65], v[62:63], v[60:61] op_sel:[0,0] op_sel_hi:[0,1]
    v_pk_fma_f32 v[64:65], v[62:63], v[60:61], v[64:65] op_sel:[1,1,0] op_sel_hi:[1,0,1] neg_lo:[0,1,0]
    ds_write_addtid_b32 v27 offset:2880
    v_cvt_pk_f16_f32 v28, v64, v65
    v_pk_mul_f32 v[62:63], v[64:65], v[60:61] op_sel:[0,0] op_sel_hi:[0,1]
    v_pk_fma_f32 v[62:63], v[64:65], v[60:61], v[62:63] op_sel:[1,1,0] op_sel_hi:[1,0,1] neg_lo:[0,1,0]
    ds_write_addtid_b32 v28 offset:3168
    v_cvt_pk_f16_f32 v29, v62, v63
    v_pk_mul_f32 v[64:65], v[62:63], v[60:61] op_sel:[0,0] op_sel_hi:[0,1]
    v_pk_fma_f32 v[64:65], v[62:63], v[60:61], v[64:65] op_sel:[1,1,0] op_sel_hi:[1,0,1] neg_lo:[0,1,0]
    ds_write_addtid_b32 v29 offset:3456
    v_cvt_pk_f16_f32 v26, v64, v65
    v_pk_mul_f32 v[62:63], v[64:65], v[60:61] op_sel:[0,0] op_sel_hi:[0,1]
    v_pk_fma_f32 v[62:63], v[64:65], v[60:61], v[62:63] op_sel:[1,1,0] op_sel_hi:[1,0,1] neg_lo:[0,1,0]
    ds_write_addtid_b32 v26 offset:3744
    v_cvt_pk_f16_f32 v27, v62, v63
    v_pk_mul_f32 v[64:65], v[62:63], v[60:61] op_sel:[0,0] op_sel_hi:[0,1]
    v_pk_fma_f32 v[64:65], v[62:63], v[60:61], v[64:65] op_sel:[1,1,0] op_sel_hi:[1,0,1] neg_lo:[0,1,0]
    ds_write_addtid_b32 v27 offset:4032
    v_cvt_pk_f16_f32 v28, v64, v65
    s_lshr_b32 s8, s8, 23
    s_sub_u32 s8, 258, s8
    s_min_u32 s54, s8, 253
    s_lshl_b32 s8, s54, 23
    v_mul_f32 v42, s8, v42
    v_mul_f32 v43, s8, v43
    ds_write_addtid_b32 v28 offset:4320
    ds_read_b128 v[72:75], v7 offset:0
    ds_read_b128 v[76:79], v7 offset:64
    ds_read_b128 v[80:83], v7 offset:128
    ds_read_b128 v[84:87], v7 offset:192
    v_mul_f32 v44, 0x43000000, v40
    v_mul_f32 v45, 0x43000000, v41
    v_exp_f32 v24, v44
    v_fract_f32 v45, v45
    v_cos_f32 v44, v45
    v_sin_f32 v45, v45
    v_mul_f32 v44, v24, v44
    v_mul_f32 v45, v24, v45
    v_pk_mul_f32 v[50:51], v[48:49], v[46:47] op_sel:[0,0] op_sel_hi:[0,1]
    v_pk_fma_f32 v[50:51], v[48:49], v[46:47], v[50:51] op_sel:[1,1,0] op_sel_hi:[1,0,1] neg_lo:[0,1,0]
    v_pk_mul_f32 v[54:55], v[52:53], v[46:47] op_sel:[0,0] op_sel_hi:[0,1]
    v_pk_fma_f32 v[54:55], v[52:53], v[46:47], v[54:55] op_sel:[1,1,0] op_sel_hi:[1,0,1] neg_lo:[0,1,0]
    v_pk_mul_f32 v[56:57], v[50:51], v[50:51] op_sel:[0,0] op_sel_hi:[0,1]
    v_pk_fma_f32 v[56:57], v[50:51], v[50:51], v[56:57] op_sel:[1,1,0] op_sel_hi:[1,0,1] neg_lo:[0,1,0]
    v_pk_mul_f32 v[58:59], v[56:57], v[46:47] op_sel:[0,0] op_sel_hi:[0,1]
    v_pk_fma_f32 v[58:59], v[56:57], v[46:47], v[58:59] op_sel:[1,1,0] op_sel_hi:[1,0,1] neg_lo:[0,1,0]
    v_cvt_pk_f16_f32 v29, v42, v43
    v_pk_mul_f32 v[60:61], v[42:43], v[46:47] op_sel:[0,0] op_sel_hi:[0,1]
    v_pk_fma_f32 v[60:61], v[42:43], v[46:47], v[60:61] op_sel:[1,1,0] op_sel_hi:[1,0,1] neg_lo:[0,1,0]
    ds_write_addtid_b32 v29 offset:0
    v_cvt_pk_f16_f32 v26, v60, v61
    v_pk_mul_f32 v[62:63], v[42:43], v[48:49] op_sel:[0,0] op_sel_hi:[0,1]
    v_pk_fma_f32 v[62:63], v[42:43], v[48:49], v[62:63] op_sel:[1,1,0] op_sel_hi:[1,0,1] neg_lo:[0,1,0]
    ds_write_addtid_b32 v26 offset:288
    v_cvt_pk_f16_f32 v27, v62, v63
    v_pk_mul_f32 v[60:61], v[42:43], v[50:51] op_sel:[0,0] op_sel_hi:[0,1]
    v_pk_fma_f32 v[60:61], v[42:43], v[50:51], v[60:61] op_sel:[1,1,0] op_sel_hi:[1,0,1] neg_lo:[0,1,0]
    ds_write_addtid_b32 v27 offset:576
    v_cvt_pk_f16_f32 v28, v60, v61
    v_pk_mul_f32 v[62:63], v[42:43], v[52:53] op_sel:[0,0] op_sel_hi:[0,1]
    v_pk_fma_f32 v[62:63], v[42:43], v[52:53], v[62:63] op_sel:[1,1,0] op_sel_hi:[1,0,1] neg_lo:[0,1,0]
    ds_write_addtid_b32 v28 offset:864
    v_cvt_pk_f16_f32 v29, v62, v63
    v_pk_mul_f32 v[60:61], v[42:43], v[54:55] op_sel:[0,0] op_sel_hi:[0,1]
    v_pk_fma_f32 v[60:61], v[42:43], v[54:55], v[60:61] op_sel:[1,1,0] op_sel_hi:[1,0,1] neg_lo:[0,1,0]
    ds_write_addtid_b32 v29 offset:1152
    v_cvt_pk_f16_f32 v26, v60, v61
    v_pk_mul_f32 v[62:63], v[42:43], v[56:57] op_sel:[0,0] op_sel_hi:[0,1]
    v_pk_fma_f32 v[62:63], v[42:43], v[56:57], v[62:63] op_sel:[1,1,0] op_sel_hi:[1,0,1] neg_lo:[0,1,0]
    ds_write_addtid_b32 v26 offset:1440
    v_cvt_pk_f16_f32 v27, v62, v63
    v_pk_mul_f32 v[60:61], v[42:43], v[58:59] op_sel:[0,0] op_sel_hi:[0,1]
    v_pk_fma_f32 v[60:61], v[42:43], v[58:59], v[60:61] op_sel:[1,1,0] op_sel_hi:[1,0,1] neg_lo:[0,1,0]
    ds_write_addtid_b32 v27 offset:1728
    v_cvt_pk_f16_f32 v28, v60, v61
    v_pk_mul_f32 v[66:67], v[42:43], v[44:45] op_sel:[0,0] op_sel_hi:[0,1]
    v_pk_fma_f32 v[66:67], v[42:43], v[44:45], v[66:67] op_sel:[1,1,0] op_sel_hi:[1,0,1] neg_lo:[0,1,0]
    ds_write_addtid_b32 v28 offset:2016
    v_cvt_pk_f16_f32 v29, v66, v67
    v_pk_mul_f32 v[62:63], v[66:67], v[46:47] op_sel:[0,0] op_sel_hi:[0,1]
    v_pk_fma_f32 v[62:63], v[66:67], v[46:47], v[62:63] op_sel:[1,1,0] op_sel_hi:[1,0,1] neg_lo:[0,1,0]
    ds_write_addtid_b32 v29 offset:2304
    v_cvt_pk_f16_f32 v26, v62, v63
    v_pk_mul_f32 v[60:61], v[66:67], v[48:49] op_sel:[0,0] op_sel_hi:[0,1]
    v_pk_fma_f32 v[60:61], v[66:67], v[48:49], v[60:61] op_sel:[1,1,0] op_sel_hi:[1,0,1] neg_lo:[0,1,0]
    ds_write_addtid_b32 v26 offset:2592
    v_cvt_pk_f16_f32 v27, v60, v61
    v_pk_mul_f32 v[62:63], v[66:67], v[50:51] op_sel:[0,0] op_sel_hi:[0,1]
    v_pk_fma_f32 v[62:63], v[66:67], v[50:51], v[62:63] op_sel:[1,1,0] op_sel_hi:[1,0,1] neg_lo:[0,1,0]
    ds_write_addtid_b32 v27 offset:2880
    v_cvt_pk_f16_f32 v28, v62, v63
    v_pk_mul_f32 v[60:61], v[66:67], v[52:53] op_sel:[0,0] op_sel_hi:[0,1]
    v_pk_fma_f32 v[60:61], v[66:67], v[52:53], v[60:61] op_sel:[1,1,0] op_sel_hi:[1,0,1] neg_lo:[0,1,0]
    ds_write_addtid_b32 v28 offset:3168
    v_cvt_pk_f16_f32 v29, v60, v61
    v_pk_mul_f32 v[62:63], v[66:67], v[54:55] op_sel:[0,0] op_sel_hi:[0,1]
    v_pk_fma_f32 v[62:63], v[66:67], v[54:55], v[62:63] op_sel:[1,1,0] op_sel_hi:[1,0,1] neg_lo:[0,1,0]
    ds_write_addtid_b32 v29 offset:3456
    v_cvt_pk_f16_f32 v26, v62, v63
    v_pk_mul_f32 v[60:61], v[66:67], v[56:57] op_sel:[0,0] op_sel_hi:[0,1]
    v_pk_fma_f32 v[60:61], v[66:67], v[56:57], v[60:61] op_sel:[1,1,0] op_sel_hi:[1,0,1] neg_lo:[0,1,0]
    ds_write_addtid_b32 v26 offset:3744
    v_cvt_pk_f16_f32 v27, v60, v61
    v_pk_mul_f32 v[62:63], v[66:67], v[58:59] op_sel:[0,0] op_sel_hi:[0,1]
    v_pk_fma_f32 v[62:63], v[66:67], v[58:59], v[62:63] op_sel:[1,1,0] op_sel_hi:[1,0,1] neg_lo:[0,1,0]
    ds_write_addtid_b32 v27 offset:4032
    v_cvt_pk_f16_f32 v28, v62, v63
    v_pk_mul_f32 v[68:69], v[66:67], v[44:45] op_sel:[0,0] op_sel_hi:[0,1]
    v_pk_fma_f32 v[68:69], v[66:67], v[44:45], v[68:69] op_sel:[1,1,0] op_sel_hi:[1,0,1] neg_lo:[0,1,0]
    ds_write_addtid_b32 v28 offset:4320
    ds_read_b128 v[88:91], v7 offset:0
    ds_read_b128 v[92:95], v7 offset:64
    ds_read_b128 v[96:99], v7 offset:128
    ds_read_b128 v[100:103], v7 offset:192
    v_cvt_pk_f16_f32 v29, v68, v69
    v_pk_mul_f32 v[60:61], v[68:69], v[48:49] op_sel:[0,0] op_sel_hi:[0,1]
    v_pk_fma_f32 v[60:61], v[68:69], v[48:49], v[60:61] op_sel:[1,1,0] op_sel_hi:[1,0,1] neg_lo:[0,1,0]
    ds_write_addtid_b32 v29 offset:0
    v_cvt_pk_f16_f32 v26, v60, v61
    v_pk_mul_f32 v[62:63], v[68:69], v[52:53] op_sel:[0,0] op_sel_hi:[0,1]
    v_pk_fma_f32 v[62:63], v[68:69], v[52:53], v[62:63] op_sel:[1,1,0] op_sel_hi:[1,0,1] neg_lo:[0,1,0]
    ds_write_addtid_b32 v26 offset:288
    v_cvt_pk_f16_f32 v27, v62, v63
    v_pk_mul_f32 v[60:61], v[68:69], v[56:57] op_sel:[0,0] op_sel_hi:[0,1]
    v_pk_fma_f32 v[60:61], v[68:69], v[56:57], v[60:61] op_sel:[1,1,0] op_sel_hi:[1,0,1] neg_lo:[0,1,0]
    ds_write_addtid_b32 v27 offset:576
    v_cvt_pk_f16_f32 v28, v60, v61
    v_pk_mul_f32 v[66:67], v[68:69], v[44:45] op_sel:[0,0] op_sel_hi:[0,1]
    v_pk_fma_f32 v[66:67], v[68:69], v[44:45], v[66:67] op_sel:[1,1,0] op_sel_hi:[1,0,1] neg_lo:[0,1,0]
    ds_write_addtid_b32 v28 offset:864
    v_cvt_pk_f16_f32 v29, v66, v67
    s_waitcnt lgkmcnt(7)
    v_mfma_f32_16x16x32_f16 v[104:107], v[88:91], v[72:75], 0
    v_pk_mul_f32 v[62:63], v[66:67], v[48:49] op_sel:[0,0] op_sel_hi:[0,1]
    v_pk_fma_f32 v[62:63], v[66:67], v[48:49], v[62:63] op_sel:[1,1,0] op_sel_hi:[1,0,1] neg_lo:[0,1,0]
    ds_write_addtid_b32 v29 offset:1152
    v_cvt_pk_f16_f32 v26, v62, v63
    s_waitcnt lgkmcnt(7)
    v_mfma_f32_16x16x32_f16 v[104:107], v[92:95], v[76:79], v[104:107]
    v_pk_mul_f32 v[60:61], v[66:67], v[52:53] op_sel:[0,0] op_sel_hi:[0,1]
    v_pk_fma_f32 v[60:61], v[66:67], v[52:53], v[60:61] op_sel:[1,1,0] op_sel_hi:[1,0,1] neg_lo:[0,1,0]
    ds_write_addtid_b32 v26 offset:1440
    v_cvt_pk_f16_f32 v27, v60, v61
    s_waitcnt lgkmcnt(7)
    v_mfma_f32_16x16x32_f16 v[104:107], v[96:99], v[80:83], v[104:107]
    v_pk_mul_f32 v[62:63], v[66:67], v[56:57] op_sel:[0,0] op_sel_hi:[0,1]
    v_pk_fma_f32 v[62:63], v[66:67], v[56:57], v[62:63] op_sel:[1,1,0] op_sel_hi:[1,0,1] neg_lo:[0,1,0]
    ds_write_addtid_b32 v27 offset:1728
    v_cvt_pk_f16_f32 v28, v62, v63
    s_waitcnt lgkmcnt(7)
    v_mfma_f32_16x16x32_f16 v[104:107], v[100:103], v[84:87], v[104:107]
    v_pk_mul_f32 v[68:69], v[66:67], v[44:45] op_sel:[0,0] op_sel_hi:[0,1]
    v_pk_fma_f32 v[68:69], v[66:67], v[44:45], v[68:69] op_sel:[1,1,0] op_sel_hi:[1,0,1] neg_lo:[0,1,0]
    ds_write_addtid_b32 v28 offset:2016
    v_cvt_pk_f16_f32 v29, v68, v69
    v_pk_mul_f32 v[60:61], v[68:69], v[52:53] op_sel:[0,0] op_sel_hi:[0,1]
    v_pk_fma_f32 v[60:61], v[68:69], v[52:53], v[60:61] op_sel:[1,1,0] op_sel_hi:[1,0,1] neg_lo:[0,1,0]
    ds_write_addtid_b32 v29 offset:2304
    v_cvt_pk_f16_f32 v26, v60, v61
    v_pk_mul_f32 v[66:67], v[68:69], v[44:45] op_sel:[0,0] op_sel_hi:[0,1]
    v_pk_fma_f32 v[66:67], v[68:69], v[44:45], v[66:67] op_sel:[1,1,0] op_sel_hi:[1,0,1] neg_lo:[0,1,0]
    ds_write_addtid_b32 v26 offset:2592
    v_cvt_pk_f16_f32 v27, v66, v67
    v_pk_mul_f32 v[62:63], v[66:67], v[52:53] op_sel:[0,0] op_sel_hi:[0,1]
    v_pk_fma_f32 v[62:63], v[66:67], v[52:53], v[62:63] op_sel:[1,1,0] op_sel_hi:[1,0,1] neg_lo:[0,1,0]
    ds_write_addtid_b32 v27 offset:2880
    v_cvt_pk_f16_f32 v28, v62, v63
    v_pk_mul_f32 v[68:69], v[66:67], v[44:45] op_sel:[0,0] op_sel_hi:[0,1]
    v_pk_fma_f32 v[68:69], v[66:67], v[44:45], v[68:69] op_sel:[1,1,0] op_sel_hi:[1,0,1] neg_lo:[0,1,0]
    ds_write_addtid_b32 v28 offset:3168
    v_cvt_pk_f16_f32 v29, v68, v69
    v_pk_mul_f32 v[60:61], v[68:69], v[52:53] op_sel:[0,0] op_sel_hi:[0,1]
    v_pk_fma_f32 v[60:61], v[68:69], v[52:53], v[60:61] op_sel:[1,1,0] op_sel_hi:[1,0,1] neg_lo:[0,1,0]
    ds_write_addtid_b32 v29 offset:3456
    v_cvt_pk_f16_f32 v26, v60, v61
    v_pk_mul_f32 v[66:67], v[68:69], v[44:45] op_sel:[0,0] op_sel_hi:[0,1]
    v_pk_fma_f32 v[66:67], v[68:69], v[44:45], v[66:67] op_sel:[1,1,0] op_sel_hi:[1,0,1] neg_lo:[0,1,0]
    ds_write_addtid_b32 v26 offset:3744
    v_cvt_pk_f16_f32 v27, v66, v67
    v_pk_mul_f32 v[62:63], v[66:67], v[52:53] op_sel:[0,0] op_sel_hi:[0,1]
    v_pk_fma_f32 v[62:63], v[66:67], v[52:53], v[62:63] op_sel:[1,1,0] op_sel_hi:[1,0,1] neg_lo:[0,1,0]
    ds_write_addtid_b32 v27 offset:4032
    v_cvt_pk_f16_f32 v28, v62, v63
    v_pk_mul_f32 v[68:69], v[66:67], v[44:45] op_sel:[0,0] op_sel_hi:[0,1]
    v_pk_fma_f32 v[68:69], v[66:67], v[44:45], v[68:69] op_sel:[1,1,0] op_sel_hi:[1,0,1] neg_lo:[0,1,0]
    ds_write_addtid_b32 v28 offset:4320
    ds_read_b128 v[88:91], v7 offset:0
    ds_read_b128 v[92:95], v7 offset:64
    ds_read_b128 v[96:99], v7 offset:128
    ds_read_b128 v[100:103], v7 offset:192
    v_cvt_pk_f16_f32 v29, v68, v69
    v_pk_mul_f32 v[66:67], v[68:69], v[44:45] op_sel:[0,0] op_sel_hi:[0,1]
    v_pk_fma_f32 v[66:67], v[68:69], v[44:45], v[66:67] op_sel:[1,1,0] op_sel_hi:[1,0,1] neg_lo:[0,1,0]
    ds_write_addtid_b32 v29 offset:0
    v_cvt_pk_f16_f32 v26, v66, v67
    v_pk_mul_f32 v[68:69], v[66:67], v[44:45] op_sel:[0,0] op_sel_hi:[0,1]
    v_pk_fma_f32 v[68:69], v[66:67], v[44:45], v[68:69] op_sel:[1,1,0] op_sel_hi:[1,0,1] neg_lo:[0,1,0]
    ds_write_addtid_b32 v26 offset:288
    v_cvt_pk_f16_f32 v27, v68, v69
    v_pk_mul_f32 v[66:67], v[68:69], v[44:45] op_sel:[0,0] op_sel_hi:[0,1]
    v_pk_fma_f32 v[66:67], v[68:69], v[44:45], v[66:67] op_sel:[1,1,0] op_sel_hi:[1,0,1] neg_lo:[0,1,0]
    ds_write_addtid_b32 v27 offset:576
    v_cvt_pk_f16_f32 v28, v66, v67
    v_pk_mul_f32 v[68:69], v[66:67], v[44:45] op_sel:[0,0] op_sel_hi:[0,1]
    v_pk_fma_f32 v[68:69], v[66:67], v[44:45], v[68:69] op_sel:[1,1,0] op_sel_hi:[1,0,1] neg_lo:[0,1,0]
    ds_write_addtid_b32 v28 offset:864
    v_cvt_pk_f16_f32 v29, v68, v69
    v_pk_mul_f32 v[66:67], v[68:69], v[44:45] op_sel:[0,0] op_sel_hi:[0,1]
    v_pk_fma_f32 v[66:67], v[68:69], v[44:45], v[66:67] op_sel:[1,1,0] op_sel_hi:[1,0,1] neg_lo:[0,1,0]
    s_waitcnt lgkmcnt(7)
    v_mfma_f32_16x16x32_f16 v[108:111], v[88:91], v[72:75], 0
    ds_write_addtid_b32 v29 offset:1152
    v_cvt_pk_f16_f32 v26, v66, v67
    v_pk_mul_f32 v[68:69], v[66:67], v[44:45] op_sel:[0,0] op_sel_hi:[0,1]
    v_pk_fma_f32 v[68:69], v[66:67], v[44:45], v[68:69] op_sel:[1,1,0] op_sel_hi:[1,0,1] neg_lo:[0,1,0]
    s_waitcnt lgkmcnt(7)
    v_mfma_f32_16x16x32_f16 v[108:111], v[92:95], v[76:79], v[108:111]
    ds_write_addtid_b32 v26 offset:1440
    v_cvt_pk_f16_f32 v27, v68, v69
    v_pk_mul_f32 v[66:67], v[68:69], v[44:45] op_sel:[0,0] op_sel_hi:[0,1]
    v_pk_fma_f32 v[66:67], v[68:69], v[44:45], v[66:67] op_sel:[1,1,0] op_sel_hi:[1,0,1] neg_lo:[0,1,0]
    s_waitcnt lgkmcnt(7)
    v_mfma_f32_16x16x32_f16 v[108:111], v[96:99], v[80:83], v[108:111]
    ds_write_addtid_b32 v27 offset:1728
    v_cvt_pk_f16_f32 v28, v66, v67
    v_pk_mul_f32 v[68:69], v[66:67], v[44:45] op_sel:[0,0] op_sel_hi:[0,1]
    v_pk_fma_f32 v[68:69], v[66:67], v[44:45], v[68:69] op_sel:[1,1,0] op_sel_hi:[1,0,1] neg_lo:[0,1,0]
    s_waitcnt lgkmcnt(7)
    v_mfma_f32_16x16x32_f16 v[108:111], v[100:103], v[84:87], v[108:111]
    ds_write_addtid_b32 v28 offset:2016
    v_cvt_pk_f16_f32 v29, v68, v69
    ds_write_addtid_b32 v29 offset:2304
    ds_read_b128 v[88:91], v7 offset:0
    ds_read_b128 v[92:95], v7 offset:64
    ds_read_b128 v[96:99], v7 offset:128
    ds_read_b128 v[100:103], v7 offset:192
    v_lshl_add_u32 v8, v2, 4, s15
    s_waitcnt lgkmcnt(3)
    v_mfma_f32_16x16x32_f16 v[112:115], v[88:91], v[72:75], 0
    s_waitcnt lgkmcnt(2)
    v_mfma_f32_16x16x32_f16 v[112:115], v[92:95], v[76:79], v[112:115]
    s_waitcnt lgkmcnt(1)
    v_mfma_f32_16x16x32_f16 v[112:115], v[96:99], v[80:83], v[112:115]
    s_waitcnt lgkmcnt(0)
    v_mfma_f32_16x16x32_f16 v[112:115], v[100:103], v[84:87], v[112:115]
    s_lshl_b32 s8, s12, 2
    s_add_u32 s8, s8, 16
    v_mov_b32 v9, s8
    s_cmp_eq_u32 s13, 0
    s_cbranch_scc1 C_KA
    ds_write_b128 v8, v[104:107] offset:0
    ds_write_b128 v8, v[108:111] offset:1024
    s_nop 0
    ds_write_b128 v8, v[112:115] offset:2048
    v_mov_b32 v10, s54
    ds_write_b32 v9, v10
    s_setprio 0
    v_and_b32 v14, 3, v3
    v_sub_u32 v14, 3, v14
    v_mul_u32_u24 v14, 2240, v14
    v_lshrrev_b32 v13, 2, v3
    v_lshl_add_u32 v13, v4, 1, v13
    v_lshl_add_u32 v14, v13, 3, v14
    v_add3_u32 v5, v14, s52, 8
    v_lshlrev_b32 v14, 1, v3
    v_sub_u32 v14, v4, v14
    v_lshlrev_b32 v14, 4, v14
    s_add_u32 s8, s53, 480
    v_add_u32 v6, s8, v14
    v_lshl_add_u32 v14, v3, 2, v4
    s_mul_i32 s8, s12, 4160
    s_add_u32 s8, s8, 100344
    v_lshlrev_b32 v14, 3, v14
    v_sub_u32 v140, s8, v14
    s_setprio 3
    s_mov_b32 s9, 0
SP_20:
    ds_read_b32 v10, v1 offset:80
    s_waitcnt lgkmcnt(0)
    v_readfirstlane_b32 s8, v10
    s_add_u32 s9, s9, 1
    s_cmp_ge_u32 s8, 1
    s_cbranch_scc1 SP_20_D
    s_sleep 1
    s_cmp_lt_u32 s9, 524288
    s_cbranch_scc1 SP_20
SP_20_D:
    s_setprio 3
    s_mov_b32 s9, 0
SP_21:
    ds_read_b32 v10, v9 offset:48
    s_waitcnt lgkmcnt(0)
    v_readfirstlane_b32 s8, v10
    s_add_u32 s9, s9, 1
    s_cmp_lg_u32 s8, 0
    s_cbranch_scc1 SP_21_D
    s_cmp_lt_u32 s9, 524288
    s_cbranch_scc1 SP_21
SP_21_D:
    s_setprio 2
    ds_read_b64 v[32:33], v5 offset:0
    ds_read_b64 v[34:35], v5 offset:8
    ds_read_b128 v[60:63], v6 offset:2048
    ds_read_b128 v[56:59], v6 offset:2560
    ds_read_b128 v[52:55], v6 offset:3072
    ds_read_b128 v[48:51], v6 offset:3584
    ds_read_b64 v[36:37], v5 offset:512
    ds_read_b64 v[38:39], v5 offset:520
    ds_read_b64 v[40:41], v5 offset:1024
    ds_read_b64 v[42:43], v5 offset:1032
    ds_read_b64 v[44:45], v5 offset:1536
    ds_read_b64 v[46:47], v5 offset:1544
    s_waitcnt lgkmcnt(9)
    v_mfma_f32_16x16x32_bf16 v[28:31], v[32:35], v[60:63], 0
    ds_read_b64 v[76:77], v5 offset:64
    ds_read_b64 v[78:79], v5 offset:72
    s_waitcnt lgkmcnt(10)
    v_mfma_f32_16x16x32_bf16 v[24:27], v[32:35], v[56:59], 0
    ds_read_b128 v[104:107], v6 offset:2112
    s_waitcnt lgkmcnt(10)
    v_mfma_f32_16x16x32_bf16 v[20:23], v[32:35], v[52:55], 0
    ds_read_b128 v[100:103], v6 offset:2624
    s_waitcnt lgkmcnt(10)
    v_mfma_f32_16x16x32_bf16 v[16:19], v[32:35], v[48:51], 0
    ds_read_b128 v[96:99], v6 offset:3136
    s_waitcnt lgkmcnt(9)
    v_mfma_f32_16x16x32_bf16 v[28:31], v[36:39], v[56:59], v[28:31]
    ds_read_b128 v[92:95], v6 offset:3648
    v_mfma_f32_16x16x32_bf16 v[24:27], v[36:39], v[52:55], v[24:27]
    ds_read_b64 v[80:81], v5 offset:576
    ds_read_b64 v[82:83], v5 offset:584
    v_mfma_f32_16x16x32_bf16 v[20:23], v[36:39], v[48:51], v[20:23]
    ds_read_b64 v[84:85], v5 offset:1088
    s_waitcnt lgkmcnt(11)
    v_mfma_f32_16x16x32_bf16 v[28:31], v[40:43], v[52:55], v[28:31]
    ds_read_b64 v[86:87], v5 offset:1096
    v_mfma_f32_16x16x32_bf16 v[24:27], v[40:43], v[48:51], v[24:27]
    ds_read_b64 v[88:89], v5 offset:1600
    s_waitcnt lgkmcnt(11)
    v_mfma_f32_16x16x32_bf16 v[28:31], v[44:47], v[48:51], v[28:31]
    ds_read_b64 v[90:91], v5 offset:1608
    s_waitcnt lgkmcnt(4)
    v_mfma_f32_16x16x32_bf16 v[28:31], v[76:79], v[104:107], v[28:31]
    ds_read_b64 v[32:33], v5 offset:128
    ds_read_b64 v[34:35], v5 offset:136
    v_mfma_f32_16x16x32_bf16 v[24:27], v[76:79], v[100:103], v[24:27]
    ds_read_b128 v[60:63], v6 offset:2176
    v_mfma_f32_16x16x32_bf16 v[20:23], v[76:79], v[96:99], v[20:23]
    ds_read_b128 v[56:59], v6 offset:2688
    v_mfma_f32_16x16x32_bf16 v[16:19], v[76:79], v[92:95], v[16:19]
    ds_read_b128 v[52:55], v6 offset:3200
    v_mfma_f32_16x16x32_bf16 v[28:31], v[80:83], v[100:103], v[28:31]
    ds_read_b128 v[48:51], v6 offset:3712
    s_waitcnt lgkmcnt(6)
    v_mfma_f32_16x16x32_bf16 v[24:27], v[80:83], v[96:99], v[24:27]
    ds_read_b64 v[36:37], v5 offset:640
    ds_read_b64 v[38:39], v5 offset:648
    v_mfma_f32_16x16x32_bf16 v[20:23], v[80:83], v[92:95], v[20:23]
    ds_read_b64 v[40:41], v5 offset:1152
    v_mfma_f32_16x16x32_bf16 v[28:31], v[84:87], v[96:99], v[28:31]
    ds_read_b64 v[42:43], v5 offset:1160
    v_mfma_f32_16x16x32_bf16 v[24:27], v[84:87], v[92:95], v[24:27]
    ds_read_b64 v[44:45], v5 offset:1664
    v_mfma_f32_16x16x32_bf16 v[28:31], v[88:91], v[92:95], v[28:31]
    ds_read_b64 v[46:47], v5 offset:1672
    s_waitcnt lgkmcnt(4)
    v_mfma_f32_16x16x32_bf16 v[28:31], v[32:35], v[60:63], v[28:31]
    ds_read_b64 v[76:77], v5 offset:192
    ds_read_b64 v[78:79], v5 offset:200
    v_mfma_f32_16x16x32_bf16 v[24:27], v[32:35], v[56:59], v[24:27]
    ds_read_b128 v[104:107], v6 offset:2240
    v_mfma_f32_16x16x32_bf16 v[20:23], v[32:35], v[52:55], v[20:23]
    ds_read_b128 v[100:103], v6 offset:2752
    v_mfma_f32_16x16x32_bf16 v[16:19], v[32:35], v[48:51], v[16:19]
    ds_read_b128 v[96:99], v6 offset:3264
    v_mfma_f32_16x16x32_bf16 v[28:31], v[36:39], v[56:59], v[28:31]
    ds_read_b128 v[92:95], v6 offset:3776
    s_waitcnt lgkmcnt(6)
    v_mfma_f32_16x16x32_bf16 v[24:27], v[36:39], v[52:55], v[24:27]
    ds_read_b64 v[80:81], v5 offset:704
    ds_read_b64 v[82:83], v5 offset:712
    v_mfma_f32_16x16x32_bf16 v[20:23], v[36:39], v[48:51], v[20:23]
    ds_read_b64 v[84:85], v5 offset:1216
    v_mfma_f32_16x16x32_bf16 v[28:31], v[40:43], v[52:55], v[28:31]
    ds_read_b64 v[86:87], v5 offset:1224
    v_mfma_f32_16x16x32_bf16 v[24:27], v[40:43], v[48:51], v[24:27]
    ds_read_b64 v[88:89], v5 offset:1728
    v_mfma_f32_16x16x32_bf16 v[28:31], v[44:47], v[48:51], v[28:31]
    ds_read_b64 v[90:91], v5 offset:1736
    s_waitcnt lgkmcnt(4)
    v_mfma_f32_16x16x32_bf16 v[28:31], v[76:79], v[104:107], v[28:31]
    ds_read_b64 v[32:33], v5 offset:256
    ds_read_b64 v[34:35], v5 offset:264
    v_mfma_f32_16x16x32_bf16 v[24:27], v[76:79], v[100:103], v[24:27]
    ds_read_b128 v[60:63], v6 offset:2304
    v_mfma_f32_16x16x32_bf16 v[20:23], v[76:79], v[96:99], v[20:23]
    ds_read_b128 v[56:59], v6 offset:2816
    v_mfma_f32_16x16x32_bf16 v[16:19], v[76:79], v[92:95], v[16:19]
    ds_read_b128 v[52:55], v6 offset:3328
    v_mfma_f32_16x16x32_bf16 v[28:31], v[80:83], v[100:103], v[28:31]
    ds_read_b128 v[48:51], v6 offset:3840
    s_waitcnt lgkmcnt(6)
    v_mfma_f32_16x16x32_bf16 v[24:27], v[80:83], v[96:99], v[24:27]
    ds_read_b64 v[36:37], v5 offset:768
    ds_read_b64 v[38:39], v5 offset:776
    v_mfma_f32_16x16x32_bf16 v[20:23], v[80:83], v[92:95], v[20:23]
    ds_read_b64 v[40:41], v5 offset:1280
    v_mfma_f32_16x16x32_bf16 v[28:31], v[84:87], v[96:99], v[28:31]
    ds_read_b64 v[42:43], v5 offset:1288
    v_mfma_f32_16x16x32_bf16 v[24:27], v[84:87], v[92:95], v[24:27]
    ds_read_b64 v[44:45], v5 offset:1792
    v_mfma_f32_16x16x32_bf16 v[28:31], v[88:91], v[92:95], v[28:31]
    ds_read_b64 v[46:47], v5 offset:1800
    s_waitcnt lgkmcnt(4)
    v_mfma_f32_16x16x32_bf16 v[28:31], v[32:35], v[60:63], v[28:31]
    ds_read_b64 v[76:77], v5 offset:320
    ds_read_b64 v[78:79], v5 offset:328
    v_mfma_f32_16x16x32_bf16 v[24:27], v[32:35], v[56:59], v[24:27]
    ds_read_b128 v[104:107], v6 offset:2368
    v_mfma_f32_16x16x32_bf16 v[20:23], v[32:35], v[52:55], v[20:23]
    ds_read_b128 v[100:103], v6 offset:2880
    v_mfma_f32_16x16x32_bf16 v[16:19], v[32:35], v[48:51], v[16:19]
    ds_read_b128 v[96:99], v6 offset:3392
    v_mfma_f32_16x16x32_bf16 v[28:31], v[36:39], v[56:59], v[28:31]
    ds_read_b128 v[92:95], v6 offset:3904
    s_waitcnt lgkmcnt(6)
    v_mfma_f32_16x16x32_bf16 v[24:27], v[36:39], v[52:55], v[24:27]
    ds_read_b64 v[80:81], v5 offset:832
    ds_read_b64 v[82:83], v5 offset:840
    v_mfma_f32_16x16x32_bf16 v[20:23], v[36:39], v[48:51], v[20:23]
    ds_read_b64 v[84:85], v5 offset:1344
    v_mfma_f32_16x16x32_bf16 v[28:31], v[40:43], v[52:55], v[28:31]
    ds_read_b64 v[86:87], v5 offset:1352
    v_mfma_f32_16x16x32_bf16 v[24:27], v[40:43], v[48:51], v[24:27]
    ds_read_b64 v[88:89], v5 offset:1856
    v_mfma_f32_16x16x32_bf16 v[28:31], v[44:47], v[48:51], v[28:31]
    ds_read_b64 v[90:91], v5 offset:1864
    s_waitcnt lgkmcnt(4)
    v_mfma_f32_16x16x32_bf16 v[28:31], v[76:79], v[104:107], v[28:31]
    ds_read_b64 v[32:33], v5 offset:384
    ds_read_b64 v[34:35], v5 offset:392
    v_mfma_f32_16x16x32_bf16 v[24:27], v[76:79], v[100:103], v[24:27]
    ds_read_b128 v[60:63], v6 offset:2432
    v_mfma_f32_16x16x32_bf16 v[20:23], v[76:79], v[96:99], v[20:23]
    ds_read_b128 v[56:59], v6 offset:2944
    v_mfma_f32_16x16x32_bf16 v[16:19], v[76:79], v[92:95], v[16:19]
    ds_read_b128 v[52:55], v6 offset:3456
    v_mfma_f32_16x16x32_bf16 v[28:31], v[80:83], v[100:103], v[28:31]
    ds_read_b128 v[48:51], v6 offset:3968
    s_waitcnt lgkmcnt(6)
    v_mfma_f32_16x16x32_bf16 v[24:27], v[80:83], v[96:99], v[24:27]
    ds_read_b64 v[36:37], v5 offset:896
    ds_read_b64 v[38:39], v5 offset:904
    v_mfma_f32_16x16x32_bf16 v[20:23], v[80:83], v[92:95], v[20:23]
    ds_read_b64 v[40:41], v5 offset:1408
    v_mfma_f32_16x16x32_bf16 v[28:31], v[84:87], v[96:99], v[28:31]
    ds_read_b64 v[42:43], v5 offset:1416
    v_mfma_f32_16x16x32_bf16 v[24:27], v[84:87], v[92:95], v[24:27]
    ds_read_b64 v[44:45], v5 offset:1920
    v_mfma_f32_16x16x32_bf16 v[28:31], v[88:91], v[92:95], v[28:31]
    ds_read_b64 v[46:47], v5 offset:1928
    s_waitcnt lgkmcnt(4)
    v_mfma_f32_16x16x32_bf16 v[28:31], v[32:35], v[60:63], v[28:31]
    ds_read_b64 v[76:77], v5 offset:448
    ds_read_b64 v[78:79], v5 offset:456
    v_mfma_f32_16x16x32_bf16 v[24:27], v[32:35], v[56:59], v[24:27]
    ds_read_b128 v[104:107], v6 offset:2496
    v_mfma_f32_16x16x32_bf16 v[20:23], v[32:35], v[52:55], v[20:23]
    ds_read_b128 v[100:103], v6 offset:3008
    v_mfma_f32_16x16x32_bf16 v[16:19], v[32:35], v[48:51], v[16:19]
    ds_read_b128 v[96:99], v6 offset:3520
    v_mfma_f32_16x16x32_bf16 v[28:31], v[36:39], v[56:59], v[28:31]
    ds_read_b128 v[92:95], v6 offset:4032
    s_waitcnt lgkmcnt(6)
    v_mfma_f32_16x16x32_bf16 v[24:27], v[36:39], v[52:55], v[24:27]
    ds_read_b64 v[80:81], v5 offset:960
    ds_read_b64 v[82:83], v5 offset:968
    v_mfma_f32_16x16x32_bf16 v[20:23], v[36:39], v[48:51], v[20:23]
    ds_read_b64 v[84:85], v5 offset:1472
    v_mfma_f32_16x16x32_bf16 v[28:31], v[40:43], v[52:55], v[28:31]
    ds_read_b64 v[86:87], v5 offset:1480
    v_mfma_f32_16x16x32_bf16 v[24:27], v[40:43], v[48:51], v[24:27]
    ds_read_b64 v[88:89], v5 offset:1984
    v_mfma_f32_16x16x32_bf16 v[28:31], v[44:47], v[48:51], v[28:31]
    ds_read_b64 v[90:91], v5 offset:1992
    s_waitcnt lgkmcnt(4)
    v_mfma_f32_16x16x32_bf16 v[28:31], v[76:79], v[104:107], v[28:31]
    v_mfma_f32_16x16x32_bf16 v[24:27], v[76:79], v[100:103], v[24:27]
    v_mfma_f32_16x16x32_bf16 v[20:23], v[76:79], v[96:99], v[20:23]
    v_mfma_f32_16x16x32_bf16 v[16:19], v[76:79], v[92:95], v[16:19]
    v_mfma_f32_16x16x32_bf16 v[28:31], v[80:83], v[100:103], v[28:31]
    s_waitcnt lgkmcnt(0)
    v_mfma_f32_16x16x32_bf16 v[24:27], v[80:83], v[96:99], v[24:27]
    v_mfma_f32_16x16x32_bf16 v[20:23], v[80:83], v[92:95], v[20:23]
    v_mfma_f32_16x16x32_bf16 v[28:31], v[84:87], v[96:99], v[28:31]
    v_mfma_f32_16x16x32_bf16 v[24:27], v[84:87], v[92:95], v[24:27]
    v_mfma_f32_16x16x32_bf16 v[28:31], v[88:91], v[92:95], v[28:31]
    s_nop 0
    v_cvt_pk_bf16_f32 v124, v19, v18
    v_cvt_pk_bf16_f32 v125, v17, v16
    ds_write_b64 v140, v[124:125] offset:3584
    s_nop 0
    v_cvt_pk_bf16_f32 v126, v23, v22
    v_cvt_pk_bf16_f32 v127, v21, v20
    ds_write_b64 v140, v[126:127] offset:3072
    v_cvt_pk_bf16_f32 v128, v27, v26
    v_cvt_pk_bf16_f32 v129, v25, v24
    ds_write_b64 v140, v[128:129] offset:2560
    v_cvt_pk_bf16_f32 v130, v31, v30
    v_cvt_pk_bf16_f32 v131, v29, v28
    ds_write_b64 v140, v[130:131] offset:2048
    v_mov_b32 v12, 1
    s_mov_b64 exec, 1
    ds_add_u32 v1, v12 offset:96
    s_mov_b64 exec, -1
    ds_read_b32 v10, v1 offset:8
    s_cmp_eq_u32 s3, 4
    s_cbranch_scc1 C_FIN
    s_endpgm
C_KA:
    s_setprio 1
    v_lshrrev_b32 v116, 1, v4
    v_and_b32 v117, 1, v4
    v_lshlrev_b32 v116, 8, v116
    v_lshl_add_u32 v116, v117, 3, v116
    v_lshl_add_u32 v116, v3, 4, v116
    v_add_u32 v116, s15, v116
    v_cmp_gt_u32 vcc, 2, v4
    v_lshlrev_b32 v117, 2, v3
    v_lshlrev_b32 v118, 3, v3
    v_cndmask_b32 v117, v117, v118, vcc
    v_lshl_add_u32 v117, v4, 7, v117
    v_add_u32 v117, s15, v117
    v_mov_b32 v118, 64
    v_cndmask_b32 v118, v118, 4, vcc
    v_add_u32 v118, v118, v117
    v_lshlrev_b32 v119, 1, v3
    v_lshl_add_u32 v119, v4, 7, v119
    v_add_u32 v119, s15, v119
    v_lshlrev_b32 v120, 5, v2
    v_lshlrev_b32 v121, 4, v2
    v_add_u32 v121, 256, v121
    v_min_u32 v120, v120, v121
    v_lshlrev_b32 v121, 3, v2
    v_add_u32 v121, 512, v121
    v_min_u32 v120, v120, v121
    v_add_u32 v120, s15, v120
    v_min_u32 v121, 15, v2
    v_lshl_add_u32 v121, v121, 2, s15
    v_lshlrev_b32 v122, 2, v4
    v_sub_u32 v122, v3, v122
    v_lshl_add_u32 v122, v122, 2, s15
    v_add_u32 v122, 2100, v122
    v_lshl_add_u32 v123, v2, 5, s52
    s_mov_b32 s56, 0x01000100
    s_mov_b32 s57, 0x03020302
    v_and_b32 v14, 3, v3
    v_sub_u32 v14, 3, v14
    v_mul_u32_u24 v14, 2240, v14
    v_lshrrev_b32 v13, 2, v3
    v_lshl_add_u32 v13, v4, 1, v13
    v_lshl_add_u32 v14, v13, 3, v14
    v_add3_u32 v5, v14, s52, 8
    v_lshlrev_b32 v14, 1, v3
    v_sub_u32 v14, v4, v14
    v_lshlrev_b32 v14, 4, v14
    s_add_u32 s8, s53, 480
    v_add_u32 v6, s8, v14
    v_lshl_add_u32 v14, v3, 2, v4
    s_mul_i32 s8, s12, 4160
    s_add_u32 s8, s8, 100344
    v_lshlrev_b32 v14, 3, v14
    v_sub_u32 v140, s8, v14
    v_lshl_add_u32 v14, v4, 3, v3
    v_sub_u32 v14, 39, v14
    s_mov_b32 s8, 0x3f800000
    v_mov_b32 v10, 127
    v_mov_b32 v11, 0
    v_lshlrev_b64 v[10:11], v14, v[10:11]
    v_alignbit_b32 v10, v11, v10, 19
    v_bfe_i32 v11, v10, 0, 1
    v_bfe_i32 v12, v10, 1, 1
    v_and_b32 v11, 0x3f80, v11
    v_and_or_b32 v142, v12, s8, v11
    v_bfe_i32 v11, v10, 2, 1
    v_bfe_i32 v12, v10, 3, 1
    v_and_b32 v11, 0x3f80, v11
    v_and_or_b32 v143, v12, s8, v11
    v_bfe_i32 v11, v10, 4, 1
    v_bfe_i32 v12, v10, 5, 1
    v_and_b32 v11, 0x3f80, v11
    v_and_or_b32 v144, v12, s8, v11
    v_bfe_i32 v11, v10, 6, 1
    v_bfe_i32 v12, v10, 7, 1
    v_and_b32 v11, 0x3f80, v11
    v_and_or_b32 v145, v12, s8, v11
    v_mov_b32 v10, 511
    v_mov_b32 v11, 0
    v_lshlrev_b64 v[10:11], v14, v[10:11]
    v_alignbit_b32 v10, v11, v10, 20
    v_bfe_i32 v11, v10, 0, 1
    v_bfe_i32 v12, v10, 1, 1
    v_and_b32 v11, 0x3f80, v11
    v_and_or_b32 v146, v12, s8, v11
    v_bfe_i32 v11, v10, 2, 1
    v_bfe_i32 v12, v10, 3, 1
    v_and_b32 v11, 0x3f80, v11
    v_and_or_b32 v147, v12, s8, v11
    v_bfe_i32 v11, v10, 4, 1
    v_bfe_i32 v12, v10, 5, 1
    v_and_b32 v11, 0x3f80, v11
    v_and_or_b32 v148, v12, s8, v11
    v_bfe_i32 v11, v10, 6, 1
    v_bfe_i32 v12, v10, 7, 1
    v_and_b32 v11, 0x3f80, v11
    v_and_or_b32 v149, v12, s8, v11
    s_lshl_b32 s8, s12, 4
    s_lshr_b64 s[68:69], s[68:69], s8
    s_lshl_b32 s68, s68, 16
    s_sub_u32 s58, 254, s54
    s_lshl_b32 s58, s58, 23
    v_mul_f32 v104, s58, v104
    v_mul_f32 v105, s58, v105
    v_mul_f32 v106, s58, v106
    v_mul_f32 v107, s58, v107
    v_mul_f32 v108, s58, v108
    v_mul_f32 v109, s58, v109
    v_mul_f32 v110, s58, v110
    v_mul_f32 v111, s58, v111
    v_mul_f32 v112, s58, v112
    v_mul_f32 v113, s58, v113
    v_mul_f32 v114, s58, v114
    v_mul_f32 v115, s58, v115
    s_mov_b64 exec, 1
    v_add_f32 v104, s68, v104
    s_mov_b64 exec, -1
    s_setprio 0
    s_mov_b32 s9, 0
SP_22:
    ds_read_b32 v18, v9
    s_waitcnt lgkmcnt(0)
    v_readfirstlane_b32 s8, v18
    s_add_u32 s9, s9, 1
    s_cmp_lg_u32 s8, 0
    s_cbranch_scc1 SP_22_D
    s_cmp_lt_u32 s9, 524288
    s_cbranch_scc1 SP_22
SP_22_D:
    s_setprio 2
    s_sub_u32 s60, 254, s8
    s_lshl_b32 s60, s60, 23
    ds_read_b128 v[88:91], v8 offset:18432
    ds_read_b128 v[92:95], v8 offset:19456
    ds_read_b128 v[96:99], v8 offset:20480
    s_waitcnt lgkmcnt(2)
    v_pk_fma_f32 v[104:105], v[88:89], s[60:61], v[104:105] op_sel_hi:[1,0,1]
    v_cvt_pk_bf16_f32 v20, v104, v105
    v_pk_fma_f32 v[106:107], v[90:91], s[60:61], v[106:107] op_sel_hi:[1,0,1]
    v_cvt_pk_bf16_f32 v21, v106, v107
    ds_write_b64 v116, v[20:21]
    s_waitcnt lgkmcnt(2)
    v_pk_fma_f32 v[108:109], v[92:93], s[60:61], v[108:109] op_sel_hi:[1,0,1]
    v_cvt_pk_bf16_f32 v22, v108, v109
    v_pk_fma_f32 v[110:111], v[94:95], s[60:61], v[110:111] op_sel_hi:[1,0,1]
    v_cvt_pk_bf16_f32 v23, v110, v111
    ds_write_b32 v117, v22 offset:512
    ds_write_b32 v118, v23 offset:512
    s_waitcnt lgkmcnt(3)
    v_pk_fma_f32 v[112:113], v[96:97], s[60:61], v[112:113] op_sel_hi:[1,0,1]
    v_cvt_pk_bf16_f32 v24, v112, v113
    v_pk_fma_f32 v[114:115], v[98:99], s[60:61], v[114:115] op_sel_hi:[1,0,1]
    v_cvt_pk_bf16_f32 v25, v114, v115
    ds_write_b16 v119, v24 offset:1024
    ds_read_b64 v[32:33], v120 offset:0
    ds_read_b64 v[34:35], v120 offset:8
    ds_read_b64 v[36:37], v120 offset:16
    ds_read_b64 v[38:39], v120 offset:24
    s_mov_b32 exec_lo, 0xffff0000
    s_mov_b32 exec_hi, 0
    s_waitcnt lgkmcnt(0)
    v_alignbit_b32 v39, v36, v35, 16
    v_perm_b32 v38, v35, v35, s56
    v_alignbit_b32 v37, v35, v34, 16
    v_perm_b32 v36, v34, v34, s56
    v_alignbit_b32 v35, v34, v33, 16
    v_perm_b32 v34, v33, v33, s56
    v_alignbit_b32 v33, v33, v32, 16
    v_perm_b32 v32, v32, v32, s56
    s_mov_b32 exec_lo, 0
    s_mov_b32 exec_hi, -1
    v_perm_b32 v39, v34, v34, s56
    v_perm_b32 v38, v33, v33, s57
    v_mov_b32 v37, v33
    v_perm_b32 v36, v33, v33, s56
    v_perm_b32 v35, v33, v33, s56
    v_perm_b32 v34, v32, v32, s57
    v_mov_b32 v33, v32
    v_perm_b32 v32, v32, v32, s56
    s_mov_b64 exec, -1
    ds_write_b128 v123, v[32:35] offset:32
    ds_write_b128 v123, v[36:39] offset:48
    v_mov_b32_dpp v30, v38 wave_shr:1 row_mask:0xf bank_mask:0xf bound_ctrl:0
    v_mov_b32_dpp v31, v39 wave_shr:1 row_mask:0xf bank_mask:0xf bound_ctrl:0
    v_alignbit_b32 v44, v32, v31, 16
    v_alignbit_b32 v45, v33, v32, 16
    v_alignbit_b32 v46, v34, v33, 16
    v_alignbit_b32 v47, v35, v34, 16
    ds_write_b128 v123, v[44:47] offset:2272
    v_alignbit_b32 v48, v36, v35, 16
    v_alignbit_b32 v49, v37, v36, 16
    v_alignbit_b32 v50, v38, v37, 16
    v_alignbit_b32 v51, v39, v38, 16
    ds_write_b128 v123, v[48:51] offset:2288
    v_pk_mov_b32 v[52:53], v[30:31], v[32:33] op_sel:[1,0]
    v_pk_mov_b32 v[54:55], v[32:33], v[34:35] op_sel:[1,0]
    ds_write_b128 v123, v[52:55] offset:4512
    v_pk_mov_b32 v[56:57], v[34:35], v[36:37] op_sel:[1,0]
    v_pk_mov_b32 v[58:59], v[36:37], v[38:39] op_sel:[1,0]
    ds_write_b128 v123, v[56:59] offset:4528
    v_alignbit_b32 v60, v31, v30, 16
    v_alignbit_b32 v61, v32, v31, 16
    v_alignbit_b32 v62, v33, v32, 16
    v_alignbit_b32 v63, v34, v33, 16
    ds_write_b128 v123, v[60:63] offset:6752
    v_alignbit_b32 v64, v35, v34, 16
    v_alignbit_b32 v65, v36, v35, 16
    v_alignbit_b32 v66, v37, v36, 16
    v_alignbit_b32 v67, v38, v37, 16
    ds_write_b128 v123, v[64:67] offset:6768
    v_mov_b32 v10, 1
    ds_write_b32 v9, v10 offset:48
    s_setprio 3
    ds_write_b16 v119, v24 offset:2110
    ds_write_b16_d16_hi v119, v24 offset:2142
    ds_write_b16 v119, v25 offset:2174
    ds_write_b16_d16_hi v119, v25 offset:2206
    ds_write_b32 v121, v1 offset:2048
    ds_read2_b32 v[150:151], v122 offset0:3 offset1:2
    ds_read2_b32 v[152:153], v122 offset0:1 offset1:0
    ds_read2_b32 v[154:155], v122 offset0:19 offset1:18
    ds_read2_b32 v[156:157], v122 offset0:17 offset1:16
    ds_read2_b32 v[158:159], v122 offset0:35 offset1:34
    ds_read2_b32 v[160:161], v122 offset0:33 offset1:32
    ds_read2_b32 v[162:163], v122 offset0:51 offset1:50
    ds_read2_b32 v[164:165], v122 offset0:49 offset1:48
    v_alignbit_b32 v72, v39, v38, 16
    v_mov_b32 v73, v39
    v_mov_b32 v74, v39
    v_mov_b32 v75, v39
    v_mov_b32 v78, v39
    v_mov_b32 v79, v39
    v_mov_b32 v80, v39
    v_mov_b32 v82, v39
    v_mov_b32 v83, v39
    v_mov_b32 v84, v39
    v_and_b32 v76, 0xffff, v39
    v_and_b32 v81, 0xffff, v39
    v_mov_b32 v77, 0
    v_mov_b32 v85, 0
    s_mov_b32 exec_lo, 0
    s_mov_b32 exec_hi, 0x80000000
    ds_write_b128 v123, v[72:75] offset:6784
    ds_write_b128 v123, v[74:77] offset:64
    ds_write_b128 v123, v[78:81] offset:4544
    ds_write_b128 v123, v[82:85] offset:2304
    s_mov_b64 exec, -1
    s_mov_b32 s9, 0
SP_23:
    ds_read_b32 v10, v1 offset:80
    s_waitcnt lgkmcnt(0)
    v_readfirstlane_b32 s8, v10
    s_add_u32 s9, s9, 1
    s_cmp_ge_u32 s8, 1
    s_cbranch_scc1 SP_23_D
    s_sleep 1
    s_cmp_lt_u32 s9, 524288
    s_cbranch_scc1 SP_23
SP_23_D:
    s_setprio 3
    ds_read_b128 v[32:35], v6 offset:3584
    ds_read_b128 v[48:51], v6 offset:3600
    ds_read_b128 v[36:39], v6 offset:3072
    ds_read_b128 v[52:55], v6 offset:3088
    ds_read_b128 v[40:43], v6 offset:2560
    ds_read_b128 v[56:59], v6 offset:2576
    ds_read_b128 v[44:47], v6 offset:2048
    ds_read_b128 v[60:63], v6 offset:2064
    ds_read_b64 v[96:97], v5 offset:2048
    ds_read_b64 v[98:99], v5 offset:2056
    s_waitcnt lgkmcnt(9)
    v_mfma_f32_16x16x32_bf16 v[64:67], v[32:35], v[142:145], 0
    s_waitcnt lgkmcnt(8)
    v_mfma_f32_16x16x32_bf16 v[80:83], v[48:51], v[146:149], 0
    s_waitcnt lgkmcnt(7)
    v_mfma_f32_16x16x32_bf16 v[68:71], v[36:39], v[142:145], 0
    s_waitcnt lgkmcnt(6)
    v_mfma_f32_16x16x32_bf16 v[84:87], v[52:55], v[146:149], 0
    s_waitcnt lgkmcnt(5)
    v_mfma_f32_16x16x32_bf16 v[72:75], v[40:43], v[142:145], 0
    s_waitcnt lgkmcnt(4)
    v_mfma_f32_16x16x32_bf16 v[88:91], v[56:59], v[146:149], 0
    s_waitcnt lgkmcnt(3)
    v_mfma_f32_16x16x32_bf16 v[76:79], v[44:47], v[142:145], 0
    s_waitcnt lgkmcnt(2)
    v_mfma_f32_16x16x32_bf16 v[92:95], v[60:63], v[146:149], 0
    s_waitcnt lgkmcnt(0)
    v_mfma_f32_16x16x32_bf16 v[16:19], v[96:99], v[32:35], 0
    v_cvt_pk_bf16_f32 v64, v64, v80
    v_cvt_pk_bf16_f32 v65, v65, v81
    v_cvt_pk_bf16_f32 v66, v66, v82
    v_cvt_pk_bf16_f32 v67, v67, v83
    v_mfma_f32_16x16x32_bf16 v[20:23], v[96:99], v[36:39], 0
    v_cvt_pk_bf16_f32 v68, v68, v84
    v_cvt_pk_bf16_f32 v69, v69, v85
    v_cvt_pk_bf16_f32 v70, v70, v86
    v_cvt_pk_bf16_f32 v71, v71, v87
    v_mfma_f32_16x16x32_bf16 v[24:27], v[96:99], v[40:43], 0
    v_cvt_pk_bf16_f32 v72, v72, v88
    v_cvt_pk_bf16_f32 v73, v73, v89
    v_cvt_pk_bf16_f32 v74, v74, v90
    v_cvt_pk_bf16_f32 v75, v75, v91
    v_mfma_f32_16x16x32_bf16 v[28:31], v[96:99], v[44:47], 0
    v_cvt_pk_bf16_f32 v76, v76, v92
    v_cvt_pk_bf16_f32 v77, v77, v93
    v_cvt_pk_bf16_f32 v78, v78, v94
    v_cvt_pk_bf16_f32 v79, v79, v95
    v_mfma_f32_16x16x32_bf16 v[16:19], v[64:67], v[150:153], v[16:19]
    v_mfma_f32_16x16x32_bf16 v[20:23], v[64:67], v[154:157], v[20:23]
    v_mfma_f32_16x16x32_bf16 v[20:23], v[68:71], v[150:153], v[20:23]
    v_mfma_f32_16x16x32_bf16 v[24:27], v[64:67], v[158:161], v[24:27]
    v_mfma_f32_16x16x32_bf16 v[24:27], v[68:71], v[154:157], v[24:27]
    v_mfma_f32_16x16x32_bf16 v[24:27], v[72:75], v[150:153], v[24:27]
    v_mfma_f32_16x16x32_bf16 v[28:31], v[64:67], v[162:165], v[28:31]
    v_mfma_f32_16x16x32_bf16 v[28:31], v[68:71], v[158:161], v[28:31]
    v_mfma_f32_16x16x32_bf16 v[28:31], v[72:75], v[154:157], v[28:31]
    v_mfma_f32_16x16x32_bf16 v[28:31], v[76:79], v[150:153], v[28:31]
    s_setprio 3
    s_mov_b32 s9, 0
SP_24:
    ds_read_b32 v10, v1 offset:84
    s_waitcnt lgkmcnt(0)
    v_readfirstlane_b32 s8, v10
    s_add_u32 s9, s9, 1
    s_cmp_ge_u32 s8, 1
    s_cbranch_scc1 SP_24_D
    s_sleep 1
    s_cmp_lt_u32 s9, 524288
    s_cbranch_scc1 SP_24
SP_24_D:
    s_setprio 1
    v_cmp_eq_u32 vcc, 0, v2
    v_mov_b32 v13, 100
    s_nop 0
    v_cndmask_b32 v12, 0, 1, vcc
    v_lshl_add_u32 v14, v2, 2, s15
    v_cndmask_b32 v13, v14, v13, vcc
    ds_read_b64 v[32:33], v5 offset:0
    ds_read_b64 v[34:35], v5 offset:8
    ds_read_b128 v[48:51], v6 offset:0
    ds_read_b128 v[72:75], v6 offset:512
    ds_read_b128 v[68:71], v6 offset:1024
    ds_read_b128 v[64:67], v6 offset:1536
    ds_read_b64 v[36:37], v5 offset:512
    ds_read_b64 v[38:39], v5 offset:520
    ds_read_b128 v[60:63], v6 offset:2048
    ds_read_b64 v[40:41], v5 offset:1024
    ds_read_b64 v[42:43], v5 offset:1032
    ds_read_b128 v[56:59], v6 offset:2560
    ds_read_b64 v[44:45], v5 offset:1536
    ds_read_b64 v[46:47], v5 offset:1544
    ds_read_b128 v[52:55], v6 offset:3072
    s_waitcnt lgkmcnt(12)
    v_mfma_f32_16x16x32_bf16 v[28:31], v[32:35], v[48:51], v[28:31]
    ds_read_b64 v[76:77], v5 offset:64
    s_waitcnt lgkmcnt(12)
    v_mfma_f32_16x16x32_bf16 v[24:27], v[32:35], v[72:75], v[24:27]
    ds_read_b64 v[78:79], v5 offset:72
    s_waitcnt lgkmcnt(12)
    v_mfma_f32_16x16x32_bf16 v[20:23], v[32:35], v[68:71], v[20:23]
    ds_read_b128 v[92:95], v6 offset:64
    s_waitcnt lgkmcnt(12)
    v_mfma_f32_16x16x32_bf16 v[16:19], v[32:35], v[64:67], v[16:19]
    ds_read_b128 v[116:119], v6 offset:576
    s_waitcnt lgkmcnt(11)
    v_mfma_f32_16x16x32_bf16 v[28:31], v[36:39], v[72:75], v[28:31]
    ds_read_b128 v[112:115], v6 offset:1088
    v_mfma_f32_16x16x32_bf16 v[24:27], v[36:39], v[68:71], v[24:27]
    ds_read_b128 v[108:111], v6 offset:1600
    v_mfma_f32_16x16x32_bf16 v[20:23], v[36:39], v[64:67], v[20:23]
    ds_read_b64 v[80:81], v5 offset:576
    s_waitcnt lgkmcnt(13)
    v_mfma_f32_16x16x32_bf16 v[16:19], v[36:39], v[60:63], v[16:19]
    ds_read_b64 v[82:83], v5 offset:584
    s_waitcnt lgkmcnt(12)
    v_mfma_f32_16x16x32_bf16 v[28:31], v[40:43], v[68:71], v[28:31]
    ds_read_b128 v[104:107], v6 offset:2112
    v_mfma_f32_16x16x32_bf16 v[24:27], v[40:43], v[64:67], v[24:27]
    ds_read_b64 v[84:85], v5 offset:1088
    v_mfma_f32_16x16x32_bf16 v[20:23], v[40:43], v[60:63], v[20:23]
    ds_read_b64 v[86:87], v5 offset:1096
    s_waitcnt lgkmcnt(14)
    v_mfma_f32_16x16x32_bf16 v[16:19], v[40:43], v[56:59], v[16:19]
    ds_read_b128 v[100:103], v6 offset:2624
    s_waitcnt lgkmcnt(13)
    v_mfma_f32_16x16x32_bf16 v[28:31], v[44:47], v[64:67], v[28:31]
    ds_read_b64 v[88:89], v5 offset:1600
    v_mfma_f32_16x16x32_bf16 v[24:27], v[44:47], v[60:63], v[24:27]
    ds_read_b64 v[90:91], v5 offset:1608
    v_mfma_f32_16x16x32_bf16 v[20:23], v[44:47], v[56:59], v[20:23]
    ds_read_b128 v[96:99], v6 offset:3136
    s_waitcnt lgkmcnt(15)
    v_mfma_f32_16x16x32_bf16 v[16:19], v[44:47], v[52:55], v[16:19]
    s_waitcnt lgkmcnt(6)
    v_mfma_f32_16x16x32_bf16 v[28:31], v[76:79], v[92:95], v[28:31]
    ds_read_b64 v[32:33], v5 offset:128
    v_mfma_f32_16x16x32_bf16 v[24:27], v[76:79], v[116:119], v[24:27]
    ds_read_b64 v[34:35], v5 offset:136
    v_mfma_f32_16x16x32_bf16 v[20:23], v[76:79], v[112:115], v[20:23]
    ds_read_b128 v[48:51], v6 offset:128
    v_mfma_f32_16x16x32_bf16 v[16:19], v[76:79], v[108:111], v[16:19]
    ds_read_b128 v[72:75], v6 offset:640
    v_mfma_f32_16x16x32_bf16 v[28:31], v[80:83], v[116:119], v[28:31]
    ds_read_b128 v[68:71], v6 offset:1152
    v_mfma_f32_16x16x32_bf16 v[24:27], v[80:83], v[112:115], v[24:27]
    ds_read_b128 v[64:67], v6 offset:1664
    v_mfma_f32_16x16x32_bf16 v[20:23], v[80:83], v[108:111], v[20:23]
    ds_read_b64 v[36:37], v5 offset:640
    v_mfma_f32_16x16x32_bf16 v[16:19], v[80:83], v[104:107], v[16:19]
    ds_read_b64 v[38:39], v5 offset:648
    s_waitcnt lgkmcnt(8)
    v_mfma_f32_16x16x32_bf16 v[28:31], v[84:87], v[112:115], v[28:31]
    ds_read_b128 v[60:63], v6 offset:2176
    v_mfma_f32_16x16x32_bf16 v[24:27], v[84:87], v[108:111], v[24:27]
    ds_read_b64 v[40:41], v5 offset:1152
    v_mfma_f32_16x16x32_bf16 v[20:23], v[84:87], v[104:107], v[20:23]
    ds_read_b64 v[42:43], v5 offset:1160
    v_mfma_f32_16x16x32_bf16 v[16:19], v[84:87], v[100:103], v[16:19]
    ds_read_b128 v[56:59], v6 offset:2688
    v_mfma_f32_16x16x32_bf16 v[28:31], v[88:91], v[108:111], v[28:31]
    ds_read_b64 v[44:45], v5 offset:1664
    v_mfma_f32_16x16x32_bf16 v[24:27], v[88:91], v[104:107], v[24:27]
    ds_read_b64 v[46:47], v5 offset:1672
    v_mfma_f32_16x16x32_bf16 v[20:23], v[88:91], v[100:103], v[20:23]
    ds_read_b128 v[52:55], v6 offset:3200
    v_mfma_f32_16x16x32_bf16 v[16:19], v[88:91], v[96:99], v[16:19]
    s_waitcnt lgkmcnt(6)
    v_mfma_f32_16x16x32_bf16 v[28:31], v[32:35], v[48:51], v[28:31]
    ds_read_b64 v[76:77], v5 offset:192
    v_mfma_f32_16x16x32_bf16 v[24:27], v[32:35], v[72:75], v[24:27]
    ds_read_b64 v[78:79], v5 offset:200
    v_mfma_f32_16x16x32_bf16 v[20:23], v[32:35], v[68:71], v[20:23]
    ds_read_b128 v[92:95], v6 offset:192
    v_mfma_f32_16x16x32_bf16 v[16:19], v[32:35], v[64:67], v[16:19]
    ds_read_b128 v[116:119], v6 offset:704
    v_mfma_f32_16x16x32_bf16 v[28:31], v[36:39], v[72:75], v[28:31]
    ds_read_b128 v[112:115], v6 offset:1216
    v_mfma_f32_16x16x32_bf16 v[24:27], v[36:39], v[68:71], v[24:27]
    ds_read_b128 v[108:111], v6 offset:1728
    v_mfma_f32_16x16x32_bf16 v[20:23], v[36:39], v[64:67], v[20:23]
    ds_read_b64 v[80:81], v5 offset:704
    v_mfma_f32_16x16x32_bf16 v[16:19], v[36:39], v[60:63], v[16:19]
    ds_read_b64 v[82:83], v5 offset:712
    s_waitcnt lgkmcnt(8)
    v_mfma_f32_16x16x32_bf16 v[28:31], v[40:43], v[68:71], v[28:31]
    ds_read_b128 v[104:107], v6 offset:2240
    v_mfma_f32_16x16x32_bf16 v[24:27], v[40:43], v[64:67], v[24:27]
    ds_read_b64 v[84:85], v5 offset:1216
    v_mfma_f32_16x16x32_bf16 v[20:23], v[40:43], v[60:63], v[20:23]
    ds_read_b64 v[86:87], v5 offset:1224
    v_mfma_f32_16x16x32_bf16 v[16:19], v[40:43], v[56:59], v[16:19]
    ds_read_b128 v[100:103], v6 offset:2752
    v_mfma_f32_16x16x32_bf16 v[28:31], v[44:47], v[64:67], v[28:31]
    ds_read_b64 v[88:89], v5 offset:1728
    v_mfma_f32_16x16x32_bf16 v[24:27], v[44:47], v[60:63], v[24:27]
    ds_read_b64 v[90:91], v5 offset:1736
    v_mfma_f32_16x16x32_bf16 v[20:23], v[44:47], v[56:59], v[20:23]
    ds_read_b128 v[96:99], v6 offset:3264
    v_mfma_f32_16x16x32_bf16 v[16:19], v[44:47], v[52:55], v[16:19]
    s_waitcnt lgkmcnt(6)
    v_mfma_f32_16x16x32_bf16 v[28:31], v[76:79], v[92:95], v[28:31]
    ds_read_b64 v[32:33], v5 offset:256
    v_mfma_f32_16x16x32_bf16 v[24:27], v[76:79], v[116:119], v[24:27]
    ds_read_b64 v[34:35], v5 offset:264
    v_mfma_f32_16x16x32_bf16 v[20:23], v[76:79], v[112:115], v[20:23]
    ds_read_b128 v[48:51], v6 offset:256
    v_mfma_f32_16x16x32_bf16 v[16:19], v[76:79], v[108:111], v[16:19]
    ds_read_b128 v[72:75], v6 offset:768
    v_mfma_f32_16x16x32_bf16 v[28:31], v[80:83], v[116:119], v[28:31]
    ds_read_b128 v[68:71], v6 offset:1280
    v_mfma_f32_16x16x32_bf16 v[24:27], v[80:83], v[112:115], v[24:27]
    ds_read_b128 v[64:67], v6 offset:1792
    v_mfma_f32_16x16x32_bf16 v[20:23], v[80:83], v[108:111], v[20:23]
    ds_read_b64 v[36:37], v5 offset:768
    v_mfma_f32_16x16x32_bf16 v[16:19], v[80:83], v[104:107], v[16:19]
    ds_read_b64 v[38:39], v5 offset:776
    s_waitcnt lgkmcnt(8)
    v_mfma_f32_16x16x32_bf16 v[28:31], v[84:87], v[112:115], v[28:31]
    ds_read_b128 v[60:63], v6 offset:2304
    v_mfma_f32_16x16x32_bf16 v[24:27], v[84:87], v[108:111], v[24:27]
    ds_read_b64 v[40:41], v5 offset:1280
    v_mfma_f32_16x16x32_bf16 v[20:23], v[84:87], v[104:107], v[20:23]
    ds_read_b64 v[42:43], v5 offset:1288
    v_mfma_f32_16x16x32_bf16 v[16:19], v[84:87], v[100:103], v[16:19]
    ds_read_b128 v[56:59], v6 offset:2816
    v_mfma_f32_16x16x32_bf16 v[28:31], v[88:91], v[108:111], v[28:31]
    ds_read_b64 v[44:45], v5 offset:1792
    v_mfma_f32_16x16x32_bf16 v[24:27], v[88:91], v[104:107], v[24:27]
    ds_read_b64 v[46:47], v5 offset:1800
    v_mfma_f32_16x16x32_bf16 v[20:23], v[88:91], v[100:103], v[20:23]
    ds_read_b128 v[52:55], v6 offset:3328
    v_mfma_f32_16x16x32_bf16 v[16:19], v[88:91], v[96:99], v[16:19]
    s_waitcnt lgkmcnt(6)
    v_mfma_f32_16x16x32_bf16 v[28:31], v[32:35], v[48:51], v[28:31]
    ds_read_b64 v[76:77], v5 offset:320
    v_mfma_f32_16x16x32_bf16 v[24:27], v[32:35], v[72:75], v[24:27]
    ds_read_b64 v[78:79], v5 offset:328
    v_mfma_f32_16x16x32_bf16 v[20:23], v[32:35], v[68:71], v[20:23]
    ds_read_b128 v[92:95], v6 offset:320
    v_mfma_f32_16x16x32_bf16 v[16:19], v[32:35], v[64:67], v[16:19]
    ds_read_b128 v[116:119], v6 offset:832
    v_mfma_f32_16x16x32_bf16 v[28:31], v[36:39], v[72:75], v[28:31]
    ds_read_b128 v[112:115], v6 offset:1344
    v_mfma_f32_16x16x32_bf16 v[24:27], v[36:39], v[68:71], v[24:27]
    ds_read_b128 v[108:111], v6 offset:1856
    v_mfma_f32_16x16x32_bf16 v[20:23], v[36:39], v[64:67], v[20:23]
    ds_read_b64 v[80:81], v5 offset:832
    v_mfma_f32_16x16x32_bf16 v[16:19], v[36:39], v[60:63], v[16:19]
    ds_read_b64 v[82:83], v5 offset:840
    s_waitcnt lgkmcnt(8)
    v_mfma_f32_16x16x32_bf16 v[28:31], v[40:43], v[68:71], v[28:31]
    ds_read_b128 v[104:107], v6 offset:2368
    v_mfma_f32_16x16x32_bf16 v[24:27], v[40:43], v[64:67], v[24:27]
    ds_read_b64 v[84:85], v5 offset:1344
    v_mfma_f32_16x16x32_bf16 v[20:23], v[40:43], v[60:63], v[20:23]
    ds_read_b64 v[86:87], v5 offset:1352
    v_mfma_f32_16x16x32_bf16 v[16:19], v[40:43], v[56:59], v[16:19]
    ds_read_b128 v[100:103], v6 offset:2880
    v_mfma_f32_16x16x32_bf16 v[28:31], v[44:47], v[64:67], v[28:31]
    ds_read_b64 v[88:89], v5 offset:1856
    v_mfma_f32_16x16x32_bf16 v[24:27], v[44:47], v[60:63], v[24:27]
    ds_read_b64 v[90:91], v5 offset:1864
    v_mfma_f32_16x16x32_bf16 v[20:23], v[44:47], v[56:59], v[20:23]
    ds_read_b128 v[96:99], v6 offset:3392
    v_mfma_f32_16x16x32_bf16 v[16:19], v[44:47], v[52:55], v[16:19]
    s_waitcnt lgkmcnt(6)
    v_mfma_f32_16x16x32_bf16 v[28:31], v[76:79], v[92:95], v[28:31]
    ds_read_b64 v[32:33], v5 offset:384
    v_mfma_f32_16x16x32_bf16 v[24:27], v[76:79], v[116:119], v[24:27]
    ds_read_b64 v[34:35], v5 offset:392
    v_mfma_f32_16x16x32_bf16 v[20:23], v[76:79], v[112:115], v[20:23]
    ds_read_b128 v[68:71], v6 offset:1408
    v_mfma_f32_16x16x32_bf16 v[16:19], v[76:79], v[108:111], v[16:19]
    ds_read_b128 v[64:67], v6 offset:1920
    v_mfma_f32_16x16x32_bf16 v[28:31], v[80:83], v[116:119], v[28:31]
    ds_read_b64 v[36:37], v5 offset:896
    v_mfma_f32_16x16x32_bf16 v[24:27], v[80:83], v[112:115], v[24:27]
    v_mfma_f32_16x16x32_bf16 v[20:23], v[80:83], v[108:111], v[20:23]
    ds_read_b64 v[38:39], v5 offset:904
    v_mfma_f32_16x16x32_bf16 v[16:19], v[80:83], v[104:107], v[16:19]
    ds_read_b128 v[60:63], v6 offset:2432
    s_waitcnt lgkmcnt(7)
    v_mfma_f32_16x16x32_bf16 v[28:31], v[84:87], v[112:115], v[28:31]
    ds_read_b64 v[40:41], v5 offset:1408
    v_mfma_f32_16x16x32_bf16 v[24:27], v[84:87], v[108:111], v[24:27]
    ds_read_b64 v[42:43], v5 offset:1416
    v_mfma_f32_16x16x32_bf16 v[20:23], v[84:87], v[104:107], v[20:23]
    v_mfma_f32_16x16x32_bf16 v[16:19], v[84:87], v[100:103], v[16:19]
    ds_read_b128 v[56:59], v6 offset:2944
    v_mfma_f32_16x16x32_bf16 v[28:31], v[88:91], v[108:111], v[28:31]
    ds_read_b64 v[44:45], v5 offset:1920
    v_mfma_f32_16x16x32_bf16 v[24:27], v[88:91], v[104:107], v[24:27]
    ds_read_b64 v[46:47], v5 offset:1928
    v_mfma_f32_16x16x32_bf16 v[20:23], v[88:91], v[100:103], v[20:23]
    ds_read_b128 v[52:55], v6 offset:3456
    v_mfma_f32_16x16x32_bf16 v[16:19], v[88:91], v[96:99], v[16:19]
    s_waitcnt lgkmcnt(6)
    v_mfma_f32_16x16x32_bf16 v[20:23], v[32:35], v[68:71], v[20:23]
    ds_read_b64 v[76:77], v5 offset:448
    ds_read_b64 v[78:79], v5 offset:456
    v_mfma_f32_16x16x32_bf16 v[16:19], v[32:35], v[64:67], v[16:19]
    ds_read_b128 v[112:115], v6 offset:1472
    ds_read_b128 v[108:111], v6 offset:1984
    v_mfma_f32_16x16x32_bf16 v[20:23], v[36:39], v[64:67], v[20:23]
    ds_read_b64 v[80:81], v5 offset:960
    v_mfma_f32_16x16x32_bf16 v[16:19], v[36:39], v[60:63], v[16:19]
    ds_read_b64 v[82:83], v5 offset:968
    ds_read_b128 v[104:107], v6 offset:2496
    s_waitcnt lgkmcnt(7)
    v_mfma_f32_16x16x32_bf16 v[20:23], v[40:43], v[60:63], v[20:23]
    ds_read_b64 v[84:85], v5 offset:1472
    ds_read_b64 v[86:87], v5 offset:1480
    v_mfma_f32_16x16x32_bf16 v[16:19], v[40:43], v[56:59], v[16:19]
    ds_read_b128 v[100:103], v6 offset:3008
    v_mfma_f32_16x16x32_bf16 v[20:23], v[44:47], v[56:59], v[20:23]
    ds_read_b64 v[88:89], v5 offset:1984
    ds_read_b64 v[90:91], v5 offset:1992
    v_mfma_f32_16x16x32_bf16 v[16:19], v[44:47], v[52:55], v[16:19]
    ds_read_b128 v[96:99], v6 offset:3520
    s_waitcnt lgkmcnt(6)
    v_mfma_f32_16x16x32_bf16 v[20:23], v[76:79], v[112:115], v[20:23]
    ds_read_b64 v[32:33], v5 offset:384
    ds_read_b64 v[34:35], v5 offset:392
    v_mfma_f32_16x16x32_bf16 v[16:19], v[76:79], v[108:111], v[16:19]
    ds_read_b128 v[48:51], v6 offset:384
    ds_read_b128 v[72:75], v6 offset:896
    v_mfma_f32_16x16x32_bf16 v[20:23], v[80:83], v[108:111], v[20:23]
    ds_read_b64 v[36:37], v5 offset:896
    v_mfma_f32_16x16x32_bf16 v[16:19], v[80:83], v[104:107], v[16:19]
    ds_read_b64 v[38:39], v5 offset:904
    ds_read_b128 v[68:71], v6 offset:1408
    s_waitcnt lgkmcnt(7)
    v_mfma_f32_16x16x32_bf16 v[20:23], v[84:87], v[104:107], v[20:23]
    ds_read_b64 v[40:41], v5 offset:1408
    ds_read_b64 v[42:43], v5 offset:1416
    v_mfma_f32_16x16x32_bf16 v[16:19], v[84:87], v[100:103], v[16:19]
    ds_read_b128 v[64:67], v6 offset:1920
    v_mfma_f32_16x16x32_bf16 v[20:23], v[88:91], v[100:103], v[20:23]
    ds_read_b64 v[44:45], v5 offset:1920
    ds_read_b64 v[46:47], v5 offset:1928
    v_mfma_f32_16x16x32_bf16 v[16:19], v[88:91], v[96:99], v[16:19]
    ds_read_b128 v[60:63], v6 offset:2432
    s_waitcnt lgkmcnt(6)
    v_mfma_f32_16x16x32_bf16 v[28:31], v[32:35], v[48:51], v[28:31]
    ds_read_b64 v[76:77], v5 offset:448
    ds_read_b64 v[78:79], v5 offset:456
    ds_read_b128 v[92:95], v6 offset:448
    v_mfma_f32_16x16x32_bf16 v[24:27], v[32:35], v[72:75], v[24:27]
    ds_read_b128 v[116:119], v6 offset:960
    ds_read_b64 v[80:81], v5 offset:960
    v_mfma_f32_16x16x32_bf16 v[28:31], v[36:39], v[72:75], v[28:31]
    ds_read_b64 v[82:83], v5 offset:968
    ds_read_b128 v[112:115], v6 offset:1472
    ds_read_b64 v[84:85], v5 offset:1472
    v_mfma_f32_16x16x32_bf16 v[24:27], v[36:39], v[68:71], v[24:27]
    ds_read_b64 v[86:87], v5 offset:1480
    ds_read_b128 v[108:111], v6 offset:1984
    s_waitcnt lgkmcnt(10)
    v_mfma_f32_16x16x32_bf16 v[28:31], v[40:43], v[68:71], v[28:31]
    ds_read_b64 v[88:89], v5 offset:1984
    ds_read_b64 v[90:91], v5 offset:1992
    ds_read_b128 v[104:107], v6 offset:2496
    v_mfma_f32_16x16x32_bf16 v[24:27], v[40:43], v[64:67], v[24:27]
    v_cvt_pk_bf16_f32 v124, v23, v22
    v_cvt_pk_bf16_f32 v125, v21, v20
    v_mfma_f32_16x16x32_bf16 v[28:31], v[44:47], v[64:67], v[28:31]
    ds_write_b64 v140, v[124:125] offset:1024
    v_cvt_pk_bf16_f32 v126, v19, v18
    v_cvt_pk_bf16_f32 v127, v17, v16
    v_mfma_f32_16x16x32_bf16 v[24:27], v[44:47], v[60:63], v[24:27]
    ds_write_b64 v140, v[126:127] offset:1536
    ds_add_u32 v13, v12
    s_waitcnt lgkmcnt(9)
    v_mfma_f32_16x16x32_bf16 v[28:31], v[76:79], v[92:95], v[28:31]
    v_mfma_f32_16x16x32_bf16 v[24:27], v[76:79], v[116:119], v[24:27]
    v_mfma_f32_16x16x32_bf16 v[28:31], v[80:83], v[116:119], v[28:31]
    v_mfma_f32_16x16x32_bf16 v[24:27], v[80:83], v[112:115], v[24:27]
    s_waitcnt lgkmcnt(3)
    v_mfma_f32_16x16x32_bf16 v[28:31], v[84:87], v[112:115], v[28:31]
    v_mfma_f32_16x16x32_bf16 v[24:27], v[84:87], v[108:111], v[24:27]
    v_mfma_f32_16x16x32_bf16 v[28:31], v[88:91], v[108:111], v[28:31]
    v_mfma_f32_16x16x32_bf16 v[24:27], v[88:91], v[104:107], v[24:27]
    s_nop 6
    v_cvt_pk_bf16_f32 v124, v31, v30
    v_cvt_pk_bf16_f32 v125, v29, v28
    ds_write_b64 v140, v[124:125] offset:0
    v_cvt_pk_bf16_f32 v126, v27, v26
    v_cvt_pk_bf16_f32 v127, v25, v24
    ds_write_b64 v140, v[126:127] offset:512
    v_mov_b32 v12, 1
    s_mov_b64 exec, 1
    ds_add_u32 v1, v12 offset:104
    s_mov_b64 exec, -1
    s_endpgm
SELECT:
    s_mov_b32 s52, s16
    s_mov_b32 s53, s17
    s_mov_b32 s54, 2359296
    s_mov_b32 s55, 0x20000
    v_lshlrev_b32 v7, 4, v2
    v_add_u32 v15, 0x1000, v7
    v_lshlrev_b32 v8, 2, v2
    v_sub_u32 v8, 2047, v8
    v_subrev_u32 v48, 0, v8
    v_subrev_u32 v49, 1, v8
    v_subrev_u32 v50, 2, v8
    v_subrev_u32 v51, 3, v8
    v_subrev_u32 v52, 256, v8
    v_subrev_u32 v53, 257, v8
    v_subrev_u32 v54, 258, v8
    v_subrev_u32 v55, 259, v8
    v_subrev_u32 v56, 512, v8
    v_subrev_u32 v57, 513, v8
    v_subrev_u32 v58, 514, v8
    v_subrev_u32 v59, 515, v8
    v_subrev_u32 v60, 768, v8
    v_subrev_u32 v61, 769, v8
    v_subrev_u32 v62, 770, v8
    v_subrev_u32 v63, 771, v8
    v_subrev_u32 v64, 1024, v8
    v_subrev_u32 v65, 1025, v8
    v_subrev_u32 v66, 1026, v8
    v_subrev_u32 v67, 1027, v8
    v_subrev_u32 v68, 1280, v8
    v_subrev_u32 v69, 1281, v8
    v_subrev_u32 v70, 1282, v8
    v_subrev_u32 v71, 1283, v8
    v_subrev_u32 v72, 1536, v8
    v_subrev_u32 v73, 1537, v8
    v_subrev_u32 v74, 1538, v8
    v_subrev_u32 v75, 1539, v8
    v_subrev_u32 v76, 1792, v8
    v_subrev_u32 v77, 1793, v8
    v_subrev_u32 v78, 1794, v8
    v_subrev_u32 v79, 1795, v8
    v_lshrrev_b32 v9, 3, v2
    v_and_b32 v9, 6, v9
    v_xor_b32 v9, v9, v2
    v_and_b32 v9, 7, v9
    v_lshlrev_b32 v5, 4, v9
    v_mov_b32 v12, 0
    v_mov_b32 v6, 0
    s_mov_b32 s11, 0xffff0000
    s_mov_b32 s15, 0
    s_mov_b32 s9, 0
SP_25:
    ds_read_b32 v13, v1 offset:12
    s_waitcnt lgkmcnt(0)
    v_readfirstlane_b32 s8, v13
    s_add_u32 s9, s9, 1
    s_cmp_ge_u32 s8, 2
    s_cbranch_scc1 SP_25_D
    s_cmp_lt_u32 s9, 524288
    s_cbranch_scc1 SP_25
SP_25_D:
    s_mov_b32 s9, 0
    s_waitcnt vmcnt(0)
    s_sleep 18
SEL_POLL:
    global_load_dwordx4 v[16:19], v7, s[50:51] offset:0 sc1
    global_load_dwordx4 v[20:23], v7, s[50:51] offset:1024 sc1
    global_load_dwordx4 v[24:27], v7, s[50:51] offset:2048 sc1
    global_load_dwordx4 v[28:31], v7, s[50:51] offset:3072 sc1
    global_load_dwordx4 v[32:35], v15, s[50:51] offset:0 sc1
    global_load_dwordx4 v[36:39], v15, s[50:51] offset:1024 sc1
    global_load_dwordx4 v[40:43], v15, s[50:51] offset:2048 sc1
    global_load_dwordx4 v[44:47], v15, s[50:51] offset:3072 sc1
    s_waitcnt vmcnt(7)
    v_xor_b32 v13, v17, v14
    v_bitop3_b32 v13, v13, v19, v14 bitop3:0xf6
    s_waitcnt vmcnt(6)
    v_bitop3_b32 v13, v13, v21, v14 bitop3:0xf6
    v_bitop3_b32 v13, v13, v23, v14 bitop3:0xf6
    s_waitcnt vmcnt(5)
    v_bitop3_b32 v13, v13, v25, v14 bitop3:0xf6
    v_bitop3_b32 v13, v13, v27, v14 bitop3:0xf6
    s_waitcnt vmcnt(4)
    v_bitop3_b32 v13, v13, v29, v14 bitop3:0xf6
    v_bitop3_b32 v13, v13, v31, v14 bitop3:0xf6
    s_waitcnt vmcnt(3)
    v_bitop3_b32 v13, v13, v33, v14 bitop3:0xf6
    v_bitop3_b32 v13, v13, v35, v14 bitop3:0xf6
    s_waitcnt vmcnt(2)
    v_bitop3_b32 v13, v13, v37, v14 bitop3:0xf6
    v_bitop3_b32 v13, v13, v39, v14 bitop3:0xf6
    s_waitcnt vmcnt(1)
    v_bitop3_b32 v13, v13, v41, v14 bitop3:0xf6
    v_bitop3_b32 v13, v13, v43, v14 bitop3:0xf6
    s_waitcnt vmcnt(0)
    v_bitop3_b32 v13, v13, v45, v14 bitop3:0xf6
    v_bitop3_b32 v13, v13, v47, v14 bitop3:0xf6
    v_cmp_ne_u32 vcc, 0, v13
    s_add_u32 s9, s9, 1
    s_cmp_eq_u64 vcc, 0
    s_cbranch_scc1 SEL_GOT
    s_cmp_lt_u32 s9, 131072
    s_cbranch_scc1 SEL_POLL
SEL_GOT:
    v_lshl_or_b32 v80, v16, 16, v48
    v_and_or_b32 v81, v16, s11, v49
    v_lshl_or_b32 v82, v18, 16, v50
    v_and_or_b32 v83, v18, s11, v51
    v_min_u32 v9, v80, v81
    v_max_u32 v8, v80, v81
    v_med3_u32 v9, v8, v9, v82
    v_max_u32 v8, v8, v82
    v_med3_u32 v9, v8, v9, v83
    v_max_u32 v8, v8, v83
    v_lshl_or_b32 v84, v20, 16, v52
    v_and_or_b32 v85, v20, s11, v53
    v_lshl_or_b32 v86, v22, 16, v54
    v_and_or_b32 v87, v22, s11, v55
    v_med3_u32 v9, v8, v9, v84
    v_max_u32 v8, v8, v84
    v_med3_u32 v9, v8, v9, v85
    v_max_u32 v8, v8, v85
    v_med3_u32 v9, v8, v9, v86
    v_max_u32 v8, v8, v86
    v_med3_u32 v9, v8, v9, v87
    v_max_u32 v8, v8, v87
    v_lshl_or_b32 v88, v24, 16, v56
    v_and_or_b32 v89, v24, s11, v57
    v_lshl_or_b32 v90, v26, 16, v58
    v_and_or_b32 v91, v26, s11, v59
    v_med3_u32 v9, v8, v9, v88
    v_max_u32 v8, v8, v88
    v_med3_u32 v9, v8, v9, v89
    v_max_u32 v8, v8, v89
    v_med3_u32 v9, v8, v9, v90
    v_max_u32 v8, v8, v90
    v_med3_u32 v9, v8, v9, v91
    v_max_u32 v8, v8, v91
    v_lshl_or_b32 v92, v28, 16, v60
    v_and_or_b32 v93, v28, s11, v61
    v_lshl_or_b32 v94, v30, 16, v62
    v_and_or_b32 v95, v30, s11, v63
    v_med3_u32 v9, v8, v9, v92
    v_max_u32 v8, v8, v92
    v_med3_u32 v9, v8, v9, v93
    v_max_u32 v8, v8, v93
    v_med3_u32 v9, v8, v9, v94
    v_max_u32 v8, v8, v94
    v_med3_u32 v9, v8, v9, v95
    v_max_u32 v8, v8, v95
    v_lshl_or_b32 v96, v32, 16, v64
    v_and_or_b32 v97, v32, s11, v65
    v_lshl_or_b32 v98, v34, 16, v66
    v_and_or_b32 v99, v34, s11, v67
    v_med3_u32 v9, v8, v9, v96
    v_max_u32 v8, v8, v96
    v_med3_u32 v9, v8, v9, v97
    v_max_u32 v8, v8, v97
    v_med3_u32 v9, v8, v9, v98
    v_max_u32 v8, v8, v98
    v_med3_u32 v9, v8, v9, v99
    v_max_u32 v8, v8, v99
    v_lshl_or_b32 v100, v36, 16, v68
    v_and_or_b32 v101, v36, s11, v69
    v_lshl_or_b32 v102, v38, 16, v70
    v_and_or_b32 v103, v38, s11, v71
    v_med3_u32 v9, v8, v9, v100
    v_max_u32 v8, v8, v100
    v_med3_u32 v9, v8, v9, v101
    v_max_u32 v8, v8, v101
    v_med3_u32 v9, v8, v9, v102
    v_max_u32 v8, v8, v102
    v_med3_u32 v9, v8, v9, v103
    v_max_u32 v8, v8, v103
    v_lshl_or_b32 v104, v40, 16, v72
    v_and_or_b32 v105, v40, s11, v73
    v_lshl_or_b32 v106, v42, 16, v74
    v_and_or_b32 v107, v42, s11, v75
    v_med3_u32 v9, v8, v9, v104
    v_max_u32 v8, v8, v104
    v_med3_u32 v9, v8, v9, v105
    v_max_u32 v8, v8, v105
    v_med3_u32 v9, v8, v9, v106
    v_max_u32 v8, v8, v106
    v_med3_u32 v9, v8, v9, v107
    v_max_u32 v8, v8, v107
    v_lshl_or_b32 v108, v44, 16, v76
    v_and_or_b32 v109, v44, s11, v77
    v_lshl_or_b32 v110, v46, 16, v78
    v_and_or_b32 v111, v46, s11, v79
    v_med3_u32 v9, v8, v9, v108
    v_max_u32 v8, v8, v108
    v_med3_u32 v9, v8, v9, v109
    v_max_u32 v8, v8, v109
    v_med3_u32 v9, v8, v9, v110
    v_max_u32 v8, v8, v110
    v_med3_u32 v9, v8, v9, v111
    v_max_u32 v8, v8, v111
    v_mov_b32 v10, v8
    s_nop 1
    v_max_u32_dpp v10, v10, v10 row_shr:1 row_mask:0xf bank_mask:0xf
    s_nop 1
    v_max_u32_dpp v10, v10, v10 row_shr:2 row_mask:0xf bank_mask:0xf
    s_nop 1
    v_max_u32_dpp v10, v10, v10 row_shr:4 row_mask:0xf bank_mask:0xf
    s_nop 1
    v_max_u32_dpp v10, v10, v10 row_shr:8 row_mask:0xf bank_mask:0xf
    s_nop 1
    v_max_u32_dpp v10, v10, v10 row_bcast:15 row_mask:0xa bank_mask:0xf
    s_nop 1
    v_max_u32_dpp v10, v10, v10 row_bcast:31 row_mask:0xc bank_mask:0xf
    s_nop 0
    v_readlane_b32 s8, v10, 63
    s_mov_b32 s12, s8
    v_subrev_u32 v10, s12, v8
    v_subrev_u32 v11, s12, v9
    v_max_u32 v10, v10, v11
    s_and_b32 s13, s12, 0x7ff
    s_sub_u32 s13, 2047, s13
    v_max_u32_dpp v10, v10, v10 row_shr:1 row_mask:0xf bank_mask:0xf
    s_mul_i32 s13, s13, 1152
    s_nop 0
    v_max_u32_dpp v10, v10, v10 row_shr:2 row_mask:0xf bank_mask:0xf
    s_mov_b32 exec_lo, 0xff
    s_mov_b32 exec_hi, 0x0
    v_add_u32 v12, s13, v5
    v_mov_b32 v6, s12
    s_mov_b64 exec, -1
    v_max_u32_dpp v10, v10, v10 row_shr:4 row_mask:0xf bank_mask:0xf
    s_nop 1
    v_max_u32_dpp v10, v10, v10 row_shr:8 row_mask:0xf bank_mask:0xf
    s_nop 1
    v_max_u32_dpp v10, v10, v10 row_bcast:15 row_mask:0xa bank_mask:0xf
    s_nop 1
    v_max_u32_dpp v10, v10, v10 row_bcast:31 row_mask:0xc bank_mask:0xf
    s_nop 0
    v_readlane_b32 s8, v10, 63
    s_add_u32 s12, s12, s8
    v_subrev_u32 v10, s12, v8
    v_subrev_u32 v11, s12, v9
    v_max_u32 v10, v10, v11
    s_and_b32 s13, s12, 0x7ff
    s_sub_u32 s13, 2047, s13
    v_max_u32_dpp v10, v10, v10 row_shr:1 row_mask:0xf bank_mask:0xf
    s_mul_i32 s13, s13, 1152
    s_nop 0
    v_max_u32_dpp v10, v10, v10 row_shr:2 row_mask:0xf bank_mask:0xf
    s_mov_b32 exec_lo, 0xff00
    s_mov_b32 exec_hi, 0x0
    v_add_u32 v12, s13, v5
    v_mov_b32 v6, s12
    s_mov_b64 exec, -1
    v_max_u32_dpp v10, v10, v10 row_shr:4 row_mask:0xf bank_mask:0xf
    s_nop 1
    v_max_u32_dpp v10, v10, v10 row_shr:8 row_mask:0xf bank_mask:0xf
    s_nop 1
    v_max_u32_dpp v10, v10, v10 row_bcast:15 row_mask:0xa bank_mask:0xf
    s_nop 1
    v_max_u32_dpp v10, v10, v10 row_bcast:31 row_mask:0xc bank_mask:0xf
    s_nop 0
    v_readlane_b32 s8, v10, 63
    s_add_u32 s12, s12, s8
    v_subrev_u32 v10, s12, v8
    v_subrev_u32 v11, s12, v9
    v_max_u32 v10, v10, v11
    s_and_b32 s13, s12, 0x7ff
    s_sub_u32 s13, 2047, s13
    v_max_u32_dpp v10, v10, v10 row_shr:1 row_mask:0xf bank_mask:0xf
    s_mul_i32 s13, s13, 1152
    s_nop 0
    v_max_u32_dpp v10, v10, v10 row_shr:2 row_mask:0xf bank_mask:0xf
    s_mov_b32 exec_lo, 0xff0000
    s_mov_b32 exec_hi, 0x0
    v_add_u32 v12, s13, v5
    v_mov_b32 v6, s12
    s_mov_b64 exec, -1
    v_max_u32_dpp v10, v10, v10 row_shr:4 row_mask:0xf bank_mask:0xf
    s_nop 1
    v_max_u32_dpp v10, v10, v10 row_shr:8 row_mask:0xf bank_mask:0xf
    s_nop 1
    v_max_u32_dpp v10, v10, v10 row_bcast:15 row_mask:0xa bank_mask:0xf
    s_nop 1
    v_max_u32_dpp v10, v10, v10 row_bcast:31 row_mask:0xc bank_mask:0xf
    s_nop 0
    v_readlane_b32 s8, v10, 63
    s_add_u32 s12, s12, s8
    v_subrev_u32 v10, s12, v8
    v_subrev_u32 v11, s12, v9
    v_max_u32 v10, v10, v11
    s_and_b32 s13, s12, 0x7ff
    s_sub_u32 s13, 2047, s13
    v_max_u32_dpp v10, v10, v10 row_shr:1 row_mask:0xf bank_mask:0xf
    s_mul_i32 s13, s13, 1152
    s_nop 0
    v_max_u32_dpp v10, v10, v10 row_shr:2 row_mask:0xf bank_mask:0xf
    s_mov_b32 exec_lo, 0xff000000
    s_mov_b32 exec_hi, 0x0
    v_add_u32 v12, s13, v5
    v_mov_b32 v6, s12
    s_mov_b64 exec, -1
    v_max_u32_dpp v10, v10, v10 row_shr:4 row_mask:0xf bank_mask:0xf
    s_nop 1
    v_max_u32_dpp v10, v10, v10 row_shr:8 row_mask:0xf bank_mask:0xf
    s_nop 1
    v_max_u32_dpp v10, v10, v10 row_bcast:15 row_mask:0xa bank_mask:0xf
    s_nop 1
    v_max_u32_dpp v10, v10, v10 row_bcast:31 row_mask:0xc bank_mask:0xf
    s_nop 0
    v_readlane_b32 s8, v10, 63
    s_add_u32 s12, s12, s8
    v_subrev_u32 v10, s12, v8
    v_subrev_u32 v11, s12, v9
    v_max_u32 v10, v10, v11
    s_and_b32 s13, s12, 0x7ff
    s_sub_u32 s13, 2047, s13
    v_max_u32_dpp v10, v10, v10 row_shr:1 row_mask:0xf bank_mask:0xf
    s_mul_i32 s13, s13, 1152
    s_nop 0
    v_max_u32_dpp v10, v10, v10 row_shr:2 row_mask:0xf bank_mask:0xf
    s_mov_b32 exec_lo, 0x0
    s_mov_b32 exec_hi, 0xff
    v_add_u32 v12, s13, v5
    v_mov_b32 v6, s12
    s_mov_b64 exec, -1
    v_max_u32_dpp v10, v10, v10 row_shr:4 row_mask:0xf bank_mask:0xf
    s_nop 1
    v_max_u32_dpp v10, v10, v10 row_shr:8 row_mask:0xf bank_mask:0xf
    s_nop 1
    v_max_u32_dpp v10, v10, v10 row_bcast:15 row_mask:0xa bank_mask:0xf
    s_nop 1
    v_max_u32_dpp v10, v10, v10 row_bcast:31 row_mask:0xc bank_mask:0xf
    s_nop 0
    v_readlane_b32 s8, v10, 63
    s_add_u32 s12, s12, s8
    v_subrev_u32 v10, s12, v8
    v_subrev_u32 v11, s12, v9
    v_max_u32 v10, v10, v11
    s_and_b32 s13, s12, 0x7ff
    s_sub_u32 s13, 2047, s13
    v_max_u32_dpp v10, v10, v10 row_shr:1 row_mask:0xf bank_mask:0xf
    s_mul_i32 s13, s13, 1152
    s_nop 0
    v_max_u32_dpp v10, v10, v10 row_shr:2 row_mask:0xf bank_mask:0xf
    s_mov_b32 exec_lo, 0x0
    s_mov_b32 exec_hi, 0xff00
    v_add_u32 v12, s13, v5
    v_mov_b32 v6, s12
    s_mov_b64 exec, -1
    v_max_u32_dpp v10, v10, v10 row_shr:4 row_mask:0xf bank_mask:0xf
    s_nop 1
    v_max_u32_dpp v10, v10, v10 row_shr:8 row_mask:0xf bank_mask:0xf
    s_nop 1
    v_max_u32_dpp v10, v10, v10 row_bcast:15 row_mask:0xa bank_mask:0xf
    s_nop 1
    v_max_u32_dpp v10, v10, v10 row_bcast:31 row_mask:0xc bank_mask:0xf
    s_nop 0
    v_readlane_b32 s8, v10, 63
    s_add_u32 s12, s12, s8
    v_subrev_u32 v10, s12, v8
    v_subrev_u32 v11, s12, v9
    v_max_u32 v10, v10, v11
    s_and_b32 s13, s12, 0x7ff
    s_sub_u32 s13, 2047, s13
    v_max_u32_dpp v10, v10, v10 row_shr:1 row_mask:0xf bank_mask:0xf
    s_mul_i32 s13, s13, 1152
    s_nop 0
    v_max_u32_dpp v10, v10, v10 row_shr:2 row_mask:0xf bank_mask:0xf
    s_mov_b32 exec_lo, 0x0
    s_mov_b32 exec_hi, 0xff0000
    v_add_u32 v12, s13, v5
    v_mov_b32 v6, s12
    s_mov_b64 exec, -1
    v_max_u32_dpp v10, v10, v10 row_shr:4 row_mask:0xf bank_mask:0xf
    s_nop 1
    v_max_u32_dpp v10, v10, v10 row_shr:8 row_mask:0xf bank_mask:0xf
    s_nop 1
    v_max_u32_dpp v10, v10, v10 row_bcast:15 row_mask:0xa bank_mask:0xf
    s_nop 1
    v_max_u32_dpp v10, v10, v10 row_bcast:31 row_mask:0xc bank_mask:0xf
    s_nop 0
    v_readlane_b32 s8, v10, 63
    s_add_u32 s12, s12, s8
    s_and_b32 s13, s12, 0x7ff
    s_sub_u32 s13, 2047, s13
    s_mul_i32 s13, s13, 1152
    s_mov_b32 exec_lo, 0x0
    s_mov_b32 exec_hi, 0xff000000
    v_add_u32 v12, s13, v5
    v_mov_b32 v6, s12
    s_mov_b64 exec, -1
    s_mov_b32 s14, 0
SEL_GATHER:
    s_mov_b32 m0, 147712
    s_nop 0
    buffer_load_dwordx4 v12, s[52:55], 0 offen offset:0 lds
    s_mov_b32 m0, 148608
    s_nop 0
    buffer_load_dwordx4 v12, s[52:55], 0 offen offset:128 lds
    s_mov_b32 m0, 149504
    s_nop 0
    buffer_load_dwordx4 v12, s[52:55], 0 offen offset:256 lds
    s_mov_b32 m0, 150400
    s_nop 0
    buffer_load_dwordx4 v12, s[52:55], 0 offen offset:384 lds
    s_mov_b32 m0, 151296
    s_nop 0
    buffer_load_dwordx4 v12, s[52:55], 0 offen offset:512 lds
    s_mov_b32 m0, 152192
    s_nop 0
    buffer_load_dwordx4 v12, s[52:55], 0 offen offset:640 lds
    s_mov_b32 m0, 153088
    s_nop 0
    buffer_load_dwordx4 v12, s[52:55], 0 offen offset:768 lds
    s_mov_b32 m0, 153984
    s_nop 0
    buffer_load_dwordx4 v12, s[52:55], 0 offen offset:896 lds
    s_mov_b32 m0, 154880
    s_nop 0
    buffer_load_dwordx4 v12, s[52:55], 0 offen offset:1024 lds
    v_mov_b32 v13, 1
    s_mov_b64 exec, 1
    ds_add_u32 v1, v13 offset:40
    s_mov_b64 exec, -1
    s_cmp_lg_u32 s14, 0
    s_cbranch_scc1 SEL_OK
    v_sub_u32 v16, v80, v9
    v_sub_u32 v17, v81, v9
    v_sub_u32 v18, v82, v9
    v_sub_u32 v19, v83, v9
    v_sub_u32 v20, v84, v9
    v_sub_u32 v21, v85, v9
    v_sub_u32 v22, v86, v9
    v_sub_u32 v23, v87, v9
    v_sub_u32 v24, v88, v9
    v_sub_u32 v25, v89, v9
    v_sub_u32 v26, v90, v9
    v_sub_u32 v27, v91, v9
    v_sub_u32 v28, v92, v9
    v_sub_u32 v29, v93, v9
    v_sub_u32 v30, v94, v9
    v_sub_u32 v31, v95, v9
    v_sub_u32 v32, v96, v9
    v_sub_u32 v33, v97, v9
    v_sub_u32 v34, v98, v9
    v_sub_u32 v35, v99, v9
    v_sub_u32 v36, v100, v9
    v_sub_u32 v37, v101, v9
    v_sub_u32 v38, v102, v9
    v_sub_u32 v39, v103, v9
    v_sub_u32 v40, v104, v9
    v_sub_u32 v41, v105, v9
    v_sub_u32 v42, v106, v9
    v_sub_u32 v43, v107, v9
    v_sub_u32 v44, v108, v9
    v_sub_u32 v45, v109, v9
    v_sub_u32 v46, v110, v9
    v_sub_u32 v47, v111, v9
    v_max3_u32 v16, v16, v17, v18
    v_max3_u32 v19, v19, v20, v21
    v_max3_u32 v22, v22, v23, v24
    v_max3_u32 v25, v25, v26, v27
    v_max3_u32 v28, v28, v29, v30
    v_max3_u32 v31, v31, v32, v33
    v_max3_u32 v34, v34, v35, v36
    v_max3_u32 v37, v37, v38, v39
    v_max3_u32 v40, v40, v41, v42
    v_max3_u32 v43, v43, v44, v45
    v_max3_u32 v16, v16, v19, v22
    v_max3_u32 v25, v25, v28, v31
    v_max3_u32 v34, v34, v37, v40
    v_max3_u32 v43, v43, v46, v47
    v_max3_u32 v16, v16, v25, v34
    v_max_u32 v16, v16, v43
    v_add_u32 v16, v16, v9
    v_cmp_lt_u32 vcc, s12, v16
    s_cmp_eq_u64 vcc, 0
    s_cbranch_scc1 SEL_OK
    s_waitcnt vmcnt(0)
    s_mov_b32 s12, 0
    s_mov_b64 s[56:57], 0xff
SEL_SLOW:
    v_subrev_u32 v16, s12, v80
    v_subrev_u32 v17, s12, v81
    v_subrev_u32 v18, s12, v82
    v_subrev_u32 v19, s12, v83
    v_subrev_u32 v20, s12, v84
    v_subrev_u32 v21, s12, v85
    v_subrev_u32 v22, s12, v86
    v_subrev_u32 v23, s12, v87
    v_subrev_u32 v24, s12, v88
    v_subrev_u32 v25, s12, v89
    v_subrev_u32 v26, s12, v90
    v_subrev_u32 v27, s12, v91
    v_subrev_u32 v28, s12, v92
    v_subrev_u32 v29, s12, v93
    v_subrev_u32 v30, s12, v94
    v_subrev_u32 v31, s12, v95
    v_subrev_u32 v32, s12, v96
    v_subrev_u32 v33, s12, v97
    v_subrev_u32 v34, s12, v98
    v_subrev_u32 v35, s12, v99
    v_subrev_u32 v36, s12, v100
    v_subrev_u32 v37, s12, v101
    v_subrev_u32 v38, s12, v102
    v_subrev_u32 v39, s12, v103
    v_subrev_u32 v40, s12, v104
    v_subrev_u32 v41, s12, v105
    v_subrev_u32 v42, s12, v106
    v_subrev_u32 v43, s12, v107
    v_subrev_u32 v44, s12, v108
    v_subrev_u32 v45, s12, v109
    v_subrev_u32 v46, s12, v110
    v_subrev_u32 v47, s12, v111
    v_max3_u32 v16, v16, v17, v18
    v_max3_u32 v19, v19, v20, v21
    v_max3_u32 v22, v22, v23, v24
    v_max3_u32 v25, v25, v26, v27
    v_max3_u32 v28, v28, v29, v30
    v_max3_u32 v31, v31, v32, v33
    v_max3_u32 v34, v34, v35, v36
    v_max3_u32 v37, v37, v38, v39
    v_max3_u32 v40, v40, v41, v42
    v_max3_u32 v43, v43, v44, v45
    v_max3_u32 v16, v16, v19, v22
    v_max3_u32 v25, v25, v28, v31
    v_max3_u32 v34, v34, v37, v40
    v_max3_u32 v43, v43, v46, v47
    v_max3_u32 v16, v16, v25, v34
    v_max_u32 v16, v16, v43
    s_nop 1
    v_max_u32_dpp v16, v16, v16 row_shr:1 row_mask:0xf bank_mask:0xf
    s_nop 1
    v_max_u32_dpp v16, v16, v16 row_shr:2 row_mask:0xf bank_mask:0xf
    s_nop 1
    v_max_u32_dpp v16, v16, v16 row_shr:4 row_mask:0xf bank_mask:0xf
    s_nop 1
    v_max_u32_dpp v16, v16, v16 row_shr:8 row_mask:0xf bank_mask:0xf
    s_nop 1
    v_max_u32_dpp v16, v16, v16 row_bcast:15 row_mask:0xa bank_mask:0xf
    s_nop 1
    v_max_u32_dpp v16, v16, v16 row_bcast:31 row_mask:0xc bank_mask:0xf
    s_nop 0
    v_readlane_b32 s8, v16, 63
    s_add_u32 s12, s12, s8
    s_and_b32 s13, s12, 0x7ff
    s_sub_u32 s13, 2047, s13
    s_mul_i32 s13, s13, 1152
    s_mov_b64 exec, s[56:57]
    v_add_u32 v12, s13, v5
    v_mov_b32 v6, s12
    s_mov_b64 exec, -1
    s_lshl_b64 s[56:57], s[56:57], 8
    s_add_u32 s14, s14, 1
    s_cmp_lt_u32 s14, 8
    s_cbranch_scc1 SEL_SLOW
    s_branch SEL_GATHER
SEL_OK:
    s_cmp_lg_u32 s2, 0
    s_cbranch_scc1 SEL_NOPUB
    v_mov_b32 v7, v14
    v_add_u32 v8, 16384, v2
    s_mov_b32 exec_lo, 0x01010101
    s_mov_b32 exec_hi, 0x01010101
    global_store_dwordx2 v8, v[6:7], s[50:51] sc1
    s_mov_b64 exec, 1
    global_store_dword v8, v14, s[50:51] offset:256 sc1
    s_mov_b64 exec, -1
    s_waitcnt vmcnt(2)
    s_branch SEL_END
SEL_NOPUB:
    s_waitcnt vmcnt(0)
SEL_END:
    v_mov_b32 v8, 3
    ds_write_b32 v1, v8 offset:84
    s_endpgm
F_COMP:
F_COMP2:
    s_and_b32 s12, s3, 3
    v_lshrrev_b32 v5, 2, v3
    v_bfe_u32 v7, v3, 3, 1
    v_and_b32 v13, 1, v4
    v_lshl_or_b32 v14, v13, 1, v7
    v_and_b32 v15, 7, v3
    v_mul_u32_u24 v16, 144, v15
    v_add_u32 v16, 156928, v16
    s_mov_b32 s56, 0xff00ff00
    s_mov_b32 s57, 0xff00ff00
    s_lshr_b32 s8, s3, 2
    s_cmp_lg_u32 s8, 1
    s_cbranch_scc1 F_DOWN
    v_bfe_u32 v6, v3, 1, 1
    v_lshl_or_b32 v8, v6, 2, v14
    v_xor_b32 v8, s12, v8
    v_lshlrev_b32 v8, 4, v8
    v_lshl_add_u32 v8, v5, 7, v8
    v_lshl_add_u32 v8, v6, 10, v8
    v_lshl_add_u32 v8, v4, 11, v8
    v_and_b32 v9, 1, v3
    v_lshl_add_u32 v8, v9, 3, v8
    v_xor_b32 v9, 64, v8
    v_add_u32 v10, 49408, v8
    v_add_u32 v11, 49408, v9
    v_lshlrev_b32 v6, 2, v13
    v_lshrrev_b32 v5, 1, v4
    v_add_u32 v6, v6, v5
    v_lshl_add_u32 v6, v7, 5, v6
    s_lshl_b32 s8, s12, 3
    v_add_lshl_u32 v6, v6, s8, 1
    v_add_u32 v5, v6, v16
    v_and_b32 v6, 6, v3
    v_xor_b32 v6, v6, v4
    v_lshlrev_b32 v6, 4, v6
    v_lshl_add_u32 v6, v15, 7, v6
    v_add_u32 v6, 147712, v6
    v_xor_b32 v7, 64, v6
    s_mov_b32 s9, 0
SP_26:
    ds_read_b32 v12, v1 offset:16
    s_waitcnt lgkmcnt(0)
    v_readfirstlane_b32 s8, v12
    s_add_u32 s9, s9, 1
    s_cmp_ge_u32 s8, 3
    s_cbranch_scc1 SP_26_D
    s_sleep 1
    s_cmp_lt_u32 s9, 524288
    s_cbranch_scc1 SP_26
SP_26_D:
    ds_read_b64_tr_b16 v[24:25], v8 offset:256
    ds_read_b64_tr_b16 v[26:27], v8 offset:768
    ds_read_b64_tr_b16 v[28:29], v9 offset:256
    ds_read_b64_tr_b16 v[30:31], v9 offset:768
    ds_read_b64_tr_b16 v[32:33], v8 offset:8448
    ds_read_b64_tr_b16 v[34:35], v8 offset:8960
    ds_read_b64_tr_b16 v[36:37], v9 offset:8448
    ds_read_b64_tr_b16 v[38:39], v9 offset:8960
    ds_read_b64_tr_b16 v[40:41], v8 offset:16640
    ds_read_b64_tr_b16 v[42:43], v8 offset:17152
    ds_read_b64_tr_b16 v[44:45], v9 offset:16640
    ds_read_b64_tr_b16 v[46:47], v9 offset:17152
    s_waitcnt lgkmcnt(0)
    v_mov_b32 v12, 1
    s_mov_b64 exec, 1
    ds_add_u32 v1, v12 offset:48
    s_mov_b64 exec, -1
    s_mov_b32 s9, 0
SP_27:
    ds_read_b32 v12, v1 offset:20
    s_waitcnt lgkmcnt(0)
    v_readfirstlane_b32 s8, v12
    s_add_u32 s9, s9, 1
    s_cmp_ge_u32 s8, 3
    s_cbranch_scc1 SP_27_D
    s_sleep 1
    s_cmp_lt_u32 s9, 524288
    s_cbranch_scc1 SP_27
SP_27_D:
    ds_read_b64_tr_b16 v[48:49], v8 offset:24832
    ds_read_b64_tr_b16 v[50:51], v8 offset:25344
    ds_read_b64_tr_b16 v[52:53], v9 offset:24832
    ds_read_b64_tr_b16 v[54:55], v9 offset:25344
    ds_read_b64_tr_b16 v[56:57], v8 offset:33024
    ds_read_b64_tr_b16 v[58:59], v8 offset:33536
    ds_read_b64_tr_b16 v[60:61], v9 offset:33024
    ds_read_b64_tr_b16 v[62:63], v9 offset:33536
    ds_read_b64_tr_b16 v[64:65], v8 offset:41216
    ds_read_b64_tr_b16 v[66:67], v8 offset:41728
    ds_read_b64_tr_b16 v[68:69], v9 offset:41216
    ds_read_b64_tr_b16 v[70:71], v9 offset:41728
    s_waitcnt lgkmcnt(0)
    v_mov_b32 v12, 1
    s_mov_b64 exec, 1
    ds_add_u32 v1, v12 offset:52
    s_mov_b64 exec, -1
    s_mov_b32 s9, 0
SP_28:
    ds_read_b32 v12, v1 offset:24
    s_waitcnt lgkmcnt(0)
    v_readfirstlane_b32 s8, v12
    s_add_u32 s9, s9, 1
    s_cmp_ge_u32 s8, 3
    s_cbranch_scc1 SP_28_D
    s_sleep 1
    s_cmp_lt_u32 s9, 524288
    s_cbranch_scc1 SP_28
SP_28_D:
    ds_read_b64_tr_b16 v[72:73], v10 offset:0
    ds_read_b64_tr_b16 v[74:75], v10 offset:512
    ds_read_b64_tr_b16 v[76:77], v11 offset:0
    ds_read_b64_tr_b16 v[78:79], v11 offset:512
    ds_read_b64_tr_b16 v[80:81], v10 offset:8192
    ds_read_b64_tr_b16 v[82:83], v10 offset:8704
    ds_read_b64_tr_b16 v[84:85], v11 offset:8192
    ds_read_b64_tr_b16 v[86:87], v11 offset:8704
    ds_read_b64_tr_b16 v[88:89], v10 offset:16384
    ds_read_b64_tr_b16 v[90:91], v10 offset:16896
    ds_read_b64_tr_b16 v[92:93], v11 offset:16384
    ds_read_b64_tr_b16 v[94:95], v11 offset:16896
    s_waitcnt lgkmcnt(0)
    v_mov_b32 v12, 1
    s_mov_b64 exec, 1
    ds_add_u32 v1, v12 offset:56
    s_mov_b64 exec, -1
    s_mov_b32 s9, 0
SP_29:
    ds_read_b32 v12, v1 offset:28
    s_waitcnt lgkmcnt(0)
    v_readfirstlane_b32 s8, v12
    s_add_u32 s9, s9, 1
    s_cmp_ge_u32 s8, 3
    s_cbranch_scc1 SP_29_D
    s_sleep 1
    s_cmp_lt_u32 s9, 524288
    s_cbranch_scc1 SP_29
SP_29_D:
    ds_read_b64_tr_b16 v[96:97], v8 offset:256
    ds_read_b64_tr_b16 v[98:99], v8 offset:768
    ds_read_b64_tr_b16 v[100:101], v9 offset:256
    ds_read_b64_tr_b16 v[102:103], v9 offset:768
    ds_read_b64_tr_b16 v[104:105], v8 offset:8448
    ds_read_b64_tr_b16 v[106:107], v8 offset:8960
    ds_read_b64_tr_b16 v[108:109], v9 offset:8448
    ds_read_b64_tr_b16 v[110:111], v9 offset:8960
    ds_read_b64_tr_b16 v[112:113], v8 offset:16640
    ds_read_b64_tr_b16 v[114:115], v8 offset:17152
    ds_read_b64_tr_b16 v[116:117], v9 offset:16640
    ds_read_b64_tr_b16 v[118:119], v9 offset:17152
    s_mov_b32 s9, 0
SP_30:
    ds_read_b32 v12, v1 offset:32
    s_waitcnt lgkmcnt(0)
    v_readfirstlane_b32 s8, v12
    s_add_u32 s9, s9, 1
    s_cmp_ge_u32 s8, 3
    s_cbranch_scc1 SP_30_D
    s_sleep 1
    s_cmp_lt_u32 s9, 524288
    s_cbranch_scc1 SP_30
SP_30_D:
    ds_read_b64_tr_b16 v[120:121], v8 offset:24832
    ds_read_b64_tr_b16 v[122:123], v8 offset:25344
    ds_read_b64_tr_b16 v[124:125], v9 offset:24832
    ds_read_b64_tr_b16 v[126:127], v9 offset:25344
    ds_read_b64_tr_b16 v[128:129], v8 offset:33024
    ds_read_b64_tr_b16 v[130:131], v8 offset:33536
    ds_read_b64_tr_b16 v[132:133], v9 offset:33024
    ds_read_b64_tr_b16 v[134:135], v9 offset:33536
    ds_read_b64_tr_b16 v[136:137], v8 offset:41216
    ds_read_b64_tr_b16 v[138:139], v8 offset:41728
    ds_read_b64_tr_b16 v[140:141], v9 offset:41216
    ds_read_b64_tr_b16 v[142:143], v9 offset:41728
    s_mov_b32 s9, 0
SP_31:
    ds_read_b32 v12, v1 offset:36
    s_waitcnt lgkmcnt(0)
    v_readfirstlane_b32 s8, v12
    s_add_u32 s9, s9, 1
    s_cmp_ge_u32 s8, 3
    s_cbranch_scc1 SP_31_D
    s_sleep 1
    s_cmp_lt_u32 s9, 524288
    s_cbranch_scc1 SP_31
SP_31_D:
    ds_read_b64_tr_b16 v[144:145], v10 offset:0
    ds_read_b64_tr_b16 v[146:147], v10 offset:512
    ds_read_b64_tr_b16 v[148:149], v11 offset:0
    ds_read_b64_tr_b16 v[150:151], v11 offset:512
    ds_read_b64_tr_b16 v[152:153], v10 offset:8192
    ds_read_b64_tr_b16 v[154:155], v10 offset:8704
    ds_read_b64_tr_b16 v[156:157], v11 offset:8192
    ds_read_b64_tr_b16 v[158:159], v11 offset:8704
    ds_read_b64_tr_b16 v[160:161], v10 offset:16384
    ds_read_b64_tr_b16 v[162:163], v10 offset:16896
    ds_read_b64_tr_b16 v[164:165], v11 offset:16384
    ds_read_b64_tr_b16 v[166:167], v11 offset:16896
    s_setprio 3
    s_mov_b32 s9, 0
SP_32:
    ds_read_b32 v12, v1 offset:84
    s_waitcnt lgkmcnt(0)
    v_readfirstlane_b32 s8, v12
    s_add_u32 s9, s9, 1
    s_cmp_ge_u32 s8, 1
    s_cbranch_scc1 SP_32_D
    s_cmp_lt_u32 s9, 524288
    s_cbranch_scc1 SP_32
SP_32_D:
    ds_read_b128 v[16:19], v6 offset:0
    ds_read_b128 v[20:23], v7 offset:0
    s_waitcnt lgkmcnt(1)
    v_mfma_f32_16x16x32_bf16 v[8:11], v[24:27], v[16:19], 0
    ds_read_b128 v[24:27], v6 offset:1024
    v_mfma_f32_16x16x32_bf16 v[12:15], v[28:31], v[16:19], 0
    ds_read_b128 v[28:31], v7 offset:1024
    s_waitcnt lgkmcnt(2)
    v_mfma_f32_16x16x32_bf16 v[8:11], v[32:35], v[20:23], v[8:11]
    ds_read_b128 v[32:35], v6 offset:2048
    v_mfma_f32_16x16x32_bf16 v[12:15], v[36:39], v[20:23], v[12:15]
    ds_read_b128 v[36:39], v7 offset:2048
    s_waitcnt lgkmcnt(3)
    v_mfma_f32_16x16x32_bf16 v[8:11], v[40:43], v[24:27], v[8:11]
    ds_read_b128 v[40:43], v6 offset:3072
    v_mfma_f32_16x16x32_bf16 v[12:15], v[44:47], v[24:27], v[12:15]
    ds_read_b128 v[44:47], v7 offset:3072
    s_waitcnt lgkmcnt(4)
    v_mfma_f32_16x16x32_bf16 v[8:11], v[48:51], v[28:31], v[8:11]
    ds_read_b128 v[48:51], v6 offset:4096
    v_mfma_f32_16x16x32_bf16 v[12:15], v[52:55], v[28:31], v[12:15]
    ds_read_b128 v[52:55], v7 offset:4096
    s_waitcnt lgkmcnt(5)
    v_mfma_f32_16x16x32_bf16 v[8:11], v[56:59], v[32:35], v[8:11]
    ds_read_b128 v[56:59], v6 offset:5120
    v_mfma_f32_16x16x32_bf16 v[12:15], v[60:63], v[32:35], v[12:15]
    ds_read_b128 v[60:63], v7 offset:5120
    s_waitcnt lgkmcnt(6)
    v_mfma_f32_16x16x32_bf16 v[8:11], v[64:67], v[36:39], v[8:11]
    ds_read_b128 v[64:67], v6 offset:6144
    v_mfma_f32_16x16x32_bf16 v[12:15], v[68:71], v[36:39], v[12:15]
    ds_read_b128 v[68:71], v7 offset:6144
    s_waitcnt lgkmcnt(7)
    v_mfma_f32_16x16x32_bf16 v[8:11], v[72:75], v[40:43], v[8:11]
    ds_read_b128 v[72:75], v6 offset:7168
    v_mfma_f32_16x16x32_bf16 v[12:15], v[76:79], v[40:43], v[12:15]
    ds_read_b128 v[76:79], v7 offset:7168
    s_waitcnt lgkmcnt(8)
    v_mfma_f32_16x16x32_bf16 v[8:11], v[80:83], v[44:47], v[8:11]
    ds_read_b128 v[80:83], v6 offset:8192
    v_mfma_f32_16x16x32_bf16 v[12:15], v[84:87], v[44:47], v[12:15]
    ds_read_b128 v[84:87], v7 offset:8192
    s_waitcnt lgkmcnt(9)
    v_mfma_f32_16x16x32_bf16 v[8:11], v[88:91], v[48:51], v[8:11]
    v_mfma_f32_16x16x32_bf16 v[12:15], v[92:95], v[48:51], v[12:15]
    s_waitcnt lgkmcnt(8)
    v_mfma_f32_16x16x32_bf16 v[8:11], v[96:99], v[52:55], v[8:11]
    v_mfma_f32_16x16x32_bf16 v[12:15], v[100:103], v[52:55], v[12:15]
    s_waitcnt lgkmcnt(7)
    v_mfma_f32_16x16x32_bf16 v[8:11], v[104:107], v[56:59], v[8:11]
    v_mfma_f32_16x16x32_bf16 v[12:15], v[108:111], v[56:59], v[12:15]
    s_waitcnt lgkmcnt(6)
    v_mfma_f32_16x16x32_bf16 v[8:11], v[112:115], v[60:63], v[8:11]
    v_mfma_f32_16x16x32_bf16 v[12:15], v[116:119], v[60:63], v[12:15]
    s_waitcnt lgkmcnt(5)
    v_mfma_f32_16x16x32_bf16 v[8:11], v[120:123], v[64:67], v[8:11]
    v_mfma_f32_16x16x32_bf16 v[12:15], v[124:127], v[64:67], v[12:15]
    s_waitcnt lgkmcnt(4)
    v_mfma_f32_16x16x32_bf16 v[8:11], v[128:131], v[68:71], v[8:11]
    v_mfma_f32_16x16x32_bf16 v[12:15], v[132:135], v[68:71], v[12:15]
    s_waitcnt lgkmcnt(3)
    v_mfma_f32_16x16x32_bf16 v[8:11], v[136:139], v[72:75], v[8:11]
    v_mfma_f32_16x16x32_bf16 v[12:15], v[140:143], v[72:75], v[12:15]
    s_waitcnt lgkmcnt(2)
    v_mfma_f32_16x16x32_bf16 v[8:11], v[144:147], v[76:79], v[8:11]
    v_mfma_f32_16x16x32_bf16 v[12:15], v[148:151], v[76:79], v[12:15]
    s_waitcnt lgkmcnt(1)
    v_mfma_f32_16x16x32_bf16 v[8:11], v[152:155], v[80:83], v[8:11]
    v_mfma_f32_16x16x32_bf16 v[12:15], v[156:159], v[80:83], v[12:15]
    s_waitcnt lgkmcnt(0)
    v_mfma_f32_16x16x32_bf16 v[8:11], v[160:163], v[84:87], v[8:11]
    v_mfma_f32_16x16x32_bf16 v[12:15], v[164:167], v[84:87], v[12:15]
    s_nop 7
    v_cndmask_b32 v8, v8, v12, s[56:57]
    v_cndmask_b32 v9, v9, v13, s[56:57]
    v_cndmask_b32 v10, v10, v14, s[56:57]
    v_cndmask_b32 v11, v11, v15, s[56:57]
    v_permlane32_swap_b32 v8, v9
    s_nop 0
    v_permlane32_swap_b32 v10, v11
    v_cvt_pk_bf16_f32 v9, v8, v9
    v_cvt_pk_bf16_f32 v11, v10, v11
    v_lshlrev_b32 v8, 16, v9
    v_lshlrev_b32 v10, 16, v11
    v_mul_f32 v12, 0xbfb8aa3b, v8
    v_mul_f32 v13, 0xbfb8aa3b, v10
    v_exp_f32 v12, v12
    v_exp_f32 v13, v13
    v_and_b32 v9, 0xffff0000, v9
    v_and_b32 v11, 0xffff0000, v11
    v_add_f32 v12, 1.0, v12
    v_add_f32 v13, 1.0, v13
    v_rcp_f32 v12, v12
    v_rcp_f32 v13, v13
    v_mul_f32 v8, v8, v12
    v_mul_f32 v10, v10, v13
    v_cvt_pk_bf16_f32 v8, v8, v8
    v_cvt_pk_bf16_f32 v10, v10, v10
    v_and_b32 v8, 0xffff0000, v8
    v_and_b32 v10, 0xffff0000, v10
    v_mul_f32 v8, v8, v9
    v_mul_f32 v10, v10, v11
    v_cvt_pk_bf16_f32 v8, v8, v10
    ds_write_b16 v5, v8
    ds_write_b16_d16_hi v5, v8 offset:4
    s_waitcnt lgkmcnt(0)
    s_barrier
    s_endpgm
F_DOWN:
    v_lshl_add_u32 v10, v4, 4, v16
    v_mul_u32_u24 v8, 9216, v4
    s_mul_i32 s13, s7, 73728
    s_mov_b32 s60, 0x7060500
    s_mov_b32 s61, 0x7060501
    s_mov_b32 s62, 0x7060502
    s_mov_b32 s63, 0x7060503
    s_mov_b32 s64, 0x05040100
    s_mov_b32 s65, 0x07060302
    s_lshl_b32 s14, s7, 7
    s_add_u32 s14, s14, 32768
    v_lshl_add_u32 v11, v15, 4, s14
    s_waitcnt lgkmcnt(0)
    s_mov_b32 s52, s50
    s_mov_b32 s53, s51
    s_mov_b32 s54, 268435456
    s_mov_b32 s55, 0x20000
    s_mov_b32 s68, s42
    s_mov_b32 s69, s43
    s_mov_b32 s70, 5308416
    s_mov_b32 s71, 0x20000
    s_cmp_eq_u32 s3, 9
    s_cbranch_scc1 F_DN2
    v_lshl_add_u32 v8, v3, 4, v8
    s_lshl_b32 s8, s3, 8
    s_add_u32 s13, s13, s8
    s_lshl_b32 s8, s3, 5
    v_lshl_add_u32 v6, v4, 3, v7
    v_add_u32 v6, s8, v6
    v_mul_u32_u24 v6, 9216, v6
    v_add_u32 v11, v6, v11
    s_mov_b32 s9, 0
SP_33:
    ds_read_b32 v17, v1 offset:8
    s_waitcnt lgkmcnt(0)
    v_readfirstlane_b32 s8, v17
    s_add_u32 s9, s9, 1
    s_cmp_lg_u32 s8, 0
    s_cbranch_scc1 SP_33_D
    s_sleep 2
    s_cmp_lt_u32 s9, 524288
    s_cbranch_scc1 SP_33
SP_33_D:
    s_mov_b32 s9, 0
SP_34:
    ds_read_b32 v12, v1 offset:40
    s_waitcnt lgkmcnt(0)
    v_readfirstlane_b32 s8, v12
    s_add_u32 s9, s9, 1
    s_cmp_ge_u32 s8, 3
    s_cbranch_scc1 SP_34_D
    s_sleep 1
    s_cmp_lt_u32 s9, 524288
    s_cbranch_scc1 SP_34
SP_34_D:
    s_setprio 2
    buffer_load_dwordx4 v[24:27], v8, s[68:71], s13 offen offset:0
    buffer_load_dwordx4 v[28:31], v8, s[68:71], s13 offen offset:1152
    buffer_load_dwordx4 v[32:35], v8, s[68:71], s13 offen offset:2304
    buffer_load_dwordx4 v[36:39], v8, s[68:71], s13 offen offset:3456
    s_add_u32 s13, s13, 4608
    s_mov_b32 s9, 0
SP_35:
    ds_read_b32 v12, v1 offset:40
    s_waitcnt lgkmcnt(0)
    v_readfirstlane_b32 s8, v12
    s_add_u32 s9, s9, 1
    s_cmp_ge_u32 s8, 4
    s_cbranch_scc1 SP_35_D
    s_sleep 1
    s_cmp_lt_u32 s9, 524288
    s_cbranch_scc1 SP_35
SP_35_D:
    buffer_load_dwordx4 v[40:43], v8, s[68:71], s13 offen offset:0
    buffer_load_dwordx4 v[44:47], v8, s[68:71], s13 offen offset:1152
    buffer_load_dwordx4 v[48:51], v8, s[68:71], s13 offen offset:2304
    buffer_load_dwordx4 v[52:55], v8, s[68:71], s13 offen offset:3456
    s_add_u32 s13, s13, 32256
    buffer_load_dwordx4 v[88:91], v8, s[68:71], s13 offen offset:0
    buffer_load_dwordx4 v[92:95], v8, s[68:71], s13 offen offset:1152
    buffer_load_dwordx4 v[96:99], v8, s[68:71], s13 offen offset:2304
    buffer_load_dwordx4 v[100:103], v8, s[68:71], s13 offen offset:3456
    s_add_u32 s13, s13, 4608
    buffer_load_dwordx4 v[104:107], v8, s[68:71], s13 offen offset:0
    buffer_load_dwordx4 v[108:111], v8, s[68:71], s13 offen offset:1152
    buffer_load_dwordx4 v[112:115], v8, s[68:71], s13 offen offset:2304
    buffer_load_dwordx4 v[116:119], v8, s[68:71], s13 offen offset:3456
    s_add_u32 s13, s13, 32256
    s_waitcnt vmcnt(14)
    v_perm_b32 v56, v28, v24, s64
    v_perm_b32 v60, v28, v24, s65
    v_perm_b32 v64, v29, v25, s64
    v_perm_b32 v68, v29, v25, s65
    v_perm_b32 v72, v30, v26, s64
    v_perm_b32 v76, v30, v26, s65
    v_perm_b32 v80, v31, v27, s64
    v_perm_b32 v84, v31, v27, s65
    s_waitcnt vmcnt(12)
    v_perm_b32 v57, v36, v32, s64
    v_perm_b32 v61, v36, v32, s65
    v_perm_b32 v65, v37, v33, s64
    v_perm_b32 v69, v37, v33, s65
    v_perm_b32 v73, v38, v34, s64
    v_perm_b32 v77, v38, v34, s65
    v_perm_b32 v81, v39, v35, s64
    v_perm_b32 v85, v39, v35, s65
    s_waitcnt vmcnt(10)
    v_perm_b32 v58, v44, v40, s64
    v_perm_b32 v62, v44, v40, s65
    v_perm_b32 v66, v45, v41, s64
    v_perm_b32 v70, v45, v41, s65
    v_perm_b32 v74, v46, v42, s64
    v_perm_b32 v78, v46, v42, s65
    v_perm_b32 v82, v47, v43, s64
    v_perm_b32 v86, v47, v43, s65
    s_waitcnt vmcnt(8)
    v_perm_b32 v59, v52, v48, s64
    v_perm_b32 v63, v52, v48, s65
    v_perm_b32 v67, v53, v49, s64
    v_perm_b32 v71, v53, v49, s65
    v_perm_b32 v75, v54, v50, s64
    v_perm_b32 v79, v54, v50, s65
    v_perm_b32 v83, v55, v51, s64
    v_perm_b32 v87, v55, v51, s65
    s_waitcnt vmcnt(6)
    v_perm_b32 v24, v92, v88, s64
    v_perm_b32 v28, v92, v88, s65
    v_perm_b32 v32, v93, v89, s64
    v_perm_b32 v36, v93, v89, s65
    v_perm_b32 v40, v94, v90, s64
    v_perm_b32 v44, v94, v90, s65
    v_perm_b32 v48, v95, v91, s64
    v_perm_b32 v52, v95, v91, s65
    s_waitcnt vmcnt(4)
    v_perm_b32 v25, v100, v96, s64
    v_perm_b32 v29, v100, v96, s65
    v_perm_b32 v33, v101, v97, s64
    v_perm_b32 v37, v101, v97, s65
    v_perm_b32 v41, v102, v98, s64
    v_perm_b32 v45, v102, v98, s65
    v_perm_b32 v49, v103, v99, s64
    v_perm_b32 v53, v103, v99, s65
    s_waitcnt vmcnt(2)
    v_perm_b32 v26, v108, v104, s64
    v_perm_b32 v30, v108, v104, s65
    v_perm_b32 v34, v109, v105, s64
    v_perm_b32 v38, v109, v105, s65
    v_perm_b32 v42, v110, v106, s64
    v_perm_b32 v46, v110, v106, s65
    v_perm_b32 v50, v111, v107, s64
    v_perm_b32 v54, v111, v107, s65
    s_waitcnt vmcnt(0)
    v_perm_b32 v27, v116, v112, s64
    v_perm_b32 v31, v116, v112, s65
    v_perm_b32 v35, v117, v113, s64
    v_perm_b32 v39, v117, v113, s65
    v_perm_b32 v43, v118, v114, s64
    v_perm_b32 v47, v118, v114, s65
    v_perm_b32 v51, v119, v115, s64
    v_perm_b32 v55, v119, v115, s65
    s_barrier
    ds_read_b128 v[152:155], v10 offset:0
    ds_read_b128 v[156:159], v10 offset:64
    s_waitcnt lgkmcnt(0)
    v_mfma_f32_16x16x32_bf16 v[120:123], v[56:59], v[152:155], 0
    v_mfma_f32_16x16x32_bf16 v[120:123], v[24:27], v[156:159], v[120:123]
    v_mfma_f32_16x16x32_bf16 v[124:127], v[60:63], v[152:155], 0
    v_mfma_f32_16x16x32_bf16 v[124:127], v[28:31], v[156:159], v[124:127]
    v_mfma_f32_16x16x32_bf16 v[128:131], v[64:67], v[152:155], 0
    v_mfma_f32_16x16x32_bf16 v[128:131], v[32:35], v[156:159], v[128:131]
    v_mfma_f32_16x16x32_bf16 v[132:135], v[68:71], v[152:155], 0
    v_mfma_f32_16x16x32_bf16 v[132:135], v[36:39], v[156:159], v[132:135]
    v_mfma_f32_16x16x32_bf16 v[136:139], v[72:75], v[152:155], 0
    v_mfma_f32_16x16x32_bf16 v[136:139], v[40:43], v[156:159], v[136:139]
    v_mfma_f32_16x16x32_bf16 v[140:143], v[76:79], v[152:155], 0
    v_mfma_f32_16x16x32_bf16 v[140:143], v[44:47], v[156:159], v[140:143]
    v_mfma_f32_16x16x32_bf16 v[144:147], v[80:83], v[152:155], 0
    v_mfma_f32_16x16x32_bf16 v[144:147], v[48:51], v[156:159], v[144:147]
    v_mfma_f32_16x16x32_bf16 v[148:151], v[84:87], v[152:155], 0
    v_mfma_f32_16x16x32_bf16 v[148:151], v[52:55], v[156:159], v[148:151]
    s_nop 1
    v_cndmask_b32 v88, v120, v136, s[56:57]
    s_nop 0
    v_cndmask_b32 v89, v124, v140, s[56:57]
    s_nop 0
    v_cndmask_b32 v90, v128, v144, s[56:57]
    s_nop 0
    v_cndmask_b32 v91, v132, v148, s[56:57]
    v_perm_b32 v88, v88, v17, s60
    v_perm_b32 v89, v89, v17, s61
    v_perm_b32 v90, v90, v17, s62
    v_perm_b32 v91, v91, v17, s63
    s_mov_b32 s12, 0
    buffer_store_dwordx4 v[88:91], v11, s[52:55], s12 offen sc1
    v_cndmask_b32 v92, v121, v137, s[56:57]
    v_cndmask_b32 v93, v125, v141, s[56:57]
    v_cndmask_b32 v94, v129, v145, s[56:57]
    v_cndmask_b32 v95, v133, v149, s[56:57]
    v_perm_b32 v92, v92, v17, s60
    v_perm_b32 v93, v93, v17, s61
    v_perm_b32 v94, v94, v17, s62
    v_perm_b32 v95, v95, v17, s63
    s_mov_b32 s12, 18432
    buffer_store_dwordx4 v[92:95], v11, s[52:55], s12 offen sc1
    v_cndmask_b32 v96, v122, v138, s[56:57]
    v_cndmask_b32 v97, v126, v142, s[56:57]
    v_cndmask_b32 v98, v130, v146, s[56:57]
    v_cndmask_b32 v99, v134, v150, s[56:57]
    v_perm_b32 v96, v96, v17, s60
    v_perm_b32 v97, v97, v17, s61
    v_perm_b32 v98, v98, v17, s62
    v_perm_b32 v99, v99, v17, s63
    s_mov_b32 s12, 36864
    buffer_store_dwordx4 v[96:99], v11, s[52:55], s12 offen sc1
    v_cndmask_b32 v100, v123, v139, s[56:57]
    v_cndmask_b32 v101, v127, v143, s[56:57]
    v_cndmask_b32 v102, v131, v147, s[56:57]
    v_cndmask_b32 v103, v135, v151, s[56:57]
    v_perm_b32 v100, v100, v17, s60
    v_perm_b32 v101, v101, v17, s61
    v_perm_b32 v102, v102, v17, s62
    v_perm_b32 v103, v103, v17, s63
    s_mov_b32 s12, 55296
    buffer_store_dwordx4 v[100:103], v11, s[52:55], s12 offen sc1
    s_endpgm
F_DN2:
    v_lshl_add_u32 v8, v3, 3, v8
    s_add_u32 s13, s13, 1024
    v_lshl_add_u32 v6, v4, 2, v7
    v_add_u32 v6, 128, v6
    v_mul_u32_u24 v6, 9216, v6
    v_add_u32 v11, v6, v11
    s_mov_b32 s9, 0
SP_36:
    ds_read_b32 v17, v1 offset:8
    s_waitcnt lgkmcnt(0)
    v_readfirstlane_b32 s8, v17
    s_add_u32 s9, s9, 1
    s_cmp_lg_u32 s8, 0
    s_cbranch_scc1 SP_36_D
    s_cmp_lt_u32 s9, 524288
    s_cbranch_scc1 SP_36
SP_36_D:
    buffer_load_dwordx2 v[24:25], v8, s[68:71], s13 offen offset:0
    buffer_load_dwordx2 v[26:27], v8, s[68:71], s13 offen offset:1152
    buffer_load_dwordx2 v[28:29], v8, s[68:71], s13 offen offset:2304
    buffer_load_dwordx2 v[30:31], v8, s[68:71], s13 offen offset:3456
    s_add_u32 s13, s13, 4608
    buffer_load_dwordx2 v[32:33], v8, s[68:71], s13 offen offset:0
    buffer_load_dwordx2 v[34:35], v8, s[68:71], s13 offen offset:1152
    buffer_load_dwordx2 v[36:37], v8, s[68:71], s13 offen offset:2304
    buffer_load_dwordx2 v[38:39], v8, s[68:71], s13 offen offset:3456
    s_add_u32 s13, s13, 32256
    buffer_load_dwordx2 v[88:89], v8, s[68:71], s13 offen offset:0
    buffer_load_dwordx2 v[90:91], v8, s[68:71], s13 offen offset:1152
    buffer_load_dwordx2 v[92:93], v8, s[68:71], s13 offen offset:2304
    buffer_load_dwordx2 v[94:95], v8, s[68:71], s13 offen offset:3456
    s_add_u32 s13, s13, 4608
    buffer_load_dwordx2 v[96:97], v8, s[68:71], s13 offen offset:0
    buffer_load_dwordx2 v[98:99], v8, s[68:71], s13 offen offset:1152
    buffer_load_dwordx2 v[100:101], v8, s[68:71], s13 offen offset:2304
    buffer_load_dwordx2 v[102:103], v8, s[68:71], s13 offen offset:3456
    s_add_u32 s13, s13, 32256
    s_waitcnt vmcnt(14)
    v_perm_b32 v56, v26, v24, s64
    v_perm_b32 v60, v26, v24, s65
    v_perm_b32 v64, v27, v25, s64
    v_perm_b32 v68, v27, v25, s65
    s_waitcnt vmcnt(12)
    v_perm_b32 v57, v30, v28, s64
    v_perm_b32 v61, v30, v28, s65
    v_perm_b32 v65, v31, v29, s64
    v_perm_b32 v69, v31, v29, s65
    s_waitcnt vmcnt(10)
    v_perm_b32 v58, v34, v32, s64
    v_perm_b32 v62, v34, v32, s65
    v_perm_b32 v66, v35, v33, s64
    v_perm_b32 v70, v35, v33, s65
    s_waitcnt vmcnt(8)
    v_perm_b32 v59, v38, v36, s64
    v_perm_b32 v63, v38, v36, s65
    v_perm_b32 v67, v39, v37, s64
    v_perm_b32 v71, v39, v37, s65
    s_waitcnt vmcnt(6)
    v_perm_b32 v24, v90, v88, s64
    v_perm_b32 v28, v90, v88, s65
    v_perm_b32 v32, v91, v89, s64
    v_perm_b32 v36, v91, v89, s65
    s_waitcnt vmcnt(4)
    v_perm_b32 v25, v94, v92, s64
    v_perm_b32 v29, v94, v92, s65
    v_perm_b32 v33, v95, v93, s64
    v_perm_b32 v37, v95, v93, s65
    s_waitcnt vmcnt(2)
    v_perm_b32 v26, v98, v96, s64
    v_perm_b32 v30, v98, v96, s65
    v_perm_b32 v34, v99, v97, s64
    v_perm_b32 v38, v99, v97, s65
    s_waitcnt vmcnt(0)
    v_perm_b32 v27, v102, v100, s64
    v_perm_b32 v31, v102, v100, s65
    v_perm_b32 v35, v103, v101, s64
    v_perm_b32 v39, v103, v101, s65
    s_barrier
    ds_read_b128 v[152:155], v10 offset:0
    ds_read_b128 v[156:159], v10 offset:64
    s_waitcnt lgkmcnt(0)
    v_mfma_f32_16x16x32_bf16 v[120:123], v[56:59], v[152:155], 0
    v_mfma_f32_16x16x32_bf16 v[120:123], v[24:27], v[156:159], v[120:123]
    v_mfma_f32_16x16x32_bf16 v[124:127], v[60:63], v[152:155], 0
    v_mfma_f32_16x16x32_bf16 v[124:127], v[28:31], v[156:159], v[124:127]
    v_mfma_f32_16x16x32_bf16 v[128:131], v[64:67], v[152:155], 0
    v_mfma_f32_16x16x32_bf16 v[128:131], v[32:35], v[156:159], v[128:131]
    v_mfma_f32_16x16x32_bf16 v[132:135], v[68:71], v[152:155], 0
    v_mfma_f32_16x16x32_bf16 v[132:135], v[36:39], v[156:159], v[132:135]
    s_nop 1
    v_cndmask_b32 v88, v120, v121, s[56:57]
    s_nop 0
    v_cndmask_b32 v89, v124, v125, s[56:57]
    s_nop 0
    v_cndmask_b32 v90, v128, v129, s[56:57]
    s_nop 0
    v_cndmask_b32 v91, v132, v133, s[56:57]
    v_perm_b32 v88, v88, v17, s60
    v_perm_b32 v89, v89, v17, s61
    v_perm_b32 v90, v90, v17, s62
    v_perm_b32 v91, v91, v17, s63
    s_mov_b32 s12, 0
    buffer_store_dwordx4 v[88:91], v11, s[52:55], s12 offen sc1
    v_cndmask_b32 v92, v122, v123, s[56:57]
    v_cndmask_b32 v93, v126, v127, s[56:57]
    v_cndmask_b32 v94, v130, v131, s[56:57]
    v_cndmask_b32 v95, v134, v135, s[56:57]
    v_perm_b32 v92, v92, v17, s60
    v_perm_b32 v93, v93, v17, s61
    v_perm_b32 v94, v94, v17, s62
    v_perm_b32 v95, v95, v17, s63
    s_mov_b32 s12, 18432
    buffer_store_dwordx4 v[92:95], v11, s[52:55], s12 offen sc1
    s_endpgm
K_END:
    s_endpgm
CODE_END:
.section .rodata,"a"
.p2align 6
.amdhsa_kernel k1_kernel
  .amdhsa_next_free_vgpr 168
  .amdhsa_next_free_sgpr 102
  .amdhsa_accum_offset 168
  .amdhsa_group_segment_fixed_size 0
  .amdhsa_kernarg_size 144
  .amdhsa_user_sgpr_count 2
  .amdhsa_user_sgpr_kernarg_segment_ptr 1
  .amdhsa_system_sgpr_workgroup_id_x 1
.end_amdhsa_kernel
```

```asm
; @launch kernel=k1_kernel grid=(256,1,1) block=(768,1,1) lds=163840
.amdgcn_target "amdgcn-amd-amdhsa--gfx950"
.text
.p2align 8
.globl k1_kernel
.type k1_kernel,@function
k1_kernel:
    v_lshrrev_b32 v1, 6, v0
    s_cmp_ge_u32 s2, 256
    v_readfirstlane_b32 s3, v1
    s_cbranch_scc1 K_END
    v_and_b32 v2, 63, v0
    v_mov_b32 v1, 0
    s_cmp_lg_u32 s3, 1
    s_cbranch_scc1 K_NOZ
    v_lshlrev_b32 v3, 2, v2
    ds_write_b32 v3, v1
    s_waitcnt lgkmcnt(0)
K_NOZ:
    s_load_dwordx16 s[16:31], s[0:1], 0
    s_load_dwordx16 s[32:47], s[0:1], 64
    s_load_dwordx4 s[48:51], s[0:1], 128
    s_lshr_b32 s5, s2, 3
    s_lshl_b32 s8, s3, 8
    s_add_u32 s8, s8, s5
    s_cmp_lg_u32 s8, 9
    s_cbranch_scc1 K_NOCPF
    s_getpc_b64 s[8:9]
    s_and_b32 s8, s8, 0xffffff00
    v_lshlrev_b32 v8, 7, v2
    v_min_u32 v9, CODE_END-k1_kernel-4, v8
    global_load_dword v160, v9, s[8:9]
    v_add_u32 v8, 8192, v8
    v_min_u32 v9, CODE_END-k1_kernel-4, v8
    global_load_dword v161, v9, s[8:9]
    v_add_u32 v8, 8192, v8
    v_min_u32 v9, CODE_END-k1_kernel-4, v8
    global_load_dword v162, v9, s[8:9]
    v_add_u32 v8, 8192, v8
    v_min_u32 v9, CODE_END-k1_kernel-4, v8
    global_load_dword v163, v9, s[8:9]
    v_add_u32 v8, 8192, v8
K_NOCPF:
    v_and_b32 v3, 15, v2
    v_lshrrev_b32 v4, 4, v2
    s_and_b32 s4, s2, 7
    s_barrier
    s_cmp_eq_u32 s3, 8
    s_cbranch_scc1 ROUTER
    s_cmp_lt_u32 s5, 14
    s_cbranch_scc1 K_OTHER
    s_mul_i32 s7, s4, 18
    s_add_u32 s7, s7, s5
    s_sub_u32 s7, s7, 14
    s_cmp_ge_u32 s3, 8
    s_cbranch_scc1 K_CIO
C_KGEN:
    s_and_b32 s12, s3, 3
    s_lshr_b32 s13, s3, 2
    s_lshl_b32 s14, s7, 2
    s_add_u32 s14, s14, s12
    s_lshl_b32 s8, s14, 8
    s_lshl_b32 s9, s13, 7
    s_add_u32 s8, s8, s9
    v_lshl_add_u32 v5, v2, 1, s8
    v_mov_b32 v16, 0
    v_mov_b32 v17, 0
    v_mov_b32 v18, 0
    v_mov_b32 v19, 0
    v_mov_b32 v20, 0
    v_mov_b32 v21, 0
    s_lshl_b32 s55, s7, 3
    s_setprio 2
    s_mul_i32 s15, s3, 4608
    s_add_u32 s15, s15, 256
    s_mul_i32 s52, s12, 4864
    s_add_u32 s52, s52, 37120
    s_mul_i32 s53, s12, 4672
    s_add_u32 s53, s53, 56576
    v_mul_u32_u24 v7, 288, v3
    v_lshl_add_u32 v7, v4, 4, v7
    v_add_u32 v7, s15, v7
    s_mov_b32 m0, s15
    s_waitcnt lgkmcnt(0)
    s_load_dwordx2 s[58:59], s[30:31], s55
    global_load_short_d16_hi v16, v5, s[18:19]
    global_load_short_d16_hi v17, v5, s[20:21]
    global_load_short_d16_hi v18, v5, s[22:23]
    global_load_short_d16_hi v19, v5, s[24:25]
    global_load_short_d16_hi v20, v5, s[26:27]
    global_load_short_d16_hi v21, v5, s[28:29]
    s_load_dwordx2 s[68:69], s[32:33], s55
    s_branch C_KBODY
ROUTER:
    s_setprio 3
    v_lshrrev_b32 v5, 3, v2
    v_and_b32 v6, 7, v2
    v_lshlrev_b32 v9, 4, v6
    v_mul_u32_u24 v8, 1152, v5
    s_mul_i32 s8, s2, 9216
    v_add3_u32 v8, v8, v9, s8
    v_lshlrev_b32 v7, 4, v2
    v_min_u32 v10, 7, v2
    v_lshlrev_b32 v10, 4, v10
    s_mov_b32 m0, 147712
    s_waitcnt lgkmcnt(0)
    s_load_dword s10, s[50:51], 8448
    global_load_dwordx4 v[16:19], v8, s[16:17] offset:0
    global_load_dwordx4 v[52:55], v9, s[36:37] offset:0
    global_load_dwordx4 v[20:23], v8, s[16:17] offset:128
    global_load_dwordx4 v[56:59], v9, s[36:37] offset:128
    global_load_dwordx4 v[24:27], v8, s[16:17] offset:256
    global_load_dwordx4 v[60:63], v9, s[36:37] offset:256
    global_load_dwordx4 v[28:31], v8, s[16:17] offset:384
    global_load_dwordx4 v[64:67], v9, s[36:37] offset:384
    global_load_dwordx4 v[32:35], v8, s[16:17] offset:512
    global_load_dwordx4 v[68:71], v9, s[36:37] offset:512
    global_load_dwordx4 v[36:39], v8, s[16:17] offset:640
    global_load_dwordx4 v[72:75], v9, s[36:37] offset:640
    global_load_dwordx4 v[40:43], v8, s[16:17] offset:768
    global_load_dwordx4 v[76:79], v9, s[36:37] offset:768
    global_load_dwordx4 v[44:47], v8, s[16:17] offset:896
    global_load_dwordx4 v[80:83], v9, s[36:37] offset:896
    global_load_dwordx4 v[48:51], v8, s[16:17] offset:1024
    global_load_dwordx4 v[84:87], v9, s[36:37] offset:1024
    s_mov_b32 m0, 158080
    s_nop 0
    global_load_lds_dwordx4 v7, s[44:45]
    global_load_lds_dwordx4 v10, s[44:45] offset:1024
    v_mov_b32 v11, 1
    ds_write_b32 v1, v11 offset:4
    v_add_u32 v7, 147712, v7
    s_lshl_b32 s8, s2, 5
    v_lshl_add_u32 v15, v4, 3, s8
    s_mov_b32 s11, 0xffff
    v_mov_b32 v8, 0
    v_mov_b32 v9, 0
    v_mov_b32 v10, 0
    v_mov_b32 v11, 0
    s_waitcnt lgkmcnt(0)
    s_add_u32 s10, s10, 1
    s_addc_u32 s10, s10, 0
    v_mov_b32 v14, s10
    v_mov_b32 v13, s10
    s_waitcnt vmcnt(18)
    v_dot2c_f32_bf16 v8, v16, v52
    v_dot2c_f32_bf16 v9, v17, v53
    v_dot2c_f32_bf16 v10, v18, v54
    v_dot2c_f32_bf16 v11, v19, v55
    s_waitcnt vmcnt(16)
    v_dot2c_f32_bf16 v8, v20, v56
    v_dot2c_f32_bf16 v9, v21, v57
    v_dot2c_f32_bf16 v10, v22, v58
    v_dot2c_f32_bf16 v11, v23, v59
    s_waitcnt vmcnt(14)
    v_dot2c_f32_bf16 v8, v24, v60
    v_dot2c_f32_bf16 v9, v25, v61
    v_dot2c_f32_bf16 v10, v26, v62
    v_dot2c_f32_bf16 v11, v27, v63
    s_waitcnt vmcnt(12)
    v_dot2c_f32_bf16 v8, v28, v64
    v_dot2c_f32_bf16 v9, v29, v65
    v_dot2c_f32_bf16 v10, v30, v66
    v_dot2c_f32_bf16 v11, v31, v67
    s_waitcnt vmcnt(10)
    v_dot2c_f32_bf16 v8, v32, v68
    v_dot2c_f32_bf16 v9, v33, v69
    v_dot2c_f32_bf16 v10, v34, v70
    v_dot2c_f32_bf16 v11, v35, v71
    s_waitcnt vmcnt(8)
    v_dot2c_f32_bf16 v8, v36, v72
    v_dot2c_f32_bf16 v9, v37, v73
    v_dot2c_f32_bf16 v10, v38, v74
    v_dot2c_f32_bf16 v11, v39, v75
    s_waitcnt vmcnt(6)
    v_dot2c_f32_bf16 v8, v40, v76
    v_dot2c_f32_bf16 v9, v41, v77
    v_dot2c_f32_bf16 v10, v42, v78
    v_dot2c_f32_bf16 v11, v43, v79
    s_waitcnt vmcnt(4)
    v_dot2c_f32_bf16 v8, v44, v80
    v_dot2c_f32_bf16 v9, v45, v81
    v_dot2c_f32_bf16 v10, v46, v82
    v_dot2c_f32_bf16 v11, v47, v83
    s_waitcnt vmcnt(2)
    v_dot2c_f32_bf16 v8, v48, v84
    v_dot2c_f32_bf16 v9, v49, v85
    v_dot2c_f32_bf16 v10, v50, v86
    v_dot2c_f32_bf16 v11, v51, v87
    s_nop 0
    v_add_f32 v8, v8, v9
    s_nop 0
    v_add_f32 v10, v10, v11
    v_add_f32 v8, v8, v10
    s_nop 1
    v_add_f32_dpp v8, v8, v8 quad_perm:[1,0,3,2] row_mask:0xf bank_mask:0xf
    s_nop 1
    v_add_f32_dpp v8, v8, v8 quad_perm:[2,3,0,1] row_mask:0xf bank_mask:0xf
    s_nop 1
    v_add_f32_dpp v8, v8, v8 row_half_mirror row_mask:0xf bank_mask:0xf
    v_cvt_pk_bf16_f32 v8, v8, v8
    v_ashrrev_i32 v9, 31, v8
    v_or_b32 v9, 0x80008000, v9
    v_xor_b32 v8, v8, v9
    s_nop 1
    v_mov_b32_dpp v9, v8 row_ror:8 row_mask:0xf bank_mask:0xf
    s_mov_b32 exec_lo, 0x10001
    s_mov_b32 exec_hi, 0x10001
    v_bfi_b32 v12, s11, v8, v9
    global_store_dwordx2 v15, v[12:13], s[50:51] sc1
    s_mov_b64 exec, -1
    ds_write_b32 v1, v14 offset:0
    ds_write_b128 v7, v[16:19] offset:0
    ds_write_b128 v7, v[20:23] offset:1024
    ds_write_b128 v7, v[24:27] offset:2048
    ds_write_b128 v7, v[28:31] offset:3072
    ds_write_b128 v7, v[32:35] offset:4096
    ds_write_b128 v7, v[36:39] offset:5120
    ds_write_b128 v7, v[40:43] offset:6144
    ds_write_b128 v7, v[44:47] offset:7168
    ds_write_b128 v7, v[48:51] offset:8192
    s_waitcnt vmcnt(1)
    ds_write_b32 v1, v14 offset:8
    s_cmp_ge_u32 s5, 14
    s_cbranch_scc1 C_IO
    s_cmp_lt_u32 s5, 9
    s_cbranch_scc1 SELECT
    s_endpgm
K_OTHER:
    s_mul_i32 s7, s4, 9
    s_add_u32 s7, s7, s5
    s_mov_b32 s12, s3
    s_cmp_lt_u32 s3, 2
    s_cbranch_scc1 GATE
    s_cmp_ge_u32 s5, 9
    s_cbranch_scc1 HELPER
    s_cmp_lt_u32 s3, 8
    s_cbranch_scc1 F_COMP
F_LOAD:
    s_setprio 3
    s_sub_u32 s12, s3, 9
    v_lshrrev_b32 v5, 3, v2
    v_bfe_u32 v6, v2, 4, 1
    v_xor_b32 v6, v6, v2
    v_and_b32 v6, 7, v6
    s_movk_i32 s8, 9216
    v_mul_lo_u32 v7, v5, s8
    v_lshl_add_u32 v8, v6, 4, v7
    v_xor_b32 v9, 32, v8
    v_xor_b32 v10, 64, v8
    v_xor_b32 v11, 96, v8
    v_bfe_u32 v6, v2, 4, 1
    v_lshlrev_b32 v6, 1, v6
    v_xor_b32 v6, v6, v2
    v_and_b32 v6, 7, v6
    v_mul_u32_u24 v7, 1152, v5
    v_lshl_add_u32 v12, v6, 4, v7
    v_xor_b32 v13, 64, v12
    s_mul_i32 s13, s12, 294912
    s_lshl_b32 s8, s7, 7
    s_add_u32 s13, s13, s8
    s_lshl_b32 s15, s12, 13
    s_add_u32 s15, s15, 256
    s_mul_i32 s14, s12, 24576
    s_add_u32 s14, s14, 73984
    s_mul_i32 s11, s7, 73728
    s_mul_i32 s8, s12, 384
    s_add_u32 s11, s11, s8
    s_waitcnt lgkmcnt(0)
    s_mov_b32 s52, s38
    s_mov_b32 s53, s39
    s_mov_b32 s54, 5308416
    s_mov_b32 s55, 0x20000
    s_mov_b32 s56, s40
    s_mov_b32 s57, s41
    s_mov_b32 s58, 5308416
    s_mov_b32 s59, 0x20000
    s_mov_b32 s60, s42
    s_mov_b32 s61, s43
    s_mov_b32 s62, 5308416
    s_mov_b32 s63, 0x20000
    s_mov_b32 s9, 0
SP_1:
    ds_read_b32 v14, v1 offset:4
    s_waitcnt lgkmcnt(0)
    v_readfirstlane_b32 s8, v14
    s_add_u32 s9, s9, 1
    s_cmp_ge_u32 s8, 1
    s_cbranch_scc1 SP_1_D
    s_cmp_lt_u32 s9, 524288
    s_cbranch_scc1 SP_1
SP_1_D:
    s_add_u32 m0, s15, 0
    s_nop 0
    buffer_load_dwordx4 v8, s[52:55], s13 offen  lds
    s_add_u32 m0, s15, 1024
    s_nop 0
    buffer_load_dwordx4 v10, s[56:59], s13 offen  lds
    s_add_u32 s13, s13, 73728
    s_add_u32 m0, s15, 2048
    s_nop 0
    buffer_load_dwordx4 v9, s[52:55], s13 offen  lds
    s_add_u32 m0, s15, 3072
    s_nop 0
    buffer_load_dwordx4 v11, s[56:59], s13 offen  lds
    s_add_u32 s13, s13, 73728
    s_add_u32 m0, s15, 4096
    s_nop 0
    buffer_load_dwordx4 v8, s[52:55], s13 offen  lds
    s_add_u32 m0, s15, 5120
    s_nop 0
    buffer_load_dwordx4 v10, s[56:59], s13 offen  lds
    s_add_u32 s13, s13, 73728
    s_add_u32 m0, s15, 6144
    s_nop 0
    buffer_load_dwordx4 v9, s[52:55], s13 offen  lds
    s_add_u32 m0, s15, 7168
    s_nop 0
    buffer_load_dwordx4 v11, s[56:59], s13 offen  lds
    s_add_u32 s13, s13, 663552
    s_add_u32 m0, s15, 24576
    s_nop 0
    buffer_load_dwordx4 v8, s[52:55], s13 offen  lds
    s_add_u32 m0, s15, 25600
    s_nop 0
    buffer_load_dwordx4 v10, s[56:59], s13 offen  lds
    s_add_u32 s13, s13, 73728
    s_waitcnt vmcnt(9)
    s_add_u32 m0, s15, 26624
    s_nop 0
    buffer_load_dwordx4 v9, s[52:55], s13 offen  lds
    s_waitcnt vmcnt(9)
    s_add_u32 m0, s15, 27648
    s_nop 0
    buffer_load_dwordx4 v11, s[56:59], s13 offen  lds
    s_add_u32 s13, s13, 73728
    s_waitcnt vmcnt(9)
    s_add_u32 m0, s15, 28672
    s_nop 0
    buffer_load_dwordx4 v8, s[52:55], s13 offen  lds
    s_waitcnt vmcnt(9)
    s_add_u32 m0, s15, 29696
    s_nop 0
    buffer_load_dwordx4 v10, s[56:59], s13 offen  lds
    s_add_u32 s13, s13, 73728
    s_waitcnt vmcnt(9)
    s_add_u32 m0, s15, 30720
    s_nop 0
    buffer_load_dwordx4 v9, s[52:55], s13 offen  lds
    s_waitcnt vmcnt(9)
    s_add_u32 m0, s15, 31744
    s_nop 0
    buffer_load_dwordx4 v11, s[56:59], s13 offen  lds
    s_add_u32 s13, s13, 663552
    s_waitcnt vmcnt(9)
    s_add_u32 m0, s15, 49152
    s_nop 0
    buffer_load_dwordx4 v8, s[52:55], s13 offen  lds
    s_waitcnt vmcnt(9)
    v_mov_b32 v14, 1
    s_mov_b64 exec, 1
    ds_add_u32 v1, v14 offset:16
    s_mov_b64 exec, -1
    s_add_u32 m0, s15, 50176
    s_nop 0
    buffer_load_dwordx4 v10, s[56:59], s13 offen  lds
    s_add_u32 s13, s13, 73728
    s_waitcnt vmcnt(9)
    s_add_u32 m0, s15, 51200
    s_nop 0
    buffer_load_dwordx4 v9, s[52:55], s13 offen  lds
    s_waitcnt vmcnt(9)
    s_add_u32 m0, s15, 52224
    s_nop 0
    buffer_load_dwordx4 v11, s[56:59], s13 offen  lds
    s_add_u32 s13, s13, 73728
    s_waitcnt vmcnt(9)
    s_add_u32 m0, s15, 53248
    s_nop 0
    buffer_load_dwordx4 v8, s[52:55], s13 offen  lds
    s_waitcnt vmcnt(9)
    s_add_u32 m0, s15, 54272
    s_nop 0
    buffer_load_dwordx4 v10, s[56:59], s13 offen  lds
    s_add_u32 s13, s13, 73728
    s_waitcnt vmcnt(9)
    s_add_u32 m0, s15, 55296
    s_nop 0
    buffer_load_dwordx4 v9, s[52:55], s13 offen  lds
    s_waitcnt vmcnt(9)
    s_add_u32 m0, s15, 56320
    s_nop 0
    buffer_load_dwordx4 v11, s[56:59], s13 offen  lds
    s_add_u32 s13, s13, 663552
    s_mov_b32 s9, 0
SP_2:
    ds_read_b32 v14, v1 offset:48
    s_waitcnt lgkmcnt(0)
    v_readfirstlane_b32 s8, v14
    s_add_u32 s9, s9, 1
    s_cmp_ge_u32 s8, 4
    s_cbranch_scc1 SP_2_D
    s_cmp_lt_u32 s9, 524288
    s_cbranch_scc1 SP_2
SP_2_D:
    s_waitcnt vmcnt(9)
    s_add_u32 m0, s15, 0
    s_nop 0
    buffer_load_dwordx4 v8, s[52:55], s13 offen  lds
    s_waitcnt vmcnt(9)
    v_mov_b32 v14, 1
    s_mov_b64 exec, 1
    ds_add_u32 v1, v14 offset:20
    s_mov_b64 exec, -1
    s_add_u32 m0, s15, 1024
    s_nop 0
    buffer_load_dwordx4 v10, s[56:59], s13 offen  lds
    s_add_u32 s13, s13, 73728
    s_waitcnt vmcnt(9)
    s_add_u32 m0, s15, 2048
    s_nop 0
    buffer_load_dwordx4 v9, s[52:55], s13 offen  lds
    s_waitcnt vmcnt(9)
    s_add_u32 m0, s15, 3072
    s_nop 0
    buffer_load_dwordx4 v11, s[56:59], s13 offen  lds
    s_add_u32 s13, s13, 73728
    s_waitcnt vmcnt(9)
    s_add_u32 m0, s15, 4096
    s_nop 0
    buffer_load_dwordx4 v8, s[52:55], s13 offen  lds
    s_waitcnt vmcnt(9)
    s_add_u32 m0, s15, 5120
    s_nop 0
    buffer_load_dwordx4 v10, s[56:59], s13 offen  lds
    s_add_u32 s13, s13, 73728
    s_waitcnt vmcnt(9)
    s_add_u32 m0, s15, 6144
    s_nop 0
    buffer_load_dwordx4 v9, s[52:55], s13 offen  lds
    s_waitcnt vmcnt(9)
    s_add_u32 m0, s15, 7168
    s_nop 0
    buffer_load_dwordx4 v11, s[56:59], s13 offen  lds
    s_add_u32 s13, s13, 663552
    s_mov_b32 s9, 0
SP_3:
    ds_read_b32 v14, v1 offset:52
    s_waitcnt lgkmcnt(0)
    v_readfirstlane_b32 s8, v14
    s_add_u32 s9, s9, 1
    s_cmp_ge_u32 s8, 4
    s_cbranch_scc1 SP_3_D
    s_cmp_lt_u32 s9, 524288
    s_cbranch_scc1 SP_3
SP_3_D:
    s_waitcnt vmcnt(9)
    s_add_u32 m0, s15, 24576
    s_nop 0
    buffer_load_dwordx4 v8, s[52:55], s13 offen  lds
    s_waitcnt vmcnt(9)
    v_mov_b32 v14, 1
    s_mov_b64 exec, 1
    ds_add_u32 v1, v14 offset:24
    s_mov_b64 exec, -1
    s_add_u32 m0, s15, 25600
    s_nop 0
    buffer_load_dwordx4 v10, s[56:59], s13 offen  lds
    s_add_u32 s13, s13, 73728
    s_waitcnt vmcnt(9)
    s_add_u32 m0, s15, 26624
    s_nop 0
    buffer_load_dwordx4 v9, s[52:55], s13 offen  lds
    s_waitcnt vmcnt(9)
    s_add_u32 m0, s15, 27648
    s_nop 0
    buffer_load_dwordx4 v11, s[56:59], s13 offen  lds
    s_add_u32 s13, s13, 73728
    s_waitcnt vmcnt(9)
    s_add_u32 m0, s15, 28672
    s_nop 0
    buffer_load_dwordx4 v8, s[52:55], s13 offen  lds
    s_waitcnt vmcnt(9)
    s_add_u32 m0, s15, 29696
    s_nop 0
    buffer_load_dwordx4 v10, s[56:59], s13 offen  lds
    s_add_u32 s13, s13, 73728
    s_waitcnt vmcnt(9)
    s_add_u32 m0, s15, 30720
    s_nop 0
    buffer_load_dwordx4 v9, s[52:55], s13 offen  lds
    s_waitcnt vmcnt(9)
    s_add_u32 m0, s15, 31744
    s_nop 0
    buffer_load_dwordx4 v11, s[56:59], s13 offen  lds
    s_add_u32 s13, s13, 663552
    s_mov_b32 s9, 0
SP_4:
    ds_read_b32 v14, v1 offset:56
    s_waitcnt lgkmcnt(0)
    v_readfirstlane_b32 s8, v14
    s_add_u32 s9, s9, 1
    s_cmp_ge_u32 s8, 4
    s_cbranch_scc1 SP_4_D
    s_cmp_lt_u32 s9, 524288
    s_cbranch_scc1 SP_4
SP_4_D:
    s_waitcnt vmcnt(9)
    s_add_u32 m0, s15, 49152
    s_nop 0
    buffer_load_dwordx4 v8, s[52:55], s13 offen  lds
    s_waitcnt vmcnt(9)
    v_mov_b32 v14, 1
    s_mov_b64 exec, 1
    ds_add_u32 v1, v14 offset:28
    s_mov_b64 exec, -1
    s_add_u32 m0, s15, 50176
    s_nop 0
    buffer_load_dwordx4 v10, s[56:59], s13 offen  lds
    s_add_u32 s13, s13, 73728
    s_waitcnt vmcnt(9)
    s_add_u32 m0, s15, 51200
    s_nop 0
    buffer_load_dwordx4 v9, s[52:55], s13 offen  lds
    s_waitcnt vmcnt(9)
    s_add_u32 m0, s15, 52224
    s_nop 0
    buffer_load_dwordx4 v11, s[56:59], s13 offen  lds
    s_add_u32 s13, s13, 73728
    s_waitcnt vmcnt(9)
    s_add_u32 m0, s15, 53248
    s_nop 0
    buffer_load_dwordx4 v8, s[52:55], s13 offen  lds
    s_waitcnt vmcnt(9)
    s_add_u32 m0, s15, 54272
    s_nop 0
    buffer_load_dwordx4 v10, s[56:59], s13 offen  lds
    s_add_u32 s13, s13, 73728
    s_waitcnt vmcnt(9)
    s_add_u32 m0, s15, 55296
    s_nop 0
    buffer_load_dwordx4 v9, s[52:55], s13 offen  lds
    s_waitcnt vmcnt(9)
    s_add_u32 m0, s15, 56320
    s_nop 0
    buffer_load_dwordx4 v11, s[56:59], s13 offen  lds
    s_add_u32 s13, s13, 663552
    v_mov_b32 v14, 1
    s_mov_b64 exec, 1
    ds_add_u32 v1, v14 offset:40
    s_mov_b64 exec, -1
    s_waitcnt vmcnt(8)
    v_mov_b32 v14, 1
    s_mov_b64 exec, 1
    ds_add_u32 v1, v14 offset:32
    s_mov_b64 exec, -1
    s_waitcnt vmcnt(0)
    v_mov_b32 v14, 1
    s_mov_b64 exec, 1
    ds_add_u32 v1, v14 offset:36
    s_mov_b64 exec, -1
    s_cmp_eq_u32 s3, 9
    s_cbranch_scc1 F_COMP2
    s_endpgm
K_CIO:
    s_sub_u32 s12, s3, 9
    s_cmp_eq_u32 s3, 11
    s_cbranch_scc1 C_LOAD
    v_lshl_add_u32 v14, v4, 3, v3
    v_sub_u32 v14, 39, v14
    s_lshl_b32 s8, s12, 11
    s_add_u32 s8, s8, 100096
    v_lshl_add_u32 v15, v2, 4, s8
    s_cmp_eq_u32 s12, 0
    s_cselect_b32 s8, 127, 7
    s_cselect_b32 s9, 19, 21
    s_movk_i32 s11, 0x3f80
    s_lshl_b32 s13, s11, 16
    v_mov_b32 v10, s8
    v_mov_b32 v11, 0
    v_lshlrev_b64 v[10:11], v14, v[10:11]
    v_alignbit_b32 v10, v11, v10, s9
    v_bfe_i32 v11, v10, 0, 1
    v_bfe_i32 v12, v10, 1, 1
    v_and_b32 v11, s11, v11
    v_and_or_b32 v16, v12, s13, v11
    v_bfe_i32 v11, v10, 2, 1
    v_bfe_i32 v12, v10, 3, 1
    v_and_b32 v11, s11, v11
    v_and_or_b32 v17, v12, s13, v11
    v_bfe_i32 v11, v10, 4, 1
    v_bfe_i32 v12, v10, 5, 1
    v_and_b32 v11, s11, v11
    v_and_or_b32 v18, v12, s13, v11
    v_bfe_i32 v11, v10, 6, 1
    v_bfe_i32 v12, v10, 7, 1
    v_and_b32 v11, s11, v11
    v_and_or_b32 v19, v12, s13, v11
    ds_write_b128 v15, v[16:19] offset:0
    s_cmp_eq_u32 s12, 0
    s_cselect_b32 s8, 511, 31
    s_cselect_b32 s9, 20, 18
    s_movk_i32 s11, 0x3f80
    s_lshl_b32 s13, s11, 16
    v_mov_b32 v10, s8
    v_mov_b32 v11, 0
    v_lshlrev_b64 v[10:11], v14, v[10:11]
    v_alignbit_b32 v10, v11, v10, s9
    v_bfe_i32 v11, v10, 0, 1
    v_bfe_i32 v12, v10, 1, 1
    v_and_b32 v11, s11, v11
    v_and_or_b32 v20, v12, s13, v11
    v_bfe_i32 v11, v10, 2, 1
    v_bfe_i32 v12, v10, 3, 1
    v_and_b32 v11, s11, v11
    v_and_or_b32 v21, v12, s13, v11
    v_bfe_i32 v11, v10, 4, 1
    v_bfe_i32 v12, v10, 5, 1
    v_and_b32 v11, s11, v11
    v_and_or_b32 v22, v12, s13, v11
    v_bfe_i32 v11, v10, 6, 1
    v_bfe_i32 v12, v10, 7, 1
    v_and_b32 v11, s11, v11
    v_and_or_b32 v23, v12, s13, v11
    ds_write_b128 v15, v[20:23] offset:1024
    s_cmp_eq_u32 s12, 0
    s_cselect_b32 s8, 7, 3
    s_cselect_b32 s9, 21, 21
    s_movk_i32 s11, 0x3f80
    s_cselect_b32 s11, s11, 0xffff
    s_lshl_b32 s13, s11, 16
    v_mov_b32 v10, s8
    v_mov_b32 v11, 0
    v_lshlrev_b64 v[10:11], v14, v[10:11]
    v_alignbit_b32 v10, v11, v10, s9
    v_bfe_i32 v11, v10, 0, 1
    v_bfe_i32 v12, v10, 1, 1
    v_and_b32 v11, s11, v11
    v_and_or_b32 v24, v12, s13, v11
    v_bfe_i32 v11, v10, 2, 1
    v_bfe_i32 v12, v10, 3, 1
    v_and_b32 v11, s11, v11
    v_and_or_b32 v25, v12, s13, v11
    v_bfe_i32 v11, v10, 4, 1
    v_bfe_i32 v12, v10, 5, 1
    v_and_b32 v11, s11, v11
    v_and_or_b32 v26, v12, s13, v11
    v_bfe_i32 v11, v10, 6, 1
    v_bfe_i32 v12, v10, 7, 1
    v_and_b32 v11, s11, v11
    v_and_or_b32 v27, v12, s13, v11
    ds_write_b128 v15, v[24:27] offset:2048
    s_branch GATE
C_LOAD:
    s_setprio 3
    s_sub_u32 s13, s5, 14
    s_mov_b32 s8, s13
    s_mul_i32 s8, s8, 73728
    s_lshl_b32 s9, s4, 7
    s_add_u32 s8, s8, s9
    v_mul_u32_u24 v9, 1152, v2
    v_add_u32 v9, s8, v9
    s_add_u32 s8, s13, 18
    s_min_u32 s8, s8, 31
    s_sub_u32 s8, s8, s13
    s_mul_i32 s8, s8, 73728
    v_add_u32 v8, s8, v9
    v_mul_u32_u24 v6, 4608, v2
    s_lshl_b32 s8, s7, 3
    v_add_u32 v6, s8, v6
    v_lshlrev_b32 v7, 3, v2
    v_sub_u32 v7, 57080, v7
    s_mov_b32 s56, 0x05040100
    s_mov_b32 s58, 0x07060302
    s_mov_b32 s57, s13
    s_waitcnt lgkmcnt(0)
    s_mov_b32 s72, s16
    s_mov_b32 s73, s17
    s_mov_b32 s74, 2359296
    s_mov_b32 s75, 0x20000
    s_mov_b32 s9, 0
SP_5:
    ds_read_b32 v12, v1 offset:4
    s_waitcnt lgkmcnt(0)
    v_readfirstlane_b32 s8, v12
    s_add_u32 s9, s9, 1
    s_cmp_ge_u32 s8, 1
    s_cbranch_scc1 SP_5_D
    s_cmp_lt_u32 s9, 524288
    s_cbranch_scc1 SP_5
SP_5_D:
    global_load_dword v10, v9, s[16:17]
    global_load_dword v11, v9, s[16:17] offset:128
    global_load_dword v10, v8, s[16:17]
    global_load_dword v11, v8, s[16:17] offset:128
    s_mul_i32 s7, s4, 18
    s_add_u32 s7, s7, s5
    s_sub_u32 s7, s7, 14
    s_lshl_b32 s55, s7, 3
    s_sub_u32 s12, s3, 8
    s_mov_b32 s60, s46
    s_mov_b32 s61, s47
    s_mov_b32 s62, 2359296
    s_mov_b32 s63, 0x20000
    v_bfe_u32 v79, v2, 2, 2
    v_and_b32 v80, 3, v2
    v_lshl_add_u32 v80, v4, 2, v80
    s_lshl_b32 s8, s12, 7
    v_mul_u32_u24 v72, 4672, v79
    v_lshl_add_u32 v72, v80, 3, v72
    s_sub_u32 s9, 56960, s8
    v_add_u32 v72, s9, v72
    v_mul_u32_u24 v73, 4160, v79
    v_lshl_add_u32 v73, v80, 3, v73
    s_sub_u32 s9, 83840, s8
    v_add_u32 v73, s9, v73
    v_xor_b32 v79, 63, v2
    s_lshl_b32 s8, s12, 9
    s_add_u32 s8, s8, 16384
    v_lshl_add_u32 v74, v79, 3, s8
    v_add_u32 v75, 4096, v74
    v_add_u32 v76, 8192, v74
    v_add_u32 v77, 12288, v74
    v_mul_u32_u24 v78, 1152, v79
    v_add_u32 v78, s55, v78
    s_mul_i32 s68, s12, 73728
    s_mov_b32 s70, 0x05040100
    s_mov_b32 s71, 0x07060302
    s_sub_u32 s9, s5, 14
    s_lshl_b32 s9, s9, 2
    s_add_u32 s9, s9, s12
    s_mul_i32 s9, s9, 9216
    s_mul_i32 s8, s4, 663552
    s_add_u32 s8, s8, s9
    s_add_u32 s8, s8, 3072
    v_min_u32 v88, 47, v2
    v_lshl_add_u32 v88, v88, 7, s8
    v_mov_b32 v24, 0
    v_mov_b32 v25, 0
    v_mov_b32 v26, 0
    v_mov_b32 v27, 0
    v_lshrrev_b32 v28, 2, v2
    v_mul_u32_u24 v28, 1216, v28
    v_add_u32 v28, 37120, v28
    v_and_b32 v29, 3, v2
    v_lshl_add_u32 v30, v29, 4, v28
    ds_write_b128 v30, v[24:27] offset:1072
    v_and_b32 v29, 1, v2
    v_lshl_add_u32 v30, v29, 4, v28
    ds_write_b128 v30, v[24:27]
    v_lshrrev_b32 v28, 5, v2
    v_mul_u32_u24 v28, 4672, v28
    v_and_b32 v29, 31, v2
    v_lshl_add_u32 v30, v29, 4, v28
    v_add_u32 v30, 60672, v30
    ds_write_b128 v30, v[24:27]
    ds_write_b128 v30, v[24:27] offset:9344
    s_mov_b32 s15, 0
    s_add_u32 s8, s57, 0
    s_and_b32 s8, s8, 3
    s_mul_i32 s76, s8, 294912
    s_add_u32 s64, s76, 1179648
    s_lshl_b32 s8, s8, 9
    v_subrev_u32 v32, s8, v7
    s_add_u32 s8, s57, 1
    s_and_b32 s8, s8, 3
    s_mul_i32 s77, s8, 294912
    s_add_u32 s65, s77, 1179648
    s_lshl_b32 s8, s8, 9
    v_subrev_u32 v33, s8, v7
    s_add_u32 s8, s57, 2
    s_and_b32 s8, s8, 3
    s_mul_i32 s78, s8, 294912
    s_add_u32 s66, s78, 1179648
    s_lshl_b32 s8, s8, 9
    v_subrev_u32 v34, s8, v7
    s_add_u32 s8, s57, 3
    s_and_b32 s8, s8, 3
    s_mul_i32 s79, s8, 294912
    s_add_u32 s67, s79, 1179648
    s_lshl_b32 s8, s8, 9
    v_subrev_u32 v35, s8, v7
    v_mov_b32 v12, 1
    s_waitcnt vmcnt(2)
    buffer_load_dwordx2 v[104:105], v6, s[72:75], s76 offen offset:0
    buffer_load_dwordx2 v[106:107], v6, s[72:75], s76 offen offset:1152
    buffer_load_dwordx2 v[108:109], v6, s[72:75], s76 offen offset:2304
    buffer_load_dwordx2 v[110:111], v6, s[72:75], s76 offen offset:3456
    s_add_u32 s15, s15, 294912
    buffer_load_dwordx2 v[112:113], v6, s[72:75], s77 offen offset:0
    s_waitcnt vmcnt(4)
    buffer_load_dwordx2 v[114:115], v6, s[72:75], s77 offen offset:1152
    s_waitcnt vmcnt(4)
    buffer_load_dwordx2 v[116:117], v6, s[72:75], s77 offen offset:2304
    s_waitcnt vmcnt(4)
    buffer_load_dwordx2 v[118:119], v6, s[72:75], s77 offen offset:3456
    s_add_u32 s15, s15, 294912
    s_waitcnt vmcnt(4)
    buffer_load_dwordx2 v[120:121], v6, s[72:75], s78 offen offset:0
    v_perm_b32 v16, v108, v110, s56
    v_perm_b32 v17, v104, v106, s56
    ds_write_b64 v32, v[16:17] offset:3584
    v_perm_b32 v18, v108, v110, s58
    v_perm_b32 v19, v104, v106, s58
    ds_write_b64 v32, v[18:19] offset:8256
    v_perm_b32 v20, v109, v111, s56
    v_perm_b32 v21, v105, v107, s56
    ds_write_b64 v32, v[20:21] offset:12928
    v_perm_b32 v22, v109, v111, s58
    v_perm_b32 v23, v105, v107, s58
    ds_write_b64 v32, v[22:23] offset:17600
    s_waitcnt vmcnt(4)
    buffer_load_dwordx2 v[122:123], v6, s[72:75], s78 offen offset:1152
    s_waitcnt vmcnt(4)
    buffer_load_dwordx2 v[124:125], v6, s[72:75], s78 offen offset:2304
    s_waitcnt vmcnt(4)
    buffer_load_dwordx2 v[126:127], v6, s[72:75], s78 offen offset:3456
    s_add_u32 s15, s15, 294912
    s_waitcnt vmcnt(4)
    buffer_load_dwordx2 v[128:129], v6, s[72:75], s79 offen offset:0
    v_perm_b32 v24, v116, v118, s56
    v_perm_b32 v25, v112, v114, s56
    ds_write_b64 v33, v[24:25] offset:3584
    v_perm_b32 v26, v116, v118, s58
    v_perm_b32 v27, v112, v114, s58
    ds_write_b64 v33, v[26:27] offset:8256
    v_perm_b32 v28, v117, v119, s56
    v_perm_b32 v29, v113, v115, s56
    ds_write_b64 v33, v[28:29] offset:12928
    v_perm_b32 v30, v117, v119, s58
    v_perm_b32 v31, v113, v115, s58
    ds_write_b64 v33, v[30:31] offset:17600
    s_waitcnt vmcnt(4)
    buffer_load_dwordx2 v[130:131], v6, s[72:75], s79 offen offset:1152
    s_waitcnt vmcnt(4)
    buffer_load_dwordx2 v[132:133], v6, s[72:75], s79 offen offset:2304
    s_waitcnt vmcnt(4)
    buffer_load_dwordx2 v[134:135], v6, s[72:75], s79 offen offset:3456
    s_add_u32 s15, s15, 294912
    s_waitcnt vmcnt(4)
    buffer_load_dwordx2 v[136:137], v6, s[72:75], s64 offen offset:0
    v_perm_b32 v16, v124, v126, s56
    v_perm_b32 v17, v120, v122, s56
    ds_write_b64 v34, v[16:17] offset:3584
    v_perm_b32 v18, v124, v126, s58
    v_perm_b32 v19, v120, v122, s58
    ds_write_b64 v34, v[18:19] offset:8256
    v_perm_b32 v20, v125, v127, s56
    v_perm_b32 v21, v121, v123, s56
    ds_write_b64 v34, v[20:21] offset:12928
    v_perm_b32 v22, v125, v127, s58
    v_perm_b32 v23, v121, v123, s58
    ds_write_b64 v34, v[22:23] offset:17600
    s_waitcnt vmcnt(4)
    buffer_load_dwordx2 v[138:139], v6, s[72:75], s64 offen offset:1152
    s_waitcnt vmcnt(4)
    buffer_load_dwordx2 v[140:141], v6, s[72:75], s64 offen offset:2304
    s_waitcnt vmcnt(4)
    buffer_load_dwordx2 v[142:143], v6, s[72:75], s64 offen offset:3456
    s_add_u32 s15, s15, 294912
    s_waitcnt vmcnt(4)
    buffer_load_dwordx2 v[144:145], v6, s[72:75], s65 offen offset:0
    v_perm_b32 v24, v132, v134, s56
    v_perm_b32 v25, v128, v130, s56
    ds_write_b64 v35, v[24:25] offset:3584
    v_perm_b32 v26, v132, v134, s58
    v_perm_b32 v27, v128, v130, s58
    ds_write_b64 v35, v[26:27] offset:8256
    v_perm_b32 v28, v133, v135, s56
    v_perm_b32 v29, v129, v131, s56
    ds_write_b64 v35, v[28:29] offset:12928
    v_perm_b32 v30, v133, v135, s58
    v_perm_b32 v31, v129, v131, s58
    ds_write_b64 v35, v[30:31] offset:17600
    ds_write_b32 v1, v12 offset:80
    s_waitcnt vmcnt(4)
    buffer_load_dwordx2 v[146:147], v6, s[72:75], s65 offen offset:1152
    s_waitcnt vmcnt(4)
    buffer_load_dwordx2 v[148:149], v6, s[72:75], s65 offen offset:2304
    s_waitcnt vmcnt(4)
    buffer_load_dwordx2 v[150:151], v6, s[72:75], s65 offen offset:3456
    s_add_u32 s15, s15, 294912
    s_waitcnt vmcnt(4)
    buffer_load_dwordx2 v[152:153], v6, s[72:75], s66 offen offset:0
    v_perm_b32 v16, v140, v142, s56
    v_perm_b32 v17, v136, v138, s56
    ds_write_b64 v32, v[16:17] offset:1536
    v_perm_b32 v18, v140, v142, s58
    v_perm_b32 v19, v136, v138, s58
    ds_write_b64 v32, v[18:19] offset:6208
    v_perm_b32 v20, v141, v143, s56
    v_perm_b32 v21, v137, v139, s56
    ds_write_b64 v32, v[20:21] offset:10880
    v_perm_b32 v22, v141, v143, s58
    v_perm_b32 v23, v137, v139, s58
    ds_write_b64 v32, v[22:23] offset:15552
    s_waitcnt vmcnt(4)
    buffer_load_dwordx2 v[154:155], v6, s[72:75], s66 offen offset:1152
    s_waitcnt vmcnt(4)
    buffer_load_dwordx2 v[156:157], v6, s[72:75], s66 offen offset:2304
    s_waitcnt vmcnt(4)
    buffer_load_dwordx2 v[158:159], v6, s[72:75], s66 offen offset:3456
    s_add_u32 s15, s15, 294912
    s_waitcnt vmcnt(4)
    buffer_load_dwordx2 v[160:161], v6, s[72:75], s67 offen offset:0
    v_perm_b32 v24, v148, v150, s56
    v_perm_b32 v25, v144, v146, s56
    ds_write_b64 v33, v[24:25] offset:1536
    v_perm_b32 v26, v148, v150, s58
    v_perm_b32 v27, v144, v146, s58
    ds_write_b64 v33, v[26:27] offset:6208
    v_perm_b32 v28, v149, v151, s56
    v_perm_b32 v29, v145, v147, s56
    ds_write_b64 v33, v[28:29] offset:10880
    v_perm_b32 v30, v149, v151, s58
    v_perm_b32 v31, v145, v147, s58
    ds_write_b64 v33, v[30:31] offset:15552
    s_waitcnt vmcnt(4)
    buffer_load_dwordx2 v[162:163], v6, s[72:75], s67 offen offset:1152
    s_waitcnt vmcnt(4)
    buffer_load_dwordx2 v[164:165], v6, s[72:75], s67 offen offset:2304
    s_waitcnt vmcnt(4)
    buffer_load_dwordx2 v[166:167], v6, s[72:75], s67 offen offset:3456
    s_add_u32 s15, s15, 294912
    ds_write_b32 v1, v12 offset:88
    global_load_dwordx2 v[56:57], v74, s[50:51] offset:0 sc1
    global_load_dwordx2 v[58:59], v74, s[50:51] offset:2048 sc1
    global_load_dwordx2 v[60:61], v75, s[50:51] offset:0 sc1
    global_load_dwordx2 v[62:63], v75, s[50:51] offset:2048 sc1
    global_load_dwordx2 v[64:65], v76, s[50:51] offset:0 sc1
    global_load_dwordx2 v[66:67], v76, s[50:51] offset:2048 sc1
    global_load_dwordx2 v[68:69], v77, s[50:51] offset:0 sc1
    global_load_dwordx2 v[70:71], v77, s[50:51] offset:2048 sc1
    global_load_dword v96, v88, s[42:43]
    s_waitcnt vmcnt(13)
    v_perm_b32 v16, v156, v158, s56
    v_perm_b32 v17, v152, v154, s56
    ds_write_b64 v34, v[16:17] offset:1536
    v_perm_b32 v18, v156, v158, s58
    v_perm_b32 v19, v152, v154, s58
    ds_write_b64 v34, v[18:19] offset:6208
    v_perm_b32 v20, v157, v159, s56
    v_perm_b32 v21, v153, v155, s56
    ds_write_b64 v34, v[20:21] offset:10880
    v_perm_b32 v22, v157, v159, s58
    v_perm_b32 v23, v153, v155, s58
    ds_write_b64 v34, v[22:23] offset:15552
    s_waitcnt vmcnt(12)
    s_waitcnt vmcnt(11)
    s_waitcnt vmcnt(10)
    s_waitcnt vmcnt(9)
    v_perm_b32 v24, v164, v166, s56
    v_perm_b32 v25, v160, v162, s56
    ds_write_b64 v35, v[24:25] offset:1536
    v_perm_b32 v26, v164, v166, s58
    v_perm_b32 v27, v160, v162, s58
    ds_write_b64 v35, v[26:27] offset:6208
    v_perm_b32 v28, v165, v167, s56
    v_perm_b32 v29, v161, v163, s56
    ds_write_b64 v35, v[28:29] offset:10880
    v_perm_b32 v30, v165, v167, s58
    v_perm_b32 v31, v161, v163, s58
    ds_write_b64 v35, v[30:31] offset:15552
    ds_write_b32 v1, v12 offset:84
    s_mov_b32 s9, 0
SP_6:
    ds_read_b32 v10, v1 offset:8
    s_waitcnt lgkmcnt(0)
    v_readfirstlane_b32 s8, v10
    s_add_u32 s9, s9, 1
    s_cmp_lg_u32 s8, 0
    s_cbranch_scc1 SP_6_D
    s_cmp_lt_u32 s9, 524288
    s_cbranch_scc1 SP_6
SP_6_D:
    s_branch C_IO3
C_IO:
    s_mul_i32 s7, s4, 18
    s_add_u32 s7, s7, s5
    s_sub_u32 s7, s7, 14
    s_lshl_b32 s55, s7, 3
    s_sub_u32 s12, s3, 8
    s_mov_b32 s60, s46
    s_mov_b32 s61, s47
    s_mov_b32 s62, 2359296
    s_mov_b32 s63, 0x20000
    v_bfe_u32 v79, v2, 2, 2
    v_and_b32 v80, 3, v2
    v_lshl_add_u32 v80, v4, 2, v80
    s_lshl_b32 s8, s12, 7
    v_mul_u32_u24 v72, 4672, v79
    v_lshl_add_u32 v72, v80, 3, v72
    s_sub_u32 s9, 56960, s8
    v_add_u32 v72, s9, v72
    v_mul_u32_u24 v73, 4160, v79
    v_lshl_add_u32 v73, v80, 3, v73
    s_sub_u32 s9, 83840, s8
    v_add_u32 v73, s9, v73
    v_xor_b32 v79, 63, v2
    s_lshl_b32 s8, s12, 9
    s_add_u32 s8, s8, 16384
    v_lshl_add_u32 v74, v79, 3, s8
    v_add_u32 v75, 4096, v74
    v_add_u32 v76, 8192, v74
    v_add_u32 v77, 12288, v74
    v_mul_u32_u24 v78, 1152, v79
    v_add_u32 v78, s55, v78
    s_mul_i32 s68, s12, 73728
    s_mov_b32 s70, 0x05040100
    s_mov_b32 s71, 0x07060302
    s_sub_u32 s9, s5, 14
    s_lshl_b32 s9, s9, 2
    s_add_u32 s9, s9, s12
    s_mul_i32 s9, s9, 9216
    s_mul_i32 s8, s4, 663552
    s_add_u32 s8, s8, s9
    s_add_u32 s8, s8, 3072
    v_min_u32 v88, 47, v2
    v_lshl_add_u32 v88, v88, 7, s8
    s_mov_b32 s9, 0
SP_7:
    ds_read_b32 v10, v1 offset:8
    s_waitcnt lgkmcnt(0)
    v_readfirstlane_b32 s8, v10
    s_add_u32 s9, s9, 1
    s_cmp_lg_u32 s8, 0
    s_cbranch_scc1 SP_7_D
    s_cmp_lt_u32 s9, 524288
    s_cbranch_scc1 SP_7
SP_7_D:
    s_setprio 3
    s_mov_b32 s9, 0
SP_8:
    ds_read_b32 v12, v1 offset:88
    s_waitcnt lgkmcnt(0)
    v_readfirstlane_b32 s8, v12
    s_add_u32 s9, s9, 1
    s_cmp_ge_u32 s8, 1
    s_cbranch_scc1 SP_8_D
    s_sleep 1
    s_cmp_lt_u32 s9, 524288
    s_cbranch_scc1 SP_8
SP_8_D:
    s_setprio 3
    global_load_dwordx2 v[56:57], v74, s[50:51] offset:0 sc1
    global_load_dwordx2 v[58:59], v74, s[50:51] offset:2048 sc1
    global_load_dwordx2 v[60:61], v75, s[50:51] offset:0 sc1
    global_load_dwordx2 v[62:63], v75, s[50:51] offset:2048 sc1
    global_load_dwordx2 v[64:65], v76, s[50:51] offset:0 sc1
    global_load_dwordx2 v[66:67], v76, s[50:51] offset:2048 sc1
    global_load_dwordx2 v[68:69], v77, s[50:51] offset:0 sc1
    global_load_dwordx2 v[70:71], v77, s[50:51] offset:2048 sc1
    global_load_dword v96, v88, s[42:43]
C_IO3:
    s_setprio 3
    s_mov_b32 s9, 0
SP_9:
    ds_read_b32 v12, v1 offset:84
    s_waitcnt lgkmcnt(0)
    v_readfirstlane_b32 s8, v12
    s_add_u32 s9, s9, 1
    s_cmp_ge_u32 s8, 1
    s_cbranch_scc1 SP_9_D
    s_sleep 1
    s_cmp_lt_u32 s9, 524288
    s_cbranch_scc1 SP_9
SP_9_D:
    s_setprio 3
    ds_read_b64_tr_b16 v[40:41], v72 offset:3584
    ds_read_b64_tr_b16 v[42:43], v72 offset:3072
    ds_read_b64_tr_b16 v[44:45], v72 offset:2560
    ds_read_b64_tr_b16 v[46:47], v72 offset:2048
    ds_read_b64_tr_b16 v[48:49], v72 offset:1536
    ds_read_b64_tr_b16 v[50:51], v72 offset:1024
    ds_read_b64_tr_b16 v[52:53], v72 offset:512
    ds_read_b64_tr_b16 v[54:55], v72 offset:0
    s_waitcnt vmcnt(1)
    s_mov_b32 s9, 0
GP_10:
    v_xor_b32 v14, v57, v10
    v_bitop3_b32 v14, v14, v59, v10 bitop3:0xf6
    v_bitop3_b32 v14, v14, v61, v10 bitop3:0xf6
    v_bitop3_b32 v14, v14, v63, v10 bitop3:0xf6
    v_bitop3_b32 v14, v14, v65, v10 bitop3:0xf6
    v_bitop3_b32 v14, v14, v67, v10 bitop3:0xf6
    v_bitop3_b32 v14, v14, v69, v10 bitop3:0xf6
    v_bitop3_b32 v14, v14, v71, v10 bitop3:0xf6
    v_cmp_ne_u32 vcc, 0, v14
    s_add_u32 s9, s9, 1
    s_cmp_eq_u64 vcc, 0
    s_cbranch_scc1 GP_10_D
    s_cmp_ge_u32 s9, 131072
    s_cbranch_scc1 GP_10_D
    global_load_dwordx2 v[56:57], v74, s[50:51] offset:0 sc1
    global_load_dwordx2 v[58:59], v74, s[50:51] offset:2048 sc1
    global_load_dwordx2 v[60:61], v75, s[50:51] offset:0 sc1
    global_load_dwordx2 v[62:63], v75, s[50:51] offset:2048 sc1
    global_load_dwordx2 v[64:65], v76, s[50:51] offset:0 sc1
    global_load_dwordx2 v[66:67], v76, s[50:51] offset:2048 sc1
    global_load_dwordx2 v[68:69], v77, s[50:51] offset:0 sc1
    global_load_dwordx2 v[70:71], v77, s[50:51] offset:2048 sc1
    s_waitcnt vmcnt(0)
    s_branch GP_10
GP_10_D:
    s_setprio 3
    s_mov_b32 s9, 0
SP_11:
    ds_read_b32 v15, v1 offset:96
    s_waitcnt lgkmcnt(0)
    v_readfirstlane_b32 s8, v15
    s_add_u32 s9, s9, 1
    s_cmp_ge_u32 s8, 4
    s_cbranch_scc1 SP_11_D
    s_sleep 1
    s_cmp_lt_u32 s9, 524288
    s_cbranch_scc1 SP_11
SP_11_D:
    s_setprio 3
    ds_read_b64_tr_b16 v[16:17], v73 offset:3584
    ds_read_b64_tr_b16 v[18:19], v73 offset:3072
    ds_read_b64_tr_b16 v[20:21], v73 offset:2560
    ds_read_b64_tr_b16 v[22:23], v73 offset:2048
    s_waitcnt lgkmcnt(3)
    v_perm_b32 v24, v40, v16, s70
    v_perm_b32 v25, v40, v16, s71
    v_perm_b32 v26, v41, v17, s70
    v_perm_b32 v27, v41, v17, s71
    s_waitcnt lgkmcnt(2)
    v_perm_b32 v28, v42, v18, s70
    v_perm_b32 v29, v42, v18, s71
    v_perm_b32 v30, v43, v19, s70
    v_perm_b32 v31, v43, v19, s71
    v_dot2_f32_bf16 v24, v24, v56, 0
    v_dot2_f32_bf16 v25, v25, v56, 0
    v_dot2_f32_bf16 v26, v26, v56, 0
    v_dot2_f32_bf16 v27, v27, v56, 0
    v_dot2_f32_bf16 v28, v28, v58, 0
    v_dot2_f32_bf16 v29, v29, v58, 0
    v_dot2_f32_bf16 v30, v30, v58, 0
    v_dot2_f32_bf16 v31, v31, v58, 0
    v_cvt_pk_bf16_f32 v40, v24, v25
    v_cvt_pk_bf16_f32 v41, v26, v27
    buffer_store_dwordx2 v[40:41], v78, s[60:63], s68 offen
    s_add_u32 s68, s68, 294912
    v_cvt_pk_bf16_f32 v42, v28, v29
    v_cvt_pk_bf16_f32 v43, v30, v31
    buffer_store_dwordx2 v[42:43], v78, s[60:63], s68 offen
    s_add_u32 s68, s68, 294912
    s_waitcnt lgkmcnt(1)
    v_perm_b32 v32, v44, v20, s70
    v_perm_b32 v33, v44, v20, s71
    v_perm_b32 v34, v45, v21, s70
    v_perm_b32 v35, v45, v21, s71
    s_waitcnt lgkmcnt(0)
    v_perm_b32 v36, v46, v22, s70
    v_perm_b32 v37, v46, v22, s71
    v_perm_b32 v38, v47, v23, s70
    v_perm_b32 v39, v47, v23, s71
    v_dot2_f32_bf16 v32, v32, v60, 0
    v_dot2_f32_bf16 v33, v33, v60, 0
    v_dot2_f32_bf16 v34, v34, v60, 0
    v_dot2_f32_bf16 v35, v35, v60, 0
    v_dot2_f32_bf16 v36, v36, v62, 0
    v_dot2_f32_bf16 v37, v37, v62, 0
    v_dot2_f32_bf16 v38, v38, v62, 0
    v_dot2_f32_bf16 v39, v39, v62, 0
    v_cvt_pk_bf16_f32 v44, v32, v33
    v_cvt_pk_bf16_f32 v45, v34, v35
    buffer_store_dwordx2 v[44:45], v78, s[60:63], s68 offen
    s_add_u32 s68, s68, 294912
    v_cvt_pk_bf16_f32 v46, v36, v37
    v_cvt_pk_bf16_f32 v47, v38, v39
    buffer_store_dwordx2 v[46:47], v78, s[60:63], s68 offen
    s_add_u32 s68, s68, 294912
    s_lshl_b32 s8, s12, 8
    s_sub_u32 s8, 76032, s8
    v_lshl_add_u32 v14, v2, 2, s8
    ds_write_b32 v14, v56 offset:7168
    ds_write_b32 v14, v58 offset:6144
    ds_write_b32 v14, v60 offset:5120
    ds_write_b32 v14, v62 offset:4096
    ds_write_b32 v14, v64 offset:3072
    ds_write_b32 v14, v66 offset:2048
    ds_write_b32 v14, v68 offset:1024
    ds_write_b32 v14, v70 offset:0
    s_setprio 3
    s_mov_b32 s9, 0
SP_12:
    ds_read_b32 v15, v1 offset:100
    s_waitcnt lgkmcnt(0)
    v_readfirstlane_b32 s8, v15
    s_add_u32 s9, s9, 1
    s_cmp_ge_u32 s8, 4
    s_cbranch_scc1 SP_12_D
    s_sleep 1
    s_cmp_lt_u32 s9, 524288
    s_cbranch_scc1 SP_12
SP_12_D:
    s_setprio 3
    ds_read_b64_tr_b16 v[16:17], v73 offset:1536
    ds_read_b64_tr_b16 v[18:19], v73 offset:1024
    s_waitcnt lgkmcnt(1)
    v_perm_b32 v24, v48, v16, s70
    v_perm_b32 v25, v48, v16, s71
    v_perm_b32 v26, v49, v17, s70
    v_perm_b32 v27, v49, v17, s71
    s_waitcnt lgkmcnt(0)
    v_perm_b32 v28, v50, v18, s70
    v_perm_b32 v29, v50, v18, s71
    v_perm_b32 v30, v51, v19, s70
    v_perm_b32 v31, v51, v19, s71
    v_dot2_f32_bf16 v24, v24, v64, 0
    v_dot2_f32_bf16 v25, v25, v64, 0
    v_dot2_f32_bf16 v26, v26, v64, 0
    v_dot2_f32_bf16 v27, v27, v64, 0
    v_dot2_f32_bf16 v28, v28, v66, 0
    v_dot2_f32_bf16 v29, v29, v66, 0
    v_dot2_f32_bf16 v30, v30, v66, 0
    v_dot2_f32_bf16 v31, v31, v66, 0
    v_cvt_pk_bf16_f32 v48, v24, v25
    v_cvt_pk_bf16_f32 v49, v26, v27
    buffer_store_dwordx2 v[48:49], v78, s[60:63], s68 offen
    s_add_u32 s68, s68, 294912
    v_cvt_pk_bf16_f32 v50, v28, v29
    v_cvt_pk_bf16_f32 v51, v30, v31
    buffer_store_dwordx2 v[50:51], v78, s[60:63], s68 offen
    s_add_u32 s68, s68, 294912
    s_setprio 3
    s_mov_b32 s9, 0
SP_13:
    ds_read_b32 v15, v1 offset:104
    s_waitcnt lgkmcnt(0)
    v_readfirstlane_b32 s8, v15
    s_add_u32 s9, s9, 1
    s_cmp_ge_u32 s8, 4
    s_cbranch_scc1 SP_13_D
    s_sleep 1
    s_cmp_lt_u32 s9, 524288
    s_cbranch_scc1 SP_13
SP_13_D:
    s_setprio 3
    ds_read_b64_tr_b16 v[16:17], v73 offset:512
    ds_read_b64_tr_b16 v[18:19], v73 offset:0
    s_waitcnt lgkmcnt(1)
    v_perm_b32 v24, v52, v16, s70
    v_perm_b32 v25, v52, v16, s71
    v_perm_b32 v26, v53, v17, s70
    v_perm_b32 v27, v53, v17, s71
    s_waitcnt lgkmcnt(0)
    v_perm_b32 v28, v54, v18, s70
    v_perm_b32 v29, v54, v18, s71
    v_perm_b32 v30, v55, v19, s70
    v_perm_b32 v31, v55, v19, s71
    v_dot2_f32_bf16 v24, v24, v68, 0
    v_dot2_f32_bf16 v25, v25, v68, 0
    v_dot2_f32_bf16 v26, v26, v68, 0
    v_dot2_f32_bf16 v27, v27, v68, 0
    v_dot2_f32_bf16 v28, v28, v70, 0
    v_dot2_f32_bf16 v29, v29, v70, 0
    v_dot2_f32_bf16 v30, v30, v70, 0
    v_dot2_f32_bf16 v31, v31, v70, 0
    v_cvt_pk_bf16_f32 v52, v24, v25
    v_cvt_pk_bf16_f32 v53, v26, v27
    buffer_store_dwordx2 v[52:53], v78, s[60:63], s68 offen
    s_add_u32 s68, s68, 294912
    v_cvt_pk_bf16_f32 v54, v28, v29
    v_cvt_pk_bf16_f32 v55, v30, v31
    buffer_store_dwordx2 v[54:55], v78, s[60:63], s68 offen
    s_add_u32 s68, s68, 294912
    v_mov_b32 v8, 1
    s_mov_b64 exec, 1
    ds_add_u32 v1, v8 offset:44
    s_mov_b64 exec, -1
    s_waitcnt vmcnt(0)
    v_mov_b32 v8, 1
    s_mov_b64 exec, 1
    ds_add_u32 v1, v8 offset:40
    s_mov_b64 exec, -1
    s_endpgm
C_FIN:
    s_setprio 0
    v_and_b32 v8, 7, v2
    v_lshlrev_b32 v8, 3, v8
    v_add_u32 v8, 8192, v8
    s_mul_i32 s8, s7, 9216
    s_add_u32 s8, s8, 32768
    v_lshl_add_u32 v5, v2, 4, s8
    v_add_u32 v6, 0x1000, v5
    v_add_u32 v7, 0x2000, v5
    global_load_dwordx2 v[16:17], v8, s[50:51] sc1
    v_and_b32 v19, 1, v4
    v_lshrrev_b32 v20, 1, v4
    v_lshl_or_b32 v19, v19, 1, v20
    v_mul_u32_u24 v12, 4672, v19
    v_add_u32 v12, 56576, v12
    v_mul_u32_u24 v13, 4160, v19
    v_add_u32 v13, 83456, v13
    s_add_u32 s8, s55, 2358144
    v_lshl_add_u32 v14, v19, 1, s8
    s_waitcnt lgkmcnt(0)
    v_bfe_u32 v110, v10, 0, 8
    v_bfe_u32 v111, v10, 8, 8
    v_bfe_u32 v112, v10, 16, 8
    v_bfe_u32 v113, v10, 24, 8
    s_setprio 3
    s_mov_b32 s9, 0
SP_14:
    ds_read_b32 v26, v1 offset:44
    s_waitcnt lgkmcnt(0)
    v_readfirstlane_b32 s8, v26
    s_add_u32 s9, s9, 1
    s_cmp_ge_u32 s8, 4
    s_cbranch_scc1 SP_14_D
    s_sleep 1
    s_cmp_lt_u32 s9, 524288
    s_cbranch_scc1 SP_14
SP_14_D:
    s_setprio 3
    s_mov_b32 s9, 0
C_MPOLL:
    global_load_dwordx4 v[120:123], v5, s[50:51] offset:0 sc1
    global_load_dwordx4 v[124:127], v5, s[50:51] offset:1024 sc1
    global_load_dwordx4 v[128:131], v5, s[50:51] offset:2048 sc1
    global_load_dwordx4 v[132:135], v5, s[50:51] offset:3072 sc1
    global_load_dwordx4 v[136:139], v6, s[50:51] offset:0 sc1
    global_load_dwordx4 v[140:143], v6, s[50:51] offset:1024 sc1
    global_load_dwordx4 v[144:147], v6, s[50:51] offset:2048 sc1
    global_load_dwordx4 v[148:151], v6, s[50:51] offset:3072 sc1
    global_load_dwordx4 v[152:155], v7, s[50:51] offset:0 sc1
    s_waitcnt vmcnt(9)
    v_and_b32 v22, 0x7ff, v16
    v_lshl_add_u32 v23, v22, 1, v12
    ds_read_u16 v105, v23
    v_lshl_add_u32 v23, v22, 1, v13
    ds_read_u16 v107, v23
    v_lshlrev_b32 v23, 2, v22
    v_add_u32 v23, 75264, v23
    ds_read_b32 v24, v23
    v_and_b32 v20, 0xffff0000, v16
    v_ashrrev_i32 v21, 31, v20
    v_not_b32 v21, v21
    v_or_b32 v21, 0x80000000, v21
    v_and_b32 v21, 0xffff0000, v21
    v_xor_b32 v20, v20, v21
    v_mul_f32 v21, 0xbfb8aa3b, v20
    v_exp_f32 v21, v21
    s_nop 0
    v_add_f32 v21, 1.0, v21
    v_rcp_f32 v104, v21
    s_nop 0
    v_cvt_pk_bf16_f32 v104, v104, v104
    v_and_b32 v104, 0xffff0000, v104
    v_mul_u32_u24 v108, 1152, v22
    v_sub_u32 v108, v14, v108
    s_waitcnt lgkmcnt(0)
    v_lshlrev_b32 v105, 16, v105
    s_waitcnt vmcnt(8)
    v_xor_b32 v120, v120, v110
    v_xor_b32 v121, v121, v111
    v_xor_b32 v122, v122, v112
    v_xor_b32 v123, v123, v113
    v_or3_b32 v26, v120, v121, 0
    v_or3_b32 v26, v122, v123, v26
    s_waitcnt vmcnt(7)
    v_xor_b32 v124, v124, v110
    v_xor_b32 v125, v125, v111
    v_xor_b32 v126, v126, v112
    v_xor_b32 v127, v127, v113
    v_or3_b32 v26, v124, v125, v26
    v_or3_b32 v26, v126, v127, v26
    v_pk_add_f32 v[28:29], v[120:121], v[124:125]
    v_pk_add_f32 v[30:31], v[122:123], v[126:127]
    s_waitcnt vmcnt(6)
    v_xor_b32 v128, v128, v110
    v_xor_b32 v129, v129, v111
    v_xor_b32 v130, v130, v112
    v_xor_b32 v131, v131, v113
    v_or3_b32 v26, v128, v129, v26
    v_or3_b32 v26, v130, v131, v26
    v_pk_add_f32 v[28:29], v[28:29], v[128:129]
    v_pk_add_f32 v[30:31], v[30:31], v[130:131]
    s_waitcnt vmcnt(5)
    v_xor_b32 v132, v132, v110
    v_xor_b32 v133, v133, v111
    v_xor_b32 v134, v134, v112
    v_xor_b32 v135, v135, v113
    v_or3_b32 v26, v132, v133, v26
    v_or3_b32 v26, v134, v135, v26
    v_pk_add_f32 v[28:29], v[28:29], v[132:133]
    v_pk_add_f32 v[30:31], v[30:31], v[134:135]
    s_waitcnt vmcnt(4)
    v_xor_b32 v136, v136, v110
    v_xor_b32 v137, v137, v111
    v_xor_b32 v138, v138, v112
    v_xor_b32 v139, v139, v113
    v_or3_b32 v26, v136, v137, v26
    v_or3_b32 v26, v138, v139, v26
    v_pk_add_f32 v[28:29], v[28:29], v[136:137]
    v_pk_add_f32 v[30:31], v[30:31], v[138:139]
    s_waitcnt vmcnt(3)
    v_xor_b32 v140, v140, v110
    v_xor_b32 v141, v141, v111
    v_xor_b32 v142, v142, v112
    v_xor_b32 v143, v143, v113
    v_or3_b32 v26, v140, v141, v26
    v_or3_b32 v26, v142, v143, v26
    v_pk_add_f32 v[28:29], v[28:29], v[140:141]
    v_pk_add_f32 v[30:31], v[30:31], v[142:143]
    s_waitcnt vmcnt(2)
    v_xor_b32 v144, v144, v110
    v_xor_b32 v145, v145, v111
    v_xor_b32 v146, v146, v112
    v_xor_b32 v147, v147, v113
    v_or3_b32 v26, v144, v145, v26
    v_or3_b32 v26, v146, v147, v26
    v_pk_add_f32 v[28:29], v[28:29], v[144:145]
    v_pk_add_f32 v[30:31], v[30:31], v[146:147]
    s_waitcnt vmcnt(1)
    v_xor_b32 v148, v148, v110
    v_xor_b32 v149, v149, v111
    v_xor_b32 v150, v150, v112
    v_xor_b32 v151, v151, v113
    v_or3_b32 v26, v148, v149, v26
    v_or3_b32 v26, v150, v151, v26
    v_pk_add_f32 v[28:29], v[28:29], v[148:149]
    v_pk_add_f32 v[30:31], v[30:31], v[150:151]
    s_waitcnt vmcnt(0)
    v_xor_b32 v152, v152, v110
    v_xor_b32 v153, v153, v111
    v_xor_b32 v154, v154, v112
    v_xor_b32 v155, v155, v113
    v_or3_b32 v26, v152, v153, v26
    v_or3_b32 v26, v154, v155, v26
    v_pk_add_f32 v[28:29], v[28:29], v[152:153]
    v_pk_add_f32 v[30:31], v[30:31], v[154:155]
    v_and_b32 v26, 0xff, v26
    v_bitop3_b32 v26, v26, v17, v10 bitop3:0xf6
    v_cmp_ne_u32 vcc, 0, v26
    s_add_u32 s9, s9, 1
    s_cmp_eq_u64 vcc, 0
    s_cbranch_scc1 C_MOK
    global_load_dwordx2 v[16:17], v8, s[50:51] sc1
    s_cmp_lt_u32 s9, 131072
    s_cbranch_scc1 C_MPOLL
C_MOK:
    v_permlane32_swap_b32 v28, v29
    v_permlane32_swap_b32 v30, v31
    v_add_f32 v28, v28, v29
    v_add_f32 v30, v30, v31
    s_nop 1
    v_permlane16_swap_b32 v28, v30
    v_add_f32 v28, v28, v30
    s_nop 1
    v_add_f32_dpp v28, v28, v28 row_ror:8 row_mask:0xf bank_mask:0xf
    v_cvt_pk_bf16_f32 v28, v28, v28
    v_and_b32 v28, 0xffff0000, v28
    v_mul_f32 v28, v28, v104
    v_cvt_pk_bf16_f32 v28, v28, v28
    v_and_b32 v28, 0xffff0000, v28
    v_add_f32 v28, v28, v105
    v_cvt_pk_bf16_f32 v28, v28, v28
    v_and_b32 v28, 0xffff0000, v28
    v_or_b32 v28, v28, v107
    v_dot2_f32_bf16 v28, v28, v24, 0
    s_nop 2
    v_cvt_pk_bf16_f32 v28, v28, v28
    s_mov_b32 s9, 0
SP_15:
    ds_read_b32 v27, v1 offset:40
    s_waitcnt lgkmcnt(0)
    v_readfirstlane_b32 s8, v27
    s_add_u32 s9, s9, 1
    s_cmp_ge_u32 s8, 4
    s_cbranch_scc1 SP_15_D
    s_cmp_lt_u32 s9, 524288
    s_cbranch_scc1 SP_15
SP_15_D:
    s_mov_b32 exec_lo, 0x00ff00ff
    s_mov_b32 exec_hi, 0x00ff00ff
    global_store_short v108, v28, s[46:47]
    s_mov_b64 exec, -1
    s_endpgm
HELPER:
    s_cmp_ge_u32 s3, 6
    s_cbranch_scc1 K_END
    s_and_b32 s12, s3, 1
    s_sub_u32 s13, s3, 2
    s_lshr_b32 s13, s13, 1
    s_mul_i32 s13, s13, 5
    s_add_u32 s13, s13, s5
    s_add_u32 s13, s13, 44
    v_mul_u32_u24 v5, 57, v2
    v_lshrrev_b32 v5, 9, v5
    v_mul_u32_u24 v6, 9, v5
    v_sub_u32 v6, v2, v6
    s_waitcnt lgkmcnt(0)
    s_cmp_eq_u32 s12, 1
    s_cselect_b32 s52, s40, s38
    s_cselect_b32 s53, s41, s39
    s_mov_b32 s54, 5308416
    s_mov_b32 s55, 0x20000
    v_mul_u32_u24 v5, 9216, v5
    v_lshl_add_u32 v5, v6, 7, v5
    s_mul_i32 s8, s4, 1152
    s_sub_u32 s14, s13, 53
    s_lshr_b32 s9, s52, 7
    s_add_u32 s9, s9, s4
    s_sub_u32 s9, 3, s9
    s_and_b32 s9, s9, 7
    s_lshl_b32 s15, s9, 7
    s_add_u32 s15, s15, s8
    s_mul_i32 s14, s14, 258048
    s_add_u32 s15, s15, s14
    s_add_u32 s15, s15, 838656
    s_cmp_eq_u32 s9, 0
    s_cselect_b32 s9, 1024, 0
    v_and_b32 v7, 31, v2
    v_min_u32 v7, 27, v7
    v_mul_u32_u24 v7, 9216, v7
    v_lshrrev_b32 v9, 5, v2
    v_mul_u32_u24 v9, s9, v9
    v_add_u32 v7, v7, v9
    s_mul_i32 s13, s13, 64512
    s_add_u32 s13, s13, s8
    s_mov_b32 s9, 0
SP_16:
    ds_read_b32 v13, v1 offset:4
    s_waitcnt lgkmcnt(0)
    v_readfirstlane_b32 s8, v13
    s_add_u32 s9, s9, 1
    s_cmp_ge_u32 s8, 1
    s_cbranch_scc1 SP_16_D
    s_cmp_lt_u32 s9, 524288
    s_cbranch_scc1 SP_16
SP_16_D:
    buffer_load_dword v8, v7, s[52:55], s15 offen
    s_waitcnt vmcnt(0)
    buffer_load_dword v8, v5, s[52:55], s13 offen
    s_add_u32 s13, s13, 645120
    s_waitcnt vmcnt(0)
    buffer_load_dword v8, v5, s[52:55], s13 offen
    s_add_u32 s13, s13, 645120
    s_waitcnt vmcnt(0)
    buffer_load_dword v8, v5, s[52:55], s13 offen
    s_add_u32 s13, s13, 645120
    s_sub_u32 s8, s5, 9
    s_mul_i32 s8, s8, 4
    s_add_u32 s8, s8, s3
    s_sub_u32 s8, s8, 2
    s_lshl_b32 s8, s8, 6
    s_mul_i32 s9, s4, 663552
    v_add_u32 v9, s8, v2
    v_min_u32 v9, 1727, v9
    v_mul_u32_u24 v10, 2731, v9
    v_lshrrev_b32 v10, 16, v10
    v_mul_u32_u24 v10, 48, v10
    v_add_u32 v9, v9, v10
    v_min_u32 v9, 5183, v9
    v_lshl_add_u32 v9, v9, 7, s9
    s_waitcnt vmcnt(0)
    global_load_dword v8, v9, s[42:43]
    s_add_u32 s8, s8, 1280
    v_add_u32 v9, s8, v2
    v_min_u32 v9, 1727, v9
    v_mul_u32_u24 v10, 2731, v9
    v_lshrrev_b32 v10, 16, v10
    v_mul_u32_u24 v10, 48, v10
    v_add_u32 v9, v9, v10
    v_min_u32 v9, 5183, v9
    v_lshl_add_u32 v9, v9, 7, s9
    s_waitcnt vmcnt(0)
    global_load_dword v8, v9, s[42:43]
    s_add_u32 s8, s8, 1280
    s_endpgm
GATE:
    s_lshl_b32 s8, s12, 9
    s_add_u32 s8, s8, 147712
    v_lshl_add_u32 v5, v2, 2, s8
    v_and_b32 v6, 31, v2
    v_lshlrev_b32 v6, 2, v6
    v_add_u32 v6, 158080, v6
    s_lshl_b32 s8, s2, 1
    s_add_u32 s8, s8, s12
    v_mov_b32 v8, 0
    v_mov_b32 v9, 0
    v_mov_b32 v10, 0x3f803f80
    s_lshl_b32 s8, s8, 5
    s_add_u32 s8, s8, 16384
    v_lshrrev_b32 v7, 5, v2
    v_lshl_add_u32 v7, v7, 3, s8
    v_and_b32 v11, 16, v2
    v_add_u32 v7, v7, v11
    s_mov_b32 s9, 0
SP_17:
    ds_read_b32 v13, v1 offset:8
    s_waitcnt lgkmcnt(0)
    v_readfirstlane_b32 s8, v13
    s_add_u32 s9, s9, 1
    s_cmp_lg_u32 s8, 0
    s_cbranch_scc1 SP_17_D
    s_sleep 1
    s_cmp_lt_u32 s9, 524288
    s_cbranch_scc1 SP_17
SP_17_D:
    ds_read2_b32 v[34:35], v6 offset0:0 offset1:32
    ds_read2_b32 v[36:37], v6 offset0:64 offset1:96
    ds_read2_b32 v[38:39], v6 offset0:128 offset1:160
    ds_read2_b32 v[40:41], v6 offset0:192 offset1:224
    ds_read_b32 v42, v6 offset:1024
    ds_read2st64_b32 v[16:17], v5 offset0:0 offset1:1
    ds_read2st64_b32 v[18:19], v5 offset0:4 offset1:5
    ds_read2st64_b32 v[20:21], v5 offset0:8 offset1:9
    ds_read2st64_b32 v[22:23], v5 offset0:12 offset1:13
    ds_read2st64_b32 v[24:25], v5 offset0:16 offset1:17
    ds_read2st64_b32 v[26:27], v5 offset0:20 offset1:21
    ds_read2st64_b32 v[28:29], v5 offset0:24 offset1:25
    ds_read2st64_b32 v[30:31], v5 offset0:28 offset1:29
    ds_read2st64_b32 v[32:33], v5 offset0:32 offset1:33
    s_waitcnt lgkmcnt(13)
    v_and_b32 v44, 0xffff, v34
    v_and_b32 v34, 0xffff0000, v34
    v_and_b32 v45, 0xffff, v35
    v_and_b32 v35, 0xffff0000, v35
    s_waitcnt lgkmcnt(12)
    v_and_b32 v46, 0xffff, v36
    v_and_b32 v36, 0xffff0000, v36
    v_and_b32 v47, 0xffff, v37
    v_and_b32 v37, 0xffff0000, v37
    s_waitcnt lgkmcnt(11)
    v_and_b32 v48, 0xffff, v38
    v_and_b32 v38, 0xffff0000, v38
    v_and_b32 v49, 0xffff, v39
    v_and_b32 v39, 0xffff0000, v39
    s_waitcnt lgkmcnt(10)
    v_and_b32 v50, 0xffff, v40
    v_and_b32 v40, 0xffff0000, v40
    v_and_b32 v51, 0xffff, v41
    v_and_b32 v41, 0xffff0000, v41
    s_waitcnt lgkmcnt(9)
    v_and_b32 v52, 0xffff, v42
    v_and_b32 v42, 0xffff0000, v42
    s_waitcnt lgkmcnt(8)
    v_dot2_f32_bf16 v56, v16, v44, 0
    v_dot2_f32_bf16 v57, v16, v34, 0
    v_dot2_f32_bf16 v58, v17, v44, 0
    v_dot2_f32_bf16 v59, v17, v34, 0
    s_waitcnt lgkmcnt(7)
    v_dot2_f32_bf16 v60, v18, v45, 0
    v_dot2_f32_bf16 v61, v18, v35, 0
    v_dot2_f32_bf16 v62, v19, v45, 0
    v_dot2_f32_bf16 v63, v19, v35, 0
    v_cvt_pk_bf16_f32 v56, v56, v57
    v_cvt_pk_bf16_f32 v58, v58, v59
    v_dot2c_f32_bf16 v8, v56, v10
    v_dot2c_f32_bf16 v9, v58, v10
    s_waitcnt lgkmcnt(6)
    v_dot2_f32_bf16 v56, v20, v46, 0
    v_dot2_f32_bf16 v57, v20, v36, 0
    v_dot2_f32_bf16 v58, v21, v46, 0
    v_dot2_f32_bf16 v59, v21, v36, 0
    v_cvt_pk_bf16_f32 v60, v60, v61
    v_cvt_pk_bf16_f32 v62, v62, v63
    v_dot2c_f32_bf16 v8, v60, v10
    v_dot2c_f32_bf16 v9, v62, v10
    s_waitcnt lgkmcnt(5)
    v_dot2_f32_bf16 v60, v22, v47, 0
    v_dot2_f32_bf16 v61, v22, v37, 0
    v_dot2_f32_bf16 v62, v23, v47, 0
    v_dot2_f32_bf16 v63, v23, v37, 0
    v_cvt_pk_bf16_f32 v56, v56, v57
    v_cvt_pk_bf16_f32 v58, v58, v59
    v_dot2c_f32_bf16 v8, v56, v10
    v_dot2c_f32_bf16 v9, v58, v10
    s_waitcnt lgkmcnt(4)
    v_dot2_f32_bf16 v56, v24, v48, 0
    v_dot2_f32_bf16 v57, v24, v38, 0
    v_dot2_f32_bf16 v58, v25, v48, 0
    v_dot2_f32_bf16 v59, v25, v38, 0
    v_cvt_pk_bf16_f32 v60, v60, v61
    v_cvt_pk_bf16_f32 v62, v62, v63
    v_dot2c_f32_bf16 v8, v60, v10
    v_dot2c_f32_bf16 v9, v62, v10
    s_waitcnt lgkmcnt(3)
    v_dot2_f32_bf16 v60, v26, v49, 0
    v_dot2_f32_bf16 v61, v26, v39, 0
    v_dot2_f32_bf16 v62, v27, v49, 0
    v_dot2_f32_bf16 v63, v27, v39, 0
    v_cvt_pk_bf16_f32 v56, v56, v57
    v_cvt_pk_bf16_f32 v58, v58, v59
    v_dot2c_f32_bf16 v8, v56, v10
    v_dot2c_f32_bf16 v9, v58, v10
    s_waitcnt lgkmcnt(2)
    v_dot2_f32_bf16 v56, v28, v50, 0
    v_dot2_f32_bf16 v57, v28, v40, 0
    v_dot2_f32_bf16 v58, v29, v50, 0
    v_dot2_f32_bf16 v59, v29, v40, 0
    v_cvt_pk_bf16_f32 v60, v60, v61
    v_cvt_pk_bf16_f32 v62, v62, v63
    v_dot2c_f32_bf16 v8, v60, v10
    v_dot2c_f32_bf16 v9, v62, v10
    s_waitcnt lgkmcnt(1)
    v_dot2_f32_bf16 v60, v30, v51, 0
    v_dot2_f32_bf16 v61, v30, v41, 0
    v_dot2_f32_bf16 v62, v31, v51, 0
    v_dot2_f32_bf16 v63, v31, v41, 0
    v_cvt_pk_bf16_f32 v56, v56, v57
    v_cvt_pk_bf16_f32 v58, v58, v59
    v_dot2c_f32_bf16 v8, v56, v10
    v_dot2c_f32_bf16 v9, v58, v10
    s_waitcnt lgkmcnt(0)
    v_dot2_f32_bf16 v56, v32, v52, 0
    v_dot2_f32_bf16 v57, v32, v42, 0
    v_dot2_f32_bf16 v58, v33, v52, 0
    v_dot2_f32_bf16 v59, v33, v42, 0
    v_cvt_pk_bf16_f32 v60, v60, v61
    v_cvt_pk_bf16_f32 v62, v62, v63
    v_dot2c_f32_bf16 v8, v60, v10
    v_dot2c_f32_bf16 v9, v62, v10
    v_cvt_pk_bf16_f32 v56, v56, v57
    v_cvt_pk_bf16_f32 v58, v58, v59
    v_dot2c_f32_bf16 v8, v56, v10
    v_dot2c_f32_bf16 v9, v58, v10
    v_mov_b32 v11, 1
    s_mov_b64 exec, 1
    ds_add_u32 v1, v11 offset:12
    s_mov_b64 exec, -1
    v_permlane16_swap_b32 v8, v9
    v_add_f32 v8, v8, v9
    s_nop 1
    v_add_f32_dpp v8, v8, v8 row_ror:8 row_mask:0xf bank_mask:0xf
    s_nop 1
    v_add_f32_dpp v8, v8, v8 row_ror:4 row_mask:0xf bank_mask:0xf
    s_nop 1
    v_add_f32_dpp v8, v8, v8 row_ror:2 row_mask:0xf bank_mask:0xf
    s_nop 1
    v_add_f32_dpp v8, v8, v8 row_ror:1 row_mask:0xf bank_mask:0xf
    v_cvt_pk_bf16_f32 v8, v8, v8
    v_and_b32 v8, 0xffff0000, v8
    v_mul_f32 v9, 0xbfb8aa3b, v8
    v_exp_f32 v9, v9
    s_nop 0
    v_add_f32 v9, 1.0, v9
    v_rcp_f32 v8, v9
    s_nop 0
    v_cvt_pk_bf16_f32 v8, v8, v8
    v_and_b32 v8, 0xffff0000, v8
    v_sub_f32 v9, 1.0, v8
    v_cvt_pk_bf16_f32 v12, v8, v9
    s_mov_b32 exec_lo, 0x00010001
    s_mov_b32 exec_hi, 0x00010001
    global_store_dwordx2 v7, v[12:13], s[50:51] sc1
    s_mov_b64 exec, -1
    s_cmp_lt_u32 s5, 9
    s_cbranch_scc1 F_COMP2
    s_cmp_ge_u32 s5, 14
    s_cbranch_scc1 C_IO
    s_endpgm
C_KBODY:
C_SETD:
    s_waitcnt lgkmcnt(0)
    s_lshl_b32 s8, s12, 4
    s_lshr_b64 s[58:59], s[58:59], s8
    s_lshl_b32 s8, s58, 16
    v_mov_b32 v44, s8
    v_mul_f32 v45, 0x3fb8aa3b, v44
    v_mov_b32 v46, 0x3fb8aa3b
    v_fma_f32 v46, v44, v46, -v45
    v_mov_b32 v47, 0x32a57060
    v_fma_f32 v46, v44, v47, v46
    v_exp_f32 v45, v45
    v_mul_f32 v46, 0x3f317218, v46
    v_fma_f32 v45, v45, v46, v45
    v_cvt_pk_bf16_f32 v45, v45, v45
    v_and_b32 v36, 0xffff0000, v45
    v_mul_f32 v37, 0x3fb8aa3b, v36
    v_mul_f32 v38, 0x3e22f983, v36
    s_waitcnt vmcnt(0)
    v_mul_f32 v40, v16, v37
    v_mul_f32 v41, v17, v38
    v_exp_f32 v24, v40
    v_fract_f32 v47, v41
    v_cos_f32 v46, v47
    v_sin_f32 v47, v47
    v_mul_f32 v46, v24, v46
    v_mul_f32 v47, v24, v47
    v_mul_f32 v18, v18, v36
    v_mul_f32 v19, v19, v36
    v_pk_mul_f32 v[42:43], v[20:21], v[18:19] op_sel:[0,0] op_sel_hi:[0,1]
    v_pk_fma_f32 v[42:43], v[20:21], v[18:19], v[42:43] op_sel:[1,1,0] op_sel_hi:[1,0,1] neg_lo:[0,1,0]
    v_max_f32 v39, |v42|, |v43|
    v_pk_mul_f32 v[48:49], v[46:47], v[46:47] op_sel:[0,0] op_sel_hi:[0,1]
    v_pk_fma_f32 v[48:49], v[46:47], v[46:47], v[48:49] op_sel:[1,1,0] op_sel_hi:[1,0,1] neg_lo:[0,1,0]
    v_pk_mul_f32 v[52:53], v[48:49], v[48:49] op_sel:[0,0] op_sel_hi:[0,1]
    v_pk_fma_f32 v[52:53], v[48:49], v[48:49], v[52:53] op_sel:[1,1,0] op_sel_hi:[1,0,1] neg_lo:[0,1,0]
    v_pk_mul_f32 v[60:61], v[52:53], v[52:53] op_sel:[0,0] op_sel_hi:[0,1]
    v_pk_fma_f32 v[60:61], v[52:53], v[52:53], v[60:61] op_sel:[1,1,0] op_sel_hi:[1,0,1] neg_lo:[0,1,0]
    v_mov_b32 v30, 0x3c00
    v_xor_b32 v61, 0x80000000, v61
    ds_write_addtid_b32 v30
    v_cvt_pk_f16_f32 v26, v60, v61
    v_pk_mul_f32 v[62:63], v[60:61], v[60:61] op_sel:[0,0] op_sel_hi:[0,1]
    v_pk_fma_f32 v[62:63], v[60:61], v[60:61], v[62:63] op_sel:[1,1,0] op_sel_hi:[1,0,1] neg_lo:[0,1,0]
    v_max_u32_dpp v39, v39, v39 row_shr:1 row_mask:0xf bank_mask:0xf
    ds_write_addtid_b32 v26 offset:288
    v_cvt_pk_f16_f32 v27, v62, v63
    v_pk_mul_f32 v[64:65], v[62:63], v[60:61] op_sel:[0,0] op_sel_hi:[0,1]
    v_pk_fma_f32 v[64:65], v[62:63], v[60:61], v[64:65] op_sel:[1,1,0] op_sel_hi:[1,0,1] neg_lo:[0,1,0]
    v_max_u32_dpp v39, v39, v39 row_shr:2 row_mask:0xf bank_mask:0xf
    ds_write_addtid_b32 v27 offset:576
    v_cvt_pk_f16_f32 v28, v64, v65
    v_pk_mul_f32 v[62:63], v[64:65], v[60:61] op_sel:[0,0] op_sel_hi:[0,1]
    v_pk_fma_f32 v[62:63], v[64:65], v[60:61], v[62:63] op_sel:[1,1,0] op_sel_hi:[1,0,1] neg_lo:[0,1,0]
    v_max_u32_dpp v39, v39, v39 row_shr:4 row_mask:0xf bank_mask:0xf
    ds_write_addtid_b32 v28 offset:864
    v_cvt_pk_f16_f32 v29, v62, v63
    v_pk_mul_f32 v[64:65], v[62:63], v[60:61] op_sel:[0,0] op_sel_hi:[0,1]
    v_pk_fma_f32 v[64:65], v[62:63], v[60:61], v[64:65] op_sel:[1,1,0] op_sel_hi:[1,0,1] neg_lo:[0,1,0]
    v_max_u32_dpp v39, v39, v39 row_shr:8 row_mask:0xf bank_mask:0xf
    ds_write_addtid_b32 v29 offset:1152
    v_cvt_pk_f16_f32 v26, v64, v65
    v_pk_mul_f32 v[62:63], v[64:65], v[60:61] op_sel:[0,0] op_sel_hi:[0,1]
    v_pk_fma_f32 v[62:63], v[64:65], v[60:61], v[62:63] op_sel:[1,1,0] op_sel_hi:[1,0,1] neg_lo:[0,1,0]
    v_max_u32_dpp v39, v39, v39 row_bcast:15 row_mask:0xa bank_mask:0xf
    ds_write_addtid_b32 v26 offset:1440
    v_cvt_pk_f16_f32 v27, v62, v63
    v_pk_mul_f32 v[64:65], v[62:63], v[60:61] op_sel:[0,0] op_sel_hi:[0,1]
    v_pk_fma_f32 v[64:65], v[62:63], v[60:61], v[64:65] op_sel:[1,1,0] op_sel_hi:[1,0,1] neg_lo:[0,1,0]
    v_max_u32_dpp v39, v39, v39 row_bcast:31 row_mask:0xc bank_mask:0xf
    ds_write_addtid_b32 v27 offset:1728
    v_cvt_pk_f16_f32 v28, v64, v65
    v_pk_mul_f32 v[62:63], v[64:65], v[60:61] op_sel:[0,0] op_sel_hi:[0,1]
    v_pk_fma_f32 v[62:63], v[64:65], v[60:61], v[62:63] op_sel:[1,1,0] op_sel_hi:[1,0,1] neg_lo:[0,1,0]
    v_readlane_b32 s8, v39, 63
    ds_write_addtid_b32 v28 offset:2016
    v_cvt_pk_f16_f32 v29, v62, v63
    v_pk_mul_f32 v[64:65], v[62:63], v[60:61] op_sel:[0,0] op_sel_hi:[0,1]
    v_pk_fma_f32 v[64:65], v[62:63], v[60:61], v[64:65] op_sel:[1,1,0] op_sel_hi:[1,0,1] neg_lo:[0,1,0]
    ds_write_addtid_b32 v29 offset:2304
    v_cvt_pk_f16_f32 v26, v64, v65
    v_pk_mul_f32 v[62:63], v[64:65], v[60:61] op_sel:[0,0] op_sel_hi:[0,1]
    v_pk_fma_f32 v[62:63], v[64:65], v[60:61], v[62:63] op_sel:[1,1,0] op_sel_hi:[1,0,1] neg_lo:[0,1,0]
    ds_write_addtid_b32 v26 offset:2592
    v_cvt_pk_f16_f32 v27, v62, v63
    v_pk_mul_f32 v[64:65], v[62:63], v[60:61] op_sel:[0,0] op_sel_hi:[0,1]
    v_pk_fma_f32 v[64:65], v[62:63], v[60:61], v[64:65] op_sel:[1,1,0] op_sel_hi:[1,0,1] neg_lo:[0,1,0]
    ds_write_addtid_b32 v27 offset:2880
    v_cvt_pk_f16_f32 v28, v64, v65
    v_pk_mul_f32 v[62:63], v[64:65], v[60:61] op_sel:[0,0] op_sel_hi:[0,1]
    v_pk_fma_f32 v[62:63], v[64:65], v[60:61], v[62:63] op_sel:[1,1,0] op_sel_hi:[1,0,1] neg_lo:[0,1,0]
    ds_write_addtid_b32 v28 offset:3168
    v_cvt_pk_f16_f32 v29, v62, v63
    v_pk_mul_f32 v[64:65], v[62:63], v[60:61] op_sel:[0,0] op_sel_hi:[0,1]
    v_pk_fma_f32 v[64:65], v[62:63], v[60:61], v[64:65] op_sel:[1,1,0] op_sel_hi:[1,0,1] neg_lo:[0,1,0]
    ds_write_addtid_b32 v29 offset:3456
    v_cvt_pk_f16_f32 v26, v64, v65
    v_pk_mul_f32 v[62:63], v[64:65], v[60:61] op_sel:[0,0] op_sel_hi:[0,1]
    v_pk_fma_f32 v[62:63], v[64:65], v[60:61], v[62:63] op_sel:[1,1,0] op_sel_hi:[1,0,1] neg_lo:[0,1,0]
    ds_write_addtid_b32 v26 offset:3744
    v_cvt_pk_f16_f32 v27, v62, v63
    v_pk_mul_f32 v[64:65], v[62:63], v[60:61] op_sel:[0,0] op_sel_hi:[0,1]
    v_pk_fma_f32 v[64:65], v[62:63], v[60:61], v[64:65] op_sel:[1,1,0] op_sel_hi:[1,0,1] neg_lo:[0,1,0]
    ds_write_addtid_b32 v27 offset:4032
    v_cvt_pk_f16_f32 v28, v64, v65
    s_lshr_b32 s8, s8, 23
    s_sub_u32 s8, 258, s8
    s_min_u32 s54, s8, 253
    s_lshl_b32 s8, s54, 23
    v_mul_f32 v42, s8, v42
    v_mul_f32 v43, s8, v43
    ds_write_addtid_b32 v28 offset:4320
    ds_read_b128 v[72:75], v7 offset:0
    ds_read_b128 v[76:79], v7 offset:64
    ds_read_b128 v[80:83], v7 offset:128
    ds_read_b128 v[84:87], v7 offset:192
    v_mul_f32 v44, 0x43000000, v40
    v_mul_f32 v45, 0x43000000, v41
    v_exp_f32 v24, v44
    v_fract_f32 v45, v45
    v_cos_f32 v44, v45
    v_sin_f32 v45, v45
    v_mul_f32 v44, v24, v44
    v_mul_f32 v45, v24, v45
    v_pk_mul_f32 v[50:51], v[48:49], v[46:47] op_sel:[0,0] op_sel_hi:[0,1]
    v_pk_fma_f32 v[50:51], v[48:49], v[46:47], v[50:51] op_sel:[1,1,0] op_sel_hi:[1,0,1] neg_lo:[0,1,0]
    v_pk_mul_f32 v[54:55], v[52:53], v[46:47] op_sel:[0,0] op_sel_hi:[0,1]
    v_pk_fma_f32 v[54:55], v[52:53], v[46:47], v[54:55] op_sel:[1,1,0] op_sel_hi:[1,0,1] neg_lo:[0,1,0]
    v_pk_mul_f32 v[56:57], v[50:51], v[50:51] op_sel:[0,0] op_sel_hi:[0,1]
    v_pk_fma_f32 v[56:57], v[50:51], v[50:51], v[56:57] op_sel:[1,1,0] op_sel_hi:[1,0,1] neg_lo:[0,1,0]
    v_pk_mul_f32 v[58:59], v[56:57], v[46:47] op_sel:[0,0] op_sel_hi:[0,1]
    v_pk_fma_f32 v[58:59], v[56:57], v[46:47], v[58:59] op_sel:[1,1,0] op_sel_hi:[1,0,1] neg_lo:[0,1,0]
    v_cvt_pk_f16_f32 v29, v42, v43
    v_pk_mul_f32 v[60:61], v[42:43], v[46:47] op_sel:[0,0] op_sel_hi:[0,1]
    v_pk_fma_f32 v[60:61], v[42:43], v[46:47], v[60:61] op_sel:[1,1,0] op_sel_hi:[1,0,1] neg_lo:[0,1,0]
    ds_write_addtid_b32 v29 offset:0
    v_cvt_pk_f16_f32 v26, v60, v61
    v_pk_mul_f32 v[62:63], v[42:43], v[48:49] op_sel:[0,0] op_sel_hi:[0,1]
    v_pk_fma_f32 v[62:63], v[42:43], v[48:49], v[62:63] op_sel:[1,1,0] op_sel_hi:[1,0,1] neg_lo:[0,1,0]
    ds_write_addtid_b32 v26 offset:288
    v_cvt_pk_f16_f32 v27, v62, v63
    v_pk_mul_f32 v[60:61], v[42:43], v[50:51] op_sel:[0,0] op_sel_hi:[0,1]
    v_pk_fma_f32 v[60:61], v[42:43], v[50:51], v[60:61] op_sel:[1,1,0] op_sel_hi:[1,0,1] neg_lo:[0,1,0]
    ds_write_addtid_b32 v27 offset:576
    v_cvt_pk_f16_f32 v28, v60, v61
    v_pk_mul_f32 v[62:63], v[42:43], v[52:53] op_sel:[0,0] op_sel_hi:[0,1]
    v_pk_fma_f32 v[62:63], v[42:43], v[52:53], v[62:63] op_sel:[1,1,0] op_sel_hi:[1,0,1] neg_lo:[0,1,0]
    ds_write_addtid_b32 v28 offset:864
    v_cvt_pk_f16_f32 v29, v62, v63
    v_pk_mul_f32 v[60:61], v[42:43], v[54:55] op_sel:[0,0] op_sel_hi:[0,1]
    v_pk_fma_f32 v[60:61], v[42:43], v[54:55], v[60:61] op_sel:[1,1,0] op_sel_hi:[1,0,1] neg_lo:[0,1,0]
    ds_write_addtid_b32 v29 offset:1152
    v_cvt_pk_f16_f32 v26, v60, v61
    v_pk_mul_f32 v[62:63], v[42:43], v[56:57] op_sel:[0,0] op_sel_hi:[0,1]
    v_pk_fma_f32 v[62:63], v[42:43], v[56:57], v[62:63] op_sel:[1,1,0] op_sel_hi:[1,0,1] neg_lo:[0,1,0]
    ds_write_addtid_b32 v26 offset:1440
    v_cvt_pk_f16_f32 v27, v62, v63
    v_pk_mul_f32 v[60:61], v[42:43], v[58:59] op_sel:[0,0] op_sel_hi:[0,1]
    v_pk_fma_f32 v[60:61], v[42:43], v[58:59], v[60:61] op_sel:[1,1,0] op_sel_hi:[1,0,1] neg_lo:[0,1,0]
    ds_write_addtid_b32 v27 offset:1728
    v_cvt_pk_f16_f32 v28, v60, v61
    v_pk_mul_f32 v[66:67], v[42:43], v[44:45] op_sel:[0,0] op_sel_hi:[0,1]
    v_pk_fma_f32 v[66:67], v[42:43], v[44:45], v[66:67] op_sel:[1,1,0] op_sel_hi:[1,0,1] neg_lo:[0,1,0]
    ds_write_addtid_b32 v28 offset:2016
    v_cvt_pk_f16_f32 v29, v66, v67
    v_pk_mul_f32 v[62:63], v[66:67], v[46:47] op_sel:[0,0] op_sel_hi:[0,1]
    v_pk_fma_f32 v[62:63], v[66:67], v[46:47], v[62:63] op_sel:[1,1,0] op_sel_hi:[1,0,1] neg_lo:[0,1,0]
    ds_write_addtid_b32 v29 offset:2304
    v_cvt_pk_f16_f32 v26, v62, v63
    v_pk_mul_f32 v[60:61], v[66:67], v[48:49] op_sel:[0,0] op_sel_hi:[0,1]
    v_pk_fma_f32 v[60:61], v[66:67], v[48:49], v[60:61] op_sel:[1,1,0] op_sel_hi:[1,0,1] neg_lo:[0,1,0]
    ds_write_addtid_b32 v26 offset:2592
    v_cvt_pk_f16_f32 v27, v60, v61
    v_pk_mul_f32 v[62:63], v[66:67], v[50:51] op_sel:[0,0] op_sel_hi:[0,1]
    v_pk_fma_f32 v[62:63], v[66:67], v[50:51], v[62:63] op_sel:[1,1,0] op_sel_hi:[1,0,1] neg_lo:[0,1,0]
    ds_write_addtid_b32 v27 offset:2880
    v_cvt_pk_f16_f32 v28, v62, v63
    v_pk_mul_f32 v[60:61], v[66:67], v[52:53] op_sel:[0,0] op_sel_hi:[0,1]
    v_pk_fma_f32 v[60:61], v[66:67], v[52:53], v[60:61] op_sel:[1,1,0] op_sel_hi:[1,0,1] neg_lo:[0,1,0]
    ds_write_addtid_b32 v28 offset:3168
    v_cvt_pk_f16_f32 v29, v60, v61
    v_pk_mul_f32 v[62:63], v[66:67], v[54:55] op_sel:[0,0] op_sel_hi:[0,1]
    v_pk_fma_f32 v[62:63], v[66:67], v[54:55], v[62:63] op_sel:[1,1,0] op_sel_hi:[1,0,1] neg_lo:[0,1,0]
    ds_write_addtid_b32 v29 offset:3456
    v_cvt_pk_f16_f32 v26, v62, v63
    v_pk_mul_f32 v[60:61], v[66:67], v[56:57] op_sel:[0,0] op_sel_hi:[0,1]
    v_pk_fma_f32 v[60:61], v[66:67], v[56:57], v[60:61] op_sel:[1,1,0] op_sel_hi:[1,0,1] neg_lo:[0,1,0]
    ds_write_addtid_b32 v26 offset:3744
    v_cvt_pk_f16_f32 v27, v60, v61
    v_pk_mul_f32 v[62:63], v[66:67], v[58:59] op_sel:[0,0] op_sel_hi:[0,1]
    v_pk_fma_f32 v[62:63], v[66:67], v[58:59], v[62:63] op_sel:[1,1,0] op_sel_hi:[1,0,1] neg_lo:[0,1,0]
    ds_write_addtid_b32 v27 offset:4032
    v_cvt_pk_f16_f32 v28, v62, v63
    v_pk_mul_f32 v[68:69], v[66:67], v[44:45] op_sel:[0,0] op_sel_hi:[0,1]
    v_pk_fma_f32 v[68:69], v[66:67], v[44:45], v[68:69] op_sel:[1,1,0] op_sel_hi:[1,0,1] neg_lo:[0,1,0]
    ds_write_addtid_b32 v28 offset:4320
    ds_read_b128 v[88:91], v7 offset:0
    ds_read_b128 v[92:95], v7 offset:64
    ds_read_b128 v[96:99], v7 offset:128
    ds_read_b128 v[100:103], v7 offset:192
    v_cvt_pk_f16_f32 v29, v68, v69
    v_pk_mul_f32 v[60:61], v[68:69], v[48:49] op_sel:[0,0] op_sel_hi:[0,1]
    v_pk_fma_f32 v[60:61], v[68:69], v[48:49], v[60:61] op_sel:[1,1,0] op_sel_hi:[1,0,1] neg_lo:[0,1,0]
    ds_write_addtid_b32 v29 offset:0
    v_cvt_pk_f16_f32 v26, v60, v61
    v_pk_mul_f32 v[62:63], v[68:69], v[52:53] op_sel:[0,0] op_sel_hi:[0,1]
    v_pk_fma_f32 v[62:63], v[68:69], v[52:53], v[62:63] op_sel:[1,1,0] op_sel_hi:[1,0,1] neg_lo:[0,1,0]
    ds_write_addtid_b32 v26 offset:288
    v_cvt_pk_f16_f32 v27, v62, v63
    v_pk_mul_f32 v[60:61], v[68:69], v[56:57] op_sel:[0,0] op_sel_hi:[0,1]
    v_pk_fma_f32 v[60:61], v[68:69], v[56:57], v[60:61] op_sel:[1,1,0] op_sel_hi:[1,0,1] neg_lo:[0,1,0]
    ds_write_addtid_b32 v27 offset:576
    v_cvt_pk_f16_f32 v28, v60, v61
    v_pk_mul_f32 v[66:67], v[68:69], v[44:45] op_sel:[0,0] op_sel_hi:[0,1]
    v_pk_fma_f32 v[66:67], v[68:69], v[44:45], v[66:67] op_sel:[1,1,0] op_sel_hi:[1,0,1] neg_lo:[0,1,0]
    ds_write_addtid_b32 v28 offset:864
    v_cvt_pk_f16_f32 v29, v66, v67
    s_waitcnt lgkmcnt(7)
    v_mfma_f32_16x16x32_f16 v[104:107], v[88:91], v[72:75], 0
    v_pk_mul_f32 v[62:63], v[66:67], v[48:49] op_sel:[0,0] op_sel_hi:[0,1]
    v_pk_fma_f32 v[62:63], v[66:67], v[48:49], v[62:63] op_sel:[1,1,0] op_sel_hi:[1,0,1] neg_lo:[0,1,0]
    ds_write_addtid_b32 v29 offset:1152
    v_cvt_pk_f16_f32 v26, v62, v63
    s_waitcnt lgkmcnt(7)
    v_mfma_f32_16x16x32_f16 v[104:107], v[92:95], v[76:79], v[104:107]
    v_pk_mul_f32 v[60:61], v[66:67], v[52:53] op_sel:[0,0] op_sel_hi:[0,1]
    v_pk_fma_f32 v[60:61], v[66:67], v[52:53], v[60:61] op_sel:[1,1,0] op_sel_hi:[1,0,1] neg_lo:[0,1,0]
    ds_write_addtid_b32 v26 offset:1440
    v_cvt_pk_f16_f32 v27, v60, v61
    s_waitcnt lgkmcnt(7)
    v_mfma_f32_16x16x32_f16 v[104:107], v[96:99], v[80:83], v[104:107]
    v_pk_mul_f32 v[62:63], v[66:67], v[56:57] op_sel:[0,0] op_sel_hi:[0,1]
    v_pk_fma_f32 v[62:63], v[66:67], v[56:57], v[62:63] op_sel:[1,1,0] op_sel_hi:[1,0,1] neg_lo:[0,1,0]
    ds_write_addtid_b32 v27 offset:1728
    v_cvt_pk_f16_f32 v28, v62, v63
    s_waitcnt lgkmcnt(7)
    v_mfma_f32_16x16x32_f16 v[104:107], v[100:103], v[84:87], v[104:107]
    v_pk_mul_f32 v[68:69], v[66:67], v[44:45] op_sel:[0,0] op_sel_hi:[0,1]
    v_pk_fma_f32 v[68:69], v[66:67], v[44:45], v[68:69] op_sel:[1,1,0] op_sel_hi:[1,0,1] neg_lo:[0,1,0]
    ds_write_addtid_b32 v28 offset:2016
    v_cvt_pk_f16_f32 v29, v68, v69
    v_pk_mul_f32 v[60:61], v[68:69], v[52:53] op_sel:[0,0] op_sel_hi:[0,1]
    v_pk_fma_f32 v[60:61], v[68:69], v[52:53], v[60:61] op_sel:[1,1,0] op_sel_hi:[1,0,1] neg_lo:[0,1,0]
    ds_write_addtid_b32 v29 offset:2304
    v_cvt_pk_f16_f32 v26, v60, v61
    v_pk_mul_f32 v[66:67], v[68:69], v[44:45] op_sel:[0,0] op_sel_hi:[0,1]
    v_pk_fma_f32 v[66:67], v[68:69], v[44:45], v[66:67] op_sel:[1,1,0] op_sel_hi:[1,0,1] neg_lo:[0,1,0]
    ds_write_addtid_b32 v26 offset:2592
    v_cvt_pk_f16_f32 v27, v66, v67
    v_pk_mul_f32 v[62:63], v[66:67], v[52:53] op_sel:[0,0] op_sel_hi:[0,1]
    v_pk_fma_f32 v[62:63], v[66:67], v[52:53], v[62:63] op_sel:[1,1,0] op_sel_hi:[1,0,1] neg_lo:[0,1,0]
    ds_write_addtid_b32 v27 offset:2880
    v_cvt_pk_f16_f32 v28, v62, v63
    v_pk_mul_f32 v[68:69], v[66:67], v[44:45] op_sel:[0,0] op_sel_hi:[0,1]
    v_pk_fma_f32 v[68:69], v[66:67], v[44:45], v[68:69] op_sel:[1,1,0] op_sel_hi:[1,0,1] neg_lo:[0,1,0]
    ds_write_addtid_b32 v28 offset:3168
    v_cvt_pk_f16_f32 v29, v68, v69
    v_pk_mul_f32 v[60:61], v[68:69], v[52:53] op_sel:[0,0] op_sel_hi:[0,1]
    v_pk_fma_f32 v[60:61], v[68:69], v[52:53], v[60:61] op_sel:[1,1,0] op_sel_hi:[1,0,1] neg_lo:[0,1,0]
    ds_write_addtid_b32 v29 offset:3456
    v_cvt_pk_f16_f32 v26, v60, v61
    v_pk_mul_f32 v[66:67], v[68:69], v[44:45] op_sel:[0,0] op_sel_hi:[0,1]
    v_pk_fma_f32 v[66:67], v[68:69], v[44:45], v[66:67] op_sel:[1,1,0] op_sel_hi:[1,0,1] neg_lo:[0,1,0]
    ds_write_addtid_b32 v26 offset:3744
    v_cvt_pk_f16_f32 v27, v66, v67
    v_pk_mul_f32 v[62:63], v[66:67], v[52:53] op_sel:[0,0] op_sel_hi:[0,1]
    v_pk_fma_f32 v[62:63], v[66:67], v[52:53], v[62:63] op_sel:[1,1,0] op_sel_hi:[1,0,1] neg_lo:[0,1,0]
    ds_write_addtid_b32 v27 offset:4032
    v_cvt_pk_f16_f32 v28, v62, v63
    v_pk_mul_f32 v[68:69], v[66:67], v[44:45] op_sel:[0,0] op_sel_hi:[0,1]
    v_pk_fma_f32 v[68:69], v[66:67], v[44:45], v[68:69] op_sel:[1,1,0] op_sel_hi:[1,0,1] neg_lo:[0,1,0]
    ds_write_addtid_b32 v28 offset:4320
    ds_read_b128 v[88:91], v7 offset:0
    ds_read_b128 v[92:95], v7 offset:64
    ds_read_b128 v[96:99], v7 offset:128
    ds_read_b128 v[100:103], v7 offset:192
    v_cvt_pk_f16_f32 v29, v68, v69
    v_pk_mul_f32 v[66:67], v[68:69], v[44:45] op_sel:[0,0] op_sel_hi:[0,1]
    v_pk_fma_f32 v[66:67], v[68:69], v[44:45], v[66:67] op_sel:[1,1,0] op_sel_hi:[1,0,1] neg_lo:[0,1,0]
    ds_write_addtid_b32 v29 offset:0
    v_cvt_pk_f16_f32 v26, v66, v67
    v_pk_mul_f32 v[68:69], v[66:67], v[44:45] op_sel:[0,0] op_sel_hi:[0,1]
    v_pk_fma_f32 v[68:69], v[66:67], v[44:45], v[68:69] op_sel:[1,1,0] op_sel_hi:[1,0,1] neg_lo:[0,1,0]
    ds_write_addtid_b32 v26 offset:288
    v_cvt_pk_f16_f32 v27, v68, v69
    v_pk_mul_f32 v[66:67], v[68:69], v[44:45] op_sel:[0,0] op_sel_hi:[0,1]
    v_pk_fma_f32 v[66:67], v[68:69], v[44:45], v[66:67] op_sel:[1,1,0] op_sel_hi:[1,0,1] neg_lo:[0,1,0]
    ds_write_addtid_b32 v27 offset:576
    v_cvt_pk_f16_f32 v28, v66, v67
    v_pk_mul_f32 v[68:69], v[66:67], v[44:45] op_sel:[0,0] op_sel_hi:[0,1]
    v_pk_fma_f32 v[68:69], v[66:67], v[44:45], v[68:69] op_sel:[1,1,0] op_sel_hi:[1,0,1] neg_lo:[0,1,0]
    ds_write_addtid_b32 v28 offset:864
    v_cvt_pk_f16_f32 v29, v68, v69
    v_pk_mul_f32 v[66:67], v[68:69], v[44:45] op_sel:[0,0] op_sel_hi:[0,1]
    v_pk_fma_f32 v[66:67], v[68:69], v[44:45], v[66:67] op_sel:[1,1,0] op_sel_hi:[1,0,1] neg_lo:[0,1,0]
    s_waitcnt lgkmcnt(7)
    v_mfma_f32_16x16x32_f16 v[108:111], v[88:91], v[72:75], 0
    ds_write_addtid_b32 v29 offset:1152
    v_cvt_pk_f16_f32 v26, v66, v67
    v_pk_mul_f32 v[68:69], v[66:67], v[44:45] op_sel:[0,0] op_sel_hi:[0,1]
    v_pk_fma_f32 v[68:69], v[66:67], v[44:45], v[68:69] op_sel:[1,1,0] op_sel_hi:[1,0,1] neg_lo:[0,1,0]
    s_waitcnt lgkmcnt(7)
    v_mfma_f32_16x16x32_f16 v[108:111], v[92:95], v[76:79], v[108:111]
    ds_write_addtid_b32 v26 offset:1440
    v_cvt_pk_f16_f32 v27, v68, v69
    v_pk_mul_f32 v[66:67], v[68:69], v[44:45] op_sel:[0,0] op_sel_hi:[0,1]
    v_pk_fma_f32 v[66:67], v[68:69], v[44:45], v[66:67] op_sel:[1,1,0] op_sel_hi:[1,0,1] neg_lo:[0,1,0]
    s_waitcnt lgkmcnt(7)
    v_mfma_f32_16x16x32_f16 v[108:111], v[96:99], v[80:83], v[108:111]
    ds_write_addtid_b32 v27 offset:1728
    v_cvt_pk_f16_f32 v28, v66, v67
    v_pk_mul_f32 v[68:69], v[66:67], v[44:45] op_sel:[0,0] op_sel_hi:[0,1]
    v_pk_fma_f32 v[68:69], v[66:67], v[44:45], v[68:69] op_sel:[1,1,0] op_sel_hi:[1,0,1] neg_lo:[0,1,0]
    s_waitcnt lgkmcnt(7)
    v_mfma_f32_16x16x32_f16 v[108:111], v[100:103], v[84:87], v[108:111]
    ds_write_addtid_b32 v28 offset:2016
    v_cvt_pk_f16_f32 v29, v68, v69
    ds_write_addtid_b32 v29 offset:2304
    ds_read_b128 v[88:91], v7 offset:0
    ds_read_b128 v[92:95], v7 offset:64
    ds_read_b128 v[96:99], v7 offset:128
    ds_read_b128 v[100:103], v7 offset:192
    v_lshl_add_u32 v8, v2, 4, s15
    s_waitcnt lgkmcnt(3)
    v_mfma_f32_16x16x32_f16 v[112:115], v[88:91], v[72:75], 0
    s_waitcnt lgkmcnt(2)
    v_mfma_f32_16x16x32_f16 v[112:115], v[92:95], v[76:79], v[112:115]
    s_waitcnt lgkmcnt(1)
    v_mfma_f32_16x16x32_f16 v[112:115], v[96:99], v[80:83], v[112:115]
    s_waitcnt lgkmcnt(0)
    v_mfma_f32_16x16x32_f16 v[112:115], v[100:103], v[84:87], v[112:115]
    s_lshl_b32 s8, s12, 2
    s_add_u32 s8, s8, 16
    v_mov_b32 v9, s8
    s_cmp_eq_u32 s13, 0
    s_cbranch_scc1 C_KA
    ds_write_b128 v8, v[104:107] offset:0
    ds_write_b128 v8, v[108:111] offset:1024
    s_nop 0
    ds_write_b128 v8, v[112:115] offset:2048
    v_mov_b32 v10, s54
    ds_write_b32 v9, v10
    s_setprio 0
    v_and_b32 v14, 3, v3
    v_sub_u32 v14, 3, v14
    v_mul_u32_u24 v14, 1216, v14
    v_lshrrev_b32 v13, 2, v3
    v_lshl_add_u32 v13, v4, 1, v13
    v_lshl_add_u32 v14, v13, 3, v14
    v_add3_u32 v5, v14, s52, 8
    v_lshlrev_b32 v14, 1, v3
    v_sub_u32 v14, v4, v14
    v_lshlrev_b32 v14, 4, v14
    s_add_u32 s8, s53, 480
    v_add_u32 v6, s8, v14
    v_lshl_add_u32 v14, v3, 2, v4
    s_mul_i32 s8, s12, 4160
    s_add_u32 s8, s8, 83960
    v_lshlrev_b32 v14, 3, v14
    v_sub_u32 v7, s8, v14
    s_setprio 3
    s_mov_b32 s9, 0
SP_18:
    ds_read_b32 v10, v1 offset:80
    s_waitcnt lgkmcnt(0)
    v_readfirstlane_b32 s8, v10
    s_add_u32 s9, s9, 1
    s_cmp_ge_u32 s8, 1
    s_cbranch_scc1 SP_18_D
    s_sleep 1
    s_cmp_lt_u32 s9, 524288
    s_cbranch_scc1 SP_18
SP_18_D:
    s_setprio 3
    s_mov_b32 s9, 0
SP_19:
    ds_read_b32 v10, v9 offset:48
    s_waitcnt lgkmcnt(0)
    v_readfirstlane_b32 s8, v10
    s_add_u32 s9, s9, 1
    s_cmp_lg_u32 s8, 0
    s_cbranch_scc1 SP_19_D
    s_cmp_lt_u32 s9, 524288
    s_cbranch_scc1 SP_19
SP_19_D:
    s_setprio 2
    ds_read_b64 v[40:41], v5 offset:0
    ds_read_b64 v[42:43], v5 offset:8
    ds_read_b128 v[60:63], v6 offset:2048
    ds_read_b128 v[56:59], v6 offset:2560
    ds_read_b128 v[52:55], v6 offset:3072
    ds_read_b128 v[48:51], v6 offset:3584
    ds_read_b64 v[44:45], v5 offset:512
    ds_read_b64 v[46:47], v5 offset:520
    s_waitcnt lgkmcnt(5)
    v_mfma_f32_16x16x32_bf16 v[28:31], v[40:43], v[60:63], 0
    ds_read_b64 v[68:69], v5 offset:64
    ds_read_b64 v[70:71], v5 offset:72
    s_waitcnt lgkmcnt(6)
    v_mfma_f32_16x16x32_bf16 v[24:27], v[40:43], v[56:59], 0
    ds_read_b128 v[88:91], v6 offset:2112
    s_waitcnt lgkmcnt(6)
    v_mfma_f32_16x16x32_bf16 v[20:23], v[40:43], v[52:55], 0
    ds_read_b128 v[84:87], v6 offset:2624
    s_waitcnt lgkmcnt(6)
    v_mfma_f32_16x16x32_bf16 v[16:19], v[40:43], v[48:51], 0
    ds_read_b128 v[80:83], v6 offset:3136
    s_waitcnt lgkmcnt(5)
    v_mfma_f32_16x16x32_bf16 v[28:31], v[44:47], v[56:59], v[28:31]
    ds_read_b128 v[76:79], v6 offset:3648
    v_mfma_f32_16x16x32_bf16 v[24:27], v[44:47], v[52:55], v[24:27]
    ds_read_b64 v[72:73], v5 offset:576
    v_mfma_f32_16x16x32_bf16 v[20:23], v[44:47], v[48:51], v[20:23]
    ds_read_b64 v[74:75], v5 offset:584
    s_waitcnt lgkmcnt(3)
    v_mfma_f32_16x16x32_bf16 v[28:31], v[68:71], v[88:91], v[28:31]
    ds_read_b64 v[40:41], v5 offset:128
    ds_read_b64 v[42:43], v5 offset:136
    v_mfma_f32_16x16x32_bf16 v[24:27], v[68:71], v[84:87], v[24:27]
    ds_read_b128 v[60:63], v6 offset:2176
    v_mfma_f32_16x16x32_bf16 v[20:23], v[68:71], v[80:83], v[20:23]
    ds_read_b128 v[56:59], v6 offset:2688
    s_waitcnt lgkmcnt(4)
    v_mfma_f32_16x16x32_bf16 v[16:19], v[68:71], v[76:79], v[16:19]
    ds_read_b128 v[52:55], v6 offset:3200
    v_mfma_f32_16x16x32_bf16 v[28:31], v[72:75], v[84:87], v[28:31]
    ds_read_b128 v[48:51], v6 offset:3712
    v_mfma_f32_16x16x32_bf16 v[24:27], v[72:75], v[80:83], v[24:27]
    ds_read_b64 v[44:45], v5 offset:640
    v_mfma_f32_16x16x32_bf16 v[20:23], v[72:75], v[76:79], v[20:23]
    ds_read_b64 v[46:47], v5 offset:648
    s_waitcnt lgkmcnt(3)
    v_mfma_f32_16x16x32_bf16 v[28:31], v[40:43], v[60:63], v[28:31]
    ds_read_b64 v[68:69], v5 offset:192
    ds_read_b64 v[70:71], v5 offset:200
    v_mfma_f32_16x16x32_bf16 v[24:27], v[40:43], v[56:59], v[24:27]
    ds_read_b128 v[88:91], v6 offset:2240
    v_mfma_f32_16x16x32_bf16 v[20:23], v[40:43], v[52:55], v[20:23]
    ds_read_b128 v[84:87], v6 offset:2752
    s_waitcnt lgkmcnt(4)
    v_mfma_f32_16x16x32_bf16 v[16:19], v[40:43], v[48:51], v[16:19]
    ds_read_b128 v[80:83], v6 offset:3264
    v_mfma_f32_16x16x32_bf16 v[28:31], v[44:47], v[56:59], v[28:31]
    ds_read_b128 v[76:79], v6 offset:3776
    v_mfma_f32_16x16x32_bf16 v[24:27], v[44:47], v[52:55], v[24:27]
    ds_read_b64 v[72:73], v5 offset:704
    v_mfma_f32_16x16x32_bf16 v[20:23], v[44:47], v[48:51], v[20:23]
    ds_read_b64 v[74:75], v5 offset:712
    s_waitcnt lgkmcnt(3)
    v_mfma_f32_16x16x32_bf16 v[28:31], v[68:71], v[88:91], v[28:31]
    ds_read_b64 v[40:41], v5 offset:256
    ds_read_b64 v[42:43], v5 offset:264
    v_mfma_f32_16x16x32_bf16 v[24:27], v[68:71], v[84:87], v[24:27]
    ds_read_b128 v[60:63], v6 offset:2304
    v_mfma_f32_16x16x32_bf16 v[20:23], v[68:71], v[80:83], v[20:23]
    ds_read_b128 v[56:59], v6 offset:2816
    s_waitcnt lgkmcnt(4)
    v_mfma_f32_16x16x32_bf16 v[16:19], v[68:71], v[76:79], v[16:19]
    ds_read_b128 v[52:55], v6 offset:3328
    v_mfma_f32_16x16x32_bf16 v[28:31], v[72:75], v[84:87], v[28:31]
    ds_read_b128 v[48:51], v6 offset:3840
    v_mfma_f32_16x16x32_bf16 v[24:27], v[72:75], v[80:83], v[24:27]
    ds_read_b64 v[44:45], v5 offset:768
    v_mfma_f32_16x16x32_bf16 v[20:23], v[72:75], v[76:79], v[20:23]
    ds_read_b64 v[46:47], v5 offset:776
    s_waitcnt lgkmcnt(3)
    v_mfma_f32_16x16x32_bf16 v[28:31], v[40:43], v[60:63], v[28:31]
    ds_read_b64 v[68:69], v5 offset:320
    ds_read_b64 v[70:71], v5 offset:328
    v_mfma_f32_16x16x32_bf16 v[24:27], v[40:43], v[56:59], v[24:27]
    ds_read_b128 v[88:91], v6 offset:2368
    v_mfma_f32_16x16x32_bf16 v[20:23], v[40:43], v[52:55], v[20:23]
    ds_read_b128 v[84:87], v6 offset:2880
    s_waitcnt lgkmcnt(4)
    v_mfma_f32_16x16x32_bf16 v[16:19], v[40:43], v[48:51], v[16:19]
    ds_read_b128 v[80:83], v6 offset:3392
    v_mfma_f32_16x16x32_bf16 v[28:31], v[44:47], v[56:59], v[28:31]
    ds_read_b128 v[76:79], v6 offset:3904
    v_mfma_f32_16x16x32_bf16 v[24:27], v[44:47], v[52:55], v[24:27]
    ds_read_b64 v[72:73], v5 offset:832
    v_mfma_f32_16x16x32_bf16 v[20:23], v[44:47], v[48:51], v[20:23]
    ds_read_b64 v[74:75], v5 offset:840
    s_waitcnt lgkmcnt(3)
    v_mfma_f32_16x16x32_bf16 v[28:31], v[68:71], v[88:91], v[28:31]
    ds_read_b64 v[40:41], v5 offset:384
    ds_read_b64 v[42:43], v5 offset:392
    v_mfma_f32_16x16x32_bf16 v[24:27], v[68:71], v[84:87], v[24:27]
    ds_read_b128 v[60:63], v6 offset:2432
    v_mfma_f32_16x16x32_bf16 v[20:23], v[68:71], v[80:83], v[20:23]
    ds_read_b128 v[56:59], v6 offset:2944
    s_waitcnt lgkmcnt(4)
    v_mfma_f32_16x16x32_bf16 v[16:19], v[68:71], v[76:79], v[16:19]
    ds_read_b128 v[52:55], v6 offset:3456
    v_mfma_f32_16x16x32_bf16 v[28:31], v[72:75], v[84:87], v[28:31]
    ds_read_b128 v[48:51], v6 offset:3968
    v_mfma_f32_16x16x32_bf16 v[24:27], v[72:75], v[80:83], v[24:27]
    ds_read_b64 v[44:45], v5 offset:896
    v_mfma_f32_16x16x32_bf16 v[20:23], v[72:75], v[76:79], v[20:23]
    ds_read_b64 v[46:47], v5 offset:904
    s_waitcnt lgkmcnt(3)
    v_mfma_f32_16x16x32_bf16 v[28:31], v[40:43], v[60:63], v[28:31]
    ds_read_b64 v[68:69], v5 offset:448
    ds_read_b64 v[70:71], v5 offset:456
    v_mfma_f32_16x16x32_bf16 v[24:27], v[40:43], v[56:59], v[24:27]
    ds_read_b128 v[88:91], v6 offset:2496
    v_mfma_f32_16x16x32_bf16 v[20:23], v[40:43], v[52:55], v[20:23]
    ds_read_b128 v[84:87], v6 offset:3008
    s_waitcnt lgkmcnt(4)
    v_mfma_f32_16x16x32_bf16 v[16:19], v[40:43], v[48:51], v[16:19]
    ds_read_b128 v[80:83], v6 offset:3520
    v_mfma_f32_16x16x32_bf16 v[28:31], v[44:47], v[56:59], v[28:31]
    ds_read_b128 v[76:79], v6 offset:4032
    v_mfma_f32_16x16x32_bf16 v[24:27], v[44:47], v[52:55], v[24:27]
    ds_read_b64 v[72:73], v5 offset:960
    v_mfma_f32_16x16x32_bf16 v[20:23], v[44:47], v[48:51], v[20:23]
    ds_read_b64 v[74:75], v5 offset:968
    s_waitcnt lgkmcnt(3)
    v_mfma_f32_16x16x32_bf16 v[28:31], v[68:71], v[88:91], v[28:31]
    v_mfma_f32_16x16x32_bf16 v[24:27], v[68:71], v[84:87], v[24:27]
    v_mfma_f32_16x16x32_bf16 v[20:23], v[68:71], v[80:83], v[20:23]
    s_waitcnt lgkmcnt(0)
    v_mfma_f32_16x16x32_bf16 v[16:19], v[68:71], v[76:79], v[16:19]
    v_mfma_f32_16x16x32_bf16 v[28:31], v[72:75], v[84:87], v[28:31]
    v_mfma_f32_16x16x32_bf16 v[24:27], v[72:75], v[80:83], v[24:27]
    v_mfma_f32_16x16x32_bf16 v[20:23], v[72:75], v[76:79], v[20:23]
    s_setprio 3
    v_subrev_u32 v8, 18432, v8
    s_mov_b32 s9, 0
SP_20:
    ds_read_b32 v10, v9 offset:32
    s_waitcnt lgkmcnt(0)
    v_readfirstlane_b32 s8, v10
    s_add_u32 s9, s9, 1
    s_cmp_ge_u32 s8, 1
    s_cbranch_scc1 SP_20_D
    s_cmp_lt_u32 s9, 524288
    s_cbranch_scc1 SP_20
SP_20_D:
    ds_read_b128 v[40:43], v8 offset:0
    ds_read_b128 v[44:47], v8 offset:1024
    s_waitcnt lgkmcnt(1)
    v_add_f32 v24, v24, v40
    v_add_f32 v25, v25, v41
    v_add_f32 v26, v26, v42
    v_add_f32 v27, v27, v43
    s_waitcnt lgkmcnt(0)
    v_add_f32 v28, v28, v44
    v_add_f32 v29, v29, v45
    v_add_f32 v30, v30, v46
    v_add_f32 v31, v31, v47
    v_cvt_pk_bf16_f32 v96, v19, v18
    v_cvt_pk_bf16_f32 v97, v17, v16
    ds_write_b64 v7, v[96:97] offset:3584
    v_cvt_pk_bf16_f32 v98, v23, v22
    v_cvt_pk_bf16_f32 v99, v21, v20
    ds_write_b64 v7, v[98:99] offset:3072
    v_cvt_pk_bf16_f32 v100, v27, v26
    v_cvt_pk_bf16_f32 v101, v25, v24
    ds_write_b64 v7, v[100:101] offset:2560
    v_cvt_pk_bf16_f32 v102, v31, v30
    v_cvt_pk_bf16_f32 v103, v29, v28
    ds_write_b64 v7, v[102:103] offset:2048
    v_mov_b32 v12, 1
    s_mov_b64 exec, 1
    ds_add_u32 v1, v12 offset:96
    s_mov_b64 exec, -1
    s_setprio 3
    s_mov_b32 s9, 0
SP_21:
    ds_read_b32 v10, v1 offset:84
    s_waitcnt lgkmcnt(0)
    v_readfirstlane_b32 s8, v10
    s_add_u32 s9, s9, 1
    s_cmp_ge_u32 s8, 1
    s_cbranch_scc1 SP_21_D
    s_sleep 1
    s_cmp_lt_u32 s9, 524288
    s_cbranch_scc1 SP_21
SP_21_D:
    s_setprio 2
    ds_read_b64 v[40:41], v5 offset:0
    ds_read_b64 v[42:43], v5 offset:8
    ds_read_b128 v[48:51], v6 offset:1024
    ds_read_b128 v[64:67], v6 offset:1536
    ds_read_b64 v[44:45], v5 offset:512
    ds_read_b64 v[46:47], v5 offset:520
    ds_read_b128 v[60:63], v6 offset:2048
    s_waitcnt lgkmcnt(4)
    v_mfma_f32_16x16x32_bf16 v[36:39], v[40:43], v[48:51], 0
    ds_read_b64 v[68:69], v5 offset:64
    ds_read_b64 v[70:71], v5 offset:72
    s_waitcnt lgkmcnt(5)
    v_mfma_f32_16x16x32_bf16 v[32:35], v[40:43], v[64:67], 0
    ds_read_b128 v[76:79], v6 offset:1088
    ds_read_b128 v[92:95], v6 offset:1600
    s_waitcnt lgkmcnt(5)
    v_mfma_f32_16x16x32_bf16 v[36:39], v[44:47], v[64:67], v[36:39]
    ds_read_b64 v[72:73], v5 offset:576
    ds_read_b64 v[74:75], v5 offset:584
    s_waitcnt lgkmcnt(6)
    v_mfma_f32_16x16x32_bf16 v[32:35], v[44:47], v[60:63], v[32:35]
    ds_read_b128 v[88:91], v6 offset:2112
    s_waitcnt lgkmcnt(3)
    v_mfma_f32_16x16x32_bf16 v[36:39], v[68:71], v[76:79], v[36:39]
    ds_read_b64 v[40:41], v5 offset:128
    ds_read_b64 v[42:43], v5 offset:136
    v_mfma_f32_16x16x32_bf16 v[32:35], v[68:71], v[92:95], v[32:35]
    ds_read_b128 v[48:51], v6 offset:1152
    ds_read_b128 v[64:67], v6 offset:1664
    s_waitcnt lgkmcnt(4)
    v_mfma_f32_16x16x32_bf16 v[36:39], v[72:75], v[92:95], v[36:39]
    ds_read_b64 v[44:45], v5 offset:640
    ds_read_b64 v[46:47], v5 offset:648
    v_mfma_f32_16x16x32_bf16 v[32:35], v[72:75], v[88:91], v[32:35]
    ds_read_b128 v[60:63], v6 offset:2176
    s_waitcnt lgkmcnt(3)
    v_mfma_f32_16x16x32_bf16 v[36:39], v[40:43], v[48:51], v[36:39]
    ds_read_b64 v[68:69], v5 offset:192
    ds_read_b64 v[70:71], v5 offset:200
    v_mfma_f32_16x16x32_bf16 v[32:35], v[40:43], v[64:67], v[32:35]
    ds_read_b128 v[76:79], v6 offset:1216
    ds_read_b128 v[92:95], v6 offset:1728
    s_waitcnt lgkmcnt(4)
    v_mfma_f32_16x16x32_bf16 v[36:39], v[44:47], v[64:67], v[36:39]
    ds_read_b64 v[72:73], v5 offset:704
    ds_read_b64 v[74:75], v5 offset:712
    v_mfma_f32_16x16x32_bf16 v[32:35], v[44:47], v[60:63], v[32:35]
    ds_read_b128 v[88:91], v6 offset:2240
    s_waitcnt lgkmcnt(3)
    v_mfma_f32_16x16x32_bf16 v[36:39], v[68:71], v[76:79], v[36:39]
    ds_read_b64 v[40:41], v5 offset:256
    ds_read_b64 v[42:43], v5 offset:264
    v_mfma_f32_16x16x32_bf16 v[32:35], v[68:71], v[92:95], v[32:35]
    ds_read_b128 v[48:51], v6 offset:1280
    ds_read_b128 v[64:67], v6 offset:1792
    s_waitcnt lgkmcnt(4)
    v_mfma_f32_16x16x32_bf16 v[36:39], v[72:75], v[92:95], v[36:39]
    ds_read_b64 v[44:45], v5 offset:768
    ds_read_b64 v[46:47], v5 offset:776
    v_mfma_f32_16x16x32_bf16 v[32:35], v[72:75], v[88:91], v[32:35]
    ds_read_b128 v[60:63], v6 offset:2304
    s_waitcnt lgkmcnt(3)
    v_mfma_f32_16x16x32_bf16 v[36:39], v[40:43], v[48:51], v[36:39]
    ds_read_b64 v[68:69], v5 offset:320
    ds_read_b64 v[70:71], v5 offset:328
    v_mfma_f32_16x16x32_bf16 v[32:35], v[40:43], v[64:67], v[32:35]
    ds_read_b128 v[76:79], v6 offset:1344
    ds_read_b128 v[92:95], v6 offset:1856
    s_waitcnt lgkmcnt(4)
    v_mfma_f32_16x16x32_bf16 v[36:39], v[44:47], v[64:67], v[36:39]
    ds_read_b64 v[72:73], v5 offset:832
    ds_read_b64 v[74:75], v5 offset:840
    v_mfma_f32_16x16x32_bf16 v[32:35], v[44:47], v[60:63], v[32:35]
    ds_read_b128 v[88:91], v6 offset:2368
    s_waitcnt lgkmcnt(3)
    v_mfma_f32_16x16x32_bf16 v[36:39], v[68:71], v[76:79], v[36:39]
    ds_read_b64 v[40:41], v5 offset:384
    ds_read_b64 v[42:43], v5 offset:392
    v_mfma_f32_16x16x32_bf16 v[32:35], v[68:71], v[92:95], v[32:35]
    ds_read_b128 v[48:51], v6 offset:1408
    ds_read_b128 v[64:67], v6 offset:1920
    s_waitcnt lgkmcnt(4)
    v_mfma_f32_16x16x32_bf16 v[36:39], v[72:75], v[92:95], v[36:39]
    ds_read_b64 v[44:45], v5 offset:896
    ds_read_b64 v[46:47], v5 offset:904
    v_mfma_f32_16x16x32_bf16 v[32:35], v[72:75], v[88:91], v[32:35]
    ds_read_b128 v[60:63], v6 offset:2432
    s_waitcnt lgkmcnt(3)
    v_mfma_f32_16x16x32_bf16 v[36:39], v[40:43], v[48:51], v[36:39]
    ds_read_b64 v[68:69], v5 offset:448
    ds_read_b64 v[70:71], v5 offset:456
    v_mfma_f32_16x16x32_bf16 v[32:35], v[40:43], v[64:67], v[32:35]
    ds_read_b128 v[76:79], v6 offset:1472
    ds_read_b128 v[92:95], v6 offset:1984
    s_waitcnt lgkmcnt(4)
    v_mfma_f32_16x16x32_bf16 v[36:39], v[44:47], v[64:67], v[36:39]
    ds_read_b64 v[72:73], v5 offset:960
    ds_read_b64 v[74:75], v5 offset:968
    v_mfma_f32_16x16x32_bf16 v[32:35], v[44:47], v[60:63], v[32:35]
    ds_read_b128 v[88:91], v6 offset:2496
    s_waitcnt lgkmcnt(3)
    v_mfma_f32_16x16x32_bf16 v[36:39], v[68:71], v[76:79], v[36:39]
    v_mfma_f32_16x16x32_bf16 v[32:35], v[68:71], v[92:95], v[32:35]
    s_waitcnt lgkmcnt(0)
    v_mfma_f32_16x16x32_bf16 v[36:39], v[72:75], v[92:95], v[36:39]
    v_mfma_f32_16x16x32_bf16 v[32:35], v[72:75], v[88:91], v[32:35]
    s_setprio 3
    s_mov_b32 s9, 0
SP_22:
    ds_read_b32 v10, v9 offset:32
    s_waitcnt lgkmcnt(0)
    v_readfirstlane_b32 s8, v10
    s_add_u32 s9, s9, 1
    s_cmp_ge_u32 s8, 2
    s_cbranch_scc1 SP_22_D
    s_cmp_lt_u32 s9, 524288
    s_cbranch_scc1 SP_22
SP_22_D:
    ds_read_b128 v[40:43], v8 offset:2048
    ds_read_b128 v[44:47], v8 offset:3072
    s_waitcnt lgkmcnt(1)
    v_add_f32 v32, v32, v40
    v_add_f32 v33, v33, v41
    v_add_f32 v34, v34, v42
    v_add_f32 v35, v35, v43
    s_waitcnt lgkmcnt(0)
    v_add_f32 v36, v36, v44
    v_add_f32 v37, v37, v45
    v_add_f32 v38, v38, v46
    v_add_f32 v39, v39, v47
    v_cvt_pk_bf16_f32 v96, v35, v34
    v_cvt_pk_bf16_f32 v97, v33, v32
    ds_write_b64 v7, v[96:97] offset:1536
    v_cvt_pk_bf16_f32 v98, v39, v38
    v_cvt_pk_bf16_f32 v99, v37, v36
    ds_write_b64 v7, v[98:99] offset:1024
    v_mov_b32 v12, 1
    s_mov_b64 exec, 1
    ds_add_u32 v1, v12 offset:100
    s_mov_b64 exec, -1
    ds_read_b32 v10, v1 offset:8
    s_cmp_eq_u32 s3, 4
    s_cbranch_scc1 C_FIN
    s_endpgm
C_KA:
    s_setprio 1
    v_lshrrev_b32 v116, 1, v4
    v_and_b32 v117, 1, v4
    v_lshlrev_b32 v116, 8, v116
    v_lshl_add_u32 v116, v117, 3, v116
    v_lshl_add_u32 v116, v3, 4, v116
    v_add_u32 v116, s15, v116
    v_cmp_gt_u32 vcc, 2, v4
    v_lshlrev_b32 v117, 2, v3
    v_lshlrev_b32 v118, 3, v3
    v_cndmask_b32 v117, v117, v118, vcc
    v_lshl_add_u32 v117, v4, 7, v117
    v_add_u32 v117, s15, v117
    v_mov_b32 v118, 64
    v_cndmask_b32 v118, v118, 4, vcc
    v_add_u32 v118, v118, v117
    v_lshlrev_b32 v119, 1, v3
    v_lshl_add_u32 v119, v4, 7, v119
    v_add_u32 v119, s15, v119
    v_lshlrev_b32 v120, 4, v2
    v_lshlrev_b32 v121, 3, v2
    v_add_u32 v121, 256, v121
    v_min_u32 v120, v120, v121
    v_add_u32 v120, s15, v120
    v_min_u32 v121, 15, v2
    v_lshl_add_u32 v121, v121, 2, s15
    v_lshrrev_b32 v124, 5, v2
    v_lshlrev_b32 v124, 8, v124
    v_lshl_add_u32 v124, v2, 2, v124
    v_add_u32 v124, s15, v124
    v_lshlrev_b32 v122, 2, v4
    v_sub_u32 v122, v3, v122
    v_lshl_add_u32 v125, v122, 3, s15
    v_add_u32 v125, 3176, v125
    v_lshl_add_u32 v122, v122, 2, s15
    v_add_u32 v122, 2100, v122
    v_lshl_add_u32 v123, v2, 4, s52
    s_mov_b32 s56, 0x01000100
    s_mov_b32 s57, 0x03020302
    v_and_b32 v14, 3, v3
    v_sub_u32 v14, 3, v14
    v_mul_u32_u24 v14, 1216, v14
    v_lshrrev_b32 v13, 2, v3
    v_lshl_add_u32 v13, v4, 1, v13
    v_lshl_add_u32 v14, v13, 3, v14
    v_add3_u32 v5, v14, s52, 8
    v_lshlrev_b32 v14, 1, v3
    v_sub_u32 v14, v4, v14
    v_lshlrev_b32 v14, 4, v14
    s_add_u32 s8, s53, 480
    v_add_u32 v6, s8, v14
    v_lshl_add_u32 v14, v3, 2, v4
    s_mul_i32 s8, s12, 4160
    s_add_u32 s8, s8, 83960
    v_lshlrev_b32 v14, 3, v14
    v_sub_u32 v7, s8, v14
    s_lshl_b32 s8, s12, 4
    s_lshr_b64 s[68:69], s[68:69], s8
    s_lshl_b32 s68, s68, 16
    s_sub_u32 s58, 254, s54
    s_lshl_b32 s58, s58, 23
    v_mul_f32 v104, s58, v104
    v_mul_f32 v105, s58, v105
    v_mul_f32 v106, s58, v106
    v_mul_f32 v107, s58, v107
    v_mul_f32 v108, s58, v108
    v_mul_f32 v109, s58, v109
    v_mul_f32 v110, s58, v110
    v_mul_f32 v111, s58, v111
    v_mul_f32 v112, s58, v112
    v_mul_f32 v113, s58, v113
    v_mul_f32 v114, s58, v114
    v_mul_f32 v115, s58, v115
    s_mov_b64 exec, 1
    v_add_f32 v104, s68, v104
    s_mov_b64 exec, -1
    s_setprio 0
    s_mov_b32 s9, 0
SP_23:
    ds_read_b32 v18, v9
    s_waitcnt lgkmcnt(0)
    v_readfirstlane_b32 s8, v18
    s_add_u32 s9, s9, 1
    s_cmp_lg_u32 s8, 0
    s_cbranch_scc1 SP_23_D
    s_cmp_lt_u32 s9, 524288
    s_cbranch_scc1 SP_23
SP_23_D:
    s_setprio 2
    s_sub_u32 s60, 254, s8
    s_lshl_b32 s60, s60, 23
    ds_read_b128 v[88:91], v8 offset:18432
    ds_read_b128 v[92:95], v8 offset:19456
    ds_read_b128 v[96:99], v8 offset:20480
    s_waitcnt lgkmcnt(2)
    v_pk_fma_f32 v[104:105], v[88:89], s[60:61], v[104:105] op_sel_hi:[1,0,1]
    v_cvt_pk_bf16_f32 v20, v104, v105
    v_pk_fma_f32 v[106:107], v[90:91], s[60:61], v[106:107] op_sel_hi:[1,0,1]
    v_cvt_pk_bf16_f32 v21, v106, v107
    ds_write_b64 v116, v[20:21]
    s_waitcnt lgkmcnt(2)
    v_pk_fma_f32 v[108:109], v[92:93], s[60:61], v[108:109] op_sel_hi:[1,0,1]
    v_cvt_pk_bf16_f32 v22, v108, v109
    v_pk_fma_f32 v[110:111], v[94:95], s[60:61], v[110:111] op_sel_hi:[1,0,1]
    v_cvt_pk_bf16_f32 v23, v110, v111
    ds_write_b32 v117, v22 offset:512
    ds_write_b32 v118, v23 offset:512
    ds_read_b64 v[32:33], v120 offset:0
    ds_read_b64 v[34:35], v120 offset:8
    s_waitcnt lgkmcnt(5)
    v_pk_fma_f32 v[112:113], v[96:97], s[60:61], v[112:113] op_sel_hi:[1,0,1]
    v_cvt_pk_bf16_f32 v24, v112, v113
    v_pk_fma_f32 v[114:115], v[98:99], s[60:61], v[114:115] op_sel_hi:[1,0,1]
    v_cvt_pk_bf16_f32 v25, v114, v115
    s_mov_b32 exec_lo, 0
    s_waitcnt lgkmcnt(0)
    v_alignbit_b32 v35, v34, v33, 16
    v_perm_b32 v34, v33, v33, s56
    v_alignbit_b32 v33, v33, v32, 16
    v_perm_b32 v32, v32, v32, s56
    s_mov_b32 exec_lo, -1
    ds_write_b128 v123, v[32:35] offset:32
    v_mov_b32_dpp v30, v34 wave_shr:1 row_mask:0xf bank_mask:0xf bound_ctrl:0
    v_mov_b32_dpp v31, v35 wave_shr:1 row_mask:0xf bank_mask:0xf bound_ctrl:0
    v_alignbit_b32 v44, v32, v31, 16
    v_alignbit_b32 v45, v33, v32, 16
    v_alignbit_b32 v46, v34, v33, 16
    v_alignbit_b32 v47, v35, v34, 16
    ds_write_b128 v123, v[44:47] offset:1248
    v_mov_b32 v52, v31
    v_mov_b32 v53, v32
    v_mov_b32 v54, v33
    v_mov_b32 v55, v34
    ds_write_b128 v123, v[52:55] offset:2464
    v_alignbit_b32 v60, v31, v30, 16
    v_alignbit_b32 v61, v32, v31, 16
    v_alignbit_b32 v62, v33, v32, 16
    v_alignbit_b32 v63, v34, v33, 16
    ds_write_b128 v123, v[60:63] offset:3680
    v_mov_b32 v10, 1
    ds_write_b32 v9, v10 offset:48
    s_setprio 3
    s_mov_b32 exec_lo, 0
    ds_write_b16 v117, v22 offset:2942
    ds_write_b16_d16_hi v117, v22 offset:2944
    ds_write_b16 v118, v23 offset:2942
    ds_write_b16_d16_hi v118, v23 offset:2944
    s_mov_b64 exec, 1
    ds_write_b16 v119, v24 offset:3454
    s_mov_b64 exec, -1
    ds_write_b32 v124, v1 offset:3072
    ds_write_b16 v119, v24 offset:2110
    ds_write_b16_d16_hi v119, v24 offset:2142
    ds_write_b16 v119, v25 offset:2174
    ds_write_b16_d16_hi v119, v25 offset:2206
    ds_write_b32 v121, v1 offset:2048
    ds_read2_b32 v[128:129], v125 offset0:6 offset1:4
    ds_read2_b32 v[130:131], v125 offset0:2 offset1:0
    ds_read2_b32 v[132:133], v125 offset0:7 offset1:5
    ds_read2_b32 v[134:135], v125 offset0:3 offset1:1
    ds_read2_b32 v[136:137], v125 offset0:38 offset1:36
    ds_read2_b32 v[138:139], v125 offset0:34 offset1:32
    ds_read2_b32 v[140:141], v125 offset0:39 offset1:37
    ds_read2_b32 v[142:143], v125 offset0:35 offset1:33
    ds_read2_b32 v[144:145], v125 offset0:70 offset1:68
    ds_read2_b32 v[146:147], v125 offset0:66 offset1:64
    ds_read2_b32 v[148:149], v125 offset0:71 offset1:69
    ds_read2_b32 v[150:151], v125 offset0:67 offset1:65
    ds_read2_b32 v[152:153], v122 offset0:3 offset1:2
    ds_read2_b32 v[154:155], v122 offset0:1 offset1:0
    ds_read2_b32 v[156:157], v122 offset0:19 offset1:18
    ds_read2_b32 v[158:159], v122 offset0:17 offset1:16
    ds_read2_b32 v[160:161], v122 offset0:35 offset1:34
    ds_read2_b32 v[162:163], v122 offset0:33 offset1:32
    ds_read2_b32 v[164:165], v122 offset0:51 offset1:50
    ds_read2_b32 v[166:167], v122 offset0:49 offset1:48
    v_readlane_b32 s59, v24, 0
    v_perm_b32 v73, v35, v35, s57
    v_alignbit_b32 v72, v35, v34, 16
    v_lshrrev_b32 v78, 16, v35
    v_mov_b32 v76, v35
    v_mov_b32 v74, v73
    v_mov_b32 v77, v73
    v_mov_b32 v80, v73
    v_mov_b32 v81, v73
    v_mov_b32 v84, v73
    v_mov_b32 v85, v78
    v_mov_b32 v75, 0
    v_mov_b32 v79, 0
    v_mov_b32 v82, 0
    v_mov_b32 v83, 0
    v_mov_b32 v86, 0
    v_mov_b32 v87, 0
    s_pack_ll_b32_b16 s59, s59, s59
    s_mov_b32 exec_lo, 0
    s_mov_b32 exec_hi, 0x80000000
    ds_write_b128 v123, v[84:87] offset:48
    ds_write_b128 v123, v[80:83] offset:1264
    ds_write_b128 v123, v[76:79] offset:2480
    ds_write_b128 v123, v[72:75] offset:3696
    s_mov_b64 exec, -1
    v_lshlrev_b32 v11, 4, v2
    v_add_u32 v11, 100096, v11
    s_mov_b32 s9, 0
SP_24:
    ds_read_b32 v10, v1 offset:12
    s_waitcnt lgkmcnt(0)
    v_readfirstlane_b32 s8, v10
    s_add_u32 s9, s9, 1
    s_cmp_ge_u32 s8, 2
    s_cbranch_scc1 SP_24_D
    s_cmp_lt_u32 s9, 524288
    s_cbranch_scc1 SP_24
SP_24_D:
    ds_read_b128 v[104:107], v11 offset:0
    ds_read_b128 v[108:111], v11 offset:1024
    ds_read_b128 v[112:115], v11 offset:2048
    ds_read_b128 v[116:119], v11 offset:3072
    ds_read_b128 v[124:127], v11 offset:4096
    s_mov_b32 s9, 0
SP_25:
    ds_read_b32 v10, v1 offset:80
    s_waitcnt lgkmcnt(0)
    v_readfirstlane_b32 s8, v10
    s_add_u32 s9, s9, 1
    s_cmp_ge_u32 s8, 1
    s_cbranch_scc1 SP_25_D
    s_sleep 1
    s_cmp_lt_u32 s9, 524288
    s_cbranch_scc1 SP_25
SP_25_D:
    s_setprio 3
    ds_read_b128 v[40:43], v6 offset:3584
    ds_read_b128 v[44:47], v6 offset:3600
    ds_read_b128 v[48:51], v6 offset:3072
    ds_read_b128 v[52:55], v6 offset:3088
    ds_read_b64 v[120:121], v5 offset:1024
    ds_read_b64 v[122:123], v5 offset:1032
    v_and_b32 v124, s59, v124
    v_and_b32 v125, s59, v125
    v_and_b32 v126, s59, v126
    v_and_b32 v127, s59, v127
    s_waitcnt lgkmcnt(5)
    v_mfma_f32_16x16x32_bf16 v[56:59], v[40:43], v[112:115], 0
    v_mfma_f32_16x16x32_bf16 v[60:63], v[40:43], v[116:119], 0
    s_waitcnt lgkmcnt(4)
    v_mfma_f32_16x16x32_bf16 v[64:67], v[44:47], v[112:115], 0
    v_mfma_f32_16x16x32_bf16 v[68:71], v[44:47], v[116:119], 0
    s_waitcnt lgkmcnt(0)
    v_mfma_f32_16x16x32_bf16 v[16:19], v[120:123], v[40:43], 0
    v_mfma_f32_16x16x32_bf16 v[80:83], v[48:51], v[112:115], 0
    s_nop 1
    v_cvt_pk_bf16_f32 v56, v56, v60
    v_cvt_pk_bf16_f32 v57, v57, v61
    v_mfma_f32_16x16x32_bf16 v[84:87], v[48:51], v[116:119], 0
    v_cvt_pk_bf16_f32 v58, v58, v62
    v_cvt_pk_bf16_f32 v59, v59, v63
    v_mfma_f32_16x16x32_bf16 v[88:91], v[52:55], v[112:115], 0
    v_cvt_pk_bf16_f32 v64, v64, v68
    v_cvt_pk_bf16_f32 v65, v65, v69
    v_mfma_f32_16x16x32_bf16 v[92:95], v[52:55], v[116:119], 0
    v_cvt_pk_bf16_f32 v66, v66, v70
    v_cvt_pk_bf16_f32 v67, v67, v71
    v_mfma_f32_16x16x32_bf16 v[20:23], v[120:123], v[48:51], 0
    v_mfma_f32_16x16x32_bf16 v[16:19], v[56:59], v[128:131], v[16:19]
    v_cvt_pk_bf16_f32 v80, v80, v84
    v_cvt_pk_bf16_f32 v81, v81, v85
    v_mfma_f32_16x16x32_bf16 v[16:19], v[64:67], v[132:135], v[16:19]
    v_cvt_pk_bf16_f32 v82, v82, v86
    v_cvt_pk_bf16_f32 v83, v83, v87
    v_mfma_f32_16x16x32_bf16 v[20:23], v[56:59], v[136:139], v[20:23]
    v_cvt_pk_bf16_f32 v88, v88, v92
    v_cvt_pk_bf16_f32 v89, v89, v93
    v_mfma_f32_16x16x32_bf16 v[20:23], v[64:67], v[140:143], v[20:23]
    v_cvt_pk_bf16_f32 v90, v90, v94
    v_cvt_pk_bf16_f32 v91, v91, v95
    v_mfma_f32_16x16x32_bf16 v[20:23], v[80:83], v[128:131], v[20:23]
    s_nop 0
    v_mfma_f32_16x16x32_bf16 v[20:23], v[88:91], v[132:135], v[20:23]
    v_mfma_f32_16x16x32_bf16 v[72:75], v[40:43], v[104:107], 0
    v_mfma_f32_16x16x32_bf16 v[76:79], v[44:47], v[108:111], 0
    v_mfma_f32_16x16x32_bf16 v[24:27], v[124:127], v[40:43], 0
    ds_write_b128 v8, v[16:19] offset:0
    s_nop 3
    ds_write_b128 v8, v[20:23] offset:1024
    v_mov_b32 v10, 1
    ds_write_b32 v9, v10 offset:32
    s_setprio 1
    v_mfma_f32_16x16x32_bf16 v[96:99], v[48:51], v[104:107], 0
    ds_read_b128 v[40:43], v6 offset:2560
    ds_read_b128 v[44:47], v6 offset:2576
    v_mfma_f32_16x16x32_bf16 v[100:103], v[52:55], v[108:111], 0
    v_cvt_pk_bf16_f32 v72, v72, v76
    v_cvt_pk_bf16_f32 v73, v73, v77
    v_mfma_f32_16x16x32_bf16 v[28:31], v[124:127], v[48:51], 0
    v_cvt_pk_bf16_f32 v74, v74, v78
    v_cvt_pk_bf16_f32 v75, v75, v79
    v_mfma_f32_16x16x32_bf16 v[24:27], v[56:59], v[144:147], v[24:27]
    v_mfma_f32_16x16x32_bf16 v[24:27], v[64:67], v[148:151], v[24:27]
    v_mfma_f32_16x16x32_bf16 v[24:27], v[80:83], v[136:139], v[24:27]
    ds_read_b128 v[48:51], v6 offset:2048
    v_mfma_f32_16x16x32_bf16 v[24:27], v[88:91], v[140:143], v[24:27]
    ds_read_b128 v[52:55], v6 offset:2064
    v_mfma_f32_16x16x32_bf16 v[28:31], v[80:83], v[144:147], v[28:31]
    v_cvt_pk_bf16_f32 v96, v96, v100
    v_mfma_f32_16x16x32_bf16 v[28:31], v[88:91], v[148:151], v[28:31]
    v_cvt_pk_bf16_f32 v97, v97, v101
    v_mfma_f32_16x16x32_bf16 v[24:27], v[72:75], v[152:155], v[24:27]
    v_cvt_pk_bf16_f32 v98, v98, v102
    v_mfma_f32_16x16x32_bf16 v[28:31], v[72:75], v[156:159], v[28:31]
    v_cvt_pk_bf16_f32 v99, v99, v103
    s_waitcnt lgkmcnt(3)
    v_mfma_f32_16x16x32_bf16 v[56:59], v[40:43], v[112:115], 0
    v_mfma_f32_16x16x32_bf16 v[60:63], v[40:43], v[116:119], 0
    s_waitcnt lgkmcnt(2)
    v_mfma_f32_16x16x32_bf16 v[64:67], v[44:47], v[112:115], 0
    v_mfma_f32_16x16x32_bf16 v[68:71], v[44:47], v[116:119], 0
    v_mfma_f32_16x16x32_bf16 v[24:27], v[120:123], v[40:43], v[24:27]
    v_mfma_f32_16x16x32_bf16 v[28:31], v[96:99], v[152:155], v[28:31]
    s_waitcnt lgkmcnt(1)
    v_mfma_f32_16x16x32_bf16 v[80:83], v[48:51], v[112:115], 0
    s_nop 0
    v_cvt_pk_bf16_f32 v56, v56, v60
    v_cvt_pk_bf16_f32 v57, v57, v61
    v_mfma_f32_16x16x32_bf16 v[84:87], v[48:51], v[116:119], 0
    v_cvt_pk_bf16_f32 v58, v58, v62
    v_cvt_pk_bf16_f32 v59, v59, v63
    s_waitcnt lgkmcnt(0)
    v_mfma_f32_16x16x32_bf16 v[88:91], v[52:55], v[112:115], 0
    v_cvt_pk_bf16_f32 v64, v64, v68
    v_cvt_pk_bf16_f32 v65, v65, v69
    v_mfma_f32_16x16x32_bf16 v[92:95], v[52:55], v[116:119], 0
    v_cvt_pk_bf16_f32 v66, v66, v70
    v_cvt_pk_bf16_f32 v67, v67, v71
    v_mfma_f32_16x16x32_bf16 v[28:31], v[120:123], v[48:51], v[28:31]
    v_mfma_f32_16x16x32_bf16 v[24:27], v[56:59], v[128:131], v[24:27]
    v_cvt_pk_bf16_f32 v80, v80, v84
    v_cvt_pk_bf16_f32 v81, v81, v85
    v_mfma_f32_16x16x32_bf16 v[24:27], v[64:67], v[132:135], v[24:27]
    v_cvt_pk_bf16_f32 v82, v82, v86
    v_cvt_pk_bf16_f32 v83, v83, v87
    v_mfma_f32_16x16x32_bf16 v[28:31], v[56:59], v[136:139], v[28:31]
    v_cvt_pk_bf16_f32 v88, v88, v92
    v_cvt_pk_bf16_f32 v89, v89, v93
    v_mfma_f32_16x16x32_bf16 v[28:31], v[64:67], v[140:143], v[28:31]
    v_cvt_pk_bf16_f32 v90, v90, v94
    v_cvt_pk_bf16_f32 v91, v91, v95
    v_mfma_f32_16x16x32_bf16 v[28:31], v[80:83], v[128:131], v[28:31]
    s_nop 0
    v_mfma_f32_16x16x32_bf16 v[28:31], v[88:91], v[132:135], v[28:31]
    v_mfma_f32_16x16x32_bf16 v[32:35], v[72:75], v[160:163], 0
    v_mfma_f32_16x16x32_bf16 v[36:39], v[72:75], v[164:167], 0
    v_mfma_f32_16x16x32_bf16 v[32:35], v[96:99], v[156:159], v[32:35]
    v_mfma_f32_16x16x32_bf16 v[36:39], v[96:99], v[160:163], v[36:39]
    ds_write_b128 v8, v[24:27] offset:2048
    s_nop 2
    ds_write_b128 v8, v[28:31] offset:3072
    v_mov_b32 v10, 2
    ds_write_b32 v9, v10 offset:32
    s_setprio 1
    v_mfma_f32_16x16x32_bf16 v[72:75], v[40:43], v[104:107], 0
    v_mfma_f32_16x16x32_bf16 v[76:79], v[44:47], v[108:111], 0
    v_mfma_f32_16x16x32_bf16 v[32:35], v[124:127], v[40:43], v[32:35]
    v_mfma_f32_16x16x32_bf16 v[96:99], v[48:51], v[104:107], 0
    v_mfma_f32_16x16x32_bf16 v[100:103], v[52:55], v[108:111], 0
    v_mfma_f32_16x16x32_bf16 v[36:39], v[124:127], v[48:51], v[36:39]
    v_mfma_f32_16x16x32_bf16 v[32:35], v[56:59], v[144:147], v[32:35]
    v_mfma_f32_16x16x32_bf16 v[32:35], v[64:67], v[148:151], v[32:35]
    v_mfma_f32_16x16x32_bf16 v[32:35], v[80:83], v[136:139], v[32:35]
    s_nop 0
    v_cvt_pk_bf16_f32 v72, v72, v76
    v_cvt_pk_bf16_f32 v73, v73, v77
    v_mfma_f32_16x16x32_bf16 v[32:35], v[88:91], v[140:143], v[32:35]
    v_cvt_pk_bf16_f32 v74, v74, v78
    v_cvt_pk_bf16_f32 v75, v75, v79
    v_mfma_f32_16x16x32_bf16 v[36:39], v[80:83], v[144:147], v[36:39]
    v_cvt_pk_bf16_f32 v96, v96, v100
    v_cvt_pk_bf16_f32 v97, v97, v101
    v_mfma_f32_16x16x32_bf16 v[36:39], v[88:91], v[148:151], v[36:39]
    v_cvt_pk_bf16_f32 v98, v98, v102
    v_cvt_pk_bf16_f32 v99, v99, v103
    v_mfma_f32_16x16x32_bf16 v[32:35], v[72:75], v[152:155], v[32:35]
    v_mfma_f32_16x16x32_bf16 v[36:39], v[72:75], v[156:159], v[36:39]
    v_mfma_f32_16x16x32_bf16 v[36:39], v[96:99], v[152:155], v[36:39]
    s_setprio 3
    s_mov_b32 s9, 0
SP_26:
    ds_read_b32 v10, v1 offset:84
    s_waitcnt lgkmcnt(0)
    v_readfirstlane_b32 s8, v10
    s_add_u32 s9, s9, 1
    s_cmp_ge_u32 s8, 1
    s_cbranch_scc1 SP_26_D
    s_sleep 1
    s_cmp_lt_u32 s9, 524288
    s_cbranch_scc1 SP_26
SP_26_D:
    s_setprio 1
    ds_read_b64 v[40:41], v5 offset:0
    ds_read_b64 v[42:43], v5 offset:8
    ds_read_b128 v[56:59], v6 offset:0
    ds_read_b128 v[52:55], v6 offset:512
    ds_read_b64 v[44:45], v5 offset:512
    ds_read_b64 v[46:47], v5 offset:520
    ds_read_b128 v[48:51], v6 offset:1024
    s_waitcnt lgkmcnt(4)
    v_mfma_f32_16x16x32_bf16 v[36:39], v[40:43], v[56:59], v[36:39]
    ds_read_b64 v[68:69], v5 offset:64
    ds_read_b64 v[70:71], v5 offset:72
    ds_read_b128 v[84:87], v6 offset:64
    s_waitcnt lgkmcnt(6)
    v_mfma_f32_16x16x32_bf16 v[32:35], v[40:43], v[52:55], v[32:35]
    ds_read_b128 v[80:83], v6 offset:576
    ds_read_b64 v[72:73], v5 offset:576
    ds_read_b64 v[74:75], v5 offset:584
    s_waitcnt lgkmcnt(7)
    v_mfma_f32_16x16x32_bf16 v[36:39], v[44:47], v[52:55], v[36:39]
    ds_read_b128 v[76:79], v6 offset:1088
    ds_read_b128 v[152:155], v6 offset:1536
    ds_read_b128 v[156:159], v6 offset:1552
    s_waitcnt lgkmcnt(9)
    v_mfma_f32_16x16x32_bf16 v[32:35], v[44:47], v[48:51], v[32:35]
    ds_read_b128 v[160:163], v6 offset:1024
    ds_read_b128 v[164:167], v6 offset:1040
    s_waitcnt lgkmcnt(7)
    v_mfma_f32_16x16x32_bf16 v[36:39], v[68:71], v[84:87], v[36:39]
    ds_read_b64 v[40:41], v5 offset:128
    ds_read_b64 v[42:43], v5 offset:136
    ds_read_b128 v[56:59], v6 offset:128
    v_mfma_f32_16x16x32_bf16 v[32:35], v[68:71], v[80:83], v[32:35]
    ds_read_b128 v[52:55], v6 offset:640
    ds_read_b64 v[44:45], v5 offset:640
    ds_read_b64 v[46:47], v5 offset:648
    s_waitcnt lgkmcnt(10)
    v_mfma_f32_16x16x32_bf16 v[36:39], v[72:75], v[80:83], v[36:39]
    ds_read_b128 v[48:51], v6 offset:1152
    s_waitcnt lgkmcnt(10)
    v_mfma_f32_16x16x32_bf16 v[96:99], v[152:155], v[112:115], 0
    v_mfma_f32_16x16x32_bf16 v[100:103], v[152:155], v[116:119], 0
    v_mfma_f32_16x16x32_bf16 v[32:35], v[72:75], v[76:79], v[32:35]
    s_waitcnt lgkmcnt(9)
    v_mfma_f32_16x16x32_bf16 v[104:107], v[156:159], v[112:115], 0
    v_mfma_f32_16x16x32_bf16 v[108:111], v[156:159], v[116:119], 0
    v_mfma_f32_16x16x32_bf16 v[32:35], v[120:123], v[152:155], v[32:35]
    s_waitcnt lgkmcnt(3)
    v_mfma_f32_16x16x32_bf16 v[36:39], v[40:43], v[56:59], v[36:39]
    ds_read_b64 v[68:69], v5 offset:192
    ds_read_b64 v[70:71], v5 offset:200
    ds_read_b128 v[84:87], v6 offset:192
    ds_read_b128 v[80:83], v6 offset:704
    v_mfma_f32_16x16x32_bf16 v[32:35], v[40:43], v[52:55], v[32:35]
    ds_read_b64 v[72:73], v5 offset:704
    ds_read_b64 v[74:75], v5 offset:712
    ds_read_b128 v[76:79], v6 offset:1216
    v_cvt_pk_bf16_f32 v96, v96, v100
    s_waitcnt lgkmcnt(7)
    v_mfma_f32_16x16x32_bf16 v[36:39], v[44:47], v[52:55], v[36:39]
    v_cvt_pk_bf16_f32 v97, v97, v101
    v_cvt_pk_bf16_f32 v98, v98, v102
    v_cvt_pk_bf16_f32 v99, v99, v103
    v_cvt_pk_bf16_f32 v104, v104, v108
    v_mfma_f32_16x16x32_bf16 v[32:35], v[44:47], v[48:51], v[32:35]
    v_cvt_pk_bf16_f32 v105, v105, v109
    v_cvt_pk_bf16_f32 v106, v106, v110
    v_cvt_pk_bf16_f32 v107, v107, v111
    s_waitcnt lgkmcnt(3)
    v_mfma_f32_16x16x32_bf16 v[36:39], v[68:71], v[84:87], v[36:39]
    ds_read_b64 v[40:41], v5 offset:256
    ds_read_b64 v[42:43], v5 offset:264
    ds_read_b128 v[56:59], v6 offset:256
    ds_read_b128 v[52:55], v6 offset:768
    v_mfma_f32_16x16x32_bf16 v[32:35], v[68:71], v[80:83], v[32:35]
    ds_read_b64 v[44:45], v5 offset:768
    ds_read_b64 v[46:47], v5 offset:776
    ds_read_b128 v[48:51], v6 offset:1280
    v_mfma_f32_16x16x32_bf16 v[32:35], v[96:99], v[128:131], v[32:35]
    s_waitcnt lgkmcnt(7)
    v_mfma_f32_16x16x32_bf16 v[36:39], v[72:75], v[80:83], v[36:39]
    v_mfma_f32_16x16x32_bf16 v[32:35], v[104:107], v[132:135], v[32:35]
    v_mfma_f32_16x16x32_bf16 v[36:39], v[96:99], v[136:139], v[36:39]
    v_mfma_f32_16x16x32_bf16 v[36:39], v[104:107], v[140:143], v[36:39]
    v_mfma_f32_16x16x32_bf16 v[96:99], v[160:163], v[112:115], 0
    v_mfma_f32_16x16x32_bf16 v[32:35], v[72:75], v[76:79], v[32:35]
    v_mfma_f32_16x16x32_bf16 v[100:103], v[160:163], v[116:119], 0
    v_mfma_f32_16x16x32_bf16 v[104:107], v[164:167], v[112:115], 0
    v_mfma_f32_16x16x32_bf16 v[108:111], v[164:167], v[116:119], 0
    v_mfma_f32_16x16x32_bf16 v[36:39], v[120:123], v[160:163], v[36:39]
    s_waitcnt lgkmcnt(3)
    v_mfma_f32_16x16x32_bf16 v[36:39], v[40:43], v[56:59], v[36:39]
    ds_read_b64 v[68:69], v5 offset:320
    ds_read_b64 v[70:71], v5 offset:328
    ds_read_b128 v[84:87], v6 offset:320
    ds_read_b128 v[80:83], v6 offset:832
    v_mfma_f32_16x16x32_bf16 v[32:35], v[40:43], v[52:55], v[32:35]
    ds_read_b64 v[72:73], v5 offset:832
    ds_read_b64 v[74:75], v5 offset:840
    ds_read_b128 v[76:79], v6 offset:1344
    v_cvt_pk_bf16_f32 v96, v96, v100
    s_waitcnt lgkmcnt(7)
    v_mfma_f32_16x16x32_bf16 v[36:39], v[44:47], v[52:55], v[36:39]
    v_cvt_pk_bf16_f32 v97, v97, v101
    v_cvt_pk_bf16_f32 v98, v98, v102
    v_cvt_pk_bf16_f32 v99, v99, v103
    v_cvt_pk_bf16_f32 v104, v104, v108
    v_mfma_f32_16x16x32_bf16 v[32:35], v[44:47], v[48:51], v[32:35]
    v_cvt_pk_bf16_f32 v105, v105, v109
    v_cvt_pk_bf16_f32 v106, v106, v110
    v_cvt_pk_bf16_f32 v107, v107, v111
    s_waitcnt lgkmcnt(3)
    v_mfma_f32_16x16x32_bf16 v[36:39], v[68:71], v[84:87], v[36:39]
    ds_read_b64 v[40:41], v5 offset:384
    ds_read_b64 v[42:43], v5 offset:392
    ds_read_b128 v[56:59], v6 offset:384
    v_mfma_f32_16x16x32_bf16 v[32:35], v[68:71], v[80:83], v[32:35]
    ds_read_b128 v[52:55], v6 offset:896
    ds_read_b64 v[44:45], v5 offset:896
    s_waitcnt lgkmcnt(5)
    v_mfma_f32_16x16x32_bf16 v[36:39], v[72:75], v[80:83], v[36:39]
    ds_read_b64 v[46:47], v5 offset:904
    ds_read_b128 v[48:51], v6 offset:1408
    v_mfma_f32_16x16x32_bf16 v[32:35], v[72:75], v[76:79], v[32:35]
    v_mfma_f32_16x16x32_bf16 v[36:39], v[96:99], v[128:131], v[36:39]
    v_mfma_f32_16x16x32_bf16 v[36:39], v[104:107], v[132:135], v[36:39]
    s_waitcnt lgkmcnt(3)
    v_mfma_f32_16x16x32_bf16 v[36:39], v[40:43], v[56:59], v[36:39]
    ds_read_b64 v[68:69], v5 offset:448
    ds_read_b64 v[70:71], v5 offset:456
    v_mfma_f32_16x16x32_bf16 v[32:35], v[40:43], v[52:55], v[32:35]
    ds_read_b128 v[84:87], v6 offset:448
    ds_read_b128 v[80:83], v6 offset:960
    s_waitcnt lgkmcnt(4)
    v_mfma_f32_16x16x32_bf16 v[36:39], v[44:47], v[52:55], v[36:39]
    ds_read_b64 v[72:73], v5 offset:960
    ds_read_b64 v[74:75], v5 offset:968
    v_mfma_f32_16x16x32_bf16 v[32:35], v[44:47], v[48:51], v[32:35]
    ds_read_b128 v[76:79], v6 offset:1472
    s_waitcnt lgkmcnt(3)
    v_mfma_f32_16x16x32_bf16 v[36:39], v[68:71], v[84:87], v[36:39]
    v_mfma_f32_16x16x32_bf16 v[32:35], v[68:71], v[80:83], v[32:35]
    s_waitcnt lgkmcnt(0)
    v_mfma_f32_16x16x32_bf16 v[36:39], v[72:75], v[80:83], v[36:39]
    v_mfma_f32_16x16x32_bf16 v[32:35], v[72:75], v[76:79], v[32:35]
    s_nop 6
    v_cvt_pk_bf16_f32 v96, v39, v38
    v_cvt_pk_bf16_f32 v97, v37, v36
    ds_write_b64 v7, v[96:97] offset:0
    v_cvt_pk_bf16_f32 v98, v35, v34
    v_cvt_pk_bf16_f32 v99, v33, v32
    ds_write_b64 v7, v[98:99] offset:512
    v_mov_b32 v12, 1
    s_mov_b64 exec, 1
    ds_add_u32 v1, v12 offset:104
    s_mov_b64 exec, -1
    s_endpgm
SELECT:
    s_mov_b32 s52, s16
    s_mov_b32 s53, s17
    s_mov_b32 s54, 2359296
    s_mov_b32 s55, 0x20000
    v_lshlrev_b32 v7, 4, v2
    v_add_u32 v15, 0x1000, v7
    v_lshlrev_b32 v8, 2, v2
    v_sub_u32 v8, 2047, v8
    v_subrev_u32 v48, 0, v8
    v_subrev_u32 v49, 1, v8
    v_subrev_u32 v50, 2, v8
    v_subrev_u32 v51, 3, v8
    v_subrev_u32 v52, 256, v8
    v_subrev_u32 v53, 257, v8
    v_subrev_u32 v54, 258, v8
    v_subrev_u32 v55, 259, v8
    v_subrev_u32 v56, 512, v8
    v_subrev_u32 v57, 513, v8
    v_subrev_u32 v58, 514, v8
    v_subrev_u32 v59, 515, v8
    v_subrev_u32 v60, 768, v8
    v_subrev_u32 v61, 769, v8
    v_subrev_u32 v62, 770, v8
    v_subrev_u32 v63, 771, v8
    v_subrev_u32 v64, 1024, v8
    v_subrev_u32 v65, 1025, v8
    v_subrev_u32 v66, 1026, v8
    v_subrev_u32 v67, 1027, v8
    v_subrev_u32 v68, 1280, v8
    v_subrev_u32 v69, 1281, v8
    v_subrev_u32 v70, 1282, v8
    v_subrev_u32 v71, 1283, v8
    v_subrev_u32 v72, 1536, v8
    v_subrev_u32 v73, 1537, v8
    v_subrev_u32 v74, 1538, v8
    v_subrev_u32 v75, 1539, v8
    v_subrev_u32 v76, 1792, v8
    v_subrev_u32 v77, 1793, v8
    v_subrev_u32 v78, 1794, v8
    v_subrev_u32 v79, 1795, v8
    v_lshrrev_b32 v9, 3, v2
    v_and_b32 v9, 6, v9
    v_xor_b32 v9, v9, v2
    v_and_b32 v9, 7, v9
    v_lshlrev_b32 v5, 4, v9
    v_mov_b32 v12, 0
    v_mov_b32 v6, 0
    s_mov_b32 s11, 0xffff0000
    s_mov_b32 s15, 0
    s_mov_b32 s9, 0
SP_27:
    ds_read_b32 v13, v1 offset:12
    s_waitcnt lgkmcnt(0)
    v_readfirstlane_b32 s8, v13
    s_add_u32 s9, s9, 1
    s_cmp_ge_u32 s8, 2
    s_cbranch_scc1 SP_27_D
    s_cmp_lt_u32 s9, 524288
    s_cbranch_scc1 SP_27
SP_27_D:
    s_mov_b32 s9, 0
    s_waitcnt vmcnt(0)
    s_sleep 16
SEL_POLL:
    global_load_dwordx4 v[16:19], v7, s[50:51] offset:0 sc1
    global_load_dwordx4 v[20:23], v7, s[50:51] offset:1024 sc1
    global_load_dwordx4 v[24:27], v7, s[50:51] offset:2048 sc1
    global_load_dwordx4 v[28:31], v7, s[50:51] offset:3072 sc1
    global_load_dwordx4 v[32:35], v15, s[50:51] offset:0 sc1
    global_load_dwordx4 v[36:39], v15, s[50:51] offset:1024 sc1
    global_load_dwordx4 v[40:43], v15, s[50:51] offset:2048 sc1
    global_load_dwordx4 v[44:47], v15, s[50:51] offset:3072 sc1
    s_waitcnt vmcnt(7)
    v_xor_b32 v13, v17, v14
    v_bitop3_b32 v13, v13, v19, v14 bitop3:0xf6
    s_waitcnt vmcnt(6)
    v_bitop3_b32 v13, v13, v21, v14 bitop3:0xf6
    v_bitop3_b32 v13, v13, v23, v14 bitop3:0xf6
    s_waitcnt vmcnt(5)
    v_bitop3_b32 v13, v13, v25, v14 bitop3:0xf6
    v_bitop3_b32 v13, v13, v27, v14 bitop3:0xf6
    s_waitcnt vmcnt(4)
    v_bitop3_b32 v13, v13, v29, v14 bitop3:0xf6
    v_bitop3_b32 v13, v13, v31, v14 bitop3:0xf6
    s_waitcnt vmcnt(3)
    v_bitop3_b32 v13, v13, v33, v14 bitop3:0xf6
    v_bitop3_b32 v13, v13, v35, v14 bitop3:0xf6
    s_waitcnt vmcnt(2)
    v_bitop3_b32 v13, v13, v37, v14 bitop3:0xf6
    v_bitop3_b32 v13, v13, v39, v14 bitop3:0xf6
    s_waitcnt vmcnt(1)
    v_bitop3_b32 v13, v13, v41, v14 bitop3:0xf6
    v_bitop3_b32 v13, v13, v43, v14 bitop3:0xf6
    s_waitcnt vmcnt(0)
    v_bitop3_b32 v13, v13, v45, v14 bitop3:0xf6
    v_bitop3_b32 v13, v13, v47, v14 bitop3:0xf6
    v_cmp_ne_u32 vcc, 0, v13
    s_add_u32 s9, s9, 1
    s_cmp_eq_u64 vcc, 0
    s_cbranch_scc1 SEL_GOT
    s_cmp_lt_u32 s9, 131072
    s_cbranch_scc1 SEL_POLL
SEL_GOT:
    v_lshl_or_b32 v80, v16, 16, v48
    v_and_or_b32 v81, v16, s11, v49
    v_lshl_or_b32 v82, v18, 16, v50
    v_and_or_b32 v83, v18, s11, v51
    v_min_u32 v9, v80, v81
    v_max_u32 v8, v80, v81
    v_med3_u32 v9, v8, v9, v82
    v_max_u32 v8, v8, v82
    v_med3_u32 v9, v8, v9, v83
    v_max_u32 v8, v8, v83
    v_lshl_or_b32 v84, v20, 16, v52
    v_and_or_b32 v85, v20, s11, v53
    v_lshl_or_b32 v86, v22, 16, v54
    v_and_or_b32 v87, v22, s11, v55
    v_med3_u32 v9, v8, v9, v84
    v_max_u32 v8, v8, v84
    v_med3_u32 v9, v8, v9, v85
    v_max_u32 v8, v8, v85
    v_med3_u32 v9, v8, v9, v86
    v_max_u32 v8, v8, v86
    v_med3_u32 v9, v8, v9, v87
    v_max_u32 v8, v8, v87
    v_lshl_or_b32 v88, v24, 16, v56
    v_and_or_b32 v89, v24, s11, v57
    v_lshl_or_b32 v90, v26, 16, v58
    v_and_or_b32 v91, v26, s11, v59
    v_med3_u32 v9, v8, v9, v88
    v_max_u32 v8, v8, v88
    v_med3_u32 v9, v8, v9, v89
    v_max_u32 v8, v8, v89
    v_med3_u32 v9, v8, v9, v90
    v_max_u32 v8, v8, v90
    v_med3_u32 v9, v8, v9, v91
    v_max_u32 v8, v8, v91
    v_lshl_or_b32 v92, v28, 16, v60
    v_and_or_b32 v93, v28, s11, v61
    v_lshl_or_b32 v94, v30, 16, v62
    v_and_or_b32 v95, v30, s11, v63
    v_med3_u32 v9, v8, v9, v92
    v_max_u32 v8, v8, v92
    v_med3_u32 v9, v8, v9, v93
    v_max_u32 v8, v8, v93
    v_med3_u32 v9, v8, v9, v94
    v_max_u32 v8, v8, v94
    v_med3_u32 v9, v8, v9, v95
    v_max_u32 v8, v8, v95
    v_lshl_or_b32 v96, v32, 16, v64
    v_and_or_b32 v97, v32, s11, v65
    v_lshl_or_b32 v98, v34, 16, v66
    v_and_or_b32 v99, v34, s11, v67
    v_med3_u32 v9, v8, v9, v96
    v_max_u32 v8, v8, v96
    v_med3_u32 v9, v8, v9, v97
    v_max_u32 v8, v8, v97
    v_med3_u32 v9, v8, v9, v98
    v_max_u32 v8, v8, v98
    v_med3_u32 v9, v8, v9, v99
    v_max_u32 v8, v8, v99
    v_lshl_or_b32 v100, v36, 16, v68
    v_and_or_b32 v101, v36, s11, v69
    v_lshl_or_b32 v102, v38, 16, v70
    v_and_or_b32 v103, v38, s11, v71
    v_med3_u32 v9, v8, v9, v100
    v_max_u32 v8, v8, v100
    v_med3_u32 v9, v8, v9, v101
    v_max_u32 v8, v8, v101
    v_med3_u32 v9, v8, v9, v102
    v_max_u32 v8, v8, v102
    v_med3_u32 v9, v8, v9, v103
    v_max_u32 v8, v8, v103
    v_lshl_or_b32 v104, v40, 16, v72
    v_and_or_b32 v105, v40, s11, v73
    v_lshl_or_b32 v106, v42, 16, v74
    v_and_or_b32 v107, v42, s11, v75
    v_med3_u32 v9, v8, v9, v104
    v_max_u32 v8, v8, v104
    v_med3_u32 v9, v8, v9, v105
    v_max_u32 v8, v8, v105
    v_med3_u32 v9, v8, v9, v106
    v_max_u32 v8, v8, v106
    v_med3_u32 v9, v8, v9, v107
    v_max_u32 v8, v8, v107
    v_lshl_or_b32 v108, v44, 16, v76
    v_and_or_b32 v109, v44, s11, v77
    v_lshl_or_b32 v110, v46, 16, v78
    v_and_or_b32 v111, v46, s11, v79
    v_med3_u32 v9, v8, v9, v108
    v_max_u32 v8, v8, v108
    v_med3_u32 v9, v8, v9, v109
    v_max_u32 v8, v8, v109
    v_med3_u32 v9, v8, v9, v110
    v_max_u32 v8, v8, v110
    v_med3_u32 v9, v8, v9, v111
    v_max_u32 v8, v8, v111
    v_mov_b32 v10, v8
    s_nop 1
    v_max_u32_dpp v10, v10, v10 row_shr:1 row_mask:0xf bank_mask:0xf
    s_nop 1
    v_max_u32_dpp v10, v10, v10 row_shr:2 row_mask:0xf bank_mask:0xf
    s_nop 1
    v_max_u32_dpp v10, v10, v10 row_shr:4 row_mask:0xf bank_mask:0xf
    s_nop 1
    v_max_u32_dpp v10, v10, v10 row_shr:8 row_mask:0xf bank_mask:0xf
    s_nop 1
    v_max_u32_dpp v10, v10, v10 row_bcast:15 row_mask:0xa bank_mask:0xf
    s_nop 1
    v_max_u32_dpp v10, v10, v10 row_bcast:31 row_mask:0xc bank_mask:0xf
    s_nop 0
    v_readlane_b32 s8, v10, 63
    s_mov_b32 s12, s8
    v_subrev_u32 v10, s12, v8
    v_subrev_u32 v11, s12, v9
    v_max_u32 v10, v10, v11
    s_and_b32 s13, s12, 0x7ff
    s_sub_u32 s13, 2047, s13
    v_max_u32_dpp v10, v10, v10 row_shr:1 row_mask:0xf bank_mask:0xf
    s_mul_i32 s13, s13, 1152
    s_nop 0
    v_max_u32_dpp v10, v10, v10 row_shr:2 row_mask:0xf bank_mask:0xf
    s_mov_b32 exec_lo, 0xff
    s_mov_b32 exec_hi, 0x0
    v_add_u32 v12, s13, v5
    v_mov_b32 v6, s12
    s_mov_b64 exec, -1
    v_max_u32_dpp v10, v10, v10 row_shr:4 row_mask:0xf bank_mask:0xf
    s_nop 1
    v_max_u32_dpp v10, v10, v10 row_shr:8 row_mask:0xf bank_mask:0xf
    s_nop 1
    v_max_u32_dpp v10, v10, v10 row_bcast:15 row_mask:0xa bank_mask:0xf
    s_nop 1
    v_max_u32_dpp v10, v10, v10 row_bcast:31 row_mask:0xc bank_mask:0xf
    s_nop 0
    v_readlane_b32 s8, v10, 63
    s_add_u32 s12, s12, s8
    v_subrev_u32 v10, s12, v8
    v_subrev_u32 v11, s12, v9
    v_max_u32 v10, v10, v11
    s_and_b32 s13, s12, 0x7ff
    s_sub_u32 s13, 2047, s13
    v_max_u32_dpp v10, v10, v10 row_shr:1 row_mask:0xf bank_mask:0xf
    s_mul_i32 s13, s13, 1152
    s_nop 0
    v_max_u32_dpp v10, v10, v10 row_shr:2 row_mask:0xf bank_mask:0xf
    s_mov_b32 exec_lo, 0xff00
    s_mov_b32 exec_hi, 0x0
    v_add_u32 v12, s13, v5
    v_mov_b32 v6, s12
    s_mov_b64 exec, -1
    v_max_u32_dpp v10, v10, v10 row_shr:4 row_mask:0xf bank_mask:0xf
    s_nop 1
    v_max_u32_dpp v10, v10, v10 row_shr:8 row_mask:0xf bank_mask:0xf
    s_nop 1
    v_max_u32_dpp v10, v10, v10 row_bcast:15 row_mask:0xa bank_mask:0xf
    s_nop 1
    v_max_u32_dpp v10, v10, v10 row_bcast:31 row_mask:0xc bank_mask:0xf
    s_nop 0
    v_readlane_b32 s8, v10, 63
    s_add_u32 s12, s12, s8
    v_subrev_u32 v10, s12, v8
    v_subrev_u32 v11, s12, v9
    v_max_u32 v10, v10, v11
    s_and_b32 s13, s12, 0x7ff
    s_sub_u32 s13, 2047, s13
    v_max_u32_dpp v10, v10, v10 row_shr:1 row_mask:0xf bank_mask:0xf
    s_mul_i32 s13, s13, 1152
    s_nop 0
    v_max_u32_dpp v10, v10, v10 row_shr:2 row_mask:0xf bank_mask:0xf
    s_mov_b32 exec_lo, 0xff0000
    s_mov_b32 exec_hi, 0x0
    v_add_u32 v12, s13, v5
    v_mov_b32 v6, s12
    s_mov_b64 exec, -1
    v_max_u32_dpp v10, v10, v10 row_shr:4 row_mask:0xf bank_mask:0xf
    s_nop 1
    v_max_u32_dpp v10, v10, v10 row_shr:8 row_mask:0xf bank_mask:0xf
    s_nop 1
    v_max_u32_dpp v10, v10, v10 row_bcast:15 row_mask:0xa bank_mask:0xf
    s_nop 1
    v_max_u32_dpp v10, v10, v10 row_bcast:31 row_mask:0xc bank_mask:0xf
    s_nop 0
    v_readlane_b32 s8, v10, 63
    s_add_u32 s12, s12, s8
    v_subrev_u32 v10, s12, v8
    v_subrev_u32 v11, s12, v9
    v_max_u32 v10, v10, v11
    s_and_b32 s13, s12, 0x7ff
    s_sub_u32 s13, 2047, s13
    v_max_u32_dpp v10, v10, v10 row_shr:1 row_mask:0xf bank_mask:0xf
    s_mul_i32 s13, s13, 1152
    s_nop 0
    v_max_u32_dpp v10, v10, v10 row_shr:2 row_mask:0xf bank_mask:0xf
    s_mov_b32 exec_lo, 0xff000000
    s_mov_b32 exec_hi, 0x0
    v_add_u32 v12, s13, v5
    v_mov_b32 v6, s12
    s_mov_b64 exec, -1
    v_max_u32_dpp v10, v10, v10 row_shr:4 row_mask:0xf bank_mask:0xf
    s_nop 1
    v_max_u32_dpp v10, v10, v10 row_shr:8 row_mask:0xf bank_mask:0xf
    s_nop 1
    v_max_u32_dpp v10, v10, v10 row_bcast:15 row_mask:0xa bank_mask:0xf
    s_nop 1
    v_max_u32_dpp v10, v10, v10 row_bcast:31 row_mask:0xc bank_mask:0xf
    s_nop 0
    v_readlane_b32 s8, v10, 63
    s_add_u32 s12, s12, s8
    v_subrev_u32 v10, s12, v8
    v_subrev_u32 v11, s12, v9
    v_max_u32 v10, v10, v11
    s_and_b32 s13, s12, 0x7ff
    s_sub_u32 s13, 2047, s13
    v_max_u32_dpp v10, v10, v10 row_shr:1 row_mask:0xf bank_mask:0xf
    s_mul_i32 s13, s13, 1152
    s_nop 0
    v_max_u32_dpp v10, v10, v10 row_shr:2 row_mask:0xf bank_mask:0xf
    s_mov_b32 exec_lo, 0x0
    s_mov_b32 exec_hi, 0xff
    v_add_u32 v12, s13, v5
    v_mov_b32 v6, s12
    s_mov_b64 exec, -1
    v_max_u32_dpp v10, v10, v10 row_shr:4 row_mask:0xf bank_mask:0xf
    s_nop 1
    v_max_u32_dpp v10, v10, v10 row_shr:8 row_mask:0xf bank_mask:0xf
    s_nop 1
    v_max_u32_dpp v10, v10, v10 row_bcast:15 row_mask:0xa bank_mask:0xf
    s_nop 1
    v_max_u32_dpp v10, v10, v10 row_bcast:31 row_mask:0xc bank_mask:0xf
    s_nop 0
    v_readlane_b32 s8, v10, 63
    s_add_u32 s12, s12, s8
    v_subrev_u32 v10, s12, v8
    v_subrev_u32 v11, s12, v9
    v_max_u32 v10, v10, v11
    s_and_b32 s13, s12, 0x7ff
    s_sub_u32 s13, 2047, s13
    v_max_u32_dpp v10, v10, v10 row_shr:1 row_mask:0xf bank_mask:0xf
    s_mul_i32 s13, s13, 1152
    s_nop 0
    v_max_u32_dpp v10, v10, v10 row_shr:2 row_mask:0xf bank_mask:0xf
    s_mov_b32 exec_lo, 0x0
    s_mov_b32 exec_hi, 0xff00
    v_add_u32 v12, s13, v5
    v_mov_b32 v6, s12
    s_mov_b64 exec, -1
    v_max_u32_dpp v10, v10, v10 row_shr:4 row_mask:0xf bank_mask:0xf
    s_nop 1
    v_max_u32_dpp v10, v10, v10 row_shr:8 row_mask:0xf bank_mask:0xf
    s_nop 1
    v_max_u32_dpp v10, v10, v10 row_bcast:15 row_mask:0xa bank_mask:0xf
    s_nop 1
    v_max_u32_dpp v10, v10, v10 row_bcast:31 row_mask:0xc bank_mask:0xf
    s_nop 0
    v_readlane_b32 s8, v10, 63
    s_add_u32 s12, s12, s8
    v_subrev_u32 v10, s12, v8
    v_subrev_u32 v11, s12, v9
    v_max_u32 v10, v10, v11
    s_and_b32 s13, s12, 0x7ff
    s_sub_u32 s13, 2047, s13
    v_max_u32_dpp v10, v10, v10 row_shr:1 row_mask:0xf bank_mask:0xf
    s_mul_i32 s13, s13, 1152
    s_nop 0
    v_max_u32_dpp v10, v10, v10 row_shr:2 row_mask:0xf bank_mask:0xf
    s_mov_b32 exec_lo, 0x0
    s_mov_b32 exec_hi, 0xff0000
    v_add_u32 v12, s13, v5
    v_mov_b32 v6, s12
    s_mov_b64 exec, -1
    v_max_u32_dpp v10, v10, v10 row_shr:4 row_mask:0xf bank_mask:0xf
    s_nop 1
    v_max_u32_dpp v10, v10, v10 row_shr:8 row_mask:0xf bank_mask:0xf
    s_nop 1
    v_max_u32_dpp v10, v10, v10 row_bcast:15 row_mask:0xa bank_mask:0xf
    s_nop 1
    v_max_u32_dpp v10, v10, v10 row_bcast:31 row_mask:0xc bank_mask:0xf
    s_nop 0
    v_readlane_b32 s8, v10, 63
    s_add_u32 s12, s12, s8
    s_and_b32 s13, s12, 0x7ff
    s_sub_u32 s13, 2047, s13
    s_mul_i32 s13, s13, 1152
    s_mov_b32 exec_lo, 0x0
    s_mov_b32 exec_hi, 0xff000000
    v_add_u32 v12, s13, v5
    v_mov_b32 v6, s12
    s_mov_b64 exec, -1
    s_mov_b32 s14, 0
SEL_GATHER:
    s_mov_b32 m0, 147712
    s_nop 0
    buffer_load_dwordx4 v12, s[52:55], 0 offen offset:0 lds
    s_mov_b32 m0, 148608
    s_nop 0
    buffer_load_dwordx4 v12, s[52:55], 0 offen offset:128 lds
    s_mov_b32 m0, 149504
    s_nop 0
    buffer_load_dwordx4 v12, s[52:55], 0 offen offset:256 lds
    s_mov_b32 m0, 150400
    s_nop 0
    buffer_load_dwordx4 v12, s[52:55], 0 offen offset:384 lds
    s_mov_b32 m0, 151296
    s_nop 0
    buffer_load_dwordx4 v12, s[52:55], 0 offen offset:512 lds
    s_mov_b32 m0, 152192
    s_nop 0
    buffer_load_dwordx4 v12, s[52:55], 0 offen offset:640 lds
    s_mov_b32 m0, 153088
    s_nop 0
    buffer_load_dwordx4 v12, s[52:55], 0 offen offset:768 lds
    s_mov_b32 m0, 153984
    s_nop 0
    buffer_load_dwordx4 v12, s[52:55], 0 offen offset:896 lds
    s_mov_b32 m0, 154880
    s_nop 0
    buffer_load_dwordx4 v12, s[52:55], 0 offen offset:1024 lds
    v_mov_b32 v13, 1
    s_mov_b64 exec, 1
    ds_add_u32 v1, v13 offset:40
    s_mov_b64 exec, -1
    s_cmp_lg_u32 s14, 0
    s_cbranch_scc1 SEL_OK
    v_sub_u32 v16, v80, v9
    v_sub_u32 v17, v81, v9
    v_sub_u32 v18, v82, v9
    v_sub_u32 v19, v83, v9
    v_sub_u32 v20, v84, v9
    v_sub_u32 v21, v85, v9
    v_sub_u32 v22, v86, v9
    v_sub_u32 v23, v87, v9
    v_sub_u32 v24, v88, v9
    v_sub_u32 v25, v89, v9
    v_sub_u32 v26, v90, v9
    v_sub_u32 v27, v91, v9
    v_sub_u32 v28, v92, v9
    v_sub_u32 v29, v93, v9
    v_sub_u32 v30, v94, v9
    v_sub_u32 v31, v95, v9
    v_sub_u32 v32, v96, v9
    v_sub_u32 v33, v97, v9
    v_sub_u32 v34, v98, v9
    v_sub_u32 v35, v99, v9
    v_sub_u32 v36, v100, v9
    v_sub_u32 v37, v101, v9
    v_sub_u32 v38, v102, v9
    v_sub_u32 v39, v103, v9
    v_sub_u32 v40, v104, v9
    v_sub_u32 v41, v105, v9
    v_sub_u32 v42, v106, v9
    v_sub_u32 v43, v107, v9
    v_sub_u32 v44, v108, v9
    v_sub_u32 v45, v109, v9
    v_sub_u32 v46, v110, v9
    v_sub_u32 v47, v111, v9
    v_max3_u32 v16, v16, v17, v18
    v_max3_u32 v19, v19, v20, v21
    v_max3_u32 v22, v22, v23, v24
    v_max3_u32 v25, v25, v26, v27
    v_max3_u32 v28, v28, v29, v30
    v_max3_u32 v31, v31, v32, v33
    v_max3_u32 v34, v34, v35, v36
    v_max3_u32 v37, v37, v38, v39
    v_max3_u32 v40, v40, v41, v42
    v_max3_u32 v43, v43, v44, v45
    v_max3_u32 v16, v16, v19, v22
    v_max3_u32 v25, v25, v28, v31
    v_max3_u32 v34, v34, v37, v40
    v_max3_u32 v43, v43, v46, v47
    v_max3_u32 v16, v16, v25, v34
    v_max_u32 v16, v16, v43
    v_add_u32 v16, v16, v9
    v_cmp_lt_u32 vcc, s12, v16
    s_cmp_eq_u64 vcc, 0
    s_cbranch_scc1 SEL_OK
    s_waitcnt vmcnt(0)
    s_mov_b32 s12, 0
    s_mov_b64 s[56:57], 0xff
SEL_SLOW:
    v_subrev_u32 v16, s12, v80
    v_subrev_u32 v17, s12, v81
    v_subrev_u32 v18, s12, v82
    v_subrev_u32 v19, s12, v83
    v_subrev_u32 v20, s12, v84
    v_subrev_u32 v21, s12, v85
    v_subrev_u32 v22, s12, v86
    v_subrev_u32 v23, s12, v87
    v_subrev_u32 v24, s12, v88
    v_subrev_u32 v25, s12, v89
    v_subrev_u32 v26, s12, v90
    v_subrev_u32 v27, s12, v91
    v_subrev_u32 v28, s12, v92
    v_subrev_u32 v29, s12, v93
    v_subrev_u32 v30, s12, v94
    v_subrev_u32 v31, s12, v95
    v_subrev_u32 v32, s12, v96
    v_subrev_u32 v33, s12, v97
    v_subrev_u32 v34, s12, v98
    v_subrev_u32 v35, s12, v99
    v_subrev_u32 v36, s12, v100
    v_subrev_u32 v37, s12, v101
    v_subrev_u32 v38, s12, v102
    v_subrev_u32 v39, s12, v103
    v_subrev_u32 v40, s12, v104
    v_subrev_u32 v41, s12, v105
    v_subrev_u32 v42, s12, v106
    v_subrev_u32 v43, s12, v107
    v_subrev_u32 v44, s12, v108
    v_subrev_u32 v45, s12, v109
    v_subrev_u32 v46, s12, v110
    v_subrev_u32 v47, s12, v111
    v_max3_u32 v16, v16, v17, v18
    v_max3_u32 v19, v19, v20, v21
    v_max3_u32 v22, v22, v23, v24
    v_max3_u32 v25, v25, v26, v27
    v_max3_u32 v28, v28, v29, v30
    v_max3_u32 v31, v31, v32, v33
    v_max3_u32 v34, v34, v35, v36
    v_max3_u32 v37, v37, v38, v39
    v_max3_u32 v40, v40, v41, v42
    v_max3_u32 v43, v43, v44, v45
    v_max3_u32 v16, v16, v19, v22
    v_max3_u32 v25, v25, v28, v31
    v_max3_u32 v34, v34, v37, v40
    v_max3_u32 v43, v43, v46, v47
    v_max3_u32 v16, v16, v25, v34
    v_max_u32 v16, v16, v43
    s_nop 1
    v_max_u32_dpp v16, v16, v16 row_shr:1 row_mask:0xf bank_mask:0xf
    s_nop 1
    v_max_u32_dpp v16, v16, v16 row_shr:2 row_mask:0xf bank_mask:0xf
    s_nop 1
    v_max_u32_dpp v16, v16, v16 row_shr:4 row_mask:0xf bank_mask:0xf
    s_nop 1
    v_max_u32_dpp v16, v16, v16 row_shr:8 row_mask:0xf bank_mask:0xf
    s_nop 1
    v_max_u32_dpp v16, v16, v16 row_bcast:15 row_mask:0xa bank_mask:0xf
    s_nop 1
    v_max_u32_dpp v16, v16, v16 row_bcast:31 row_mask:0xc bank_mask:0xf
    s_nop 0
    v_readlane_b32 s8, v16, 63
    s_add_u32 s12, s12, s8
    s_and_b32 s13, s12, 0x7ff
    s_sub_u32 s13, 2047, s13
    s_mul_i32 s13, s13, 1152
    s_mov_b64 exec, s[56:57]
    v_add_u32 v12, s13, v5
    v_mov_b32 v6, s12
    s_mov_b64 exec, -1
    s_lshl_b64 s[56:57], s[56:57], 8
    s_add_u32 s14, s14, 1
    s_cmp_lt_u32 s14, 8
    s_cbranch_scc1 SEL_SLOW
    s_branch SEL_GATHER
SEL_OK:
    s_cmp_lg_u32 s2, 0
    s_cbranch_scc1 SEL_NOPUB
    v_mov_b32 v7, v14
    v_add_u32 v8, 8192, v2
    s_mov_b32 exec_lo, 0x01010101
    s_mov_b32 exec_hi, 0x01010101
    global_store_dwordx2 v8, v[6:7], s[50:51] sc1
    s_mov_b64 exec, 1
    global_store_dword v8, v14, s[50:51] offset:256 sc1
    s_mov_b64 exec, -1
    s_waitcnt vmcnt(2)
    s_branch SEL_END
SEL_NOPUB:
    s_waitcnt vmcnt(0)
SEL_END:
    v_mov_b32 v8, 3
    ds_write_b32 v1, v8 offset:84
    s_endpgm
F_COMP:
F_COMP2:
    s_and_b32 s12, s3, 3
    v_lshrrev_b32 v5, 2, v3
    v_bfe_u32 v7, v3, 3, 1
    v_and_b32 v13, 1, v4
    v_lshl_or_b32 v14, v13, 1, v7
    v_and_b32 v15, 7, v3
    v_mul_u32_u24 v16, 144, v15
    v_add_u32 v16, 156928, v16
    s_mov_b32 s56, 0xff00ff00
    s_mov_b32 s57, 0xff00ff00
    s_lshr_b32 s8, s3, 2
    s_cmp_lg_u32 s8, 1
    s_cbranch_scc1 F_DOWN
    v_bfe_u32 v6, v3, 1, 1
    v_lshl_or_b32 v8, v6, 2, v14
    v_xor_b32 v8, s12, v8
    v_lshlrev_b32 v8, 4, v8
    v_lshl_add_u32 v8, v5, 7, v8
    v_lshl_add_u32 v8, v6, 10, v8
    v_lshl_add_u32 v8, v4, 11, v8
    v_and_b32 v9, 1, v3
    v_lshl_add_u32 v8, v9, 3, v8
    v_xor_b32 v9, 64, v8
    v_add_u32 v10, 49408, v8
    v_add_u32 v11, 49408, v9
    v_lshlrev_b32 v6, 2, v13
    v_lshrrev_b32 v5, 1, v4
    v_add_u32 v6, v6, v5
    v_lshl_add_u32 v6, v7, 5, v6
    s_lshl_b32 s8, s12, 3
    v_add_lshl_u32 v6, v6, s8, 1
    v_add_u32 v5, v6, v16
    v_and_b32 v6, 6, v3
    v_xor_b32 v6, v6, v4
    v_lshlrev_b32 v6, 4, v6
    v_lshl_add_u32 v6, v15, 7, v6
    v_add_u32 v6, 147712, v6
    v_xor_b32 v7, 64, v6
    s_mov_b32 s9, 0
SP_28:
    ds_read_b32 v12, v1 offset:16
    s_waitcnt lgkmcnt(0)
    v_readfirstlane_b32 s8, v12
    s_add_u32 s9, s9, 1
    s_cmp_ge_u32 s8, 3
    s_cbranch_scc1 SP_28_D
    s_sleep 1
    s_cmp_lt_u32 s9, 524288
    s_cbranch_scc1 SP_28
SP_28_D:
    ds_read_b64_tr_b16 v[24:25], v8 offset:256
    ds_read_b64_tr_b16 v[26:27], v8 offset:768
    ds_read_b64_tr_b16 v[28:29], v9 offset:256
    ds_read_b64_tr_b16 v[30:31], v9 offset:768
    ds_read_b64_tr_b16 v[32:33], v8 offset:8448
    ds_read_b64_tr_b16 v[34:35], v8 offset:8960
    ds_read_b64_tr_b16 v[36:37], v9 offset:8448
    ds_read_b64_tr_b16 v[38:39], v9 offset:8960
    ds_read_b64_tr_b16 v[40:41], v8 offset:16640
    ds_read_b64_tr_b16 v[42:43], v8 offset:17152
    ds_read_b64_tr_b16 v[44:45], v9 offset:16640
    ds_read_b64_tr_b16 v[46:47], v9 offset:17152
    s_waitcnt lgkmcnt(0)
    v_mov_b32 v12, 1
    s_mov_b64 exec, 1
    ds_add_u32 v1, v12 offset:48
    s_mov_b64 exec, -1
    s_mov_b32 s9, 0
SP_29:
    ds_read_b32 v12, v1 offset:20
    s_waitcnt lgkmcnt(0)
    v_readfirstlane_b32 s8, v12
    s_add_u32 s9, s9, 1
    s_cmp_ge_u32 s8, 3
    s_cbranch_scc1 SP_29_D
    s_sleep 1
    s_cmp_lt_u32 s9, 524288
    s_cbranch_scc1 SP_29
SP_29_D:
    ds_read_b64_tr_b16 v[48:49], v8 offset:24832
    ds_read_b64_tr_b16 v[50:51], v8 offset:25344
    ds_read_b64_tr_b16 v[52:53], v9 offset:24832
    ds_read_b64_tr_b16 v[54:55], v9 offset:25344
    ds_read_b64_tr_b16 v[56:57], v8 offset:33024
    ds_read_b64_tr_b16 v[58:59], v8 offset:33536
    ds_read_b64_tr_b16 v[60:61], v9 offset:33024
    ds_read_b64_tr_b16 v[62:63], v9 offset:33536
    ds_read_b64_tr_b16 v[64:65], v8 offset:41216
    ds_read_b64_tr_b16 v[66:67], v8 offset:41728
    ds_read_b64_tr_b16 v[68:69], v9 offset:41216
    ds_read_b64_tr_b16 v[70:71], v9 offset:41728
    s_waitcnt lgkmcnt(0)
    v_mov_b32 v12, 1
    s_mov_b64 exec, 1
    ds_add_u32 v1, v12 offset:52
    s_mov_b64 exec, -1
    s_mov_b32 s9, 0
SP_30:
    ds_read_b32 v12, v1 offset:24
    s_waitcnt lgkmcnt(0)
    v_readfirstlane_b32 s8, v12
    s_add_u32 s9, s9, 1
    s_cmp_ge_u32 s8, 3
    s_cbranch_scc1 SP_30_D
    s_sleep 1
    s_cmp_lt_u32 s9, 524288
    s_cbranch_scc1 SP_30
SP_30_D:
    ds_read_b64_tr_b16 v[72:73], v10 offset:0
    ds_read_b64_tr_b16 v[74:75], v10 offset:512
    ds_read_b64_tr_b16 v[76:77], v11 offset:0
    ds_read_b64_tr_b16 v[78:79], v11 offset:512
    ds_read_b64_tr_b16 v[80:81], v10 offset:8192
    ds_read_b64_tr_b16 v[82:83], v10 offset:8704
    ds_read_b64_tr_b16 v[84:85], v11 offset:8192
    ds_read_b64_tr_b16 v[86:87], v11 offset:8704
    ds_read_b64_tr_b16 v[88:89], v10 offset:16384
    ds_read_b64_tr_b16 v[90:91], v10 offset:16896
    ds_read_b64_tr_b16 v[92:93], v11 offset:16384
    ds_read_b64_tr_b16 v[94:95], v11 offset:16896
    s_waitcnt lgkmcnt(0)
    v_mov_b32 v12, 1
    s_mov_b64 exec, 1
    ds_add_u32 v1, v12 offset:56
    s_mov_b64 exec, -1
    s_mov_b32 s9, 0
SP_31:
    ds_read_b32 v12, v1 offset:28
    s_waitcnt lgkmcnt(0)
    v_readfirstlane_b32 s8, v12
    s_add_u32 s9, s9, 1
    s_cmp_ge_u32 s8, 3
    s_cbranch_scc1 SP_31_D
    s_sleep 1
    s_cmp_lt_u32 s9, 524288
    s_cbranch_scc1 SP_31
SP_31_D:
    ds_read_b64_tr_b16 v[96:97], v8 offset:256
    ds_read_b64_tr_b16 v[98:99], v8 offset:768
    ds_read_b64_tr_b16 v[100:101], v9 offset:256
    ds_read_b64_tr_b16 v[102:103], v9 offset:768
    ds_read_b64_tr_b16 v[104:105], v8 offset:8448
    ds_read_b64_tr_b16 v[106:107], v8 offset:8960
    ds_read_b64_tr_b16 v[108:109], v9 offset:8448
    ds_read_b64_tr_b16 v[110:111], v9 offset:8960
    ds_read_b64_tr_b16 v[112:113], v8 offset:16640
    ds_read_b64_tr_b16 v[114:115], v8 offset:17152
    ds_read_b64_tr_b16 v[116:117], v9 offset:16640
    ds_read_b64_tr_b16 v[118:119], v9 offset:17152
    s_mov_b32 s9, 0
SP_32:
    ds_read_b32 v12, v1 offset:32
    s_waitcnt lgkmcnt(0)
    v_readfirstlane_b32 s8, v12
    s_add_u32 s9, s9, 1
    s_cmp_ge_u32 s8, 3
    s_cbranch_scc1 SP_32_D
    s_sleep 1
    s_cmp_lt_u32 s9, 524288
    s_cbranch_scc1 SP_32
SP_32_D:
    ds_read_b64_tr_b16 v[120:121], v8 offset:24832
    ds_read_b64_tr_b16 v[122:123], v8 offset:25344
    ds_read_b64_tr_b16 v[124:125], v9 offset:24832
    ds_read_b64_tr_b16 v[126:127], v9 offset:25344
    ds_read_b64_tr_b16 v[128:129], v8 offset:33024
    ds_read_b64_tr_b16 v[130:131], v8 offset:33536
    ds_read_b64_tr_b16 v[132:133], v9 offset:33024
    ds_read_b64_tr_b16 v[134:135], v9 offset:33536
    ds_read_b64_tr_b16 v[136:137], v8 offset:41216
    ds_read_b64_tr_b16 v[138:139], v8 offset:41728
    ds_read_b64_tr_b16 v[140:141], v9 offset:41216
    ds_read_b64_tr_b16 v[142:143], v9 offset:41728
    s_mov_b32 s9, 0
SP_33:
    ds_read_b32 v12, v1 offset:36
    s_waitcnt lgkmcnt(0)
    v_readfirstlane_b32 s8, v12
    s_add_u32 s9, s9, 1
    s_cmp_ge_u32 s8, 3
    s_cbranch_scc1 SP_33_D
    s_sleep 1
    s_cmp_lt_u32 s9, 524288
    s_cbranch_scc1 SP_33
SP_33_D:
    ds_read_b64_tr_b16 v[144:145], v10 offset:0
    ds_read_b64_tr_b16 v[146:147], v10 offset:512
    ds_read_b64_tr_b16 v[148:149], v11 offset:0
    ds_read_b64_tr_b16 v[150:151], v11 offset:512
    ds_read_b64_tr_b16 v[152:153], v10 offset:8192
    ds_read_b64_tr_b16 v[154:155], v10 offset:8704
    ds_read_b64_tr_b16 v[156:157], v11 offset:8192
    ds_read_b64_tr_b16 v[158:159], v11 offset:8704
    ds_read_b64_tr_b16 v[160:161], v10 offset:16384
    ds_read_b64_tr_b16 v[162:163], v10 offset:16896
    ds_read_b64_tr_b16 v[164:165], v11 offset:16384
    ds_read_b64_tr_b16 v[166:167], v11 offset:16896
    s_setprio 3
    s_mov_b32 s9, 0
SP_34:
    ds_read_b32 v12, v1 offset:84
    s_waitcnt lgkmcnt(0)
    v_readfirstlane_b32 s8, v12
    s_add_u32 s9, s9, 1
    s_cmp_ge_u32 s8, 1
    s_cbranch_scc1 SP_34_D
    s_cmp_lt_u32 s9, 524288
    s_cbranch_scc1 SP_34
SP_34_D:
    ds_read_b128 v[16:19], v6 offset:0
    ds_read_b128 v[20:23], v7 offset:0
    s_waitcnt lgkmcnt(1)
    v_mfma_f32_16x16x32_bf16 v[8:11], v[24:27], v[16:19], 0
    ds_read_b128 v[24:27], v6 offset:1024
    v_mfma_f32_16x16x32_bf16 v[12:15], v[28:31], v[16:19], 0
    ds_read_b128 v[28:31], v7 offset:1024
    s_waitcnt lgkmcnt(2)
    v_mfma_f32_16x16x32_bf16 v[8:11], v[32:35], v[20:23], v[8:11]
    ds_read_b128 v[32:35], v6 offset:2048
    v_mfma_f32_16x16x32_bf16 v[12:15], v[36:39], v[20:23], v[12:15]
    ds_read_b128 v[36:39], v7 offset:2048
    s_waitcnt lgkmcnt(3)
    v_mfma_f32_16x16x32_bf16 v[8:11], v[40:43], v[24:27], v[8:11]
    ds_read_b128 v[40:43], v6 offset:3072
    v_mfma_f32_16x16x32_bf16 v[12:15], v[44:47], v[24:27], v[12:15]
    ds_read_b128 v[44:47], v7 offset:3072
    s_waitcnt lgkmcnt(4)
    v_mfma_f32_16x16x32_bf16 v[8:11], v[48:51], v[28:31], v[8:11]
    ds_read_b128 v[48:51], v6 offset:4096
    v_mfma_f32_16x16x32_bf16 v[12:15], v[52:55], v[28:31], v[12:15]
    ds_read_b128 v[52:55], v7 offset:4096
    s_waitcnt lgkmcnt(5)
    v_mfma_f32_16x16x32_bf16 v[8:11], v[56:59], v[32:35], v[8:11]
    ds_read_b128 v[56:59], v6 offset:5120
    v_mfma_f32_16x16x32_bf16 v[12:15], v[60:63], v[32:35], v[12:15]
    ds_read_b128 v[60:63], v7 offset:5120
    s_waitcnt lgkmcnt(6)
    v_mfma_f32_16x16x32_bf16 v[8:11], v[64:67], v[36:39], v[8:11]
    ds_read_b128 v[64:67], v6 offset:6144
    v_mfma_f32_16x16x32_bf16 v[12:15], v[68:71], v[36:39], v[12:15]
    ds_read_b128 v[68:71], v7 offset:6144
    s_waitcnt lgkmcnt(7)
    v_mfma_f32_16x16x32_bf16 v[8:11], v[72:75], v[40:43], v[8:11]
    ds_read_b128 v[72:75], v6 offset:7168
    v_mfma_f32_16x16x32_bf16 v[12:15], v[76:79], v[40:43], v[12:15]
    ds_read_b128 v[76:79], v7 offset:7168
    s_waitcnt lgkmcnt(8)
    v_mfma_f32_16x16x32_bf16 v[8:11], v[80:83], v[44:47], v[8:11]
    ds_read_b128 v[80:83], v6 offset:8192
    v_mfma_f32_16x16x32_bf16 v[12:15], v[84:87], v[44:47], v[12:15]
    ds_read_b128 v[84:87], v7 offset:8192
    s_waitcnt lgkmcnt(9)
    v_mfma_f32_16x16x32_bf16 v[8:11], v[88:91], v[48:51], v[8:11]
    v_mfma_f32_16x16x32_bf16 v[12:15], v[92:95], v[48:51], v[12:15]
    s_waitcnt lgkmcnt(8)
    v_mfma_f32_16x16x32_bf16 v[8:11], v[96:99], v[52:55], v[8:11]
    v_mfma_f32_16x16x32_bf16 v[12:15], v[100:103], v[52:55], v[12:15]
    s_waitcnt lgkmcnt(7)
    v_mfma_f32_16x16x32_bf16 v[8:11], v[104:107], v[56:59], v[8:11]
    v_mfma_f32_16x16x32_bf16 v[12:15], v[108:111], v[56:59], v[12:15]
    s_waitcnt lgkmcnt(6)
    v_mfma_f32_16x16x32_bf16 v[8:11], v[112:115], v[60:63], v[8:11]
    v_mfma_f32_16x16x32_bf16 v[12:15], v[116:119], v[60:63], v[12:15]
    s_waitcnt lgkmcnt(5)
    v_mfma_f32_16x16x32_bf16 v[8:11], v[120:123], v[64:67], v[8:11]
    v_mfma_f32_16x16x32_bf16 v[12:15], v[124:127], v[64:67], v[12:15]
    s_waitcnt lgkmcnt(4)
    v_mfma_f32_16x16x32_bf16 v[8:11], v[128:131], v[68:71], v[8:11]
    v_mfma_f32_16x16x32_bf16 v[12:15], v[132:135], v[68:71], v[12:15]
    s_waitcnt lgkmcnt(3)
    v_mfma_f32_16x16x32_bf16 v[8:11], v[136:139], v[72:75], v[8:11]
    v_mfma_f32_16x16x32_bf16 v[12:15], v[140:143], v[72:75], v[12:15]
    s_waitcnt lgkmcnt(2)
    v_mfma_f32_16x16x32_bf16 v[8:11], v[144:147], v[76:79], v[8:11]
    v_mfma_f32_16x16x32_bf16 v[12:15], v[148:151], v[76:79], v[12:15]
    s_waitcnt lgkmcnt(1)
    v_mfma_f32_16x16x32_bf16 v[8:11], v[152:155], v[80:83], v[8:11]
    v_mfma_f32_16x16x32_bf16 v[12:15], v[156:159], v[80:83], v[12:15]
    s_waitcnt lgkmcnt(0)
    v_mfma_f32_16x16x32_bf16 v[8:11], v[160:163], v[84:87], v[8:11]
    v_mfma_f32_16x16x32_bf16 v[12:15], v[164:167], v[84:87], v[12:15]
    s_nop 7
    v_cndmask_b32 v8, v8, v12, s[56:57]
    v_cndmask_b32 v9, v9, v13, s[56:57]
    v_cndmask_b32 v10, v10, v14, s[56:57]
    v_cndmask_b32 v11, v11, v15, s[56:57]
    v_permlane32_swap_b32 v8, v9
    s_nop 0
    v_permlane32_swap_b32 v10, v11
    v_cvt_pk_bf16_f32 v9, v8, v9
    v_cvt_pk_bf16_f32 v11, v10, v11
    v_lshlrev_b32 v8, 16, v9
    v_lshlrev_b32 v10, 16, v11
    v_mul_f32 v12, 0xbfb8aa3b, v8
    v_mul_f32 v13, 0xbfb8aa3b, v10
    v_exp_f32 v12, v12
    v_exp_f32 v13, v13
    v_and_b32 v9, 0xffff0000, v9
    v_and_b32 v11, 0xffff0000, v11
    v_add_f32 v12, 1.0, v12
    v_add_f32 v13, 1.0, v13
    v_rcp_f32 v12, v12
    v_rcp_f32 v13, v13
    v_mul_f32 v8, v8, v12
    v_mul_f32 v10, v10, v13
    v_cvt_pk_bf16_f32 v8, v8, v8
    v_cvt_pk_bf16_f32 v10, v10, v10
    v_and_b32 v8, 0xffff0000, v8
    v_and_b32 v10, 0xffff0000, v10
    v_mul_f32 v8, v8, v9
    v_mul_f32 v10, v10, v11
    v_cvt_pk_bf16_f32 v8, v8, v10
    ds_write_b16 v5, v8
    ds_write_b16_d16_hi v5, v8 offset:4
    s_waitcnt lgkmcnt(0)
    s_barrier
    s_endpgm
F_DOWN:
    v_lshl_add_u32 v10, v4, 4, v16
    v_mul_u32_u24 v8, 9216, v4
    s_mul_i32 s13, s7, 73728
    s_mov_b32 s60, 0x7060500
    s_mov_b32 s61, 0x7060501
    s_mov_b32 s62, 0x7060502
    s_mov_b32 s63, 0x7060503
    s_mov_b32 s64, 0x05040100
    s_mov_b32 s65, 0x07060302
    s_lshl_b32 s14, s7, 7
    s_add_u32 s14, s14, 32768
    v_lshl_add_u32 v11, v15, 4, s14
    s_waitcnt lgkmcnt(0)
    s_mov_b32 s52, s50
    s_mov_b32 s53, s51
    s_mov_b32 s54, 268435456
    s_mov_b32 s55, 0x20000
    s_mov_b32 s68, s42
    s_mov_b32 s69, s43
    s_mov_b32 s70, 5308416
    s_mov_b32 s71, 0x20000
    s_cmp_eq_u32 s3, 9
    s_cbranch_scc1 F_DN2
    v_lshl_add_u32 v8, v3, 4, v8
    s_lshl_b32 s8, s3, 8
    s_add_u32 s13, s13, s8
    s_lshl_b32 s8, s3, 5
    v_lshl_add_u32 v6, v4, 3, v7
    v_add_u32 v6, s8, v6
    v_mul_u32_u24 v6, 9216, v6
    v_add_u32 v11, v6, v11
    s_mov_b32 s9, 0
SP_35:
    ds_read_b32 v17, v1 offset:8
    s_waitcnt lgkmcnt(0)
    v_readfirstlane_b32 s8, v17
    s_add_u32 s9, s9, 1
    s_cmp_lg_u32 s8, 0
    s_cbranch_scc1 SP_35_D
    s_sleep 2
    s_cmp_lt_u32 s9, 524288
    s_cbranch_scc1 SP_35
SP_35_D:
    s_mov_b32 s9, 0
SP_36:
    ds_read_b32 v12, v1 offset:40
    s_waitcnt lgkmcnt(0)
    v_readfirstlane_b32 s8, v12
    s_add_u32 s9, s9, 1
    s_cmp_ge_u32 s8, 3
    s_cbranch_scc1 SP_36_D
    s_sleep 1
    s_cmp_lt_u32 s9, 524288
    s_cbranch_scc1 SP_36
SP_36_D:
    s_setprio 2
    buffer_load_dwordx4 v[24:27], v8, s[68:71], s13 offen offset:0
    buffer_load_dwordx4 v[28:31], v8, s[68:71], s13 offen offset:1152
    buffer_load_dwordx4 v[32:35], v8, s[68:71], s13 offen offset:2304
    buffer_load_dwordx4 v[36:39], v8, s[68:71], s13 offen offset:3456
    s_add_u32 s13, s13, 4608
    s_mov_b32 s9, 0
SP_37:
    ds_read_b32 v12, v1 offset:40
    s_waitcnt lgkmcnt(0)
    v_readfirstlane_b32 s8, v12
    s_add_u32 s9, s9, 1
    s_cmp_ge_u32 s8, 4
    s_cbranch_scc1 SP_37_D
    s_sleep 1
    s_cmp_lt_u32 s9, 524288
    s_cbranch_scc1 SP_37
SP_37_D:
    buffer_load_dwordx4 v[40:43], v8, s[68:71], s13 offen offset:0
    buffer_load_dwordx4 v[44:47], v8, s[68:71], s13 offen offset:1152
    buffer_load_dwordx4 v[48:51], v8, s[68:71], s13 offen offset:2304
    buffer_load_dwordx4 v[52:55], v8, s[68:71], s13 offen offset:3456
    s_add_u32 s13, s13, 32256
    buffer_load_dwordx4 v[88:91], v8, s[68:71], s13 offen offset:0
    buffer_load_dwordx4 v[92:95], v8, s[68:71], s13 offen offset:1152
    buffer_load_dwordx4 v[96:99], v8, s[68:71], s13 offen offset:2304
    buffer_load_dwordx4 v[100:103], v8, s[68:71], s13 offen offset:3456
    s_add_u32 s13, s13, 4608
    buffer_load_dwordx4 v[104:107], v8, s[68:71], s13 offen offset:0
    buffer_load_dwordx4 v[108:111], v8, s[68:71], s13 offen offset:1152
    buffer_load_dwordx4 v[112:115], v8, s[68:71], s13 offen offset:2304
    buffer_load_dwordx4 v[116:119], v8, s[68:71], s13 offen offset:3456
    s_add_u32 s13, s13, 32256
    s_waitcnt vmcnt(14)
    v_perm_b32 v56, v28, v24, s64
    v_perm_b32 v60, v28, v24, s65
    v_perm_b32 v64, v29, v25, s64
    v_perm_b32 v68, v29, v25, s65
    v_perm_b32 v72, v30, v26, s64
    v_perm_b32 v76, v30, v26, s65
    v_perm_b32 v80, v31, v27, s64
    v_perm_b32 v84, v31, v27, s65
    s_waitcnt vmcnt(12)
    v_perm_b32 v57, v36, v32, s64
    v_perm_b32 v61, v36, v32, s65
    v_perm_b32 v65, v37, v33, s64
    v_perm_b32 v69, v37, v33, s65
    v_perm_b32 v73, v38, v34, s64
    v_perm_b32 v77, v38, v34, s65
    v_perm_b32 v81, v39, v35, s64
    v_perm_b32 v85, v39, v35, s65
    s_waitcnt vmcnt(10)
    v_perm_b32 v58, v44, v40, s64
    v_perm_b32 v62, v44, v40, s65
    v_perm_b32 v66, v45, v41, s64
    v_perm_b32 v70, v45, v41, s65
    v_perm_b32 v74, v46, v42, s64
    v_perm_b32 v78, v46, v42, s65
    v_perm_b32 v82, v47, v43, s64
    v_perm_b32 v86, v47, v43, s65
    s_waitcnt vmcnt(8)
    v_perm_b32 v59, v52, v48, s64
    v_perm_b32 v63, v52, v48, s65
    v_perm_b32 v67, v53, v49, s64
    v_perm_b32 v71, v53, v49, s65
    v_perm_b32 v75, v54, v50, s64
    v_perm_b32 v79, v54, v50, s65
    v_perm_b32 v83, v55, v51, s64
    v_perm_b32 v87, v55, v51, s65
    s_waitcnt vmcnt(6)
    v_perm_b32 v24, v92, v88, s64
    v_perm_b32 v28, v92, v88, s65
    v_perm_b32 v32, v93, v89, s64
    v_perm_b32 v36, v93, v89, s65
    v_perm_b32 v40, v94, v90, s64
    v_perm_b32 v44, v94, v90, s65
    v_perm_b32 v48, v95, v91, s64
    v_perm_b32 v52, v95, v91, s65
    s_waitcnt vmcnt(4)
    v_perm_b32 v25, v100, v96, s64
    v_perm_b32 v29, v100, v96, s65
    v_perm_b32 v33, v101, v97, s64
    v_perm_b32 v37, v101, v97, s65
    v_perm_b32 v41, v102, v98, s64
    v_perm_b32 v45, v102, v98, s65
    v_perm_b32 v49, v103, v99, s64
    v_perm_b32 v53, v103, v99, s65
    s_waitcnt vmcnt(2)
    v_perm_b32 v26, v108, v104, s64
    v_perm_b32 v30, v108, v104, s65
    v_perm_b32 v34, v109, v105, s64
    v_perm_b32 v38, v109, v105, s65
    v_perm_b32 v42, v110, v106, s64
    v_perm_b32 v46, v110, v106, s65
    v_perm_b32 v50, v111, v107, s64
    v_perm_b32 v54, v111, v107, s65
    s_waitcnt vmcnt(0)
    v_perm_b32 v27, v116, v112, s64
    v_perm_b32 v31, v116, v112, s65
    v_perm_b32 v35, v117, v113, s64
    v_perm_b32 v39, v117, v113, s65
    v_perm_b32 v43, v118, v114, s64
    v_perm_b32 v47, v118, v114, s65
    v_perm_b32 v51, v119, v115, s64
    v_perm_b32 v55, v119, v115, s65
    s_barrier
    ds_read_b128 v[152:155], v10 offset:0
    ds_read_b128 v[156:159], v10 offset:64
    s_waitcnt lgkmcnt(0)
    v_mfma_f32_16x16x32_bf16 v[120:123], v[56:59], v[152:155], 0
    v_mfma_f32_16x16x32_bf16 v[120:123], v[24:27], v[156:159], v[120:123]
    v_mfma_f32_16x16x32_bf16 v[124:127], v[60:63], v[152:155], 0
    v_mfma_f32_16x16x32_bf16 v[124:127], v[28:31], v[156:159], v[124:127]
    v_mfma_f32_16x16x32_bf16 v[128:131], v[64:67], v[152:155], 0
    v_mfma_f32_16x16x32_bf16 v[128:131], v[32:35], v[156:159], v[128:131]
    v_mfma_f32_16x16x32_bf16 v[132:135], v[68:71], v[152:155], 0
    v_mfma_f32_16x16x32_bf16 v[132:135], v[36:39], v[156:159], v[132:135]
    v_mfma_f32_16x16x32_bf16 v[136:139], v[72:75], v[152:155], 0
    v_mfma_f32_16x16x32_bf16 v[136:139], v[40:43], v[156:159], v[136:139]
    v_mfma_f32_16x16x32_bf16 v[140:143], v[76:79], v[152:155], 0
    v_mfma_f32_16x16x32_bf16 v[140:143], v[44:47], v[156:159], v[140:143]
    v_mfma_f32_16x16x32_bf16 v[144:147], v[80:83], v[152:155], 0
    v_mfma_f32_16x16x32_bf16 v[144:147], v[48:51], v[156:159], v[144:147]
    v_mfma_f32_16x16x32_bf16 v[148:151], v[84:87], v[152:155], 0
    v_mfma_f32_16x16x32_bf16 v[148:151], v[52:55], v[156:159], v[148:151]
    s_nop 1
    v_cndmask_b32 v88, v120, v136, s[56:57]
    s_nop 0
    v_cndmask_b32 v89, v124, v140, s[56:57]
    s_nop 0
    v_cndmask_b32 v90, v128, v144, s[56:57]
    s_nop 0
    v_cndmask_b32 v91, v132, v148, s[56:57]
    v_perm_b32 v88, v88, v17, s60
    v_perm_b32 v89, v89, v17, s61
    v_perm_b32 v90, v90, v17, s62
    v_perm_b32 v91, v91, v17, s63
    s_mov_b32 s12, 0
    buffer_store_dwordx4 v[88:91], v11, s[52:55], s12 offen sc1
    v_cndmask_b32 v92, v121, v137, s[56:57]
    v_cndmask_b32 v93, v125, v141, s[56:57]
    v_cndmask_b32 v94, v129, v145, s[56:57]
    v_cndmask_b32 v95, v133, v149, s[56:57]
    v_perm_b32 v92, v92, v17, s60
    v_perm_b32 v93, v93, v17, s61
    v_perm_b32 v94, v94, v17, s62
    v_perm_b32 v95, v95, v17, s63
    s_mov_b32 s12, 18432
    buffer_store_dwordx4 v[92:95], v11, s[52:55], s12 offen sc1
    v_cndmask_b32 v96, v122, v138, s[56:57]
    v_cndmask_b32 v97, v126, v142, s[56:57]
    v_cndmask_b32 v98, v130, v146, s[56:57]
    v_cndmask_b32 v99, v134, v150, s[56:57]
    v_perm_b32 v96, v96, v17, s60
    v_perm_b32 v97, v97, v17, s61
    v_perm_b32 v98, v98, v17, s62
    v_perm_b32 v99, v99, v17, s63
    s_mov_b32 s12, 36864
    buffer_store_dwordx4 v[96:99], v11, s[52:55], s12 offen sc1
    v_cndmask_b32 v100, v123, v139, s[56:57]
    v_cndmask_b32 v101, v127, v143, s[56:57]
    v_cndmask_b32 v102, v131, v147, s[56:57]
    v_cndmask_b32 v103, v135, v151, s[56:57]
    v_perm_b32 v100, v100, v17, s60
    v_perm_b32 v101, v101, v17, s61
    v_perm_b32 v102, v102, v17, s62
    v_perm_b32 v103, v103, v17, s63
    s_mov_b32 s12, 55296
    buffer_store_dwordx4 v[100:103], v11, s[52:55], s12 offen sc1
    s_endpgm
F_DN2:
    v_lshl_add_u32 v8, v3, 3, v8
    s_add_u32 s13, s13, 1024
    v_lshl_add_u32 v6, v4, 2, v7
    v_add_u32 v6, 128, v6
    v_mul_u32_u24 v6, 9216, v6
    v_add_u32 v11, v6, v11
    s_mov_b32 s9, 0
SP_38:
    ds_read_b32 v17, v1 offset:8
    s_waitcnt lgkmcnt(0)
    v_readfirstlane_b32 s8, v17
    s_add_u32 s9, s9, 1
    s_cmp_lg_u32 s8, 0
    s_cbranch_scc1 SP_38_D
    s_cmp_lt_u32 s9, 524288
    s_cbranch_scc1 SP_38
SP_38_D:
    buffer_load_dwordx2 v[24:25], v8, s[68:71], s13 offen offset:0
    buffer_load_dwordx2 v[26:27], v8, s[68:71], s13 offen offset:1152
    buffer_load_dwordx2 v[28:29], v8, s[68:71], s13 offen offset:2304
    buffer_load_dwordx2 v[30:31], v8, s[68:71], s13 offen offset:3456
    s_add_u32 s13, s13, 4608
    buffer_load_dwordx2 v[32:33], v8, s[68:71], s13 offen offset:0
    buffer_load_dwordx2 v[34:35], v8, s[68:71], s13 offen offset:1152
    buffer_load_dwordx2 v[36:37], v8, s[68:71], s13 offen offset:2304
    buffer_load_dwordx2 v[38:39], v8, s[68:71], s13 offen offset:3456
    s_add_u32 s13, s13, 32256
    buffer_load_dwordx2 v[88:89], v8, s[68:71], s13 offen offset:0
    buffer_load_dwordx2 v[90:91], v8, s[68:71], s13 offen offset:1152
    buffer_load_dwordx2 v[92:93], v8, s[68:71], s13 offen offset:2304
    buffer_load_dwordx2 v[94:95], v8, s[68:71], s13 offen offset:3456
    s_add_u32 s13, s13, 4608
    buffer_load_dwordx2 v[96:97], v8, s[68:71], s13 offen offset:0
    buffer_load_dwordx2 v[98:99], v8, s[68:71], s13 offen offset:1152
    buffer_load_dwordx2 v[100:101], v8, s[68:71], s13 offen offset:2304
    buffer_load_dwordx2 v[102:103], v8, s[68:71], s13 offen offset:3456
    s_add_u32 s13, s13, 32256
    s_waitcnt vmcnt(14)
    v_perm_b32 v56, v26, v24, s64
    v_perm_b32 v60, v26, v24, s65
    v_perm_b32 v64, v27, v25, s64
    v_perm_b32 v68, v27, v25, s65
    s_waitcnt vmcnt(12)
    v_perm_b32 v57, v30, v28, s64
    v_perm_b32 v61, v30, v28, s65
    v_perm_b32 v65, v31, v29, s64
    v_perm_b32 v69, v31, v29, s65
    s_waitcnt vmcnt(10)
    v_perm_b32 v58, v34, v32, s64
    v_perm_b32 v62, v34, v32, s65
    v_perm_b32 v66, v35, v33, s64
    v_perm_b32 v70, v35, v33, s65
    s_waitcnt vmcnt(8)
    v_perm_b32 v59, v38, v36, s64
    v_perm_b32 v63, v38, v36, s65
    v_perm_b32 v67, v39, v37, s64
    v_perm_b32 v71, v39, v37, s65
    s_waitcnt vmcnt(6)
    v_perm_b32 v24, v90, v88, s64
    v_perm_b32 v28, v90, v88, s65
    v_perm_b32 v32, v91, v89, s64
    v_perm_b32 v36, v91, v89, s65
    s_waitcnt vmcnt(4)
    v_perm_b32 v25, v94, v92, s64
    v_perm_b32 v29, v94, v92, s65
    v_perm_b32 v33, v95, v93, s64
    v_perm_b32 v37, v95, v93, s65
    s_waitcnt vmcnt(2)
    v_perm_b32 v26, v98, v96, s64
    v_perm_b32 v30, v98, v96, s65
    v_perm_b32 v34, v99, v97, s64
    v_perm_b32 v38, v99, v97, s65
    s_waitcnt vmcnt(0)
    v_perm_b32 v27, v102, v100, s64
    v_perm_b32 v31, v102, v100, s65
    v_perm_b32 v35, v103, v101, s64
    v_perm_b32 v39, v103, v101, s65
    s_barrier
    ds_read_b128 v[152:155], v10 offset:0
    ds_read_b128 v[156:159], v10 offset:64
    s_waitcnt lgkmcnt(0)
    v_mfma_f32_16x16x32_bf16 v[120:123], v[56:59], v[152:155], 0
    v_mfma_f32_16x16x32_bf16 v[120:123], v[24:27], v[156:159], v[120:123]
    v_mfma_f32_16x16x32_bf16 v[124:127], v[60:63], v[152:155], 0
    v_mfma_f32_16x16x32_bf16 v[124:127], v[28:31], v[156:159], v[124:127]
    v_mfma_f32_16x16x32_bf16 v[128:131], v[64:67], v[152:155], 0
    v_mfma_f32_16x16x32_bf16 v[128:131], v[32:35], v[156:159], v[128:131]
    v_mfma_f32_16x16x32_bf16 v[132:135], v[68:71], v[152:155], 0
    v_mfma_f32_16x16x32_bf16 v[132:135], v[36:39], v[156:159], v[132:135]
    s_nop 1
    v_cndmask_b32 v88, v120, v121, s[56:57]
    s_nop 0
    v_cndmask_b32 v89, v124, v125, s[56:57]
    s_nop 0
    v_cndmask_b32 v90, v128, v129, s[56:57]
    s_nop 0
    v_cndmask_b32 v91, v132, v133, s[56:57]
    v_perm_b32 v88, v88, v17, s60
    v_perm_b32 v89, v89, v17, s61
    v_perm_b32 v90, v90, v17, s62
    v_perm_b32 v91, v91, v17, s63
    s_mov_b32 s12, 0
    buffer_store_dwordx4 v[88:91], v11, s[52:55], s12 offen sc1
    v_cndmask_b32 v92, v122, v123, s[56:57]
    v_cndmask_b32 v93, v126, v127, s[56:57]
    v_cndmask_b32 v94, v130, v131, s[56:57]
    v_cndmask_b32 v95, v134, v135, s[56:57]
    v_perm_b32 v92, v92, v17, s60
    v_perm_b32 v93, v93, v17, s61
    v_perm_b32 v94, v94, v17, s62
    v_perm_b32 v95, v95, v17, s63
    s_mov_b32 s12, 18432
    buffer_store_dwordx4 v[92:95], v11, s[52:55], s12 offen sc1
    s_endpgm
K_END:
    s_endpgm
CODE_END:
.section .rodata,"a"
.p2align 6
.amdhsa_kernel k1_kernel
  .amdhsa_next_free_vgpr 168
  .amdhsa_next_free_sgpr 102
  .amdhsa_accum_offset 168
  .amdhsa_group_segment_fixed_size 0
  .amdhsa_kernarg_size 144
  .amdhsa_user_sgpr_count 2
  .amdhsa_user_sgpr_kernarg_segment_ptr 1
  .amdhsa_system_sgpr_workgroup_id_x 1
.end_amdhsa_kernel
```

```asm
; @launch kernel=k1_kernel grid=(256,1,1) block=(768,1,1) lds=163840
.amdgcn_target "amdgcn-amd-amdhsa--gfx950"
.text
.p2align 8
.globl k1_kernel
.type k1_kernel,@function
k1_kernel:
    v_lshrrev_b32 v1, 6, v0
    s_cmp_ge_u32 s2, 256
    v_readfirstlane_b32 s3, v1
    s_cbranch_scc1 K_END
    v_and_b32 v2, 63, v0
    v_mov_b32 v1, 0
    s_cmp_lg_u32 s3, 1
    s_cbranch_scc1 K_NOZ
    v_lshlrev_b32 v3, 2, v2
    ds_write_b32 v3, v1
    s_waitcnt lgkmcnt(0)
K_NOZ:
    s_load_dwordx16 s[16:31], s[0:1], 0
    s_load_dwordx16 s[32:47], s[0:1], 64
    s_load_dwordx4 s[48:51], s[0:1], 128
    s_lshr_b32 s5, s2, 3
    s_lshl_b32 s8, s3, 8
    s_add_u32 s8, s8, s5
    s_cmp_lg_u32 s8, 9
    s_cbranch_scc1 K_NOCPF
    s_getpc_b64 s[8:9]
    s_and_b32 s8, s8, 0xffffff00
    v_lshlrev_b32 v8, 7, v2
    v_min_u32 v9, CODE_END-k1_kernel-4, v8
    global_load_dword v160, v9, s[8:9]
    v_add_u32 v8, 8192, v8
    v_min_u32 v9, CODE_END-k1_kernel-4, v8
    global_load_dword v161, v9, s[8:9]
    v_add_u32 v8, 8192, v8
    v_min_u32 v9, CODE_END-k1_kernel-4, v8
    global_load_dword v162, v9, s[8:9]
    v_add_u32 v8, 8192, v8
    v_min_u32 v9, CODE_END-k1_kernel-4, v8
    global_load_dword v163, v9, s[8:9]
    v_add_u32 v8, 8192, v8
K_NOCPF:
    v_and_b32 v3, 15, v2
    v_lshrrev_b32 v4, 4, v2
    s_and_b32 s4, s2, 7
    s_barrier
    s_cmp_eq_u32 s3, 8
    s_cbranch_scc1 ROUTER
    s_cmp_lt_u32 s5, 14
    s_cbranch_scc1 K_OTHER
    s_mul_i32 s7, s4, 18
    s_add_u32 s7, s7, s5
    s_sub_u32 s7, s7, 14
    s_cmp_ge_u32 s3, 8
    s_cbranch_scc1 K_CIO
C_KGEN:
    s_and_b32 s12, s3, 3
    s_lshr_b32 s13, s3, 2
    s_lshl_b32 s14, s7, 2
    s_add_u32 s14, s14, s12
    s_lshl_b32 s8, s14, 8
    s_lshl_b32 s9, s13, 7
    s_add_u32 s8, s8, s9
    v_lshl_add_u32 v5, v2, 1, s8
    v_mov_b32 v16, 0
    v_mov_b32 v17, 0
    v_mov_b32 v18, 0
    v_mov_b32 v19, 0
    v_mov_b32 v20, 0
    v_mov_b32 v21, 0
    s_lshl_b32 s55, s7, 3
    s_setprio 2
    s_mul_i32 s15, s3, 4608
    s_add_u32 s15, s15, 256
    s_mul_i32 s52, s12, 4864
    s_add_u32 s52, s52, 37120
    s_mul_i32 s53, s12, 4672
    s_add_u32 s53, s53, 56576
    v_mul_u32_u24 v7, 288, v3
    v_lshl_add_u32 v7, v4, 4, v7
    v_add_u32 v7, s15, v7
    s_mov_b32 m0, s15
    s_waitcnt lgkmcnt(0)
    s_load_dwordx2 s[58:59], s[30:31], s55
    global_load_short_d16_hi v16, v5, s[18:19]
    global_load_short_d16_hi v17, v5, s[20:21]
    global_load_short_d16_hi v18, v5, s[22:23]
    global_load_short_d16_hi v19, v5, s[24:25]
    global_load_short_d16_hi v20, v5, s[26:27]
    global_load_short_d16_hi v21, v5, s[28:29]
    s_load_dwordx2 s[68:69], s[32:33], s55
    s_branch C_KBODY
ROUTER:
    s_setprio 3
    v_lshrrev_b32 v5, 3, v2
    v_and_b32 v6, 7, v2
    v_lshlrev_b32 v9, 4, v6
    v_mul_u32_u24 v8, 1152, v5
    s_mul_i32 s8, s2, 9216
    v_add3_u32 v8, v8, v9, s8
    v_lshlrev_b32 v7, 4, v2
    v_min_u32 v10, 7, v2
    v_lshlrev_b32 v10, 4, v10
    s_mov_b32 m0, 147712
    s_waitcnt lgkmcnt(0)
    s_load_dword s10, s[50:51], 8448
    global_load_dwordx4 v[16:19], v8, s[16:17] offset:0
    global_load_dwordx4 v[52:55], v9, s[36:37] offset:0
    global_load_dwordx4 v[20:23], v8, s[16:17] offset:128
    global_load_dwordx4 v[56:59], v9, s[36:37] offset:128
    global_load_dwordx4 v[24:27], v8, s[16:17] offset:256
    global_load_dwordx4 v[60:63], v9, s[36:37] offset:256
    global_load_dwordx4 v[28:31], v8, s[16:17] offset:384
    global_load_dwordx4 v[64:67], v9, s[36:37] offset:384
    global_load_dwordx4 v[32:35], v8, s[16:17] offset:512
    global_load_dwordx4 v[68:71], v9, s[36:37] offset:512
    global_load_dwordx4 v[36:39], v8, s[16:17] offset:640
    global_load_dwordx4 v[72:75], v9, s[36:37] offset:640
    global_load_dwordx4 v[40:43], v8, s[16:17] offset:768
    global_load_dwordx4 v[76:79], v9, s[36:37] offset:768
    global_load_dwordx4 v[44:47], v8, s[16:17] offset:896
    global_load_dwordx4 v[80:83], v9, s[36:37] offset:896
    global_load_dwordx4 v[48:51], v8, s[16:17] offset:1024
    global_load_dwordx4 v[84:87], v9, s[36:37] offset:1024
    s_mov_b32 m0, 158224
    s_nop 0
    global_load_lds_dwordx4 v7, s[44:45]
    global_load_lds_dwordx4 v10, s[44:45] offset:1024
    v_mov_b32 v11, 1
    ds_write_b32 v1, v11 offset:4
    v_add_u32 v7, 147712, v7
    s_lshl_b32 s8, s2, 5
    v_lshl_add_u32 v15, v4, 3, s8
    s_mov_b32 s11, 0xffff
    v_mov_b32 v8, 0
    v_mov_b32 v9, 0
    v_mov_b32 v10, 0
    v_mov_b32 v11, 0
    s_waitcnt lgkmcnt(0)
    s_add_u32 s10, s10, 1
    s_addc_u32 s10, s10, 0
    v_mov_b32 v14, s10
    v_mov_b32 v13, s10
    s_waitcnt vmcnt(18)
    v_dot2c_f32_bf16 v8, v16, v52
    v_dot2c_f32_bf16 v9, v17, v53
    v_dot2c_f32_bf16 v10, v18, v54
    v_dot2c_f32_bf16 v11, v19, v55
    s_waitcnt vmcnt(16)
    v_dot2c_f32_bf16 v8, v20, v56
    v_dot2c_f32_bf16 v9, v21, v57
    v_dot2c_f32_bf16 v10, v22, v58
    v_dot2c_f32_bf16 v11, v23, v59
    s_waitcnt vmcnt(14)
    v_dot2c_f32_bf16 v8, v24, v60
    v_dot2c_f32_bf16 v9, v25, v61
    v_dot2c_f32_bf16 v10, v26, v62
    v_dot2c_f32_bf16 v11, v27, v63
    s_waitcnt vmcnt(12)
    v_dot2c_f32_bf16 v8, v28, v64
    v_dot2c_f32_bf16 v9, v29, v65
    v_dot2c_f32_bf16 v10, v30, v66
    v_dot2c_f32_bf16 v11, v31, v67
    s_waitcnt vmcnt(10)
    v_dot2c_f32_bf16 v8, v32, v68
    v_dot2c_f32_bf16 v9, v33, v69
    v_dot2c_f32_bf16 v10, v34, v70
    v_dot2c_f32_bf16 v11, v35, v71
    s_waitcnt vmcnt(8)
    v_dot2c_f32_bf16 v8, v36, v72
    v_dot2c_f32_bf16 v9, v37, v73
    v_dot2c_f32_bf16 v10, v38, v74
    v_dot2c_f32_bf16 v11, v39, v75
    s_waitcnt vmcnt(6)
    v_dot2c_f32_bf16 v8, v40, v76
    v_dot2c_f32_bf16 v9, v41, v77
    v_dot2c_f32_bf16 v10, v42, v78
    v_dot2c_f32_bf16 v11, v43, v79
    s_waitcnt vmcnt(4)
    v_dot2c_f32_bf16 v8, v44, v80
    v_dot2c_f32_bf16 v9, v45, v81
    v_dot2c_f32_bf16 v10, v46, v82
    v_dot2c_f32_bf16 v11, v47, v83
    s_waitcnt vmcnt(2)
    v_dot2c_f32_bf16 v8, v48, v84
    v_dot2c_f32_bf16 v9, v49, v85
    v_dot2c_f32_bf16 v10, v50, v86
    v_dot2c_f32_bf16 v11, v51, v87
    s_nop 0
    v_add_f32 v8, v8, v9
    s_nop 0
    v_add_f32 v10, v10, v11
    v_add_f32 v8, v8, v10
    s_nop 1
    v_add_f32_dpp v8, v8, v8 quad_perm:[1,0,3,2] row_mask:0xf bank_mask:0xf
    s_nop 1
    v_add_f32_dpp v8, v8, v8 quad_perm:[2,3,0,1] row_mask:0xf bank_mask:0xf
    s_nop 1
    v_add_f32_dpp v8, v8, v8 row_half_mirror row_mask:0xf bank_mask:0xf
    v_cvt_pk_bf16_f32 v8, v8, v8
    v_ashrrev_i32 v9, 31, v8
    v_or_b32 v9, 0x80008000, v9
    v_xor_b32 v8, v8, v9
    s_nop 1
    v_mov_b32_dpp v9, v8 row_ror:8 row_mask:0xf bank_mask:0xf
    s_mov_b32 exec_lo, 0x10001
    s_mov_b32 exec_hi, 0x10001
    v_bfi_b32 v12, s11, v8, v9
    global_store_dwordx2 v15, v[12:13], s[50:51] sc1
    s_mov_b64 exec, -1
    ds_write_b32 v1, v14 offset:0
    s_setprio 0
    ds_write_b128 v7, v[16:19] offset:0
    ds_write_b128 v7, v[20:23] offset:1024
    ds_write_b128 v7, v[24:27] offset:2048
    ds_write_b128 v7, v[28:31] offset:3072
    ds_write_b128 v7, v[32:35] offset:4096
    ds_write_b128 v7, v[36:39] offset:5120
    ds_write_b128 v7, v[40:43] offset:6144
    ds_write_b128 v7, v[44:47] offset:7168
    ds_write_b128 v7, v[48:51] offset:8192
    s_waitcnt vmcnt(1)
    ds_write_b32 v1, v14 offset:8
    s_cmp_ge_u32 s5, 14
    s_cbranch_scc1 C_IO
    s_cmp_lt_u32 s5, 9
    s_cbranch_scc1 SELECT
    s_endpgm
K_OTHER:
    s_mul_i32 s7, s4, 9
    s_add_u32 s7, s7, s5
    s_mov_b32 s12, s3
    s_cmp_lt_u32 s3, 2
    s_cbranch_scc1 GATE
    s_cmp_ge_u32 s5, 9
    s_cbranch_scc1 HELPER
    s_cmp_lt_u32 s3, 8
    s_cbranch_scc1 F_COMP
F_LOAD:
    s_setprio 3
    s_sub_u32 s12, s3, 9
    v_lshrrev_b32 v5, 3, v2
    v_bfe_u32 v6, v2, 4, 1
    v_xor_b32 v6, v6, v2
    v_and_b32 v6, 7, v6
    s_movk_i32 s8, 9216
    v_mul_lo_u32 v7, v5, s8
    v_lshl_add_u32 v8, v6, 4, v7
    v_xor_b32 v9, 32, v8
    v_xor_b32 v10, 64, v8
    v_xor_b32 v11, 96, v8
    v_bfe_u32 v6, v2, 4, 1
    v_lshlrev_b32 v6, 1, v6
    v_xor_b32 v6, v6, v2
    v_and_b32 v6, 7, v6
    v_mul_u32_u24 v7, 1152, v5
    v_lshl_add_u32 v12, v6, 4, v7
    v_xor_b32 v13, 64, v12
    s_mul_i32 s13, s12, 294912
    s_lshl_b32 s8, s7, 7
    s_add_u32 s13, s13, s8
    s_lshl_b32 s15, s12, 13
    s_add_u32 s15, s15, 256
    s_mul_i32 s14, s12, 24576
    s_add_u32 s14, s14, 73984
    s_mul_i32 s11, s7, 73728
    s_mul_i32 s8, s12, 384
    s_add_u32 s11, s11, s8
    s_waitcnt lgkmcnt(0)
    s_mov_b32 s52, s38
    s_mov_b32 s53, s39
    s_mov_b32 s54, 5308416
    s_mov_b32 s55, 0x20000
    s_mov_b32 s56, s40
    s_mov_b32 s57, s41
    s_mov_b32 s58, 5308416
    s_mov_b32 s59, 0x20000
    s_mov_b32 s60, s42
    s_mov_b32 s61, s43
    s_mov_b32 s62, 5308416
    s_mov_b32 s63, 0x20000
    s_mov_b32 s9, 0
SP_1:
    ds_read_b32 v14, v1 offset:4
    s_waitcnt lgkmcnt(0)
    v_readfirstlane_b32 s8, v14
    s_add_u32 s9, s9, 1
    s_cmp_ge_u32 s8, 1
    s_cbranch_scc1 SP_1_D
    s_cmp_lt_u32 s9, 524288
    s_cbranch_scc1 SP_1
SP_1_D:
    s_add_u32 m0, s15, 0
    s_nop 0
    buffer_load_dwordx4 v8, s[52:55], s13 offen  lds
    s_add_u32 m0, s15, 1024
    s_nop 0
    buffer_load_dwordx4 v10, s[56:59], s13 offen  lds
    s_add_u32 s13, s13, 73728
    s_add_u32 m0, s15, 2048
    s_nop 0
    buffer_load_dwordx4 v9, s[52:55], s13 offen  lds
    s_add_u32 m0, s15, 3072
    s_nop 0
    buffer_load_dwordx4 v11, s[56:59], s13 offen  lds
    s_add_u32 s13, s13, 73728
    s_add_u32 m0, s15, 4096
    s_nop 0
    buffer_load_dwordx4 v8, s[52:55], s13 offen  lds
    s_add_u32 m0, s15, 5120
    s_nop 0
    buffer_load_dwordx4 v10, s[56:59], s13 offen  lds
    s_add_u32 s13, s13, 73728
    s_add_u32 m0, s15, 6144
    s_nop 0
    buffer_load_dwordx4 v9, s[52:55], s13 offen  lds
    s_add_u32 m0, s15, 7168
    s_nop 0
    buffer_load_dwordx4 v11, s[56:59], s13 offen  lds
    s_add_u32 s13, s13, 663552
    s_add_u32 m0, s15, 24576
    s_nop 0
    buffer_load_dwordx4 v8, s[52:55], s13 offen  lds
    s_add_u32 m0, s15, 25600
    s_nop 0
    buffer_load_dwordx4 v10, s[56:59], s13 offen  lds
    s_add_u32 s13, s13, 73728
    s_waitcnt vmcnt(9)
    s_add_u32 m0, s15, 26624
    s_nop 0
    buffer_load_dwordx4 v9, s[52:55], s13 offen  lds
    s_waitcnt vmcnt(9)
    s_add_u32 m0, s15, 27648
    s_nop 0
    buffer_load_dwordx4 v11, s[56:59], s13 offen  lds
    s_add_u32 s13, s13, 73728
    s_waitcnt vmcnt(9)
    s_add_u32 m0, s15, 28672
    s_nop 0
    buffer_load_dwordx4 v8, s[52:55], s13 offen  lds
    s_waitcnt vmcnt(9)
    s_add_u32 m0, s15, 29696
    s_nop 0
    buffer_load_dwordx4 v10, s[56:59], s13 offen  lds
    s_add_u32 s13, s13, 73728
    s_waitcnt vmcnt(9)
    s_add_u32 m0, s15, 30720
    s_nop 0
    buffer_load_dwordx4 v9, s[52:55], s13 offen  lds
    s_waitcnt vmcnt(9)
    s_add_u32 m0, s15, 31744
    s_nop 0
    buffer_load_dwordx4 v11, s[56:59], s13 offen  lds
    s_add_u32 s13, s13, 663552
    s_waitcnt vmcnt(9)
    s_add_u32 m0, s15, 49152
    s_nop 0
    buffer_load_dwordx4 v8, s[52:55], s13 offen  lds
    s_waitcnt vmcnt(9)
    v_mov_b32 v14, 1
    s_mov_b64 exec, 1
    ds_add_u32 v1, v14 offset:16
    s_mov_b64 exec, -1
    s_add_u32 m0, s15, 50176
    s_nop 0
    buffer_load_dwordx4 v10, s[56:59], s13 offen  lds
    s_add_u32 s13, s13, 73728
    s_waitcnt vmcnt(9)
    s_add_u32 m0, s15, 51200
    s_nop 0
    buffer_load_dwordx4 v9, s[52:55], s13 offen  lds
    s_waitcnt vmcnt(9)
    s_add_u32 m0, s15, 52224
    s_nop 0
    buffer_load_dwordx4 v11, s[56:59], s13 offen  lds
    s_add_u32 s13, s13, 73728
    s_waitcnt vmcnt(9)
    s_add_u32 m0, s15, 53248
    s_nop 0
    buffer_load_dwordx4 v8, s[52:55], s13 offen  lds
    s_waitcnt vmcnt(9)
    s_add_u32 m0, s15, 54272
    s_nop 0
    buffer_load_dwordx4 v10, s[56:59], s13 offen  lds
    s_add_u32 s13, s13, 73728
    s_waitcnt vmcnt(9)
    s_add_u32 m0, s15, 55296
    s_nop 0
    buffer_load_dwordx4 v9, s[52:55], s13 offen  lds
    s_waitcnt vmcnt(9)
    s_add_u32 m0, s15, 56320
    s_nop 0
    buffer_load_dwordx4 v11, s[56:59], s13 offen  lds
    s_add_u32 s13, s13, 663552
    s_mov_b32 s9, 0
SP_2:
    ds_read_b32 v14, v1 offset:48
    s_waitcnt lgkmcnt(0)
    v_readfirstlane_b32 s8, v14
    s_add_u32 s9, s9, 1
    s_cmp_ge_u32 s8, 4
    s_cbranch_scc1 SP_2_D
    s_cmp_lt_u32 s9, 524288
    s_cbranch_scc1 SP_2
SP_2_D:
    s_waitcnt vmcnt(9)
    s_add_u32 m0, s15, 0
    s_nop 0
    buffer_load_dwordx4 v8, s[52:55], s13 offen  lds
    s_waitcnt vmcnt(9)
    v_mov_b32 v14, 1
    s_mov_b64 exec, 1
    ds_add_u32 v1, v14 offset:20
    s_mov_b64 exec, -1
    s_add_u32 m0, s15, 1024
    s_nop 0
    buffer_load_dwordx4 v10, s[56:59], s13 offen  lds
    s_add_u32 s13, s13, 73728
    s_waitcnt vmcnt(9)
    s_add_u32 m0, s15, 2048
    s_nop 0
    buffer_load_dwordx4 v9, s[52:55], s13 offen  lds
    s_waitcnt vmcnt(9)
    s_add_u32 m0, s15, 3072
    s_nop 0
    buffer_load_dwordx4 v11, s[56:59], s13 offen  lds
    s_add_u32 s13, s13, 73728
    s_waitcnt vmcnt(9)
    s_add_u32 m0, s15, 4096
    s_nop 0
    buffer_load_dwordx4 v8, s[52:55], s13 offen  lds
    s_waitcnt vmcnt(9)
    s_add_u32 m0, s15, 5120
    s_nop 0
    buffer_load_dwordx4 v10, s[56:59], s13 offen  lds
    s_add_u32 s13, s13, 73728
    s_waitcnt vmcnt(9)
    s_add_u32 m0, s15, 6144
    s_nop 0
    buffer_load_dwordx4 v9, s[52:55], s13 offen  lds
    s_waitcnt vmcnt(9)
    s_add_u32 m0, s15, 7168
    s_nop 0
    buffer_load_dwordx4 v11, s[56:59], s13 offen  lds
    s_add_u32 s13, s13, 663552
    s_mov_b32 s9, 0
SP_3:
    ds_read_b32 v14, v1 offset:52
    s_waitcnt lgkmcnt(0)
    v_readfirstlane_b32 s8, v14
    s_add_u32 s9, s9, 1
    s_cmp_ge_u32 s8, 4
    s_cbranch_scc1 SP_3_D
    s_cmp_lt_u32 s9, 524288
    s_cbranch_scc1 SP_3
SP_3_D:
    s_waitcnt vmcnt(9)
    s_add_u32 m0, s15, 24576
    s_nop 0
    buffer_load_dwordx4 v8, s[52:55], s13 offen  lds
    s_waitcnt vmcnt(9)
    v_mov_b32 v14, 1
    s_mov_b64 exec, 1
    ds_add_u32 v1, v14 offset:24
    s_mov_b64 exec, -1
    s_add_u32 m0, s15, 25600
    s_nop 0
    buffer_load_dwordx4 v10, s[56:59], s13 offen  lds
    s_add_u32 s13, s13, 73728
    s_waitcnt vmcnt(9)
    s_add_u32 m0, s15, 26624
    s_nop 0
    buffer_load_dwordx4 v9, s[52:55], s13 offen  lds
    s_waitcnt vmcnt(9)
    s_add_u32 m0, s15, 27648
    s_nop 0
    buffer_load_dwordx4 v11, s[56:59], s13 offen  lds
    s_add_u32 s13, s13, 73728
    s_waitcnt vmcnt(9)
    s_add_u32 m0, s15, 28672
    s_nop 0
    buffer_load_dwordx4 v8, s[52:55], s13 offen  lds
    s_waitcnt vmcnt(9)
    s_add_u32 m0, s15, 29696
    s_nop 0
    buffer_load_dwordx4 v10, s[56:59], s13 offen  lds
    s_add_u32 s13, s13, 73728
    s_waitcnt vmcnt(9)
    s_add_u32 m0, s15, 30720
    s_nop 0
    buffer_load_dwordx4 v9, s[52:55], s13 offen  lds
    s_waitcnt vmcnt(9)
    s_add_u32 m0, s15, 31744
    s_nop 0
    buffer_load_dwordx4 v11, s[56:59], s13 offen  lds
    s_add_u32 s13, s13, 663552
    s_mov_b32 s9, 0
SP_4:
    ds_read_b32 v14, v1 offset:56
    s_waitcnt lgkmcnt(0)
    v_readfirstlane_b32 s8, v14
    s_add_u32 s9, s9, 1
    s_cmp_ge_u32 s8, 4
    s_cbranch_scc1 SP_4_D
    s_cmp_lt_u32 s9, 524288
    s_cbranch_scc1 SP_4
SP_4_D:
    s_waitcnt vmcnt(9)
    s_add_u32 m0, s15, 49152
    s_nop 0
    buffer_load_dwordx4 v8, s[52:55], s13 offen  lds
    s_waitcnt vmcnt(9)
    v_mov_b32 v14, 1
    s_mov_b64 exec, 1
    ds_add_u32 v1, v14 offset:28
    s_mov_b64 exec, -1
    s_add_u32 m0, s15, 50176
    s_nop 0
    buffer_load_dwordx4 v10, s[56:59], s13 offen  lds
    s_add_u32 s13, s13, 73728
    s_waitcnt vmcnt(9)
    s_add_u32 m0, s15, 51200
    s_nop 0
    buffer_load_dwordx4 v9, s[52:55], s13 offen  lds
    s_waitcnt vmcnt(9)
    s_add_u32 m0, s15, 52224
    s_nop 0
    buffer_load_dwordx4 v11, s[56:59], s13 offen  lds
    s_add_u32 s13, s13, 73728
    s_waitcnt vmcnt(9)
    s_add_u32 m0, s15, 53248
    s_nop 0
    buffer_load_dwordx4 v8, s[52:55], s13 offen  lds
    s_waitcnt vmcnt(9)
    s_add_u32 m0, s15, 54272
    s_nop 0
    buffer_load_dwordx4 v10, s[56:59], s13 offen  lds
    s_add_u32 s13, s13, 73728
    s_waitcnt vmcnt(9)
    s_add_u32 m0, s15, 55296
    s_nop 0
    buffer_load_dwordx4 v9, s[52:55], s13 offen  lds
    s_waitcnt vmcnt(9)
    s_add_u32 m0, s15, 56320
    s_nop 0
    buffer_load_dwordx4 v11, s[56:59], s13 offen  lds
    s_add_u32 s13, s13, 663552
    v_mov_b32 v14, 1
    s_mov_b64 exec, 1
    ds_add_u32 v1, v14 offset:40
    s_mov_b64 exec, -1
    s_waitcnt vmcnt(8)
    v_mov_b32 v14, 1
    s_mov_b64 exec, 1
    ds_add_u32 v1, v14 offset:32
    s_mov_b64 exec, -1
    s_waitcnt vmcnt(0)
    v_mov_b32 v14, 1
    s_mov_b64 exec, 1
    ds_add_u32 v1, v14 offset:36
    s_mov_b64 exec, -1
    s_cmp_eq_u32 s3, 9
    s_cbranch_scc1 F_COMP2
    s_endpgm
K_CIO:
    s_sub_u32 s12, s3, 9
    s_cmp_eq_u32 s3, 11
    s_cbranch_scc1 C_LOAD
    v_lshl_add_u32 v14, v4, 3, v3
    v_sub_u32 v14, 39, v14
    s_lshl_b32 s8, s12, 11
    s_add_u32 s8, s8, 100096
    v_lshl_add_u32 v15, v2, 4, s8
    s_cmp_eq_u32 s12, 0
    s_cselect_b32 s8, 127, 7
    s_cselect_b32 s9, 19, 21
    s_movk_i32 s11, 0x3f80
    s_lshl_b32 s13, s11, 16
    v_mov_b32 v10, s8
    v_mov_b32 v11, 0
    v_lshlrev_b64 v[10:11], v14, v[10:11]
    v_alignbit_b32 v10, v11, v10, s9
    v_bfe_i32 v11, v10, 0, 1
    v_bfe_i32 v12, v10, 1, 1
    v_and_b32 v11, s11, v11
    v_and_or_b32 v16, v12, s13, v11
    v_bfe_i32 v11, v10, 2, 1
    v_bfe_i32 v12, v10, 3, 1
    v_and_b32 v11, s11, v11
    v_and_or_b32 v17, v12, s13, v11
    v_bfe_i32 v11, v10, 4, 1
    v_bfe_i32 v12, v10, 5, 1
    v_and_b32 v11, s11, v11
    v_and_or_b32 v18, v12, s13, v11
    v_bfe_i32 v11, v10, 6, 1
    v_bfe_i32 v12, v10, 7, 1
    v_and_b32 v11, s11, v11
    v_and_or_b32 v19, v12, s13, v11
    ds_write_b128 v15, v[16:19] offset:0
    s_cmp_eq_u32 s12, 0
    s_cselect_b32 s8, 511, 31
    s_cselect_b32 s9, 20, 18
    s_movk_i32 s11, 0x3f80
    s_lshl_b32 s13, s11, 16
    v_mov_b32 v10, s8
    v_mov_b32 v11, 0
    v_lshlrev_b64 v[10:11], v14, v[10:11]
    v_alignbit_b32 v10, v11, v10, s9
    v_bfe_i32 v11, v10, 0, 1
    v_bfe_i32 v12, v10, 1, 1
    v_and_b32 v11, s11, v11
    v_and_or_b32 v20, v12, s13, v11
    v_bfe_i32 v11, v10, 2, 1
    v_bfe_i32 v12, v10, 3, 1
    v_and_b32 v11, s11, v11
    v_and_or_b32 v21, v12, s13, v11
    v_bfe_i32 v11, v10, 4, 1
    v_bfe_i32 v12, v10, 5, 1
    v_and_b32 v11, s11, v11
    v_and_or_b32 v22, v12, s13, v11
    v_bfe_i32 v11, v10, 6, 1
    v_bfe_i32 v12, v10, 7, 1
    v_and_b32 v11, s11, v11
    v_and_or_b32 v23, v12, s13, v11
    ds_write_b128 v15, v[20:23] offset:1024
    s_cmp_eq_u32 s12, 0
    s_cselect_b32 s8, 7, 3
    s_cselect_b32 s9, 21, 21
    s_movk_i32 s11, 0x3f80
    s_cselect_b32 s11, s11, 0xffff
    s_lshl_b32 s13, s11, 16
    v_mov_b32 v10, s8
    v_mov_b32 v11, 0
    v_lshlrev_b64 v[10:11], v14, v[10:11]
    v_alignbit_b32 v10, v11, v10, s9
    v_bfe_i32 v11, v10, 0, 1
    v_bfe_i32 v12, v10, 1, 1
    v_and_b32 v11, s11, v11
    v_and_or_b32 v24, v12, s13, v11
    v_bfe_i32 v11, v10, 2, 1
    v_bfe_i32 v12, v10, 3, 1
    v_and_b32 v11, s11, v11
    v_and_or_b32 v25, v12, s13, v11
    v_bfe_i32 v11, v10, 4, 1
    v_bfe_i32 v12, v10, 5, 1
    v_and_b32 v11, s11, v11
    v_and_or_b32 v26, v12, s13, v11
    v_bfe_i32 v11, v10, 6, 1
    v_bfe_i32 v12, v10, 7, 1
    v_and_b32 v11, s11, v11
    v_and_or_b32 v27, v12, s13, v11
    ds_write_b128 v15, v[24:27] offset:2048
    v_mov_b32 v10, 1
    s_mov_b64 exec, 1
    ds_add_u32 v1, v10 offset:32
    s_mov_b64 exec, -1
    s_branch GATE
C_LOAD:
    s_setprio 3
    s_sub_u32 s13, s5, 14
    s_mov_b32 s8, s13
    s_mul_i32 s8, s8, 73728
    s_lshl_b32 s9, s4, 7
    s_add_u32 s8, s8, s9
    v_mul_u32_u24 v9, 1152, v2
    v_add_u32 v9, s8, v9
    s_add_u32 s8, s13, 18
    s_min_u32 s8, s8, 31
    s_sub_u32 s8, s8, s13
    s_mul_i32 s8, s8, 73728
    v_add_u32 v8, s8, v9
    v_mul_u32_u24 v6, 4608, v2
    s_lshl_b32 s8, s7, 3
    v_add_u32 v6, s8, v6
    v_lshlrev_b32 v7, 3, v2
    v_sub_u32 v7, 57080, v7
    s_mov_b32 s56, 0x05040100
    s_mov_b32 s58, 0x07060302
    s_mov_b32 s57, s13
    s_waitcnt lgkmcnt(0)
    s_mov_b32 s72, s16
    s_mov_b32 s73, s17
    s_mov_b32 s74, 2359296
    s_mov_b32 s75, 0x20000
    s_mov_b32 s9, 0
SP_5:
    ds_read_b32 v12, v1 offset:4
    s_waitcnt lgkmcnt(0)
    v_readfirstlane_b32 s8, v12
    s_add_u32 s9, s9, 1
    s_cmp_ge_u32 s8, 1
    s_cbranch_scc1 SP_5_D
    s_cmp_lt_u32 s9, 524288
    s_cbranch_scc1 SP_5
SP_5_D:
    global_load_dword v10, v9, s[16:17]
    global_load_dword v11, v9, s[16:17] offset:128
    global_load_dword v10, v8, s[16:17]
    global_load_dword v11, v8, s[16:17] offset:128
    s_mul_i32 s7, s4, 18
    s_add_u32 s7, s7, s5
    s_sub_u32 s7, s7, 14
    s_lshl_b32 s55, s7, 3
    s_sub_u32 s12, s3, 8
    s_mov_b32 s60, s46
    s_mov_b32 s61, s47
    s_mov_b32 s62, 2359296
    s_mov_b32 s63, 0x20000
    v_bfe_u32 v79, v2, 2, 2
    v_and_b32 v80, 3, v2
    v_lshl_add_u32 v80, v4, 2, v80
    s_lshl_b32 s8, s12, 7
    v_mul_u32_u24 v72, 4672, v79
    v_lshl_add_u32 v72, v80, 3, v72
    s_sub_u32 s9, 56960, s8
    v_add_u32 v72, s9, v72
    v_mul_u32_u24 v73, 4160, v79
    v_lshl_add_u32 v73, v80, 3, v73
    s_sub_u32 s9, 83840, s8
    v_add_u32 v73, s9, v73
    v_xor_b32 v79, 63, v2
    s_lshl_b32 s8, s12, 9
    s_add_u32 s8, s8, 16384
    v_lshl_add_u32 v74, v79, 3, s8
    v_add_u32 v75, 4096, v74
    v_add_u32 v76, 8192, v74
    v_add_u32 v77, 12288, v74
    v_mul_u32_u24 v78, 1152, v79
    v_add_u32 v78, s55, v78
    s_mul_i32 s68, s12, 73728
    s_mov_b32 s70, 0x05040100
    s_mov_b32 s71, 0x07060302
    s_sub_u32 s9, s5, 14
    s_mul_i32 s9, s9, 3
    s_min_u32 s8, s12, 2
    s_add_u32 s9, s9, s8
    s_mul_i32 s9, s9, 12288
    s_mul_i32 s8, s4, 663552
    s_add_u32 s8, s8, s9
    v_lshl_add_u32 v88, v2, 7, s8
    v_min_u32 v89, 31, v2
    v_lshl_add_u32 v89, v89, 7, s8
    v_add_u32 v89, 8192, v89
    v_mov_b32 v24, 0
    v_mov_b32 v25, 0
    v_mov_b32 v26, 0
    v_mov_b32 v27, 0
    v_lshrrev_b32 v28, 2, v2
    v_mul_u32_u24 v28, 1216, v28
    v_add_u32 v28, 37120, v28
    v_and_b32 v29, 3, v2
    v_lshl_add_u32 v30, v29, 4, v28
    ds_write_b128 v30, v[24:27] offset:1072
    v_and_b32 v29, 1, v2
    v_lshl_add_u32 v30, v29, 4, v28
    ds_write_b128 v30, v[24:27]
    v_lshrrev_b32 v28, 5, v2
    v_mul_u32_u24 v28, 4672, v28
    v_and_b32 v29, 31, v2
    v_lshl_add_u32 v30, v29, 4, v28
    v_add_u32 v30, 60672, v30
    ds_write_b128 v30, v[24:27]
    ds_write_b128 v30, v[24:27] offset:9344
    s_mov_b32 s15, 0
    v_mov_b32 v12, 1
    s_waitcnt vmcnt(2)
    buffer_load_dwordx2 v[104:105], v6, s[72:75], s15 offen offset:0
    buffer_load_dwordx2 v[106:107], v6, s[72:75], s15 offen offset:1152
    buffer_load_dwordx2 v[108:109], v6, s[72:75], s15 offen offset:2304
    buffer_load_dwordx2 v[110:111], v6, s[72:75], s15 offen offset:3456
    s_add_u32 s15, s15, 294912
    buffer_load_dwordx2 v[112:113], v6, s[72:75], s15 offen offset:0
    s_waitcnt vmcnt(4)
    buffer_load_dwordx2 v[114:115], v6, s[72:75], s15 offen offset:1152
    s_waitcnt vmcnt(4)
    buffer_load_dwordx2 v[116:117], v6, s[72:75], s15 offen offset:2304
    s_waitcnt vmcnt(4)
    buffer_load_dwordx2 v[118:119], v6, s[72:75], s15 offen offset:3456
    s_add_u32 s15, s15, 294912
    s_waitcnt vmcnt(4)
    buffer_load_dwordx2 v[120:121], v6, s[72:75], s15 offen offset:0
    v_perm_b32 v16, v108, v110, s56
    v_perm_b32 v17, v104, v106, s56
    ds_write_b64 v7, v[16:17] offset:3584
    v_perm_b32 v18, v108, v110, s58
    v_perm_b32 v19, v104, v106, s58
    ds_write_b64 v7, v[18:19] offset:8256
    v_perm_b32 v20, v109, v111, s56
    v_perm_b32 v21, v105, v107, s56
    ds_write_b64 v7, v[20:21] offset:12928
    v_perm_b32 v22, v109, v111, s58
    v_perm_b32 v23, v105, v107, s58
    ds_write_b64 v7, v[22:23] offset:17600
    v_mov_b32 v36, 1
    ds_write_b32 v1, v36 offset:80
    s_waitcnt vmcnt(4)
    buffer_load_dwordx2 v[122:123], v6, s[72:75], s15 offen offset:1152
    s_waitcnt vmcnt(4)
    buffer_load_dwordx2 v[124:125], v6, s[72:75], s15 offen offset:2304
    s_waitcnt vmcnt(4)
    buffer_load_dwordx2 v[126:127], v6, s[72:75], s15 offen offset:3456
    s_add_u32 s15, s15, 294912
    s_waitcnt vmcnt(4)
    buffer_load_dwordx2 v[128:129], v6, s[72:75], s15 offen offset:0
    v_perm_b32 v24, v116, v118, s56
    v_perm_b32 v25, v112, v114, s56
    ds_write_b64 v7, v[24:25] offset:3072
    v_perm_b32 v26, v116, v118, s58
    v_perm_b32 v27, v112, v114, s58
    ds_write_b64 v7, v[26:27] offset:7744
    v_perm_b32 v28, v117, v119, s56
    v_perm_b32 v29, v113, v115, s56
    ds_write_b64 v7, v[28:29] offset:12416
    v_perm_b32 v30, v117, v119, s58
    v_perm_b32 v31, v113, v115, s58
    ds_write_b64 v7, v[30:31] offset:17088
    v_mov_b32 v36, 2
    ds_write_b32 v1, v36 offset:80
    s_waitcnt vmcnt(4)
    buffer_load_dwordx2 v[130:131], v6, s[72:75], s15 offen offset:1152
    s_waitcnt vmcnt(4)
    buffer_load_dwordx2 v[132:133], v6, s[72:75], s15 offen offset:2304
    s_waitcnt vmcnt(4)
    buffer_load_dwordx2 v[134:135], v6, s[72:75], s15 offen offset:3456
    s_add_u32 s15, s15, 294912
    s_waitcnt vmcnt(4)
    buffer_load_dwordx2 v[136:137], v6, s[72:75], s15 offen offset:0
    v_perm_b32 v16, v124, v126, s56
    v_perm_b32 v17, v120, v122, s56
    ds_write_b64 v7, v[16:17] offset:2560
    v_perm_b32 v18, v124, v126, s58
    v_perm_b32 v19, v120, v122, s58
    ds_write_b64 v7, v[18:19] offset:7232
    v_perm_b32 v20, v125, v127, s56
    v_perm_b32 v21, v121, v123, s56
    ds_write_b64 v7, v[20:21] offset:11904
    v_perm_b32 v22, v125, v127, s58
    v_perm_b32 v23, v121, v123, s58
    ds_write_b64 v7, v[22:23] offset:16576
    v_mov_b32 v36, 3
    ds_write_b32 v1, v36 offset:80
    s_waitcnt vmcnt(4)
    buffer_load_dwordx2 v[138:139], v6, s[72:75], s15 offen offset:1152
    s_waitcnt vmcnt(4)
    buffer_load_dwordx2 v[140:141], v6, s[72:75], s15 offen offset:2304
    s_waitcnt vmcnt(4)
    buffer_load_dwordx2 v[142:143], v6, s[72:75], s15 offen offset:3456
    s_add_u32 s15, s15, 294912
    s_waitcnt vmcnt(4)
    buffer_load_dwordx2 v[144:145], v6, s[72:75], s15 offen offset:0
    v_perm_b32 v24, v132, v134, s56
    v_perm_b32 v25, v128, v130, s56
    ds_write_b64 v7, v[24:25] offset:2048
    v_perm_b32 v26, v132, v134, s58
    v_perm_b32 v27, v128, v130, s58
    ds_write_b64 v7, v[26:27] offset:6720
    v_perm_b32 v28, v133, v135, s56
    v_perm_b32 v29, v129, v131, s56
    ds_write_b64 v7, v[28:29] offset:11392
    v_perm_b32 v30, v133, v135, s58
    v_perm_b32 v31, v129, v131, s58
    ds_write_b64 v7, v[30:31] offset:16064
    v_mov_b32 v36, 4
    ds_write_b32 v1, v36 offset:80
    s_waitcnt vmcnt(4)
    buffer_load_dwordx2 v[146:147], v6, s[72:75], s15 offen offset:1152
    s_waitcnt vmcnt(4)
    buffer_load_dwordx2 v[148:149], v6, s[72:75], s15 offen offset:2304
    s_waitcnt vmcnt(4)
    buffer_load_dwordx2 v[150:151], v6, s[72:75], s15 offen offset:3456
    s_add_u32 s15, s15, 294912
    s_waitcnt vmcnt(4)
    buffer_load_dwordx2 v[152:153], v6, s[72:75], s15 offen offset:0
    v_perm_b32 v16, v140, v142, s56
    v_perm_b32 v17, v136, v138, s56
    ds_write_b64 v7, v[16:17] offset:1536
    v_perm_b32 v18, v140, v142, s58
    v_perm_b32 v19, v136, v138, s58
    ds_write_b64 v7, v[18:19] offset:6208
    v_perm_b32 v20, v141, v143, s56
    v_perm_b32 v21, v137, v139, s56
    ds_write_b64 v7, v[20:21] offset:10880
    v_perm_b32 v22, v141, v143, s58
    v_perm_b32 v23, v137, v139, s58
    ds_write_b64 v7, v[22:23] offset:15552
    v_mov_b32 v36, 5
    ds_write_b32 v1, v36 offset:80
    s_waitcnt vmcnt(4)
    buffer_load_dwordx2 v[154:155], v6, s[72:75], s15 offen offset:1152
    s_waitcnt vmcnt(4)
    buffer_load_dwordx2 v[156:157], v6, s[72:75], s15 offen offset:2304
    s_waitcnt vmcnt(4)
    buffer_load_dwordx2 v[158:159], v6, s[72:75], s15 offen offset:3456
    s_add_u32 s15, s15, 294912
    s_waitcnt vmcnt(4)
    buffer_load_dwordx2 v[160:161], v6, s[72:75], s15 offen offset:0
    v_perm_b32 v24, v148, v150, s56
    v_perm_b32 v25, v144, v146, s56
    ds_write_b64 v7, v[24:25] offset:1024
    v_perm_b32 v26, v148, v150, s58
    v_perm_b32 v27, v144, v146, s58
    ds_write_b64 v7, v[26:27] offset:5696
    v_perm_b32 v28, v149, v151, s56
    v_perm_b32 v29, v145, v147, s56
    ds_write_b64 v7, v[28:29] offset:10368
    v_perm_b32 v30, v149, v151, s58
    v_perm_b32 v31, v145, v147, s58
    ds_write_b64 v7, v[30:31] offset:15040
    v_mov_b32 v36, 6
    ds_write_b32 v1, v36 offset:80
    s_waitcnt vmcnt(4)
    buffer_load_dwordx2 v[162:163], v6, s[72:75], s15 offen offset:1152
    s_waitcnt vmcnt(4)
    buffer_load_dwordx2 v[164:165], v6, s[72:75], s15 offen offset:2304
    s_waitcnt vmcnt(4)
    buffer_load_dwordx2 v[166:167], v6, s[72:75], s15 offen offset:3456
    s_add_u32 s15, s15, 294912
    ds_write_b32 v1, v12 offset:88
    global_load_dwordx2 v[56:57], v74, s[50:51] offset:0 sc1
    global_load_dwordx2 v[58:59], v74, s[50:51] offset:2048 sc1
    global_load_dwordx2 v[60:61], v75, s[50:51] offset:0 sc1
    global_load_dwordx2 v[62:63], v75, s[50:51] offset:2048 sc1
    global_load_dwordx2 v[64:65], v76, s[50:51] offset:0 sc1
    global_load_dwordx2 v[66:67], v76, s[50:51] offset:2048 sc1
    global_load_dwordx2 v[68:69], v77, s[50:51] offset:0 sc1
    global_load_dwordx2 v[70:71], v77, s[50:51] offset:2048 sc1
    s_waitcnt vmcnt(12)
    v_perm_b32 v16, v156, v158, s56
    v_perm_b32 v17, v152, v154, s56
    ds_write_b64 v7, v[16:17] offset:512
    v_perm_b32 v18, v156, v158, s58
    v_perm_b32 v19, v152, v154, s58
    ds_write_b64 v7, v[18:19] offset:5184
    v_perm_b32 v20, v157, v159, s56
    v_perm_b32 v21, v153, v155, s56
    ds_write_b64 v7, v[20:21] offset:9856
    v_perm_b32 v22, v157, v159, s58
    v_perm_b32 v23, v153, v155, s58
    ds_write_b64 v7, v[22:23] offset:14528
    v_mov_b32 v36, 7
    ds_write_b32 v1, v36 offset:80
    s_waitcnt vmcnt(11)
    s_waitcnt vmcnt(10)
    s_waitcnt vmcnt(9)
    s_waitcnt vmcnt(8)
    v_perm_b32 v24, v164, v166, s56
    v_perm_b32 v25, v160, v162, s56
    ds_write_b64 v7, v[24:25] offset:0
    v_perm_b32 v26, v164, v166, s58
    v_perm_b32 v27, v160, v162, s58
    ds_write_b64 v7, v[26:27] offset:4672
    v_perm_b32 v28, v165, v167, s56
    v_perm_b32 v29, v161, v163, s56
    ds_write_b64 v7, v[28:29] offset:9344
    v_perm_b32 v30, v165, v167, s58
    v_perm_b32 v31, v161, v163, s58
    ds_write_b64 v7, v[30:31] offset:14016
    v_mov_b32 v36, 8
    ds_write_b32 v1, v36 offset:80
    ds_read_b64_tr_b16 v[40:41], v72 offset:3584
    ds_read_b64_tr_b16 v[42:43], v72 offset:3072
    ds_read_b64_tr_b16 v[44:45], v72 offset:2560
    ds_read_b64_tr_b16 v[46:47], v72 offset:2048
    s_mov_b32 s9, 0
SP_6:
    ds_read_b32 v10, v1 offset:8
    s_waitcnt lgkmcnt(0)
    v_readfirstlane_b32 s8, v10
    s_add_u32 s9, s9, 1
    s_cmp_lg_u32 s8, 0
    s_cbranch_scc1 SP_6_D
    s_cmp_lt_u32 s9, 524288
    s_cbranch_scc1 SP_6
SP_6_D:
    v_lshlrev_b32 v120, 16, v40
    v_and_b32 v121, 0xffff0000, v40
    v_lshlrev_b32 v122, 16, v41
    v_and_b32 v123, 0xffff0000, v41
    v_lshlrev_b32 v124, 16, v42
    v_and_b32 v125, 0xffff0000, v42
    v_lshlrev_b32 v126, 16, v43
    v_and_b32 v127, 0xffff0000, v43
    v_lshlrev_b32 v128, 16, v44
    v_and_b32 v129, 0xffff0000, v44
    v_lshlrev_b32 v130, 16, v45
    v_and_b32 v131, 0xffff0000, v45
    v_lshlrev_b32 v132, 16, v46
    v_and_b32 v133, 0xffff0000, v46
    v_lshlrev_b32 v134, 16, v47
    v_and_b32 v135, 0xffff0000, v47
    s_waitcnt vmcnt(0)
    s_branch C_IO3
C_IO:
    s_mul_i32 s7, s4, 18
    s_add_u32 s7, s7, s5
    s_sub_u32 s7, s7, 14
    s_lshl_b32 s55, s7, 3
    s_sub_u32 s12, s3, 8
    s_mov_b32 s60, s46
    s_mov_b32 s61, s47
    s_mov_b32 s62, 2359296
    s_mov_b32 s63, 0x20000
    v_bfe_u32 v79, v2, 2, 2
    v_and_b32 v80, 3, v2
    v_lshl_add_u32 v80, v4, 2, v80
    s_lshl_b32 s8, s12, 7
    v_mul_u32_u24 v72, 4672, v79
    v_lshl_add_u32 v72, v80, 3, v72
    s_sub_u32 s9, 56960, s8
    v_add_u32 v72, s9, v72
    v_mul_u32_u24 v73, 4160, v79
    v_lshl_add_u32 v73, v80, 3, v73
    s_sub_u32 s9, 83840, s8
    v_add_u32 v73, s9, v73
    v_xor_b32 v79, 63, v2
    s_lshl_b32 s8, s12, 9
    s_add_u32 s8, s8, 16384
    v_lshl_add_u32 v74, v79, 3, s8
    v_add_u32 v75, 4096, v74
    v_add_u32 v76, 8192, v74
    v_add_u32 v77, 12288, v74
    v_mul_u32_u24 v78, 1152, v79
    v_add_u32 v78, s55, v78
    s_mul_i32 s68, s12, 73728
    s_mov_b32 s70, 0x05040100
    s_mov_b32 s71, 0x07060302
    s_sub_u32 s9, s5, 14
    s_mul_i32 s9, s9, 3
    s_min_u32 s8, s12, 2
    s_add_u32 s9, s9, s8
    s_mul_i32 s9, s9, 12288
    s_mul_i32 s8, s4, 663552
    s_add_u32 s8, s8, s9
    v_lshl_add_u32 v88, v2, 7, s8
    v_min_u32 v89, 31, v2
    v_lshl_add_u32 v89, v89, 7, s8
    v_add_u32 v89, 8192, v89
    s_mov_b32 s9, 0
SP_7:
    ds_read_b32 v10, v1 offset:8
    s_waitcnt lgkmcnt(0)
    v_readfirstlane_b32 s8, v10
    s_add_u32 s9, s9, 1
    s_cmp_lg_u32 s8, 0
    s_cbranch_scc1 SP_7_D
    s_cmp_lt_u32 s9, 524288
    s_cbranch_scc1 SP_7
SP_7_D:
    s_setprio 3
    s_mov_b32 s9, 0
SP_8:
    ds_read_b32 v12, v1 offset:80
    s_waitcnt lgkmcnt(0)
    v_readfirstlane_b32 s8, v12
    s_add_u32 s9, s9, 1
    s_cmp_ge_u32 s8, 4
    s_cbranch_scc1 SP_8_D
    s_sleep 2
    s_cmp_lt_u32 s9, 524288
    s_cbranch_scc1 SP_8
SP_8_D:
    s_setprio 3
    ds_read_b64_tr_b16 v[40:41], v72 offset:3584
    ds_read_b64_tr_b16 v[42:43], v72 offset:3072
    ds_read_b64_tr_b16 v[44:45], v72 offset:2560
    ds_read_b64_tr_b16 v[46:47], v72 offset:2048
    s_waitcnt lgkmcnt(0)
    v_lshlrev_b32 v120, 16, v40
    v_and_b32 v121, 0xffff0000, v40
    v_lshlrev_b32 v122, 16, v41
    v_and_b32 v123, 0xffff0000, v41
    v_lshlrev_b32 v124, 16, v42
    v_and_b32 v125, 0xffff0000, v42
    v_lshlrev_b32 v126, 16, v43
    v_and_b32 v127, 0xffff0000, v43
    v_lshlrev_b32 v128, 16, v44
    v_and_b32 v129, 0xffff0000, v44
    v_lshlrev_b32 v130, 16, v45
    v_and_b32 v131, 0xffff0000, v45
    v_lshlrev_b32 v132, 16, v46
    v_and_b32 v133, 0xffff0000, v46
    v_lshlrev_b32 v134, 16, v47
    v_and_b32 v135, 0xffff0000, v47
    s_setprio 3
    s_mov_b32 s9, 0
SP_9:
    ds_read_b32 v12, v1 offset:88
    s_waitcnt lgkmcnt(0)
    v_readfirstlane_b32 s8, v12
    s_add_u32 s9, s9, 1
    s_cmp_ge_u32 s8, 1
    s_cbranch_scc1 SP_9_D
    s_sleep 1
    s_cmp_lt_u32 s9, 524288
    s_cbranch_scc1 SP_9
SP_9_D:
    s_setprio 3
    global_load_dwordx2 v[56:57], v74, s[50:51] offset:0 sc1
    global_load_dwordx2 v[58:59], v74, s[50:51] offset:2048 sc1
    global_load_dwordx2 v[60:61], v75, s[50:51] offset:0 sc1
    global_load_dwordx2 v[62:63], v75, s[50:51] offset:2048 sc1
    global_load_dwordx2 v[64:65], v76, s[50:51] offset:0 sc1
    global_load_dwordx2 v[66:67], v76, s[50:51] offset:2048 sc1
    global_load_dwordx2 v[68:69], v77, s[50:51] offset:0 sc1
    global_load_dwordx2 v[70:71], v77, s[50:51] offset:2048 sc1
    v_mov_b32 v12, 1
    s_mov_b64 exec, 1
    ds_add_u32 v1, v12 offset:36
    s_mov_b64 exec, -1
    s_mov_b32 s9, 0
SP_10:
    ds_read_b32 v12, v1 offset:36
    s_waitcnt lgkmcnt(0)
    v_readfirstlane_b32 s8, v12
    s_add_u32 s9, s9, 1
    s_cmp_ge_u32 s8, 3
    s_cbranch_scc1 SP_10_D
    s_cmp_lt_u32 s9, 524288
    s_cbranch_scc1 SP_10
SP_10_D:
    global_load_dword v96, v88, s[42:43]
    global_load_dword v97, v89, s[42:43]
    s_waitcnt vmcnt(2)
C_IO3:
    s_waitcnt vmcnt(2)
    s_mov_b32 s9, 0
GP_11:
    v_xor_b32 v14, v57, v10
    v_bitop3_b32 v14, v14, v59, v10 bitop3:0xf6
    v_bitop3_b32 v14, v14, v61, v10 bitop3:0xf6
    v_bitop3_b32 v14, v14, v63, v10 bitop3:0xf6
    v_bitop3_b32 v14, v14, v65, v10 bitop3:0xf6
    v_bitop3_b32 v14, v14, v67, v10 bitop3:0xf6
    v_bitop3_b32 v14, v14, v69, v10 bitop3:0xf6
    v_bitop3_b32 v14, v14, v71, v10 bitop3:0xf6
    v_cmp_ne_u32 vcc, 0, v14
    s_add_u32 s9, s9, 1
    s_cmp_eq_u64 vcc, 0
    s_cbranch_scc1 GP_11_D
    s_cmp_ge_u32 s9, 131072
    s_cbranch_scc1 GP_11_D
    global_load_dwordx2 v[56:57], v74, s[50:51] offset:0 sc1
    global_load_dwordx2 v[58:59], v74, s[50:51] offset:2048 sc1
    global_load_dwordx2 v[60:61], v75, s[50:51] offset:0 sc1
    global_load_dwordx2 v[62:63], v75, s[50:51] offset:2048 sc1
    global_load_dwordx2 v[64:65], v76, s[50:51] offset:0 sc1
    global_load_dwordx2 v[66:67], v76, s[50:51] offset:2048 sc1
    global_load_dwordx2 v[68:69], v77, s[50:51] offset:0 sc1
    global_load_dwordx2 v[70:71], v77, s[50:51] offset:2048 sc1
    s_waitcnt vmcnt(0)
    s_branch GP_11
GP_11_D:
    v_and_b32 v16, 0xffff0000, v56
    v_lshlrev_b32 v57, 16, v56
    v_mul_f32 v120, v120, v16
    v_mul_f32 v121, v121, v16
    v_mul_f32 v122, v122, v16
    v_mul_f32 v123, v123, v16
    v_and_b32 v17, 0xffff0000, v58
    v_lshlrev_b32 v59, 16, v58
    v_mul_f32 v124, v124, v17
    v_mul_f32 v125, v125, v17
    v_mul_f32 v126, v126, v17
    v_mul_f32 v127, v127, v17
    v_and_b32 v18, 0xffff0000, v60
    v_lshlrev_b32 v61, 16, v60
    v_mul_f32 v128, v128, v18
    v_mul_f32 v129, v129, v18
    v_mul_f32 v130, v130, v18
    v_mul_f32 v131, v131, v18
    v_and_b32 v19, 0xffff0000, v62
    v_lshlrev_b32 v63, 16, v62
    v_mul_f32 v132, v132, v19
    v_mul_f32 v133, v133, v19
    v_mul_f32 v134, v134, v19
    v_mul_f32 v135, v135, v19
    s_setprio 3
    s_mov_b32 s9, 0
SP_12:
    ds_read_b32 v15, v1 offset:96
    s_waitcnt lgkmcnt(0)
    v_readfirstlane_b32 s8, v15
    s_add_u32 s9, s9, 1
    s_cmp_ge_u32 s8, 4
    s_cbranch_scc1 SP_12_D
    s_sleep 1
    s_cmp_lt_u32 s9, 524288
    s_cbranch_scc1 SP_12
SP_12_D:
    s_setprio 3
    ds_read_b64_tr_b16 v[16:17], v73 offset:3584
    ds_read_b64_tr_b16 v[18:19], v73 offset:3072
    s_waitcnt lgkmcnt(1)
    v_lshlrev_b32 v24, 16, v16
    v_and_b32 v25, 0xffff0000, v16
    v_lshlrev_b32 v26, 16, v17
    v_and_b32 v27, 0xffff0000, v17
    v_fma_f32 v24, v24, v57, v120
    v_fma_f32 v25, v25, v57, v121
    v_fma_f32 v26, v26, v57, v122
    v_fma_f32 v27, v27, v57, v123
    s_waitcnt lgkmcnt(0)
    v_lshlrev_b32 v28, 16, v18
    v_and_b32 v29, 0xffff0000, v18
    v_lshlrev_b32 v30, 16, v19
    v_and_b32 v31, 0xffff0000, v19
    v_fma_f32 v28, v28, v59, v124
    v_fma_f32 v29, v29, v59, v125
    v_fma_f32 v30, v30, v59, v126
    v_fma_f32 v31, v31, v59, v127
    v_cvt_pk_bf16_f32 v40, v24, v25
    v_cvt_pk_bf16_f32 v41, v26, v27
    buffer_store_dwordx2 v[40:41], v78, s[60:63], s68 offen
    s_add_u32 s68, s68, 294912
    v_cvt_pk_bf16_f32 v42, v28, v29
    v_cvt_pk_bf16_f32 v43, v30, v31
    buffer_store_dwordx2 v[42:43], v78, s[60:63], s68 offen
    s_add_u32 s68, s68, 294912
    s_setprio 3
    s_mov_b32 s9, 0
SP_13:
    ds_read_b32 v15, v1 offset:100
    s_waitcnt lgkmcnt(0)
    v_readfirstlane_b32 s8, v15
    s_add_u32 s9, s9, 1
    s_cmp_ge_u32 s8, 4
    s_cbranch_scc1 SP_13_D
    s_sleep 1
    s_cmp_lt_u32 s9, 524288
    s_cbranch_scc1 SP_13
SP_13_D:
    s_setprio 3
    ds_read_b64_tr_b16 v[16:17], v73 offset:2560
    ds_read_b64_tr_b16 v[18:19], v73 offset:2048
    s_waitcnt lgkmcnt(1)
    v_lshlrev_b32 v24, 16, v16
    v_and_b32 v25, 0xffff0000, v16
    v_lshlrev_b32 v26, 16, v17
    v_and_b32 v27, 0xffff0000, v17
    v_fma_f32 v24, v24, v61, v128
    v_fma_f32 v25, v25, v61, v129
    v_fma_f32 v26, v26, v61, v130
    v_fma_f32 v27, v27, v61, v131
    s_waitcnt lgkmcnt(0)
    v_lshlrev_b32 v28, 16, v18
    v_and_b32 v29, 0xffff0000, v18
    v_lshlrev_b32 v30, 16, v19
    v_and_b32 v31, 0xffff0000, v19
    v_fma_f32 v28, v28, v63, v132
    v_fma_f32 v29, v29, v63, v133
    v_fma_f32 v30, v30, v63, v134
    v_fma_f32 v31, v31, v63, v135
    v_cvt_pk_bf16_f32 v44, v24, v25
    v_cvt_pk_bf16_f32 v45, v26, v27
    buffer_store_dwordx2 v[44:45], v78, s[60:63], s68 offen
    s_add_u32 s68, s68, 294912
    v_cvt_pk_bf16_f32 v46, v28, v29
    v_cvt_pk_bf16_f32 v47, v30, v31
    buffer_store_dwordx2 v[46:47], v78, s[60:63], s68 offen
    s_add_u32 s68, s68, 294912
    s_mov_b32 s9, 0
SP_14:
    ds_read_b32 v12, v1 offset:80
    s_waitcnt lgkmcnt(0)
    v_readfirstlane_b32 s8, v12
    s_add_u32 s9, s9, 1
    s_cmp_ge_u32 s8, 8
    s_cbranch_scc1 SP_14_D
    s_cmp_lt_u32 s9, 524288
    s_cbranch_scc1 SP_14
SP_14_D:
    ds_read_b64_tr_b16 v[48:49], v72 offset:1536
    ds_read_b64_tr_b16 v[50:51], v72 offset:1024
    ds_read_b64_tr_b16 v[52:53], v72 offset:512
    ds_read_b64_tr_b16 v[54:55], v72 offset:0
    s_lshl_b32 s8, s12, 8
    s_sub_u32 s8, 76032, s8
    v_lshl_add_u32 v14, v2, 2, s8
    ds_write_b32 v14, v56 offset:7168
    ds_write_b32 v14, v58 offset:6144
    ds_write_b32 v14, v60 offset:5120
    ds_write_b32 v14, v62 offset:4096
    ds_write_b32 v14, v64 offset:3072
    ds_write_b32 v14, v66 offset:2048
    ds_write_b32 v14, v68 offset:1024
    ds_write_b32 v14, v70 offset:0
    s_setprio 3
    s_mov_b32 s9, 0
SP_15:
    ds_read_b32 v15, v1 offset:104
    s_waitcnt lgkmcnt(0)
    v_readfirstlane_b32 s8, v15
    s_add_u32 s9, s9, 1
    s_cmp_ge_u32 s8, 4
    s_cbranch_scc1 SP_15_D
    s_sleep 1
    s_cmp_lt_u32 s9, 524288
    s_cbranch_scc1 SP_15
SP_15_D:
    s_setprio 3
    ds_read_b64_tr_b16 v[16:17], v73 offset:1536
    ds_read_b64_tr_b16 v[18:19], v73 offset:1024
    s_waitcnt lgkmcnt(1)
    v_perm_b32 v24, v48, v16, s70
    v_perm_b32 v25, v48, v16, s71
    v_perm_b32 v26, v49, v17, s70
    v_perm_b32 v27, v49, v17, s71
    s_waitcnt lgkmcnt(0)
    v_perm_b32 v28, v50, v18, s70
    v_perm_b32 v29, v50, v18, s71
    v_perm_b32 v30, v51, v19, s70
    v_perm_b32 v31, v51, v19, s71
    v_dot2_f32_bf16 v24, v24, v64, 0
    v_dot2_f32_bf16 v25, v25, v64, 0
    v_dot2_f32_bf16 v26, v26, v64, 0
    v_dot2_f32_bf16 v27, v27, v64, 0
    v_dot2_f32_bf16 v28, v28, v66, 0
    v_dot2_f32_bf16 v29, v29, v66, 0
    v_dot2_f32_bf16 v30, v30, v66, 0
    v_dot2_f32_bf16 v31, v31, v66, 0
    v_cvt_pk_bf16_f32 v48, v24, v25
    v_cvt_pk_bf16_f32 v49, v26, v27
    buffer_store_dwordx2 v[48:49], v78, s[60:63], s68 offen
    s_add_u32 s68, s68, 294912
    v_cvt_pk_bf16_f32 v50, v28, v29
    v_cvt_pk_bf16_f32 v51, v30, v31
    buffer_store_dwordx2 v[50:51], v78, s[60:63], s68 offen
    s_add_u32 s68, s68, 294912
    s_setprio 3
    s_mov_b32 s9, 0
SP_16:
    ds_read_b32 v15, v1 offset:108
    s_waitcnt lgkmcnt(0)
    v_readfirstlane_b32 s8, v15
    s_add_u32 s9, s9, 1
    s_cmp_ge_u32 s8, 4
    s_cbranch_scc1 SP_16_D
    s_sleep 1
    s_cmp_lt_u32 s9, 524288
    s_cbranch_scc1 SP_16
SP_16_D:
    s_setprio 3
    ds_read_b64_tr_b16 v[16:17], v73 offset:512
    s_waitcnt lgkmcnt(0)
    v_perm_b32 v24, v52, v16, s70
    v_perm_b32 v25, v52, v16, s71
    v_perm_b32 v26, v53, v17, s70
    v_perm_b32 v27, v53, v17, s71
    v_dot2_f32_bf16 v24, v24, v68, 0
    v_dot2_f32_bf16 v25, v25, v68, 0
    v_dot2_f32_bf16 v26, v26, v68, 0
    v_dot2_f32_bf16 v27, v27, v68, 0
    s_nop 0
    v_cvt_pk_bf16_f32 v52, v24, v25
    s_nop 0
    v_cvt_pk_bf16_f32 v53, v26, v27
    buffer_store_dwordx2 v[52:53], v78, s[60:63], s68 offen
    s_add_u32 s68, s68, 294912
    s_setprio 3
    s_mov_b32 s9, 0
SP_17:
    ds_read_b32 v15, v1 offset:112
    s_waitcnt lgkmcnt(0)
    v_readfirstlane_b32 s8, v15
    s_add_u32 s9, s9, 1
    s_cmp_ge_u32 s8, 4
    s_cbranch_scc1 SP_17_D
    s_sleep 1
    s_cmp_lt_u32 s9, 524288
    s_cbranch_scc1 SP_17
SP_17_D:
    s_setprio 3
    ds_read_b64_tr_b16 v[16:17], v73 offset:0
    s_waitcnt lgkmcnt(0)
    v_perm_b32 v24, v54, v16, s70
    v_perm_b32 v25, v54, v16, s71
    v_perm_b32 v26, v55, v17, s70
    v_perm_b32 v27, v55, v17, s71
    v_dot2_f32_bf16 v24, v24, v70, 0
    v_dot2_f32_bf16 v25, v25, v70, 0
    v_dot2_f32_bf16 v26, v26, v70, 0
    v_dot2_f32_bf16 v27, v27, v70, 0
    s_nop 0
    v_cvt_pk_bf16_f32 v54, v24, v25
    s_nop 0
    v_cvt_pk_bf16_f32 v55, v26, v27
    buffer_store_dwordx2 v[54:55], v78, s[60:63], s68 offen
    s_add_u32 s68, s68, 294912
    v_mov_b32 v8, 1
    s_mov_b64 exec, 1
    ds_add_u32 v1, v8 offset:44
    s_mov_b64 exec, -1
    s_waitcnt vmcnt(0)
    v_mov_b32 v8, 1
    s_mov_b64 exec, 1
    ds_add_u32 v1, v8 offset:40
    s_mov_b64 exec, -1
    s_endpgm
C_FIN:
    s_setprio 0
    v_and_b32 v8, 7, v2
    v_lshlrev_b32 v8, 3, v8
    v_add_u32 v8, 8192, v8
    s_mul_i32 s8, s7, 9216
    s_add_u32 s8, s8, 32768
    v_lshl_add_u32 v5, v2, 4, s8
    v_add_u32 v6, 0x1000, v5
    v_add_u32 v7, 0x2000, v5
    v_and_b32 v19, 1, v4
    v_lshrrev_b32 v20, 1, v4
    v_lshl_or_b32 v19, v19, 1, v20
    v_mul_u32_u24 v12, 4672, v19
    v_add_u32 v12, 56576, v12
    v_mul_u32_u24 v13, 4160, v19
    v_add_u32 v13, 83456, v13
    s_add_u32 s8, s55, 2358144
    v_lshl_add_u32 v14, v19, 1, s8
    s_waitcnt lgkmcnt(0)
    v_bfe_u32 v110, v10, 0, 8
    v_bfe_u32 v111, v10, 8, 8
    v_bfe_u32 v112, v10, 16, 8
    v_bfe_u32 v113, v10, 24, 8
    s_setprio 3
    s_mov_b32 s9, 0
SP_18:
    ds_read_b32 v26, v1 offset:44
    s_waitcnt lgkmcnt(0)
    v_readfirstlane_b32 s8, v26
    s_add_u32 s9, s9, 1
    s_cmp_ge_u32 s8, 4
    s_cbranch_scc1 SP_18_D
    s_sleep 1
    s_cmp_lt_u32 s9, 524288
    s_cbranch_scc1 SP_18
SP_18_D:
    s_setprio 3
    s_mov_b32 s9, 0
C_MPOLL:
    global_load_dwordx2 v[16:17], v8, s[50:51] sc1
    global_load_dwordx4 v[120:123], v5, s[50:51] offset:0 sc1
    global_load_dwordx4 v[124:127], v5, s[50:51] offset:1024 sc1
    global_load_dwordx4 v[128:131], v5, s[50:51] offset:2048 sc1
    global_load_dwordx4 v[132:135], v5, s[50:51] offset:3072 sc1
    global_load_dwordx4 v[136:139], v6, s[50:51] offset:0 sc1
    global_load_dwordx4 v[140:143], v6, s[50:51] offset:1024 sc1
    global_load_dwordx4 v[144:147], v6, s[50:51] offset:2048 sc1
    global_load_dwordx4 v[148:151], v6, s[50:51] offset:3072 sc1
    global_load_dwordx4 v[152:155], v7, s[50:51] offset:0 sc1
    s_waitcnt vmcnt(9)
    v_and_b32 v22, 0x7ff, v16
    v_lshl_add_u32 v23, v22, 1, v12
    ds_read_u16 v105, v23
    v_lshl_add_u32 v23, v22, 1, v13
    ds_read_u16 v107, v23
    v_lshlrev_b32 v23, 2, v22
    v_add_u32 v23, 75264, v23
    ds_read_b32 v24, v23
    v_and_b32 v20, 0xffff0000, v16
    v_ashrrev_i32 v21, 31, v20
    v_not_b32 v21, v21
    v_or_b32 v21, 0x80000000, v21
    v_and_b32 v21, 0xffff0000, v21
    v_xor_b32 v20, v20, v21
    v_mul_f32 v21, 0xbfb8aa3b, v20
    v_exp_f32 v21, v21
    s_nop 0
    v_add_f32 v21, 1.0, v21
    v_rcp_f32 v104, v21
    s_nop 0
    v_cvt_pk_bf16_f32 v104, v104, v104
    v_and_b32 v104, 0xffff0000, v104
    v_mul_u32_u24 v108, 1152, v22
    v_sub_u32 v108, v14, v108
    s_waitcnt lgkmcnt(0)
    v_lshlrev_b32 v105, 16, v105
    s_waitcnt vmcnt(8)
    v_xor_b32 v120, v120, v110
    v_xor_b32 v121, v121, v111
    v_xor_b32 v122, v122, v112
    v_xor_b32 v123, v123, v113
    v_or3_b32 v26, v120, v121, 0
    v_or3_b32 v26, v122, v123, v26
    s_waitcnt vmcnt(7)
    v_xor_b32 v124, v124, v110
    v_xor_b32 v125, v125, v111
    v_xor_b32 v126, v126, v112
    v_xor_b32 v127, v127, v113
    v_or3_b32 v26, v124, v125, v26
    v_or3_b32 v26, v126, v127, v26
    v_pk_add_f32 v[28:29], v[120:121], v[124:125]
    v_pk_add_f32 v[30:31], v[122:123], v[126:127]
    s_waitcnt vmcnt(6)
    v_xor_b32 v128, v128, v110
    v_xor_b32 v129, v129, v111
    v_xor_b32 v130, v130, v112
    v_xor_b32 v131, v131, v113
    v_or3_b32 v26, v128, v129, v26
    v_or3_b32 v26, v130, v131, v26
    v_pk_add_f32 v[28:29], v[28:29], v[128:129]
    v_pk_add_f32 v[30:31], v[30:31], v[130:131]
    s_waitcnt vmcnt(5)
    v_xor_b32 v132, v132, v110
    v_xor_b32 v133, v133, v111
    v_xor_b32 v134, v134, v112
    v_xor_b32 v135, v135, v113
    v_or3_b32 v26, v132, v133, v26
    v_or3_b32 v26, v134, v135, v26
    v_pk_add_f32 v[28:29], v[28:29], v[132:133]
    v_pk_add_f32 v[30:31], v[30:31], v[134:135]
    s_waitcnt vmcnt(4)
    v_xor_b32 v136, v136, v110
    v_xor_b32 v137, v137, v111
    v_xor_b32 v138, v138, v112
    v_xor_b32 v139, v139, v113
    v_or3_b32 v26, v136, v137, v26
    v_or3_b32 v26, v138, v139, v26
    v_pk_add_f32 v[28:29], v[28:29], v[136:137]
    v_pk_add_f32 v[30:31], v[30:31], v[138:139]
    s_waitcnt vmcnt(3)
    v_xor_b32 v140, v140, v110
    v_xor_b32 v141, v141, v111
    v_xor_b32 v142, v142, v112
    v_xor_b32 v143, v143, v113
    v_or3_b32 v26, v140, v141, v26
    v_or3_b32 v26, v142, v143, v26
    v_pk_add_f32 v[28:29], v[28:29], v[140:141]
    v_pk_add_f32 v[30:31], v[30:31], v[142:143]
    s_waitcnt vmcnt(2)
    v_xor_b32 v144, v144, v110
    v_xor_b32 v145, v145, v111
    v_xor_b32 v146, v146, v112
    v_xor_b32 v147, v147, v113
    v_or3_b32 v26, v144, v145, v26
    v_or3_b32 v26, v146, v147, v26
    v_pk_add_f32 v[28:29], v[28:29], v[144:145]
    v_pk_add_f32 v[30:31], v[30:31], v[146:147]
    s_waitcnt vmcnt(1)
    v_xor_b32 v148, v148, v110
    v_xor_b32 v149, v149, v111
    v_xor_b32 v150, v150, v112
    v_xor_b32 v151, v151, v113
    v_or3_b32 v26, v148, v149, v26
    v_or3_b32 v26, v150, v151, v26
    v_pk_add_f32 v[28:29], v[28:29], v[148:149]
    v_pk_add_f32 v[30:31], v[30:31], v[150:151]
    s_waitcnt vmcnt(0)
    v_xor_b32 v152, v152, v110
    v_xor_b32 v153, v153, v111
    v_xor_b32 v154, v154, v112
    v_xor_b32 v155, v155, v113
    v_or3_b32 v26, v152, v153, v26
    v_or3_b32 v26, v154, v155, v26
    v_pk_add_f32 v[28:29], v[28:29], v[152:153]
    v_pk_add_f32 v[30:31], v[30:31], v[154:155]
    v_and_b32 v26, 0xff, v26
    v_bitop3_b32 v26, v26, v17, v10 bitop3:0xf6
    v_cmp_ne_u32 vcc, 0, v26
    s_add_u32 s9, s9, 1
    s_cmp_eq_u64 vcc, 0
    s_cbranch_scc1 C_MOK
    s_cmp_lt_u32 s9, 131072
    s_cbranch_scc1 C_MPOLL
C_MOK:
    v_permlane32_swap_b32 v28, v29
    v_permlane32_swap_b32 v30, v31
    v_add_f32 v28, v28, v29
    v_add_f32 v30, v30, v31
    s_nop 1
    v_permlane16_swap_b32 v28, v30
    v_add_f32 v28, v28, v30
    s_nop 1
    v_add_f32_dpp v28, v28, v28 row_ror:8 row_mask:0xf bank_mask:0xf
    v_cvt_pk_bf16_f32 v28, v28, v28
    v_and_b32 v28, 0xffff0000, v28
    v_mul_f32 v28, v28, v104
    v_cvt_pk_bf16_f32 v28, v28, v28
    v_and_b32 v28, 0xffff0000, v28
    v_add_f32 v28, v28, v105
    v_cvt_pk_bf16_f32 v28, v28, v28
    v_and_b32 v28, 0xffff0000, v28
    v_or_b32 v28, v28, v107
    v_dot2_f32_bf16 v28, v28, v24, 0
    s_nop 2
    v_cvt_pk_bf16_f32 v28, v28, v28
    s_mov_b32 s9, 0
SP_19:
    ds_read_b32 v27, v1 offset:40
    s_waitcnt lgkmcnt(0)
    v_readfirstlane_b32 s8, v27
    s_add_u32 s9, s9, 1
    s_cmp_ge_u32 s8, 4
    s_cbranch_scc1 SP_19_D
    s_cmp_lt_u32 s9, 524288
    s_cbranch_scc1 SP_19
SP_19_D:
    s_mov_b32 exec_lo, 0x00ff00ff
    s_mov_b32 exec_hi, 0x00ff00ff
    global_store_short v108, v28, s[46:47]
    s_mov_b64 exec, -1
    s_endpgm
HELPER:
    s_cmp_ge_u32 s3, 6
    s_cbranch_scc1 K_END
    s_and_b32 s12, s3, 1
    s_sub_u32 s13, s3, 2
    s_lshr_b32 s13, s13, 1
    s_mul_i32 s13, s13, 5
    s_add_u32 s13, s13, s5
    s_add_u32 s13, s13, 44
    v_mul_u32_u24 v5, 57, v2
    v_lshrrev_b32 v5, 9, v5
    v_mul_u32_u24 v6, 9, v5
    v_sub_u32 v6, v2, v6
    s_waitcnt lgkmcnt(0)
    s_cmp_eq_u32 s12, 1
    s_cselect_b32 s52, s40, s38
    s_cselect_b32 s53, s41, s39
    s_mov_b32 s54, 5308416
    s_mov_b32 s55, 0x20000
    v_mul_u32_u24 v5, 9216, v5
    v_lshl_add_u32 v5, v6, 7, v5
    s_mul_i32 s8, s4, 1152
    s_sub_u32 s14, s13, 53
    s_lshr_b32 s9, s52, 7
    s_add_u32 s9, s9, s4
    s_sub_u32 s9, 3, s9
    s_and_b32 s9, s9, 7
    s_lshl_b32 s15, s9, 7
    s_add_u32 s15, s15, s8
    s_mul_i32 s14, s14, 258048
    s_add_u32 s15, s15, s14
    s_add_u32 s15, s15, 838656
    s_cmp_eq_u32 s9, 0
    s_cselect_b32 s9, 1024, 0
    v_and_b32 v7, 31, v2
    v_min_u32 v7, 27, v7
    v_mul_u32_u24 v7, 9216, v7
    v_lshrrev_b32 v9, 5, v2
    v_mul_u32_u24 v9, s9, v9
    v_add_u32 v7, v7, v9
    s_mul_i32 s13, s13, 64512
    s_add_u32 s13, s13, s8
    s_mov_b32 s9, 0
SP_20:
    ds_read_b32 v13, v1 offset:4
    s_waitcnt lgkmcnt(0)
    v_readfirstlane_b32 s8, v13
    s_add_u32 s9, s9, 1
    s_cmp_ge_u32 s8, 1
    s_cbranch_scc1 SP_20_D
    s_cmp_lt_u32 s9, 524288
    s_cbranch_scc1 SP_20
SP_20_D:
    buffer_load_dword v8, v7, s[52:55], s15 offen
    s_waitcnt vmcnt(0)
    buffer_load_dword v8, v5, s[52:55], s13 offen
    s_add_u32 s13, s13, 645120
    s_waitcnt vmcnt(0)
    buffer_load_dword v8, v5, s[52:55], s13 offen
    s_add_u32 s13, s13, 645120
    s_waitcnt vmcnt(0)
    buffer_load_dword v8, v5, s[52:55], s13 offen
    s_add_u32 s13, s13, 645120
    s_endpgm
GATE:
    s_lshl_b32 s8, s12, 9
    s_add_u32 s8, s8, 147712
    v_lshl_add_u32 v5, v2, 2, s8
    v_and_b32 v6, 31, v2
    v_lshlrev_b32 v6, 2, v6
    v_add_u32 v6, 158224, v6
    s_lshl_b32 s8, s2, 1
    s_add_u32 s8, s8, s12
    v_mov_b32 v8, 0
    v_mov_b32 v9, 0
    v_mov_b32 v10, 0x3f803f80
    s_lshl_b32 s8, s8, 5
    s_add_u32 s8, s8, 16384
    v_lshrrev_b32 v7, 5, v2
    v_lshl_add_u32 v7, v7, 3, s8
    v_and_b32 v11, 16, v2
    v_add_u32 v7, v7, v11
    s_mov_b32 s9, 0
SP_21:
    ds_read_b32 v13, v1 offset:8
    s_waitcnt lgkmcnt(0)
    v_readfirstlane_b32 s8, v13
    s_add_u32 s9, s9, 1
    s_cmp_lg_u32 s8, 0
    s_cbranch_scc1 SP_21_D
    s_sleep 1
    s_cmp_lt_u32 s9, 524288
    s_cbranch_scc1 SP_21
SP_21_D:
    ds_read2_b32 v[34:35], v6 offset0:0 offset1:32
    ds_read2_b32 v[36:37], v6 offset0:64 offset1:96
    ds_read2_b32 v[38:39], v6 offset0:128 offset1:160
    ds_read2_b32 v[40:41], v6 offset0:192 offset1:224
    ds_read_b32 v42, v6 offset:1024
    ds_read2st64_b32 v[16:17], v5 offset0:0 offset1:1
    ds_read2st64_b32 v[18:19], v5 offset0:4 offset1:5
    ds_read2st64_b32 v[20:21], v5 offset0:8 offset1:9
    ds_read2st64_b32 v[22:23], v5 offset0:12 offset1:13
    ds_read2st64_b32 v[24:25], v5 offset0:16 offset1:17
    ds_read2st64_b32 v[26:27], v5 offset0:20 offset1:21
    ds_read2st64_b32 v[28:29], v5 offset0:24 offset1:25
    ds_read2st64_b32 v[30:31], v5 offset0:28 offset1:29
    ds_read2st64_b32 v[32:33], v5 offset0:32 offset1:33
    s_waitcnt lgkmcnt(13)
    v_and_b32 v44, 0xffff, v34
    v_and_b32 v34, 0xffff0000, v34
    v_and_b32 v45, 0xffff, v35
    v_and_b32 v35, 0xffff0000, v35
    s_waitcnt lgkmcnt(12)
    v_and_b32 v46, 0xffff, v36
    v_and_b32 v36, 0xffff0000, v36
    v_and_b32 v47, 0xffff, v37
    v_and_b32 v37, 0xffff0000, v37
    s_waitcnt lgkmcnt(11)
    v_and_b32 v48, 0xffff, v38
    v_and_b32 v38, 0xffff0000, v38
    v_and_b32 v49, 0xffff, v39
    v_and_b32 v39, 0xffff0000, v39
    s_waitcnt lgkmcnt(10)
    v_and_b32 v50, 0xffff, v40
    v_and_b32 v40, 0xffff0000, v40
    v_and_b32 v51, 0xffff, v41
    v_and_b32 v41, 0xffff0000, v41
    s_waitcnt lgkmcnt(9)
    v_and_b32 v52, 0xffff, v42
    v_and_b32 v42, 0xffff0000, v42
    s_waitcnt lgkmcnt(8)
    v_dot2_f32_bf16 v56, v16, v44, 0
    v_dot2_f32_bf16 v57, v16, v34, 0
    v_dot2_f32_bf16 v58, v17, v44, 0
    v_dot2_f32_bf16 v59, v17, v34, 0
    s_waitcnt lgkmcnt(7)
    v_dot2_f32_bf16 v60, v18, v45, 0
    v_dot2_f32_bf16 v61, v18, v35, 0
    v_dot2_f32_bf16 v62, v19, v45, 0
    v_dot2_f32_bf16 v63, v19, v35, 0
    v_cvt_pk_bf16_f32 v56, v56, v57
    v_cvt_pk_bf16_f32 v58, v58, v59
    v_dot2c_f32_bf16 v8, v56, v10
    v_dot2c_f32_bf16 v9, v58, v10
    s_waitcnt lgkmcnt(6)
    v_dot2_f32_bf16 v56, v20, v46, 0
    v_dot2_f32_bf16 v57, v20, v36, 0
    v_dot2_f32_bf16 v58, v21, v46, 0
    v_dot2_f32_bf16 v59, v21, v36, 0
    v_cvt_pk_bf16_f32 v60, v60, v61
    v_cvt_pk_bf16_f32 v62, v62, v63
    v_dot2c_f32_bf16 v8, v60, v10
    v_dot2c_f32_bf16 v9, v62, v10
    s_waitcnt lgkmcnt(5)
    v_dot2_f32_bf16 v60, v22, v47, 0
    v_dot2_f32_bf16 v61, v22, v37, 0
    v_dot2_f32_bf16 v62, v23, v47, 0
    v_dot2_f32_bf16 v63, v23, v37, 0
    v_cvt_pk_bf16_f32 v56, v56, v57
    v_cvt_pk_bf16_f32 v58, v58, v59
    v_dot2c_f32_bf16 v8, v56, v10
    v_dot2c_f32_bf16 v9, v58, v10
    s_waitcnt lgkmcnt(4)
    v_dot2_f32_bf16 v56, v24, v48, 0
    v_dot2_f32_bf16 v57, v24, v38, 0
    v_dot2_f32_bf16 v58, v25, v48, 0
    v_dot2_f32_bf16 v59, v25, v38, 0
    v_cvt_pk_bf16_f32 v60, v60, v61
    v_cvt_pk_bf16_f32 v62, v62, v63
    v_dot2c_f32_bf16 v8, v60, v10
    v_dot2c_f32_bf16 v9, v62, v10
    s_waitcnt lgkmcnt(3)
    v_dot2_f32_bf16 v60, v26, v49, 0
    v_dot2_f32_bf16 v61, v26, v39, 0
    v_dot2_f32_bf16 v62, v27, v49, 0
    v_dot2_f32_bf16 v63, v27, v39, 0
    v_cvt_pk_bf16_f32 v56, v56, v57
    v_cvt_pk_bf16_f32 v58, v58, v59
    v_dot2c_f32_bf16 v8, v56, v10
    v_dot2c_f32_bf16 v9, v58, v10
    s_waitcnt lgkmcnt(2)
    v_dot2_f32_bf16 v56, v28, v50, 0
    v_dot2_f32_bf16 v57, v28, v40, 0
    v_dot2_f32_bf16 v58, v29, v50, 0
    v_dot2_f32_bf16 v59, v29, v40, 0
    v_cvt_pk_bf16_f32 v60, v60, v61
    v_cvt_pk_bf16_f32 v62, v62, v63
    v_dot2c_f32_bf16 v8, v60, v10
    v_dot2c_f32_bf16 v9, v62, v10
    s_waitcnt lgkmcnt(1)
    v_dot2_f32_bf16 v60, v30, v51, 0
    v_dot2_f32_bf16 v61, v30, v41, 0
    v_dot2_f32_bf16 v62, v31, v51, 0
    v_dot2_f32_bf16 v63, v31, v41, 0
    v_cvt_pk_bf16_f32 v56, v56, v57
    v_cvt_pk_bf16_f32 v58, v58, v59
    v_dot2c_f32_bf16 v8, v56, v10
    v_dot2c_f32_bf16 v9, v58, v10
    s_waitcnt lgkmcnt(0)
    v_dot2_f32_bf16 v56, v32, v52, 0
    v_dot2_f32_bf16 v57, v32, v42, 0
    v_dot2_f32_bf16 v58, v33, v52, 0
    v_dot2_f32_bf16 v59, v33, v42, 0
    v_cvt_pk_bf16_f32 v60, v60, v61
    v_cvt_pk_bf16_f32 v62, v62, v63
    v_dot2c_f32_bf16 v8, v60, v10
    v_dot2c_f32_bf16 v9, v62, v10
    v_cvt_pk_bf16_f32 v56, v56, v57
    v_cvt_pk_bf16_f32 v58, v58, v59
    v_dot2c_f32_bf16 v8, v56, v10
    v_dot2c_f32_bf16 v9, v58, v10
    v_mov_b32 v11, 1
    s_mov_b64 exec, 1
    ds_add_u32 v1, v11 offset:12
    s_mov_b64 exec, -1
    v_permlane16_swap_b32 v8, v9
    v_add_f32 v8, v8, v9
    s_nop 1
    v_add_f32_dpp v8, v8, v8 row_ror:8 row_mask:0xf bank_mask:0xf
    s_nop 1
    v_add_f32_dpp v8, v8, v8 row_ror:4 row_mask:0xf bank_mask:0xf
    s_nop 1
    v_add_f32_dpp v8, v8, v8 row_ror:2 row_mask:0xf bank_mask:0xf
    s_nop 1
    v_add_f32_dpp v8, v8, v8 row_ror:1 row_mask:0xf bank_mask:0xf
    v_cvt_pk_bf16_f32 v8, v8, v8
    v_and_b32 v8, 0xffff0000, v8
    v_mul_f32 v9, 0xbfb8aa3b, v8
    v_exp_f32 v9, v9
    s_nop 0
    v_add_f32 v9, 1.0, v9
    v_rcp_f32 v8, v9
    s_nop 0
    v_cvt_pk_bf16_f32 v8, v8, v8
    v_and_b32 v8, 0xffff0000, v8
    v_sub_f32 v9, 1.0, v8
    v_cvt_pk_bf16_f32 v12, v8, v9
    s_mov_b32 exec_lo, 0x00010001
    s_mov_b32 exec_hi, 0x00010001
    global_store_dwordx2 v7, v[12:13], s[50:51] sc1
    s_mov_b64 exec, -1
    s_cmp_lt_u32 s5, 9
    s_cbranch_scc1 F_COMP2
    s_cmp_ge_u32 s5, 14
    s_cbranch_scc1 C_IO
    s_endpgm
C_KBODY:
C_SETD:
    s_waitcnt lgkmcnt(0)
    s_lshl_b32 s8, s12, 4
    s_lshr_b64 s[58:59], s[58:59], s8
    s_lshl_b32 s8, s58, 16
    v_mov_b32 v44, s8
    v_mul_f32 v45, 0x3fb8aa3b, v44
    v_mov_b32 v46, 0x3fb8aa3b
    v_fma_f32 v46, v44, v46, -v45
    v_mov_b32 v47, 0x32a57060
    v_fma_f32 v46, v44, v47, v46
    v_exp_f32 v45, v45
    v_mul_f32 v46, 0x3f317218, v46
    v_fma_f32 v45, v45, v46, v45
    v_cvt_pk_bf16_f32 v45, v45, v45
    v_and_b32 v36, 0xffff0000, v45
    v_mul_f32 v37, 0x3fb8aa3b, v36
    v_mul_f32 v38, 0x3e22f983, v36
    s_waitcnt vmcnt(0)
    v_mul_f32 v40, v16, v37
    v_mul_f32 v41, v17, v38
    v_exp_f32 v24, v40
    v_fract_f32 v47, v41
    v_cos_f32 v46, v47
    v_sin_f32 v47, v47
    v_mul_f32 v46, v24, v46
    v_mul_f32 v47, v24, v47
    v_mul_f32 v18, v18, v36
    v_mul_f32 v19, v19, v36
    v_pk_mul_f32 v[42:43], v[20:21], v[18:19] op_sel:[0,0] op_sel_hi:[0,1]
    v_pk_fma_f32 v[42:43], v[20:21], v[18:19], v[42:43] op_sel:[1,1,0] op_sel_hi:[1,0,1] neg_lo:[0,1,0]
    v_max_f32 v39, |v42|, |v43|
    v_pk_mul_f32 v[48:49], v[46:47], v[46:47] op_sel:[0,0] op_sel_hi:[0,1]
    v_pk_fma_f32 v[48:49], v[46:47], v[46:47], v[48:49] op_sel:[1,1,0] op_sel_hi:[1,0,1] neg_lo:[0,1,0]
    v_pk_mul_f32 v[52:53], v[48:49], v[48:49] op_sel:[0,0] op_sel_hi:[0,1]
    v_pk_fma_f32 v[52:53], v[48:49], v[48:49], v[52:53] op_sel:[1,1,0] op_sel_hi:[1,0,1] neg_lo:[0,1,0]
    v_pk_mul_f32 v[60:61], v[52:53], v[52:53] op_sel:[0,0] op_sel_hi:[0,1]
    v_pk_fma_f32 v[60:61], v[52:53], v[52:53], v[60:61] op_sel:[1,1,0] op_sel_hi:[1,0,1] neg_lo:[0,1,0]
    v_mov_b32 v30, 0x3c00
    v_xor_b32 v61, 0x80000000, v61
    ds_write_addtid_b32 v30
    v_cvt_pk_f16_f32 v26, v60, v61
    v_pk_mul_f32 v[62:63], v[60:61], v[60:61] op_sel:[0,0] op_sel_hi:[0,1]
    v_pk_fma_f32 v[62:63], v[60:61], v[60:61], v[62:63] op_sel:[1,1,0] op_sel_hi:[1,0,1] neg_lo:[0,1,0]
    v_max_u32_dpp v39, v39, v39 row_shr:1 row_mask:0xf bank_mask:0xf
    ds_write_addtid_b32 v26 offset:288
    v_cvt_pk_f16_f32 v27, v62, v63
    v_pk_mul_f32 v[64:65], v[62:63], v[60:61] op_sel:[0,0] op_sel_hi:[0,1]
    v_pk_fma_f32 v[64:65], v[62:63], v[60:61], v[64:65] op_sel:[1,1,0] op_sel_hi:[1,0,1] neg_lo:[0,1,0]
    v_max_u32_dpp v39, v39, v39 row_shr:2 row_mask:0xf bank_mask:0xf
    ds_write_addtid_b32 v27 offset:576
    v_cvt_pk_f16_f32 v28, v64, v65
    v_pk_mul_f32 v[62:63], v[64:65], v[60:61] op_sel:[0,0] op_sel_hi:[0,1]
    v_pk_fma_f32 v[62:63], v[64:65], v[60:61], v[62:63] op_sel:[1,1,0] op_sel_hi:[1,0,1] neg_lo:[0,1,0]
    v_max_u32_dpp v39, v39, v39 row_shr:4 row_mask:0xf bank_mask:0xf
    ds_write_addtid_b32 v28 offset:864
    v_cvt_pk_f16_f32 v29, v62, v63
    v_pk_mul_f32 v[64:65], v[62:63], v[60:61] op_sel:[0,0] op_sel_hi:[0,1]
    v_pk_fma_f32 v[64:65], v[62:63], v[60:61], v[64:65] op_sel:[1,1,0] op_sel_hi:[1,0,1] neg_lo:[0,1,0]
    v_max_u32_dpp v39, v39, v39 row_shr:8 row_mask:0xf bank_mask:0xf
    ds_write_addtid_b32 v29 offset:1152
    v_cvt_pk_f16_f32 v26, v64, v65
    v_pk_mul_f32 v[62:63], v[64:65], v[60:61] op_sel:[0,0] op_sel_hi:[0,1]
    v_pk_fma_f32 v[62:63], v[64:65], v[60:61], v[62:63] op_sel:[1,1,0] op_sel_hi:[1,0,1] neg_lo:[0,1,0]
    v_max_u32_dpp v39, v39, v39 row_bcast:15 row_mask:0xa bank_mask:0xf
    ds_write_addtid_b32 v26 offset:1440
    v_cvt_pk_f16_f32 v27, v62, v63
    v_pk_mul_f32 v[64:65], v[62:63], v[60:61] op_sel:[0,0] op_sel_hi:[0,1]
    v_pk_fma_f32 v[64:65], v[62:63], v[60:61], v[64:65] op_sel:[1,1,0] op_sel_hi:[1,0,1] neg_lo:[0,1,0]
    v_max_u32_dpp v39, v39, v39 row_bcast:31 row_mask:0xc bank_mask:0xf
    ds_write_addtid_b32 v27 offset:1728
    v_cvt_pk_f16_f32 v28, v64, v65
    v_pk_mul_f32 v[62:63], v[64:65], v[60:61] op_sel:[0,0] op_sel_hi:[0,1]
    v_pk_fma_f32 v[62:63], v[64:65], v[60:61], v[62:63] op_sel:[1,1,0] op_sel_hi:[1,0,1] neg_lo:[0,1,0]
    v_readlane_b32 s8, v39, 63
    ds_write_addtid_b32 v28 offset:2016
    v_cvt_pk_f16_f32 v29, v62, v63
    v_pk_mul_f32 v[64:65], v[62:63], v[60:61] op_sel:[0,0] op_sel_hi:[0,1]
    v_pk_fma_f32 v[64:65], v[62:63], v[60:61], v[64:65] op_sel:[1,1,0] op_sel_hi:[1,0,1] neg_lo:[0,1,0]
    ds_write_addtid_b32 v29 offset:2304
    v_cvt_pk_f16_f32 v26, v64, v65
    v_pk_mul_f32 v[62:63], v[64:65], v[60:61] op_sel:[0,0] op_sel_hi:[0,1]
    v_pk_fma_f32 v[62:63], v[64:65], v[60:61], v[62:63] op_sel:[1,1,0] op_sel_hi:[1,0,1] neg_lo:[0,1,0]
    ds_write_addtid_b32 v26 offset:2592
    v_cvt_pk_f16_f32 v27, v62, v63
    v_pk_mul_f32 v[64:65], v[62:63], v[60:61] op_sel:[0,0] op_sel_hi:[0,1]
    v_pk_fma_f32 v[64:65], v[62:63], v[60:61], v[64:65] op_sel:[1,1,0] op_sel_hi:[1,0,1] neg_lo:[0,1,0]
    ds_write_addtid_b32 v27 offset:2880
    v_cvt_pk_f16_f32 v28, v64, v65
    v_pk_mul_f32 v[62:63], v[64:65], v[60:61] op_sel:[0,0] op_sel_hi:[0,1]
    v_pk_fma_f32 v[62:63], v[64:65], v[60:61], v[62:63] op_sel:[1,1,0] op_sel_hi:[1,0,1] neg_lo:[0,1,0]
    ds_write_addtid_b32 v28 offset:3168
    v_cvt_pk_f16_f32 v29, v62, v63
    v_pk_mul_f32 v[64:65], v[62:63], v[60:61] op_sel:[0,0] op_sel_hi:[0,1]
    v_pk_fma_f32 v[64:65], v[62:63], v[60:61], v[64:65] op_sel:[1,1,0] op_sel_hi:[1,0,1] neg_lo:[0,1,0]
    ds_write_addtid_b32 v29 offset:3456
    v_cvt_pk_f16_f32 v26, v64, v65
    v_pk_mul_f32 v[62:63], v[64:65], v[60:61] op_sel:[0,0] op_sel_hi:[0,1]
    v_pk_fma_f32 v[62:63], v[64:65], v[60:61], v[62:63] op_sel:[1,1,0] op_sel_hi:[1,0,1] neg_lo:[0,1,0]
    ds_write_addtid_b32 v26 offset:3744
    v_cvt_pk_f16_f32 v27, v62, v63
    v_pk_mul_f32 v[64:65], v[62:63], v[60:61] op_sel:[0,0] op_sel_hi:[0,1]
    v_pk_fma_f32 v[64:65], v[62:63], v[60:61], v[64:65] op_sel:[1,1,0] op_sel_hi:[1,0,1] neg_lo:[0,1,0]
    ds_write_addtid_b32 v27 offset:4032
    v_cvt_pk_f16_f32 v28, v64, v65
    s_lshr_b32 s8, s8, 23
    s_sub_u32 s8, 258, s8
    s_min_u32 s54, s8, 253
    s_lshl_b32 s8, s54, 23
    v_mul_f32 v42, s8, v42
    v_mul_f32 v43, s8, v43
    ds_write_addtid_b32 v28 offset:4320
    ds_read_b128 v[72:75], v7 offset:0
    ds_read_b128 v[76:79], v7 offset:64
    ds_read_b128 v[80:83], v7 offset:128
    ds_read_b128 v[84:87], v7 offset:192
    v_mul_f32 v44, 0x43000000, v40
    v_mul_f32 v45, 0x43000000, v41
    v_exp_f32 v24, v44
    v_fract_f32 v45, v45
    v_cos_f32 v44, v45
    v_sin_f32 v45, v45
    v_mul_f32 v44, v24, v44
    v_mul_f32 v45, v24, v45
    v_pk_mul_f32 v[50:51], v[48:49], v[46:47] op_sel:[0,0] op_sel_hi:[0,1]
    v_pk_fma_f32 v[50:51], v[48:49], v[46:47], v[50:51] op_sel:[1,1,0] op_sel_hi:[1,0,1] neg_lo:[0,1,0]
    v_pk_mul_f32 v[54:55], v[52:53], v[46:47] op_sel:[0,0] op_sel_hi:[0,1]
    v_pk_fma_f32 v[54:55], v[52:53], v[46:47], v[54:55] op_sel:[1,1,0] op_sel_hi:[1,0,1] neg_lo:[0,1,0]
    v_pk_mul_f32 v[56:57], v[50:51], v[50:51] op_sel:[0,0] op_sel_hi:[0,1]
    v_pk_fma_f32 v[56:57], v[50:51], v[50:51], v[56:57] op_sel:[1,1,0] op_sel_hi:[1,0,1] neg_lo:[0,1,0]
    v_pk_mul_f32 v[58:59], v[56:57], v[46:47] op_sel:[0,0] op_sel_hi:[0,1]
    v_pk_fma_f32 v[58:59], v[56:57], v[46:47], v[58:59] op_sel:[1,1,0] op_sel_hi:[1,0,1] neg_lo:[0,1,0]
    v_cvt_pk_f16_f32 v29, v42, v43
    v_pk_mul_f32 v[60:61], v[42:43], v[46:47] op_sel:[0,0] op_sel_hi:[0,1]
    v_pk_fma_f32 v[60:61], v[42:43], v[46:47], v[60:61] op_sel:[1,1,0] op_sel_hi:[1,0,1] neg_lo:[0,1,0]
    ds_write_addtid_b32 v29 offset:0
    v_cvt_pk_f16_f32 v26, v60, v61
    v_pk_mul_f32 v[62:63], v[42:43], v[48:49] op_sel:[0,0] op_sel_hi:[0,1]
    v_pk_fma_f32 v[62:63], v[42:43], v[48:49], v[62:63] op_sel:[1,1,0] op_sel_hi:[1,0,1] neg_lo:[0,1,0]
    ds_write_addtid_b32 v26 offset:288
    v_cvt_pk_f16_f32 v27, v62, v63
    v_pk_mul_f32 v[60:61], v[42:43], v[50:51] op_sel:[0,0] op_sel_hi:[0,1]
    v_pk_fma_f32 v[60:61], v[42:43], v[50:51], v[60:61] op_sel:[1,1,0] op_sel_hi:[1,0,1] neg_lo:[0,1,0]
    ds_write_addtid_b32 v27 offset:576
    v_cvt_pk_f16_f32 v28, v60, v61
    v_pk_mul_f32 v[62:63], v[42:43], v[52:53] op_sel:[0,0] op_sel_hi:[0,1]
    v_pk_fma_f32 v[62:63], v[42:43], v[52:53], v[62:63] op_sel:[1,1,0] op_sel_hi:[1,0,1] neg_lo:[0,1,0]
    ds_write_addtid_b32 v28 offset:864
    v_cvt_pk_f16_f32 v29, v62, v63
    v_pk_mul_f32 v[60:61], v[42:43], v[54:55] op_sel:[0,0] op_sel_hi:[0,1]
    v_pk_fma_f32 v[60:61], v[42:43], v[54:55], v[60:61] op_sel:[1,1,0] op_sel_hi:[1,0,1] neg_lo:[0,1,0]
    ds_write_addtid_b32 v29 offset:1152
    v_cvt_pk_f16_f32 v26, v60, v61
    v_pk_mul_f32 v[62:63], v[42:43], v[56:57] op_sel:[0,0] op_sel_hi:[0,1]
    v_pk_fma_f32 v[62:63], v[42:43], v[56:57], v[62:63] op_sel:[1,1,0] op_sel_hi:[1,0,1] neg_lo:[0,1,0]
    ds_write_addtid_b32 v26 offset:1440
    v_cvt_pk_f16_f32 v27, v62, v63
    v_pk_mul_f32 v[60:61], v[42:43], v[58:59] op_sel:[0,0] op_sel_hi:[0,1]
    v_pk_fma_f32 v[60:61], v[42:43], v[58:59], v[60:61] op_sel:[1,1,0] op_sel_hi:[1,0,1] neg_lo:[0,1,0]
    ds_write_addtid_b32 v27 offset:1728
    v_cvt_pk_f16_f32 v28, v60, v61
    v_pk_mul_f32 v[66:67], v[42:43], v[44:45] op_sel:[0,0] op_sel_hi:[0,1]
    v_pk_fma_f32 v[66:67], v[42:43], v[44:45], v[66:67] op_sel:[1,1,0] op_sel_hi:[1,0,1] neg_lo:[0,1,0]
    ds_write_addtid_b32 v28 offset:2016
    v_cvt_pk_f16_f32 v29, v66, v67
    v_pk_mul_f32 v[62:63], v[66:67], v[46:47] op_sel:[0,0] op_sel_hi:[0,1]
    v_pk_fma_f32 v[62:63], v[66:67], v[46:47], v[62:63] op_sel:[1,1,0] op_sel_hi:[1,0,1] neg_lo:[0,1,0]
    ds_write_addtid_b32 v29 offset:2304
    v_cvt_pk_f16_f32 v26, v62, v63
    v_pk_mul_f32 v[60:61], v[66:67], v[48:49] op_sel:[0,0] op_sel_hi:[0,1]
    v_pk_fma_f32 v[60:61], v[66:67], v[48:49], v[60:61] op_sel:[1,1,0] op_sel_hi:[1,0,1] neg_lo:[0,1,0]
    ds_write_addtid_b32 v26 offset:2592
    v_cvt_pk_f16_f32 v27, v60, v61
    v_pk_mul_f32 v[62:63], v[66:67], v[50:51] op_sel:[0,0] op_sel_hi:[0,1]
    v_pk_fma_f32 v[62:63], v[66:67], v[50:51], v[62:63] op_sel:[1,1,0] op_sel_hi:[1,0,1] neg_lo:[0,1,0]
    ds_write_addtid_b32 v27 offset:2880
    v_cvt_pk_f16_f32 v28, v62, v63
    v_pk_mul_f32 v[60:61], v[66:67], v[52:53] op_sel:[0,0] op_sel_hi:[0,1]
    v_pk_fma_f32 v[60:61], v[66:67], v[52:53], v[60:61] op_sel:[1,1,0] op_sel_hi:[1,0,1] neg_lo:[0,1,0]
    ds_write_addtid_b32 v28 offset:3168
    v_cvt_pk_f16_f32 v29, v60, v61
    v_pk_mul_f32 v[62:63], v[66:67], v[54:55] op_sel:[0,0] op_sel_hi:[0,1]
    v_pk_fma_f32 v[62:63], v[66:67], v[54:55], v[62:63] op_sel:[1,1,0] op_sel_hi:[1,0,1] neg_lo:[0,1,0]
    ds_write_addtid_b32 v29 offset:3456
    v_cvt_pk_f16_f32 v26, v62, v63
    v_pk_mul_f32 v[60:61], v[66:67], v[56:57] op_sel:[0,0] op_sel_hi:[0,1]
    v_pk_fma_f32 v[60:61], v[66:67], v[56:57], v[60:61] op_sel:[1,1,0] op_sel_hi:[1,0,1] neg_lo:[0,1,0]
    ds_write_addtid_b32 v26 offset:3744
    v_cvt_pk_f16_f32 v27, v60, v61
    v_pk_mul_f32 v[62:63], v[66:67], v[58:59] op_sel:[0,0] op_sel_hi:[0,1]
    v_pk_fma_f32 v[62:63], v[66:67], v[58:59], v[62:63] op_sel:[1,1,0] op_sel_hi:[1,0,1] neg_lo:[0,1,0]
    ds_write_addtid_b32 v27 offset:4032
    v_cvt_pk_f16_f32 v28, v62, v63
    v_pk_mul_f32 v[68:69], v[66:67], v[44:45] op_sel:[0,0] op_sel_hi:[0,1]
    v_pk_fma_f32 v[68:69], v[66:67], v[44:45], v[68:69] op_sel:[1,1,0] op_sel_hi:[1,0,1] neg_lo:[0,1,0]
    ds_write_addtid_b32 v28 offset:4320
    ds_read_b128 v[88:91], v7 offset:0
    ds_read_b128 v[92:95], v7 offset:64
    ds_read_b128 v[96:99], v7 offset:128
    ds_read_b128 v[100:103], v7 offset:192
    v_cvt_pk_f16_f32 v29, v68, v69
    v_pk_mul_f32 v[60:61], v[68:69], v[48:49] op_sel:[0,0] op_sel_hi:[0,1]
    v_pk_fma_f32 v[60:61], v[68:69], v[48:49], v[60:61] op_sel:[1,1,0] op_sel_hi:[1,0,1] neg_lo:[0,1,0]
    ds_write_addtid_b32 v29 offset:0
    v_cvt_pk_f16_f32 v26, v60, v61
    v_pk_mul_f32 v[62:63], v[68:69], v[52:53] op_sel:[0,0] op_sel_hi:[0,1]
    v_pk_fma_f32 v[62:63], v[68:69], v[52:53], v[62:63] op_sel:[1,1,0] op_sel_hi:[1,0,1] neg_lo:[0,1,0]
    ds_write_addtid_b32 v26 offset:288
    v_cvt_pk_f16_f32 v27, v62, v63
    v_pk_mul_f32 v[60:61], v[68:69], v[56:57] op_sel:[0,0] op_sel_hi:[0,1]
    v_pk_fma_f32 v[60:61], v[68:69], v[56:57], v[60:61] op_sel:[1,1,0] op_sel_hi:[1,0,1] neg_lo:[0,1,0]
    ds_write_addtid_b32 v27 offset:576
    v_cvt_pk_f16_f32 v28, v60, v61
    v_pk_mul_f32 v[66:67], v[68:69], v[44:45] op_sel:[0,0] op_sel_hi:[0,1]
    v_pk_fma_f32 v[66:67], v[68:69], v[44:45], v[66:67] op_sel:[1,1,0] op_sel_hi:[1,0,1] neg_lo:[0,1,0]
    ds_write_addtid_b32 v28 offset:864
    v_cvt_pk_f16_f32 v29, v66, v67
    s_waitcnt lgkmcnt(7)
    v_mfma_f32_16x16x32_f16 v[104:107], v[88:91], v[72:75], 0
    v_pk_mul_f32 v[62:63], v[66:67], v[48:49] op_sel:[0,0] op_sel_hi:[0,1]
    v_pk_fma_f32 v[62:63], v[66:67], v[48:49], v[62:63] op_sel:[1,1,0] op_sel_hi:[1,0,1] neg_lo:[0,1,0]
    ds_write_addtid_b32 v29 offset:1152
    v_cvt_pk_f16_f32 v26, v62, v63
    s_waitcnt lgkmcnt(7)
    v_mfma_f32_16x16x32_f16 v[104:107], v[92:95], v[76:79], v[104:107]
    v_pk_mul_f32 v[60:61], v[66:67], v[52:53] op_sel:[0,0] op_sel_hi:[0,1]
    v_pk_fma_f32 v[60:61], v[66:67], v[52:53], v[60:61] op_sel:[1,1,0] op_sel_hi:[1,0,1] neg_lo:[0,1,0]
    ds_write_addtid_b32 v26 offset:1440
    v_cvt_pk_f16_f32 v27, v60, v61
    s_waitcnt lgkmcnt(7)
    v_mfma_f32_16x16x32_f16 v[104:107], v[96:99], v[80:83], v[104:107]
    v_pk_mul_f32 v[62:63], v[66:67], v[56:57] op_sel:[0,0] op_sel_hi:[0,1]
    v_pk_fma_f32 v[62:63], v[66:67], v[56:57], v[62:63] op_sel:[1,1,0] op_sel_hi:[1,0,1] neg_lo:[0,1,0]
    ds_write_addtid_b32 v27 offset:1728
    v_cvt_pk_f16_f32 v28, v62, v63
    s_waitcnt lgkmcnt(7)
    v_mfma_f32_16x16x32_f16 v[104:107], v[100:103], v[84:87], v[104:107]
    v_pk_mul_f32 v[68:69], v[66:67], v[44:45] op_sel:[0,0] op_sel_hi:[0,1]
    v_pk_fma_f32 v[68:69], v[66:67], v[44:45], v[68:69] op_sel:[1,1,0] op_sel_hi:[1,0,1] neg_lo:[0,1,0]
    ds_write_addtid_b32 v28 offset:2016
    v_cvt_pk_f16_f32 v29, v68, v69
    v_pk_mul_f32 v[60:61], v[68:69], v[52:53] op_sel:[0,0] op_sel_hi:[0,1]
    v_pk_fma_f32 v[60:61], v[68:69], v[52:53], v[60:61] op_sel:[1,1,0] op_sel_hi:[1,0,1] neg_lo:[0,1,0]
    ds_write_addtid_b32 v29 offset:2304
    v_cvt_pk_f16_f32 v26, v60, v61
    v_pk_mul_f32 v[66:67], v[68:69], v[44:45] op_sel:[0,0] op_sel_hi:[0,1]
    v_pk_fma_f32 v[66:67], v[68:69], v[44:45], v[66:67] op_sel:[1,1,0] op_sel_hi:[1,0,1] neg_lo:[0,1,0]
    ds_write_addtid_b32 v26 offset:2592
    v_cvt_pk_f16_f32 v27, v66, v67
    v_pk_mul_f32 v[62:63], v[66:67], v[52:53] op_sel:[0,0] op_sel_hi:[0,1]
    v_pk_fma_f32 v[62:63], v[66:67], v[52:53], v[62:63] op_sel:[1,1,0] op_sel_hi:[1,0,1] neg_lo:[0,1,0]
    ds_write_addtid_b32 v27 offset:2880
    v_cvt_pk_f16_f32 v28, v62, v63
    v_pk_mul_f32 v[68:69], v[66:67], v[44:45] op_sel:[0,0] op_sel_hi:[0,1]
    v_pk_fma_f32 v[68:69], v[66:67], v[44:45], v[68:69] op_sel:[1,1,0] op_sel_hi:[1,0,1] neg_lo:[0,1,0]
    ds_write_addtid_b32 v28 offset:3168
    v_cvt_pk_f16_f32 v29, v68, v69
    v_pk_mul_f32 v[60:61], v[68:69], v[52:53] op_sel:[0,0] op_sel_hi:[0,1]
    v_pk_fma_f32 v[60:61], v[68:69], v[52:53], v[60:61] op_sel:[1,1,0] op_sel_hi:[1,0,1] neg_lo:[0,1,0]
    ds_write_addtid_b32 v29 offset:3456
    v_cvt_pk_f16_f32 v26, v60, v61
    v_pk_mul_f32 v[66:67], v[68:69], v[44:45] op_sel:[0,0] op_sel_hi:[0,1]
    v_pk_fma_f32 v[66:67], v[68:69], v[44:45], v[66:67] op_sel:[1,1,0] op_sel_hi:[1,0,1] neg_lo:[0,1,0]
    ds_write_addtid_b32 v26 offset:3744
    v_cvt_pk_f16_f32 v27, v66, v67
    v_pk_mul_f32 v[62:63], v[66:67], v[52:53] op_sel:[0,0] op_sel_hi:[0,1]
    v_pk_fma_f32 v[62:63], v[66:67], v[52:53], v[62:63] op_sel:[1,1,0] op_sel_hi:[1,0,1] neg_lo:[0,1,0]
    ds_write_addtid_b32 v27 offset:4032
    v_cvt_pk_f16_f32 v28, v62, v63
    v_pk_mul_f32 v[68:69], v[66:67], v[44:45] op_sel:[0,0] op_sel_hi:[0,1]
    v_pk_fma_f32 v[68:69], v[66:67], v[44:45], v[68:69] op_sel:[1,1,0] op_sel_hi:[1,0,1] neg_lo:[0,1,0]
    ds_write_addtid_b32 v28 offset:4320
    ds_read_b128 v[88:91], v7 offset:0
    ds_read_b128 v[92:95], v7 offset:64
    ds_read_b128 v[96:99], v7 offset:128
    ds_read_b128 v[100:103], v7 offset:192
    v_cvt_pk_f16_f32 v29, v68, v69
    v_pk_mul_f32 v[66:67], v[68:69], v[44:45] op_sel:[0,0] op_sel_hi:[0,1]
    v_pk_fma_f32 v[66:67], v[68:69], v[44:45], v[66:67] op_sel:[1,1,0] op_sel_hi:[1,0,1] neg_lo:[0,1,0]
    ds_write_addtid_b32 v29 offset:0
    v_cvt_pk_f16_f32 v26, v66, v67
    v_pk_mul_f32 v[68:69], v[66:67], v[44:45] op_sel:[0,0] op_sel_hi:[0,1]
    v_pk_fma_f32 v[68:69], v[66:67], v[44:45], v[68:69] op_sel:[1,1,0] op_sel_hi:[1,0,1] neg_lo:[0,1,0]
    ds_write_addtid_b32 v26 offset:288
    v_cvt_pk_f16_f32 v27, v68, v69
    v_pk_mul_f32 v[66:67], v[68:69], v[44:45] op_sel:[0,0] op_sel_hi:[0,1]
    v_pk_fma_f32 v[66:67], v[68:69], v[44:45], v[66:67] op_sel:[1,1,0] op_sel_hi:[1,0,1] neg_lo:[0,1,0]
    ds_write_addtid_b32 v27 offset:576
    v_cvt_pk_f16_f32 v28, v66, v67
    v_pk_mul_f32 v[68:69], v[66:67], v[44:45] op_sel:[0,0] op_sel_hi:[0,1]
    v_pk_fma_f32 v[68:69], v[66:67], v[44:45], v[68:69] op_sel:[1,1,0] op_sel_hi:[1,0,1] neg_lo:[0,1,0]
    ds_write_addtid_b32 v28 offset:864
    v_cvt_pk_f16_f32 v29, v68, v69
    v_pk_mul_f32 v[66:67], v[68:69], v[44:45] op_sel:[0,0] op_sel_hi:[0,1]
    v_pk_fma_f32 v[66:67], v[68:69], v[44:45], v[66:67] op_sel:[1,1,0] op_sel_hi:[1,0,1] neg_lo:[0,1,0]
    s_waitcnt lgkmcnt(7)
    v_mfma_f32_16x16x32_f16 v[108:111], v[88:91], v[72:75], 0
    ds_write_addtid_b32 v29 offset:1152
    v_cvt_pk_f16_f32 v26, v66, v67
    v_pk_mul_f32 v[68:69], v[66:67], v[44:45] op_sel:[0,0] op_sel_hi:[0,1]
    v_pk_fma_f32 v[68:69], v[66:67], v[44:45], v[68:69] op_sel:[1,1,0] op_sel_hi:[1,0,1] neg_lo:[0,1,0]
    s_waitcnt lgkmcnt(7)
    v_mfma_f32_16x16x32_f16 v[108:111], v[92:95], v[76:79], v[108:111]
    ds_write_addtid_b32 v26 offset:1440
    v_cvt_pk_f16_f32 v27, v68, v69
    v_pk_mul_f32 v[66:67], v[68:69], v[44:45] op_sel:[0,0] op_sel_hi:[0,1]
    v_pk_fma_f32 v[66:67], v[68:69], v[44:45], v[66:67] op_sel:[1,1,0] op_sel_hi:[1,0,1] neg_lo:[0,1,0]
    s_waitcnt lgkmcnt(7)
    v_mfma_f32_16x16x32_f16 v[108:111], v[96:99], v[80:83], v[108:111]
    ds_write_addtid_b32 v27 offset:1728
    v_cvt_pk_f16_f32 v28, v66, v67
    v_pk_mul_f32 v[68:69], v[66:67], v[44:45] op_sel:[0,0] op_sel_hi:[0,1]
    v_pk_fma_f32 v[68:69], v[66:67], v[44:45], v[68:69] op_sel:[1,1,0] op_sel_hi:[1,0,1] neg_lo:[0,1,0]
    s_waitcnt lgkmcnt(7)
    v_mfma_f32_16x16x32_f16 v[108:111], v[100:103], v[84:87], v[108:111]
    ds_write_addtid_b32 v28 offset:2016
    v_cvt_pk_f16_f32 v29, v68, v69
    ds_write_addtid_b32 v29 offset:2304
    ds_read_b128 v[88:91], v7 offset:0
    ds_read_b128 v[92:95], v7 offset:64
    ds_read_b128 v[96:99], v7 offset:128
    ds_read_b128 v[100:103], v7 offset:192
    v_lshl_add_u32 v8, v2, 4, s15
    s_waitcnt lgkmcnt(3)
    v_mfma_f32_16x16x32_f16 v[112:115], v[88:91], v[72:75], 0
    s_waitcnt lgkmcnt(2)
    v_mfma_f32_16x16x32_f16 v[112:115], v[92:95], v[76:79], v[112:115]
    s_waitcnt lgkmcnt(1)
    v_mfma_f32_16x16x32_f16 v[112:115], v[96:99], v[80:83], v[112:115]
    s_waitcnt lgkmcnt(0)
    v_mfma_f32_16x16x32_f16 v[112:115], v[100:103], v[84:87], v[112:115]
    s_lshl_b32 s8, s12, 2
    s_add_u32 s8, s8, 16
    v_mov_b32 v9, s8
    s_cmp_eq_u32 s13, 0
    s_cbranch_scc1 C_KA
    ds_write_b128 v8, v[104:107] offset:0
    ds_write_b128 v8, v[108:111] offset:1024
    s_nop 0
    ds_write_b128 v8, v[112:115] offset:2048
    v_mov_b32 v10, s54
    ds_write_b32 v9, v10
    s_setprio 0
    v_and_b32 v14, 3, v3
    v_sub_u32 v14, 3, v14
    v_mul_u32_u24 v14, 1216, v14
    v_lshrrev_b32 v13, 2, v3
    v_lshl_add_u32 v13, v4, 1, v13
    v_lshl_add_u32 v14, v13, 3, v14
    v_add3_u32 v5, v14, s52, 8
    v_lshlrev_b32 v14, 1, v3
    v_sub_u32 v14, v4, v14
    v_lshlrev_b32 v14, 4, v14
    s_add_u32 s8, s53, 480
    v_add_u32 v6, s8, v14
    v_lshl_add_u32 v14, v3, 2, v4
    s_mul_i32 s8, s12, 4160
    s_add_u32 s8, s8, 83960
    v_lshlrev_b32 v14, 3, v14
    v_sub_u32 v7, s8, v14
    s_setprio 3
    s_mov_b32 s9, 0
SP_22:
    ds_read_b32 v10, v1 offset:80
    s_waitcnt lgkmcnt(0)
    v_readfirstlane_b32 s8, v10
    s_add_u32 s9, s9, 1
    s_cmp_ge_u32 s8, 1
    s_cbranch_scc1 SP_22_D
    s_sleep 1
    s_cmp_lt_u32 s9, 524288
    s_cbranch_scc1 SP_22
SP_22_D:
    s_setprio 3
    s_mov_b32 s9, 0
SP_23:
    ds_read_b32 v10, v9 offset:48
    s_waitcnt lgkmcnt(0)
    v_readfirstlane_b32 s8, v10
    s_add_u32 s9, s9, 1
    s_cmp_lg_u32 s8, 0
    s_cbranch_scc1 SP_23_D
    s_cmp_lt_u32 s9, 524288
    s_cbranch_scc1 SP_23
SP_23_D:
    s_setprio 2
    v_subrev_u32 v8, 18432, v8
    v_cmp_eq_u32 vcc, 0, v2
    v_mov_b32 v13, 96
    s_nop 0
    v_cndmask_b32 v12, 0, 1, vcc
    v_lshlrev_b32 v14, 2, v2
    v_add_u32 v14, 105216, v14
    v_cndmask_b32 v13, v14, v13, vcc
    ds_read_b64 v[40:41], v5 offset:0
    ds_read_b64 v[42:43], v5 offset:8
    ds_read_b128 v[104:107], v6 offset:3584
    ds_read_b64 v[72:73], v5 offset:512
    ds_read_b64 v[74:75], v5 offset:520
    ds_read_b128 v[108:111], v6 offset:3648
    ds_read_b64 v[44:45], v5 offset:64
    ds_read_b64 v[46:47], v5 offset:72
    ds_read_b64 v[76:77], v5 offset:576
    ds_read_b64 v[78:79], v5 offset:584
    ds_read_b128 v[112:115], v6 offset:3712
    ds_read_b128 v[116:119], v6 offset:3776
    s_waitcnt lgkmcnt(9)
    v_mfma_f32_16x16x32_bf16 v[16:19], v[40:43], v[104:107], 0
    ds_read_b64 v[48:49], v5 offset:128
    ds_read_b64 v[50:51], v5 offset:136
    s_waitcnt lgkmcnt(9)
    v_mfma_f32_16x16x32_bf16 v[20:23], v[72:75], v[104:107], 0
    ds_read_b128 v[120:123], v6 offset:3840
    ds_read_b64 v[80:81], v5 offset:640
    ds_read_b64 v[82:83], v5 offset:648
    s_waitcnt lgkmcnt(9)
    v_mfma_f32_16x16x32_bf16 v[16:19], v[44:47], v[108:111], v[16:19]
    ds_read_b64 v[52:53], v5 offset:192
    ds_read_b64 v[54:55], v5 offset:200
    s_waitcnt lgkmcnt(9)
    v_mfma_f32_16x16x32_bf16 v[20:23], v[76:79], v[108:111], v[20:23]
    ds_read_b128 v[124:127], v6 offset:3904
    ds_read_b64 v[84:85], v5 offset:704
    ds_read_b64 v[86:87], v5 offset:712
    s_waitcnt lgkmcnt(8)
    v_mfma_f32_16x16x32_bf16 v[16:19], v[48:51], v[112:115], v[16:19]
    ds_read_b64 v[56:57], v5 offset:256
    ds_read_b64 v[58:59], v5 offset:264
    s_waitcnt lgkmcnt(7)
    v_mfma_f32_16x16x32_bf16 v[20:23], v[80:83], v[112:115], v[20:23]
    ds_read_b128 v[104:107], v6 offset:3968
    ds_read_b64 v[88:89], v5 offset:768
    ds_read_b64 v[90:91], v5 offset:776
    s_waitcnt lgkmcnt(8)
    v_mfma_f32_16x16x32_bf16 v[16:19], v[52:55], v[116:119], v[16:19]
    ds_read_b64 v[60:61], v5 offset:320
    ds_read_b64 v[62:63], v5 offset:328
    s_waitcnt lgkmcnt(7)
    v_mfma_f32_16x16x32_bf16 v[20:23], v[84:87], v[116:119], v[20:23]
    ds_read_b128 v[108:111], v6 offset:4032
    ds_read_b64 v[92:93], v5 offset:832
    ds_read_b64 v[94:95], v5 offset:840
    s_waitcnt lgkmcnt(8)
    v_mfma_f32_16x16x32_bf16 v[16:19], v[56:59], v[120:123], v[16:19]
    ds_read_b64 v[64:65], v5 offset:384
    ds_read_b64 v[66:67], v5 offset:392
    ds_read_b32 v28, v1 offset:80
    ds_read_b32 v29, v9 offset:32
    s_waitcnt lgkmcnt(9)
    v_mfma_f32_16x16x32_bf16 v[20:23], v[88:91], v[120:123], v[20:23]
    ds_read_b128 v[112:115], v6 offset:3072
    ds_read_b64 v[96:97], v5 offset:896
    ds_read_b64 v[98:99], v5 offset:904
    s_waitcnt lgkmcnt(10)
    v_mfma_f32_16x16x32_bf16 v[16:19], v[60:63], v[124:127], v[16:19]
    ds_read_b64 v[68:69], v5 offset:448
    ds_read_b64 v[70:71], v5 offset:456
    s_waitcnt lgkmcnt(9)
    v_mfma_f32_16x16x32_bf16 v[20:23], v[92:95], v[124:127], v[20:23]
    ds_read_b128 v[116:119], v6 offset:3136
    ds_read_b64 v[100:101], v5 offset:960
    ds_read_b64 v[102:103], v5 offset:968
    s_waitcnt lgkmcnt(10)
    v_mfma_f32_16x16x32_bf16 v[16:19], v[64:67], v[104:107], v[16:19]
    s_waitcnt lgkmcnt(5)
    v_mfma_f32_16x16x32_bf16 v[20:23], v[96:99], v[104:107], v[20:23]
    ds_read_b128 v[120:123], v6 offset:3200
    v_readfirstlane_b32 s9, v29
    s_waitcnt lgkmcnt(4)
    v_mfma_f32_16x16x32_bf16 v[16:19], v[68:71], v[108:111], v[16:19]
    v_readfirstlane_b32 s8, v28
    s_add_u32 s9, s9, 2
    s_waitcnt lgkmcnt(1)
    v_mfma_f32_16x16x32_bf16 v[20:23], v[100:103], v[108:111], v[20:23]
    ds_read_b128 v[124:127], v6 offset:3264
    s_cmp_lt_u32 s8, 2
    s_cbranch_scc1 C_SLOW0
KEEP_P0:
    v_mfma_f32_16x16x32_bf16 v[20:23], v[40:43], v[112:115], v[20:23]
    v_mfma_f32_16x16x32_bf16 v[24:27], v[72:75], v[112:115], 0
    ds_read_b128 v[104:107], v6 offset:3328
    v_mfma_f32_16x16x32_bf16 v[20:23], v[44:47], v[116:119], v[20:23]
    v_mfma_f32_16x16x32_bf16 v[24:27], v[76:79], v[116:119], v[24:27]
    ds_read_b128 v[108:111], v6 offset:3392
    s_waitcnt lgkmcnt(3)
    v_mfma_f32_16x16x32_bf16 v[20:23], v[48:51], v[120:123], v[20:23]
    v_cvt_pk_bf16_f32 v30, v19, v18
    v_cvt_pk_bf16_f32 v31, v17, v16
    v_mfma_f32_16x16x32_bf16 v[24:27], v[80:83], v[120:123], v[24:27]
    ds_read_b128 v[112:115], v6 offset:3456
    ds_write_b64 v7, v[30:31] offset:3584
    s_waitcnt lgkmcnt(4)
    v_mfma_f32_16x16x32_bf16 v[20:23], v[52:55], v[124:127], v[20:23]
    v_mfma_f32_16x16x32_bf16 v[24:27], v[84:87], v[124:127], v[24:27]
    ds_read_b128 v[116:119], v6 offset:3520
    s_waitcnt lgkmcnt(4)
    v_mfma_f32_16x16x32_bf16 v[20:23], v[56:59], v[104:107], v[20:23]
    ds_read_b32 v28, v1 offset:80
    ds_read_b32 v29, v9 offset:32
    v_mfma_f32_16x16x32_bf16 v[24:27], v[88:91], v[104:107], v[24:27]
    ds_read_b128 v[120:123], v6 offset:2560
    s_waitcnt lgkmcnt(6)
    v_mfma_f32_16x16x32_bf16 v[20:23], v[60:63], v[108:111], v[20:23]
    v_mfma_f32_16x16x32_bf16 v[24:27], v[92:95], v[108:111], v[24:27]
    ds_read_b128 v[124:127], v6 offset:2624
    s_waitcnt lgkmcnt(6)
    v_mfma_f32_16x16x32_bf16 v[20:23], v[64:67], v[112:115], v[20:23]
    v_mfma_f32_16x16x32_bf16 v[24:27], v[96:99], v[112:115], v[24:27]
    ds_read_b128 v[104:107], v6 offset:2688
    s_waitcnt lgkmcnt(3)
    v_readfirstlane_b32 s9, v29
    v_mfma_f32_16x16x32_bf16 v[20:23], v[68:71], v[116:119], v[20:23]
    v_readfirstlane_b32 s8, v28
    s_add_u32 s9, s9, 2
    v_mfma_f32_16x16x32_bf16 v[24:27], v[100:103], v[116:119], v[24:27]
    ds_read_b128 v[108:111], v6 offset:2752
    s_cmp_lt_u32 s8, 3
    s_cbranch_scc1 C_SLOW1
KEEP_P1:
    s_waitcnt lgkmcnt(3)
    v_mfma_f32_16x16x32_bf16 v[24:27], v[40:43], v[120:123], v[24:27]
    v_mfma_f32_16x16x32_bf16 v[16:19], v[72:75], v[120:123], 0
    ds_read_b128 v[112:115], v6 offset:2816
    s_waitcnt lgkmcnt(3)
    v_mfma_f32_16x16x32_bf16 v[24:27], v[44:47], v[124:127], v[24:27]
    v_mfma_f32_16x16x32_bf16 v[16:19], v[76:79], v[124:127], v[16:19]
    ds_read_b128 v[116:119], v6 offset:2880
    s_waitcnt lgkmcnt(3)
    v_mfma_f32_16x16x32_bf16 v[24:27], v[48:51], v[104:107], v[24:27]
    v_cvt_pk_bf16_f32 v30, v23, v22
    v_cvt_pk_bf16_f32 v31, v21, v20
    v_mfma_f32_16x16x32_bf16 v[16:19], v[80:83], v[104:107], v[16:19]
    ds_read_b128 v[120:123], v6 offset:2944
    ds_write_b64 v7, v[30:31] offset:3072
    ds_add_u32 v13, v12 offset:0
    s_waitcnt lgkmcnt(5)
    v_mfma_f32_16x16x32_bf16 v[24:27], v[52:55], v[108:111], v[24:27]
    v_mfma_f32_16x16x32_bf16 v[16:19], v[84:87], v[108:111], v[16:19]
    ds_read_b128 v[124:127], v6 offset:3008
    s_waitcnt lgkmcnt(5)
    v_mfma_f32_16x16x32_bf16 v[24:27], v[56:59], v[112:115], v[24:27]
    ds_read_b32 v28, v1 offset:80
    ds_read_b32 v29, v9 offset:32
    v_mfma_f32_16x16x32_bf16 v[16:19], v[88:91], v[112:115], v[16:19]
    ds_read_b128 v[104:107], v6 offset:2048
    s_waitcnt lgkmcnt(7)
    v_mfma_f32_16x16x32_bf16 v[24:27], v[60:63], v[116:119], v[24:27]
    ds_read_b128 v[32:35], v8 offset:0
    v_mfma_f32_16x16x32_bf16 v[16:19], v[92:95], v[116:119], v[16:19]
    ds_read_b128 v[108:111], v6 offset:2112
    s_waitcnt lgkmcnt(8)
    v_mfma_f32_16x16x32_bf16 v[24:27], v[64:67], v[120:123], v[24:27]
    v_mfma_f32_16x16x32_bf16 v[16:19], v[96:99], v[120:123], v[16:19]
    ds_read_b128 v[112:115], v6 offset:2176
    s_waitcnt lgkmcnt(4)
    v_readfirstlane_b32 s9, v29
    v_mfma_f32_16x16x32_bf16 v[24:27], v[68:71], v[124:127], v[24:27]
    v_readfirstlane_b32 s8, v28
    s_add_u32 s9, s9, 2
    v_mfma_f32_16x16x32_bf16 v[16:19], v[100:103], v[124:127], v[16:19]
    ds_read_b128 v[116:119], v6 offset:2240
    s_min_u32 s8, s8, s9
    s_cmp_lt_u32 s8, 4
    s_cbranch_scc1 C_SLOW2
KEEP_P2:
    s_waitcnt lgkmcnt(4)
    v_mfma_f32_16x16x32_bf16 v[16:19], v[40:43], v[104:107], v[16:19]
    v_mfma_f32_16x16x32_bf16 v[20:23], v[72:75], v[104:107], 0
    ds_read_b128 v[120:123], v6 offset:2304
    s_waitcnt lgkmcnt(3)
    v_mfma_f32_16x16x32_bf16 v[16:19], v[44:47], v[108:111], v[16:19]
    v_mfma_f32_16x16x32_bf16 v[20:23], v[76:79], v[108:111], v[20:23]
    ds_read_b128 v[124:127], v6 offset:2368
    s_waitcnt lgkmcnt(3)
    v_mfma_f32_16x16x32_bf16 v[16:19], v[48:51], v[112:115], v[16:19]
    v_add_f32 v24, v24, v32
    v_add_f32 v25, v25, v33
    v_mfma_f32_16x16x32_bf16 v[20:23], v[80:83], v[112:115], v[20:23]
    ds_read_b128 v[104:107], v6 offset:2432
    v_add_f32 v26, v26, v34
    v_add_f32 v27, v27, v35
    s_waitcnt lgkmcnt(3)
    v_mfma_f32_16x16x32_bf16 v[16:19], v[52:55], v[116:119], v[16:19]
    v_cvt_pk_bf16_f32 v30, v27, v26
    v_cvt_pk_bf16_f32 v31, v25, v24
    v_mfma_f32_16x16x32_bf16 v[20:23], v[84:87], v[116:119], v[20:23]
    ds_read_b128 v[108:111], v6 offset:2496
    ds_write_b64 v7, v[30:31] offset:2560
    s_waitcnt lgkmcnt(4)
    v_mfma_f32_16x16x32_bf16 v[16:19], v[56:59], v[120:123], v[16:19]
    ds_read_b32 v28, v1 offset:80
    ds_read_b32 v29, v9 offset:32
    v_mfma_f32_16x16x32_bf16 v[20:23], v[88:91], v[120:123], v[20:23]
    ds_read_b128 v[112:115], v6 offset:1536
    s_waitcnt lgkmcnt(6)
    v_mfma_f32_16x16x32_bf16 v[16:19], v[60:63], v[124:127], v[16:19]
    ds_read_b128 v[32:35], v8 offset:1024
    v_mfma_f32_16x16x32_bf16 v[20:23], v[92:95], v[124:127], v[20:23]
    ds_read_b128 v[116:119], v6 offset:1600
    s_waitcnt lgkmcnt(7)
    v_mfma_f32_16x16x32_bf16 v[16:19], v[64:67], v[104:107], v[16:19]
    v_mfma_f32_16x16x32_bf16 v[20:23], v[96:99], v[104:107], v[20:23]
    ds_read_b128 v[120:123], v6 offset:1664
    s_waitcnt lgkmcnt(4)
    v_readfirstlane_b32 s9, v29
    v_mfma_f32_16x16x32_bf16 v[16:19], v[68:71], v[108:111], v[16:19]
    v_readfirstlane_b32 s8, v28
    s_add_u32 s9, s9, 2
    v_mfma_f32_16x16x32_bf16 v[20:23], v[100:103], v[108:111], v[20:23]
    ds_read_b128 v[124:127], v6 offset:1728
    s_min_u32 s8, s8, s9
    s_cmp_lt_u32 s8, 5
    s_cbranch_scc1 C_SLOW3
KEEP_P3:
    s_waitcnt lgkmcnt(4)
    v_mfma_f32_16x16x32_bf16 v[20:23], v[40:43], v[112:115], v[20:23]
    v_mfma_f32_16x16x32_bf16 v[24:27], v[72:75], v[112:115], 0
    ds_read_b128 v[104:107], v6 offset:1792
    s_waitcnt lgkmcnt(3)
    v_mfma_f32_16x16x32_bf16 v[20:23], v[44:47], v[116:119], v[20:23]
    v_mfma_f32_16x16x32_bf16 v[24:27], v[76:79], v[116:119], v[24:27]
    ds_read_b128 v[108:111], v6 offset:1856
    s_waitcnt lgkmcnt(3)
    v_mfma_f32_16x16x32_bf16 v[20:23], v[48:51], v[120:123], v[20:23]
    v_add_f32 v16, v16, v32
    v_add_f32 v17, v17, v33
    v_mfma_f32_16x16x32_bf16 v[24:27], v[80:83], v[120:123], v[24:27]
    ds_read_b128 v[112:115], v6 offset:1920
    v_add_f32 v18, v18, v34
    v_add_f32 v19, v19, v35
    s_waitcnt lgkmcnt(3)
    v_mfma_f32_16x16x32_bf16 v[20:23], v[52:55], v[124:127], v[20:23]
    v_cvt_pk_bf16_f32 v30, v19, v18
    v_cvt_pk_bf16_f32 v31, v17, v16
    v_mfma_f32_16x16x32_bf16 v[24:27], v[84:87], v[124:127], v[24:27]
    ds_read_b128 v[116:119], v6 offset:1984
    ds_write_b64 v7, v[30:31] offset:2048
    ds_add_u32 v13, v12 offset:4
    s_waitcnt lgkmcnt(5)
    v_mfma_f32_16x16x32_bf16 v[20:23], v[56:59], v[104:107], v[20:23]
    ds_read_b32 v28, v1 offset:80
    ds_read_b32 v29, v9 offset:32
    v_mfma_f32_16x16x32_bf16 v[24:27], v[88:91], v[104:107], v[24:27]
    ds_read_b128 v[120:123], v6 offset:1024
    s_waitcnt lgkmcnt(7)
    v_mfma_f32_16x16x32_bf16 v[20:23], v[60:63], v[108:111], v[20:23]
    ds_read_b128 v[32:35], v8 offset:2048
    v_mfma_f32_16x16x32_bf16 v[24:27], v[92:95], v[108:111], v[24:27]
    ds_read_b128 v[124:127], v6 offset:1088
    s_waitcnt lgkmcnt(8)
    v_mfma_f32_16x16x32_bf16 v[20:23], v[64:67], v[112:115], v[20:23]
    v_mfma_f32_16x16x32_bf16 v[24:27], v[96:99], v[112:115], v[24:27]
    ds_read_b128 v[104:107], v6 offset:1152
    s_waitcnt lgkmcnt(4)
    v_readfirstlane_b32 s9, v29
    v_mfma_f32_16x16x32_bf16 v[20:23], v[68:71], v[116:119], v[20:23]
    v_readfirstlane_b32 s8, v28
    s_add_u32 s9, s9, 2
    v_mfma_f32_16x16x32_bf16 v[24:27], v[100:103], v[116:119], v[24:27]
    ds_read_b128 v[108:111], v6 offset:1216
    s_min_u32 s8, s8, s9
    s_cmp_lt_u32 s8, 6
    s_cbranch_scc1 C_SLOW4
KEEP_P4:
    s_waitcnt lgkmcnt(4)
    v_mfma_f32_16x16x32_bf16 v[24:27], v[40:43], v[120:123], v[24:27]
    v_mfma_f32_16x16x32_bf16 v[16:19], v[72:75], v[120:123], 0
    ds_read_b128 v[112:115], v6 offset:1280
    s_waitcnt lgkmcnt(3)
    v_mfma_f32_16x16x32_bf16 v[24:27], v[44:47], v[124:127], v[24:27]
    v_mfma_f32_16x16x32_bf16 v[16:19], v[76:79], v[124:127], v[16:19]
    ds_read_b128 v[116:119], v6 offset:1344
    s_waitcnt lgkmcnt(3)
    v_mfma_f32_16x16x32_bf16 v[24:27], v[48:51], v[104:107], v[24:27]
    v_add_f32 v20, v20, v32
    v_add_f32 v21, v21, v33
    v_mfma_f32_16x16x32_bf16 v[16:19], v[80:83], v[104:107], v[16:19]
    ds_read_b128 v[120:123], v6 offset:1408
    v_add_f32 v22, v22, v34
    v_add_f32 v23, v23, v35
    s_waitcnt lgkmcnt(3)
    v_mfma_f32_16x16x32_bf16 v[24:27], v[52:55], v[108:111], v[24:27]
    v_cvt_pk_bf16_f32 v30, v23, v22
    v_cvt_pk_bf16_f32 v31, v21, v20
    v_mfma_f32_16x16x32_bf16 v[16:19], v[84:87], v[108:111], v[16:19]
    ds_read_b128 v[124:127], v6 offset:1472
    ds_write_b64 v7, v[30:31] offset:1536
    s_waitcnt lgkmcnt(4)
    v_mfma_f32_16x16x32_bf16 v[24:27], v[56:59], v[112:115], v[24:27]
    ds_read_b32 v28, v1 offset:80
    ds_read_b32 v29, v9 offset:32
    v_mfma_f32_16x16x32_bf16 v[16:19], v[88:91], v[112:115], v[16:19]
    ds_read_b128 v[104:107], v6 offset:512
    s_waitcnt lgkmcnt(6)
    v_mfma_f32_16x16x32_bf16 v[24:27], v[60:63], v[116:119], v[24:27]
    ds_read_b128 v[32:35], v8 offset:3072
    v_mfma_f32_16x16x32_bf16 v[16:19], v[92:95], v[116:119], v[16:19]
    ds_read_b128 v[108:111], v6 offset:576
    s_waitcnt lgkmcnt(7)
    v_mfma_f32_16x16x32_bf16 v[24:27], v[64:67], v[120:123], v[24:27]
    v_mfma_f32_16x16x32_bf16 v[16:19], v[96:99], v[120:123], v[16:19]
    ds_read_b128 v[112:115], v6 offset:640
    s_waitcnt lgkmcnt(4)
    v_readfirstlane_b32 s9, v29
    v_mfma_f32_16x16x32_bf16 v[24:27], v[68:71], v[124:127], v[24:27]
    v_readfirstlane_b32 s8, v28
    s_add_u32 s9, s9, 2
    v_mfma_f32_16x16x32_bf16 v[16:19], v[100:103], v[124:127], v[16:19]
    ds_read_b128 v[116:119], v6 offset:704
    s_min_u32 s8, s8, s9
    s_cmp_lt_u32 s8, 7
    s_cbranch_scc1 C_SLOW5
KEEP_P5:
    s_waitcnt lgkmcnt(4)
    v_mfma_f32_16x16x32_bf16 v[16:19], v[40:43], v[104:107], v[16:19]
    v_mfma_f32_16x16x32_bf16 v[20:23], v[72:75], v[104:107], 0
    ds_read_b128 v[120:123], v6 offset:768
    s_waitcnt lgkmcnt(3)
    v_mfma_f32_16x16x32_bf16 v[16:19], v[44:47], v[108:111], v[16:19]
    v_mfma_f32_16x16x32_bf16 v[20:23], v[76:79], v[108:111], v[20:23]
    ds_read_b128 v[124:127], v6 offset:832
    s_waitcnt lgkmcnt(3)
    v_mfma_f32_16x16x32_bf16 v[16:19], v[48:51], v[112:115], v[16:19]
    v_add_f32 v24, v24, v32
    v_add_f32 v25, v25, v33
    v_mfma_f32_16x16x32_bf16 v[20:23], v[80:83], v[112:115], v[20:23]
    ds_read_b128 v[104:107], v6 offset:896
    v_add_f32 v26, v26, v34
    v_add_f32 v27, v27, v35
    s_waitcnt lgkmcnt(3)
    v_mfma_f32_16x16x32_bf16 v[16:19], v[52:55], v[116:119], v[16:19]
    v_cvt_pk_bf16_f32 v30, v27, v26
    v_cvt_pk_bf16_f32 v31, v25, v24
    v_mfma_f32_16x16x32_bf16 v[20:23], v[84:87], v[116:119], v[20:23]
    ds_read_b128 v[108:111], v6 offset:960
    ds_write_b64 v7, v[30:31] offset:1024
    ds_add_u32 v13, v12 offset:8
    s_waitcnt lgkmcnt(5)
    v_mfma_f32_16x16x32_bf16 v[16:19], v[56:59], v[120:123], v[16:19]
    ds_read_b32 v28, v1 offset:80
    ds_read_b32 v29, v9 offset:32
    v_mfma_f32_16x16x32_bf16 v[20:23], v[88:91], v[120:123], v[20:23]
    ds_read_b128 v[112:115], v6 offset:0
    s_waitcnt lgkmcnt(7)
    v_mfma_f32_16x16x32_bf16 v[16:19], v[60:63], v[124:127], v[16:19]
    ds_read_b128 v[32:35], v8 offset:18432
    v_mfma_f32_16x16x32_bf16 v[20:23], v[92:95], v[124:127], v[20:23]
    ds_read_b128 v[116:119], v6 offset:64
    s_waitcnt lgkmcnt(8)
    v_mfma_f32_16x16x32_bf16 v[16:19], v[64:67], v[104:107], v[16:19]
    v_mfma_f32_16x16x32_bf16 v[20:23], v[96:99], v[104:107], v[20:23]
    ds_read_b128 v[120:123], v6 offset:128
    s_waitcnt lgkmcnt(4)
    v_readfirstlane_b32 s9, v29
    v_mfma_f32_16x16x32_bf16 v[16:19], v[68:71], v[108:111], v[16:19]
    v_readfirstlane_b32 s8, v28
    s_add_u32 s9, s9, 2
    v_mfma_f32_16x16x32_bf16 v[20:23], v[100:103], v[108:111], v[20:23]
    ds_read_b128 v[124:127], v6 offset:192
    s_min_u32 s8, s8, s9
    s_cmp_lt_u32 s8, 8
    s_cbranch_scc1 C_SLOW6
KEEP_P6:
    s_waitcnt lgkmcnt(4)
    v_mfma_f32_16x16x32_bf16 v[20:23], v[40:43], v[112:115], v[20:23]
    ds_read_b128 v[104:107], v6 offset:256
    s_waitcnt lgkmcnt(3)
    v_mfma_f32_16x16x32_bf16 v[20:23], v[44:47], v[116:119], v[20:23]
    ds_read_b128 v[108:111], v6 offset:320
    s_waitcnt lgkmcnt(3)
    v_mfma_f32_16x16x32_bf16 v[20:23], v[48:51], v[120:123], v[20:23]
    v_add_f32 v16, v16, v32
    v_add_f32 v17, v17, v33
    ds_read_b128 v[112:115], v6 offset:384
    v_add_f32 v18, v18, v34
    v_add_f32 v19, v19, v35
    s_waitcnt lgkmcnt(3)
    v_mfma_f32_16x16x32_bf16 v[20:23], v[52:55], v[124:127], v[20:23]
    v_cvt_pk_bf16_f32 v30, v19, v18
    v_cvt_pk_bf16_f32 v31, v17, v16
    ds_read_b128 v[116:119], v6 offset:448
    ds_write_b64 v7, v[30:31] offset:512
    ds_add_u32 v13, v12 offset:12
    s_waitcnt lgkmcnt(5)
    v_mfma_f32_16x16x32_bf16 v[20:23], v[56:59], v[104:107], v[20:23]
    ds_read_b32 v28, v1 offset:80
    ds_read_b32 v29, v9 offset:32
    s_waitcnt lgkmcnt(6)
    v_mfma_f32_16x16x32_bf16 v[20:23], v[60:63], v[108:111], v[20:23]
    ds_read_b128 v[32:35], v8 offset:19456
    s_waitcnt lgkmcnt(6)
    v_mfma_f32_16x16x32_bf16 v[20:23], v[64:67], v[112:115], v[20:23]
    s_waitcnt lgkmcnt(1)
    v_readfirstlane_b32 s9, v29
    v_mfma_f32_16x16x32_bf16 v[20:23], v[68:71], v[116:119], v[20:23]
    v_readfirstlane_b32 s8, v28
    s_add_u32 s9, s9, 2
    s_cmp_lt_u32 s9, 9
    s_cbranch_scc1 C_SLOW7
KEEP_P7:
    s_waitcnt lgkmcnt(0)
    s_nop 2
    v_add_f32 v20, v20, v32
    v_add_f32 v21, v21, v33
    v_add_f32 v22, v22, v34
    v_add_f32 v23, v23, v35
    v_cvt_pk_bf16_f32 v30, v23, v22
    v_cvt_pk_bf16_f32 v31, v21, v20
    ds_write_b64 v7, v[30:31] offset:0
    ds_add_u32 v13, v12 offset:16
    ds_read_b32 v10, v1 offset:8
    s_cmp_eq_u32 s3, 4
    s_cbranch_scc1 C_FIN
    s_endpgm
C_SLOW0:
    s_mov_b32 s9, 0
SP_24:
    ds_read_b32 v28, v1 offset:80
    s_waitcnt lgkmcnt(0)
    v_readfirstlane_b32 s8, v28
    s_add_u32 s9, s9, 1
    s_cmp_ge_u32 s8, 2
    s_cbranch_scc1 SP_24_D
    s_cmp_lt_u32 s9, 524288
    s_cbranch_scc1 SP_24
SP_24_D:
    ds_read_b128 v[112:115], v6 offset:3072
    ds_read_b128 v[116:119], v6 offset:3136
    ds_read_b128 v[120:123], v6 offset:3200
    ds_read_b128 v[124:127], v6 offset:3264
    s_waitcnt lgkmcnt(0)
    s_branch KEEP_P0
C_SLOW1:
    s_mov_b32 s9, 0
SP_25:
    ds_read_b32 v28, v1 offset:80
    s_waitcnt lgkmcnt(0)
    v_readfirstlane_b32 s8, v28
    s_add_u32 s9, s9, 1
    s_cmp_ge_u32 s8, 3
    s_cbranch_scc1 SP_25_D
    s_cmp_lt_u32 s9, 524288
    s_cbranch_scc1 SP_25
SP_25_D:
    ds_read_b128 v[120:123], v6 offset:2560
    ds_read_b128 v[124:127], v6 offset:2624
    ds_read_b128 v[104:107], v6 offset:2688
    ds_read_b128 v[108:111], v6 offset:2752
    s_waitcnt lgkmcnt(0)
    s_branch KEEP_P1
C_SLOW2:
    s_mov_b32 s9, 0
SP_26:
    ds_read_b32 v28, v1 offset:80
    s_waitcnt lgkmcnt(0)
    v_readfirstlane_b32 s8, v28
    s_add_u32 s9, s9, 1
    s_cmp_ge_u32 s8, 4
    s_cbranch_scc1 SP_26_D
    s_cmp_lt_u32 s9, 524288
    s_cbranch_scc1 SP_26
SP_26_D:
    s_mov_b32 s9, 0
SP_27:
    ds_read_b32 v28, v9 offset:32
    s_waitcnt lgkmcnt(0)
    v_readfirstlane_b32 s8, v28
    s_add_u32 s9, s9, 1
    s_cmp_ge_u32 s8, 2
    s_cbranch_scc1 SP_27_D
    s_cmp_lt_u32 s9, 524288
    s_cbranch_scc1 SP_27
SP_27_D:
    ds_read_b128 v[32:35], v8 offset:0
    ds_read_b128 v[104:107], v6 offset:2048
    ds_read_b128 v[108:111], v6 offset:2112
    ds_read_b128 v[112:115], v6 offset:2176
    ds_read_b128 v[116:119], v6 offset:2240
    s_waitcnt lgkmcnt(0)
    s_branch KEEP_P2
C_SLOW3:
    s_mov_b32 s9, 0
SP_28:
    ds_read_b32 v28, v1 offset:80
    s_waitcnt lgkmcnt(0)
    v_readfirstlane_b32 s8, v28
    s_add_u32 s9, s9, 1
    s_cmp_ge_u32 s8, 5
    s_cbranch_scc1 SP_28_D
    s_cmp_lt_u32 s9, 524288
    s_cbranch_scc1 SP_28
SP_28_D:
    s_mov_b32 s9, 0
SP_29:
    ds_read_b32 v28, v9 offset:32
    s_waitcnt lgkmcnt(0)
    v_readfirstlane_b32 s8, v28
    s_add_u32 s9, s9, 1
    s_cmp_ge_u32 s8, 3
    s_cbranch_scc1 SP_29_D
    s_cmp_lt_u32 s9, 524288
    s_cbranch_scc1 SP_29
SP_29_D:
    ds_read_b128 v[32:35], v8 offset:1024
    ds_read_b128 v[112:115], v6 offset:1536
    ds_read_b128 v[116:119], v6 offset:1600
    ds_read_b128 v[120:123], v6 offset:1664
    ds_read_b128 v[124:127], v6 offset:1728
    s_waitcnt lgkmcnt(0)
    s_branch KEEP_P3
C_SLOW4:
    s_mov_b32 s9, 0
SP_30:
    ds_read_b32 v28, v1 offset:80
    s_waitcnt lgkmcnt(0)
    v_readfirstlane_b32 s8, v28
    s_add_u32 s9, s9, 1
    s_cmp_ge_u32 s8, 6
    s_cbranch_scc1 SP_30_D
    s_cmp_lt_u32 s9, 524288
    s_cbranch_scc1 SP_30
SP_30_D:
    s_mov_b32 s9, 0
SP_31:
    ds_read_b32 v28, v9 offset:32
    s_waitcnt lgkmcnt(0)
    v_readfirstlane_b32 s8, v28
    s_add_u32 s9, s9, 1
    s_cmp_ge_u32 s8, 4
    s_cbranch_scc1 SP_31_D
    s_cmp_lt_u32 s9, 524288
    s_cbranch_scc1 SP_31
SP_31_D:
    ds_read_b128 v[32:35], v8 offset:2048
    ds_read_b128 v[120:123], v6 offset:1024
    ds_read_b128 v[124:127], v6 offset:1088
    ds_read_b128 v[104:107], v6 offset:1152
    ds_read_b128 v[108:111], v6 offset:1216
    s_waitcnt lgkmcnt(0)
    s_branch KEEP_P4
C_SLOW5:
    s_mov_b32 s9, 0
SP_32:
    ds_read_b32 v28, v1 offset:80
    s_waitcnt lgkmcnt(0)
    v_readfirstlane_b32 s8, v28
    s_add_u32 s9, s9, 1
    s_cmp_ge_u32 s8, 7
    s_cbranch_scc1 SP_32_D
    s_cmp_lt_u32 s9, 524288
    s_cbranch_scc1 SP_32
SP_32_D:
    s_mov_b32 s9, 0
SP_33:
    ds_read_b32 v28, v9 offset:32
    s_waitcnt lgkmcnt(0)
    v_readfirstlane_b32 s8, v28
    s_add_u32 s9, s9, 1
    s_cmp_ge_u32 s8, 5
    s_cbranch_scc1 SP_33_D
    s_cmp_lt_u32 s9, 524288
    s_cbranch_scc1 SP_33
SP_33_D:
    ds_read_b128 v[32:35], v8 offset:3072
    ds_read_b128 v[104:107], v6 offset:512
    ds_read_b128 v[108:111], v6 offset:576
    ds_read_b128 v[112:115], v6 offset:640
    ds_read_b128 v[116:119], v6 offset:704
    s_waitcnt lgkmcnt(0)
    s_branch KEEP_P5
C_SLOW6:
    s_mov_b32 s9, 0
SP_34:
    ds_read_b32 v28, v1 offset:80
    s_waitcnt lgkmcnt(0)
    v_readfirstlane_b32 s8, v28
    s_add_u32 s9, s9, 1
    s_cmp_ge_u32 s8, 8
    s_cbranch_scc1 SP_34_D
    s_cmp_lt_u32 s9, 524288
    s_cbranch_scc1 SP_34
SP_34_D:
    s_mov_b32 s9, 0
SP_35:
    ds_read_b32 v28, v9 offset:32
    s_waitcnt lgkmcnt(0)
    v_readfirstlane_b32 s8, v28
    s_add_u32 s9, s9, 1
    s_cmp_ge_u32 s8, 6
    s_cbranch_scc1 SP_35_D
    s_cmp_lt_u32 s9, 524288
    s_cbranch_scc1 SP_35
SP_35_D:
    ds_read_b128 v[32:35], v8 offset:18432
    ds_read_b128 v[112:115], v6 offset:0
    ds_read_b128 v[116:119], v6 offset:64
    ds_read_b128 v[120:123], v6 offset:128
    ds_read_b128 v[124:127], v6 offset:192
    s_waitcnt lgkmcnt(0)
    s_branch KEEP_P6
C_SLOW7:
    s_mov_b32 s9, 0
SP_36:
    ds_read_b32 v28, v9 offset:32
    s_waitcnt lgkmcnt(0)
    v_readfirstlane_b32 s8, v28
    s_add_u32 s9, s9, 1
    s_cmp_ge_u32 s8, 7
    s_cbranch_scc1 SP_36_D
    s_cmp_lt_u32 s9, 524288
    s_cbranch_scc1 SP_36
SP_36_D:
    ds_read_b128 v[32:35], v8 offset:19456
    s_waitcnt lgkmcnt(0)
    s_branch KEEP_P7
C_KA:
    s_setprio 1
    v_and_b32 v14, 3, v3
    v_sub_u32 v14, 3, v14
    v_mul_u32_u24 v14, 1216, v14
    v_lshrrev_b32 v13, 2, v3
    v_lshl_add_u32 v13, v4, 1, v13
    v_lshl_add_u32 v14, v13, 3, v14
    v_add3_u32 v5, v14, s52, 8
    v_lshlrev_b32 v14, 1, v3
    v_sub_u32 v14, v4, v14
    v_lshlrev_b32 v14, 4, v14
    s_add_u32 s8, s53, 480
    v_add_u32 v6, s8, v14
    v_lshl_add_u32 v14, v3, 2, v4
    s_mul_i32 s8, s12, 4160
    s_add_u32 s8, s8, 83960
    v_lshlrev_b32 v14, 3, v14
    v_sub_u32 v7, s8, v14
    v_lshrrev_b32 v11, 1, v4
    v_and_b32 v12, 1, v4
    v_lshlrev_b32 v11, 8, v11
    v_lshl_add_u32 v11, v12, 3, v11
    v_lshl_add_u32 v11, v3, 4, v11
    v_add_u32 v11, s15, v11
    v_cmp_gt_u32 vcc, 2, v4
    v_lshlrev_b32 v12, 2, v3
    v_lshlrev_b32 v13, 3, v3
    v_cndmask_b32 v12, v12, v13, vcc
    v_lshl_add_u32 v12, v4, 7, v12
    v_add_u32 v12, s15, v12
    v_mov_b32 v13, 64
    v_cndmask_b32 v13, v13, 4, vcc
    v_add_u32 v13, v13, v12
    v_lshlrev_b32 v14, 1, v3
    v_lshl_add_u32 v14, v4, 7, v14
    v_add_u32 v14, s15, v14
    v_lshlrev_b32 v15, 4, v2
    v_lshlrev_b32 v16, 3, v2
    v_add_u32 v16, 256, v16
    v_min_u32 v15, v15, v16
    v_add_u32 v15, s15, v15
    v_min_u32 v16, 15, v2
    v_lshl_add_u32 v16, v16, 2, s15
    v_lshrrev_b32 v26, 5, v2
    v_lshlrev_b32 v26, 8, v26
    v_lshl_add_u32 v26, v2, 2, v26
    v_add_u32 v26, s15, v26
    v_lshlrev_b32 v17, 2, v4
    v_sub_u32 v17, v3, v17
    v_lshl_add_u32 v27, v17, 3, s15
    v_add_u32 v27, 3176, v27
    v_lshl_add_u32 v17, v17, 2, s15
    v_add_u32 v17, 2100, v17
    v_lshl_add_u32 v19, v2, 4, s52
    s_mov_b32 s56, 0x01000100
    s_mov_b32 s57, 0x03020302
    s_lshl_b32 s8, s12, 4
    s_lshr_b64 s[68:69], s[68:69], s8
    s_lshl_b32 s68, s68, 16
    s_sub_u32 s58, 254, s54
    s_lshl_b32 s58, s58, 23
    v_mul_f32 v104, s58, v104
    v_mul_f32 v105, s58, v105
    v_mul_f32 v106, s58, v106
    v_mul_f32 v107, s58, v107
    v_mul_f32 v108, s58, v108
    v_mul_f32 v109, s58, v109
    v_mul_f32 v110, s58, v110
    v_mul_f32 v111, s58, v111
    v_mul_f32 v112, s58, v112
    v_mul_f32 v113, s58, v113
    v_mul_f32 v114, s58, v114
    v_mul_f32 v115, s58, v115
    s_mov_b64 exec, 1
    v_add_f32 v104, s68, v104
    s_mov_b64 exec, -1
    v_mov_b32 v75, 0
    v_mov_b32 v79, 0
    v_mov_b32 v82, 0
    v_mov_b32 v83, 0
    v_mov_b32 v86, 0
    v_mov_b32 v87, 0
    v_lshlrev_b32 v28, 4, v2
    v_add_u32 v28, 100096, v28
    s_mov_b32 s9, 0
SP_37:
    ds_read_b32 v18, v1 offset:32
    s_waitcnt lgkmcnt(0)
    v_readfirstlane_b32 s8, v18
    s_add_u32 s9, s9, 1
    s_cmp_ge_u32 s8, 2
    s_cbranch_scc1 SP_37_D
    s_cmp_lt_u32 s9, 524288
    s_cbranch_scc1 SP_37
SP_37_D:
    ds_read_b128 v[116:119], v28 offset:2048
    ds_read_b128 v[120:123], v28 offset:3072
    ds_read_b128 v[124:127], v28 offset:4096
    s_setprio 0
    s_mov_b32 s9, 0
SP_38:
    ds_read_b32 v18, v9
    s_waitcnt lgkmcnt(0)
    v_readfirstlane_b32 s8, v18
    s_add_u32 s9, s9, 1
    s_cmp_lg_u32 s8, 0
    s_cbranch_scc1 SP_38_D
    s_cmp_lt_u32 s9, 524288
    s_cbranch_scc1 SP_38
SP_38_D:
    s_setprio 2
    s_sub_u32 s60, 254, s8
    s_lshl_b32 s60, s60, 23
    ds_read_b128 v[88:91], v8 offset:18432
    ds_read_b128 v[92:95], v8 offset:19456
    ds_read_b128 v[96:99], v8 offset:20480
    s_waitcnt lgkmcnt(2)
    v_pk_fma_f32 v[104:105], v[88:89], s[60:61], v[104:105] op_sel_hi:[1,0,1]
    v_cvt_pk_bf16_f32 v20, v104, v105
    v_pk_fma_f32 v[106:107], v[90:91], s[60:61], v[106:107] op_sel_hi:[1,0,1]
    v_cvt_pk_bf16_f32 v21, v106, v107
    ds_write_b64 v11, v[20:21]
    s_waitcnt lgkmcnt(2)
    v_pk_fma_f32 v[108:109], v[92:93], s[60:61], v[108:109] op_sel_hi:[1,0,1]
    v_cvt_pk_bf16_f32 v22, v108, v109
    v_pk_fma_f32 v[110:111], v[94:95], s[60:61], v[110:111] op_sel_hi:[1,0,1]
    v_cvt_pk_bf16_f32 v23, v110, v111
    ds_write_b32 v12, v22 offset:512
    ds_write_b32 v13, v23 offset:512
    ds_read_b64 v[32:33], v15 offset:0
    ds_read_b64 v[34:35], v15 offset:8
    s_waitcnt lgkmcnt(5)
    v_pk_fma_f32 v[112:113], v[96:97], s[60:61], v[112:113] op_sel_hi:[1,0,1]
    v_cvt_pk_bf16_f32 v24, v112, v113
    v_pk_fma_f32 v[114:115], v[98:99], s[60:61], v[114:115] op_sel_hi:[1,0,1]
    v_cvt_pk_bf16_f32 v25, v114, v115
    s_mov_b32 exec_lo, 0
    s_waitcnt lgkmcnt(0)
    v_alignbit_b32 v35, v34, v33, 16
    v_perm_b32 v34, v33, v33, s56
    v_alignbit_b32 v33, v33, v32, 16
    v_perm_b32 v32, v32, v32, s56
    s_mov_b32 exec_lo, -1
    ds_write_b128 v19, v[32:35] offset:32
    v_mov_b32_dpp v30, v34 wave_shr:1 row_mask:0xf bank_mask:0xf bound_ctrl:0
    v_mov_b32_dpp v31, v35 wave_shr:1 row_mask:0xf bank_mask:0xf bound_ctrl:0
    v_alignbit_b32 v44, v32, v31, 16
    v_alignbit_b32 v45, v33, v32, 16
    v_alignbit_b32 v46, v34, v33, 16
    v_alignbit_b32 v47, v35, v34, 16
    ds_write_b128 v19, v[44:47] offset:1248
    v_mov_b32 v52, v31
    v_mov_b32 v53, v32
    v_mov_b32 v54, v33
    v_mov_b32 v55, v34
    ds_write_b128 v19, v[52:55] offset:2464
    v_alignbit_b32 v60, v31, v30, 16
    v_alignbit_b32 v61, v32, v31, 16
    v_alignbit_b32 v62, v33, v32, 16
    v_alignbit_b32 v63, v34, v33, 16
    ds_write_b128 v19, v[60:63] offset:3680
    v_mov_b32 v10, 1
    ds_write_b32 v9, v10 offset:48
    s_setprio 3
    v_perm_b32 v73, v35, v35, s57
    v_alignbit_b32 v72, v35, v34, 16
    v_lshrrev_b32 v78, 16, v35
    v_mov_b32 v76, v35
    v_mov_b32 v74, v73
    v_mov_b32 v77, v73
    v_mov_b32 v80, v73
    v_mov_b32 v81, v73
    v_mov_b32 v84, v73
    v_mov_b32 v85, v78
    s_mov_b32 exec_lo, 0
    ds_write_b16 v12, v22 offset:2942
    ds_write_b16_d16_hi v12, v22 offset:2944
    ds_write_b16 v13, v23 offset:2942
    ds_write_b16_d16_hi v13, v23 offset:2944
    s_mov_b32 exec_hi, 0x80000000
    ds_write_b128 v19, v[84:87] offset:48
    ds_write_b128 v19, v[80:83] offset:1264
    ds_write_b128 v19, v[76:79] offset:2480
    ds_write_b128 v19, v[72:75] offset:3696
    s_mov_b64 exec, 1
    ds_write_b16 v14, v24 offset:3454
    s_mov_b64 exec, -1
    ds_write_b32 v26, v1 offset:3072
    ds_write_b16 v14, v24 offset:2110
    ds_write_b16_d16_hi v14, v24 offset:2142
    ds_write_b16 v14, v25 offset:2174
    ds_write_b16_d16_hi v14, v25 offset:2206
    ds_write_b32 v16, v1 offset:2048
    v_readlane_b32 s59, v24, 0
    v_mov_b32 v11, v27
    v_mov_b32 v12, v17
    v_mov_b32 v13, v28
    s_pack_ll_b32_b16 s59, s59, s59
    s_mov_b32 s9, 0
SP_39:
    ds_read_b32 v10, v1 offset:80
    s_waitcnt lgkmcnt(0)
    v_readfirstlane_b32 s8, v10
    s_add_u32 s9, s9, 1
    s_cmp_ge_u32 s8, 2
    s_cbranch_scc1 SP_39_D
    s_sleep 1
    s_cmp_lt_u32 s9, 524288
    s_cbranch_scc1 SP_39
SP_39_D:
    s_setprio 1
    ds_read_b128 v[40:43], v6 offset:3584
    ds_read_b128 v[44:47], v6 offset:3600
    ds_read_b128 v[48:51], v6 offset:3072
    ds_read_b128 v[52:55], v6 offset:3088
    ds_read_b64 v[112:113], v5 offset:1024
    ds_read_b64 v[114:115], v5 offset:1032
    ds_read2_b32 v[128:129], v11 offset0:6 offset1:4
    ds_read2_b32 v[130:131], v11 offset0:2 offset1:0
    ds_read2_b32 v[132:133], v11 offset0:7 offset1:5
    ds_read2_b32 v[134:135], v11 offset0:3 offset1:1
    v_and_b32 v124, s59, v124
    v_and_b32 v125, s59, v125
    v_and_b32 v126, s59, v126
    v_and_b32 v127, s59, v127
    s_waitcnt lgkmcnt(9)
    v_mfma_f32_16x16x32_bf16 v[56:59], v[40:43], v[116:119], 0
    ds_read2_b32 v[136:137], v11 offset0:38 offset1:36
    v_mfma_f32_16x16x32_bf16 v[60:63], v[40:43], v[120:123], 0
    ds_read2_b32 v[138:139], v11 offset0:34 offset1:32
    s_waitcnt lgkmcnt(10)
    v_mfma_f32_16x16x32_bf16 v[64:67], v[44:47], v[116:119], 0
    ds_read2_b32 v[140:141], v11 offset0:39 offset1:37
    v_mfma_f32_16x16x32_bf16 v[68:71], v[44:47], v[120:123], 0
    ds_read2_b32 v[142:143], v11 offset0:35 offset1:33
    s_waitcnt lgkmcnt(8)
    v_mfma_f32_16x16x32_bf16 v[16:19], v[112:115], v[40:43], 0
    ds_read_b128 v[104:107], v13
    ds_read_b128 v[108:111], v13 offset:1024
    v_mfma_f32_16x16x32_bf16 v[80:83], v[48:51], v[116:119], 0
    v_cvt_pk_bf16_f32 v56, v56, v60
    v_cvt_pk_bf16_f32 v57, v57, v61
    v_mfma_f32_16x16x32_bf16 v[84:87], v[48:51], v[120:123], 0
    v_cvt_pk_bf16_f32 v58, v58, v62
    v_cvt_pk_bf16_f32 v59, v59, v63
    v_mfma_f32_16x16x32_bf16 v[88:91], v[52:55], v[116:119], 0
    v_cvt_pk_bf16_f32 v64, v64, v68
    v_cvt_pk_bf16_f32 v65, v65, v69
    v_mfma_f32_16x16x32_bf16 v[92:95], v[52:55], v[120:123], 0
    v_cvt_pk_bf16_f32 v66, v66, v70
    v_cvt_pk_bf16_f32 v67, v67, v71
    v_mfma_f32_16x16x32_bf16 v[20:23], v[112:115], v[48:51], 0
    s_waitcnt lgkmcnt(8)
    v_mfma_f32_16x16x32_bf16 v[16:19], v[56:59], v[128:131], v[16:19]
    v_cvt_pk_bf16_f32 v80, v80, v84
    v_cvt_pk_bf16_f32 v81, v81, v85
    s_waitcnt lgkmcnt(6)
    v_mfma_f32_16x16x32_bf16 v[16:19], v[64:67], v[132:135], v[16:19]
    v_cvt_pk_bf16_f32 v82, v82, v86
    v_cvt_pk_bf16_f32 v83, v83, v87
    s_waitcnt lgkmcnt(4)
    v_mfma_f32_16x16x32_bf16 v[20:23], v[56:59], v[136:139], v[20:23]
    v_cvt_pk_bf16_f32 v88, v88, v92
    v_cvt_pk_bf16_f32 v89, v89, v93
    s_waitcnt lgkmcnt(2)
    v_mfma_f32_16x16x32_bf16 v[20:23], v[64:67], v[140:143], v[20:23]
    v_cvt_pk_bf16_f32 v90, v90, v94
    v_cvt_pk_bf16_f32 v91, v91, v95
    v_mfma_f32_16x16x32_bf16 v[20:23], v[80:83], v[128:131], v[20:23]
    ds_read2_b32 v[144:145], v11 offset0:70 offset1:68
    ds_read2_b32 v[146:147], v11 offset0:66 offset1:64
    v_mfma_f32_16x16x32_bf16 v[20:23], v[88:91], v[132:135], v[20:23]
    ds_read2_b32 v[148:149], v11 offset0:71 offset1:69
    ds_read2_b32 v[150:151], v11 offset0:67 offset1:65
    s_waitcnt lgkmcnt(5)
    v_mfma_f32_16x16x32_bf16 v[72:75], v[40:43], v[104:107], 0
    ds_write_b128 v8, v[16:19] offset:0
    v_mov_b32 v10, 2
    s_waitcnt lgkmcnt(5)
    v_mfma_f32_16x16x32_bf16 v[76:79], v[44:47], v[108:111], 0
    ds_write_b32 v9, v10 offset:32
    ds_read2_b32 v[152:153], v12 offset0:3 offset1:2
    v_mfma_f32_16x16x32_bf16 v[24:27], v[124:127], v[40:43], 0
    ds_read2_b32 v[154:155], v12 offset0:1 offset1:0
    ds_read2_b32 v[156:157], v12 offset0:19 offset1:18
    v_mfma_f32_16x16x32_bf16 v[96:99], v[48:51], v[104:107], 0
    ds_read2_b32 v[158:159], v12 offset0:17 offset1:16
    ds_read2_b32 v[160:161], v12 offset0:35 offset1:34
    v_mfma_f32_16x16x32_bf16 v[100:103], v[52:55], v[108:111], 0
    ds_read2_b32 v[162:163], v12 offset0:33 offset1:32
    ds_read2_b32 v[164:165], v12 offset0:51 offset1:50
    v_mfma_f32_16x16x32_bf16 v[28:31], v[124:127], v[48:51], 0
    ds_read2_b32 v[166:167], v12 offset0:49 offset1:48
    ds_write_b128 v8, v[20:23] offset:1024
    v_mov_b32 v10, 3
    ds_write_b32 v9, v10 offset:32
    s_mov_b32 s9, 0
SP_40:
    ds_read_b32 v10, v1 offset:80
    s_waitcnt lgkmcnt(0)
    v_readfirstlane_b32 s8, v10
    s_add_u32 s9, s9, 1
    s_cmp_ge_u32 s8, 4
    s_cbranch_scc1 SP_40_D
    s_sleep 1
    s_cmp_lt_u32 s9, 524288
    s_cbranch_scc1 SP_40
SP_40_D:
    ds_read_b128 v[40:43], v6 offset:2560
    ds_read_b128 v[44:47], v6 offset:2576
    ds_read_b128 v[48:51], v6 offset:2048
    ds_read_b128 v[52:55], v6 offset:2064
    v_mfma_f32_16x16x32_bf16 v[24:27], v[56:59], v[144:147], v[24:27]
    v_cvt_pk_bf16_f32 v72, v72, v76
    v_cvt_pk_bf16_f32 v73, v73, v77
    v_mfma_f32_16x16x32_bf16 v[24:27], v[64:67], v[148:151], v[24:27]
    v_cvt_pk_bf16_f32 v74, v74, v78
    v_cvt_pk_bf16_f32 v75, v75, v79
    v_mfma_f32_16x16x32_bf16 v[24:27], v[80:83], v[136:139], v[24:27]
    v_cvt_pk_bf16_f32 v96, v96, v100
    v_cvt_pk_bf16_f32 v97, v97, v101
    v_mfma_f32_16x16x32_bf16 v[24:27], v[88:91], v[140:143], v[24:27]
    v_cvt_pk_bf16_f32 v98, v98, v102
    v_cvt_pk_bf16_f32 v99, v99, v103
    v_mfma_f32_16x16x32_bf16 v[28:31], v[80:83], v[144:147], v[28:31]
    v_mfma_f32_16x16x32_bf16 v[28:31], v[88:91], v[148:151], v[28:31]
    s_waitcnt lgkmcnt(3)
    v_mfma_f32_16x16x32_bf16 v[56:59], v[40:43], v[116:119], 0
    v_mfma_f32_16x16x32_bf16 v[60:63], v[40:43], v[120:123], 0
    s_waitcnt lgkmcnt(2)
    v_mfma_f32_16x16x32_bf16 v[64:67], v[44:47], v[116:119], 0
    v_mfma_f32_16x16x32_bf16 v[68:71], v[44:47], v[120:123], 0
    v_mfma_f32_16x16x32_bf16 v[24:27], v[112:115], v[40:43], v[24:27]
    v_mfma_f32_16x16x32_bf16 v[24:27], v[72:75], v[152:155], v[24:27]
    v_mfma_f32_16x16x32_bf16 v[28:31], v[72:75], v[156:159], v[28:31]
    v_mfma_f32_16x16x32_bf16 v[32:35], v[72:75], v[160:163], 0
    v_mfma_f32_16x16x32_bf16 v[36:39], v[72:75], v[164:167], 0
    v_mfma_f32_16x16x32_bf16 v[28:31], v[96:99], v[152:155], v[28:31]
    v_mfma_f32_16x16x32_bf16 v[32:35], v[96:99], v[156:159], v[32:35]
    v_mfma_f32_16x16x32_bf16 v[36:39], v[96:99], v[160:163], v[36:39]
    s_waitcnt lgkmcnt(1)
    v_mfma_f32_16x16x32_bf16 v[80:83], v[48:51], v[116:119], 0
    v_cvt_pk_bf16_f32 v56, v56, v60
    v_cvt_pk_bf16_f32 v57, v57, v61
    v_mfma_f32_16x16x32_bf16 v[84:87], v[48:51], v[120:123], 0
    v_cvt_pk_bf16_f32 v58, v58, v62
    v_cvt_pk_bf16_f32 v59, v59, v63
    s_waitcnt lgkmcnt(0)
    v_mfma_f32_16x16x32_bf16 v[88:91], v[52:55], v[116:119], 0
    v_cvt_pk_bf16_f32 v64, v64, v68
    v_cvt_pk_bf16_f32 v65, v65, v69
    v_mfma_f32_16x16x32_bf16 v[92:95], v[52:55], v[120:123], 0
    v_cvt_pk_bf16_f32 v66, v66, v70
    v_cvt_pk_bf16_f32 v67, v67, v71
    v_mfma_f32_16x16x32_bf16 v[28:31], v[112:115], v[48:51], v[28:31]
    v_mfma_f32_16x16x32_bf16 v[72:75], v[40:43], v[104:107], 0
    v_mfma_f32_16x16x32_bf16 v[76:79], v[44:47], v[108:111], 0
    v_mfma_f32_16x16x32_bf16 v[32:35], v[124:127], v[40:43], v[32:35]
    v_mfma_f32_16x16x32_bf16 v[24:27], v[56:59], v[128:131], v[24:27]
    v_cvt_pk_bf16_f32 v80, v80, v84
    v_cvt_pk_bf16_f32 v81, v81, v85
    v_mfma_f32_16x16x32_bf16 v[24:27], v[64:67], v[132:135], v[24:27]
    v_cvt_pk_bf16_f32 v82, v82, v86
    v_cvt_pk_bf16_f32 v83, v83, v87
    v_mfma_f32_16x16x32_bf16 v[28:31], v[56:59], v[136:139], v[28:31]
    v_cvt_pk_bf16_f32 v88, v88, v92
    v_cvt_pk_bf16_f32 v89, v89, v93
    v_mfma_f32_16x16x32_bf16 v[28:31], v[64:67], v[140:143], v[28:31]
    v_cvt_pk_bf16_f32 v90, v90, v94
    v_cvt_pk_bf16_f32 v91, v91, v95
    v_mfma_f32_16x16x32_bf16 v[32:35], v[56:59], v[144:147], v[32:35]
    v_cvt_pk_bf16_f32 v72, v72, v76
    v_cvt_pk_bf16_f32 v73, v73, v77
    v_mfma_f32_16x16x32_bf16 v[32:35], v[64:67], v[148:151], v[32:35]
    v_cvt_pk_bf16_f32 v74, v74, v78
    v_cvt_pk_bf16_f32 v75, v75, v79
    v_mfma_f32_16x16x32_bf16 v[96:99], v[48:51], v[104:107], 0
    ds_write_b128 v8, v[24:27] offset:2048
    v_mov_b32 v10, 4
    v_mfma_f32_16x16x32_bf16 v[100:103], v[52:55], v[108:111], 0
    ds_write_b32 v9, v10 offset:32
    v_mfma_f32_16x16x32_bf16 v[36:39], v[124:127], v[48:51], v[36:39]
    v_mfma_f32_16x16x32_bf16 v[28:31], v[80:83], v[128:131], v[28:31]
    s_nop 4
    v_cvt_pk_bf16_f32 v96, v96, v100
    v_cvt_pk_bf16_f32 v97, v97, v101
    v_mfma_f32_16x16x32_bf16 v[28:31], v[88:91], v[132:135], v[28:31]
    v_cvt_pk_bf16_f32 v98, v98, v102
    v_cvt_pk_bf16_f32 v99, v99, v103
    v_mfma_f32_16x16x32_bf16 v[32:35], v[80:83], v[136:139], v[32:35]
    s_nop 0
    s_nop 0
    v_mfma_f32_16x16x32_bf16 v[32:35], v[88:91], v[140:143], v[32:35]
    s_nop 0
    s_nop 0
    v_mfma_f32_16x16x32_bf16 v[36:39], v[80:83], v[144:147], v[36:39]
    ds_write_b128 v8, v[28:31] offset:3072
    v_mov_b32 v10, 5
    v_mfma_f32_16x16x32_bf16 v[36:39], v[88:91], v[148:151], v[36:39]
    ds_write_b32 v9, v10 offset:32
    v_mfma_f32_16x16x32_bf16 v[32:35], v[72:75], v[152:155], v[32:35]
    v_mfma_f32_16x16x32_bf16 v[36:39], v[72:75], v[156:159], v[36:39]
    v_mfma_f32_16x16x32_bf16 v[36:39], v[96:99], v[152:155], v[36:39]
    s_mov_b32 s9, 0
SP_41:
    ds_read_b32 v10, v1 offset:80
    s_waitcnt lgkmcnt(0)
    v_readfirstlane_b32 s8, v10
    s_add_u32 s9, s9, 1
    s_cmp_ge_u32 s8, 6
    s_cbranch_scc1 SP_41_D
    s_sleep 1
    s_cmp_lt_u32 s9, 524288
    s_cbranch_scc1 SP_41
SP_41_D:
    ds_read_b128 v[40:43], v6 offset:1536
    ds_read_b128 v[44:47], v6 offset:1552
    ds_read_b128 v[48:51], v6 offset:1024
    ds_read_b128 v[52:55], v6 offset:1040
    s_waitcnt lgkmcnt(3)
    v_mfma_f32_16x16x32_bf16 v[56:59], v[40:43], v[116:119], 0
    v_mfma_f32_16x16x32_bf16 v[60:63], v[40:43], v[120:123], 0
    s_waitcnt lgkmcnt(2)
    v_mfma_f32_16x16x32_bf16 v[64:67], v[44:47], v[116:119], 0
    v_mfma_f32_16x16x32_bf16 v[68:71], v[44:47], v[120:123], 0
    v_mfma_f32_16x16x32_bf16 v[32:35], v[112:115], v[40:43], v[32:35]
    s_waitcnt lgkmcnt(1)
    v_mfma_f32_16x16x32_bf16 v[80:83], v[48:51], v[116:119], 0
    s_nop 1
    v_cvt_pk_bf16_f32 v56, v56, v60
    v_cvt_pk_bf16_f32 v57, v57, v61
    v_mfma_f32_16x16x32_bf16 v[84:87], v[48:51], v[120:123], 0
    v_cvt_pk_bf16_f32 v58, v58, v62
    v_cvt_pk_bf16_f32 v59, v59, v63
    s_waitcnt lgkmcnt(0)
    v_mfma_f32_16x16x32_bf16 v[88:91], v[52:55], v[116:119], 0
    v_cvt_pk_bf16_f32 v64, v64, v68
    v_cvt_pk_bf16_f32 v65, v65, v69
    v_mfma_f32_16x16x32_bf16 v[92:95], v[52:55], v[120:123], 0
    v_cvt_pk_bf16_f32 v66, v66, v70
    v_cvt_pk_bf16_f32 v67, v67, v71
    v_mfma_f32_16x16x32_bf16 v[36:39], v[112:115], v[48:51], v[36:39]
    v_mfma_f32_16x16x32_bf16 v[32:35], v[56:59], v[128:131], v[32:35]
    v_cvt_pk_bf16_f32 v80, v80, v84
    v_cvt_pk_bf16_f32 v81, v81, v85
    v_mfma_f32_16x16x32_bf16 v[32:35], v[64:67], v[132:135], v[32:35]
    v_cvt_pk_bf16_f32 v82, v82, v86
    v_cvt_pk_bf16_f32 v83, v83, v87
    v_mfma_f32_16x16x32_bf16 v[36:39], v[56:59], v[136:139], v[36:39]
    v_cvt_pk_bf16_f32 v88, v88, v92
    v_cvt_pk_bf16_f32 v89, v89, v93
    v_mfma_f32_16x16x32_bf16 v[36:39], v[64:67], v[140:143], v[36:39]
    v_cvt_pk_bf16_f32 v90, v90, v94
    v_cvt_pk_bf16_f32 v91, v91, v95
    v_mfma_f32_16x16x32_bf16 v[36:39], v[80:83], v[128:131], v[36:39]
    s_nop 0
    v_mfma_f32_16x16x32_bf16 v[36:39], v[88:91], v[132:135], v[36:39]
    ds_write_b128 v8, v[32:35] offset:18432
    v_mov_b32 v10, 6
    ds_write_b32 v9, v10 offset:32
    s_nop 4
    ds_write_b128 v8, v[36:39] offset:19456
    v_mov_b32 v10, 7
    ds_write_b32 v9, v10 offset:32
    s_endpgm
SELECT:
    s_setprio 3
    s_mov_b32 s52, s16
    s_mov_b32 s53, s17
    s_mov_b32 s54, 2359296
    s_mov_b32 s55, 0x20000
    v_lshlrev_b32 v7, 4, v2
    v_add_u32 v15, 0x1000, v7
    v_lshlrev_b32 v8, 2, v2
    v_sub_u32 v8, 2047, v8
    v_subrev_u32 v48, 0, v8
    v_subrev_u32 v49, 1, v8
    v_subrev_u32 v50, 2, v8
    v_subrev_u32 v51, 3, v8
    v_subrev_u32 v52, 256, v8
    v_subrev_u32 v53, 257, v8
    v_subrev_u32 v54, 258, v8
    v_subrev_u32 v55, 259, v8
    v_subrev_u32 v56, 512, v8
    v_subrev_u32 v57, 513, v8
    v_subrev_u32 v58, 514, v8
    v_subrev_u32 v59, 515, v8
    v_subrev_u32 v60, 768, v8
    v_subrev_u32 v61, 769, v8
    v_subrev_u32 v62, 770, v8
    v_subrev_u32 v63, 771, v8
    v_subrev_u32 v64, 1024, v8
    v_subrev_u32 v65, 1025, v8
    v_subrev_u32 v66, 1026, v8
    v_subrev_u32 v67, 1027, v8
    v_subrev_u32 v68, 1280, v8
    v_subrev_u32 v69, 1281, v8
    v_subrev_u32 v70, 1282, v8
    v_subrev_u32 v71, 1283, v8
    v_subrev_u32 v72, 1536, v8
    v_subrev_u32 v73, 1537, v8
    v_subrev_u32 v74, 1538, v8
    v_subrev_u32 v75, 1539, v8
    v_subrev_u32 v76, 1792, v8
    v_subrev_u32 v77, 1793, v8
    v_subrev_u32 v78, 1794, v8
    v_subrev_u32 v79, 1795, v8
    v_lshrrev_b32 v9, 3, v2
    v_and_b32 v9, 6, v9
    v_xor_b32 v9, v9, v2
    v_and_b32 v9, 7, v9
    v_lshlrev_b32 v5, 4, v9
    v_mov_b32 v12, 0
    v_mov_b32 v6, 0
    s_mov_b32 s11, 0xffff0000
    s_mov_b32 s15, 0
    s_mov_b32 s9, 0
SP_42:
    ds_read_b32 v13, v1 offset:12
    s_waitcnt lgkmcnt(0)
    v_readfirstlane_b32 s8, v13
    s_add_u32 s9, s9, 1
    s_cmp_ge_u32 s8, 2
    s_cbranch_scc1 SP_42_D
    s_cmp_lt_u32 s9, 524288
    s_cbranch_scc1 SP_42
SP_42_D:
    s_mov_b32 s9, 0
    s_waitcnt vmcnt(0)
    s_sleep 16
SEL_POLL:
    global_load_dwordx4 v[16:19], v7, s[50:51] offset:0 sc1
    global_load_dwordx4 v[20:23], v7, s[50:51] offset:1024 sc1
    global_load_dwordx4 v[24:27], v7, s[50:51] offset:2048 sc1
    global_load_dwordx4 v[28:31], v7, s[50:51] offset:3072 sc1
    global_load_dwordx4 v[32:35], v15, s[50:51] offset:0 sc1
    global_load_dwordx4 v[36:39], v15, s[50:51] offset:1024 sc1
    global_load_dwordx4 v[40:43], v15, s[50:51] offset:2048 sc1
    global_load_dwordx4 v[44:47], v15, s[50:51] offset:3072 sc1
    s_waitcnt vmcnt(7)
    v_xor_b32 v13, v17, v14
    v_bitop3_b32 v13, v13, v19, v14 bitop3:0xf6
    s_waitcnt vmcnt(6)
    v_bitop3_b32 v13, v13, v21, v14 bitop3:0xf6
    v_bitop3_b32 v13, v13, v23, v14 bitop3:0xf6
    s_waitcnt vmcnt(5)
    v_bitop3_b32 v13, v13, v25, v14 bitop3:0xf6
    v_bitop3_b32 v13, v13, v27, v14 bitop3:0xf6
    s_waitcnt vmcnt(4)
    v_bitop3_b32 v13, v13, v29, v14 bitop3:0xf6
    v_bitop3_b32 v13, v13, v31, v14 bitop3:0xf6
    s_waitcnt vmcnt(3)
    v_bitop3_b32 v13, v13, v33, v14 bitop3:0xf6
    v_bitop3_b32 v13, v13, v35, v14 bitop3:0xf6
    s_waitcnt vmcnt(2)
    v_bitop3_b32 v13, v13, v37, v14 bitop3:0xf6
    v_bitop3_b32 v13, v13, v39, v14 bitop3:0xf6
    s_waitcnt vmcnt(1)
    v_bitop3_b32 v13, v13, v41, v14 bitop3:0xf6
    v_bitop3_b32 v13, v13, v43, v14 bitop3:0xf6
    s_waitcnt vmcnt(0)
    v_bitop3_b32 v13, v13, v45, v14 bitop3:0xf6
    v_bitop3_b32 v13, v13, v47, v14 bitop3:0xf6
    v_cmp_ne_u32 vcc, 0, v13
    s_add_u32 s9, s9, 1
    s_cmp_eq_u64 vcc, 0
    s_cbranch_scc1 SEL_GOT
    s_cmp_lt_u32 s9, 131072
    s_cbranch_scc1 SEL_POLL
SEL_GOT:
    v_lshl_or_b32 v80, v16, 16, v48
    v_and_or_b32 v81, v16, s11, v49
    v_lshl_or_b32 v82, v18, 16, v50
    v_and_or_b32 v83, v18, s11, v51
    v_min_u32 v9, v80, v81
    v_max_u32 v8, v80, v81
    v_med3_u32 v9, v8, v9, v82
    v_max_u32 v8, v8, v82
    v_med3_u32 v9, v8, v9, v83
    v_max_u32 v8, v8, v83
    v_lshl_or_b32 v84, v20, 16, v52
    v_and_or_b32 v85, v20, s11, v53
    v_lshl_or_b32 v86, v22, 16, v54
    v_and_or_b32 v87, v22, s11, v55
    v_med3_u32 v9, v8, v9, v84
    v_max_u32 v8, v8, v84
    v_med3_u32 v9, v8, v9, v85
    v_max_u32 v8, v8, v85
    v_med3_u32 v9, v8, v9, v86
    v_max_u32 v8, v8, v86
    v_med3_u32 v9, v8, v9, v87
    v_max_u32 v8, v8, v87
    v_lshl_or_b32 v88, v24, 16, v56
    v_and_or_b32 v89, v24, s11, v57
    v_lshl_or_b32 v90, v26, 16, v58
    v_and_or_b32 v91, v26, s11, v59
    v_med3_u32 v9, v8, v9, v88
    v_max_u32 v8, v8, v88
    v_med3_u32 v9, v8, v9, v89
    v_max_u32 v8, v8, v89
    v_med3_u32 v9, v8, v9, v90
    v_max_u32 v8, v8, v90
    v_med3_u32 v9, v8, v9, v91
    v_max_u32 v8, v8, v91
    v_lshl_or_b32 v92, v28, 16, v60
    v_and_or_b32 v93, v28, s11, v61
    v_lshl_or_b32 v94, v30, 16, v62
    v_and_or_b32 v95, v30, s11, v63
    v_med3_u32 v9, v8, v9, v92
    v_max_u32 v8, v8, v92
    v_med3_u32 v9, v8, v9, v93
    v_max_u32 v8, v8, v93
    v_med3_u32 v9, v8, v9, v94
    v_max_u32 v8, v8, v94
    v_med3_u32 v9, v8, v9, v95
    v_max_u32 v8, v8, v95
    v_lshl_or_b32 v96, v32, 16, v64
    v_and_or_b32 v97, v32, s11, v65
    v_lshl_or_b32 v98, v34, 16, v66
    v_and_or_b32 v99, v34, s11, v67
    v_med3_u32 v9, v8, v9, v96
    v_max_u32 v8, v8, v96
    v_med3_u32 v9, v8, v9, v97
    v_max_u32 v8, v8, v97
    v_med3_u32 v9, v8, v9, v98
    v_max_u32 v8, v8, v98
    v_med3_u32 v9, v8, v9, v99
    v_max_u32 v8, v8, v99
    v_lshl_or_b32 v100, v36, 16, v68
    v_and_or_b32 v101, v36, s11, v69
    v_lshl_or_b32 v102, v38, 16, v70
    v_and_or_b32 v103, v38, s11, v71
    v_med3_u32 v9, v8, v9, v100
    v_max_u32 v8, v8, v100
    v_med3_u32 v9, v8, v9, v101
    v_max_u32 v8, v8, v101
    v_med3_u32 v9, v8, v9, v102
    v_max_u32 v8, v8, v102
    v_med3_u32 v9, v8, v9, v103
    v_max_u32 v8, v8, v103
    v_lshl_or_b32 v104, v40, 16, v72
    v_and_or_b32 v105, v40, s11, v73
    v_lshl_or_b32 v106, v42, 16, v74
    v_and_or_b32 v107, v42, s11, v75
    v_med3_u32 v9, v8, v9, v104
    v_max_u32 v8, v8, v104
    v_med3_u32 v9, v8, v9, v105
    v_max_u32 v8, v8, v105
    v_med3_u32 v9, v8, v9, v106
    v_max_u32 v8, v8, v106
    v_med3_u32 v9, v8, v9, v107
    v_max_u32 v8, v8, v107
    v_lshl_or_b32 v108, v44, 16, v76
    v_and_or_b32 v109, v44, s11, v77
    v_lshl_or_b32 v110, v46, 16, v78
    v_and_or_b32 v111, v46, s11, v79
    v_med3_u32 v9, v8, v9, v108
    v_max_u32 v8, v8, v108
    v_med3_u32 v9, v8, v9, v109
    v_max_u32 v8, v8, v109
    v_med3_u32 v9, v8, v9, v110
    v_max_u32 v8, v8, v110
    v_med3_u32 v9, v8, v9, v111
    v_max_u32 v8, v8, v111
    v_mov_b32 v10, v8
    s_nop 1
    v_max_u32_dpp v10, v10, v10 row_shr:1 row_mask:0xf bank_mask:0xf
    s_nop 1
    v_max_u32_dpp v10, v10, v10 row_shr:2 row_mask:0xf bank_mask:0xf
    s_nop 1
    v_max_u32_dpp v10, v10, v10 row_shr:4 row_mask:0xf bank_mask:0xf
    s_nop 1
    v_max_u32_dpp v10, v10, v10 row_shr:8 row_mask:0xf bank_mask:0xf
    s_nop 1
    v_max_u32_dpp v10, v10, v10 row_bcast:15 row_mask:0xa bank_mask:0xf
    s_nop 1
    v_max_u32_dpp v10, v10, v10 row_bcast:31 row_mask:0xc bank_mask:0xf
    s_nop 0
    v_readlane_b32 s8, v10, 63
    s_mov_b32 s12, s8
    v_subrev_u32 v10, s12, v8
    v_subrev_u32 v11, s12, v9
    v_max_u32 v10, v10, v11
    s_and_b32 s13, s12, 0x7ff
    s_sub_u32 s13, 2047, s13
    v_max_u32_dpp v10, v10, v10 row_shr:1 row_mask:0xf bank_mask:0xf
    s_mul_i32 s13, s13, 1152
    s_nop 0
    v_max_u32_dpp v10, v10, v10 row_shr:2 row_mask:0xf bank_mask:0xf
    s_mov_b32 exec_lo, 0xff
    s_mov_b32 exec_hi, 0x0
    v_add_u32 v12, s13, v5
    v_mov_b32 v6, s12
    s_mov_b64 exec, -1
    v_max_u32_dpp v10, v10, v10 row_shr:4 row_mask:0xf bank_mask:0xf
    s_nop 1
    v_max_u32_dpp v10, v10, v10 row_shr:8 row_mask:0xf bank_mask:0xf
    s_nop 1
    v_max_u32_dpp v10, v10, v10 row_bcast:15 row_mask:0xa bank_mask:0xf
    s_nop 1
    v_max_u32_dpp v10, v10, v10 row_bcast:31 row_mask:0xc bank_mask:0xf
    s_nop 0
    v_readlane_b32 s8, v10, 63
    s_add_u32 s12, s12, s8
    v_subrev_u32 v10, s12, v8
    v_subrev_u32 v11, s12, v9
    v_max_u32 v10, v10, v11
    s_and_b32 s13, s12, 0x7ff
    s_sub_u32 s13, 2047, s13
    v_max_u32_dpp v10, v10, v10 row_shr:1 row_mask:0xf bank_mask:0xf
    s_mul_i32 s13, s13, 1152
    s_nop 0
    v_max_u32_dpp v10, v10, v10 row_shr:2 row_mask:0xf bank_mask:0xf
    s_mov_b32 exec_lo, 0xff00
    s_mov_b32 exec_hi, 0x0
    v_add_u32 v12, s13, v5
    v_mov_b32 v6, s12
    s_mov_b64 exec, -1
    v_max_u32_dpp v10, v10, v10 row_shr:4 row_mask:0xf bank_mask:0xf
    s_nop 1
    v_max_u32_dpp v10, v10, v10 row_shr:8 row_mask:0xf bank_mask:0xf
    s_nop 1
    v_max_u32_dpp v10, v10, v10 row_bcast:15 row_mask:0xa bank_mask:0xf
    s_nop 1
    v_max_u32_dpp v10, v10, v10 row_bcast:31 row_mask:0xc bank_mask:0xf
    s_nop 0
    v_readlane_b32 s8, v10, 63
    s_add_u32 s12, s12, s8
    v_subrev_u32 v10, s12, v8
    v_subrev_u32 v11, s12, v9
    v_max_u32 v10, v10, v11
    s_and_b32 s13, s12, 0x7ff
    s_sub_u32 s13, 2047, s13
    v_max_u32_dpp v10, v10, v10 row_shr:1 row_mask:0xf bank_mask:0xf
    s_mul_i32 s13, s13, 1152
    s_nop 0
    v_max_u32_dpp v10, v10, v10 row_shr:2 row_mask:0xf bank_mask:0xf
    s_mov_b32 exec_lo, 0xff0000
    s_mov_b32 exec_hi, 0x0
    v_add_u32 v12, s13, v5
    v_mov_b32 v6, s12
    s_mov_b64 exec, -1
    v_max_u32_dpp v10, v10, v10 row_shr:4 row_mask:0xf bank_mask:0xf
    s_nop 1
    v_max_u32_dpp v10, v10, v10 row_shr:8 row_mask:0xf bank_mask:0xf
    s_nop 1
    v_max_u32_dpp v10, v10, v10 row_bcast:15 row_mask:0xa bank_mask:0xf
    s_nop 1
    v_max_u32_dpp v10, v10, v10 row_bcast:31 row_mask:0xc bank_mask:0xf
    s_nop 0
    v_readlane_b32 s8, v10, 63
    s_add_u32 s12, s12, s8
    v_subrev_u32 v10, s12, v8
    v_subrev_u32 v11, s12, v9
    v_max_u32 v10, v10, v11
    s_and_b32 s13, s12, 0x7ff
    s_sub_u32 s13, 2047, s13
    v_max_u32_dpp v10, v10, v10 row_shr:1 row_mask:0xf bank_mask:0xf
    s_mul_i32 s13, s13, 1152
    s_nop 0
    v_max_u32_dpp v10, v10, v10 row_shr:2 row_mask:0xf bank_mask:0xf
    s_mov_b32 exec_lo, 0xff000000
    s_mov_b32 exec_hi, 0x0
    v_add_u32 v12, s13, v5
    v_mov_b32 v6, s12
    s_mov_b64 exec, -1
    v_max_u32_dpp v10, v10, v10 row_shr:4 row_mask:0xf bank_mask:0xf
    s_nop 1
    v_max_u32_dpp v10, v10, v10 row_shr:8 row_mask:0xf bank_mask:0xf
    s_nop 1
    v_max_u32_dpp v10, v10, v10 row_bcast:15 row_mask:0xa bank_mask:0xf
    s_nop 1
    v_max_u32_dpp v10, v10, v10 row_bcast:31 row_mask:0xc bank_mask:0xf
    s_nop 0
    v_readlane_b32 s8, v10, 63
    s_add_u32 s12, s12, s8
    v_subrev_u32 v10, s12, v8
    v_subrev_u32 v11, s12, v9
    v_max_u32 v10, v10, v11
    s_and_b32 s13, s12, 0x7ff
    s_sub_u32 s13, 2047, s13
    v_max_u32_dpp v10, v10, v10 row_shr:1 row_mask:0xf bank_mask:0xf
    s_mul_i32 s13, s13, 1152
    s_nop 0
    v_max_u32_dpp v10, v10, v10 row_shr:2 row_mask:0xf bank_mask:0xf
    s_mov_b32 exec_lo, 0x0
    s_mov_b32 exec_hi, 0xff
    v_add_u32 v12, s13, v5
    v_mov_b32 v6, s12
    s_mov_b64 exec, -1
    v_max_u32_dpp v10, v10, v10 row_shr:4 row_mask:0xf bank_mask:0xf
    s_nop 1
    v_max_u32_dpp v10, v10, v10 row_shr:8 row_mask:0xf bank_mask:0xf
    s_nop 1
    v_max_u32_dpp v10, v10, v10 row_bcast:15 row_mask:0xa bank_mask:0xf
    s_nop 1
    v_max_u32_dpp v10, v10, v10 row_bcast:31 row_mask:0xc bank_mask:0xf
    s_nop 0
    v_readlane_b32 s8, v10, 63
    s_add_u32 s12, s12, s8
    v_subrev_u32 v10, s12, v8
    v_subrev_u32 v11, s12, v9
    v_max_u32 v10, v10, v11
    s_and_b32 s13, s12, 0x7ff
    s_sub_u32 s13, 2047, s13
    v_max_u32_dpp v10, v10, v10 row_shr:1 row_mask:0xf bank_mask:0xf
    s_mul_i32 s13, s13, 1152
    s_nop 0
    v_max_u32_dpp v10, v10, v10 row_shr:2 row_mask:0xf bank_mask:0xf
    s_mov_b32 exec_lo, 0x0
    s_mov_b32 exec_hi, 0xff00
    v_add_u32 v12, s13, v5
    v_mov_b32 v6, s12
    s_mov_b64 exec, -1
    v_max_u32_dpp v10, v10, v10 row_shr:4 row_mask:0xf bank_mask:0xf
    s_nop 1
    v_max_u32_dpp v10, v10, v10 row_shr:8 row_mask:0xf bank_mask:0xf
    s_nop 1
    v_max_u32_dpp v10, v10, v10 row_bcast:15 row_mask:0xa bank_mask:0xf
    s_nop 1
    v_max_u32_dpp v10, v10, v10 row_bcast:31 row_mask:0xc bank_mask:0xf
    s_nop 0
    v_readlane_b32 s8, v10, 63
    s_add_u32 s12, s12, s8
    v_subrev_u32 v10, s12, v8
    v_subrev_u32 v11, s12, v9
    v_max_u32 v10, v10, v11
    s_and_b32 s13, s12, 0x7ff
    s_sub_u32 s13, 2047, s13
    v_max_u32_dpp v10, v10, v10 row_shr:1 row_mask:0xf bank_mask:0xf
    s_mul_i32 s13, s13, 1152
    s_nop 0
    v_max_u32_dpp v10, v10, v10 row_shr:2 row_mask:0xf bank_mask:0xf
    s_mov_b32 exec_lo, 0x0
    s_mov_b32 exec_hi, 0xff0000
    v_add_u32 v12, s13, v5
    v_mov_b32 v6, s12
    s_mov_b64 exec, -1
    v_max_u32_dpp v10, v10, v10 row_shr:4 row_mask:0xf bank_mask:0xf
    s_nop 1
    v_max_u32_dpp v10, v10, v10 row_shr:8 row_mask:0xf bank_mask:0xf
    s_nop 1
    v_max_u32_dpp v10, v10, v10 row_bcast:15 row_mask:0xa bank_mask:0xf
    s_nop 1
    v_max_u32_dpp v10, v10, v10 row_bcast:31 row_mask:0xc bank_mask:0xf
    s_nop 0
    v_readlane_b32 s8, v10, 63
    s_add_u32 s12, s12, s8
    s_and_b32 s13, s12, 0x7ff
    s_sub_u32 s13, 2047, s13
    s_mul_i32 s13, s13, 1152
    s_mov_b32 exec_lo, 0x0
    s_mov_b32 exec_hi, 0xff000000
    v_add_u32 v12, s13, v5
    v_mov_b32 v6, s12
    s_mov_b64 exec, -1
    s_mov_b32 s14, 0
SEL_GATHER:
    s_mov_b32 m0, 147712
    s_nop 0
    buffer_load_dwordx4 v12, s[52:55], 0 offen offset:0 lds
    s_mov_b32 m0, 148608
    s_nop 0
    buffer_load_dwordx4 v12, s[52:55], 0 offen offset:128 lds
    s_mov_b32 m0, 149504
    s_nop 0
    buffer_load_dwordx4 v12, s[52:55], 0 offen offset:256 lds
    s_mov_b32 m0, 150400
    s_nop 0
    buffer_load_dwordx4 v12, s[52:55], 0 offen offset:384 lds
    s_mov_b32 m0, 151296
    s_nop 0
    buffer_load_dwordx4 v12, s[52:55], 0 offen offset:512 lds
    s_mov_b32 m0, 152192
    s_nop 0
    buffer_load_dwordx4 v12, s[52:55], 0 offen offset:640 lds
    s_mov_b32 m0, 153088
    s_nop 0
    buffer_load_dwordx4 v12, s[52:55], 0 offen offset:768 lds
    s_mov_b32 m0, 153984
    s_nop 0
    buffer_load_dwordx4 v12, s[52:55], 0 offen offset:896 lds
    s_mov_b32 m0, 154880
    s_nop 0
    buffer_load_dwordx4 v12, s[52:55], 0 offen offset:1024 lds
    v_mov_b32 v13, 1
    s_mov_b64 exec, 1
    ds_add_u32 v1, v13 offset:40
    s_mov_b64 exec, -1
    s_cmp_lg_u32 s14, 0
    s_cbranch_scc1 SEL_OK
    v_sub_u32 v16, v80, v9
    v_sub_u32 v17, v81, v9
    v_sub_u32 v18, v82, v9
    v_sub_u32 v19, v83, v9
    v_sub_u32 v20, v84, v9
    v_sub_u32 v21, v85, v9
    v_sub_u32 v22, v86, v9
    v_sub_u32 v23, v87, v9
    v_sub_u32 v24, v88, v9
    v_sub_u32 v25, v89, v9
    v_sub_u32 v26, v90, v9
    v_sub_u32 v27, v91, v9
    v_sub_u32 v28, v92, v9
    v_sub_u32 v29, v93, v9
    v_sub_u32 v30, v94, v9
    v_sub_u32 v31, v95, v9
    v_sub_u32 v32, v96, v9
    v_sub_u32 v33, v97, v9
    v_sub_u32 v34, v98, v9
    v_sub_u32 v35, v99, v9
    v_sub_u32 v36, v100, v9
    v_sub_u32 v37, v101, v9
    v_sub_u32 v38, v102, v9
    v_sub_u32 v39, v103, v9
    v_sub_u32 v40, v104, v9
    v_sub_u32 v41, v105, v9
    v_sub_u32 v42, v106, v9
    v_sub_u32 v43, v107, v9
    v_sub_u32 v44, v108, v9
    v_sub_u32 v45, v109, v9
    v_sub_u32 v46, v110, v9
    v_sub_u32 v47, v111, v9
    v_max3_u32 v16, v16, v17, v18
    v_max3_u32 v19, v19, v20, v21
    v_max3_u32 v22, v22, v23, v24
    v_max3_u32 v25, v25, v26, v27
    v_max3_u32 v28, v28, v29, v30
    v_max3_u32 v31, v31, v32, v33
    v_max3_u32 v34, v34, v35, v36
    v_max3_u32 v37, v37, v38, v39
    v_max3_u32 v40, v40, v41, v42
    v_max3_u32 v43, v43, v44, v45
    v_max3_u32 v16, v16, v19, v22
    v_max3_u32 v25, v25, v28, v31
    v_max3_u32 v34, v34, v37, v40
    v_max3_u32 v43, v43, v46, v47
    v_max3_u32 v16, v16, v25, v34
    v_max_u32 v16, v16, v43
    v_add_u32 v16, v16, v9
    v_cmp_lt_u32 vcc, s12, v16
    s_cmp_eq_u64 vcc, 0
    s_cbranch_scc1 SEL_OK
    s_waitcnt vmcnt(0)
    s_mov_b32 s12, 0
    s_mov_b64 s[56:57], 0xff
SEL_SLOW:
    v_subrev_u32 v16, s12, v80
    v_subrev_u32 v17, s12, v81
    v_subrev_u32 v18, s12, v82
    v_subrev_u32 v19, s12, v83
    v_subrev_u32 v20, s12, v84
    v_subrev_u32 v21, s12, v85
    v_subrev_u32 v22, s12, v86
    v_subrev_u32 v23, s12, v87
    v_subrev_u32 v24, s12, v88
    v_subrev_u32 v25, s12, v89
    v_subrev_u32 v26, s12, v90
    v_subrev_u32 v27, s12, v91
    v_subrev_u32 v28, s12, v92
    v_subrev_u32 v29, s12, v93
    v_subrev_u32 v30, s12, v94
    v_subrev_u32 v31, s12, v95
    v_subrev_u32 v32, s12, v96
    v_subrev_u32 v33, s12, v97
    v_subrev_u32 v34, s12, v98
    v_subrev_u32 v35, s12, v99
    v_subrev_u32 v36, s12, v100
    v_subrev_u32 v37, s12, v101
    v_subrev_u32 v38, s12, v102
    v_subrev_u32 v39, s12, v103
    v_subrev_u32 v40, s12, v104
    v_subrev_u32 v41, s12, v105
    v_subrev_u32 v42, s12, v106
    v_subrev_u32 v43, s12, v107
    v_subrev_u32 v44, s12, v108
    v_subrev_u32 v45, s12, v109
    v_subrev_u32 v46, s12, v110
    v_subrev_u32 v47, s12, v111
    v_max3_u32 v16, v16, v17, v18
    v_max3_u32 v19, v19, v20, v21
    v_max3_u32 v22, v22, v23, v24
    v_max3_u32 v25, v25, v26, v27
    v_max3_u32 v28, v28, v29, v30
    v_max3_u32 v31, v31, v32, v33
    v_max3_u32 v34, v34, v35, v36
    v_max3_u32 v37, v37, v38, v39
    v_max3_u32 v40, v40, v41, v42
    v_max3_u32 v43, v43, v44, v45
    v_max3_u32 v16, v16, v19, v22
    v_max3_u32 v25, v25, v28, v31
    v_max3_u32 v34, v34, v37, v40
    v_max3_u32 v43, v43, v46, v47
    v_max3_u32 v16, v16, v25, v34
    v_max_u32 v16, v16, v43
    s_nop 1
    v_max_u32_dpp v16, v16, v16 row_shr:1 row_mask:0xf bank_mask:0xf
    s_nop 1
    v_max_u32_dpp v16, v16, v16 row_shr:2 row_mask:0xf bank_mask:0xf
    s_nop 1
    v_max_u32_dpp v16, v16, v16 row_shr:4 row_mask:0xf bank_mask:0xf
    s_nop 1
    v_max_u32_dpp v16, v16, v16 row_shr:8 row_mask:0xf bank_mask:0xf
    s_nop 1
    v_max_u32_dpp v16, v16, v16 row_bcast:15 row_mask:0xa bank_mask:0xf
    s_nop 1
    v_max_u32_dpp v16, v16, v16 row_bcast:31 row_mask:0xc bank_mask:0xf
    s_nop 0
    v_readlane_b32 s8, v16, 63
    s_add_u32 s12, s12, s8
    s_and_b32 s13, s12, 0x7ff
    s_sub_u32 s13, 2047, s13
    s_mul_i32 s13, s13, 1152
    s_mov_b64 exec, s[56:57]
    v_add_u32 v12, s13, v5
    v_mov_b32 v6, s12
    s_mov_b64 exec, -1
    s_lshl_b64 s[56:57], s[56:57], 8
    s_add_u32 s14, s14, 1
    s_cmp_lt_u32 s14, 8
    s_cbranch_scc1 SEL_SLOW
    s_branch SEL_GATHER
SEL_OK:
    s_cmp_lg_u32 s2, 0
    s_cbranch_scc1 SEL_NOPUB
    v_mov_b32 v7, v14
    v_add_u32 v8, 8192, v2
    s_mov_b32 exec_lo, 0x01010101
    s_mov_b32 exec_hi, 0x01010101
    global_store_dwordx2 v8, v[6:7], s[50:51] sc1
    s_mov_b64 exec, 1
    global_store_dword v8, v14, s[50:51] offset:256 sc1
    s_mov_b64 exec, -1
    s_waitcnt vmcnt(2)
    s_branch SEL_END
SEL_NOPUB:
    s_waitcnt vmcnt(0)
SEL_END:
    v_mov_b32 v8, 3
    ds_write_b32 v1, v8 offset:84
    s_endpgm
F_COMP:
F_COMP2:
    s_and_b32 s12, s3, 3
    v_lshrrev_b32 v5, 2, v3
    v_bfe_u32 v7, v3, 3, 1
    v_and_b32 v13, 1, v4
    v_lshl_or_b32 v14, v13, 1, v7
    v_and_b32 v15, 7, v3
    v_mul_u32_u24 v16, 144, v15
    v_add_u32 v16, 156928, v16
    s_mov_b32 s56, 0xff00ff00
    s_mov_b32 s57, 0xff00ff00
    s_lshr_b32 s8, s3, 2
    s_cmp_lg_u32 s8, 1
    s_cbranch_scc1 F_DOWN
    v_bfe_u32 v6, v3, 1, 1
    v_lshl_or_b32 v8, v6, 2, v14
    v_xor_b32 v8, s12, v8
    v_lshlrev_b32 v8, 4, v8
    v_lshl_add_u32 v8, v5, 7, v8
    v_lshl_add_u32 v8, v6, 10, v8
    v_lshl_add_u32 v8, v4, 11, v8
    v_and_b32 v9, 1, v3
    v_lshl_add_u32 v8, v9, 3, v8
    v_xor_b32 v9, 64, v8
    v_add_u32 v10, 49408, v8
    v_add_u32 v11, 49408, v9
    v_lshlrev_b32 v6, 2, v13
    v_lshrrev_b32 v5, 1, v4
    v_add_u32 v6, v6, v5
    v_lshl_add_u32 v6, v7, 5, v6
    s_lshl_b32 s8, s12, 3
    v_add_lshl_u32 v6, v6, s8, 1
    v_add_u32 v5, v6, v16
    v_and_b32 v6, 6, v3
    v_xor_b32 v6, v6, v4
    v_lshlrev_b32 v6, 4, v6
    v_lshl_add_u32 v6, v15, 7, v6
    v_add_u32 v6, 147712, v6
    v_xor_b32 v7, 64, v6
    s_mov_b32 s9, 0
SP_43:
    ds_read_b32 v12, v1 offset:16
    s_waitcnt lgkmcnt(0)
    v_readfirstlane_b32 s8, v12
    s_add_u32 s9, s9, 1
    s_cmp_ge_u32 s8, 3
    s_cbranch_scc1 SP_43_D
    s_sleep 1
    s_cmp_lt_u32 s9, 524288
    s_cbranch_scc1 SP_43
SP_43_D:
    ds_read_b64_tr_b16 v[24:25], v8 offset:256
    ds_read_b64_tr_b16 v[26:27], v8 offset:768
    ds_read_b64_tr_b16 v[28:29], v9 offset:256
    ds_read_b64_tr_b16 v[30:31], v9 offset:768
    ds_read_b64_tr_b16 v[32:33], v8 offset:8448
    ds_read_b64_tr_b16 v[34:35], v8 offset:8960
    ds_read_b64_tr_b16 v[36:37], v9 offset:8448
    ds_read_b64_tr_b16 v[38:39], v9 offset:8960
    ds_read_b64_tr_b16 v[40:41], v8 offset:16640
    ds_read_b64_tr_b16 v[42:43], v8 offset:17152
    ds_read_b64_tr_b16 v[44:45], v9 offset:16640
    ds_read_b64_tr_b16 v[46:47], v9 offset:17152
    s_waitcnt lgkmcnt(0)
    v_mov_b32 v12, 1
    s_mov_b64 exec, 1
    ds_add_u32 v1, v12 offset:48
    s_mov_b64 exec, -1
    s_mov_b32 s9, 0
SP_44:
    ds_read_b32 v12, v1 offset:20
    s_waitcnt lgkmcnt(0)
    v_readfirstlane_b32 s8, v12
    s_add_u32 s9, s9, 1
    s_cmp_ge_u32 s8, 3
    s_cbranch_scc1 SP_44_D
    s_sleep 1
    s_cmp_lt_u32 s9, 524288
    s_cbranch_scc1 SP_44
SP_44_D:
    ds_read_b64_tr_b16 v[48:49], v8 offset:24832
    ds_read_b64_tr_b16 v[50:51], v8 offset:25344
    ds_read_b64_tr_b16 v[52:53], v9 offset:24832
    ds_read_b64_tr_b16 v[54:55], v9 offset:25344
    ds_read_b64_tr_b16 v[56:57], v8 offset:33024
    ds_read_b64_tr_b16 v[58:59], v8 offset:33536
    ds_read_b64_tr_b16 v[60:61], v9 offset:33024
    ds_read_b64_tr_b16 v[62:63], v9 offset:33536
    ds_read_b64_tr_b16 v[64:65], v8 offset:41216
    ds_read_b64_tr_b16 v[66:67], v8 offset:41728
    ds_read_b64_tr_b16 v[68:69], v9 offset:41216
    ds_read_b64_tr_b16 v[70:71], v9 offset:41728
    s_waitcnt lgkmcnt(0)
    v_mov_b32 v12, 1
    s_mov_b64 exec, 1
    ds_add_u32 v1, v12 offset:52
    s_mov_b64 exec, -1
    s_mov_b32 s9, 0
SP_45:
    ds_read_b32 v12, v1 offset:24
    s_waitcnt lgkmcnt(0)
    v_readfirstlane_b32 s8, v12
    s_add_u32 s9, s9, 1
    s_cmp_ge_u32 s8, 3
    s_cbranch_scc1 SP_45_D
    s_sleep 1
    s_cmp_lt_u32 s9, 524288
    s_cbranch_scc1 SP_45
SP_45_D:
    ds_read_b64_tr_b16 v[72:73], v10 offset:0
    ds_read_b64_tr_b16 v[74:75], v10 offset:512
    ds_read_b64_tr_b16 v[76:77], v11 offset:0
    ds_read_b64_tr_b16 v[78:79], v11 offset:512
    ds_read_b64_tr_b16 v[80:81], v10 offset:8192
    ds_read_b64_tr_b16 v[82:83], v10 offset:8704
    ds_read_b64_tr_b16 v[84:85], v11 offset:8192
    ds_read_b64_tr_b16 v[86:87], v11 offset:8704
    ds_read_b64_tr_b16 v[88:89], v10 offset:16384
    ds_read_b64_tr_b16 v[90:91], v10 offset:16896
    ds_read_b64_tr_b16 v[92:93], v11 offset:16384
    ds_read_b64_tr_b16 v[94:95], v11 offset:16896
    s_waitcnt lgkmcnt(0)
    v_mov_b32 v12, 1
    s_mov_b64 exec, 1
    ds_add_u32 v1, v12 offset:56
    s_mov_b64 exec, -1
    s_mov_b32 s9, 0
SP_46:
    ds_read_b32 v12, v1 offset:28
    s_waitcnt lgkmcnt(0)
    v_readfirstlane_b32 s8, v12
    s_add_u32 s9, s9, 1
    s_cmp_ge_u32 s8, 3
    s_cbranch_scc1 SP_46_D
    s_sleep 1
    s_cmp_lt_u32 s9, 524288
    s_cbranch_scc1 SP_46
SP_46_D:
    ds_read_b64_tr_b16 v[96:97], v8 offset:256
    ds_read_b64_tr_b16 v[98:99], v8 offset:768
    ds_read_b64_tr_b16 v[100:101], v9 offset:256
    ds_read_b64_tr_b16 v[102:103], v9 offset:768
    ds_read_b64_tr_b16 v[104:105], v8 offset:8448
    ds_read_b64_tr_b16 v[106:107], v8 offset:8960
    ds_read_b64_tr_b16 v[108:109], v9 offset:8448
    ds_read_b64_tr_b16 v[110:111], v9 offset:8960
    ds_read_b64_tr_b16 v[112:113], v8 offset:16640
    ds_read_b64_tr_b16 v[114:115], v8 offset:17152
    ds_read_b64_tr_b16 v[116:117], v9 offset:16640
    ds_read_b64_tr_b16 v[118:119], v9 offset:17152
    s_mov_b32 s9, 0
SP_47:
    ds_read_b32 v12, v1 offset:32
    s_waitcnt lgkmcnt(0)
    v_readfirstlane_b32 s8, v12
    s_add_u32 s9, s9, 1
    s_cmp_ge_u32 s8, 3
    s_cbranch_scc1 SP_47_D
    s_sleep 1
    s_cmp_lt_u32 s9, 524288
    s_cbranch_scc1 SP_47
SP_47_D:
    ds_read_b64_tr_b16 v[120:121], v8 offset:24832
    ds_read_b64_tr_b16 v[122:123], v8 offset:25344
    ds_read_b64_tr_b16 v[124:125], v9 offset:24832
    ds_read_b64_tr_b16 v[126:127], v9 offset:25344
    ds_read_b64_tr_b16 v[128:129], v8 offset:33024
    ds_read_b64_tr_b16 v[130:131], v8 offset:33536
    ds_read_b64_tr_b16 v[132:133], v9 offset:33024
    ds_read_b64_tr_b16 v[134:135], v9 offset:33536
    ds_read_b64_tr_b16 v[136:137], v8 offset:41216
    ds_read_b64_tr_b16 v[138:139], v8 offset:41728
    ds_read_b64_tr_b16 v[140:141], v9 offset:41216
    ds_read_b64_tr_b16 v[142:143], v9 offset:41728
    s_mov_b32 s9, 0
SP_48:
    ds_read_b32 v12, v1 offset:36
    s_waitcnt lgkmcnt(0)
    v_readfirstlane_b32 s8, v12
    s_add_u32 s9, s9, 1
    s_cmp_ge_u32 s8, 3
    s_cbranch_scc1 SP_48_D
    s_sleep 1
    s_cmp_lt_u32 s9, 524288
    s_cbranch_scc1 SP_48
SP_48_D:
    ds_read_b64_tr_b16 v[144:145], v10 offset:0
    ds_read_b64_tr_b16 v[146:147], v10 offset:512
    ds_read_b64_tr_b16 v[148:149], v11 offset:0
    ds_read_b64_tr_b16 v[150:151], v11 offset:512
    ds_read_b64_tr_b16 v[152:153], v10 offset:8192
    ds_read_b64_tr_b16 v[154:155], v10 offset:8704
    ds_read_b64_tr_b16 v[156:157], v11 offset:8192
    ds_read_b64_tr_b16 v[158:159], v11 offset:8704
    ds_read_b64_tr_b16 v[160:161], v10 offset:16384
    ds_read_b64_tr_b16 v[162:163], v10 offset:16896
    ds_read_b64_tr_b16 v[164:165], v11 offset:16384
    ds_read_b64_tr_b16 v[166:167], v11 offset:16896
    s_setprio 3
    s_mov_b32 s9, 0
SP_49:
    ds_read_b32 v12, v1 offset:84
    s_waitcnt lgkmcnt(0)
    v_readfirstlane_b32 s8, v12
    s_add_u32 s9, s9, 1
    s_cmp_ge_u32 s8, 1
    s_cbranch_scc1 SP_49_D
    s_cmp_lt_u32 s9, 524288
    s_cbranch_scc1 SP_49
SP_49_D:
    ds_read_b128 v[16:19], v6 offset:0
    ds_read_b128 v[20:23], v7 offset:0
    s_waitcnt lgkmcnt(1)
    v_mfma_f32_16x16x32_bf16 v[8:11], v[24:27], v[16:19], 0
    ds_read_b128 v[24:27], v6 offset:1024
    v_mfma_f32_16x16x32_bf16 v[12:15], v[28:31], v[16:19], 0
    ds_read_b128 v[28:31], v7 offset:1024
    s_waitcnt lgkmcnt(2)
    v_mfma_f32_16x16x32_bf16 v[8:11], v[32:35], v[20:23], v[8:11]
    ds_read_b128 v[32:35], v6 offset:2048
    v_mfma_f32_16x16x32_bf16 v[12:15], v[36:39], v[20:23], v[12:15]
    ds_read_b128 v[36:39], v7 offset:2048
    s_waitcnt lgkmcnt(3)
    v_mfma_f32_16x16x32_bf16 v[8:11], v[40:43], v[24:27], v[8:11]
    ds_read_b128 v[40:43], v6 offset:3072
    v_mfma_f32_16x16x32_bf16 v[12:15], v[44:47], v[24:27], v[12:15]
    ds_read_b128 v[44:47], v7 offset:3072
    s_waitcnt lgkmcnt(4)
    v_mfma_f32_16x16x32_bf16 v[8:11], v[48:51], v[28:31], v[8:11]
    ds_read_b128 v[48:51], v6 offset:4096
    v_mfma_f32_16x16x32_bf16 v[12:15], v[52:55], v[28:31], v[12:15]
    ds_read_b128 v[52:55], v7 offset:4096
    s_waitcnt lgkmcnt(5)
    v_mfma_f32_16x16x32_bf16 v[8:11], v[56:59], v[32:35], v[8:11]
    ds_read_b128 v[56:59], v6 offset:5120
    v_mfma_f32_16x16x32_bf16 v[12:15], v[60:63], v[32:35], v[12:15]
    ds_read_b128 v[60:63], v7 offset:5120
    s_waitcnt lgkmcnt(6)
    v_mfma_f32_16x16x32_bf16 v[8:11], v[64:67], v[36:39], v[8:11]
    ds_read_b128 v[64:67], v6 offset:6144
    v_mfma_f32_16x16x32_bf16 v[12:15], v[68:71], v[36:39], v[12:15]
    ds_read_b128 v[68:71], v7 offset:6144
    s_waitcnt lgkmcnt(7)
    v_mfma_f32_16x16x32_bf16 v[8:11], v[72:75], v[40:43], v[8:11]
    ds_read_b128 v[72:75], v6 offset:7168
    v_mfma_f32_16x16x32_bf16 v[12:15], v[76:79], v[40:43], v[12:15]
    ds_read_b128 v[76:79], v7 offset:7168
    s_waitcnt lgkmcnt(8)
    v_mfma_f32_16x16x32_bf16 v[8:11], v[80:83], v[44:47], v[8:11]
    ds_read_b128 v[80:83], v6 offset:8192
    v_mfma_f32_16x16x32_bf16 v[12:15], v[84:87], v[44:47], v[12:15]
    ds_read_b128 v[84:87], v7 offset:8192
    s_waitcnt lgkmcnt(9)
    v_mfma_f32_16x16x32_bf16 v[8:11], v[88:91], v[48:51], v[8:11]
    v_mfma_f32_16x16x32_bf16 v[12:15], v[92:95], v[48:51], v[12:15]
    s_waitcnt lgkmcnt(8)
    v_mfma_f32_16x16x32_bf16 v[8:11], v[96:99], v[52:55], v[8:11]
    v_mfma_f32_16x16x32_bf16 v[12:15], v[100:103], v[52:55], v[12:15]
    s_waitcnt lgkmcnt(7)
    v_mfma_f32_16x16x32_bf16 v[8:11], v[104:107], v[56:59], v[8:11]
    v_mfma_f32_16x16x32_bf16 v[12:15], v[108:111], v[56:59], v[12:15]
    s_waitcnt lgkmcnt(6)
    v_mfma_f32_16x16x32_bf16 v[8:11], v[112:115], v[60:63], v[8:11]
    v_mfma_f32_16x16x32_bf16 v[12:15], v[116:119], v[60:63], v[12:15]
    s_waitcnt lgkmcnt(5)
    v_mfma_f32_16x16x32_bf16 v[8:11], v[120:123], v[64:67], v[8:11]
    v_mfma_f32_16x16x32_bf16 v[12:15], v[124:127], v[64:67], v[12:15]
    s_waitcnt lgkmcnt(4)
    v_mfma_f32_16x16x32_bf16 v[8:11], v[128:131], v[68:71], v[8:11]
    v_mfma_f32_16x16x32_bf16 v[12:15], v[132:135], v[68:71], v[12:15]
    s_waitcnt lgkmcnt(3)
    v_mfma_f32_16x16x32_bf16 v[8:11], v[136:139], v[72:75], v[8:11]
    v_mfma_f32_16x16x32_bf16 v[12:15], v[140:143], v[72:75], v[12:15]
    s_waitcnt lgkmcnt(2)
    v_mfma_f32_16x16x32_bf16 v[8:11], v[144:147], v[76:79], v[8:11]
    v_mfma_f32_16x16x32_bf16 v[12:15], v[148:151], v[76:79], v[12:15]
    s_waitcnt lgkmcnt(1)
    v_mfma_f32_16x16x32_bf16 v[8:11], v[152:155], v[80:83], v[8:11]
    v_mfma_f32_16x16x32_bf16 v[12:15], v[156:159], v[80:83], v[12:15]
    s_waitcnt lgkmcnt(0)
    v_mfma_f32_16x16x32_bf16 v[8:11], v[160:163], v[84:87], v[8:11]
    v_mfma_f32_16x16x32_bf16 v[12:15], v[164:167], v[84:87], v[12:15]
    s_nop 7
    v_cndmask_b32 v8, v8, v12, s[56:57]
    v_cndmask_b32 v9, v9, v13, s[56:57]
    v_cndmask_b32 v10, v10, v14, s[56:57]
    v_cndmask_b32 v11, v11, v15, s[56:57]
    v_permlane32_swap_b32 v8, v9
    s_nop 0
    v_permlane32_swap_b32 v10, v11
    v_cvt_pk_bf16_f32 v9, v8, v9
    v_cvt_pk_bf16_f32 v11, v10, v11
    v_lshlrev_b32 v8, 16, v9
    v_lshlrev_b32 v10, 16, v11
    v_mul_f32 v12, 0xbfb8aa3b, v8
    v_mul_f32 v13, 0xbfb8aa3b, v10
    v_exp_f32 v12, v12
    v_exp_f32 v13, v13
    v_and_b32 v9, 0xffff0000, v9
    v_and_b32 v11, 0xffff0000, v11
    v_add_f32 v12, 1.0, v12
    v_add_f32 v13, 1.0, v13
    v_rcp_f32 v12, v12
    v_rcp_f32 v13, v13
    v_mul_f32 v8, v8, v12
    v_mul_f32 v10, v10, v13
    v_cvt_pk_bf16_f32 v8, v8, v8
    v_cvt_pk_bf16_f32 v10, v10, v10
    v_and_b32 v8, 0xffff0000, v8
    v_and_b32 v10, 0xffff0000, v10
    v_mul_f32 v8, v8, v9
    v_mul_f32 v10, v10, v11
    v_cvt_pk_bf16_f32 v8, v8, v10
    ds_write_b16 v5, v8
    ds_write_b16_d16_hi v5, v8 offset:4
    v_mov_b32 v12, 1
    s_mov_b64 exec, 1
    ds_add_u32 v1, v12 offset:88
    s_mov_b64 exec, -1
    s_endpgm
F_DOWN:
    v_lshl_add_u32 v10, v4, 4, v16
    v_mov_b32 v18, 158080
    v_cndmask_b32 v19, v18, v10, s[56:57]
    v_cndmask_b32 v18, v10, v18, s[56:57]
    v_and_b32 v20, 31, v2
    v_lshlrev_b32 v20, 2, v20
    v_add_u32 v20, 158080, v20
    ds_write_b32 v20, v1
    v_mul_u32_u24 v8, 9216, v4
    s_mul_i32 s13, s7, 73728
    s_mov_b32 s60, 0x7060500
    s_mov_b32 s61, 0x7060501
    s_mov_b32 s62, 0x7060502
    s_mov_b32 s63, 0x7060503
    s_mov_b32 s64, 0x05040100
    s_mov_b32 s65, 0x07060302
    s_lshl_b32 s14, s7, 7
    s_add_u32 s14, s14, 32768
    v_lshl_add_u32 v11, v15, 4, s14
    s_waitcnt lgkmcnt(0)
    s_mov_b32 s52, s50
    s_mov_b32 s53, s51
    s_mov_b32 s54, 268435456
    s_mov_b32 s55, 0x20000
    s_mov_b32 s68, s42
    s_mov_b32 s69, s43
    s_mov_b32 s70, 5308416
    s_mov_b32 s71, 0x20000
    s_cmp_eq_u32 s3, 9
    s_cbranch_scc1 F_DN2
    v_lshl_add_u32 v8, v3, 4, v8
    s_lshl_b32 s8, s3, 8
    s_add_u32 s13, s13, s8
    s_lshl_b32 s8, s3, 5
    v_lshl_add_u32 v6, v4, 3, v7
    v_add_u32 v6, s8, v6
    v_mul_u32_u24 v6, 9216, v6
    v_add_u32 v11, v6, v11
    s_mov_b32 s9, 0
SP_50:
    ds_read_b32 v17, v1 offset:8
    s_waitcnt lgkmcnt(0)
    v_readfirstlane_b32 s8, v17
    s_add_u32 s9, s9, 1
    s_cmp_lg_u32 s8, 0
    s_cbranch_scc1 SP_50_D
    s_sleep 2
    s_cmp_lt_u32 s9, 524288
    s_cbranch_scc1 SP_50
SP_50_D:
    s_mov_b32 s9, 0
SP_51:
    ds_read_b32 v12, v1 offset:40
    s_waitcnt lgkmcnt(0)
    v_readfirstlane_b32 s8, v12
    s_add_u32 s9, s9, 1
    s_cmp_ge_u32 s8, 3
    s_cbranch_scc1 SP_51_D
    s_sleep 1
    s_cmp_lt_u32 s9, 524288
    s_cbranch_scc1 SP_51
SP_51_D:
    s_setprio 2
    buffer_load_dwordx4 v[24:27], v8, s[68:71], s13 offen offset:0
    buffer_load_dwordx4 v[28:31], v8, s[68:71], s13 offen offset:1152
    buffer_load_dwordx4 v[32:35], v8, s[68:71], s13 offen offset:2304
    buffer_load_dwordx4 v[36:39], v8, s[68:71], s13 offen offset:3456
    s_add_u32 s13, s13, 4608
    s_mov_b32 s9, 0
SP_52:
    ds_read_b32 v12, v1 offset:40
    s_waitcnt lgkmcnt(0)
    v_readfirstlane_b32 s8, v12
    s_add_u32 s9, s9, 1
    s_cmp_ge_u32 s8, 4
    s_cbranch_scc1 SP_52_D
    s_sleep 1
    s_cmp_lt_u32 s9, 524288
    s_cbranch_scc1 SP_52
SP_52_D:
    buffer_load_dwordx4 v[40:43], v8, s[68:71], s13 offen offset:0
    buffer_load_dwordx4 v[44:47], v8, s[68:71], s13 offen offset:1152
    buffer_load_dwordx4 v[48:51], v8, s[68:71], s13 offen offset:2304
    buffer_load_dwordx4 v[52:55], v8, s[68:71], s13 offen offset:3456
    s_add_u32 s13, s13, 32256
    buffer_load_dwordx4 v[88:91], v8, s[68:71], s13 offen offset:0
    buffer_load_dwordx4 v[92:95], v8, s[68:71], s13 offen offset:1152
    buffer_load_dwordx4 v[96:99], v8, s[68:71], s13 offen offset:2304
    buffer_load_dwordx4 v[100:103], v8, s[68:71], s13 offen offset:3456
    s_add_u32 s13, s13, 4608
    buffer_load_dwordx4 v[104:107], v8, s[68:71], s13 offen offset:0
    buffer_load_dwordx4 v[108:111], v8, s[68:71], s13 offen offset:1152
    buffer_load_dwordx4 v[112:115], v8, s[68:71], s13 offen offset:2304
    buffer_load_dwordx4 v[116:119], v8, s[68:71], s13 offen offset:3456
    s_add_u32 s13, s13, 32256
    s_waitcnt vmcnt(14)
    v_perm_b32 v56, v28, v24, s64
    v_perm_b32 v60, v28, v24, s65
    v_perm_b32 v64, v29, v25, s64
    v_perm_b32 v68, v29, v25, s65
    v_perm_b32 v72, v30, v26, s64
    v_perm_b32 v76, v30, v26, s65
    v_perm_b32 v80, v31, v27, s64
    v_perm_b32 v84, v31, v27, s65
    s_waitcnt vmcnt(12)
    v_perm_b32 v57, v36, v32, s64
    v_perm_b32 v61, v36, v32, s65
    v_perm_b32 v65, v37, v33, s64
    v_perm_b32 v69, v37, v33, s65
    v_perm_b32 v73, v38, v34, s64
    v_perm_b32 v77, v38, v34, s65
    v_perm_b32 v81, v39, v35, s64
    v_perm_b32 v85, v39, v35, s65
    s_waitcnt vmcnt(10)
    v_perm_b32 v58, v44, v40, s64
    v_perm_b32 v62, v44, v40, s65
    v_perm_b32 v66, v45, v41, s64
    v_perm_b32 v70, v45, v41, s65
    v_perm_b32 v74, v46, v42, s64
    v_perm_b32 v78, v46, v42, s65
    v_perm_b32 v82, v47, v43, s64
    v_perm_b32 v86, v47, v43, s65
    s_waitcnt vmcnt(8)
    v_perm_b32 v59, v52, v48, s64
    v_perm_b32 v63, v52, v48, s65
    v_perm_b32 v67, v53, v49, s64
    v_perm_b32 v71, v53, v49, s65
    v_perm_b32 v75, v54, v50, s64
    v_perm_b32 v79, v54, v50, s65
    v_perm_b32 v83, v55, v51, s64
    v_perm_b32 v87, v55, v51, s65
    s_waitcnt vmcnt(6)
    v_perm_b32 v24, v92, v88, s64
    v_perm_b32 v28, v92, v88, s65
    v_perm_b32 v32, v93, v89, s64
    v_perm_b32 v36, v93, v89, s65
    v_perm_b32 v40, v94, v90, s64
    v_perm_b32 v44, v94, v90, s65
    v_perm_b32 v48, v95, v91, s64
    v_perm_b32 v52, v95, v91, s65
    s_waitcnt vmcnt(4)
    v_perm_b32 v25, v100, v96, s64
    v_perm_b32 v29, v100, v96, s65
    v_perm_b32 v33, v101, v97, s64
    v_perm_b32 v37, v101, v97, s65
    v_perm_b32 v41, v102, v98, s64
    v_perm_b32 v45, v102, v98, s65
    v_perm_b32 v49, v103, v99, s64
    v_perm_b32 v53, v103, v99, s65
    s_mov_b32 s9, 0
SP_53:
    ds_read_b32 v12, v1 offset:88
    s_waitcnt lgkmcnt(0)
    v_readfirstlane_b32 s8, v12
    s_add_u32 s9, s9, 1
    s_cmp_ge_u32 s8, 4
    s_cbranch_scc1 SP_53_D
    s_cmp_lt_u32 s9, 524288
    s_cbranch_scc1 SP_53
SP_53_D:
    ds_read_b128 v[152:155], v18 offset:0
    ds_read_b128 v[160:163], v19 offset:0
    ds_read_b128 v[156:159], v18 offset:64
    ds_read_b128 v[164:167], v19 offset:64
    s_waitcnt lgkmcnt(2)
    v_mfma_f32_16x16x32_bf16 v[120:123], v[56:59], v[152:155], 0
    v_mfma_f32_16x16x32_bf16 v[124:127], v[60:63], v[152:155], 0
    v_mfma_f32_16x16x32_bf16 v[128:131], v[64:67], v[152:155], 0
    v_mfma_f32_16x16x32_bf16 v[132:135], v[68:71], v[152:155], 0
    v_mfma_f32_16x16x32_bf16 v[120:123], v[72:75], v[160:163], v[120:123]
    v_mfma_f32_16x16x32_bf16 v[124:127], v[76:79], v[160:163], v[124:127]
    v_mfma_f32_16x16x32_bf16 v[128:131], v[80:83], v[160:163], v[128:131]
    v_mfma_f32_16x16x32_bf16 v[132:135], v[84:87], v[160:163], v[132:135]
    s_waitcnt lgkmcnt(0)
    s_waitcnt vmcnt(2)
    v_perm_b32 v26, v108, v104, s64
    v_perm_b32 v30, v108, v104, s65
    v_perm_b32 v34, v109, v105, s64
    v_perm_b32 v38, v109, v105, s65
    v_perm_b32 v42, v110, v106, s64
    v_perm_b32 v46, v110, v106, s65
    v_perm_b32 v50, v111, v107, s64
    v_perm_b32 v54, v111, v107, s65
    s_waitcnt vmcnt(0)
    v_perm_b32 v27, v116, v112, s64
    v_perm_b32 v31, v116, v112, s65
    v_perm_b32 v35, v117, v113, s64
    v_perm_b32 v39, v117, v113, s65
    v_perm_b32 v43, v118, v114, s64
    v_perm_b32 v47, v118, v114, s65
    v_perm_b32 v51, v119, v115, s64
    v_perm_b32 v55, v119, v115, s65
    v_mfma_f32_16x16x32_bf16 v[120:123], v[24:27], v[156:159], v[120:123]
    v_mfma_f32_16x16x32_bf16 v[124:127], v[28:31], v[156:159], v[124:127]
    v_mfma_f32_16x16x32_bf16 v[128:131], v[32:35], v[156:159], v[128:131]
    v_mfma_f32_16x16x32_bf16 v[132:135], v[36:39], v[156:159], v[132:135]
    v_mfma_f32_16x16x32_bf16 v[120:123], v[40:43], v[164:167], v[120:123]
    v_mfma_f32_16x16x32_bf16 v[124:127], v[44:47], v[164:167], v[124:127]
    v_mfma_f32_16x16x32_bf16 v[128:131], v[48:51], v[164:167], v[128:131]
    v_mfma_f32_16x16x32_bf16 v[132:135], v[52:55], v[164:167], v[132:135]
    s_nop 4
    v_perm_b32 v88, v120, v17, s60
    v_perm_b32 v89, v124, v17, s61
    v_perm_b32 v90, v128, v17, s62
    v_perm_b32 v91, v132, v17, s63
    s_mov_b32 s12, 0
    buffer_store_dwordx4 v[88:91], v11, s[52:55], s12 offen sc1
    v_perm_b32 v92, v121, v17, s60
    v_perm_b32 v93, v125, v17, s61
    v_perm_b32 v94, v129, v17, s62
    v_perm_b32 v95, v133, v17, s63
    s_mov_b32 s12, 18432
    buffer_store_dwordx4 v[92:95], v11, s[52:55], s12 offen sc1
    v_perm_b32 v96, v122, v17, s60
    v_perm_b32 v97, v126, v17, s61
    v_perm_b32 v98, v130, v17, s62
    v_perm_b32 v99, v134, v17, s63
    s_mov_b32 s12, 36864
    buffer_store_dwordx4 v[96:99], v11, s[52:55], s12 offen sc1
    v_perm_b32 v100, v123, v17, s60
    v_perm_b32 v101, v127, v17, s61
    v_perm_b32 v102, v131, v17, s62
    v_perm_b32 v103, v135, v17, s63
    s_mov_b32 s12, 55296
    buffer_store_dwordx4 v[100:103], v11, s[52:55], s12 offen sc1
    s_endpgm
F_DN2:
    v_lshl_add_u32 v8, v3, 3, v8
    s_add_u32 s13, s13, 1024
    v_lshl_add_u32 v6, v4, 2, v7
    v_add_u32 v6, 128, v6
    v_mul_u32_u24 v6, 9216, v6
    v_add_u32 v11, v6, v11
    s_mov_b32 s9, 0
SP_54:
    ds_read_b32 v17, v1 offset:8
    s_waitcnt lgkmcnt(0)
    v_readfirstlane_b32 s8, v17
    s_add_u32 s9, s9, 1
    s_cmp_lg_u32 s8, 0
    s_cbranch_scc1 SP_54_D
    s_cmp_lt_u32 s9, 524288
    s_cbranch_scc1 SP_54
SP_54_D:
    buffer_load_dwordx2 v[24:25], v8, s[68:71], s13 offen offset:0
    buffer_load_dwordx2 v[26:27], v8, s[68:71], s13 offen offset:1152
    buffer_load_dwordx2 v[28:29], v8, s[68:71], s13 offen offset:2304
    buffer_load_dwordx2 v[30:31], v8, s[68:71], s13 offen offset:3456
    s_add_u32 s13, s13, 4608
    buffer_load_dwordx2 v[32:33], v8, s[68:71], s13 offen offset:0
    buffer_load_dwordx2 v[34:35], v8, s[68:71], s13 offen offset:1152
    buffer_load_dwordx2 v[36:37], v8, s[68:71], s13 offen offset:2304
    buffer_load_dwordx2 v[38:39], v8, s[68:71], s13 offen offset:3456
    s_add_u32 s13, s13, 32256
    buffer_load_dwordx2 v[88:89], v8, s[68:71], s13 offen offset:0
    buffer_load_dwordx2 v[90:91], v8, s[68:71], s13 offen offset:1152
    buffer_load_dwordx2 v[92:93], v8, s[68:71], s13 offen offset:2304
    buffer_load_dwordx2 v[94:95], v8, s[68:71], s13 offen offset:3456
    s_add_u32 s13, s13, 4608
    buffer_load_dwordx2 v[96:97], v8, s[68:71], s13 offen offset:0
    buffer_load_dwordx2 v[98:99], v8, s[68:71], s13 offen offset:1152
    buffer_load_dwordx2 v[100:101], v8, s[68:71], s13 offen offset:2304
    buffer_load_dwordx2 v[102:103], v8, s[68:71], s13 offen offset:3456
    s_add_u32 s13, s13, 32256
    s_waitcnt vmcnt(14)
    v_perm_b32 v56, v26, v24, s64
    v_perm_b32 v60, v26, v24, s65
    v_perm_b32 v64, v27, v25, s64
    v_perm_b32 v68, v27, v25, s65
    s_waitcnt vmcnt(12)
    v_perm_b32 v57, v30, v28, s64
    v_perm_b32 v61, v30, v28, s65
    v_perm_b32 v65, v31, v29, s64
    v_perm_b32 v69, v31, v29, s65
    s_waitcnt vmcnt(10)
    v_perm_b32 v58, v34, v32, s64
    v_perm_b32 v62, v34, v32, s65
    v_perm_b32 v66, v35, v33, s64
    v_perm_b32 v70, v35, v33, s65
    s_waitcnt vmcnt(8)
    v_perm_b32 v59, v38, v36, s64
    v_perm_b32 v63, v38, v36, s65
    v_perm_b32 v67, v39, v37, s64
    v_perm_b32 v71, v39, v37, s65
    s_waitcnt vmcnt(6)
    v_perm_b32 v24, v90, v88, s64
    v_perm_b32 v28, v90, v88, s65
    v_perm_b32 v32, v91, v89, s64
    v_perm_b32 v36, v91, v89, s65
    s_waitcnt vmcnt(4)
    v_perm_b32 v25, v94, v92, s64
    v_perm_b32 v29, v94, v92, s65
    v_perm_b32 v33, v95, v93, s64
    v_perm_b32 v37, v95, v93, s65
    s_mov_b32 s9, 0
SP_55:
    ds_read_b32 v12, v1 offset:88
    s_waitcnt lgkmcnt(0)
    v_readfirstlane_b32 s8, v12
    s_add_u32 s9, s9, 1
    s_cmp_ge_u32 s8, 4
    s_cbranch_scc1 SP_55_D
    s_cmp_lt_u32 s9, 524288
    s_cbranch_scc1 SP_55
SP_55_D:
    ds_read_b128 v[152:155], v10 offset:0
    ds_read_b128 v[156:159], v10 offset:64
    s_waitcnt lgkmcnt(1)
    v_mfma_f32_16x16x32_bf16 v[120:123], v[56:59], v[152:155], 0
    v_mfma_f32_16x16x32_bf16 v[124:127], v[60:63], v[152:155], 0
    v_mfma_f32_16x16x32_bf16 v[128:131], v[64:67], v[152:155], 0
    v_mfma_f32_16x16x32_bf16 v[132:135], v[68:71], v[152:155], 0
    s_waitcnt lgkmcnt(0)
    s_waitcnt vmcnt(2)
    v_perm_b32 v26, v98, v96, s64
    v_perm_b32 v30, v98, v96, s65
    v_perm_b32 v34, v99, v97, s64
    v_perm_b32 v38, v99, v97, s65
    s_waitcnt vmcnt(0)
    v_perm_b32 v27, v102, v100, s64
    v_perm_b32 v31, v102, v100, s65
    v_perm_b32 v35, v103, v101, s64
    v_perm_b32 v39, v103, v101, s65
    v_mfma_f32_16x16x32_bf16 v[120:123], v[24:27], v[156:159], v[120:123]
    v_mfma_f32_16x16x32_bf16 v[124:127], v[28:31], v[156:159], v[124:127]
    v_mfma_f32_16x16x32_bf16 v[128:131], v[32:35], v[156:159], v[128:131]
    v_mfma_f32_16x16x32_bf16 v[132:135], v[36:39], v[156:159], v[132:135]
    s_nop 4
    v_cndmask_b32 v88, v120, v121, s[56:57]
    v_cndmask_b32 v89, v124, v125, s[56:57]
    v_cndmask_b32 v90, v128, v129, s[56:57]
    v_cndmask_b32 v91, v132, v133, s[56:57]
    v_perm_b32 v88, v88, v17, s60
    v_perm_b32 v89, v89, v17, s61
    v_perm_b32 v90, v90, v17, s62
    v_perm_b32 v91, v91, v17, s63
    s_mov_b32 s12, 0
    buffer_store_dwordx4 v[88:91], v11, s[52:55], s12 offen sc1
    v_cndmask_b32 v92, v122, v123, s[56:57]
    v_cndmask_b32 v93, v126, v127, s[56:57]
    v_cndmask_b32 v94, v130, v131, s[56:57]
    v_cndmask_b32 v95, v134, v135, s[56:57]
    v_perm_b32 v92, v92, v17, s60
    v_perm_b32 v93, v93, v17, s61
    v_perm_b32 v94, v94, v17, s62
    v_perm_b32 v95, v95, v17, s63
    s_mov_b32 s12, 18432
    buffer_store_dwordx4 v[92:95], v11, s[52:55], s12 offen sc1
    s_endpgm
K_END:
    s_endpgm
CODE_END:
.section .rodata,"a"
.p2align 6
.amdhsa_kernel k1_kernel
  .amdhsa_next_free_vgpr 168
  .amdhsa_next_free_sgpr 102
  .amdhsa_accum_offset 168
  .amdhsa_group_segment_fixed_size 0
  .amdhsa_kernarg_size 144
  .amdhsa_user_sgpr_count 2
  .amdhsa_user_sgpr_kernarg_segment_ptr 1
  .amdhsa_system_sgpr_workgroup_id_x 1
.end_amdhsa_kernel
```

```asm
; @launch kernel=k1_kernel grid=(256,1,1) block=(768,1,1) lds=163840
.amdgcn_target "amdgcn-amd-amdhsa--gfx950"
.text
.p2align 8
.globl k1_kernel
.type k1_kernel,@function
k1_kernel:
    v_lshrrev_b32 v1, 6, v0
    s_cmp_ge_u32 s2, 256
    v_readfirstlane_b32 s3, v1
    s_cbranch_scc1 K_END
    v_and_b32 v2, 63, v0
    v_mov_b32 v1, 0
    s_cmp_lg_u32 s3, 1
    s_cbranch_scc1 K_NOZ
    v_lshlrev_b32 v3, 2, v2
    ds_write_b32 v3, v1
    s_waitcnt lgkmcnt(0)
K_NOZ:
    s_load_dwordx16 s[16:31], s[0:1], 0
    s_load_dwordx16 s[32:47], s[0:1], 64
    s_load_dwordx4 s[48:51], s[0:1], 128
    s_lshr_b32 s5, s2, 3
    s_lshl_b32 s8, s3, 8
    s_add_u32 s8, s8, s5
    s_cmp_lg_u32 s8, 9
    s_cbranch_scc1 K_NOCPF
    s_getpc_b64 s[8:9]
    s_and_b32 s8, s8, 0xffffff00
    v_lshlrev_b32 v8, 7, v2
    v_min_u32 v9, CODE_END-k1_kernel-4, v8
    global_load_dword v160, v9, s[8:9]
    v_add_u32 v8, 8192, v8
    v_min_u32 v9, CODE_END-k1_kernel-4, v8
    global_load_dword v161, v9, s[8:9]
    v_add_u32 v8, 8192, v8
    v_min_u32 v9, CODE_END-k1_kernel-4, v8
    global_load_dword v162, v9, s[8:9]
    v_add_u32 v8, 8192, v8
    v_min_u32 v9, CODE_END-k1_kernel-4, v8
    global_load_dword v163, v9, s[8:9]
    v_add_u32 v8, 8192, v8
K_NOCPF:
    v_and_b32 v3, 15, v2
    v_lshrrev_b32 v4, 4, v2
    s_and_b32 s4, s2, 7
    s_barrier
    s_cmp_eq_u32 s3, 8
    s_cbranch_scc1 ROUTER
    s_cmp_lt_u32 s5, 14
    s_cbranch_scc1 K_OTHER
    s_mul_i32 s7, s4, 18
    s_add_u32 s7, s7, s5
    s_sub_u32 s7, s7, 14
    s_cmp_ge_u32 s3, 8
    s_cbranch_scc1 K_CIO
C_KGEN:
    s_and_b32 s12, s3, 3
    s_lshr_b32 s13, s3, 2
    s_lshl_b32 s14, s7, 2
    s_add_u32 s14, s14, s12
    s_lshl_b32 s8, s14, 8
    s_lshl_b32 s9, s13, 7
    s_add_u32 s8, s8, s9
    v_lshl_add_u32 v5, v2, 1, s8
    v_mov_b32 v16, 0
    v_mov_b32 v17, 0
    v_mov_b32 v18, 0
    v_mov_b32 v19, 0
    v_mov_b32 v20, 0
    v_mov_b32 v21, 0
    s_lshl_b32 s55, s7, 3
    s_setprio 2
    s_mul_i32 s15, s3, 4608
    s_add_u32 s15, s15, 256
    s_mul_i32 s52, s12, 4864
    s_add_u32 s52, s52, 37120
    s_mul_i32 s53, s12, 4672
    s_add_u32 s53, s53, 56576
    v_mul_u32_u24 v7, 288, v3
    v_lshl_add_u32 v7, v4, 4, v7
    v_add_u32 v7, s15, v7
    s_mov_b32 m0, s15
    s_waitcnt lgkmcnt(0)
    s_load_dwordx2 s[58:59], s[30:31], s55
    global_load_short_d16_hi v16, v5, s[18:19]
    global_load_short_d16_hi v17, v5, s[20:21]
    global_load_short_d16_hi v18, v5, s[22:23]
    global_load_short_d16_hi v19, v5, s[24:25]
    global_load_short_d16_hi v20, v5, s[26:27]
    global_load_short_d16_hi v21, v5, s[28:29]
    s_load_dwordx2 s[68:69], s[32:33], s55
    s_branch C_KBODY
ROUTER:
    s_setprio 3
    v_lshrrev_b32 v5, 3, v2
    v_and_b32 v6, 7, v2
    v_lshlrev_b32 v9, 4, v6
    v_mul_u32_u24 v8, 1152, v5
    s_mul_i32 s8, s2, 9216
    v_add3_u32 v8, v8, v9, s8
    v_lshlrev_b32 v7, 4, v2
    v_min_u32 v10, 7, v2
    v_lshlrev_b32 v10, 4, v10
    s_mov_b32 m0, 147712
    s_waitcnt lgkmcnt(0)
    s_load_dword s10, s[50:51], 8448
    global_load_dwordx4 v[16:19], v8, s[16:17] offset:0
    global_load_dwordx4 v[52:55], v9, s[36:37] offset:0
    global_load_dwordx4 v[20:23], v8, s[16:17] offset:128
    global_load_dwordx4 v[56:59], v9, s[36:37] offset:128
    global_load_dwordx4 v[24:27], v8, s[16:17] offset:256
    global_load_dwordx4 v[60:63], v9, s[36:37] offset:256
    global_load_dwordx4 v[28:31], v8, s[16:17] offset:384
    global_load_dwordx4 v[64:67], v9, s[36:37] offset:384
    global_load_dwordx4 v[32:35], v8, s[16:17] offset:512
    global_load_dwordx4 v[68:71], v9, s[36:37] offset:512
    global_load_dwordx4 v[36:39], v8, s[16:17] offset:640
    global_load_dwordx4 v[72:75], v9, s[36:37] offset:640
    global_load_dwordx4 v[40:43], v8, s[16:17] offset:768
    global_load_dwordx4 v[76:79], v9, s[36:37] offset:768
    global_load_dwordx4 v[44:47], v8, s[16:17] offset:896
    global_load_dwordx4 v[80:83], v9, s[36:37] offset:896
    global_load_dwordx4 v[48:51], v8, s[16:17] offset:1024
    global_load_dwordx4 v[84:87], v9, s[36:37] offset:1024
    s_mov_b32 m0, 158224
    s_nop 0
    global_load_lds_dwordx4 v7, s[44:45]
    global_load_lds_dwordx4 v10, s[44:45] offset:1024
    v_mov_b32 v11, 1
    ds_write_b32 v1, v11 offset:4
    v_add_u32 v7, 147712, v7
    s_lshl_b32 s8, s2, 5
    v_lshl_add_u32 v15, v4, 3, s8
    s_mov_b32 s11, 0xffff
    v_mov_b32 v8, 0
    v_mov_b32 v9, 0
    v_mov_b32 v10, 0
    v_mov_b32 v11, 0
    s_waitcnt lgkmcnt(0)
    s_add_u32 s10, s10, 1
    s_addc_u32 s10, s10, 0
    v_mov_b32 v14, s10
    v_mov_b32 v13, s10
    s_waitcnt vmcnt(18)
    v_dot2c_f32_bf16 v8, v16, v52
    v_dot2c_f32_bf16 v9, v17, v53
    v_dot2c_f32_bf16 v10, v18, v54
    v_dot2c_f32_bf16 v11, v19, v55
    s_waitcnt vmcnt(16)
    v_dot2c_f32_bf16 v8, v20, v56
    v_dot2c_f32_bf16 v9, v21, v57
    v_dot2c_f32_bf16 v10, v22, v58
    v_dot2c_f32_bf16 v11, v23, v59
    s_waitcnt vmcnt(14)
    v_dot2c_f32_bf16 v8, v24, v60
    v_dot2c_f32_bf16 v9, v25, v61
    v_dot2c_f32_bf16 v10, v26, v62
    v_dot2c_f32_bf16 v11, v27, v63
    s_waitcnt vmcnt(12)
    v_dot2c_f32_bf16 v8, v28, v64
    v_dot2c_f32_bf16 v9, v29, v65
    v_dot2c_f32_bf16 v10, v30, v66
    v_dot2c_f32_bf16 v11, v31, v67
    s_waitcnt vmcnt(10)
    v_dot2c_f32_bf16 v8, v32, v68
    v_dot2c_f32_bf16 v9, v33, v69
    v_dot2c_f32_bf16 v10, v34, v70
    v_dot2c_f32_bf16 v11, v35, v71
    s_waitcnt vmcnt(8)
    v_dot2c_f32_bf16 v8, v36, v72
    v_dot2c_f32_bf16 v9, v37, v73
    v_dot2c_f32_bf16 v10, v38, v74
    v_dot2c_f32_bf16 v11, v39, v75
    s_waitcnt vmcnt(6)
    v_dot2c_f32_bf16 v8, v40, v76
    v_dot2c_f32_bf16 v9, v41, v77
    v_dot2c_f32_bf16 v10, v42, v78
    v_dot2c_f32_bf16 v11, v43, v79
    s_waitcnt vmcnt(4)
    v_dot2c_f32_bf16 v8, v44, v80
    v_dot2c_f32_bf16 v9, v45, v81
    v_dot2c_f32_bf16 v10, v46, v82
    v_dot2c_f32_bf16 v11, v47, v83
    s_waitcnt vmcnt(2)
    v_dot2c_f32_bf16 v8, v48, v84
    v_dot2c_f32_bf16 v9, v49, v85
    v_dot2c_f32_bf16 v10, v50, v86
    v_dot2c_f32_bf16 v11, v51, v87
    s_nop 0
    v_add_f32 v8, v8, v9
    s_nop 0
    v_add_f32 v10, v10, v11
    v_add_f32 v8, v8, v10
    s_nop 1
    v_add_f32_dpp v8, v8, v8 quad_perm:[1,0,3,2] row_mask:0xf bank_mask:0xf
    s_nop 1
    v_add_f32_dpp v8, v8, v8 quad_perm:[2,3,0,1] row_mask:0xf bank_mask:0xf
    s_nop 1
    v_add_f32_dpp v8, v8, v8 row_half_mirror row_mask:0xf bank_mask:0xf
    v_cvt_pk_bf16_f32 v8, v8, v8
    v_ashrrev_i32 v9, 31, v8
    v_or_b32 v9, 0x80008000, v9
    v_xor_b32 v8, v8, v9
    s_nop 1
    v_mov_b32_dpp v9, v8 row_ror:8 row_mask:0xf bank_mask:0xf
    s_mov_b32 exec_lo, 0x10001
    s_mov_b32 exec_hi, 0x10001
    v_bfi_b32 v12, s11, v8, v9
    global_store_dwordx2 v15, v[12:13], s[50:51] sc1
    s_mov_b64 exec, -1
    ds_write_b32 v1, v14 offset:0
    s_setprio 0
    ds_write_b128 v7, v[16:19] offset:0
    ds_write_b128 v7, v[20:23] offset:1024
    ds_write_b128 v7, v[24:27] offset:2048
    ds_write_b128 v7, v[28:31] offset:3072
    ds_write_b128 v7, v[32:35] offset:4096
    ds_write_b128 v7, v[36:39] offset:5120
    ds_write_b128 v7, v[40:43] offset:6144
    ds_write_b128 v7, v[44:47] offset:7168
    ds_write_b128 v7, v[48:51] offset:8192
    s_waitcnt vmcnt(1)
    ds_write_b32 v1, v14 offset:8
    s_cmp_ge_u32 s5, 14
    s_cbranch_scc1 C_IO
    s_cmp_lt_u32 s5, 9
    s_cbranch_scc1 SELECT
    s_endpgm
K_OTHER:
    s_mul_i32 s7, s4, 9
    s_add_u32 s7, s7, s5
    s_mov_b32 s12, s3
    s_cmp_lt_u32 s3, 2
    s_cbranch_scc1 GATE
    s_cmp_ge_u32 s5, 9
    s_cbranch_scc1 HELPER
    s_cmp_lt_u32 s3, 8
    s_cbranch_scc1 F_COMP
F_LOAD:
    s_setprio 3
    s_sub_u32 s12, s3, 9
    v_lshrrev_b32 v5, 3, v2
    v_bfe_u32 v6, v2, 4, 1
    v_xor_b32 v6, v6, v2
    v_and_b32 v6, 7, v6
    s_movk_i32 s8, 9216
    v_mul_lo_u32 v7, v5, s8
    v_lshl_add_u32 v8, v6, 4, v7
    v_xor_b32 v9, 32, v8
    v_xor_b32 v10, 64, v8
    v_xor_b32 v11, 96, v8
    v_bfe_u32 v6, v2, 4, 1
    v_lshlrev_b32 v6, 1, v6
    v_xor_b32 v6, v6, v2
    v_and_b32 v6, 7, v6
    v_mul_u32_u24 v7, 1152, v5
    v_lshl_add_u32 v12, v6, 4, v7
    v_xor_b32 v13, 64, v12
    s_mul_i32 s13, s12, 294912
    s_lshl_b32 s8, s7, 7
    s_add_u32 s13, s13, s8
    s_lshl_b32 s15, s12, 13
    s_add_u32 s15, s15, 256
    s_mul_i32 s14, s12, 24576
    s_add_u32 s14, s14, 73984
    s_mul_i32 s11, s7, 73728
    s_mul_i32 s8, s12, 384
    s_add_u32 s11, s11, s8
    s_waitcnt lgkmcnt(0)
    s_mov_b32 s52, s38
    s_mov_b32 s53, s39
    s_mov_b32 s54, 5308416
    s_mov_b32 s55, 0x20000
    s_mov_b32 s56, s40
    s_mov_b32 s57, s41
    s_mov_b32 s58, 5308416
    s_mov_b32 s59, 0x20000
    s_mov_b32 s60, s42
    s_mov_b32 s61, s43
    s_mov_b32 s62, 5308416
    s_mov_b32 s63, 0x20000
    s_mov_b32 s9, 0
SP_1:
    ds_read_b32 v14, v1 offset:4
    s_waitcnt lgkmcnt(0)
    v_readfirstlane_b32 s8, v14
    s_add_u32 s9, s9, 1
    s_cmp_ge_u32 s8, 1
    s_cbranch_scc1 SP_1_D
    s_cmp_lt_u32 s9, 524288
    s_cbranch_scc1 SP_1
SP_1_D:
    s_add_u32 m0, s15, 0
    s_nop 0
    buffer_load_dwordx4 v8, s[52:55], s13 offen  lds
    s_add_u32 m0, s15, 1024
    s_nop 0
    buffer_load_dwordx4 v10, s[56:59], s13 offen  lds
    s_add_u32 s13, s13, 73728
    s_add_u32 m0, s15, 2048
    s_nop 0
    buffer_load_dwordx4 v9, s[52:55], s13 offen  lds
    s_add_u32 m0, s15, 3072
    s_nop 0
    buffer_load_dwordx4 v11, s[56:59], s13 offen  lds
    s_add_u32 s13, s13, 73728
    s_add_u32 m0, s15, 4096
    s_nop 0
    buffer_load_dwordx4 v8, s[52:55], s13 offen  lds
    s_add_u32 m0, s15, 5120
    s_nop 0
    buffer_load_dwordx4 v10, s[56:59], s13 offen  lds
    s_add_u32 s13, s13, 73728
    s_add_u32 m0, s15, 6144
    s_nop 0
    buffer_load_dwordx4 v9, s[52:55], s13 offen  lds
    s_add_u32 m0, s15, 7168
    s_nop 0
    buffer_load_dwordx4 v11, s[56:59], s13 offen  lds
    s_add_u32 s13, s13, 663552
    s_add_u32 m0, s15, 24576
    s_nop 0
    buffer_load_dwordx4 v8, s[52:55], s13 offen  lds
    s_add_u32 m0, s15, 25600
    s_nop 0
    buffer_load_dwordx4 v10, s[56:59], s13 offen  lds
    s_add_u32 s13, s13, 73728
    s_waitcnt vmcnt(9)
    s_add_u32 m0, s15, 26624
    s_nop 0
    buffer_load_dwordx4 v9, s[52:55], s13 offen  lds
    s_waitcnt vmcnt(9)
    s_add_u32 m0, s15, 27648
    s_nop 0
    buffer_load_dwordx4 v11, s[56:59], s13 offen  lds
    s_add_u32 s13, s13, 73728
    s_waitcnt vmcnt(9)
    s_add_u32 m0, s15, 28672
    s_nop 0
    buffer_load_dwordx4 v8, s[52:55], s13 offen  lds
    s_waitcnt vmcnt(9)
    s_add_u32 m0, s15, 29696
    s_nop 0
    buffer_load_dwordx4 v10, s[56:59], s13 offen  lds
    s_add_u32 s13, s13, 73728
    s_waitcnt vmcnt(9)
    s_add_u32 m0, s15, 30720
    s_nop 0
    buffer_load_dwordx4 v9, s[52:55], s13 offen  lds
    s_waitcnt vmcnt(9)
    s_add_u32 m0, s15, 31744
    s_nop 0
    buffer_load_dwordx4 v11, s[56:59], s13 offen  lds
    s_add_u32 s13, s13, 663552
    s_waitcnt vmcnt(9)
    s_add_u32 m0, s15, 49152
    s_nop 0
    buffer_load_dwordx4 v8, s[52:55], s13 offen  lds
    s_waitcnt vmcnt(9)
    v_mov_b32 v14, 1
    s_mov_b64 exec, 1
    ds_add_u32 v1, v14 offset:16
    s_mov_b64 exec, -1
    s_add_u32 m0, s15, 50176
    s_nop 0
    buffer_load_dwordx4 v10, s[56:59], s13 offen  lds
    s_add_u32 s13, s13, 73728
    s_waitcnt vmcnt(9)
    s_add_u32 m0, s15, 51200
    s_nop 0
    buffer_load_dwordx4 v9, s[52:55], s13 offen  lds
    s_waitcnt vmcnt(9)
    s_add_u32 m0, s15, 52224
    s_nop 0
    buffer_load_dwordx4 v11, s[56:59], s13 offen  lds
    s_add_u32 s13, s13, 73728
    s_waitcnt vmcnt(9)
    s_add_u32 m0, s15, 53248
    s_nop 0
    buffer_load_dwordx4 v8, s[52:55], s13 offen  lds
    s_waitcnt vmcnt(9)
    s_add_u32 m0, s15, 54272
    s_nop 0
    buffer_load_dwordx4 v10, s[56:59], s13 offen  lds
    s_add_u32 s13, s13, 73728
    s_waitcnt vmcnt(9)
    s_add_u32 m0, s15, 55296
    s_nop 0
    buffer_load_dwordx4 v9, s[52:55], s13 offen  lds
    s_waitcnt vmcnt(9)
    s_add_u32 m0, s15, 56320
    s_nop 0
    buffer_load_dwordx4 v11, s[56:59], s13 offen  lds
    s_add_u32 s13, s13, 663552
    s_mov_b32 s9, 0
SP_2:
    ds_read_b32 v14, v1 offset:48
    s_waitcnt lgkmcnt(0)
    v_readfirstlane_b32 s8, v14
    s_add_u32 s9, s9, 1
    s_cmp_ge_u32 s8, 4
    s_cbranch_scc1 SP_2_D
    s_cmp_lt_u32 s9, 524288
    s_cbranch_scc1 SP_2
SP_2_D:
    s_waitcnt vmcnt(9)
    s_add_u32 m0, s15, 0
    s_nop 0
    buffer_load_dwordx4 v8, s[52:55], s13 offen  lds
    s_waitcnt vmcnt(9)
    v_mov_b32 v14, 1
    s_mov_b64 exec, 1
    ds_add_u32 v1, v14 offset:20
    s_mov_b64 exec, -1
    s_add_u32 m0, s15, 1024
    s_nop 0
    buffer_load_dwordx4 v10, s[56:59], s13 offen  lds
    s_add_u32 s13, s13, 73728
    s_waitcnt vmcnt(9)
    s_add_u32 m0, s15, 2048
    s_nop 0
    buffer_load_dwordx4 v9, s[52:55], s13 offen  lds
    s_waitcnt vmcnt(9)
    s_add_u32 m0, s15, 3072
    s_nop 0
    buffer_load_dwordx4 v11, s[56:59], s13 offen  lds
    s_add_u32 s13, s13, 73728
    s_waitcnt vmcnt(9)
    s_add_u32 m0, s15, 4096
    s_nop 0
    buffer_load_dwordx4 v8, s[52:55], s13 offen  lds
    s_waitcnt vmcnt(9)
    s_add_u32 m0, s15, 5120
    s_nop 0
    buffer_load_dwordx4 v10, s[56:59], s13 offen  lds
    s_add_u32 s13, s13, 73728
    s_waitcnt vmcnt(9)
    s_add_u32 m0, s15, 6144
    s_nop 0
    buffer_load_dwordx4 v9, s[52:55], s13 offen  lds
    s_waitcnt vmcnt(9)
    s_add_u32 m0, s15, 7168
    s_nop 0
    buffer_load_dwordx4 v11, s[56:59], s13 offen  lds
    s_add_u32 s13, s13, 663552
    s_mov_b32 s9, 0
SP_3:
    ds_read_b32 v14, v1 offset:52
    s_waitcnt lgkmcnt(0)
    v_readfirstlane_b32 s8, v14
    s_add_u32 s9, s9, 1
    s_cmp_ge_u32 s8, 4
    s_cbranch_scc1 SP_3_D
    s_cmp_lt_u32 s9, 524288
    s_cbranch_scc1 SP_3
SP_3_D:
    s_waitcnt vmcnt(9)
    s_add_u32 m0, s15, 24576
    s_nop 0
    buffer_load_dwordx4 v8, s[52:55], s13 offen  lds
    s_waitcnt vmcnt(9)
    v_mov_b32 v14, 1
    s_mov_b64 exec, 1
    ds_add_u32 v1, v14 offset:24
    s_mov_b64 exec, -1
    s_add_u32 m0, s15, 25600
    s_nop 0
    buffer_load_dwordx4 v10, s[56:59], s13 offen  lds
    s_add_u32 s13, s13, 73728
    s_waitcnt vmcnt(9)
    s_add_u32 m0, s15, 26624
    s_nop 0
    buffer_load_dwordx4 v9, s[52:55], s13 offen  lds
    s_waitcnt vmcnt(9)
    s_add_u32 m0, s15, 27648
    s_nop 0
    buffer_load_dwordx4 v11, s[56:59], s13 offen  lds
    s_add_u32 s13, s13, 73728
    s_waitcnt vmcnt(9)
    s_add_u32 m0, s15, 28672
    s_nop 0
    buffer_load_dwordx4 v8, s[52:55], s13 offen  lds
    s_waitcnt vmcnt(9)
    s_add_u32 m0, s15, 29696
    s_nop 0
    buffer_load_dwordx4 v10, s[56:59], s13 offen  lds
    s_add_u32 s13, s13, 73728
    s_waitcnt vmcnt(9)
    s_add_u32 m0, s15, 30720
    s_nop 0
    buffer_load_dwordx4 v9, s[52:55], s13 offen  lds
    s_waitcnt vmcnt(9)
    s_add_u32 m0, s15, 31744
    s_nop 0
    buffer_load_dwordx4 v11, s[56:59], s13 offen  lds
    s_add_u32 s13, s13, 663552
    s_mov_b32 s9, 0
SP_4:
    ds_read_b32 v14, v1 offset:56
    s_waitcnt lgkmcnt(0)
    v_readfirstlane_b32 s8, v14
    s_add_u32 s9, s9, 1
    s_cmp_ge_u32 s8, 4
    s_cbranch_scc1 SP_4_D
    s_cmp_lt_u32 s9, 524288
    s_cbranch_scc1 SP_4
SP_4_D:
    s_waitcnt vmcnt(9)
    s_add_u32 m0, s15, 49152
    s_nop 0
    buffer_load_dwordx4 v8, s[52:55], s13 offen  lds
    s_waitcnt vmcnt(9)
    v_mov_b32 v14, 1
    s_mov_b64 exec, 1
    ds_add_u32 v1, v14 offset:28
    s_mov_b64 exec, -1
    s_add_u32 m0, s15, 50176
    s_nop 0
    buffer_load_dwordx4 v10, s[56:59], s13 offen  lds
    s_add_u32 s13, s13, 73728
    s_waitcnt vmcnt(9)
    s_add_u32 m0, s15, 51200
    s_nop 0
    buffer_load_dwordx4 v9, s[52:55], s13 offen  lds
    s_waitcnt vmcnt(9)
    s_add_u32 m0, s15, 52224
    s_nop 0
    buffer_load_dwordx4 v11, s[56:59], s13 offen  lds
    s_add_u32 s13, s13, 73728
    s_waitcnt vmcnt(9)
    s_add_u32 m0, s15, 53248
    s_nop 0
    buffer_load_dwordx4 v8, s[52:55], s13 offen  lds
    s_waitcnt vmcnt(9)
    s_add_u32 m0, s15, 54272
    s_nop 0
    buffer_load_dwordx4 v10, s[56:59], s13 offen  lds
    s_add_u32 s13, s13, 73728
    s_waitcnt vmcnt(9)
    s_add_u32 m0, s15, 55296
    s_nop 0
    buffer_load_dwordx4 v9, s[52:55], s13 offen  lds
    s_waitcnt vmcnt(9)
    s_add_u32 m0, s15, 56320
    s_nop 0
    buffer_load_dwordx4 v11, s[56:59], s13 offen  lds
    s_add_u32 s13, s13, 663552
    v_mov_b32 v14, 1
    s_mov_b64 exec, 1
    ds_add_u32 v1, v14 offset:40
    s_mov_b64 exec, -1
    s_waitcnt vmcnt(8)
    v_mov_b32 v14, 1
    s_mov_b64 exec, 1
    ds_add_u32 v1, v14 offset:32
    s_mov_b64 exec, -1
    s_waitcnt vmcnt(0)
    v_mov_b32 v14, 1
    s_mov_b64 exec, 1
    ds_add_u32 v1, v14 offset:36
    s_mov_b64 exec, -1
    s_cmp_eq_u32 s3, 9
    s_cbranch_scc1 F_COMP2
    s_endpgm
K_CIO:
    s_sub_u32 s12, s3, 9
    s_cmp_eq_u32 s3, 11
    s_cbranch_scc1 C_LOAD
    v_lshl_add_u32 v14, v4, 3, v3
    v_sub_u32 v14, 39, v14
    s_lshl_b32 s8, s12, 11
    s_add_u32 s8, s8, 100096
    v_lshl_add_u32 v15, v2, 4, s8
    s_cmp_eq_u32 s12, 0
    s_cselect_b32 s8, 127, 7
    s_cselect_b32 s9, 19, 21
    s_movk_i32 s11, 0x3f80
    s_lshl_b32 s13, s11, 16
    v_mov_b32 v10, s8
    v_mov_b32 v11, 0
    v_lshlrev_b64 v[10:11], v14, v[10:11]
    v_alignbit_b32 v10, v11, v10, s9
    v_bfe_i32 v11, v10, 0, 1
    v_bfe_i32 v12, v10, 1, 1
    v_and_b32 v11, s11, v11
    v_and_or_b32 v16, v12, s13, v11
    v_bfe_i32 v11, v10, 2, 1
    v_bfe_i32 v12, v10, 3, 1
    v_and_b32 v11, s11, v11
    v_and_or_b32 v17, v12, s13, v11
    v_bfe_i32 v11, v10, 4, 1
    v_bfe_i32 v12, v10, 5, 1
    v_and_b32 v11, s11, v11
    v_and_or_b32 v18, v12, s13, v11
    v_bfe_i32 v11, v10, 6, 1
    v_bfe_i32 v12, v10, 7, 1
    v_and_b32 v11, s11, v11
    v_and_or_b32 v19, v12, s13, v11
    ds_write_b128 v15, v[16:19] offset:0
    s_cmp_eq_u32 s12, 0
    s_cselect_b32 s8, 511, 31
    s_cselect_b32 s9, 20, 18
    s_movk_i32 s11, 0x3f80
    s_lshl_b32 s13, s11, 16
    v_mov_b32 v10, s8
    v_mov_b32 v11, 0
    v_lshlrev_b64 v[10:11], v14, v[10:11]
    v_alignbit_b32 v10, v11, v10, s9
    v_bfe_i32 v11, v10, 0, 1
    v_bfe_i32 v12, v10, 1, 1
    v_and_b32 v11, s11, v11
    v_and_or_b32 v20, v12, s13, v11
    v_bfe_i32 v11, v10, 2, 1
    v_bfe_i32 v12, v10, 3, 1
    v_and_b32 v11, s11, v11
    v_and_or_b32 v21, v12, s13, v11
    v_bfe_i32 v11, v10, 4, 1
    v_bfe_i32 v12, v10, 5, 1
    v_and_b32 v11, s11, v11
    v_and_or_b32 v22, v12, s13, v11
    v_bfe_i32 v11, v10, 6, 1
    v_bfe_i32 v12, v10, 7, 1
    v_and_b32 v11, s11, v11
    v_and_or_b32 v23, v12, s13, v11
    ds_write_b128 v15, v[20:23] offset:1024
    s_cmp_eq_u32 s12, 0
    s_cselect_b32 s8, 7, 3
    s_cselect_b32 s9, 21, 21
    s_movk_i32 s11, 0x3f80
    s_cselect_b32 s11, s11, 0xffff
    s_lshl_b32 s13, s11, 16
    v_mov_b32 v10, s8
    v_mov_b32 v11, 0
    v_lshlrev_b64 v[10:11], v14, v[10:11]
    v_alignbit_b32 v10, v11, v10, s9
    v_bfe_i32 v11, v10, 0, 1
    v_bfe_i32 v12, v10, 1, 1
    v_and_b32 v11, s11, v11
    v_and_or_b32 v24, v12, s13, v11
    v_bfe_i32 v11, v10, 2, 1
    v_bfe_i32 v12, v10, 3, 1
    v_and_b32 v11, s11, v11
    v_and_or_b32 v25, v12, s13, v11
    v_bfe_i32 v11, v10, 4, 1
    v_bfe_i32 v12, v10, 5, 1
    v_and_b32 v11, s11, v11
    v_and_or_b32 v26, v12, s13, v11
    v_bfe_i32 v11, v10, 6, 1
    v_bfe_i32 v12, v10, 7, 1
    v_and_b32 v11, s11, v11
    v_and_or_b32 v27, v12, s13, v11
    ds_write_b128 v15, v[24:27] offset:2048
    v_mov_b32 v10, 1
    s_mov_b64 exec, 1
    ds_add_u32 v1, v10 offset:32
    s_mov_b64 exec, -1
    s_branch GATE
C_LOAD:
    s_setprio 3
    s_sub_u32 s13, s5, 14
    s_mov_b32 s8, s13
    s_mul_i32 s8, s8, 73728
    s_lshl_b32 s9, s4, 7
    s_add_u32 s8, s8, s9
    v_mul_u32_u24 v9, 1152, v2
    v_add_u32 v9, s8, v9
    s_add_u32 s8, s13, 18
    s_min_u32 s8, s8, 31
    s_sub_u32 s8, s8, s13
    s_mul_i32 s8, s8, 73728
    v_add_u32 v8, s8, v9
    v_mul_u32_u24 v6, 4608, v2
    s_lshl_b32 s8, s7, 3
    v_add_u32 v6, s8, v6
    v_lshlrev_b32 v7, 3, v2
    v_sub_u32 v7, 57080, v7
    s_mov_b32 s56, 0x05040100
    s_mov_b32 s58, 0x07060302
    s_mov_b32 s57, s13
    s_waitcnt lgkmcnt(0)
    s_mov_b32 s72, s16
    s_mov_b32 s73, s17
    s_mov_b32 s74, 2359296
    s_mov_b32 s75, 0x20000
    s_mov_b32 s9, 0
SP_5:
    ds_read_b32 v12, v1 offset:4
    s_waitcnt lgkmcnt(0)
    v_readfirstlane_b32 s8, v12
    s_add_u32 s9, s9, 1
    s_cmp_ge_u32 s8, 1
    s_cbranch_scc1 SP_5_D
    s_cmp_lt_u32 s9, 524288
    s_cbranch_scc1 SP_5
SP_5_D:
    global_load_dword v10, v9, s[16:17]
    global_load_dword v11, v9, s[16:17] offset:128
    global_load_dword v10, v8, s[16:17]
    global_load_dword v11, v8, s[16:17] offset:128
    s_mul_i32 s7, s4, 18
    s_add_u32 s7, s7, s5
    s_sub_u32 s7, s7, 14
    s_lshl_b32 s55, s7, 3
    s_sub_u32 s12, s3, 8
    s_mov_b32 s60, s46
    s_mov_b32 s61, s47
    s_mov_b32 s62, 2359296
    s_mov_b32 s63, 0x20000
    v_bfe_u32 v79, v2, 2, 2
    v_and_b32 v80, 3, v2
    v_lshl_add_u32 v80, v4, 2, v80
    s_lshl_b32 s8, s12, 7
    v_mul_u32_u24 v72, 4672, v79
    v_lshl_add_u32 v72, v80, 3, v72
    s_sub_u32 s9, 56960, s8
    v_add_u32 v72, s9, v72
    v_mul_u32_u24 v73, 4160, v79
    v_lshl_add_u32 v73, v80, 3, v73
    s_sub_u32 s9, 83840, s8
    v_add_u32 v73, s9, v73
    v_xor_b32 v79, 63, v2
    s_lshl_b32 s8, s12, 9
    s_add_u32 s8, s8, 16384
    v_lshl_add_u32 v74, v79, 3, s8
    v_add_u32 v75, 4096, v74
    v_add_u32 v76, 8192, v74
    v_add_u32 v77, 12288, v74
    v_mul_u32_u24 v78, 1152, v79
    v_add_u32 v78, s55, v78
    s_mul_i32 s68, s12, 73728
    s_mov_b32 s70, 0x05040100
    s_mov_b32 s71, 0x07060302
    s_sub_u32 s9, s5, 14
    s_mul_i32 s9, s9, 3
    s_min_u32 s8, s12, 2
    s_add_u32 s9, s9, s8
    s_mul_i32 s9, s9, 12288
    s_mul_i32 s8, s4, 663552
    s_add_u32 s8, s8, s9
    v_lshl_add_u32 v88, v2, 7, s8
    v_min_u32 v89, 31, v2
    v_lshl_add_u32 v89, v89, 7, s8
    v_add_u32 v89, 8192, v89
    v_mov_b32 v24, 0
    v_mov_b32 v25, 0
    v_mov_b32 v26, 0
    v_mov_b32 v27, 0
    v_lshrrev_b32 v28, 2, v2
    v_mul_u32_u24 v28, 1216, v28
    v_add_u32 v28, 37120, v28
    v_and_b32 v29, 3, v2
    v_lshl_add_u32 v30, v29, 4, v28
    ds_write_b128 v30, v[24:27] offset:1072
    v_and_b32 v29, 1, v2
    v_lshl_add_u32 v30, v29, 4, v28
    ds_write_b128 v30, v[24:27]
    v_lshrrev_b32 v28, 5, v2
    v_mul_u32_u24 v28, 4672, v28
    v_and_b32 v29, 31, v2
    v_lshl_add_u32 v30, v29, 4, v28
    v_add_u32 v30, 60672, v30
    ds_write_b128 v30, v[24:27]
    ds_write_b128 v30, v[24:27] offset:9344
    s_mov_b32 s15, 0
    v_mov_b32 v12, 1
    s_waitcnt vmcnt(2)
    buffer_load_dwordx2 v[104:105], v6, s[72:75], s15 offen offset:0
    buffer_load_dwordx2 v[106:107], v6, s[72:75], s15 offen offset:1152
    buffer_load_dwordx2 v[108:109], v6, s[72:75], s15 offen offset:2304
    buffer_load_dwordx2 v[110:111], v6, s[72:75], s15 offen offset:3456
    s_add_u32 s15, s15, 294912
    buffer_load_dwordx2 v[112:113], v6, s[72:75], s15 offen offset:0
    buffer_load_dwordx2 v[114:115], v6, s[72:75], s15 offen offset:1152
    s_waitcnt vmcnt(5)
    buffer_load_dwordx2 v[116:117], v6, s[72:75], s15 offen offset:2304
    s_waitcnt vmcnt(5)
    buffer_load_dwordx2 v[118:119], v6, s[72:75], s15 offen offset:3456
    s_add_u32 s15, s15, 294912
    s_waitcnt vmcnt(5)
    buffer_load_dwordx2 v[120:121], v6, s[72:75], s15 offen offset:0
    s_waitcnt vmcnt(5)
    buffer_load_dwordx2 v[122:123], v6, s[72:75], s15 offen offset:1152
    v_perm_b32 v16, v108, v110, s56
    v_perm_b32 v17, v104, v106, s56
    ds_write_b64 v7, v[16:17] offset:3584
    v_perm_b32 v18, v108, v110, s58
    v_perm_b32 v19, v104, v106, s58
    ds_write_b64 v7, v[18:19] offset:8256
    v_perm_b32 v20, v109, v111, s56
    v_perm_b32 v21, v105, v107, s56
    ds_write_b64 v7, v[20:21] offset:12928
    v_perm_b32 v22, v109, v111, s58
    v_perm_b32 v23, v105, v107, s58
    ds_write_b64 v7, v[22:23] offset:17600
    v_mov_b32 v36, 1
    ds_write_b32 v1, v36 offset:80
    s_waitcnt vmcnt(5)
    buffer_load_dwordx2 v[124:125], v6, s[72:75], s15 offen offset:2304
    s_waitcnt vmcnt(5)
    buffer_load_dwordx2 v[126:127], v6, s[72:75], s15 offen offset:3456
    s_add_u32 s15, s15, 294912
    s_waitcnt vmcnt(5)
    buffer_load_dwordx2 v[128:129], v6, s[72:75], s15 offen offset:0
    s_waitcnt vmcnt(5)
    buffer_load_dwordx2 v[130:131], v6, s[72:75], s15 offen offset:1152
    v_perm_b32 v24, v116, v118, s56
    v_perm_b32 v25, v112, v114, s56
    ds_write_b64 v7, v[24:25] offset:3072
    v_perm_b32 v26, v116, v118, s58
    v_perm_b32 v27, v112, v114, s58
    ds_write_b64 v7, v[26:27] offset:7744
    v_perm_b32 v28, v117, v119, s56
    v_perm_b32 v29, v113, v115, s56
    ds_write_b64 v7, v[28:29] offset:12416
    v_perm_b32 v30, v117, v119, s58
    v_perm_b32 v31, v113, v115, s58
    ds_write_b64 v7, v[30:31] offset:17088
    v_mov_b32 v36, 2
    ds_write_b32 v1, v36 offset:80
    s_waitcnt vmcnt(5)
    buffer_load_dwordx2 v[132:133], v6, s[72:75], s15 offen offset:2304
    s_waitcnt vmcnt(5)
    buffer_load_dwordx2 v[134:135], v6, s[72:75], s15 offen offset:3456
    s_add_u32 s15, s15, 294912
    s_waitcnt vmcnt(5)
    buffer_load_dwordx2 v[136:137], v6, s[72:75], s15 offen offset:0
    s_waitcnt vmcnt(5)
    buffer_load_dwordx2 v[138:139], v6, s[72:75], s15 offen offset:1152
    v_perm_b32 v16, v124, v126, s56
    v_perm_b32 v17, v120, v122, s56
    ds_write_b64 v7, v[16:17] offset:2560
    v_perm_b32 v18, v124, v126, s58
    v_perm_b32 v19, v120, v122, s58
    ds_write_b64 v7, v[18:19] offset:7232
    v_perm_b32 v20, v125, v127, s56
    v_perm_b32 v21, v121, v123, s56
    ds_write_b64 v7, v[20:21] offset:11904
    v_perm_b32 v22, v125, v127, s58
    v_perm_b32 v23, v121, v123, s58
    ds_write_b64 v7, v[22:23] offset:16576
    v_mov_b32 v36, 3
    ds_write_b32 v1, v36 offset:80
    s_waitcnt vmcnt(5)
    buffer_load_dwordx2 v[140:141], v6, s[72:75], s15 offen offset:2304
    s_waitcnt vmcnt(5)
    buffer_load_dwordx2 v[142:143], v6, s[72:75], s15 offen offset:3456
    s_add_u32 s15, s15, 294912
    s_waitcnt vmcnt(5)
    buffer_load_dwordx2 v[144:145], v6, s[72:75], s15 offen offset:0
    s_waitcnt vmcnt(5)
    buffer_load_dwordx2 v[146:147], v6, s[72:75], s15 offen offset:1152
    v_perm_b32 v24, v132, v134, s56
    v_perm_b32 v25, v128, v130, s56
    ds_write_b64 v7, v[24:25] offset:2048
    v_perm_b32 v26, v132, v134, s58
    v_perm_b32 v27, v128, v130, s58
    ds_write_b64 v7, v[26:27] offset:6720
    v_perm_b32 v28, v133, v135, s56
    v_perm_b32 v29, v129, v131, s56
    ds_write_b64 v7, v[28:29] offset:11392
    v_perm_b32 v30, v133, v135, s58
    v_perm_b32 v31, v129, v131, s58
    ds_write_b64 v7, v[30:31] offset:16064
    v_mov_b32 v36, 4
    ds_write_b32 v1, v36 offset:80
    s_waitcnt vmcnt(5)
    buffer_load_dwordx2 v[148:149], v6, s[72:75], s15 offen offset:2304
    s_waitcnt vmcnt(5)
    buffer_load_dwordx2 v[150:151], v6, s[72:75], s15 offen offset:3456
    s_add_u32 s15, s15, 294912
    s_waitcnt vmcnt(5)
    buffer_load_dwordx2 v[152:153], v6, s[72:75], s15 offen offset:0
    s_waitcnt vmcnt(5)
    buffer_load_dwordx2 v[154:155], v6, s[72:75], s15 offen offset:1152
    v_perm_b32 v16, v140, v142, s56
    v_perm_b32 v17, v136, v138, s56
    ds_write_b64 v7, v[16:17] offset:1536
    v_perm_b32 v18, v140, v142, s58
    v_perm_b32 v19, v136, v138, s58
    ds_write_b64 v7, v[18:19] offset:6208
    v_perm_b32 v20, v141, v143, s56
    v_perm_b32 v21, v137, v139, s56
    ds_write_b64 v7, v[20:21] offset:10880
    v_perm_b32 v22, v141, v143, s58
    v_perm_b32 v23, v137, v139, s58
    ds_write_b64 v7, v[22:23] offset:15552
    v_mov_b32 v36, 5
    ds_write_b32 v1, v36 offset:80
    s_waitcnt vmcnt(5)
    buffer_load_dwordx2 v[156:157], v6, s[72:75], s15 offen offset:2304
    s_waitcnt vmcnt(5)
    buffer_load_dwordx2 v[158:159], v6, s[72:75], s15 offen offset:3456
    s_add_u32 s15, s15, 294912
    s_waitcnt vmcnt(5)
    buffer_load_dwordx2 v[160:161], v6, s[72:75], s15 offen offset:0
    s_waitcnt vmcnt(5)
    buffer_load_dwordx2 v[162:163], v6, s[72:75], s15 offen offset:1152
    v_perm_b32 v24, v148, v150, s56
    v_perm_b32 v25, v144, v146, s56
    ds_write_b64 v7, v[24:25] offset:1024
    v_perm_b32 v26, v148, v150, s58
    v_perm_b32 v27, v144, v146, s58
    ds_write_b64 v7, v[26:27] offset:5696
    v_perm_b32 v28, v149, v151, s56
    v_perm_b32 v29, v145, v147, s56
    ds_write_b64 v7, v[28:29] offset:10368
    v_perm_b32 v30, v149, v151, s58
    v_perm_b32 v31, v145, v147, s58
    ds_write_b64 v7, v[30:31] offset:15040
    v_mov_b32 v36, 6
    ds_write_b32 v1, v36 offset:80
    s_waitcnt vmcnt(5)
    buffer_load_dwordx2 v[164:165], v6, s[72:75], s15 offen offset:2304
    s_waitcnt vmcnt(5)
    buffer_load_dwordx2 v[166:167], v6, s[72:75], s15 offen offset:3456
    s_add_u32 s15, s15, 294912
    ds_write_b32 v1, v12 offset:88
    global_load_dwordx2 v[56:57], v74, s[50:51] offset:0 sc1
    global_load_dwordx2 v[58:59], v74, s[50:51] offset:2048 sc1
    global_load_dwordx2 v[60:61], v75, s[50:51] offset:0 sc1
    global_load_dwordx2 v[62:63], v75, s[50:51] offset:2048 sc1
    global_load_dwordx2 v[64:65], v76, s[50:51] offset:0 sc1
    global_load_dwordx2 v[66:67], v76, s[50:51] offset:2048 sc1
    global_load_dwordx2 v[68:69], v77, s[50:51] offset:0 sc1
    global_load_dwordx2 v[70:71], v77, s[50:51] offset:2048 sc1
    s_waitcnt vmcnt(13)
    s_waitcnt vmcnt(12)
    v_perm_b32 v16, v156, v158, s56
    v_perm_b32 v17, v152, v154, s56
    ds_write_b64 v7, v[16:17] offset:512
    v_perm_b32 v18, v156, v158, s58
    v_perm_b32 v19, v152, v154, s58
    ds_write_b64 v7, v[18:19] offset:5184
    v_perm_b32 v20, v157, v159, s56
    v_perm_b32 v21, v153, v155, s56
    ds_write_b64 v7, v[20:21] offset:9856
    v_perm_b32 v22, v157, v159, s58
    v_perm_b32 v23, v153, v155, s58
    ds_write_b64 v7, v[22:23] offset:14528
    v_mov_b32 v36, 7
    ds_write_b32 v1, v36 offset:80
    s_waitcnt vmcnt(11)
    s_waitcnt vmcnt(10)
    s_waitcnt vmcnt(9)
    s_waitcnt vmcnt(8)
    v_perm_b32 v24, v164, v166, s56
    v_perm_b32 v25, v160, v162, s56
    ds_write_b64 v7, v[24:25] offset:0
    v_perm_b32 v26, v164, v166, s58
    v_perm_b32 v27, v160, v162, s58
    ds_write_b64 v7, v[26:27] offset:4672
    v_perm_b32 v28, v165, v167, s56
    v_perm_b32 v29, v161, v163, s56
    ds_write_b64 v7, v[28:29] offset:9344
    v_perm_b32 v30, v165, v167, s58
    v_perm_b32 v31, v161, v163, s58
    ds_write_b64 v7, v[30:31] offset:14016
    v_mov_b32 v36, 8
    ds_write_b32 v1, v36 offset:80
    ds_read_b64_tr_b16 v[40:41], v72 offset:3584
    ds_read_b64_tr_b16 v[42:43], v72 offset:3072
    ds_read_b64_tr_b16 v[44:45], v72 offset:2560
    ds_read_b64_tr_b16 v[46:47], v72 offset:2048
    s_mov_b32 s9, 0
SP_6:
    ds_read_b32 v10, v1 offset:8
    s_waitcnt lgkmcnt(0)
    v_readfirstlane_b32 s8, v10
    s_add_u32 s9, s9, 1
    s_cmp_lg_u32 s8, 0
    s_cbranch_scc1 SP_6_D
    s_cmp_lt_u32 s9, 524288
    s_cbranch_scc1 SP_6
SP_6_D:
    v_lshlrev_b32 v120, 16, v40
    v_and_b32 v121, 0xffff0000, v40
    v_lshlrev_b32 v122, 16, v41
    v_and_b32 v123, 0xffff0000, v41
    v_lshlrev_b32 v124, 16, v42
    v_and_b32 v125, 0xffff0000, v42
    v_lshlrev_b32 v126, 16, v43
    v_and_b32 v127, 0xffff0000, v43
    v_lshlrev_b32 v128, 16, v44
    v_and_b32 v129, 0xffff0000, v44
    v_lshlrev_b32 v130, 16, v45
    v_and_b32 v131, 0xffff0000, v45
    v_lshlrev_b32 v132, 16, v46
    v_and_b32 v133, 0xffff0000, v46
    v_lshlrev_b32 v134, 16, v47
    v_and_b32 v135, 0xffff0000, v47
    s_waitcnt vmcnt(0)
    s_branch C_IO3
C_IO:
    s_mul_i32 s7, s4, 18
    s_add_u32 s7, s7, s5
    s_sub_u32 s7, s7, 14
    s_lshl_b32 s55, s7, 3
    s_sub_u32 s12, s3, 8
    s_mov_b32 s60, s46
    s_mov_b32 s61, s47
    s_mov_b32 s62, 2359296
    s_mov_b32 s63, 0x20000
    v_bfe_u32 v79, v2, 2, 2
    v_and_b32 v80, 3, v2
    v_lshl_add_u32 v80, v4, 2, v80
    s_lshl_b32 s8, s12, 7
    v_mul_u32_u24 v72, 4672, v79
    v_lshl_add_u32 v72, v80, 3, v72
    s_sub_u32 s9, 56960, s8
    v_add_u32 v72, s9, v72
    v_mul_u32_u24 v73, 4160, v79
    v_lshl_add_u32 v73, v80, 3, v73
    s_sub_u32 s9, 83840, s8
    v_add_u32 v73, s9, v73
    v_xor_b32 v79, 63, v2
    s_lshl_b32 s8, s12, 9
    s_add_u32 s8, s8, 16384
    v_lshl_add_u32 v74, v79, 3, s8
    v_add_u32 v75, 4096, v74
    v_add_u32 v76, 8192, v74
    v_add_u32 v77, 12288, v74
    v_mul_u32_u24 v78, 1152, v79
    v_add_u32 v78, s55, v78
    s_mul_i32 s68, s12, 73728
    s_mov_b32 s70, 0x05040100
    s_mov_b32 s71, 0x07060302
    s_sub_u32 s9, s5, 14
    s_mul_i32 s9, s9, 3
    s_min_u32 s8, s12, 2
    s_add_u32 s9, s9, s8
    s_mul_i32 s9, s9, 12288
    s_mul_i32 s8, s4, 663552
    s_add_u32 s8, s8, s9
    v_lshl_add_u32 v88, v2, 7, s8
    v_min_u32 v89, 31, v2
    v_lshl_add_u32 v89, v89, 7, s8
    v_add_u32 v89, 8192, v89
    s_mov_b32 s9, 0
SP_7:
    ds_read_b32 v10, v1 offset:8
    s_waitcnt lgkmcnt(0)
    v_readfirstlane_b32 s8, v10
    s_add_u32 s9, s9, 1
    s_cmp_lg_u32 s8, 0
    s_cbranch_scc1 SP_7_D
    s_cmp_lt_u32 s9, 524288
    s_cbranch_scc1 SP_7
SP_7_D:
    s_setprio 3
    s_mov_b32 s9, 0
SP_8:
    ds_read_b32 v12, v1 offset:80
    s_waitcnt lgkmcnt(0)
    v_readfirstlane_b32 s8, v12
    s_add_u32 s9, s9, 1
    s_cmp_ge_u32 s8, 4
    s_cbranch_scc1 SP_8_D
    s_sleep 2
    s_cmp_lt_u32 s9, 524288
    s_cbranch_scc1 SP_8
SP_8_D:
    s_setprio 3
    ds_read_b64_tr_b16 v[40:41], v72 offset:3584
    ds_read_b64_tr_b16 v[42:43], v72 offset:3072
    ds_read_b64_tr_b16 v[44:45], v72 offset:2560
    ds_read_b64_tr_b16 v[46:47], v72 offset:2048
    s_waitcnt lgkmcnt(0)
    v_lshlrev_b32 v120, 16, v40
    v_and_b32 v121, 0xffff0000, v40
    v_lshlrev_b32 v122, 16, v41
    v_and_b32 v123, 0xffff0000, v41
    v_lshlrev_b32 v124, 16, v42
    v_and_b32 v125, 0xffff0000, v42
    v_lshlrev_b32 v126, 16, v43
    v_and_b32 v127, 0xffff0000, v43
    v_lshlrev_b32 v128, 16, v44
    v_and_b32 v129, 0xffff0000, v44
    v_lshlrev_b32 v130, 16, v45
    v_and_b32 v131, 0xffff0000, v45
    v_lshlrev_b32 v132, 16, v46
    v_and_b32 v133, 0xffff0000, v46
    v_lshlrev_b32 v134, 16, v47
    v_and_b32 v135, 0xffff0000, v47
    s_setprio 3
    s_mov_b32 s9, 0
SP_9:
    ds_read_b32 v12, v1 offset:88
    s_waitcnt lgkmcnt(0)
    v_readfirstlane_b32 s8, v12
    s_add_u32 s9, s9, 1
    s_cmp_ge_u32 s8, 1
    s_cbranch_scc1 SP_9_D
    s_sleep 1
    s_cmp_lt_u32 s9, 524288
    s_cbranch_scc1 SP_9
SP_9_D:
    s_setprio 3
    global_load_dwordx2 v[56:57], v74, s[50:51] offset:0 sc1
    global_load_dwordx2 v[58:59], v74, s[50:51] offset:2048 sc1
    global_load_dwordx2 v[60:61], v75, s[50:51] offset:0 sc1
    global_load_dwordx2 v[62:63], v75, s[50:51] offset:2048 sc1
    global_load_dwordx2 v[64:65], v76, s[50:51] offset:0 sc1
    global_load_dwordx2 v[66:67], v76, s[50:51] offset:2048 sc1
    global_load_dwordx2 v[68:69], v77, s[50:51] offset:0 sc1
    global_load_dwordx2 v[70:71], v77, s[50:51] offset:2048 sc1
    v_mov_b32 v12, 1
    s_mov_b64 exec, 1
    ds_add_u32 v1, v12 offset:36
    s_mov_b64 exec, -1
    s_mov_b32 s9, 0
SP_10:
    ds_read_b32 v12, v1 offset:36
    s_waitcnt lgkmcnt(0)
    v_readfirstlane_b32 s8, v12
    s_add_u32 s9, s9, 1
    s_cmp_ge_u32 s8, 3
    s_cbranch_scc1 SP_10_D
    s_cmp_lt_u32 s9, 524288
    s_cbranch_scc1 SP_10
SP_10_D:
    global_load_dword v96, v88, s[42:43]
    global_load_dword v97, v89, s[42:43]
    s_waitcnt vmcnt(2)
C_IO3:
    s_waitcnt vmcnt(2)
    s_mov_b32 s9, 0
GP_11:
    v_xor_b32 v14, v57, v10
    v_bitop3_b32 v14, v14, v59, v10 bitop3:0xf6
    v_bitop3_b32 v14, v14, v61, v10 bitop3:0xf6
    v_bitop3_b32 v14, v14, v63, v10 bitop3:0xf6
    v_bitop3_b32 v14, v14, v65, v10 bitop3:0xf6
    v_bitop3_b32 v14, v14, v67, v10 bitop3:0xf6
    v_bitop3_b32 v14, v14, v69, v10 bitop3:0xf6
    v_bitop3_b32 v14, v14, v71, v10 bitop3:0xf6
    v_cmp_ne_u32 vcc, 0, v14
    s_add_u32 s9, s9, 1
    s_cmp_eq_u64 vcc, 0
    s_cbranch_scc1 GP_11_D
    s_cmp_ge_u32 s9, 131072
    s_cbranch_scc1 GP_11_D
    global_load_dwordx2 v[56:57], v74, s[50:51] offset:0 sc1
    global_load_dwordx2 v[58:59], v74, s[50:51] offset:2048 sc1
    global_load_dwordx2 v[60:61], v75, s[50:51] offset:0 sc1
    global_load_dwordx2 v[62:63], v75, s[50:51] offset:2048 sc1
    global_load_dwordx2 v[64:65], v76, s[50:51] offset:0 sc1
    global_load_dwordx2 v[66:67], v76, s[50:51] offset:2048 sc1
    global_load_dwordx2 v[68:69], v77, s[50:51] offset:0 sc1
    global_load_dwordx2 v[70:71], v77, s[50:51] offset:2048 sc1
    s_waitcnt vmcnt(0)
    s_branch GP_11
GP_11_D:
    v_and_b32 v16, 0xffff0000, v56
    v_lshlrev_b32 v57, 16, v56
    v_mul_f32 v120, v120, v16
    v_mul_f32 v121, v121, v16
    v_mul_f32 v122, v122, v16
    v_mul_f32 v123, v123, v16
    v_and_b32 v17, 0xffff0000, v58
    v_lshlrev_b32 v59, 16, v58
    v_mul_f32 v124, v124, v17
    v_mul_f32 v125, v125, v17
    v_mul_f32 v126, v126, v17
    v_mul_f32 v127, v127, v17
    v_and_b32 v18, 0xffff0000, v60
    v_lshlrev_b32 v61, 16, v60
    v_mul_f32 v128, v128, v18
    v_mul_f32 v129, v129, v18
    v_mul_f32 v130, v130, v18
    v_mul_f32 v131, v131, v18
    v_and_b32 v19, 0xffff0000, v62
    v_lshlrev_b32 v63, 16, v62
    v_mul_f32 v132, v132, v19
    v_mul_f32 v133, v133, v19
    v_mul_f32 v134, v134, v19
    v_mul_f32 v135, v135, v19
    s_setprio 3
    s_mov_b32 s9, 0
SP_12:
    ds_read_b32 v15, v1 offset:96
    s_waitcnt lgkmcnt(0)
    v_readfirstlane_b32 s8, v15
    s_add_u32 s9, s9, 1
    s_cmp_ge_u32 s8, 4
    s_cbranch_scc1 SP_12_D
    s_sleep 1
    s_cmp_lt_u32 s9, 524288
    s_cbranch_scc1 SP_12
SP_12_D:
    s_setprio 3
    ds_read_b64_tr_b16 v[16:17], v73 offset:3584
    ds_read_b64_tr_b16 v[18:19], v73 offset:3072
    s_waitcnt lgkmcnt(1)
    v_lshlrev_b32 v24, 16, v16
    v_and_b32 v25, 0xffff0000, v16
    v_lshlrev_b32 v26, 16, v17
    v_and_b32 v27, 0xffff0000, v17
    v_fma_f32 v24, v24, v57, v120
    v_fma_f32 v25, v25, v57, v121
    v_fma_f32 v26, v26, v57, v122
    v_fma_f32 v27, v27, v57, v123
    s_waitcnt lgkmcnt(0)
    v_lshlrev_b32 v28, 16, v18
    v_and_b32 v29, 0xffff0000, v18
    v_lshlrev_b32 v30, 16, v19
    v_and_b32 v31, 0xffff0000, v19
    v_fma_f32 v28, v28, v59, v124
    v_fma_f32 v29, v29, v59, v125
    v_fma_f32 v30, v30, v59, v126
    v_fma_f32 v31, v31, v59, v127
    v_cvt_pk_bf16_f32 v40, v24, v25
    v_cvt_pk_bf16_f32 v41, v26, v27
    buffer_store_dwordx2 v[40:41], v78, s[60:63], s68 offen
    s_add_u32 s68, s68, 294912
    v_cvt_pk_bf16_f32 v42, v28, v29
    v_cvt_pk_bf16_f32 v43, v30, v31
    buffer_store_dwordx2 v[42:43], v78, s[60:63], s68 offen
    s_add_u32 s68, s68, 294912
    s_setprio 3
    s_mov_b32 s9, 0
SP_13:
    ds_read_b32 v15, v1 offset:100
    s_waitcnt lgkmcnt(0)
    v_readfirstlane_b32 s8, v15
    s_add_u32 s9, s9, 1
    s_cmp_ge_u32 s8, 4
    s_cbranch_scc1 SP_13_D
    s_sleep 1
    s_cmp_lt_u32 s9, 524288
    s_cbranch_scc1 SP_13
SP_13_D:
    s_setprio 3
    ds_read_b64_tr_b16 v[16:17], v73 offset:2560
    ds_read_b64_tr_b16 v[18:19], v73 offset:2048
    s_waitcnt lgkmcnt(1)
    v_lshlrev_b32 v24, 16, v16
    v_and_b32 v25, 0xffff0000, v16
    v_lshlrev_b32 v26, 16, v17
    v_and_b32 v27, 0xffff0000, v17
    v_fma_f32 v24, v24, v61, v128
    v_fma_f32 v25, v25, v61, v129
    v_fma_f32 v26, v26, v61, v130
    v_fma_f32 v27, v27, v61, v131
    s_waitcnt lgkmcnt(0)
    v_lshlrev_b32 v28, 16, v18
    v_and_b32 v29, 0xffff0000, v18
    v_lshlrev_b32 v30, 16, v19
    v_and_b32 v31, 0xffff0000, v19
    v_fma_f32 v28, v28, v63, v132
    v_fma_f32 v29, v29, v63, v133
    v_fma_f32 v30, v30, v63, v134
    v_fma_f32 v31, v31, v63, v135
    v_cvt_pk_bf16_f32 v44, v24, v25
    v_cvt_pk_bf16_f32 v45, v26, v27
    buffer_store_dwordx2 v[44:45], v78, s[60:63], s68 offen
    s_add_u32 s68, s68, 294912
    v_cvt_pk_bf16_f32 v46, v28, v29
    v_cvt_pk_bf16_f32 v47, v30, v31
    buffer_store_dwordx2 v[46:47], v78, s[60:63], s68 offen
    s_add_u32 s68, s68, 294912
    s_mov_b32 s9, 0
SP_14:
    ds_read_b32 v12, v1 offset:80
    s_waitcnt lgkmcnt(0)
    v_readfirstlane_b32 s8, v12
    s_add_u32 s9, s9, 1
    s_cmp_ge_u32 s8, 8
    s_cbranch_scc1 SP_14_D
    s_cmp_lt_u32 s9, 524288
    s_cbranch_scc1 SP_14
SP_14_D:
    ds_read_b64_tr_b16 v[48:49], v72 offset:1536
    ds_read_b64_tr_b16 v[50:51], v72 offset:1024
    ds_read_b64_tr_b16 v[52:53], v72 offset:512
    ds_read_b64_tr_b16 v[54:55], v72 offset:0
    s_lshl_b32 s8, s12, 8
    s_sub_u32 s8, 76032, s8
    v_lshl_add_u32 v14, v2, 2, s8
    ds_write_b32 v14, v56 offset:7168
    ds_write_b32 v14, v58 offset:6144
    ds_write_b32 v14, v60 offset:5120
    ds_write_b32 v14, v62 offset:4096
    ds_write_b32 v14, v64 offset:3072
    ds_write_b32 v14, v66 offset:2048
    ds_write_b32 v14, v68 offset:1024
    ds_write_b32 v14, v70 offset:0
    s_setprio 3
    s_mov_b32 s9, 0
SP_15:
    ds_read_b32 v15, v1 offset:104
    s_waitcnt lgkmcnt(0)
    v_readfirstlane_b32 s8, v15
    s_add_u32 s9, s9, 1
    s_cmp_ge_u32 s8, 4
    s_cbranch_scc1 SP_15_D
    s_sleep 1
    s_cmp_lt_u32 s9, 524288
    s_cbranch_scc1 SP_15
SP_15_D:
    s_setprio 3
    ds_read_b64_tr_b16 v[16:17], v73 offset:1536
    ds_read_b64_tr_b16 v[18:19], v73 offset:1024
    s_waitcnt lgkmcnt(1)
    v_perm_b32 v24, v48, v16, s70
    v_perm_b32 v25, v48, v16, s71
    v_perm_b32 v26, v49, v17, s70
    v_perm_b32 v27, v49, v17, s71
    s_waitcnt lgkmcnt(0)
    v_perm_b32 v28, v50, v18, s70
    v_perm_b32 v29, v50, v18, s71
    v_perm_b32 v30, v51, v19, s70
    v_perm_b32 v31, v51, v19, s71
    v_dot2_f32_bf16 v24, v24, v64, 0
    v_dot2_f32_bf16 v25, v25, v64, 0
    v_dot2_f32_bf16 v26, v26, v64, 0
    v_dot2_f32_bf16 v27, v27, v64, 0
    v_dot2_f32_bf16 v28, v28, v66, 0
    v_dot2_f32_bf16 v29, v29, v66, 0
    v_dot2_f32_bf16 v30, v30, v66, 0
    v_dot2_f32_bf16 v31, v31, v66, 0
    v_cvt_pk_bf16_f32 v48, v24, v25
    v_cvt_pk_bf16_f32 v49, v26, v27
    buffer_store_dwordx2 v[48:49], v78, s[60:63], s68 offen
    s_add_u32 s68, s68, 294912
    v_cvt_pk_bf16_f32 v50, v28, v29
    v_cvt_pk_bf16_f32 v51, v30, v31
    buffer_store_dwordx2 v[50:51], v78, s[60:63], s68 offen
    s_add_u32 s68, s68, 294912
    s_setprio 3
    s_mov_b32 s9, 0
SP_16:
    ds_read_b32 v15, v1 offset:108
    s_waitcnt lgkmcnt(0)
    v_readfirstlane_b32 s8, v15
    s_add_u32 s9, s9, 1
    s_cmp_ge_u32 s8, 4
    s_cbranch_scc1 SP_16_D
    s_sleep 1
    s_cmp_lt_u32 s9, 524288
    s_cbranch_scc1 SP_16
SP_16_D:
    s_setprio 3
    ds_read_b64_tr_b16 v[16:17], v73 offset:512
    s_waitcnt lgkmcnt(0)
    v_perm_b32 v24, v52, v16, s70
    v_perm_b32 v25, v52, v16, s71
    v_perm_b32 v26, v53, v17, s70
    v_perm_b32 v27, v53, v17, s71
    v_dot2_f32_bf16 v24, v24, v68, 0
    v_dot2_f32_bf16 v25, v25, v68, 0
    v_dot2_f32_bf16 v26, v26, v68, 0
    v_dot2_f32_bf16 v27, v27, v68, 0
    s_nop 0
    v_cvt_pk_bf16_f32 v52, v24, v25
    s_nop 0
    v_cvt_pk_bf16_f32 v53, v26, v27
    buffer_store_dwordx2 v[52:53], v78, s[60:63], s68 offen
    s_add_u32 s68, s68, 294912
    s_setprio 3
    s_mov_b32 s9, 0
SP_17:
    ds_read_b32 v15, v1 offset:112
    s_waitcnt lgkmcnt(0)
    v_readfirstlane_b32 s8, v15
    s_add_u32 s9, s9, 1
    s_cmp_ge_u32 s8, 4
    s_cbranch_scc1 SP_17_D
    s_sleep 1
    s_cmp_lt_u32 s9, 524288
    s_cbranch_scc1 SP_17
SP_17_D:
    s_setprio 3
    ds_read_b64_tr_b16 v[16:17], v73 offset:0
    s_waitcnt lgkmcnt(0)
    v_perm_b32 v24, v54, v16, s70
    v_perm_b32 v25, v54, v16, s71
    v_perm_b32 v26, v55, v17, s70
    v_perm_b32 v27, v55, v17, s71
    v_dot2_f32_bf16 v24, v24, v70, 0
    v_dot2_f32_bf16 v25, v25, v70, 0
    v_dot2_f32_bf16 v26, v26, v70, 0
    v_dot2_f32_bf16 v27, v27, v70, 0
    s_nop 0
    v_cvt_pk_bf16_f32 v54, v24, v25
    s_nop 0
    v_cvt_pk_bf16_f32 v55, v26, v27
    buffer_store_dwordx2 v[54:55], v78, s[60:63], s68 offen
    s_add_u32 s68, s68, 294912
    v_mov_b32 v8, 1
    s_mov_b64 exec, 1
    ds_add_u32 v1, v8 offset:44
    s_mov_b64 exec, -1
    s_waitcnt vmcnt(0)
    v_mov_b32 v8, 1
    s_mov_b64 exec, 1
    ds_add_u32 v1, v8 offset:40
    s_mov_b64 exec, -1
    s_endpgm
C_FIN:
    s_setprio 0
    v_and_b32 v8, 7, v2
    v_lshlrev_b32 v8, 3, v8
    v_add_u32 v8, 8192, v8
    s_mul_i32 s8, s7, 9216
    s_add_u32 s8, s8, 32768
    v_lshl_add_u32 v5, v2, 4, s8
    v_add_u32 v6, 0x1000, v5
    v_add_u32 v7, 0x2000, v5
    v_and_b32 v19, 1, v4
    v_lshrrev_b32 v20, 1, v4
    v_lshl_or_b32 v19, v19, 1, v20
    v_mul_u32_u24 v12, 4672, v19
    v_add_u32 v12, 56576, v12
    v_mul_u32_u24 v13, 4160, v19
    v_add_u32 v13, 83456, v13
    s_add_u32 s8, s55, 2358144
    v_lshl_add_u32 v14, v19, 1, s8
    s_waitcnt lgkmcnt(0)
    v_bfe_u32 v110, v10, 0, 8
    v_bfe_u32 v111, v10, 8, 8
    v_bfe_u32 v112, v10, 16, 8
    v_bfe_u32 v113, v10, 24, 8
    s_setprio 3
    s_mov_b32 s9, 0
SP_18:
    ds_read_b32 v26, v1 offset:44
    s_waitcnt lgkmcnt(0)
    v_readfirstlane_b32 s8, v26
    s_add_u32 s9, s9, 1
    s_cmp_ge_u32 s8, 4
    s_cbranch_scc1 SP_18_D
    s_sleep 1
    s_cmp_lt_u32 s9, 524288
    s_cbranch_scc1 SP_18
SP_18_D:
    s_setprio 3
    s_mov_b32 s9, 0
C_MPOLL:
    global_load_dwordx2 v[16:17], v8, s[50:51] sc1
    global_load_dwordx4 v[120:123], v5, s[50:51] offset:0 sc1
    global_load_dwordx4 v[124:127], v5, s[50:51] offset:1024 sc1
    global_load_dwordx4 v[128:131], v5, s[50:51] offset:2048 sc1
    global_load_dwordx4 v[132:135], v5, s[50:51] offset:3072 sc1
    global_load_dwordx4 v[136:139], v6, s[50:51] offset:0 sc1
    global_load_dwordx4 v[140:143], v6, s[50:51] offset:1024 sc1
    global_load_dwordx4 v[144:147], v6, s[50:51] offset:2048 sc1
    global_load_dwordx4 v[148:151], v6, s[50:51] offset:3072 sc1
    global_load_dwordx4 v[152:155], v7, s[50:51] offset:0 sc1
    s_waitcnt vmcnt(9)
    v_and_b32 v22, 0x7ff, v16
    v_lshl_add_u32 v23, v22, 1, v12
    ds_read_u16 v105, v23
    v_lshl_add_u32 v23, v22, 1, v13
    ds_read_u16 v107, v23
    v_lshlrev_b32 v23, 2, v22
    v_add_u32 v23, 75264, v23
    ds_read_b32 v24, v23
    v_and_b32 v20, 0xffff0000, v16
    v_ashrrev_i32 v21, 31, v20
    v_not_b32 v21, v21
    v_or_b32 v21, 0x80000000, v21
    v_and_b32 v21, 0xffff0000, v21
    v_xor_b32 v20, v20, v21
    v_mul_f32 v21, 0xbfb8aa3b, v20
    v_exp_f32 v21, v21
    s_nop 0
    v_add_f32 v21, 1.0, v21
    v_rcp_f32 v104, v21
    s_nop 0
    v_cvt_pk_bf16_f32 v104, v104, v104
    v_and_b32 v104, 0xffff0000, v104
    v_mul_u32_u24 v108, 1152, v22
    v_sub_u32 v108, v14, v108
    s_waitcnt lgkmcnt(0)
    v_lshlrev_b32 v105, 16, v105
    s_waitcnt vmcnt(8)
    v_xor_b32 v120, v120, v110
    v_xor_b32 v121, v121, v111
    v_xor_b32 v122, v122, v112
    v_xor_b32 v123, v123, v113
    v_or3_b32 v26, v120, v121, 0
    v_or3_b32 v26, v122, v123, v26
    s_waitcnt vmcnt(7)
    v_xor_b32 v124, v124, v110
    v_xor_b32 v125, v125, v111
    v_xor_b32 v126, v126, v112
    v_xor_b32 v127, v127, v113
    v_or3_b32 v26, v124, v125, v26
    v_or3_b32 v26, v126, v127, v26
    v_pk_add_f32 v[28:29], v[120:121], v[124:125]
    v_pk_add_f32 v[30:31], v[122:123], v[126:127]
    s_waitcnt vmcnt(6)
    v_xor_b32 v128, v128, v110
    v_xor_b32 v129, v129, v111
    v_xor_b32 v130, v130, v112
    v_xor_b32 v131, v131, v113
    v_or3_b32 v26, v128, v129, v26
    v_or3_b32 v26, v130, v131, v26
    v_pk_add_f32 v[28:29], v[28:29], v[128:129]
    v_pk_add_f32 v[30:31], v[30:31], v[130:131]
    s_waitcnt vmcnt(5)
    v_xor_b32 v132, v132, v110
    v_xor_b32 v133, v133, v111
    v_xor_b32 v134, v134, v112
    v_xor_b32 v135, v135, v113
    v_or3_b32 v26, v132, v133, v26
    v_or3_b32 v26, v134, v135, v26
    v_pk_add_f32 v[28:29], v[28:29], v[132:133]
    v_pk_add_f32 v[30:31], v[30:31], v[134:135]
    s_waitcnt vmcnt(4)
    v_xor_b32 v136, v136, v110
    v_xor_b32 v137, v137, v111
    v_xor_b32 v138, v138, v112
    v_xor_b32 v139, v139, v113
    v_or3_b32 v26, v136, v137, v26
    v_or3_b32 v26, v138, v139, v26
    v_pk_add_f32 v[28:29], v[28:29], v[136:137]
    v_pk_add_f32 v[30:31], v[30:31], v[138:139]
    s_waitcnt vmcnt(3)
    v_xor_b32 v140, v140, v110
    v_xor_b32 v141, v141, v111
    v_xor_b32 v142, v142, v112
    v_xor_b32 v143, v143, v113
    v_or3_b32 v26, v140, v141, v26
    v_or3_b32 v26, v142, v143, v26
    v_pk_add_f32 v[28:29], v[28:29], v[140:141]
    v_pk_add_f32 v[30:31], v[30:31], v[142:143]
    s_waitcnt vmcnt(2)
    v_xor_b32 v144, v144, v110
    v_xor_b32 v145, v145, v111
    v_xor_b32 v146, v146, v112
    v_xor_b32 v147, v147, v113
    v_or3_b32 v26, v144, v145, v26
    v_or3_b32 v26, v146, v147, v26
    v_pk_add_f32 v[28:29], v[28:29], v[144:145]
    v_pk_add_f32 v[30:31], v[30:31], v[146:147]
    s_waitcnt vmcnt(1)
    v_xor_b32 v148, v148, v110
    v_xor_b32 v149, v149, v111
    v_xor_b32 v150, v150, v112
    v_xor_b32 v151, v151, v113
    v_or3_b32 v26, v148, v149, v26
    v_or3_b32 v26, v150, v151, v26
    v_pk_add_f32 v[28:29], v[28:29], v[148:149]
    v_pk_add_f32 v[30:31], v[30:31], v[150:151]
    s_waitcnt vmcnt(0)
    v_xor_b32 v152, v152, v110
    v_xor_b32 v153, v153, v111
    v_xor_b32 v154, v154, v112
    v_xor_b32 v155, v155, v113
    v_or3_b32 v26, v152, v153, v26
    v_or3_b32 v26, v154, v155, v26
    v_pk_add_f32 v[28:29], v[28:29], v[152:153]
    v_pk_add_f32 v[30:31], v[30:31], v[154:155]
    v_and_b32 v26, 0xff, v26
    v_bitop3_b32 v26, v26, v17, v10 bitop3:0xf6
    v_cmp_ne_u32 vcc, 0, v26
    s_add_u32 s9, s9, 1
    s_cmp_eq_u64 vcc, 0
    s_cbranch_scc1 C_MOK
    s_cmp_lt_u32 s9, 131072
    s_cbranch_scc1 C_MPOLL
C_MOK:
    v_permlane32_swap_b32 v28, v29
    v_permlane32_swap_b32 v30, v31
    v_add_f32 v28, v28, v29
    v_add_f32 v30, v30, v31
    s_nop 1
    v_permlane16_swap_b32 v28, v30
    v_add_f32 v28, v28, v30
    s_nop 1
    v_add_f32_dpp v28, v28, v28 row_ror:8 row_mask:0xf bank_mask:0xf
    v_cvt_pk_bf16_f32 v28, v28, v28
    v_and_b32 v28, 0xffff0000, v28
    v_mul_f32 v28, v28, v104
    v_cvt_pk_bf16_f32 v28, v28, v28
    v_and_b32 v28, 0xffff0000, v28
    v_add_f32 v28, v28, v105
    v_cvt_pk_bf16_f32 v28, v28, v28
    v_and_b32 v28, 0xffff0000, v28
    v_or_b32 v28, v28, v107
    v_dot2_f32_bf16 v28, v28, v24, 0
    s_nop 2
    v_cvt_pk_bf16_f32 v28, v28, v28
    s_mov_b32 s9, 0
SP_19:
    ds_read_b32 v27, v1 offset:40
    s_waitcnt lgkmcnt(0)
    v_readfirstlane_b32 s8, v27
    s_add_u32 s9, s9, 1
    s_cmp_ge_u32 s8, 4
    s_cbranch_scc1 SP_19_D
    s_cmp_lt_u32 s9, 524288
    s_cbranch_scc1 SP_19
SP_19_D:
    s_mov_b32 exec_lo, 0x00ff00ff
    s_mov_b32 exec_hi, 0x00ff00ff
    global_store_short v108, v28, s[46:47]
    s_mov_b64 exec, -1
    s_endpgm
HELPER:
    s_cmp_ge_u32 s3, 6
    s_cbranch_scc1 K_END
    s_and_b32 s12, s3, 1
    s_sub_u32 s13, s3, 2
    s_lshr_b32 s13, s13, 1
    s_mul_i32 s13, s13, 5
    s_add_u32 s13, s13, s5
    s_add_u32 s13, s13, 44
    v_mul_u32_u24 v5, 57, v2
    v_lshrrev_b32 v5, 9, v5
    v_mul_u32_u24 v6, 9, v5
    v_sub_u32 v6, v2, v6
    s_waitcnt lgkmcnt(0)
    s_cmp_eq_u32 s12, 1
    s_cselect_b32 s52, s40, s38
    s_cselect_b32 s53, s41, s39
    s_mov_b32 s54, 5308416
    s_mov_b32 s55, 0x20000
    v_mul_u32_u24 v5, 9216, v5
    v_lshl_add_u32 v5, v6, 7, v5
    s_mul_i32 s8, s4, 1152
    s_sub_u32 s14, s13, 53
    s_lshr_b32 s9, s52, 7
    s_add_u32 s9, s9, s4
    s_sub_u32 s9, 3, s9
    s_and_b32 s9, s9, 7
    s_lshl_b32 s15, s9, 7
    s_add_u32 s15, s15, s8
    s_mul_i32 s14, s14, 258048
    s_add_u32 s15, s15, s14
    s_add_u32 s15, s15, 838656
    s_cmp_eq_u32 s9, 0
    s_cselect_b32 s9, 1024, 0
    v_and_b32 v7, 31, v2
    v_min_u32 v7, 27, v7
    v_mul_u32_u24 v7, 9216, v7
    v_lshrrev_b32 v9, 5, v2
    v_mul_u32_u24 v9, s9, v9
    v_add_u32 v7, v7, v9
    s_mul_i32 s13, s13, 64512
    s_add_u32 s13, s13, s8
    s_mov_b32 s9, 0
SP_20:
    ds_read_b32 v13, v1 offset:4
    s_waitcnt lgkmcnt(0)
    v_readfirstlane_b32 s8, v13
    s_add_u32 s9, s9, 1
    s_cmp_ge_u32 s8, 1
    s_cbranch_scc1 SP_20_D
    s_cmp_lt_u32 s9, 524288
    s_cbranch_scc1 SP_20
SP_20_D:
    buffer_load_dword v8, v7, s[52:55], s15 offen
    s_waitcnt vmcnt(0)
    buffer_load_dword v8, v5, s[52:55], s13 offen
    s_add_u32 s13, s13, 645120
    s_waitcnt vmcnt(0)
    buffer_load_dword v8, v5, s[52:55], s13 offen
    s_add_u32 s13, s13, 645120
    s_waitcnt vmcnt(0)
    buffer_load_dword v8, v5, s[52:55], s13 offen
    s_add_u32 s13, s13, 645120
    s_endpgm
GATE:
    s_lshl_b32 s8, s12, 9
    s_add_u32 s8, s8, 147712
    v_lshl_add_u32 v5, v2, 2, s8
    v_and_b32 v6, 31, v2
    v_lshlrev_b32 v6, 2, v6
    v_add_u32 v6, 158224, v6
    s_lshl_b32 s8, s2, 1
    s_add_u32 s8, s8, s12
    v_mov_b32 v8, 0
    v_mov_b32 v9, 0
    v_mov_b32 v10, 0x3f803f80
    s_lshl_b32 s8, s8, 5
    s_add_u32 s8, s8, 16384
    v_lshrrev_b32 v7, 5, v2
    v_lshl_add_u32 v7, v7, 3, s8
    v_and_b32 v11, 16, v2
    v_add_u32 v7, v7, v11
    s_mov_b32 s9, 0
SP_21:
    ds_read_b32 v13, v1 offset:8
    s_waitcnt lgkmcnt(0)
    v_readfirstlane_b32 s8, v13
    s_add_u32 s9, s9, 1
    s_cmp_lg_u32 s8, 0
    s_cbranch_scc1 SP_21_D
    s_sleep 1
    s_cmp_lt_u32 s9, 524288
    s_cbranch_scc1 SP_21
SP_21_D:
    ds_read2_b32 v[34:35], v6 offset0:0 offset1:32
    ds_read2_b32 v[36:37], v6 offset0:64 offset1:96
    ds_read2_b32 v[38:39], v6 offset0:128 offset1:160
    ds_read2_b32 v[40:41], v6 offset0:192 offset1:224
    ds_read_b32 v42, v6 offset:1024
    ds_read2st64_b32 v[16:17], v5 offset0:0 offset1:1
    ds_read2st64_b32 v[18:19], v5 offset0:4 offset1:5
    ds_read2st64_b32 v[20:21], v5 offset0:8 offset1:9
    ds_read2st64_b32 v[22:23], v5 offset0:12 offset1:13
    ds_read2st64_b32 v[24:25], v5 offset0:16 offset1:17
    ds_read2st64_b32 v[26:27], v5 offset0:20 offset1:21
    ds_read2st64_b32 v[28:29], v5 offset0:24 offset1:25
    ds_read2st64_b32 v[30:31], v5 offset0:28 offset1:29
    ds_read2st64_b32 v[32:33], v5 offset0:32 offset1:33
    s_waitcnt lgkmcnt(13)
    v_and_b32 v44, 0xffff, v34
    v_and_b32 v34, 0xffff0000, v34
    v_and_b32 v45, 0xffff, v35
    v_and_b32 v35, 0xffff0000, v35
    s_waitcnt lgkmcnt(12)
    v_and_b32 v46, 0xffff, v36
    v_and_b32 v36, 0xffff0000, v36
    v_and_b32 v47, 0xffff, v37
    v_and_b32 v37, 0xffff0000, v37
    s_waitcnt lgkmcnt(11)
    v_and_b32 v48, 0xffff, v38
    v_and_b32 v38, 0xffff0000, v38
    v_and_b32 v49, 0xffff, v39
    v_and_b32 v39, 0xffff0000, v39
    s_waitcnt lgkmcnt(10)
    v_and_b32 v50, 0xffff, v40
    v_and_b32 v40, 0xffff0000, v40
    v_and_b32 v51, 0xffff, v41
    v_and_b32 v41, 0xffff0000, v41
    s_waitcnt lgkmcnt(9)
    v_and_b32 v52, 0xffff, v42
    v_and_b32 v42, 0xffff0000, v42
    s_waitcnt lgkmcnt(8)
    v_dot2_f32_bf16 v56, v16, v44, 0
    v_dot2_f32_bf16 v57, v16, v34, 0
    v_dot2_f32_bf16 v58, v17, v44, 0
    v_dot2_f32_bf16 v59, v17, v34, 0
    s_waitcnt lgkmcnt(7)
    v_dot2_f32_bf16 v60, v18, v45, 0
    v_dot2_f32_bf16 v61, v18, v35, 0
    v_dot2_f32_bf16 v62, v19, v45, 0
    v_dot2_f32_bf16 v63, v19, v35, 0
    v_cvt_pk_bf16_f32 v56, v56, v57
    v_cvt_pk_bf16_f32 v58, v58, v59
    v_dot2c_f32_bf16 v8, v56, v10
    v_dot2c_f32_bf16 v9, v58, v10
    s_waitcnt lgkmcnt(6)
    v_dot2_f32_bf16 v56, v20, v46, 0
    v_dot2_f32_bf16 v57, v20, v36, 0
    v_dot2_f32_bf16 v58, v21, v46, 0
    v_dot2_f32_bf16 v59, v21, v36, 0
    v_cvt_pk_bf16_f32 v60, v60, v61
    v_cvt_pk_bf16_f32 v62, v62, v63
    v_dot2c_f32_bf16 v8, v60, v10
    v_dot2c_f32_bf16 v9, v62, v10
    s_waitcnt lgkmcnt(5)
    v_dot2_f32_bf16 v60, v22, v47, 0
    v_dot2_f32_bf16 v61, v22, v37, 0
    v_dot2_f32_bf16 v62, v23, v47, 0
    v_dot2_f32_bf16 v63, v23, v37, 0
    v_cvt_pk_bf16_f32 v56, v56, v57
    v_cvt_pk_bf16_f32 v58, v58, v59
    v_dot2c_f32_bf16 v8, v56, v10
    v_dot2c_f32_bf16 v9, v58, v10
    s_waitcnt lgkmcnt(4)
    v_dot2_f32_bf16 v56, v24, v48, 0
    v_dot2_f32_bf16 v57, v24, v38, 0
    v_dot2_f32_bf16 v58, v25, v48, 0
    v_dot2_f32_bf16 v59, v25, v38, 0
    v_cvt_pk_bf16_f32 v60, v60, v61
    v_cvt_pk_bf16_f32 v62, v62, v63
    v_dot2c_f32_bf16 v8, v60, v10
    v_dot2c_f32_bf16 v9, v62, v10
    s_waitcnt lgkmcnt(3)
    v_dot2_f32_bf16 v60, v26, v49, 0
    v_dot2_f32_bf16 v61, v26, v39, 0
    v_dot2_f32_bf16 v62, v27, v49, 0
    v_dot2_f32_bf16 v63, v27, v39, 0
    v_cvt_pk_bf16_f32 v56, v56, v57
    v_cvt_pk_bf16_f32 v58, v58, v59
    v_dot2c_f32_bf16 v8, v56, v10
    v_dot2c_f32_bf16 v9, v58, v10
    s_waitcnt lgkmcnt(2)
    v_dot2_f32_bf16 v56, v28, v50, 0
    v_dot2_f32_bf16 v57, v28, v40, 0
    v_dot2_f32_bf16 v58, v29, v50, 0
    v_dot2_f32_bf16 v59, v29, v40, 0
    v_cvt_pk_bf16_f32 v60, v60, v61
    v_cvt_pk_bf16_f32 v62, v62, v63
    v_dot2c_f32_bf16 v8, v60, v10
    v_dot2c_f32_bf16 v9, v62, v10
    s_waitcnt lgkmcnt(1)
    v_dot2_f32_bf16 v60, v30, v51, 0
    v_dot2_f32_bf16 v61, v30, v41, 0
    v_dot2_f32_bf16 v62, v31, v51, 0
    v_dot2_f32_bf16 v63, v31, v41, 0
    v_cvt_pk_bf16_f32 v56, v56, v57
    v_cvt_pk_bf16_f32 v58, v58, v59
    v_dot2c_f32_bf16 v8, v56, v10
    v_dot2c_f32_bf16 v9, v58, v10
    s_waitcnt lgkmcnt(0)
    v_dot2_f32_bf16 v56, v32, v52, 0
    v_dot2_f32_bf16 v57, v32, v42, 0
    v_dot2_f32_bf16 v58, v33, v52, 0
    v_dot2_f32_bf16 v59, v33, v42, 0
    v_cvt_pk_bf16_f32 v60, v60, v61
    v_cvt_pk_bf16_f32 v62, v62, v63
    v_dot2c_f32_bf16 v8, v60, v10
    v_dot2c_f32_bf16 v9, v62, v10
    v_cvt_pk_bf16_f32 v56, v56, v57
    v_cvt_pk_bf16_f32 v58, v58, v59
    v_dot2c_f32_bf16 v8, v56, v10
    v_dot2c_f32_bf16 v9, v58, v10
    v_mov_b32 v11, 1
    s_mov_b64 exec, 1
    ds_add_u32 v1, v11 offset:12
    s_mov_b64 exec, -1
    v_permlane16_swap_b32 v8, v9
    v_add_f32 v8, v8, v9
    s_nop 1
    v_add_f32_dpp v8, v8, v8 row_ror:8 row_mask:0xf bank_mask:0xf
    s_nop 1
    v_add_f32_dpp v8, v8, v8 row_ror:4 row_mask:0xf bank_mask:0xf
    s_nop 1
    v_add_f32_dpp v8, v8, v8 row_ror:2 row_mask:0xf bank_mask:0xf
    s_nop 1
    v_add_f32_dpp v8, v8, v8 row_ror:1 row_mask:0xf bank_mask:0xf
    v_cvt_pk_bf16_f32 v8, v8, v8
    v_and_b32 v8, 0xffff0000, v8
    v_mul_f32 v9, 0xbfb8aa3b, v8
    v_exp_f32 v9, v9
    s_nop 0
    v_add_f32 v9, 1.0, v9
    v_rcp_f32 v8, v9
    s_nop 0
    v_cvt_pk_bf16_f32 v8, v8, v8
    v_and_b32 v8, 0xffff0000, v8
    v_sub_f32 v9, 1.0, v8
    v_cvt_pk_bf16_f32 v12, v8, v9
    s_mov_b32 exec_lo, 0x00010001
    s_mov_b32 exec_hi, 0x00010001
    global_store_dwordx2 v7, v[12:13], s[50:51] sc1
    s_mov_b64 exec, -1
    s_cmp_lt_u32 s5, 9
    s_cbranch_scc1 F_COMP2
    s_cmp_ge_u32 s5, 14
    s_cbranch_scc1 C_IO
    s_endpgm
C_KBODY:
C_SETD:
    s_waitcnt lgkmcnt(0)
    s_lshl_b32 s8, s12, 4
    s_lshr_b64 s[58:59], s[58:59], s8
    s_lshl_b32 s8, s58, 16
    v_mov_b32 v44, s8
    v_mul_f32 v45, 0x3fb8aa3b, v44
    v_mov_b32 v46, 0x3fb8aa3b
    v_fma_f32 v46, v44, v46, -v45
    v_mov_b32 v47, 0x32a57060
    v_fma_f32 v46, v44, v47, v46
    v_exp_f32 v45, v45
    v_mul_f32 v46, 0x3f317218, v46
    v_fma_f32 v45, v45, v46, v45
    v_cvt_pk_bf16_f32 v45, v45, v45
    v_and_b32 v36, 0xffff0000, v45
    v_mul_f32 v37, 0x3fb8aa3b, v36
    v_mul_f32 v38, 0x3e22f983, v36
    s_waitcnt vmcnt(0)
    v_mul_f32 v40, v16, v37
    v_mul_f32 v41, v17, v38
    v_exp_f32 v24, v40
    v_fract_f32 v47, v41
    v_cos_f32 v46, v47
    v_sin_f32 v47, v47
    v_mul_f32 v46, v24, v46
    v_mul_f32 v47, v24, v47
    v_mul_f32 v18, v18, v36
    v_mul_f32 v19, v19, v36
    v_pk_mul_f32 v[42:43], v[20:21], v[18:19] op_sel:[0,0] op_sel_hi:[0,1]
    v_pk_fma_f32 v[42:43], v[20:21], v[18:19], v[42:43] op_sel:[1,1,0] op_sel_hi:[1,0,1] neg_lo:[0,1,0]
    v_max_f32 v39, |v42|, |v43|
    v_pk_mul_f32 v[48:49], v[46:47], v[46:47] op_sel:[0,0] op_sel_hi:[0,1]
    v_pk_fma_f32 v[48:49], v[46:47], v[46:47], v[48:49] op_sel:[1,1,0] op_sel_hi:[1,0,1] neg_lo:[0,1,0]
    v_pk_mul_f32 v[52:53], v[48:49], v[48:49] op_sel:[0,0] op_sel_hi:[0,1]
    v_pk_fma_f32 v[52:53], v[48:49], v[48:49], v[52:53] op_sel:[1,1,0] op_sel_hi:[1,0,1] neg_lo:[0,1,0]
    v_pk_mul_f32 v[60:61], v[52:53], v[52:53] op_sel:[0,0] op_sel_hi:[0,1]
    v_pk_fma_f32 v[60:61], v[52:53], v[52:53], v[60:61] op_sel:[1,1,0] op_sel_hi:[1,0,1] neg_lo:[0,1,0]
    v_mov_b32 v30, 0x3c00
    v_xor_b32 v61, 0x80000000, v61
    ds_write_addtid_b32 v30
    v_cvt_pk_f16_f32 v26, v60, v61
    v_pk_mul_f32 v[62:63], v[60:61], v[60:61] op_sel:[0,0] op_sel_hi:[0,1]
    v_pk_fma_f32 v[62:63], v[60:61], v[60:61], v[62:63] op_sel:[1,1,0] op_sel_hi:[1,0,1] neg_lo:[0,1,0]
    v_max_u32_dpp v39, v39, v39 row_shr:1 row_mask:0xf bank_mask:0xf
    ds_write_addtid_b32 v26 offset:288
    v_cvt_pk_f16_f32 v27, v62, v63
    v_pk_mul_f32 v[64:65], v[62:63], v[60:61] op_sel:[0,0] op_sel_hi:[0,1]
    v_pk_fma_f32 v[64:65], v[62:63], v[60:61], v[64:65] op_sel:[1,1,0] op_sel_hi:[1,0,1] neg_lo:[0,1,0]
    v_max_u32_dpp v39, v39, v39 row_shr:2 row_mask:0xf bank_mask:0xf
    ds_write_addtid_b32 v27 offset:576
    v_cvt_pk_f16_f32 v28, v64, v65
    v_pk_mul_f32 v[62:63], v[64:65], v[60:61] op_sel:[0,0] op_sel_hi:[0,1]
    v_pk_fma_f32 v[62:63], v[64:65], v[60:61], v[62:63] op_sel:[1,1,0] op_sel_hi:[1,0,1] neg_lo:[0,1,0]
    v_max_u32_dpp v39, v39, v39 row_shr:4 row_mask:0xf bank_mask:0xf
    ds_write_addtid_b32 v28 offset:864
    v_cvt_pk_f16_f32 v29, v62, v63
    v_pk_mul_f32 v[64:65], v[62:63], v[60:61] op_sel:[0,0] op_sel_hi:[0,1]
    v_pk_fma_f32 v[64:65], v[62:63], v[60:61], v[64:65] op_sel:[1,1,0] op_sel_hi:[1,0,1] neg_lo:[0,1,0]
    v_max_u32_dpp v39, v39, v39 row_shr:8 row_mask:0xf bank_mask:0xf
    ds_write_addtid_b32 v29 offset:1152
    v_cvt_pk_f16_f32 v26, v64, v65
    v_pk_mul_f32 v[62:63], v[64:65], v[60:61] op_sel:[0,0] op_sel_hi:[0,1]
    v_pk_fma_f32 v[62:63], v[64:65], v[60:61], v[62:63] op_sel:[1,1,0] op_sel_hi:[1,0,1] neg_lo:[0,1,0]
    v_max_u32_dpp v39, v39, v39 row_bcast:15 row_mask:0xa bank_mask:0xf
    ds_write_addtid_b32 v26 offset:1440
    v_cvt_pk_f16_f32 v27, v62, v63
    v_pk_mul_f32 v[64:65], v[62:63], v[60:61] op_sel:[0,0] op_sel_hi:[0,1]
    v_pk_fma_f32 v[64:65], v[62:63], v[60:61], v[64:65] op_sel:[1,1,0] op_sel_hi:[1,0,1] neg_lo:[0,1,0]
    v_max_u32_dpp v39, v39, v39 row_bcast:31 row_mask:0xc bank_mask:0xf
    ds_write_addtid_b32 v27 offset:1728
    v_cvt_pk_f16_f32 v28, v64, v65
    v_pk_mul_f32 v[62:63], v[64:65], v[60:61] op_sel:[0,0] op_sel_hi:[0,1]
    v_pk_fma_f32 v[62:63], v[64:65], v[60:61], v[62:63] op_sel:[1,1,0] op_sel_hi:[1,0,1] neg_lo:[0,1,0]
    v_readlane_b32 s8, v39, 63
    ds_write_addtid_b32 v28 offset:2016
    v_cvt_pk_f16_f32 v29, v62, v63
    v_pk_mul_f32 v[64:65], v[62:63], v[60:61] op_sel:[0,0] op_sel_hi:[0,1]
    v_pk_fma_f32 v[64:65], v[62:63], v[60:61], v[64:65] op_sel:[1,1,0] op_sel_hi:[1,0,1] neg_lo:[0,1,0]
    ds_write_addtid_b32 v29 offset:2304
    v_cvt_pk_f16_f32 v26, v64, v65
    v_pk_mul_f32 v[62:63], v[64:65], v[60:61] op_sel:[0,0] op_sel_hi:[0,1]
    v_pk_fma_f32 v[62:63], v[64:65], v[60:61], v[62:63] op_sel:[1,1,0] op_sel_hi:[1,0,1] neg_lo:[0,1,0]
    ds_write_addtid_b32 v26 offset:2592
    v_cvt_pk_f16_f32 v27, v62, v63
    v_pk_mul_f32 v[64:65], v[62:63], v[60:61] op_sel:[0,0] op_sel_hi:[0,1]
    v_pk_fma_f32 v[64:65], v[62:63], v[60:61], v[64:65] op_sel:[1,1,0] op_sel_hi:[1,0,1] neg_lo:[0,1,0]
    ds_write_addtid_b32 v27 offset:2880
    v_cvt_pk_f16_f32 v28, v64, v65
    v_pk_mul_f32 v[62:63], v[64:65], v[60:61] op_sel:[0,0] op_sel_hi:[0,1]
    v_pk_fma_f32 v[62:63], v[64:65], v[60:61], v[62:63] op_sel:[1,1,0] op_sel_hi:[1,0,1] neg_lo:[0,1,0]
    ds_write_addtid_b32 v28 offset:3168
    v_cvt_pk_f16_f32 v29, v62, v63
    v_pk_mul_f32 v[64:65], v[62:63], v[60:61] op_sel:[0,0] op_sel_hi:[0,1]
    v_pk_fma_f32 v[64:65], v[62:63], v[60:61], v[64:65] op_sel:[1,1,0] op_sel_hi:[1,0,1] neg_lo:[0,1,0]
    ds_write_addtid_b32 v29 offset:3456
    v_cvt_pk_f16_f32 v26, v64, v65
    v_pk_mul_f32 v[62:63], v[64:65], v[60:61] op_sel:[0,0] op_sel_hi:[0,1]
    v_pk_fma_f32 v[62:63], v[64:65], v[60:61], v[62:63] op_sel:[1,1,0] op_sel_hi:[1,0,1] neg_lo:[0,1,0]
    ds_write_addtid_b32 v26 offset:3744
    v_cvt_pk_f16_f32 v27, v62, v63
    v_pk_mul_f32 v[64:65], v[62:63], v[60:61] op_sel:[0,0] op_sel_hi:[0,1]
    v_pk_fma_f32 v[64:65], v[62:63], v[60:61], v[64:65] op_sel:[1,1,0] op_sel_hi:[1,0,1] neg_lo:[0,1,0]
    ds_write_addtid_b32 v27 offset:4032
    v_cvt_pk_f16_f32 v28, v64, v65
    s_lshr_b32 s8, s8, 23
    s_sub_u32 s8, 258, s8
    s_min_u32 s54, s8, 253
    s_lshl_b32 s8, s54, 23
    v_mul_f32 v42, s8, v42
    v_mul_f32 v43, s8, v43
    ds_write_addtid_b32 v28 offset:4320
    ds_read_b128 v[72:75], v7 offset:0
    ds_read_b128 v[76:79], v7 offset:64
    ds_read_b128 v[80:83], v7 offset:128
    ds_read_b128 v[84:87], v7 offset:192
    v_mul_f32 v44, 0x43000000, v40
    v_mul_f32 v45, 0x43000000, v41
    v_exp_f32 v24, v44
    v_fract_f32 v45, v45
    v_cos_f32 v44, v45
    v_sin_f32 v45, v45
    v_mul_f32 v44, v24, v44
    v_mul_f32 v45, v24, v45
    v_pk_mul_f32 v[50:51], v[48:49], v[46:47] op_sel:[0,0] op_sel_hi:[0,1]
    v_pk_fma_f32 v[50:51], v[48:49], v[46:47], v[50:51] op_sel:[1,1,0] op_sel_hi:[1,0,1] neg_lo:[0,1,0]
    v_pk_mul_f32 v[54:55], v[52:53], v[46:47] op_sel:[0,0] op_sel_hi:[0,1]
    v_pk_fma_f32 v[54:55], v[52:53], v[46:47], v[54:55] op_sel:[1,1,0] op_sel_hi:[1,0,1] neg_lo:[0,1,0]
    v_pk_mul_f32 v[56:57], v[50:51], v[50:51] op_sel:[0,0] op_sel_hi:[0,1]
    v_pk_fma_f32 v[56:57], v[50:51], v[50:51], v[56:57] op_sel:[1,1,0] op_sel_hi:[1,0,1] neg_lo:[0,1,0]
    v_pk_mul_f32 v[58:59], v[56:57], v[46:47] op_sel:[0,0] op_sel_hi:[0,1]
    v_pk_fma_f32 v[58:59], v[56:57], v[46:47], v[58:59] op_sel:[1,1,0] op_sel_hi:[1,0,1] neg_lo:[0,1,0]
    v_cvt_pk_f16_f32 v29, v42, v43
    v_pk_mul_f32 v[60:61], v[42:43], v[46:47] op_sel:[0,0] op_sel_hi:[0,1]
    v_pk_fma_f32 v[60:61], v[42:43], v[46:47], v[60:61] op_sel:[1,1,0] op_sel_hi:[1,0,1] neg_lo:[0,1,0]
    ds_write_addtid_b32 v29 offset:0
    v_cvt_pk_f16_f32 v26, v60, v61
    v_pk_mul_f32 v[62:63], v[42:43], v[48:49] op_sel:[0,0] op_sel_hi:[0,1]
    v_pk_fma_f32 v[62:63], v[42:43], v[48:49], v[62:63] op_sel:[1,1,0] op_sel_hi:[1,0,1] neg_lo:[0,1,0]
    ds_write_addtid_b32 v26 offset:288
    v_cvt_pk_f16_f32 v27, v62, v63
    v_pk_mul_f32 v[60:61], v[42:43], v[50:51] op_sel:[0,0] op_sel_hi:[0,1]
    v_pk_fma_f32 v[60:61], v[42:43], v[50:51], v[60:61] op_sel:[1,1,0] op_sel_hi:[1,0,1] neg_lo:[0,1,0]
    ds_write_addtid_b32 v27 offset:576
    v_cvt_pk_f16_f32 v28, v60, v61
    v_pk_mul_f32 v[62:63], v[42:43], v[52:53] op_sel:[0,0] op_sel_hi:[0,1]
    v_pk_fma_f32 v[62:63], v[42:43], v[52:53], v[62:63] op_sel:[1,1,0] op_sel_hi:[1,0,1] neg_lo:[0,1,0]
    ds_write_addtid_b32 v28 offset:864
    v_cvt_pk_f16_f32 v29, v62, v63
    v_pk_mul_f32 v[60:61], v[42:43], v[54:55] op_sel:[0,0] op_sel_hi:[0,1]
    v_pk_fma_f32 v[60:61], v[42:43], v[54:55], v[60:61] op_sel:[1,1,0] op_sel_hi:[1,0,1] neg_lo:[0,1,0]
    ds_write_addtid_b32 v29 offset:1152
    v_cvt_pk_f16_f32 v26, v60, v61
    v_pk_mul_f32 v[62:63], v[42:43], v[56:57] op_sel:[0,0] op_sel_hi:[0,1]
    v_pk_fma_f32 v[62:63], v[42:43], v[56:57], v[62:63] op_sel:[1,1,0] op_sel_hi:[1,0,1] neg_lo:[0,1,0]
    ds_write_addtid_b32 v26 offset:1440
    v_cvt_pk_f16_f32 v27, v62, v63
    v_pk_mul_f32 v[60:61], v[42:43], v[58:59] op_sel:[0,0] op_sel_hi:[0,1]
    v_pk_fma_f32 v[60:61], v[42:43], v[58:59], v[60:61] op_sel:[1,1,0] op_sel_hi:[1,0,1] neg_lo:[0,1,0]
    ds_write_addtid_b32 v27 offset:1728
    v_cvt_pk_f16_f32 v28, v60, v61
    v_pk_mul_f32 v[66:67], v[42:43], v[44:45] op_sel:[0,0] op_sel_hi:[0,1]
    v_pk_fma_f32 v[66:67], v[42:43], v[44:45], v[66:67] op_sel:[1,1,0] op_sel_hi:[1,0,1] neg_lo:[0,1,0]
    ds_write_addtid_b32 v28 offset:2016
    v_cvt_pk_f16_f32 v29, v66, v67
    v_pk_mul_f32 v[62:63], v[66:67], v[46:47] op_sel:[0,0] op_sel_hi:[0,1]
    v_pk_fma_f32 v[62:63], v[66:67], v[46:47], v[62:63] op_sel:[1,1,0] op_sel_hi:[1,0,1] neg_lo:[0,1,0]
    ds_write_addtid_b32 v29 offset:2304
    v_cvt_pk_f16_f32 v26, v62, v63
    v_pk_mul_f32 v[60:61], v[66:67], v[48:49] op_sel:[0,0] op_sel_hi:[0,1]
    v_pk_fma_f32 v[60:61], v[66:67], v[48:49], v[60:61] op_sel:[1,1,0] op_sel_hi:[1,0,1] neg_lo:[0,1,0]
    ds_write_addtid_b32 v26 offset:2592
    v_cvt_pk_f16_f32 v27, v60, v61
    v_pk_mul_f32 v[62:63], v[66:67], v[50:51] op_sel:[0,0] op_sel_hi:[0,1]
    v_pk_fma_f32 v[62:63], v[66:67], v[50:51], v[62:63] op_sel:[1,1,0] op_sel_hi:[1,0,1] neg_lo:[0,1,0]
    ds_write_addtid_b32 v27 offset:2880
    v_cvt_pk_f16_f32 v28, v62, v63
    v_pk_mul_f32 v[60:61], v[66:67], v[52:53] op_sel:[0,0] op_sel_hi:[0,1]
    v_pk_fma_f32 v[60:61], v[66:67], v[52:53], v[60:61] op_sel:[1,1,0] op_sel_hi:[1,0,1] neg_lo:[0,1,0]
    ds_write_addtid_b32 v28 offset:3168
    v_cvt_pk_f16_f32 v29, v60, v61
    v_pk_mul_f32 v[62:63], v[66:67], v[54:55] op_sel:[0,0] op_sel_hi:[0,1]
    v_pk_fma_f32 v[62:63], v[66:67], v[54:55], v[62:63] op_sel:[1,1,0] op_sel_hi:[1,0,1] neg_lo:[0,1,0]
    ds_write_addtid_b32 v29 offset:3456
    v_cvt_pk_f16_f32 v26, v62, v63
    v_pk_mul_f32 v[60:61], v[66:67], v[56:57] op_sel:[0,0] op_sel_hi:[0,1]
    v_pk_fma_f32 v[60:61], v[66:67], v[56:57], v[60:61] op_sel:[1,1,0] op_sel_hi:[1,0,1] neg_lo:[0,1,0]
    ds_write_addtid_b32 v26 offset:3744
    v_cvt_pk_f16_f32 v27, v60, v61
    v_pk_mul_f32 v[62:63], v[66:67], v[58:59] op_sel:[0,0] op_sel_hi:[0,1]
    v_pk_fma_f32 v[62:63], v[66:67], v[58:59], v[62:63] op_sel:[1,1,0] op_sel_hi:[1,0,1] neg_lo:[0,1,0]
    ds_write_addtid_b32 v27 offset:4032
    v_cvt_pk_f16_f32 v28, v62, v63
    v_pk_mul_f32 v[68:69], v[66:67], v[44:45] op_sel:[0,0] op_sel_hi:[0,1]
    v_pk_fma_f32 v[68:69], v[66:67], v[44:45], v[68:69] op_sel:[1,1,0] op_sel_hi:[1,0,1] neg_lo:[0,1,0]
    ds_write_addtid_b32 v28 offset:4320
    ds_read_b128 v[88:91], v7 offset:0
    ds_read_b128 v[92:95], v7 offset:64
    ds_read_b128 v[96:99], v7 offset:128
    ds_read_b128 v[100:103], v7 offset:192
    v_cvt_pk_f16_f32 v29, v68, v69
    v_pk_mul_f32 v[60:61], v[68:69], v[48:49] op_sel:[0,0] op_sel_hi:[0,1]
    v_pk_fma_f32 v[60:61], v[68:69], v[48:49], v[60:61] op_sel:[1,1,0] op_sel_hi:[1,0,1] neg_lo:[0,1,0]
    ds_write_addtid_b32 v29 offset:0
    v_cvt_pk_f16_f32 v26, v60, v61
    v_pk_mul_f32 v[62:63], v[68:69], v[52:53] op_sel:[0,0] op_sel_hi:[0,1]
    v_pk_fma_f32 v[62:63], v[68:69], v[52:53], v[62:63] op_sel:[1,1,0] op_sel_hi:[1,0,1] neg_lo:[0,1,0]
    ds_write_addtid_b32 v26 offset:288
    v_cvt_pk_f16_f32 v27, v62, v63
    v_pk_mul_f32 v[60:61], v[68:69], v[56:57] op_sel:[0,0] op_sel_hi:[0,1]
    v_pk_fma_f32 v[60:61], v[68:69], v[56:57], v[60:61] op_sel:[1,1,0] op_sel_hi:[1,0,1] neg_lo:[0,1,0]
    ds_write_addtid_b32 v27 offset:576
    v_cvt_pk_f16_f32 v28, v60, v61
    v_pk_mul_f32 v[66:67], v[68:69], v[44:45] op_sel:[0,0] op_sel_hi:[0,1]
    v_pk_fma_f32 v[66:67], v[68:69], v[44:45], v[66:67] op_sel:[1,1,0] op_sel_hi:[1,0,1] neg_lo:[0,1,0]
    ds_write_addtid_b32 v28 offset:864
    v_cvt_pk_f16_f32 v29, v66, v67
    s_waitcnt lgkmcnt(7)
    v_mfma_f32_16x16x32_f16 v[104:107], v[88:91], v[72:75], 0
    v_pk_mul_f32 v[62:63], v[66:67], v[48:49] op_sel:[0,0] op_sel_hi:[0,1]
    v_pk_fma_f32 v[62:63], v[66:67], v[48:49], v[62:63] op_sel:[1,1,0] op_sel_hi:[1,0,1] neg_lo:[0,1,0]
    ds_write_addtid_b32 v29 offset:1152
    v_cvt_pk_f16_f32 v26, v62, v63
    s_waitcnt lgkmcnt(7)
    v_mfma_f32_16x16x32_f16 v[104:107], v[92:95], v[76:79], v[104:107]
    v_pk_mul_f32 v[60:61], v[66:67], v[52:53] op_sel:[0,0] op_sel_hi:[0,1]
    v_pk_fma_f32 v[60:61], v[66:67], v[52:53], v[60:61] op_sel:[1,1,0] op_sel_hi:[1,0,1] neg_lo:[0,1,0]
    ds_write_addtid_b32 v26 offset:1440
    v_cvt_pk_f16_f32 v27, v60, v61
    s_waitcnt lgkmcnt(7)
    v_mfma_f32_16x16x32_f16 v[104:107], v[96:99], v[80:83], v[104:107]
    v_pk_mul_f32 v[62:63], v[66:67], v[56:57] op_sel:[0,0] op_sel_hi:[0,1]
    v_pk_fma_f32 v[62:63], v[66:67], v[56:57], v[62:63] op_sel:[1,1,0] op_sel_hi:[1,0,1] neg_lo:[0,1,0]
    ds_write_addtid_b32 v27 offset:1728
    v_cvt_pk_f16_f32 v28, v62, v63
    s_waitcnt lgkmcnt(7)
    v_mfma_f32_16x16x32_f16 v[104:107], v[100:103], v[84:87], v[104:107]
    v_pk_mul_f32 v[68:69], v[66:67], v[44:45] op_sel:[0,0] op_sel_hi:[0,1]
    v_pk_fma_f32 v[68:69], v[66:67], v[44:45], v[68:69] op_sel:[1,1,0] op_sel_hi:[1,0,1] neg_lo:[0,1,0]
    ds_write_addtid_b32 v28 offset:2016
    v_cvt_pk_f16_f32 v29, v68, v69
    v_pk_mul_f32 v[60:61], v[68:69], v[52:53] op_sel:[0,0] op_sel_hi:[0,1]
    v_pk_fma_f32 v[60:61], v[68:69], v[52:53], v[60:61] op_sel:[1,1,0] op_sel_hi:[1,0,1] neg_lo:[0,1,0]
    ds_write_addtid_b32 v29 offset:2304
    v_cvt_pk_f16_f32 v26, v60, v61
    v_pk_mul_f32 v[66:67], v[68:69], v[44:45] op_sel:[0,0] op_sel_hi:[0,1]
    v_pk_fma_f32 v[66:67], v[68:69], v[44:45], v[66:67] op_sel:[1,1,0] op_sel_hi:[1,0,1] neg_lo:[0,1,0]
    ds_write_addtid_b32 v26 offset:2592
    v_cvt_pk_f16_f32 v27, v66, v67
    v_pk_mul_f32 v[62:63], v[66:67], v[52:53] op_sel:[0,0] op_sel_hi:[0,1]
    v_pk_fma_f32 v[62:63], v[66:67], v[52:53], v[62:63] op_sel:[1,1,0] op_sel_hi:[1,0,1] neg_lo:[0,1,0]
    ds_write_addtid_b32 v27 offset:2880
    v_cvt_pk_f16_f32 v28, v62, v63
    v_pk_mul_f32 v[68:69], v[66:67], v[44:45] op_sel:[0,0] op_sel_hi:[0,1]
    v_pk_fma_f32 v[68:69], v[66:67], v[44:45], v[68:69] op_sel:[1,1,0] op_sel_hi:[1,0,1] neg_lo:[0,1,0]
    ds_write_addtid_b32 v28 offset:3168
    v_cvt_pk_f16_f32 v29, v68, v69
    v_pk_mul_f32 v[60:61], v[68:69], v[52:53] op_sel:[0,0] op_sel_hi:[0,1]
    v_pk_fma_f32 v[60:61], v[68:69], v[52:53], v[60:61] op_sel:[1,1,0] op_sel_hi:[1,0,1] neg_lo:[0,1,0]
    ds_write_addtid_b32 v29 offset:3456
    v_cvt_pk_f16_f32 v26, v60, v61
    v_pk_mul_f32 v[66:67], v[68:69], v[44:45] op_sel:[0,0] op_sel_hi:[0,1]
    v_pk_fma_f32 v[66:67], v[68:69], v[44:45], v[66:67] op_sel:[1,1,0] op_sel_hi:[1,0,1] neg_lo:[0,1,0]
    ds_write_addtid_b32 v26 offset:3744
    v_cvt_pk_f16_f32 v27, v66, v67
    v_pk_mul_f32 v[62:63], v[66:67], v[52:53] op_sel:[0,0] op_sel_hi:[0,1]
    v_pk_fma_f32 v[62:63], v[66:67], v[52:53], v[62:63] op_sel:[1,1,0] op_sel_hi:[1,0,1] neg_lo:[0,1,0]
    ds_write_addtid_b32 v27 offset:4032
    v_cvt_pk_f16_f32 v28, v62, v63
    v_pk_mul_f32 v[68:69], v[66:67], v[44:45] op_sel:[0,0] op_sel_hi:[0,1]
    v_pk_fma_f32 v[68:69], v[66:67], v[44:45], v[68:69] op_sel:[1,1,0] op_sel_hi:[1,0,1] neg_lo:[0,1,0]
    ds_write_addtid_b32 v28 offset:4320
    ds_read_b128 v[88:91], v7 offset:0
    ds_read_b128 v[92:95], v7 offset:64
    ds_read_b128 v[96:99], v7 offset:128
    ds_read_b128 v[100:103], v7 offset:192
    v_cvt_pk_f16_f32 v29, v68, v69
    v_pk_mul_f32 v[66:67], v[68:69], v[44:45] op_sel:[0,0] op_sel_hi:[0,1]
    v_pk_fma_f32 v[66:67], v[68:69], v[44:45], v[66:67] op_sel:[1,1,0] op_sel_hi:[1,0,1] neg_lo:[0,1,0]
    ds_write_addtid_b32 v29 offset:0
    v_cvt_pk_f16_f32 v26, v66, v67
    v_pk_mul_f32 v[68:69], v[66:67], v[44:45] op_sel:[0,0] op_sel_hi:[0,1]
    v_pk_fma_f32 v[68:69], v[66:67], v[44:45], v[68:69] op_sel:[1,1,0] op_sel_hi:[1,0,1] neg_lo:[0,1,0]
    ds_write_addtid_b32 v26 offset:288
    v_cvt_pk_f16_f32 v27, v68, v69
    v_pk_mul_f32 v[66:67], v[68:69], v[44:45] op_sel:[0,0] op_sel_hi:[0,1]
    v_pk_fma_f32 v[66:67], v[68:69], v[44:45], v[66:67] op_sel:[1,1,0] op_sel_hi:[1,0,1] neg_lo:[0,1,0]
    ds_write_addtid_b32 v27 offset:576
    v_cvt_pk_f16_f32 v28, v66, v67
    v_pk_mul_f32 v[68:69], v[66:67], v[44:45] op_sel:[0,0] op_sel_hi:[0,1]
    v_pk_fma_f32 v[68:69], v[66:67], v[44:45], v[68:69] op_sel:[1,1,0] op_sel_hi:[1,0,1] neg_lo:[0,1,0]
    ds_write_addtid_b32 v28 offset:864
    v_cvt_pk_f16_f32 v29, v68, v69
    v_pk_mul_f32 v[66:67], v[68:69], v[44:45] op_sel:[0,0] op_sel_hi:[0,1]
    v_pk_fma_f32 v[66:67], v[68:69], v[44:45], v[66:67] op_sel:[1,1,0] op_sel_hi:[1,0,1] neg_lo:[0,1,0]
    s_waitcnt lgkmcnt(7)
    v_mfma_f32_16x16x32_f16 v[108:111], v[88:91], v[72:75], 0
    ds_write_addtid_b32 v29 offset:1152
    v_cvt_pk_f16_f32 v26, v66, v67
    v_pk_mul_f32 v[68:69], v[66:67], v[44:45] op_sel:[0,0] op_sel_hi:[0,1]
    v_pk_fma_f32 v[68:69], v[66:67], v[44:45], v[68:69] op_sel:[1,1,0] op_sel_hi:[1,0,1] neg_lo:[0,1,0]
    s_waitcnt lgkmcnt(7)
    v_mfma_f32_16x16x32_f16 v[108:111], v[92:95], v[76:79], v[108:111]
    ds_write_addtid_b32 v26 offset:1440
    v_cvt_pk_f16_f32 v27, v68, v69
    v_pk_mul_f32 v[66:67], v[68:69], v[44:45] op_sel:[0,0] op_sel_hi:[0,1]
    v_pk_fma_f32 v[66:67], v[68:69], v[44:45], v[66:67] op_sel:[1,1,0] op_sel_hi:[1,0,1] neg_lo:[0,1,0]
    s_waitcnt lgkmcnt(7)
    v_mfma_f32_16x16x32_f16 v[108:111], v[96:99], v[80:83], v[108:111]
    ds_write_addtid_b32 v27 offset:1728
    v_cvt_pk_f16_f32 v28, v66, v67
    v_pk_mul_f32 v[68:69], v[66:67], v[44:45] op_sel:[0,0] op_sel_hi:[0,1]
    v_pk_fma_f32 v[68:69], v[66:67], v[44:45], v[68:69] op_sel:[1,1,0] op_sel_hi:[1,0,1] neg_lo:[0,1,0]
    s_waitcnt lgkmcnt(7)
    v_mfma_f32_16x16x32_f16 v[108:111], v[100:103], v[84:87], v[108:111]
    ds_write_addtid_b32 v28 offset:2016
    v_cvt_pk_f16_f32 v29, v68, v69
    ds_write_addtid_b32 v29 offset:2304
    ds_read_b128 v[88:91], v7 offset:0
    ds_read_b128 v[92:95], v7 offset:64
    ds_read_b128 v[96:99], v7 offset:128
    ds_read_b128 v[100:103], v7 offset:192
    v_lshl_add_u32 v8, v2, 4, s15
    s_waitcnt lgkmcnt(3)
    v_mfma_f32_16x16x32_f16 v[112:115], v[88:91], v[72:75], 0
    s_waitcnt lgkmcnt(2)
    v_mfma_f32_16x16x32_f16 v[112:115], v[92:95], v[76:79], v[112:115]
    s_waitcnt lgkmcnt(1)
    v_mfma_f32_16x16x32_f16 v[112:115], v[96:99], v[80:83], v[112:115]
    s_waitcnt lgkmcnt(0)
    v_mfma_f32_16x16x32_f16 v[112:115], v[100:103], v[84:87], v[112:115]
    s_lshl_b32 s8, s12, 2
    s_add_u32 s8, s8, 16
    v_mov_b32 v9, s8
    s_cmp_eq_u32 s13, 0
    s_cbranch_scc1 C_KA
    ds_write_b128 v8, v[104:107] offset:0
    ds_write_b128 v8, v[108:111] offset:1024
    s_nop 0
    ds_write_b128 v8, v[112:115] offset:2048
    v_mov_b32 v10, s54
    ds_write_b32 v9, v10
    s_setprio 0
    v_and_b32 v14, 3, v3
    v_sub_u32 v14, 3, v14
    v_mul_u32_u24 v14, 1216, v14
    v_lshrrev_b32 v13, 2, v3
    v_lshl_add_u32 v13, v4, 1, v13
    v_lshl_add_u32 v14, v13, 3, v14
    v_add3_u32 v5, v14, s52, 8
    v_lshlrev_b32 v14, 1, v3
    v_sub_u32 v14, v4, v14
    v_lshlrev_b32 v14, 4, v14
    s_add_u32 s8, s53, 480
    v_add_u32 v6, s8, v14
    v_lshl_add_u32 v14, v3, 2, v4
    s_mul_i32 s8, s12, 4160
    s_add_u32 s8, s8, 83960
    v_lshlrev_b32 v14, 3, v14
    v_sub_u32 v7, s8, v14
    s_setprio 3
    s_mov_b32 s9, 0
SP_22:
    ds_read_b32 v10, v1 offset:80
    s_waitcnt lgkmcnt(0)
    v_readfirstlane_b32 s8, v10
    s_add_u32 s9, s9, 1
    s_cmp_ge_u32 s8, 1
    s_cbranch_scc1 SP_22_D
    s_sleep 1
    s_cmp_lt_u32 s9, 524288
    s_cbranch_scc1 SP_22
SP_22_D:
    s_setprio 3
    s_mov_b32 s9, 0
SP_23:
    ds_read_b32 v10, v9 offset:48
    s_waitcnt lgkmcnt(0)
    v_readfirstlane_b32 s8, v10
    s_add_u32 s9, s9, 1
    s_cmp_lg_u32 s8, 0
    s_cbranch_scc1 SP_23_D
    s_cmp_lt_u32 s9, 524288
    s_cbranch_scc1 SP_23
SP_23_D:
    s_setprio 2
    v_subrev_u32 v8, 18432, v8
    v_cmp_eq_u32 vcc, 0, v2
    v_mov_b32 v13, 96
    s_nop 0
    v_cndmask_b32 v12, 0, 1, vcc
    v_lshlrev_b32 v14, 2, v2
    v_add_u32 v14, 105216, v14
    v_cndmask_b32 v13, v14, v13, vcc
    ds_read_b64 v[40:41], v5 offset:0
    ds_read_b64 v[42:43], v5 offset:8
    ds_read_b128 v[104:107], v6 offset:3584
    ds_read_b64 v[72:73], v5 offset:512
    ds_read_b64 v[74:75], v5 offset:520
    ds_read_b128 v[108:111], v6 offset:3648
    ds_read_b64 v[44:45], v5 offset:64
    ds_read_b64 v[46:47], v5 offset:72
    ds_read_b64 v[76:77], v5 offset:576
    ds_read_b64 v[78:79], v5 offset:584
    ds_read_b128 v[112:115], v6 offset:3712
    ds_read_b128 v[116:119], v6 offset:3776
    s_waitcnt lgkmcnt(9)
    v_mfma_f32_16x16x32_bf16 v[16:19], v[40:43], v[104:107], 0
    ds_read_b64 v[48:49], v5 offset:128
    ds_read_b64 v[50:51], v5 offset:136
    s_waitcnt lgkmcnt(9)
    v_mfma_f32_16x16x32_bf16 v[20:23], v[72:75], v[104:107], 0
    ds_read_b128 v[120:123], v6 offset:3840
    ds_read_b64 v[80:81], v5 offset:640
    ds_read_b64 v[82:83], v5 offset:648
    s_waitcnt lgkmcnt(9)
    v_mfma_f32_16x16x32_bf16 v[16:19], v[44:47], v[108:111], v[16:19]
    ds_read_b64 v[52:53], v5 offset:192
    ds_read_b64 v[54:55], v5 offset:200
    s_waitcnt lgkmcnt(9)
    v_mfma_f32_16x16x32_bf16 v[20:23], v[76:79], v[108:111], v[20:23]
    ds_read_b128 v[124:127], v6 offset:3904
    ds_read_b64 v[84:85], v5 offset:704
    ds_read_b64 v[86:87], v5 offset:712
    s_waitcnt lgkmcnt(8)
    v_mfma_f32_16x16x32_bf16 v[16:19], v[48:51], v[112:115], v[16:19]
    ds_read_b64 v[56:57], v5 offset:256
    ds_read_b64 v[58:59], v5 offset:264
    s_waitcnt lgkmcnt(7)
    v_mfma_f32_16x16x32_bf16 v[20:23], v[80:83], v[112:115], v[20:23]
    ds_read_b128 v[104:107], v6 offset:3968
    ds_read_b64 v[88:89], v5 offset:768
    ds_read_b64 v[90:91], v5 offset:776
    s_waitcnt lgkmcnt(8)
    v_mfma_f32_16x16x32_bf16 v[16:19], v[52:55], v[116:119], v[16:19]
    ds_read_b64 v[60:61], v5 offset:320
    ds_read_b64 v[62:63], v5 offset:328
    s_waitcnt lgkmcnt(7)
    v_mfma_f32_16x16x32_bf16 v[20:23], v[84:87], v[116:119], v[20:23]
    ds_read_b128 v[108:111], v6 offset:4032
    ds_read_b64 v[92:93], v5 offset:832
    ds_read_b64 v[94:95], v5 offset:840
    s_waitcnt lgkmcnt(8)
    v_mfma_f32_16x16x32_bf16 v[16:19], v[56:59], v[120:123], v[16:19]
    ds_read_b64 v[64:65], v5 offset:384
    ds_read_b64 v[66:67], v5 offset:392
    ds_read_b32 v28, v1 offset:80
    ds_read_b32 v29, v9 offset:32
    s_waitcnt lgkmcnt(9)
    v_mfma_f32_16x16x32_bf16 v[20:23], v[88:91], v[120:123], v[20:23]
    ds_read_b128 v[112:115], v6 offset:3072
    ds_read_b64 v[96:97], v5 offset:896
    ds_read_b64 v[98:99], v5 offset:904
    s_waitcnt lgkmcnt(10)
    v_mfma_f32_16x16x32_bf16 v[16:19], v[60:63], v[124:127], v[16:19]
    ds_read_b64 v[68:69], v5 offset:448
    ds_read_b64 v[70:71], v5 offset:456
    s_waitcnt lgkmcnt(9)
    v_mfma_f32_16x16x32_bf16 v[20:23], v[92:95], v[124:127], v[20:23]
    ds_read_b128 v[116:119], v6 offset:3136
    ds_read_b64 v[100:101], v5 offset:960
    ds_read_b64 v[102:103], v5 offset:968
    s_waitcnt lgkmcnt(10)
    v_mfma_f32_16x16x32_bf16 v[16:19], v[64:67], v[104:107], v[16:19]
    s_waitcnt lgkmcnt(5)
    v_mfma_f32_16x16x32_bf16 v[20:23], v[96:99], v[104:107], v[20:23]
    ds_read_b128 v[120:123], v6 offset:3200
    v_readfirstlane_b32 s9, v29
    s_waitcnt lgkmcnt(4)
    v_mfma_f32_16x16x32_bf16 v[16:19], v[68:71], v[108:111], v[16:19]
    v_readfirstlane_b32 s8, v28
    s_add_u32 s9, s9, 2
    s_waitcnt lgkmcnt(1)
    v_mfma_f32_16x16x32_bf16 v[20:23], v[100:103], v[108:111], v[20:23]
    ds_read_b128 v[124:127], v6 offset:3264
    s_cmp_lt_u32 s8, 2
    s_cbranch_scc1 C_SLOW0
KEEP_P0:
    v_mfma_f32_16x16x32_bf16 v[20:23], v[40:43], v[112:115], v[20:23]
    v_mfma_f32_16x16x32_bf16 v[24:27], v[72:75], v[112:115], 0
    ds_read_b128 v[104:107], v6 offset:3328
    v_mfma_f32_16x16x32_bf16 v[20:23], v[44:47], v[116:119], v[20:23]
    v_mfma_f32_16x16x32_bf16 v[24:27], v[76:79], v[116:119], v[24:27]
    ds_read_b128 v[108:111], v6 offset:3392
    s_waitcnt lgkmcnt(3)
    v_mfma_f32_16x16x32_bf16 v[20:23], v[48:51], v[120:123], v[20:23]
    v_cvt_pk_bf16_f32 v30, v19, v18
    v_cvt_pk_bf16_f32 v31, v17, v16
    v_mfma_f32_16x16x32_bf16 v[24:27], v[80:83], v[120:123], v[24:27]
    ds_read_b128 v[112:115], v6 offset:3456
    ds_write_b64 v7, v[30:31] offset:3584
    s_waitcnt lgkmcnt(4)
    v_mfma_f32_16x16x32_bf16 v[20:23], v[52:55], v[124:127], v[20:23]
    v_mfma_f32_16x16x32_bf16 v[24:27], v[84:87], v[124:127], v[24:27]
    ds_read_b128 v[116:119], v6 offset:3520
    s_waitcnt lgkmcnt(4)
    v_mfma_f32_16x16x32_bf16 v[20:23], v[56:59], v[104:107], v[20:23]
    ds_read_b32 v28, v1 offset:80
    ds_read_b32 v29, v9 offset:32
    v_mfma_f32_16x16x32_bf16 v[24:27], v[88:91], v[104:107], v[24:27]
    ds_read_b128 v[120:123], v6 offset:2560
    s_waitcnt lgkmcnt(6)
    v_mfma_f32_16x16x32_bf16 v[20:23], v[60:63], v[108:111], v[20:23]
    v_mfma_f32_16x16x32_bf16 v[24:27], v[92:95], v[108:111], v[24:27]
    ds_read_b128 v[124:127], v6 offset:2624
    s_waitcnt lgkmcnt(6)
    v_mfma_f32_16x16x32_bf16 v[20:23], v[64:67], v[112:115], v[20:23]
    v_mfma_f32_16x16x32_bf16 v[24:27], v[96:99], v[112:115], v[24:27]
    ds_read_b128 v[104:107], v6 offset:2688
    s_waitcnt lgkmcnt(3)
    v_readfirstlane_b32 s9, v29
    v_mfma_f32_16x16x32_bf16 v[20:23], v[68:71], v[116:119], v[20:23]
    v_readfirstlane_b32 s8, v28
    s_add_u32 s9, s9, 2
    v_mfma_f32_16x16x32_bf16 v[24:27], v[100:103], v[116:119], v[24:27]
    ds_read_b128 v[108:111], v6 offset:2752
    s_cmp_lt_u32 s8, 3
    s_cbranch_scc1 C_SLOW1
KEEP_P1:
    s_waitcnt lgkmcnt(3)
    v_mfma_f32_16x16x32_bf16 v[24:27], v[40:43], v[120:123], v[24:27]
    v_mfma_f32_16x16x32_bf16 v[16:19], v[72:75], v[120:123], 0
    ds_read_b128 v[112:115], v6 offset:2816
    s_waitcnt lgkmcnt(3)
    v_mfma_f32_16x16x32_bf16 v[24:27], v[44:47], v[124:127], v[24:27]
    v_mfma_f32_16x16x32_bf16 v[16:19], v[76:79], v[124:127], v[16:19]
    ds_read_b128 v[116:119], v6 offset:2880
    s_waitcnt lgkmcnt(3)
    v_mfma_f32_16x16x32_bf16 v[24:27], v[48:51], v[104:107], v[24:27]
    v_cvt_pk_bf16_f32 v30, v23, v22
    v_cvt_pk_bf16_f32 v31, v21, v20
    v_mfma_f32_16x16x32_bf16 v[16:19], v[80:83], v[104:107], v[16:19]
    ds_read_b128 v[120:123], v6 offset:2944
    ds_write_b64 v7, v[30:31] offset:3072
    ds_add_u32 v13, v12 offset:0
    s_waitcnt lgkmcnt(5)
    v_mfma_f32_16x16x32_bf16 v[24:27], v[52:55], v[108:111], v[24:27]
    v_mfma_f32_16x16x32_bf16 v[16:19], v[84:87], v[108:111], v[16:19]
    ds_read_b128 v[124:127], v6 offset:3008
    s_waitcnt lgkmcnt(5)
    v_mfma_f32_16x16x32_bf16 v[24:27], v[56:59], v[112:115], v[24:27]
    ds_read_b32 v28, v1 offset:80
    ds_read_b32 v29, v9 offset:32
    v_mfma_f32_16x16x32_bf16 v[16:19], v[88:91], v[112:115], v[16:19]
    ds_read_b128 v[104:107], v6 offset:2048
    s_waitcnt lgkmcnt(7)
    v_mfma_f32_16x16x32_bf16 v[24:27], v[60:63], v[116:119], v[24:27]
    ds_read_b128 v[32:35], v8 offset:0
    v_mfma_f32_16x16x32_bf16 v[16:19], v[92:95], v[116:119], v[16:19]
    ds_read_b128 v[108:111], v6 offset:2112
    s_waitcnt lgkmcnt(8)
    v_mfma_f32_16x16x32_bf16 v[24:27], v[64:67], v[120:123], v[24:27]
    v_mfma_f32_16x16x32_bf16 v[16:19], v[96:99], v[120:123], v[16:19]
    ds_read_b128 v[112:115], v6 offset:2176
    s_waitcnt lgkmcnt(4)
    v_readfirstlane_b32 s9, v29
    v_mfma_f32_16x16x32_bf16 v[24:27], v[68:71], v[124:127], v[24:27]
    v_readfirstlane_b32 s8, v28
    s_add_u32 s9, s9, 2
    v_mfma_f32_16x16x32_bf16 v[16:19], v[100:103], v[124:127], v[16:19]
    ds_read_b128 v[116:119], v6 offset:2240
    s_min_u32 s8, s8, s9
    s_cmp_lt_u32 s8, 4
    s_cbranch_scc1 C_SLOW2
KEEP_P2:
    s_waitcnt lgkmcnt(4)
    v_mfma_f32_16x16x32_bf16 v[16:19], v[40:43], v[104:107], v[16:19]
    v_mfma_f32_16x16x32_bf16 v[20:23], v[72:75], v[104:107], 0
    ds_read_b128 v[120:123], v6 offset:2304
    s_waitcnt lgkmcnt(3)
    v_mfma_f32_16x16x32_bf16 v[16:19], v[44:47], v[108:111], v[16:19]
    v_mfma_f32_16x16x32_bf16 v[20:23], v[76:79], v[108:111], v[20:23]
    ds_read_b128 v[124:127], v6 offset:2368
    s_waitcnt lgkmcnt(3)
    v_mfma_f32_16x16x32_bf16 v[16:19], v[48:51], v[112:115], v[16:19]
    v_add_f32 v24, v24, v32
    v_add_f32 v25, v25, v33
    v_mfma_f32_16x16x32_bf16 v[20:23], v[80:83], v[112:115], v[20:23]
    ds_read_b128 v[104:107], v6 offset:2432
    v_add_f32 v26, v26, v34
    v_add_f32 v27, v27, v35
    s_waitcnt lgkmcnt(3)
    v_mfma_f32_16x16x32_bf16 v[16:19], v[52:55], v[116:119], v[16:19]
    v_cvt_pk_bf16_f32 v30, v27, v26
    v_cvt_pk_bf16_f32 v31, v25, v24
    v_mfma_f32_16x16x32_bf16 v[20:23], v[84:87], v[116:119], v[20:23]
    ds_read_b128 v[108:111], v6 offset:2496
    ds_write_b64 v7, v[30:31] offset:2560
    s_waitcnt lgkmcnt(4)
    v_mfma_f32_16x16x32_bf16 v[16:19], v[56:59], v[120:123], v[16:19]
    ds_read_b32 v28, v1 offset:80
    ds_read_b32 v29, v9 offset:32
    v_mfma_f32_16x16x32_bf16 v[20:23], v[88:91], v[120:123], v[20:23]
    ds_read_b128 v[112:115], v6 offset:1536
    s_waitcnt lgkmcnt(6)
    v_mfma_f32_16x16x32_bf16 v[16:19], v[60:63], v[124:127], v[16:19]
    ds_read_b128 v[32:35], v8 offset:1024
    v_mfma_f32_16x16x32_bf16 v[20:23], v[92:95], v[124:127], v[20:23]
    ds_read_b128 v[116:119], v6 offset:1600
    s_waitcnt lgkmcnt(7)
    v_mfma_f32_16x16x32_bf16 v[16:19], v[64:67], v[104:107], v[16:19]
    v_mfma_f32_16x16x32_bf16 v[20:23], v[96:99], v[104:107], v[20:23]
    ds_read_b128 v[120:123], v6 offset:1664
    s_waitcnt lgkmcnt(4)
    v_readfirstlane_b32 s9, v29
    v_mfma_f32_16x16x32_bf16 v[16:19], v[68:71], v[108:111], v[16:19]
    v_readfirstlane_b32 s8, v28
    s_add_u32 s9, s9, 2
    v_mfma_f32_16x16x32_bf16 v[20:23], v[100:103], v[108:111], v[20:23]
    ds_read_b128 v[124:127], v6 offset:1728
    s_min_u32 s8, s8, s9
    s_cmp_lt_u32 s8, 5
    s_cbranch_scc1 C_SLOW3
KEEP_P3:
    s_waitcnt lgkmcnt(4)
    v_mfma_f32_16x16x32_bf16 v[20:23], v[40:43], v[112:115], v[20:23]
    v_mfma_f32_16x16x32_bf16 v[24:27], v[72:75], v[112:115], 0
    ds_read_b128 v[104:107], v6 offset:1792
    s_waitcnt lgkmcnt(3)
    v_mfma_f32_16x16x32_bf16 v[20:23], v[44:47], v[116:119], v[20:23]
    v_mfma_f32_16x16x32_bf16 v[24:27], v[76:79], v[116:119], v[24:27]
    ds_read_b128 v[108:111], v6 offset:1856
    s_waitcnt lgkmcnt(3)
    v_mfma_f32_16x16x32_bf16 v[20:23], v[48:51], v[120:123], v[20:23]
    v_add_f32 v16, v16, v32
    v_add_f32 v17, v17, v33
    v_mfma_f32_16x16x32_bf16 v[24:27], v[80:83], v[120:123], v[24:27]
    ds_read_b128 v[112:115], v6 offset:1920
    v_add_f32 v18, v18, v34
    v_add_f32 v19, v19, v35
    s_waitcnt lgkmcnt(3)
    v_mfma_f32_16x16x32_bf16 v[20:23], v[52:55], v[124:127], v[20:23]
    v_cvt_pk_bf16_f32 v30, v19, v18
    v_cvt_pk_bf16_f32 v31, v17, v16
    v_mfma_f32_16x16x32_bf16 v[24:27], v[84:87], v[124:127], v[24:27]
    ds_read_b128 v[116:119], v6 offset:1984
    ds_write_b64 v7, v[30:31] offset:2048
    ds_add_u32 v13, v12 offset:4
    s_waitcnt lgkmcnt(5)
    v_mfma_f32_16x16x32_bf16 v[20:23], v[56:59], v[104:107], v[20:23]
    ds_read_b32 v28, v1 offset:80
    ds_read_b32 v29, v9 offset:32
    v_mfma_f32_16x16x32_bf16 v[24:27], v[88:91], v[104:107], v[24:27]
    ds_read_b128 v[120:123], v6 offset:1024
    s_waitcnt lgkmcnt(7)
    v_mfma_f32_16x16x32_bf16 v[20:23], v[60:63], v[108:111], v[20:23]
    ds_read_b128 v[32:35], v8 offset:2048
    v_mfma_f32_16x16x32_bf16 v[24:27], v[92:95], v[108:111], v[24:27]
    ds_read_b128 v[124:127], v6 offset:1088
    s_waitcnt lgkmcnt(8)
    v_mfma_f32_16x16x32_bf16 v[20:23], v[64:67], v[112:115], v[20:23]
    v_mfma_f32_16x16x32_bf16 v[24:27], v[96:99], v[112:115], v[24:27]
    ds_read_b128 v[104:107], v6 offset:1152
    s_waitcnt lgkmcnt(4)
    v_readfirstlane_b32 s9, v29
    v_mfma_f32_16x16x32_bf16 v[20:23], v[68:71], v[116:119], v[20:23]
    v_readfirstlane_b32 s8, v28
    s_add_u32 s9, s9, 2
    v_mfma_f32_16x16x32_bf16 v[24:27], v[100:103], v[116:119], v[24:27]
    ds_read_b128 v[108:111], v6 offset:1216
    s_min_u32 s8, s8, s9
    s_cmp_lt_u32 s8, 6
    s_cbranch_scc1 C_SLOW4
KEEP_P4:
    s_waitcnt lgkmcnt(4)
    v_mfma_f32_16x16x32_bf16 v[24:27], v[40:43], v[120:123], v[24:27]
    v_mfma_f32_16x16x32_bf16 v[16:19], v[72:75], v[120:123], 0
    ds_read_b128 v[112:115], v6 offset:1280
    s_waitcnt lgkmcnt(3)
    v_mfma_f32_16x16x32_bf16 v[24:27], v[44:47], v[124:127], v[24:27]
    v_mfma_f32_16x16x32_bf16 v[16:19], v[76:79], v[124:127], v[16:19]
    ds_read_b128 v[116:119], v6 offset:1344
    s_waitcnt lgkmcnt(3)
    v_mfma_f32_16x16x32_bf16 v[24:27], v[48:51], v[104:107], v[24:27]
    v_add_f32 v20, v20, v32
    v_add_f32 v21, v21, v33
    v_mfma_f32_16x16x32_bf16 v[16:19], v[80:83], v[104:107], v[16:19]
    ds_read_b128 v[120:123], v6 offset:1408
    v_add_f32 v22, v22, v34
    v_add_f32 v23, v23, v35
    s_waitcnt lgkmcnt(3)
    v_mfma_f32_16x16x32_bf16 v[24:27], v[52:55], v[108:111], v[24:27]
    v_cvt_pk_bf16_f32 v30, v23, v22
    v_cvt_pk_bf16_f32 v31, v21, v20
    v_mfma_f32_16x16x32_bf16 v[16:19], v[84:87], v[108:111], v[16:19]
    ds_read_b128 v[124:127], v6 offset:1472
    ds_write_b64 v7, v[30:31] offset:1536
    s_waitcnt lgkmcnt(4)
    v_mfma_f32_16x16x32_bf16 v[24:27], v[56:59], v[112:115], v[24:27]
    ds_read_b32 v28, v1 offset:80
    ds_read_b32 v29, v9 offset:32
    v_mfma_f32_16x16x32_bf16 v[16:19], v[88:91], v[112:115], v[16:19]
    ds_read_b128 v[104:107], v6 offset:512
    s_waitcnt lgkmcnt(6)
    v_mfma_f32_16x16x32_bf16 v[24:27], v[60:63], v[116:119], v[24:27]
    ds_read_b128 v[32:35], v8 offset:3072
    v_mfma_f32_16x16x32_bf16 v[16:19], v[92:95], v[116:119], v[16:19]
    ds_read_b128 v[108:111], v6 offset:576
    s_waitcnt lgkmcnt(7)
    v_mfma_f32_16x16x32_bf16 v[24:27], v[64:67], v[120:123], v[24:27]
    v_mfma_f32_16x16x32_bf16 v[16:19], v[96:99], v[120:123], v[16:19]
    ds_read_b128 v[112:115], v6 offset:640
    s_waitcnt lgkmcnt(4)
    v_readfirstlane_b32 s9, v29
    v_mfma_f32_16x16x32_bf16 v[24:27], v[68:71], v[124:127], v[24:27]
    v_readfirstlane_b32 s8, v28
    s_add_u32 s9, s9, 2
    v_mfma_f32_16x16x32_bf16 v[16:19], v[100:103], v[124:127], v[16:19]
    ds_read_b128 v[116:119], v6 offset:704
    s_min_u32 s8, s8, s9
    s_cmp_lt_u32 s8, 7
    s_cbranch_scc1 C_SLOW5
KEEP_P5:
    s_waitcnt lgkmcnt(4)
    v_mfma_f32_16x16x32_bf16 v[16:19], v[40:43], v[104:107], v[16:19]
    v_mfma_f32_16x16x32_bf16 v[20:23], v[72:75], v[104:107], 0
    ds_read_b128 v[120:123], v6 offset:768
    s_waitcnt lgkmcnt(3)
    v_mfma_f32_16x16x32_bf16 v[16:19], v[44:47], v[108:111], v[16:19]
    v_mfma_f32_16x16x32_bf16 v[20:23], v[76:79], v[108:111], v[20:23]
    ds_read_b128 v[124:127], v6 offset:832
    s_waitcnt lgkmcnt(3)
    v_mfma_f32_16x16x32_bf16 v[16:19], v[48:51], v[112:115], v[16:19]
    v_add_f32 v24, v24, v32
    v_add_f32 v25, v25, v33
    v_mfma_f32_16x16x32_bf16 v[20:23], v[80:83], v[112:115], v[20:23]
    ds_read_b128 v[104:107], v6 offset:896
    v_add_f32 v26, v26, v34
    v_add_f32 v27, v27, v35
    s_waitcnt lgkmcnt(3)
    v_mfma_f32_16x16x32_bf16 v[16:19], v[52:55], v[116:119], v[16:19]
    v_cvt_pk_bf16_f32 v30, v27, v26
    v_cvt_pk_bf16_f32 v31, v25, v24
    v_mfma_f32_16x16x32_bf16 v[20:23], v[84:87], v[116:119], v[20:23]
    ds_read_b128 v[108:111], v6 offset:960
    ds_write_b64 v7, v[30:31] offset:1024
    ds_add_u32 v13, v12 offset:8
    s_waitcnt lgkmcnt(5)
    v_mfma_f32_16x16x32_bf16 v[16:19], v[56:59], v[120:123], v[16:19]
    ds_read_b32 v28, v1 offset:80
    ds_read_b32 v29, v9 offset:32
    v_mfma_f32_16x16x32_bf16 v[20:23], v[88:91], v[120:123], v[20:23]
    ds_read_b128 v[112:115], v6 offset:0
    s_waitcnt lgkmcnt(7)
    v_mfma_f32_16x16x32_bf16 v[16:19], v[60:63], v[124:127], v[16:19]
    ds_read_b128 v[32:35], v8 offset:18432
    v_mfma_f32_16x16x32_bf16 v[20:23], v[92:95], v[124:127], v[20:23]
    ds_read_b128 v[116:119], v6 offset:64
    s_waitcnt lgkmcnt(8)
    v_mfma_f32_16x16x32_bf16 v[16:19], v[64:67], v[104:107], v[16:19]
    v_mfma_f32_16x16x32_bf16 v[20:23], v[96:99], v[104:107], v[20:23]
    ds_read_b128 v[120:123], v6 offset:128
    s_waitcnt lgkmcnt(4)
    v_readfirstlane_b32 s9, v29
    v_mfma_f32_16x16x32_bf16 v[16:19], v[68:71], v[108:111], v[16:19]
    v_readfirstlane_b32 s8, v28
    s_add_u32 s9, s9, 2
    v_mfma_f32_16x16x32_bf16 v[20:23], v[100:103], v[108:111], v[20:23]
    ds_read_b128 v[124:127], v6 offset:192
    s_min_u32 s8, s8, s9
    s_cmp_lt_u32 s8, 8
    s_cbranch_scc1 C_SLOW6
KEEP_P6:
    s_waitcnt lgkmcnt(4)
    v_mfma_f32_16x16x32_bf16 v[20:23], v[40:43], v[112:115], v[20:23]
    ds_read_b128 v[104:107], v6 offset:256
    s_waitcnt lgkmcnt(3)
    v_mfma_f32_16x16x32_bf16 v[20:23], v[44:47], v[116:119], v[20:23]
    ds_read_b128 v[108:111], v6 offset:320
    s_waitcnt lgkmcnt(3)
    v_mfma_f32_16x16x32_bf16 v[20:23], v[48:51], v[120:123], v[20:23]
    v_add_f32 v16, v16, v32
    v_add_f32 v17, v17, v33
    ds_read_b128 v[112:115], v6 offset:384
    v_add_f32 v18, v18, v34
    v_add_f32 v19, v19, v35
    s_waitcnt lgkmcnt(3)
    v_mfma_f32_16x16x32_bf16 v[20:23], v[52:55], v[124:127], v[20:23]
    v_cvt_pk_bf16_f32 v30, v19, v18
    v_cvt_pk_bf16_f32 v31, v17, v16
    ds_read_b128 v[116:119], v6 offset:448
    ds_write_b64 v7, v[30:31] offset:512
    ds_add_u32 v13, v12 offset:12
    s_waitcnt lgkmcnt(5)
    v_mfma_f32_16x16x32_bf16 v[20:23], v[56:59], v[104:107], v[20:23]
    ds_read_b32 v28, v1 offset:80
    ds_read_b32 v29, v9 offset:32
    s_waitcnt lgkmcnt(6)
    v_mfma_f32_16x16x32_bf16 v[20:23], v[60:63], v[108:111], v[20:23]
    ds_read_b128 v[32:35], v8 offset:19456
    s_waitcnt lgkmcnt(6)
    v_mfma_f32_16x16x32_bf16 v[20:23], v[64:67], v[112:115], v[20:23]
    s_waitcnt lgkmcnt(1)
    v_readfirstlane_b32 s9, v29
    v_mfma_f32_16x16x32_bf16 v[20:23], v[68:71], v[116:119], v[20:23]
    v_readfirstlane_b32 s8, v28
    s_add_u32 s9, s9, 2
    s_cmp_lt_u32 s9, 9
    s_cbranch_scc1 C_SLOW7
KEEP_P7:
    s_waitcnt lgkmcnt(0)
    s_nop 2
    v_add_f32 v20, v20, v32
    v_add_f32 v21, v21, v33
    v_add_f32 v22, v22, v34
    v_add_f32 v23, v23, v35
    v_cvt_pk_bf16_f32 v30, v23, v22
    v_cvt_pk_bf16_f32 v31, v21, v20
    ds_write_b64 v7, v[30:31] offset:0
    ds_add_u32 v13, v12 offset:16
    ds_read_b32 v10, v1 offset:8
    s_cmp_eq_u32 s3, 4
    s_cbranch_scc1 C_FIN
    s_endpgm
C_SLOW0:
    s_mov_b32 s9, 0
SP_24:
    ds_read_b32 v28, v1 offset:80
    s_waitcnt lgkmcnt(0)
    v_readfirstlane_b32 s8, v28
    s_add_u32 s9, s9, 1
    s_cmp_ge_u32 s8, 2
    s_cbranch_scc1 SP_24_D
    s_cmp_lt_u32 s9, 524288
    s_cbranch_scc1 SP_24
SP_24_D:
    ds_read_b128 v[112:115], v6 offset:3072
    ds_read_b128 v[116:119], v6 offset:3136
    ds_read_b128 v[120:123], v6 offset:3200
    ds_read_b128 v[124:127], v6 offset:3264
    s_waitcnt lgkmcnt(0)
    s_branch KEEP_P0
C_SLOW1:
    s_mov_b32 s9, 0
SP_25:
    ds_read_b32 v28, v1 offset:80
    s_waitcnt lgkmcnt(0)
    v_readfirstlane_b32 s8, v28
    s_add_u32 s9, s9, 1
    s_cmp_ge_u32 s8, 3
    s_cbranch_scc1 SP_25_D
    s_cmp_lt_u32 s9, 524288
    s_cbranch_scc1 SP_25
SP_25_D:
    ds_read_b128 v[120:123], v6 offset:2560
    ds_read_b128 v[124:127], v6 offset:2624
    ds_read_b128 v[104:107], v6 offset:2688
    ds_read_b128 v[108:111], v6 offset:2752
    s_waitcnt lgkmcnt(0)
    s_branch KEEP_P1
C_SLOW2:
    s_mov_b32 s9, 0
SP_26:
    ds_read_b32 v28, v1 offset:80
    s_waitcnt lgkmcnt(0)
    v_readfirstlane_b32 s8, v28
    s_add_u32 s9, s9, 1
    s_cmp_ge_u32 s8, 4
    s_cbranch_scc1 SP_26_D
    s_cmp_lt_u32 s9, 524288
    s_cbranch_scc1 SP_26
SP_26_D:
    s_mov_b32 s9, 0
SP_27:
    ds_read_b32 v28, v9 offset:32
    s_waitcnt lgkmcnt(0)
    v_readfirstlane_b32 s8, v28
    s_add_u32 s9, s9, 1
    s_cmp_ge_u32 s8, 2
    s_cbranch_scc1 SP_27_D
    s_cmp_lt_u32 s9, 524288
    s_cbranch_scc1 SP_27
SP_27_D:
    ds_read_b128 v[32:35], v8 offset:0
    ds_read_b128 v[104:107], v6 offset:2048
    ds_read_b128 v[108:111], v6 offset:2112
    ds_read_b128 v[112:115], v6 offset:2176
    ds_read_b128 v[116:119], v6 offset:2240
    s_waitcnt lgkmcnt(0)
    s_branch KEEP_P2
C_SLOW3:
    s_mov_b32 s9, 0
SP_28:
    ds_read_b32 v28, v1 offset:80
    s_waitcnt lgkmcnt(0)
    v_readfirstlane_b32 s8, v28
    s_add_u32 s9, s9, 1
    s_cmp_ge_u32 s8, 5
    s_cbranch_scc1 SP_28_D
    s_cmp_lt_u32 s9, 524288
    s_cbranch_scc1 SP_28
SP_28_D:
    s_mov_b32 s9, 0
SP_29:
    ds_read_b32 v28, v9 offset:32
    s_waitcnt lgkmcnt(0)
    v_readfirstlane_b32 s8, v28
    s_add_u32 s9, s9, 1
    s_cmp_ge_u32 s8, 3
    s_cbranch_scc1 SP_29_D
    s_cmp_lt_u32 s9, 524288
    s_cbranch_scc1 SP_29
SP_29_D:
    ds_read_b128 v[32:35], v8 offset:1024
    ds_read_b128 v[112:115], v6 offset:1536
    ds_read_b128 v[116:119], v6 offset:1600
    ds_read_b128 v[120:123], v6 offset:1664
    ds_read_b128 v[124:127], v6 offset:1728
    s_waitcnt lgkmcnt(0)
    s_branch KEEP_P3
C_SLOW4:
    s_mov_b32 s9, 0
SP_30:
    ds_read_b32 v28, v1 offset:80
    s_waitcnt lgkmcnt(0)
    v_readfirstlane_b32 s8, v28
    s_add_u32 s9, s9, 1
    s_cmp_ge_u32 s8, 6
    s_cbranch_scc1 SP_30_D
    s_cmp_lt_u32 s9, 524288
    s_cbranch_scc1 SP_30
SP_30_D:
    s_mov_b32 s9, 0
SP_31:
    ds_read_b32 v28, v9 offset:32
    s_waitcnt lgkmcnt(0)
    v_readfirstlane_b32 s8, v28
    s_add_u32 s9, s9, 1
    s_cmp_ge_u32 s8, 4
    s_cbranch_scc1 SP_31_D
    s_cmp_lt_u32 s9, 524288
    s_cbranch_scc1 SP_31
SP_31_D:
    ds_read_b128 v[32:35], v8 offset:2048
    ds_read_b128 v[120:123], v6 offset:1024
    ds_read_b128 v[124:127], v6 offset:1088
    ds_read_b128 v[104:107], v6 offset:1152
    ds_read_b128 v[108:111], v6 offset:1216
    s_waitcnt lgkmcnt(0)
    s_branch KEEP_P4
C_SLOW5:
    s_mov_b32 s9, 0
SP_32:
    ds_read_b32 v28, v1 offset:80
    s_waitcnt lgkmcnt(0)
    v_readfirstlane_b32 s8, v28
    s_add_u32 s9, s9, 1
    s_cmp_ge_u32 s8, 7
    s_cbranch_scc1 SP_32_D
    s_cmp_lt_u32 s9, 524288
    s_cbranch_scc1 SP_32
SP_32_D:
    s_mov_b32 s9, 0
SP_33:
    ds_read_b32 v28, v9 offset:32
    s_waitcnt lgkmcnt(0)
    v_readfirstlane_b32 s8, v28
    s_add_u32 s9, s9, 1
    s_cmp_ge_u32 s8, 5
    s_cbranch_scc1 SP_33_D
    s_cmp_lt_u32 s9, 524288
    s_cbranch_scc1 SP_33
SP_33_D:
    ds_read_b128 v[32:35], v8 offset:3072
    ds_read_b128 v[104:107], v6 offset:512
    ds_read_b128 v[108:111], v6 offset:576
    ds_read_b128 v[112:115], v6 offset:640
    ds_read_b128 v[116:119], v6 offset:704
    s_waitcnt lgkmcnt(0)
    s_branch KEEP_P5
C_SLOW6:
    s_mov_b32 s9, 0
SP_34:
    ds_read_b32 v28, v1 offset:80
    s_waitcnt lgkmcnt(0)
    v_readfirstlane_b32 s8, v28
    s_add_u32 s9, s9, 1
    s_cmp_ge_u32 s8, 8
    s_cbranch_scc1 SP_34_D
    s_cmp_lt_u32 s9, 524288
    s_cbranch_scc1 SP_34
SP_34_D:
    s_mov_b32 s9, 0
SP_35:
    ds_read_b32 v28, v9 offset:32
    s_waitcnt lgkmcnt(0)
    v_readfirstlane_b32 s8, v28
    s_add_u32 s9, s9, 1
    s_cmp_ge_u32 s8, 6
    s_cbranch_scc1 SP_35_D
    s_cmp_lt_u32 s9, 524288
    s_cbranch_scc1 SP_35
SP_35_D:
    ds_read_b128 v[32:35], v8 offset:18432
    ds_read_b128 v[112:115], v6 offset:0
    ds_read_b128 v[116:119], v6 offset:64
    ds_read_b128 v[120:123], v6 offset:128
    ds_read_b128 v[124:127], v6 offset:192
    s_waitcnt lgkmcnt(0)
    s_branch KEEP_P6
C_SLOW7:
    s_mov_b32 s9, 0
SP_36:
    ds_read_b32 v28, v9 offset:32
    s_waitcnt lgkmcnt(0)
    v_readfirstlane_b32 s8, v28
    s_add_u32 s9, s9, 1
    s_cmp_ge_u32 s8, 7
    s_cbranch_scc1 SP_36_D
    s_cmp_lt_u32 s9, 524288
    s_cbranch_scc1 SP_36
SP_36_D:
    ds_read_b128 v[32:35], v8 offset:19456
    s_waitcnt lgkmcnt(0)
    s_branch KEEP_P7
C_KA:
    s_setprio 1
    v_and_b32 v14, 3, v3
    v_sub_u32 v14, 3, v14
    v_mul_u32_u24 v14, 1216, v14
    v_lshrrev_b32 v13, 2, v3
    v_lshl_add_u32 v13, v4, 1, v13
    v_lshl_add_u32 v14, v13, 3, v14
    v_add3_u32 v5, v14, s52, 8
    v_lshlrev_b32 v14, 1, v3
    v_sub_u32 v14, v4, v14
    v_lshlrev_b32 v14, 4, v14
    s_add_u32 s8, s53, 480
    v_add_u32 v6, s8, v14
    v_lshl_add_u32 v14, v3, 2, v4
    s_mul_i32 s8, s12, 4160
    s_add_u32 s8, s8, 83960
    v_lshlrev_b32 v14, 3, v14
    v_sub_u32 v7, s8, v14
    v_lshrrev_b32 v11, 1, v4
    v_and_b32 v12, 1, v4
    v_lshlrev_b32 v11, 8, v11
    v_lshl_add_u32 v11, v12, 3, v11
    v_lshl_add_u32 v11, v3, 4, v11
    v_add_u32 v11, s15, v11
    v_cmp_gt_u32 vcc, 2, v4
    v_lshlrev_b32 v12, 2, v3
    v_lshlrev_b32 v13, 3, v3
    v_cndmask_b32 v12, v12, v13, vcc
    v_lshl_add_u32 v12, v4, 7, v12
    v_add_u32 v12, s15, v12
    v_mov_b32 v13, 64
    v_cndmask_b32 v13, v13, 4, vcc
    v_add_u32 v13, v13, v12
    v_lshlrev_b32 v14, 1, v3
    v_lshl_add_u32 v14, v4, 7, v14
    v_add_u32 v14, s15, v14
    v_lshlrev_b32 v15, 4, v2
    v_lshlrev_b32 v16, 3, v2
    v_add_u32 v16, 256, v16
    v_min_u32 v15, v15, v16
    v_add_u32 v15, s15, v15
    v_min_u32 v16, 15, v2
    v_lshl_add_u32 v16, v16, 2, s15
    v_lshrrev_b32 v26, 5, v2
    v_lshlrev_b32 v26, 8, v26
    v_lshl_add_u32 v26, v2, 2, v26
    v_add_u32 v26, s15, v26
    v_lshlrev_b32 v17, 2, v4
    v_sub_u32 v17, v3, v17
    v_lshl_add_u32 v27, v17, 3, s15
    v_add_u32 v27, 3176, v27
    v_lshl_add_u32 v17, v17, 2, s15
    v_add_u32 v17, 2100, v17
    v_lshl_add_u32 v19, v2, 4, s52
    s_mov_b32 s56, 0x01000100
    s_mov_b32 s57, 0x03020302
    s_lshl_b32 s8, s12, 4
    s_lshr_b64 s[68:69], s[68:69], s8
    s_lshl_b32 s68, s68, 16
    s_sub_u32 s58, 254, s54
    s_lshl_b32 s58, s58, 23
    v_mul_f32 v104, s58, v104
    v_mul_f32 v105, s58, v105
    v_mul_f32 v106, s58, v106
    v_mul_f32 v107, s58, v107
    v_mul_f32 v108, s58, v108
    v_mul_f32 v109, s58, v109
    v_mul_f32 v110, s58, v110
    v_mul_f32 v111, s58, v111
    v_mul_f32 v112, s58, v112
    v_mul_f32 v113, s58, v113
    v_mul_f32 v114, s58, v114
    v_mul_f32 v115, s58, v115
    s_mov_b64 exec, 1
    v_add_f32 v104, s68, v104
    s_mov_b64 exec, -1
    v_mov_b32 v75, 0
    v_mov_b32 v79, 0
    v_mov_b32 v82, 0
    v_mov_b32 v83, 0
    v_mov_b32 v86, 0
    v_mov_b32 v87, 0
    v_lshlrev_b32 v28, 4, v2
    v_add_u32 v28, 100096, v28
    s_mov_b32 s9, 0
SP_37:
    ds_read_b32 v18, v1 offset:32
    s_waitcnt lgkmcnt(0)
    v_readfirstlane_b32 s8, v18
    s_add_u32 s9, s9, 1
    s_cmp_ge_u32 s8, 2
    s_cbranch_scc1 SP_37_D
    s_cmp_lt_u32 s9, 524288
    s_cbranch_scc1 SP_37
SP_37_D:
    ds_read_b128 v[116:119], v28 offset:2048
    ds_read_b128 v[120:123], v28 offset:3072
    ds_read_b128 v[124:127], v28 offset:4096
    s_setprio 0
    s_mov_b32 s9, 0
SP_38:
    ds_read_b32 v18, v9
    s_waitcnt lgkmcnt(0)
    v_readfirstlane_b32 s8, v18
    s_add_u32 s9, s9, 1
    s_cmp_lg_u32 s8, 0
    s_cbranch_scc1 SP_38_D
    s_cmp_lt_u32 s9, 524288
    s_cbranch_scc1 SP_38
SP_38_D:
    s_setprio 2
    s_sub_u32 s60, 254, s8
    s_lshl_b32 s60, s60, 23
    ds_read_b128 v[88:91], v8 offset:18432
    ds_read_b128 v[92:95], v8 offset:19456
    ds_read_b128 v[96:99], v8 offset:20480
    s_waitcnt lgkmcnt(2)
    v_pk_fma_f32 v[104:105], v[88:89], s[60:61], v[104:105] op_sel_hi:[1,0,1]
    v_cvt_pk_bf16_f32 v20, v104, v105
    v_pk_fma_f32 v[106:107], v[90:91], s[60:61], v[106:107] op_sel_hi:[1,0,1]
    v_cvt_pk_bf16_f32 v21, v106, v107
    ds_write_b64 v11, v[20:21]
    s_waitcnt lgkmcnt(2)
    v_pk_fma_f32 v[108:109], v[92:93], s[60:61], v[108:109] op_sel_hi:[1,0,1]
    v_cvt_pk_bf16_f32 v22, v108, v109
    v_pk_fma_f32 v[110:111], v[94:95], s[60:61], v[110:111] op_sel_hi:[1,0,1]
    v_cvt_pk_bf16_f32 v23, v110, v111
    ds_write_b32 v12, v22 offset:512
    ds_write_b32 v13, v23 offset:512
    ds_read_b64 v[32:33], v15 offset:0
    ds_read_b64 v[34:35], v15 offset:8
    s_waitcnt lgkmcnt(5)
    v_pk_fma_f32 v[112:113], v[96:97], s[60:61], v[112:113] op_sel_hi:[1,0,1]
    v_cvt_pk_bf16_f32 v24, v112, v113
    v_pk_fma_f32 v[114:115], v[98:99], s[60:61], v[114:115] op_sel_hi:[1,0,1]
    v_cvt_pk_bf16_f32 v25, v114, v115
    s_mov_b32 exec_lo, 0
    s_waitcnt lgkmcnt(0)
    v_alignbit_b32 v35, v34, v33, 16
    v_perm_b32 v34, v33, v33, s56
    v_alignbit_b32 v33, v33, v32, 16
    v_perm_b32 v32, v32, v32, s56
    s_mov_b32 exec_lo, -1
    ds_write_b128 v19, v[32:35] offset:32
    v_mov_b32_dpp v30, v34 wave_shr:1 row_mask:0xf bank_mask:0xf bound_ctrl:0
    v_mov_b32_dpp v31, v35 wave_shr:1 row_mask:0xf bank_mask:0xf bound_ctrl:0
    v_alignbit_b32 v44, v32, v31, 16
    v_alignbit_b32 v45, v33, v32, 16
    v_alignbit_b32 v46, v34, v33, 16
    v_alignbit_b32 v47, v35, v34, 16
    ds_write_b128 v19, v[44:47] offset:1248
    v_mov_b32 v52, v31
    v_mov_b32 v53, v32
    v_mov_b32 v54, v33
    v_mov_b32 v55, v34
    ds_write_b128 v19, v[52:55] offset:2464
    v_alignbit_b32 v60, v31, v30, 16
    v_alignbit_b32 v61, v32, v31, 16
    v_alignbit_b32 v62, v33, v32, 16
    v_alignbit_b32 v63, v34, v33, 16
    ds_write_b128 v19, v[60:63] offset:3680
    v_mov_b32 v10, 1
    ds_write_b32 v9, v10 offset:48
    s_setprio 3
    v_perm_b32 v73, v35, v35, s57
    v_alignbit_b32 v72, v35, v34, 16
    v_lshrrev_b32 v78, 16, v35
    v_mov_b32 v76, v35
    v_mov_b32 v74, v73
    v_mov_b32 v77, v73
    v_mov_b32 v80, v73
    v_mov_b32 v81, v73
    v_mov_b32 v84, v73
    v_mov_b32 v85, v78
    s_mov_b32 exec_lo, 0
    ds_write_b16 v12, v22 offset:2942
    ds_write_b16_d16_hi v12, v22 offset:2944
    ds_write_b16 v13, v23 offset:2942
    ds_write_b16_d16_hi v13, v23 offset:2944
    s_mov_b32 exec_hi, 0x80000000
    ds_write_b128 v19, v[84:87] offset:48
    ds_write_b128 v19, v[80:83] offset:1264
    ds_write_b128 v19, v[76:79] offset:2480
    ds_write_b128 v19, v[72:75] offset:3696
    s_mov_b64 exec, 1
    ds_write_b16 v14, v24 offset:3454
    s_mov_b64 exec, -1
    ds_write_b32 v26, v1 offset:3072
    ds_write_b16 v14, v24 offset:2110
    ds_write_b16_d16_hi v14, v24 offset:2142
    ds_write_b16 v14, v25 offset:2174
    ds_write_b16_d16_hi v14, v25 offset:2206
    ds_write_b32 v16, v1 offset:2048
    v_readlane_b32 s59, v24, 0
    v_mov_b32 v11, v27
    v_mov_b32 v12, v17
    v_mov_b32 v13, v28
    s_pack_ll_b32_b16 s59, s59, s59
    s_mov_b32 s9, 0
SP_39:
    ds_read_b32 v10, v1 offset:80
    s_waitcnt lgkmcnt(0)
    v_readfirstlane_b32 s8, v10
    s_add_u32 s9, s9, 1
    s_cmp_ge_u32 s8, 2
    s_cbranch_scc1 SP_39_D
    s_sleep 1
    s_cmp_lt_u32 s9, 524288
    s_cbranch_scc1 SP_39
SP_39_D:
    s_setprio 1
    ds_read_b128 v[40:43], v6 offset:3584
    ds_read_b128 v[44:47], v6 offset:3600
    ds_read_b128 v[48:51], v6 offset:3072
    ds_read_b128 v[52:55], v6 offset:3088
    ds_read_b64 v[112:113], v5 offset:1024
    ds_read_b64 v[114:115], v5 offset:1032
    ds_read2_b32 v[128:129], v11 offset0:6 offset1:4
    ds_read2_b32 v[130:131], v11 offset0:2 offset1:0
    ds_read2_b32 v[132:133], v11 offset0:7 offset1:5
    ds_read2_b32 v[134:135], v11 offset0:3 offset1:1
    v_and_b32 v124, s59, v124
    v_and_b32 v125, s59, v125
    v_and_b32 v126, s59, v126
    v_and_b32 v127, s59, v127
    s_waitcnt lgkmcnt(9)
    v_mfma_f32_16x16x32_bf16 v[56:59], v[40:43], v[116:119], 0
    ds_read2_b32 v[136:137], v11 offset0:38 offset1:36
    v_mfma_f32_16x16x32_bf16 v[60:63], v[40:43], v[120:123], 0
    ds_read2_b32 v[138:139], v11 offset0:34 offset1:32
    s_waitcnt lgkmcnt(10)
    v_mfma_f32_16x16x32_bf16 v[64:67], v[44:47], v[116:119], 0
    ds_read2_b32 v[140:141], v11 offset0:39 offset1:37
    v_mfma_f32_16x16x32_bf16 v[68:71], v[44:47], v[120:123], 0
    ds_read2_b32 v[142:143], v11 offset0:35 offset1:33
    s_waitcnt lgkmcnt(8)
    v_mfma_f32_16x16x32_bf16 v[16:19], v[112:115], v[40:43], 0
    ds_read_b128 v[104:107], v13
    ds_read_b128 v[108:111], v13 offset:1024
    v_mfma_f32_16x16x32_bf16 v[80:83], v[48:51], v[116:119], 0
    v_cvt_pk_bf16_f32 v56, v56, v60
    v_cvt_pk_bf16_f32 v57, v57, v61
    v_mfma_f32_16x16x32_bf16 v[84:87], v[48:51], v[120:123], 0
    v_cvt_pk_bf16_f32 v58, v58, v62
    v_cvt_pk_bf16_f32 v59, v59, v63
    v_mfma_f32_16x16x32_bf16 v[88:91], v[52:55], v[116:119], 0
    v_cvt_pk_bf16_f32 v64, v64, v68
    v_cvt_pk_bf16_f32 v65, v65, v69
    v_mfma_f32_16x16x32_bf16 v[92:95], v[52:55], v[120:123], 0
    v_cvt_pk_bf16_f32 v66, v66, v70
    v_cvt_pk_bf16_f32 v67, v67, v71
    v_mfma_f32_16x16x32_bf16 v[20:23], v[112:115], v[48:51], 0
    s_waitcnt lgkmcnt(8)
    v_mfma_f32_16x16x32_bf16 v[16:19], v[56:59], v[128:131], v[16:19]
    v_cvt_pk_bf16_f32 v80, v80, v84
    v_cvt_pk_bf16_f32 v81, v81, v85
    s_waitcnt lgkmcnt(6)
    v_mfma_f32_16x16x32_bf16 v[16:19], v[64:67], v[132:135], v[16:19]
    v_cvt_pk_bf16_f32 v82, v82, v86
    v_cvt_pk_bf16_f32 v83, v83, v87
    s_waitcnt lgkmcnt(4)
    v_mfma_f32_16x16x32_bf16 v[20:23], v[56:59], v[136:139], v[20:23]
    v_cvt_pk_bf16_f32 v88, v88, v92
    v_cvt_pk_bf16_f32 v89, v89, v93
    s_waitcnt lgkmcnt(2)
    v_mfma_f32_16x16x32_bf16 v[20:23], v[64:67], v[140:143], v[20:23]
    v_cvt_pk_bf16_f32 v90, v90, v94
    v_cvt_pk_bf16_f32 v91, v91, v95
    v_mfma_f32_16x16x32_bf16 v[20:23], v[80:83], v[128:131], v[20:23]
    ds_read2_b32 v[144:145], v11 offset0:70 offset1:68
    ds_read2_b32 v[146:147], v11 offset0:66 offset1:64
    v_mfma_f32_16x16x32_bf16 v[20:23], v[88:91], v[132:135], v[20:23]
    ds_read2_b32 v[148:149], v11 offset0:71 offset1:69
    ds_read2_b32 v[150:151], v11 offset0:67 offset1:65
    s_waitcnt lgkmcnt(5)
    v_mfma_f32_16x16x32_bf16 v[72:75], v[40:43], v[104:107], 0
    ds_write_b128 v8, v[16:19] offset:0
    v_mov_b32 v10, 2
    s_waitcnt lgkmcnt(5)
    v_mfma_f32_16x16x32_bf16 v[76:79], v[44:47], v[108:111], 0
    ds_write_b32 v9, v10 offset:32
    ds_read2_b32 v[152:153], v12 offset0:3 offset1:2
    v_mfma_f32_16x16x32_bf16 v[24:27], v[124:127], v[40:43], 0
    ds_read2_b32 v[154:155], v12 offset0:1 offset1:0
    ds_read2_b32 v[156:157], v12 offset0:19 offset1:18
    v_mfma_f32_16x16x32_bf16 v[96:99], v[48:51], v[104:107], 0
    ds_read2_b32 v[158:159], v12 offset0:17 offset1:16
    ds_read2_b32 v[160:161], v12 offset0:35 offset1:34
    v_mfma_f32_16x16x32_bf16 v[100:103], v[52:55], v[108:111], 0
    ds_read2_b32 v[162:163], v12 offset0:33 offset1:32
    ds_read2_b32 v[164:165], v12 offset0:51 offset1:50
    v_mfma_f32_16x16x32_bf16 v[28:31], v[124:127], v[48:51], 0
    ds_read2_b32 v[166:167], v12 offset0:49 offset1:48
    ds_write_b128 v8, v[20:23] offset:1024
    v_mov_b32 v10, 3
    ds_write_b32 v9, v10 offset:32
    s_mov_b32 s9, 0
SP_40:
    ds_read_b32 v10, v1 offset:80
    s_waitcnt lgkmcnt(0)
    v_readfirstlane_b32 s8, v10
    s_add_u32 s9, s9, 1
    s_cmp_ge_u32 s8, 4
    s_cbranch_scc1 SP_40_D
    s_sleep 1
    s_cmp_lt_u32 s9, 524288
    s_cbranch_scc1 SP_40
SP_40_D:
    s_setprio 3
    ds_read_b128 v[40:43], v6 offset:2560
    ds_read_b128 v[44:47], v6 offset:2576
    ds_read_b128 v[48:51], v6 offset:2048
    ds_read_b128 v[52:55], v6 offset:2064
    v_mfma_f32_16x16x32_bf16 v[24:27], v[56:59], v[144:147], v[24:27]
    v_cvt_pk_bf16_f32 v72, v72, v76
    v_cvt_pk_bf16_f32 v73, v73, v77
    v_mfma_f32_16x16x32_bf16 v[24:27], v[64:67], v[148:151], v[24:27]
    v_cvt_pk_bf16_f32 v74, v74, v78
    v_cvt_pk_bf16_f32 v75, v75, v79
    v_mfma_f32_16x16x32_bf16 v[24:27], v[80:83], v[136:139], v[24:27]
    v_cvt_pk_bf16_f32 v96, v96, v100
    v_cvt_pk_bf16_f32 v97, v97, v101
    v_mfma_f32_16x16x32_bf16 v[24:27], v[88:91], v[140:143], v[24:27]
    v_cvt_pk_bf16_f32 v98, v98, v102
    v_cvt_pk_bf16_f32 v99, v99, v103
    v_mfma_f32_16x16x32_bf16 v[28:31], v[80:83], v[144:147], v[28:31]
    v_mfma_f32_16x16x32_bf16 v[28:31], v[88:91], v[148:151], v[28:31]
    s_waitcnt lgkmcnt(3)
    v_mfma_f32_16x16x32_bf16 v[56:59], v[40:43], v[116:119], 0
    v_mfma_f32_16x16x32_bf16 v[60:63], v[40:43], v[120:123], 0
    s_waitcnt lgkmcnt(2)
    v_mfma_f32_16x16x32_bf16 v[64:67], v[44:47], v[116:119], 0
    v_mfma_f32_16x16x32_bf16 v[68:71], v[44:47], v[120:123], 0
    v_mfma_f32_16x16x32_bf16 v[24:27], v[112:115], v[40:43], v[24:27]
    v_mfma_f32_16x16x32_bf16 v[24:27], v[72:75], v[152:155], v[24:27]
    v_mfma_f32_16x16x32_bf16 v[28:31], v[72:75], v[156:159], v[28:31]
    v_mfma_f32_16x16x32_bf16 v[32:35], v[72:75], v[160:163], 0
    v_mfma_f32_16x16x32_bf16 v[36:39], v[72:75], v[164:167], 0
    v_mfma_f32_16x16x32_bf16 v[28:31], v[96:99], v[152:155], v[28:31]
    v_mfma_f32_16x16x32_bf16 v[32:35], v[96:99], v[156:159], v[32:35]
    v_mfma_f32_16x16x32_bf16 v[36:39], v[96:99], v[160:163], v[36:39]
    s_waitcnt lgkmcnt(1)
    v_mfma_f32_16x16x32_bf16 v[80:83], v[48:51], v[116:119], 0
    v_cvt_pk_bf16_f32 v56, v56, v60
    v_cvt_pk_bf16_f32 v57, v57, v61
    v_mfma_f32_16x16x32_bf16 v[84:87], v[48:51], v[120:123], 0
    v_cvt_pk_bf16_f32 v58, v58, v62
    v_cvt_pk_bf16_f32 v59, v59, v63
    s_waitcnt lgkmcnt(0)
    v_mfma_f32_16x16x32_bf16 v[88:91], v[52:55], v[116:119], 0
    v_cvt_pk_bf16_f32 v64, v64, v68
    v_cvt_pk_bf16_f32 v65, v65, v69
    v_mfma_f32_16x16x32_bf16 v[92:95], v[52:55], v[120:123], 0
    v_cvt_pk_bf16_f32 v66, v66, v70
    v_cvt_pk_bf16_f32 v67, v67, v71
    v_mfma_f32_16x16x32_bf16 v[28:31], v[112:115], v[48:51], v[28:31]
    v_mfma_f32_16x16x32_bf16 v[72:75], v[40:43], v[104:107], 0
    v_mfma_f32_16x16x32_bf16 v[76:79], v[44:47], v[108:111], 0
    v_mfma_f32_16x16x32_bf16 v[32:35], v[124:127], v[40:43], v[32:35]
    v_mfma_f32_16x16x32_bf16 v[24:27], v[56:59], v[128:131], v[24:27]
    v_cvt_pk_bf16_f32 v80, v80, v84
    v_cvt_pk_bf16_f32 v81, v81, v85
    v_mfma_f32_16x16x32_bf16 v[24:27], v[64:67], v[132:135], v[24:27]
    v_cvt_pk_bf16_f32 v82, v82, v86
    v_cvt_pk_bf16_f32 v83, v83, v87
    v_mfma_f32_16x16x32_bf16 v[28:31], v[56:59], v[136:139], v[28:31]
    v_cvt_pk_bf16_f32 v88, v88, v92
    v_cvt_pk_bf16_f32 v89, v89, v93
    v_mfma_f32_16x16x32_bf16 v[28:31], v[64:67], v[140:143], v[28:31]
    v_cvt_pk_bf16_f32 v90, v90, v94
    v_cvt_pk_bf16_f32 v91, v91, v95
    v_mfma_f32_16x16x32_bf16 v[32:35], v[56:59], v[144:147], v[32:35]
    v_cvt_pk_bf16_f32 v72, v72, v76
    v_cvt_pk_bf16_f32 v73, v73, v77
    v_mfma_f32_16x16x32_bf16 v[32:35], v[64:67], v[148:151], v[32:35]
    v_cvt_pk_bf16_f32 v74, v74, v78
    v_cvt_pk_bf16_f32 v75, v75, v79
    v_mfma_f32_16x16x32_bf16 v[96:99], v[48:51], v[104:107], 0
    ds_write_b128 v8, v[24:27] offset:2048
    v_mov_b32 v10, 4
    v_mfma_f32_16x16x32_bf16 v[100:103], v[52:55], v[108:111], 0
    ds_write_b32 v9, v10 offset:32
    v_mfma_f32_16x16x32_bf16 v[36:39], v[124:127], v[48:51], v[36:39]
    v_mfma_f32_16x16x32_bf16 v[28:31], v[80:83], v[128:131], v[28:31]
    s_nop 4
    v_cvt_pk_bf16_f32 v96, v96, v100
    v_cvt_pk_bf16_f32 v97, v97, v101
    v_mfma_f32_16x16x32_bf16 v[28:31], v[88:91], v[132:135], v[28:31]
    v_cvt_pk_bf16_f32 v98, v98, v102
    v_cvt_pk_bf16_f32 v99, v99, v103
    v_mfma_f32_16x16x32_bf16 v[32:35], v[80:83], v[136:139], v[32:35]
    s_nop 0
    s_nop 0
    v_mfma_f32_16x16x32_bf16 v[32:35], v[88:91], v[140:143], v[32:35]
    s_nop 0
    s_nop 0
    v_mfma_f32_16x16x32_bf16 v[36:39], v[80:83], v[144:147], v[36:39]
    ds_write_b128 v8, v[28:31] offset:3072
    v_mov_b32 v10, 5
    v_mfma_f32_16x16x32_bf16 v[36:39], v[88:91], v[148:151], v[36:39]
    ds_write_b32 v9, v10 offset:32
    v_mfma_f32_16x16x32_bf16 v[32:35], v[72:75], v[152:155], v[32:35]
    v_mfma_f32_16x16x32_bf16 v[36:39], v[72:75], v[156:159], v[36:39]
    v_mfma_f32_16x16x32_bf16 v[36:39], v[96:99], v[152:155], v[36:39]
    s_setprio 3
    s_mov_b32 s9, 0
SP_41:
    ds_read_b32 v10, v1 offset:80
    s_waitcnt lgkmcnt(0)
    v_readfirstlane_b32 s8, v10
    s_add_u32 s9, s9, 1
    s_cmp_ge_u32 s8, 6
    s_cbranch_scc1 SP_41_D
    s_sleep 1
    s_cmp_lt_u32 s9, 524288
    s_cbranch_scc1 SP_41
SP_41_D:
    ds_read_b128 v[40:43], v6 offset:1536
    ds_read_b128 v[44:47], v6 offset:1552
    ds_read_b128 v[48:51], v6 offset:1024
    ds_read_b128 v[52:55], v6 offset:1040
    s_waitcnt lgkmcnt(3)
    v_mfma_f32_16x16x32_bf16 v[56:59], v[40:43], v[116:119], 0
    v_mfma_f32_16x16x32_bf16 v[60:63], v[40:43], v[120:123], 0
    s_waitcnt lgkmcnt(2)
    v_mfma_f32_16x16x32_bf16 v[64:67], v[44:47], v[116:119], 0
    v_mfma_f32_16x16x32_bf16 v[68:71], v[44:47], v[120:123], 0
    v_mfma_f32_16x16x32_bf16 v[32:35], v[112:115], v[40:43], v[32:35]
    s_waitcnt lgkmcnt(1)
    v_mfma_f32_16x16x32_bf16 v[80:83], v[48:51], v[116:119], 0
    s_nop 1
    v_cvt_pk_bf16_f32 v56, v56, v60
    v_cvt_pk_bf16_f32 v57, v57, v61
    v_mfma_f32_16x16x32_bf16 v[84:87], v[48:51], v[120:123], 0
    v_cvt_pk_bf16_f32 v58, v58, v62
    v_cvt_pk_bf16_f32 v59, v59, v63
    s_waitcnt lgkmcnt(0)
    v_mfma_f32_16x16x32_bf16 v[88:91], v[52:55], v[116:119], 0
    v_cvt_pk_bf16_f32 v64, v64, v68
    v_cvt_pk_bf16_f32 v65, v65, v69
    v_mfma_f32_16x16x32_bf16 v[92:95], v[52:55], v[120:123], 0
    v_cvt_pk_bf16_f32 v66, v66, v70
    v_cvt_pk_bf16_f32 v67, v67, v71
    v_mfma_f32_16x16x32_bf16 v[36:39], v[112:115], v[48:51], v[36:39]
    v_mfma_f32_16x16x32_bf16 v[32:35], v[56:59], v[128:131], v[32:35]
    v_cvt_pk_bf16_f32 v80, v80, v84
    v_cvt_pk_bf16_f32 v81, v81, v85
    v_mfma_f32_16x16x32_bf16 v[32:35], v[64:67], v[132:135], v[32:35]
    v_cvt_pk_bf16_f32 v82, v82, v86
    v_cvt_pk_bf16_f32 v83, v83, v87
    v_mfma_f32_16x16x32_bf16 v[36:39], v[56:59], v[136:139], v[36:39]
    v_cvt_pk_bf16_f32 v88, v88, v92
    v_cvt_pk_bf16_f32 v89, v89, v93
    v_mfma_f32_16x16x32_bf16 v[36:39], v[64:67], v[140:143], v[36:39]
    v_cvt_pk_bf16_f32 v90, v90, v94
    v_cvt_pk_bf16_f32 v91, v91, v95
    v_mfma_f32_16x16x32_bf16 v[36:39], v[80:83], v[128:131], v[36:39]
    s_nop 0
    v_mfma_f32_16x16x32_bf16 v[36:39], v[88:91], v[132:135], v[36:39]
    ds_write_b128 v8, v[32:35] offset:18432
    v_mov_b32 v10, 6
    ds_write_b32 v9, v10 offset:32
    s_nop 4
    ds_write_b128 v8, v[36:39] offset:19456
    v_mov_b32 v10, 7
    ds_write_b32 v9, v10 offset:32
    s_endpgm
SELECT:
    s_setprio 3
    s_mov_b32 s52, s16
    s_mov_b32 s53, s17
    s_mov_b32 s54, 2359296
    s_mov_b32 s55, 0x20000
    v_lshlrev_b32 v7, 4, v2
    v_add_u32 v15, 0x1000, v7
    v_lshlrev_b32 v8, 2, v2
    v_sub_u32 v8, 2047, v8
    v_subrev_u32 v48, 0, v8
    v_subrev_u32 v49, 1, v8
    v_subrev_u32 v50, 2, v8
    v_subrev_u32 v51, 3, v8
    v_subrev_u32 v52, 256, v8
    v_subrev_u32 v53, 257, v8
    v_subrev_u32 v54, 258, v8
    v_subrev_u32 v55, 259, v8
    v_subrev_u32 v56, 512, v8
    v_subrev_u32 v57, 513, v8
    v_subrev_u32 v58, 514, v8
    v_subrev_u32 v59, 515, v8
    v_subrev_u32 v60, 768, v8
    v_subrev_u32 v61, 769, v8
    v_subrev_u32 v62, 770, v8
    v_subrev_u32 v63, 771, v8
    v_subrev_u32 v64, 1024, v8
    v_subrev_u32 v65, 1025, v8
    v_subrev_u32 v66, 1026, v8
    v_subrev_u32 v67, 1027, v8
    v_subrev_u32 v68, 1280, v8
    v_subrev_u32 v69, 1281, v8
    v_subrev_u32 v70, 1282, v8
    v_subrev_u32 v71, 1283, v8
    v_subrev_u32 v72, 1536, v8
    v_subrev_u32 v73, 1537, v8
    v_subrev_u32 v74, 1538, v8
    v_subrev_u32 v75, 1539, v8
    v_subrev_u32 v76, 1792, v8
    v_subrev_u32 v77, 1793, v8
    v_subrev_u32 v78, 1794, v8
    v_subrev_u32 v79, 1795, v8
    v_lshrrev_b32 v9, 3, v2
    v_and_b32 v9, 6, v9
    v_xor_b32 v9, v9, v2
    v_and_b32 v9, 7, v9
    v_lshlrev_b32 v5, 4, v9
    v_mov_b32 v12, 0
    v_mov_b32 v6, 0
    s_mov_b32 s11, 0xffff0000
    s_mov_b32 s15, 0
    s_mov_b32 s9, 0
SP_42:
    ds_read_b32 v13, v1 offset:12
    s_waitcnt lgkmcnt(0)
    v_readfirstlane_b32 s8, v13
    s_add_u32 s9, s9, 1
    s_cmp_ge_u32 s8, 2
    s_cbranch_scc1 SP_42_D
    s_cmp_lt_u32 s9, 524288
    s_cbranch_scc1 SP_42
SP_42_D:
    s_mov_b32 s9, 0
    s_waitcnt vmcnt(0)
    s_sleep 16
SEL_POLL:
    global_load_dwordx4 v[16:19], v7, s[50:51] offset:0 sc1
    global_load_dwordx4 v[20:23], v7, s[50:51] offset:1024 sc1
    global_load_dwordx4 v[24:27], v7, s[50:51] offset:2048 sc1
    global_load_dwordx4 v[28:31], v7, s[50:51] offset:3072 sc1
    global_load_dwordx4 v[32:35], v15, s[50:51] offset:0 sc1
    global_load_dwordx4 v[36:39], v15, s[50:51] offset:1024 sc1
    global_load_dwordx4 v[40:43], v15, s[50:51] offset:2048 sc1
    global_load_dwordx4 v[44:47], v15, s[50:51] offset:3072 sc1
    s_waitcnt vmcnt(7)
    v_xor_b32 v13, v17, v14
    v_bitop3_b32 v13, v13, v19, v14 bitop3:0xf6
    s_waitcnt vmcnt(6)
    v_bitop3_b32 v13, v13, v21, v14 bitop3:0xf6
    v_bitop3_b32 v13, v13, v23, v14 bitop3:0xf6
    s_waitcnt vmcnt(5)
    v_bitop3_b32 v13, v13, v25, v14 bitop3:0xf6
    v_bitop3_b32 v13, v13, v27, v14 bitop3:0xf6
    s_waitcnt vmcnt(4)
    v_bitop3_b32 v13, v13, v29, v14 bitop3:0xf6
    v_bitop3_b32 v13, v13, v31, v14 bitop3:0xf6
    s_waitcnt vmcnt(3)
    v_bitop3_b32 v13, v13, v33, v14 bitop3:0xf6
    v_bitop3_b32 v13, v13, v35, v14 bitop3:0xf6
    s_waitcnt vmcnt(2)
    v_bitop3_b32 v13, v13, v37, v14 bitop3:0xf6
    v_bitop3_b32 v13, v13, v39, v14 bitop3:0xf6
    s_waitcnt vmcnt(1)
    v_bitop3_b32 v13, v13, v41, v14 bitop3:0xf6
    v_bitop3_b32 v13, v13, v43, v14 bitop3:0xf6
    s_waitcnt vmcnt(0)
    v_bitop3_b32 v13, v13, v45, v14 bitop3:0xf6
    v_bitop3_b32 v13, v13, v47, v14 bitop3:0xf6
    v_cmp_ne_u32 vcc, 0, v13
    s_add_u32 s9, s9, 1
    s_cmp_eq_u64 vcc, 0
    s_cbranch_scc1 SEL_GOT
    s_cmp_lt_u32 s9, 131072
    s_cbranch_scc1 SEL_POLL
SEL_GOT:
    v_lshl_or_b32 v80, v16, 16, v48
    v_and_or_b32 v81, v16, s11, v49
    v_lshl_or_b32 v82, v18, 16, v50
    v_and_or_b32 v83, v18, s11, v51
    v_min_u32 v9, v80, v81
    v_max_u32 v8, v80, v81
    v_med3_u32 v9, v8, v9, v82
    v_max_u32 v8, v8, v82
    v_med3_u32 v9, v8, v9, v83
    v_max_u32 v8, v8, v83
    v_lshl_or_b32 v84, v20, 16, v52
    v_and_or_b32 v85, v20, s11, v53
    v_lshl_or_b32 v86, v22, 16, v54
    v_and_or_b32 v87, v22, s11, v55
    v_med3_u32 v9, v8, v9, v84
    v_max_u32 v8, v8, v84
    v_med3_u32 v9, v8, v9, v85
    v_max_u32 v8, v8, v85
    v_med3_u32 v9, v8, v9, v86
    v_max_u32 v8, v8, v86
    v_med3_u32 v9, v8, v9, v87
    v_max_u32 v8, v8, v87
    v_lshl_or_b32 v88, v24, 16, v56
    v_and_or_b32 v89, v24, s11, v57
    v_lshl_or_b32 v90, v26, 16, v58
    v_and_or_b32 v91, v26, s11, v59
    v_med3_u32 v9, v8, v9, v88
    v_max_u32 v8, v8, v88
    v_med3_u32 v9, v8, v9, v89
    v_max_u32 v8, v8, v89
    v_med3_u32 v9, v8, v9, v90
    v_max_u32 v8, v8, v90
    v_med3_u32 v9, v8, v9, v91
    v_max_u32 v8, v8, v91
    v_lshl_or_b32 v92, v28, 16, v60
    v_and_or_b32 v93, v28, s11, v61
    v_lshl_or_b32 v94, v30, 16, v62
    v_and_or_b32 v95, v30, s11, v63
    v_med3_u32 v9, v8, v9, v92
    v_max_u32 v8, v8, v92
    v_med3_u32 v9, v8, v9, v93
    v_max_u32 v8, v8, v93
    v_med3_u32 v9, v8, v9, v94
    v_max_u32 v8, v8, v94
    v_med3_u32 v9, v8, v9, v95
    v_max_u32 v8, v8, v95
    v_lshl_or_b32 v96, v32, 16, v64
    v_and_or_b32 v97, v32, s11, v65
    v_lshl_or_b32 v98, v34, 16, v66
    v_and_or_b32 v99, v34, s11, v67
    v_med3_u32 v9, v8, v9, v96
    v_max_u32 v8, v8, v96
    v_med3_u32 v9, v8, v9, v97
    v_max_u32 v8, v8, v97
    v_med3_u32 v9, v8, v9, v98
    v_max_u32 v8, v8, v98
    v_med3_u32 v9, v8, v9, v99
    v_max_u32 v8, v8, v99
    v_lshl_or_b32 v100, v36, 16, v68
    v_and_or_b32 v101, v36, s11, v69
    v_lshl_or_b32 v102, v38, 16, v70
    v_and_or_b32 v103, v38, s11, v71
    v_med3_u32 v9, v8, v9, v100
    v_max_u32 v8, v8, v100
    v_med3_u32 v9, v8, v9, v101
    v_max_u32 v8, v8, v101
    v_med3_u32 v9, v8, v9, v102
    v_max_u32 v8, v8, v102
    v_med3_u32 v9, v8, v9, v103
    v_max_u32 v8, v8, v103
    v_lshl_or_b32 v104, v40, 16, v72
    v_and_or_b32 v105, v40, s11, v73
    v_lshl_or_b32 v106, v42, 16, v74
    v_and_or_b32 v107, v42, s11, v75
    v_med3_u32 v9, v8, v9, v104
    v_max_u32 v8, v8, v104
    v_med3_u32 v9, v8, v9, v105
    v_max_u32 v8, v8, v105
    v_med3_u32 v9, v8, v9, v106
    v_max_u32 v8, v8, v106
    v_med3_u32 v9, v8, v9, v107
    v_max_u32 v8, v8, v107
    v_lshl_or_b32 v108, v44, 16, v76
    v_and_or_b32 v109, v44, s11, v77
    v_lshl_or_b32 v110, v46, 16, v78
    v_and_or_b32 v111, v46, s11, v79
    v_med3_u32 v9, v8, v9, v108
    v_max_u32 v8, v8, v108
    v_med3_u32 v9, v8, v9, v109
    v_max_u32 v8, v8, v109
    v_med3_u32 v9, v8, v9, v110
    v_max_u32 v8, v8, v110
    v_med3_u32 v9, v8, v9, v111
    v_max_u32 v8, v8, v111
    v_mov_b32 v10, v8
    s_nop 1
    v_max_u32_dpp v10, v10, v10 row_shr:1 row_mask:0xf bank_mask:0xf
    s_nop 1
    v_max_u32_dpp v10, v10, v10 row_shr:2 row_mask:0xf bank_mask:0xf
    s_nop 1
    v_max_u32_dpp v10, v10, v10 row_shr:4 row_mask:0xf bank_mask:0xf
    s_nop 1
    v_max_u32_dpp v10, v10, v10 row_shr:8 row_mask:0xf bank_mask:0xf
    s_nop 1
    v_max_u32_dpp v10, v10, v10 row_bcast:15 row_mask:0xa bank_mask:0xf
    s_nop 1
    v_max_u32_dpp v10, v10, v10 row_bcast:31 row_mask:0xc bank_mask:0xf
    s_nop 0
    v_readlane_b32 s8, v10, 63
    s_mov_b32 s12, s8
    v_subrev_u32 v10, s12, v8
    v_subrev_u32 v11, s12, v9
    v_max_u32 v10, v10, v11
    s_and_b32 s13, s12, 0x7ff
    s_sub_u32 s13, 2047, s13
    v_max_u32_dpp v10, v10, v10 row_shr:1 row_mask:0xf bank_mask:0xf
    s_mul_i32 s13, s13, 1152
    s_nop 0
    v_max_u32_dpp v10, v10, v10 row_shr:2 row_mask:0xf bank_mask:0xf
    s_mov_b32 exec_lo, 0xff
    s_mov_b32 exec_hi, 0x0
    v_add_u32 v12, s13, v5
    v_mov_b32 v6, s12
    s_mov_b64 exec, -1
    v_max_u32_dpp v10, v10, v10 row_shr:4 row_mask:0xf bank_mask:0xf
    s_nop 1
    v_max_u32_dpp v10, v10, v10 row_shr:8 row_mask:0xf bank_mask:0xf
    s_nop 1
    v_max_u32_dpp v10, v10, v10 row_bcast:15 row_mask:0xa bank_mask:0xf
    s_nop 1
    v_max_u32_dpp v10, v10, v10 row_bcast:31 row_mask:0xc bank_mask:0xf
    s_nop 0
    v_readlane_b32 s8, v10, 63
    s_add_u32 s12, s12, s8
    v_subrev_u32 v10, s12, v8
    v_subrev_u32 v11, s12, v9
    v_max_u32 v10, v10, v11
    s_and_b32 s13, s12, 0x7ff
    s_sub_u32 s13, 2047, s13
    v_max_u32_dpp v10, v10, v10 row_shr:1 row_mask:0xf bank_mask:0xf
    s_mul_i32 s13, s13, 1152
    s_nop 0
    v_max_u32_dpp v10, v10, v10 row_shr:2 row_mask:0xf bank_mask:0xf
    s_mov_b32 exec_lo, 0xff00
    s_mov_b32 exec_hi, 0x0
    v_add_u32 v12, s13, v5
    v_mov_b32 v6, s12
    s_mov_b64 exec, -1
    v_max_u32_dpp v10, v10, v10 row_shr:4 row_mask:0xf bank_mask:0xf
    s_nop 1
    v_max_u32_dpp v10, v10, v10 row_shr:8 row_mask:0xf bank_mask:0xf
    s_nop 1
    v_max_u32_dpp v10, v10, v10 row_bcast:15 row_mask:0xa bank_mask:0xf
    s_nop 1
    v_max_u32_dpp v10, v10, v10 row_bcast:31 row_mask:0xc bank_mask:0xf
    s_nop 0
    v_readlane_b32 s8, v10, 63
    s_add_u32 s12, s12, s8
    v_subrev_u32 v10, s12, v8
    v_subrev_u32 v11, s12, v9
    v_max_u32 v10, v10, v11
    s_and_b32 s13, s12, 0x7ff
    s_sub_u32 s13, 2047, s13
    v_max_u32_dpp v10, v10, v10 row_shr:1 row_mask:0xf bank_mask:0xf
    s_mul_i32 s13, s13, 1152
    s_nop 0
    v_max_u32_dpp v10, v10, v10 row_shr:2 row_mask:0xf bank_mask:0xf
    s_mov_b32 exec_lo, 0xff0000
    s_mov_b32 exec_hi, 0x0
    v_add_u32 v12, s13, v5
    v_mov_b32 v6, s12
    s_mov_b64 exec, -1
    v_max_u32_dpp v10, v10, v10 row_shr:4 row_mask:0xf bank_mask:0xf
    s_nop 1
    v_max_u32_dpp v10, v10, v10 row_shr:8 row_mask:0xf bank_mask:0xf
    s_nop 1
    v_max_u32_dpp v10, v10, v10 row_bcast:15 row_mask:0xa bank_mask:0xf
    s_nop 1
    v_max_u32_dpp v10, v10, v10 row_bcast:31 row_mask:0xc bank_mask:0xf
    s_nop 0
    v_readlane_b32 s8, v10, 63
    s_add_u32 s12, s12, s8
    v_subrev_u32 v10, s12, v8
    v_subrev_u32 v11, s12, v9
    v_max_u32 v10, v10, v11
    s_and_b32 s13, s12, 0x7ff
    s_sub_u32 s13, 2047, s13
    v_max_u32_dpp v10, v10, v10 row_shr:1 row_mask:0xf bank_mask:0xf
    s_mul_i32 s13, s13, 1152
    s_nop 0
    v_max_u32_dpp v10, v10, v10 row_shr:2 row_mask:0xf bank_mask:0xf
    s_mov_b32 exec_lo, 0xff000000
    s_mov_b32 exec_hi, 0x0
    v_add_u32 v12, s13, v5
    v_mov_b32 v6, s12
    s_mov_b64 exec, -1
    v_max_u32_dpp v10, v10, v10 row_shr:4 row_mask:0xf bank_mask:0xf
    s_nop 1
    v_max_u32_dpp v10, v10, v10 row_shr:8 row_mask:0xf bank_mask:0xf
    s_nop 1
    v_max_u32_dpp v10, v10, v10 row_bcast:15 row_mask:0xa bank_mask:0xf
    s_nop 1
    v_max_u32_dpp v10, v10, v10 row_bcast:31 row_mask:0xc bank_mask:0xf
    s_nop 0
    v_readlane_b32 s8, v10, 63
    s_add_u32 s12, s12, s8
    v_subrev_u32 v10, s12, v8
    v_subrev_u32 v11, s12, v9
    v_max_u32 v10, v10, v11
    s_and_b32 s13, s12, 0x7ff
    s_sub_u32 s13, 2047, s13
    v_max_u32_dpp v10, v10, v10 row_shr:1 row_mask:0xf bank_mask:0xf
    s_mul_i32 s13, s13, 1152
    s_nop 0
    v_max_u32_dpp v10, v10, v10 row_shr:2 row_mask:0xf bank_mask:0xf
    s_mov_b32 exec_lo, 0x0
    s_mov_b32 exec_hi, 0xff
    v_add_u32 v12, s13, v5
    v_mov_b32 v6, s12
    s_mov_b64 exec, -1
    v_max_u32_dpp v10, v10, v10 row_shr:4 row_mask:0xf bank_mask:0xf
    s_nop 1
    v_max_u32_dpp v10, v10, v10 row_shr:8 row_mask:0xf bank_mask:0xf
    s_nop 1
    v_max_u32_dpp v10, v10, v10 row_bcast:15 row_mask:0xa bank_mask:0xf
    s_nop 1
    v_max_u32_dpp v10, v10, v10 row_bcast:31 row_mask:0xc bank_mask:0xf
    s_nop 0
    v_readlane_b32 s8, v10, 63
    s_add_u32 s12, s12, s8
    v_subrev_u32 v10, s12, v8
    v_subrev_u32 v11, s12, v9
    v_max_u32 v10, v10, v11
    s_and_b32 s13, s12, 0x7ff
    s_sub_u32 s13, 2047, s13
    v_max_u32_dpp v10, v10, v10 row_shr:1 row_mask:0xf bank_mask:0xf
    s_mul_i32 s13, s13, 1152
    s_nop 0
    v_max_u32_dpp v10, v10, v10 row_shr:2 row_mask:0xf bank_mask:0xf
    s_mov_b32 exec_lo, 0x0
    s_mov_b32 exec_hi, 0xff00
    v_add_u32 v12, s13, v5
    v_mov_b32 v6, s12
    s_mov_b64 exec, -1
    v_max_u32_dpp v10, v10, v10 row_shr:4 row_mask:0xf bank_mask:0xf
    s_nop 1
    v_max_u32_dpp v10, v10, v10 row_shr:8 row_mask:0xf bank_mask:0xf
    s_nop 1
    v_max_u32_dpp v10, v10, v10 row_bcast:15 row_mask:0xa bank_mask:0xf
    s_nop 1
    v_max_u32_dpp v10, v10, v10 row_bcast:31 row_mask:0xc bank_mask:0xf
    s_nop 0
    v_readlane_b32 s8, v10, 63
    s_add_u32 s12, s12, s8
    v_subrev_u32 v10, s12, v8
    v_subrev_u32 v11, s12, v9
    v_max_u32 v10, v10, v11
    s_and_b32 s13, s12, 0x7ff
    s_sub_u32 s13, 2047, s13
    v_max_u32_dpp v10, v10, v10 row_shr:1 row_mask:0xf bank_mask:0xf
    s_mul_i32 s13, s13, 1152
    s_nop 0
    v_max_u32_dpp v10, v10, v10 row_shr:2 row_mask:0xf bank_mask:0xf
    s_mov_b32 exec_lo, 0x0
    s_mov_b32 exec_hi, 0xff0000
    v_add_u32 v12, s13, v5
    v_mov_b32 v6, s12
    s_mov_b64 exec, -1
    v_max_u32_dpp v10, v10, v10 row_shr:4 row_mask:0xf bank_mask:0xf
    s_nop 1
    v_max_u32_dpp v10, v10, v10 row_shr:8 row_mask:0xf bank_mask:0xf
    s_nop 1
    v_max_u32_dpp v10, v10, v10 row_bcast:15 row_mask:0xa bank_mask:0xf
    s_nop 1
    v_max_u32_dpp v10, v10, v10 row_bcast:31 row_mask:0xc bank_mask:0xf
    s_nop 0
    v_readlane_b32 s8, v10, 63
    s_add_u32 s12, s12, s8
    s_and_b32 s13, s12, 0x7ff
    s_sub_u32 s13, 2047, s13
    s_mul_i32 s13, s13, 1152
    s_mov_b32 exec_lo, 0x0
    s_mov_b32 exec_hi, 0xff000000
    v_add_u32 v12, s13, v5
    v_mov_b32 v6, s12
    s_mov_b64 exec, -1
    s_mov_b32 s14, 0
SEL_GATHER:
    s_mov_b32 m0, 147712
    s_nop 0
    buffer_load_dwordx4 v12, s[52:55], 0 offen offset:0 lds
    s_mov_b32 m0, 148608
    s_nop 0
    buffer_load_dwordx4 v12, s[52:55], 0 offen offset:128 lds
    s_mov_b32 m0, 149504
    s_nop 0
    buffer_load_dwordx4 v12, s[52:55], 0 offen offset:256 lds
    s_mov_b32 m0, 150400
    s_nop 0
    buffer_load_dwordx4 v12, s[52:55], 0 offen offset:384 lds
    s_mov_b32 m0, 151296
    s_nop 0
    buffer_load_dwordx4 v12, s[52:55], 0 offen offset:512 lds
    s_mov_b32 m0, 152192
    s_nop 0
    buffer_load_dwordx4 v12, s[52:55], 0 offen offset:640 lds
    s_mov_b32 m0, 153088
    s_nop 0
    buffer_load_dwordx4 v12, s[52:55], 0 offen offset:768 lds
    s_mov_b32 m0, 153984
    s_nop 0
    buffer_load_dwordx4 v12, s[52:55], 0 offen offset:896 lds
    s_mov_b32 m0, 154880
    s_nop 0
    buffer_load_dwordx4 v12, s[52:55], 0 offen offset:1024 lds
    v_mov_b32 v13, 1
    s_mov_b64 exec, 1
    ds_add_u32 v1, v13 offset:40
    s_mov_b64 exec, -1
    s_cmp_lg_u32 s14, 0
    s_cbranch_scc1 SEL_OK
    v_sub_u32 v16, v80, v9
    v_sub_u32 v17, v81, v9
    v_sub_u32 v18, v82, v9
    v_sub_u32 v19, v83, v9
    v_sub_u32 v20, v84, v9
    v_sub_u32 v21, v85, v9
    v_sub_u32 v22, v86, v9
    v_sub_u32 v23, v87, v9
    v_sub_u32 v24, v88, v9
    v_sub_u32 v25, v89, v9
    v_sub_u32 v26, v90, v9
    v_sub_u32 v27, v91, v9
    v_sub_u32 v28, v92, v9
    v_sub_u32 v29, v93, v9
    v_sub_u32 v30, v94, v9
    v_sub_u32 v31, v95, v9
    v_sub_u32 v32, v96, v9
    v_sub_u32 v33, v97, v9
    v_sub_u32 v34, v98, v9
    v_sub_u32 v35, v99, v9
    v_sub_u32 v36, v100, v9
    v_sub_u32 v37, v101, v9
    v_sub_u32 v38, v102, v9
    v_sub_u32 v39, v103, v9
    v_sub_u32 v40, v104, v9
    v_sub_u32 v41, v105, v9
    v_sub_u32 v42, v106, v9
    v_sub_u32 v43, v107, v9
    v_sub_u32 v44, v108, v9
    v_sub_u32 v45, v109, v9
    v_sub_u32 v46, v110, v9
    v_sub_u32 v47, v111, v9
    v_max3_u32 v16, v16, v17, v18
    v_max3_u32 v19, v19, v20, v21
    v_max3_u32 v22, v22, v23, v24
    v_max3_u32 v25, v25, v26, v27
    v_max3_u32 v28, v28, v29, v30
    v_max3_u32 v31, v31, v32, v33
    v_max3_u32 v34, v34, v35, v36
    v_max3_u32 v37, v37, v38, v39
    v_max3_u32 v40, v40, v41, v42
    v_max3_u32 v43, v43, v44, v45
    v_max3_u32 v16, v16, v19, v22
    v_max3_u32 v25, v25, v28, v31
    v_max3_u32 v34, v34, v37, v40
    v_max3_u32 v43, v43, v46, v47
    v_max3_u32 v16, v16, v25, v34
    v_max_u32 v16, v16, v43
    v_add_u32 v16, v16, v9
    v_cmp_lt_u32 vcc, s12, v16
    s_cmp_eq_u64 vcc, 0
    s_cbranch_scc1 SEL_OK
    s_waitcnt vmcnt(0)
    s_mov_b32 s12, 0
    s_mov_b64 s[56:57], 0xff
SEL_SLOW:
    v_subrev_u32 v16, s12, v80
    v_subrev_u32 v17, s12, v81
    v_subrev_u32 v18, s12, v82
    v_subrev_u32 v19, s12, v83
    v_subrev_u32 v20, s12, v84
    v_subrev_u32 v21, s12, v85
    v_subrev_u32 v22, s12, v86
    v_subrev_u32 v23, s12, v87
    v_subrev_u32 v24, s12, v88
    v_subrev_u32 v25, s12, v89
    v_subrev_u32 v26, s12, v90
    v_subrev_u32 v27, s12, v91
    v_subrev_u32 v28, s12, v92
    v_subrev_u32 v29, s12, v93
    v_subrev_u32 v30, s12, v94
    v_subrev_u32 v31, s12, v95
    v_subrev_u32 v32, s12, v96
    v_subrev_u32 v33, s12, v97
    v_subrev_u32 v34, s12, v98
    v_subrev_u32 v35, s12, v99
    v_subrev_u32 v36, s12, v100
    v_subrev_u32 v37, s12, v101
    v_subrev_u32 v38, s12, v102
    v_subrev_u32 v39, s12, v103
    v_subrev_u32 v40, s12, v104
    v_subrev_u32 v41, s12, v105
    v_subrev_u32 v42, s12, v106
    v_subrev_u32 v43, s12, v107
    v_subrev_u32 v44, s12, v108
    v_subrev_u32 v45, s12, v109
    v_subrev_u32 v46, s12, v110
    v_subrev_u32 v47, s12, v111
    v_max3_u32 v16, v16, v17, v18
    v_max3_u32 v19, v19, v20, v21
    v_max3_u32 v22, v22, v23, v24
    v_max3_u32 v25, v25, v26, v27
    v_max3_u32 v28, v28, v29, v30
    v_max3_u32 v31, v31, v32, v33
    v_max3_u32 v34, v34, v35, v36
    v_max3_u32 v37, v37, v38, v39
    v_max3_u32 v40, v40, v41, v42
    v_max3_u32 v43, v43, v44, v45
    v_max3_u32 v16, v16, v19, v22
    v_max3_u32 v25, v25, v28, v31
    v_max3_u32 v34, v34, v37, v40
    v_max3_u32 v43, v43, v46, v47
    v_max3_u32 v16, v16, v25, v34
    v_max_u32 v16, v16, v43
    s_nop 1
    v_max_u32_dpp v16, v16, v16 row_shr:1 row_mask:0xf bank_mask:0xf
    s_nop 1
    v_max_u32_dpp v16, v16, v16 row_shr:2 row_mask:0xf bank_mask:0xf
    s_nop 1
    v_max_u32_dpp v16, v16, v16 row_shr:4 row_mask:0xf bank_mask:0xf
    s_nop 1
    v_max_u32_dpp v16, v16, v16 row_shr:8 row_mask:0xf bank_mask:0xf
    s_nop 1
    v_max_u32_dpp v16, v16, v16 row_bcast:15 row_mask:0xa bank_mask:0xf
    s_nop 1
    v_max_u32_dpp v16, v16, v16 row_bcast:31 row_mask:0xc bank_mask:0xf
    s_nop 0
    v_readlane_b32 s8, v16, 63
    s_add_u32 s12, s12, s8
    s_and_b32 s13, s12, 0x7ff
    s_sub_u32 s13, 2047, s13
    s_mul_i32 s13, s13, 1152
    s_mov_b64 exec, s[56:57]
    v_add_u32 v12, s13, v5
    v_mov_b32 v6, s12
    s_mov_b64 exec, -1
    s_lshl_b64 s[56:57], s[56:57], 8
    s_add_u32 s14, s14, 1
    s_cmp_lt_u32 s14, 8
    s_cbranch_scc1 SEL_SLOW
    s_branch SEL_GATHER
SEL_OK:
    s_cmp_lg_u32 s2, 0
    s_cbranch_scc1 SEL_NOPUB
    v_mov_b32 v7, v14
    v_add_u32 v8, 8192, v2
    s_mov_b32 exec_lo, 0x01010101
    s_mov_b32 exec_hi, 0x01010101
    global_store_dwordx2 v8, v[6:7], s[50:51] sc1
    s_mov_b64 exec, 1
    global_store_dword v8, v14, s[50:51] offset:256 sc1
    s_mov_b64 exec, -1
    s_waitcnt vmcnt(2)
    s_branch SEL_END
SEL_NOPUB:
    s_waitcnt vmcnt(0)
SEL_END:
    v_mov_b32 v8, 3
    ds_write_b32 v1, v8 offset:84
    s_endpgm
F_COMP:
F_COMP2:
    s_and_b32 s12, s3, 3
    v_lshrrev_b32 v5, 2, v3
    v_bfe_u32 v7, v3, 3, 1
    v_and_b32 v13, 1, v4
    v_lshl_or_b32 v14, v13, 1, v7
    v_and_b32 v15, 7, v3
    v_mul_u32_u24 v16, 144, v15
    v_add_u32 v16, 156928, v16
    s_mov_b32 s56, 0xff00ff00
    s_mov_b32 s57, 0xff00ff00
    s_lshr_b32 s8, s3, 2
    s_cmp_lg_u32 s8, 1
    s_cbranch_scc1 F_DOWN
    v_bfe_u32 v6, v3, 1, 1
    v_lshl_or_b32 v8, v6, 2, v14
    v_xor_b32 v8, s12, v8
    v_lshlrev_b32 v8, 4, v8
    v_lshl_add_u32 v8, v5, 7, v8
    v_lshl_add_u32 v8, v6, 10, v8
    v_lshl_add_u32 v8, v4, 11, v8
    v_and_b32 v9, 1, v3
    v_lshl_add_u32 v8, v9, 3, v8
    v_xor_b32 v9, 64, v8
    v_add_u32 v10, 49408, v8
    v_add_u32 v11, 49408, v9
    v_lshlrev_b32 v6, 2, v13
    v_lshrrev_b32 v5, 1, v4
    v_add_u32 v6, v6, v5
    v_lshl_add_u32 v6, v7, 5, v6
    s_lshl_b32 s8, s12, 3
    v_add_lshl_u32 v6, v6, s8, 1
    v_add_u32 v5, v6, v16
    v_and_b32 v6, 6, v3
    v_xor_b32 v6, v6, v4
    v_lshlrev_b32 v6, 4, v6
    v_lshl_add_u32 v6, v15, 7, v6
    v_add_u32 v6, 147712, v6
    v_xor_b32 v7, 64, v6
    s_mov_b32 s9, 0
SP_43:
    ds_read_b32 v12, v1 offset:16
    s_waitcnt lgkmcnt(0)
    v_readfirstlane_b32 s8, v12
    s_add_u32 s9, s9, 1
    s_cmp_ge_u32 s8, 3
    s_cbranch_scc1 SP_43_D
    s_sleep 1
    s_cmp_lt_u32 s9, 524288
    s_cbranch_scc1 SP_43
SP_43_D:
    ds_read_b64_tr_b16 v[24:25], v8 offset:256
    ds_read_b64_tr_b16 v[26:27], v8 offset:768
    ds_read_b64_tr_b16 v[28:29], v9 offset:256
    ds_read_b64_tr_b16 v[30:31], v9 offset:768
    ds_read_b64_tr_b16 v[32:33], v8 offset:8448
    ds_read_b64_tr_b16 v[34:35], v8 offset:8960
    ds_read_b64_tr_b16 v[36:37], v9 offset:8448
    ds_read_b64_tr_b16 v[38:39], v9 offset:8960
    ds_read_b64_tr_b16 v[40:41], v8 offset:16640
    ds_read_b64_tr_b16 v[42:43], v8 offset:17152
    ds_read_b64_tr_b16 v[44:45], v9 offset:16640
    ds_read_b64_tr_b16 v[46:47], v9 offset:17152
    s_waitcnt lgkmcnt(0)
    v_mov_b32 v12, 1
    s_mov_b64 exec, 1
    ds_add_u32 v1, v12 offset:48
    s_mov_b64 exec, -1
    s_mov_b32 s9, 0
SP_44:
    ds_read_b32 v12, v1 offset:20
    s_waitcnt lgkmcnt(0)
    v_readfirstlane_b32 s8, v12
    s_add_u32 s9, s9, 1
    s_cmp_ge_u32 s8, 3
    s_cbranch_scc1 SP_44_D
    s_sleep 1
    s_cmp_lt_u32 s9, 524288
    s_cbranch_scc1 SP_44
SP_44_D:
    ds_read_b64_tr_b16 v[48:49], v8 offset:24832
    ds_read_b64_tr_b16 v[50:51], v8 offset:25344
    ds_read_b64_tr_b16 v[52:53], v9 offset:24832
    ds_read_b64_tr_b16 v[54:55], v9 offset:25344
    ds_read_b64_tr_b16 v[56:57], v8 offset:33024
    ds_read_b64_tr_b16 v[58:59], v8 offset:33536
    ds_read_b64_tr_b16 v[60:61], v9 offset:33024
    ds_read_b64_tr_b16 v[62:63], v9 offset:33536
    ds_read_b64_tr_b16 v[64:65], v8 offset:41216
    ds_read_b64_tr_b16 v[66:67], v8 offset:41728
    ds_read_b64_tr_b16 v[68:69], v9 offset:41216
    ds_read_b64_tr_b16 v[70:71], v9 offset:41728
    s_waitcnt lgkmcnt(0)
    v_mov_b32 v12, 1
    s_mov_b64 exec, 1
    ds_add_u32 v1, v12 offset:52
    s_mov_b64 exec, -1
    s_mov_b32 s9, 0
SP_45:
    ds_read_b32 v12, v1 offset:24
    s_waitcnt lgkmcnt(0)
    v_readfirstlane_b32 s8, v12
    s_add_u32 s9, s9, 1
    s_cmp_ge_u32 s8, 3
    s_cbranch_scc1 SP_45_D
    s_sleep 1
    s_cmp_lt_u32 s9, 524288
    s_cbranch_scc1 SP_45
SP_45_D:
    ds_read_b64_tr_b16 v[72:73], v10 offset:0
    ds_read_b64_tr_b16 v[74:75], v10 offset:512
    ds_read_b64_tr_b16 v[76:77], v11 offset:0
    ds_read_b64_tr_b16 v[78:79], v11 offset:512
    ds_read_b64_tr_b16 v[80:81], v10 offset:8192
    ds_read_b64_tr_b16 v[82:83], v10 offset:8704
    ds_read_b64_tr_b16 v[84:85], v11 offset:8192
    ds_read_b64_tr_b16 v[86:87], v11 offset:8704
    ds_read_b64_tr_b16 v[88:89], v10 offset:16384
    ds_read_b64_tr_b16 v[90:91], v10 offset:16896
    ds_read_b64_tr_b16 v[92:93], v11 offset:16384
    ds_read_b64_tr_b16 v[94:95], v11 offset:16896
    s_waitcnt lgkmcnt(0)
    v_mov_b32 v12, 1
    s_mov_b64 exec, 1
    ds_add_u32 v1, v12 offset:56
    s_mov_b64 exec, -1
    s_mov_b32 s9, 0
SP_46:
    ds_read_b32 v12, v1 offset:28
    s_waitcnt lgkmcnt(0)
    v_readfirstlane_b32 s8, v12
    s_add_u32 s9, s9, 1
    s_cmp_ge_u32 s8, 3
    s_cbranch_scc1 SP_46_D
    s_sleep 1
    s_cmp_lt_u32 s9, 524288
    s_cbranch_scc1 SP_46
SP_46_D:
    ds_read_b64_tr_b16 v[96:97], v8 offset:256
    ds_read_b64_tr_b16 v[98:99], v8 offset:768
    ds_read_b64_tr_b16 v[100:101], v9 offset:256
    ds_read_b64_tr_b16 v[102:103], v9 offset:768
    ds_read_b64_tr_b16 v[104:105], v8 offset:8448
    ds_read_b64_tr_b16 v[106:107], v8 offset:8960
    ds_read_b64_tr_b16 v[108:109], v9 offset:8448
    ds_read_b64_tr_b16 v[110:111], v9 offset:8960
    ds_read_b64_tr_b16 v[112:113], v8 offset:16640
    ds_read_b64_tr_b16 v[114:115], v8 offset:17152
    ds_read_b64_tr_b16 v[116:117], v9 offset:16640
    ds_read_b64_tr_b16 v[118:119], v9 offset:17152
    s_mov_b32 s9, 0
SP_47:
    ds_read_b32 v12, v1 offset:32
    s_waitcnt lgkmcnt(0)
    v_readfirstlane_b32 s8, v12
    s_add_u32 s9, s9, 1
    s_cmp_ge_u32 s8, 3
    s_cbranch_scc1 SP_47_D
    s_sleep 1
    s_cmp_lt_u32 s9, 524288
    s_cbranch_scc1 SP_47
SP_47_D:
    ds_read_b64_tr_b16 v[120:121], v8 offset:24832
    ds_read_b64_tr_b16 v[122:123], v8 offset:25344
    ds_read_b64_tr_b16 v[124:125], v9 offset:24832
    ds_read_b64_tr_b16 v[126:127], v9 offset:25344
    ds_read_b64_tr_b16 v[128:129], v8 offset:33024
    ds_read_b64_tr_b16 v[130:131], v8 offset:33536
    ds_read_b64_tr_b16 v[132:133], v9 offset:33024
    ds_read_b64_tr_b16 v[134:135], v9 offset:33536
    ds_read_b64_tr_b16 v[136:137], v8 offset:41216
    ds_read_b64_tr_b16 v[138:139], v8 offset:41728
    ds_read_b64_tr_b16 v[140:141], v9 offset:41216
    ds_read_b64_tr_b16 v[142:143], v9 offset:41728
    s_mov_b32 s9, 0
SP_48:
    ds_read_b32 v12, v1 offset:36
    s_waitcnt lgkmcnt(0)
    v_readfirstlane_b32 s8, v12
    s_add_u32 s9, s9, 1
    s_cmp_ge_u32 s8, 3
    s_cbranch_scc1 SP_48_D
    s_sleep 1
    s_cmp_lt_u32 s9, 524288
    s_cbranch_scc1 SP_48
SP_48_D:
    ds_read_b64_tr_b16 v[144:145], v10 offset:0
    ds_read_b64_tr_b16 v[146:147], v10 offset:512
    ds_read_b64_tr_b16 v[148:149], v11 offset:0
    ds_read_b64_tr_b16 v[150:151], v11 offset:512
    ds_read_b64_tr_b16 v[152:153], v10 offset:8192
    ds_read_b64_tr_b16 v[154:155], v10 offset:8704
    ds_read_b64_tr_b16 v[156:157], v11 offset:8192
    ds_read_b64_tr_b16 v[158:159], v11 offset:8704
    ds_read_b64_tr_b16 v[160:161], v10 offset:16384
    ds_read_b64_tr_b16 v[162:163], v10 offset:16896
    ds_read_b64_tr_b16 v[164:165], v11 offset:16384
    ds_read_b64_tr_b16 v[166:167], v11 offset:16896
    s_setprio 3
    s_mov_b32 s9, 0
SP_49:
    ds_read_b32 v12, v1 offset:84
    s_waitcnt lgkmcnt(0)
    v_readfirstlane_b32 s8, v12
    s_add_u32 s9, s9, 1
    s_cmp_ge_u32 s8, 1
    s_cbranch_scc1 SP_49_D
    s_cmp_lt_u32 s9, 524288
    s_cbranch_scc1 SP_49
SP_49_D:
    ds_read_b128 v[16:19], v6 offset:0
    ds_read_b128 v[20:23], v7 offset:0
    s_waitcnt lgkmcnt(1)
    v_mfma_f32_16x16x32_bf16 v[8:11], v[24:27], v[16:19], 0
    ds_read_b128 v[24:27], v6 offset:1024
    v_mfma_f32_16x16x32_bf16 v[12:15], v[28:31], v[16:19], 0
    ds_read_b128 v[28:31], v7 offset:1024
    s_waitcnt lgkmcnt(2)
    v_mfma_f32_16x16x32_bf16 v[8:11], v[32:35], v[20:23], v[8:11]
    ds_read_b128 v[32:35], v6 offset:2048
    v_mfma_f32_16x16x32_bf16 v[12:15], v[36:39], v[20:23], v[12:15]
    ds_read_b128 v[36:39], v7 offset:2048
    s_waitcnt lgkmcnt(3)
    v_mfma_f32_16x16x32_bf16 v[8:11], v[40:43], v[24:27], v[8:11]
    ds_read_b128 v[40:43], v6 offset:3072
    v_mfma_f32_16x16x32_bf16 v[12:15], v[44:47], v[24:27], v[12:15]
    ds_read_b128 v[44:47], v7 offset:3072
    s_waitcnt lgkmcnt(4)
    v_mfma_f32_16x16x32_bf16 v[8:11], v[48:51], v[28:31], v[8:11]
    ds_read_b128 v[48:51], v6 offset:4096
    v_mfma_f32_16x16x32_bf16 v[12:15], v[52:55], v[28:31], v[12:15]
    ds_read_b128 v[52:55], v7 offset:4096
    s_waitcnt lgkmcnt(5)
    v_mfma_f32_16x16x32_bf16 v[8:11], v[56:59], v[32:35], v[8:11]
    ds_read_b128 v[56:59], v6 offset:5120
    v_mfma_f32_16x16x32_bf16 v[12:15], v[60:63], v[32:35], v[12:15]
    ds_read_b128 v[60:63], v7 offset:5120
    s_waitcnt lgkmcnt(6)
    v_mfma_f32_16x16x32_bf16 v[8:11], v[64:67], v[36:39], v[8:11]
    ds_read_b128 v[64:67], v6 offset:6144
    v_mfma_f32_16x16x32_bf16 v[12:15], v[68:71], v[36:39], v[12:15]
    ds_read_b128 v[68:71], v7 offset:6144
    s_waitcnt lgkmcnt(7)
    v_mfma_f32_16x16x32_bf16 v[8:11], v[72:75], v[40:43], v[8:11]
    ds_read_b128 v[72:75], v6 offset:7168
    v_mfma_f32_16x16x32_bf16 v[12:15], v[76:79], v[40:43], v[12:15]
    ds_read_b128 v[76:79], v7 offset:7168
    s_waitcnt lgkmcnt(8)
    v_mfma_f32_16x16x32_bf16 v[8:11], v[80:83], v[44:47], v[8:11]
    ds_read_b128 v[80:83], v6 offset:8192
    v_mfma_f32_16x16x32_bf16 v[12:15], v[84:87], v[44:47], v[12:15]
    ds_read_b128 v[84:87], v7 offset:8192
    s_waitcnt lgkmcnt(9)
    v_mfma_f32_16x16x32_bf16 v[8:11], v[88:91], v[48:51], v[8:11]
    v_mfma_f32_16x16x32_bf16 v[12:15], v[92:95], v[48:51], v[12:15]
    s_waitcnt lgkmcnt(8)
    v_mfma_f32_16x16x32_bf16 v[8:11], v[96:99], v[52:55], v[8:11]
    v_mfma_f32_16x16x32_bf16 v[12:15], v[100:103], v[52:55], v[12:15]
    s_waitcnt lgkmcnt(7)
    v_mfma_f32_16x16x32_bf16 v[8:11], v[104:107], v[56:59], v[8:11]
    v_mfma_f32_16x16x32_bf16 v[12:15], v[108:111], v[56:59], v[12:15]
    s_waitcnt lgkmcnt(6)
    v_mfma_f32_16x16x32_bf16 v[8:11], v[112:115], v[60:63], v[8:11]
    v_mfma_f32_16x16x32_bf16 v[12:15], v[116:119], v[60:63], v[12:15]
    s_waitcnt lgkmcnt(5)
    v_mfma_f32_16x16x32_bf16 v[8:11], v[120:123], v[64:67], v[8:11]
    v_mfma_f32_16x16x32_bf16 v[12:15], v[124:127], v[64:67], v[12:15]
    s_waitcnt lgkmcnt(4)
    v_mfma_f32_16x16x32_bf16 v[8:11], v[128:131], v[68:71], v[8:11]
    v_mfma_f32_16x16x32_bf16 v[12:15], v[132:135], v[68:71], v[12:15]
    s_waitcnt lgkmcnt(3)
    v_mfma_f32_16x16x32_bf16 v[8:11], v[136:139], v[72:75], v[8:11]
    v_mfma_f32_16x16x32_bf16 v[12:15], v[140:143], v[72:75], v[12:15]
    s_waitcnt lgkmcnt(2)
    v_mfma_f32_16x16x32_bf16 v[8:11], v[144:147], v[76:79], v[8:11]
    v_mfma_f32_16x16x32_bf16 v[12:15], v[148:151], v[76:79], v[12:15]
    s_waitcnt lgkmcnt(1)
    v_mfma_f32_16x16x32_bf16 v[8:11], v[152:155], v[80:83], v[8:11]
    v_mfma_f32_16x16x32_bf16 v[12:15], v[156:159], v[80:83], v[12:15]
    s_waitcnt lgkmcnt(0)
    v_mfma_f32_16x16x32_bf16 v[8:11], v[160:163], v[84:87], v[8:11]
    v_mfma_f32_16x16x32_bf16 v[12:15], v[164:167], v[84:87], v[12:15]
    s_nop 7
    v_cndmask_b32 v8, v8, v12, s[56:57]
    v_cndmask_b32 v9, v9, v13, s[56:57]
    v_cndmask_b32 v10, v10, v14, s[56:57]
    v_cndmask_b32 v11, v11, v15, s[56:57]
    v_permlane32_swap_b32 v8, v9
    s_nop 0
    v_permlane32_swap_b32 v10, v11
    v_cvt_pk_bf16_f32 v9, v8, v9
    v_cvt_pk_bf16_f32 v11, v10, v11
    v_lshlrev_b32 v8, 16, v9
    v_lshlrev_b32 v10, 16, v11
    v_mul_f32 v12, 0xbfb8aa3b, v8
    v_mul_f32 v13, 0xbfb8aa3b, v10
    v_exp_f32 v12, v12
    v_exp_f32 v13, v13
    v_and_b32 v9, 0xffff0000, v9
    v_and_b32 v11, 0xffff0000, v11
    v_add_f32 v12, 1.0, v12
    v_add_f32 v13, 1.0, v13
    v_rcp_f32 v12, v12
    v_rcp_f32 v13, v13
    v_mul_f32 v8, v8, v12
    v_mul_f32 v10, v10, v13
    v_cvt_pk_bf16_f32 v8, v8, v8
    v_cvt_pk_bf16_f32 v10, v10, v10
    v_and_b32 v8, 0xffff0000, v8
    v_and_b32 v10, 0xffff0000, v10
    v_mul_f32 v8, v8, v9
    v_mul_f32 v10, v10, v11
    v_cvt_pk_bf16_f32 v8, v8, v10
    ds_write_b16 v5, v8
    ds_write_b16_d16_hi v5, v8 offset:4
    v_mov_b32 v12, 1
    s_mov_b64 exec, 1
    ds_add_u32 v1, v12 offset:88
    s_mov_b64 exec, -1
    s_endpgm
F_DOWN:
    v_lshl_add_u32 v10, v4, 4, v16
    v_mov_b32 v18, 158080
    v_cndmask_b32 v19, v18, v10, s[56:57]
    v_cndmask_b32 v18, v10, v18, s[56:57]
    v_and_b32 v20, 31, v2
    v_lshlrev_b32 v20, 2, v20
    v_add_u32 v20, 158080, v20
    ds_write_b32 v20, v1
    v_mul_u32_u24 v8, 9216, v4
    s_mul_i32 s13, s7, 73728
    s_mov_b32 s60, 0x7060500
    s_mov_b32 s61, 0x7060501
    s_mov_b32 s62, 0x7060502
    s_mov_b32 s63, 0x7060503
    s_mov_b32 s64, 0x05040100
    s_mov_b32 s65, 0x07060302
    s_lshl_b32 s14, s7, 7
    s_add_u32 s14, s14, 32768
    v_lshl_add_u32 v11, v15, 4, s14
    s_waitcnt lgkmcnt(0)
    s_mov_b32 s52, s50
    s_mov_b32 s53, s51
    s_mov_b32 s54, 268435456
    s_mov_b32 s55, 0x20000
    s_mov_b32 s68, s42
    s_mov_b32 s69, s43
    s_mov_b32 s70, 5308416
    s_mov_b32 s71, 0x20000
    s_cmp_eq_u32 s3, 9
    s_cbranch_scc1 F_DN2
    v_lshl_add_u32 v8, v3, 4, v8
    s_lshl_b32 s8, s3, 8
    s_add_u32 s13, s13, s8
    s_lshl_b32 s8, s3, 5
    v_lshl_add_u32 v6, v4, 3, v7
    v_add_u32 v6, s8, v6
    v_mul_u32_u24 v6, 9216, v6
    v_add_u32 v11, v6, v11
    s_mov_b32 s9, 0
SP_50:
    ds_read_b32 v17, v1 offset:8
    s_waitcnt lgkmcnt(0)
    v_readfirstlane_b32 s8, v17
    s_add_u32 s9, s9, 1
    s_cmp_lg_u32 s8, 0
    s_cbranch_scc1 SP_50_D
    s_sleep 2
    s_cmp_lt_u32 s9, 524288
    s_cbranch_scc1 SP_50
SP_50_D:
    s_mov_b32 s9, 0
SP_51:
    ds_read_b32 v12, v1 offset:40
    s_waitcnt lgkmcnt(0)
    v_readfirstlane_b32 s8, v12
    s_add_u32 s9, s9, 1
    s_cmp_ge_u32 s8, 3
    s_cbranch_scc1 SP_51_D
    s_sleep 1
    s_cmp_lt_u32 s9, 524288
    s_cbranch_scc1 SP_51
SP_51_D:
    s_setprio 2
    buffer_load_dwordx4 v[24:27], v8, s[68:71], s13 offen offset:0
    buffer_load_dwordx4 v[28:31], v8, s[68:71], s13 offen offset:1152
    buffer_load_dwordx4 v[32:35], v8, s[68:71], s13 offen offset:2304
    buffer_load_dwordx4 v[36:39], v8, s[68:71], s13 offen offset:3456
    s_add_u32 s13, s13, 4608
    s_mov_b32 s9, 0
SP_52:
    ds_read_b32 v12, v1 offset:40
    s_waitcnt lgkmcnt(0)
    v_readfirstlane_b32 s8, v12
    s_add_u32 s9, s9, 1
    s_cmp_ge_u32 s8, 4
    s_cbranch_scc1 SP_52_D
    s_sleep 1
    s_cmp_lt_u32 s9, 524288
    s_cbranch_scc1 SP_52
SP_52_D:
    buffer_load_dwordx4 v[40:43], v8, s[68:71], s13 offen offset:0
    buffer_load_dwordx4 v[44:47], v8, s[68:71], s13 offen offset:1152
    buffer_load_dwordx4 v[48:51], v8, s[68:71], s13 offen offset:2304
    buffer_load_dwordx4 v[52:55], v8, s[68:71], s13 offen offset:3456
    s_add_u32 s13, s13, 32256
    buffer_load_dwordx4 v[88:91], v8, s[68:71], s13 offen offset:0
    buffer_load_dwordx4 v[92:95], v8, s[68:71], s13 offen offset:1152
    buffer_load_dwordx4 v[96:99], v8, s[68:71], s13 offen offset:2304
    buffer_load_dwordx4 v[100:103], v8, s[68:71], s13 offen offset:3456
    s_add_u32 s13, s13, 4608
    buffer_load_dwordx4 v[104:107], v8, s[68:71], s13 offen offset:0
    buffer_load_dwordx4 v[108:111], v8, s[68:71], s13 offen offset:1152
    buffer_load_dwordx4 v[112:115], v8, s[68:71], s13 offen offset:2304
    buffer_load_dwordx4 v[116:119], v8, s[68:71], s13 offen offset:3456
    s_add_u32 s13, s13, 32256
    s_waitcnt vmcnt(14)
    v_perm_b32 v56, v28, v24, s64
    v_perm_b32 v60, v28, v24, s65
    v_perm_b32 v64, v29, v25, s64
    v_perm_b32 v68, v29, v25, s65
    v_perm_b32 v72, v30, v26, s64
    v_perm_b32 v76, v30, v26, s65
    v_perm_b32 v80, v31, v27, s64
    v_perm_b32 v84, v31, v27, s65
    s_waitcnt vmcnt(12)
    v_perm_b32 v57, v36, v32, s64
    v_perm_b32 v61, v36, v32, s65
    v_perm_b32 v65, v37, v33, s64
    v_perm_b32 v69, v37, v33, s65
    v_perm_b32 v73, v38, v34, s64
    v_perm_b32 v77, v38, v34, s65
    v_perm_b32 v81, v39, v35, s64
    v_perm_b32 v85, v39, v35, s65
    s_waitcnt vmcnt(10)
    v_perm_b32 v58, v44, v40, s64
    v_perm_b32 v62, v44, v40, s65
    v_perm_b32 v66, v45, v41, s64
    v_perm_b32 v70, v45, v41, s65
    v_perm_b32 v74, v46, v42, s64
    v_perm_b32 v78, v46, v42, s65
    v_perm_b32 v82, v47, v43, s64
    v_perm_b32 v86, v47, v43, s65
    s_waitcnt vmcnt(8)
    v_perm_b32 v59, v52, v48, s64
    v_perm_b32 v63, v52, v48, s65
    v_perm_b32 v67, v53, v49, s64
    v_perm_b32 v71, v53, v49, s65
    v_perm_b32 v75, v54, v50, s64
    v_perm_b32 v79, v54, v50, s65
    v_perm_b32 v83, v55, v51, s64
    v_perm_b32 v87, v55, v51, s65
    s_waitcnt vmcnt(6)
    v_perm_b32 v24, v92, v88, s64
    v_perm_b32 v28, v92, v88, s65
    v_perm_b32 v32, v93, v89, s64
    v_perm_b32 v36, v93, v89, s65
    v_perm_b32 v40, v94, v90, s64
    v_perm_b32 v44, v94, v90, s65
    v_perm_b32 v48, v95, v91, s64
    v_perm_b32 v52, v95, v91, s65
    s_waitcnt vmcnt(4)
    v_perm_b32 v25, v100, v96, s64
    v_perm_b32 v29, v100, v96, s65
    v_perm_b32 v33, v101, v97, s64
    v_perm_b32 v37, v101, v97, s65
    v_perm_b32 v41, v102, v98, s64
    v_perm_b32 v45, v102, v98, s65
    v_perm_b32 v49, v103, v99, s64
    v_perm_b32 v53, v103, v99, s65
    s_mov_b32 s9, 0
SP_53:
    ds_read_b32 v12, v1 offset:88
    s_waitcnt lgkmcnt(0)
    v_readfirstlane_b32 s8, v12
    s_add_u32 s9, s9, 1
    s_cmp_ge_u32 s8, 4
    s_cbranch_scc1 SP_53_D
    s_cmp_lt_u32 s9, 524288
    s_cbranch_scc1 SP_53
SP_53_D:
    ds_read_b128 v[152:155], v18 offset:0
    ds_read_b128 v[160:163], v19 offset:0
    ds_read_b128 v[156:159], v18 offset:64
    ds_read_b128 v[164:167], v19 offset:64
    s_waitcnt lgkmcnt(2)
    v_mfma_f32_16x16x32_bf16 v[120:123], v[56:59], v[152:155], 0
    v_mfma_f32_16x16x32_bf16 v[124:127], v[60:63], v[152:155], 0
    v_mfma_f32_16x16x32_bf16 v[128:131], v[64:67], v[152:155], 0
    v_mfma_f32_16x16x32_bf16 v[132:135], v[68:71], v[152:155], 0
    v_mfma_f32_16x16x32_bf16 v[120:123], v[72:75], v[160:163], v[120:123]
    v_mfma_f32_16x16x32_bf16 v[124:127], v[76:79], v[160:163], v[124:127]
    v_mfma_f32_16x16x32_bf16 v[128:131], v[80:83], v[160:163], v[128:131]
    v_mfma_f32_16x16x32_bf16 v[132:135], v[84:87], v[160:163], v[132:135]
    s_waitcnt lgkmcnt(0)
    s_waitcnt vmcnt(2)
    v_perm_b32 v26, v108, v104, s64
    v_perm_b32 v30, v108, v104, s65
    v_perm_b32 v34, v109, v105, s64
    v_perm_b32 v38, v109, v105, s65
    v_perm_b32 v42, v110, v106, s64
    v_perm_b32 v46, v110, v106, s65
    v_perm_b32 v50, v111, v107, s64
    v_perm_b32 v54, v111, v107, s65
    s_waitcnt vmcnt(0)
    v_perm_b32 v27, v116, v112, s64
    v_perm_b32 v31, v116, v112, s65
    v_perm_b32 v35, v117, v113, s64
    v_perm_b32 v39, v117, v113, s65
    v_perm_b32 v43, v118, v114, s64
    v_perm_b32 v47, v118, v114, s65
    v_perm_b32 v51, v119, v115, s64
    v_perm_b32 v55, v119, v115, s65
    v_mfma_f32_16x16x32_bf16 v[120:123], v[24:27], v[156:159], v[120:123]
    v_mfma_f32_16x16x32_bf16 v[124:127], v[28:31], v[156:159], v[124:127]
    v_mfma_f32_16x16x32_bf16 v[128:131], v[32:35], v[156:159], v[128:131]
    v_mfma_f32_16x16x32_bf16 v[132:135], v[36:39], v[156:159], v[132:135]
    v_mfma_f32_16x16x32_bf16 v[120:123], v[40:43], v[164:167], v[120:123]
    v_mfma_f32_16x16x32_bf16 v[124:127], v[44:47], v[164:167], v[124:127]
    v_mfma_f32_16x16x32_bf16 v[128:131], v[48:51], v[164:167], v[128:131]
    v_mfma_f32_16x16x32_bf16 v[132:135], v[52:55], v[164:167], v[132:135]
    s_nop 4
    v_perm_b32 v88, v120, v17, s60
    v_perm_b32 v89, v124, v17, s61
    v_perm_b32 v90, v128, v17, s62
    v_perm_b32 v91, v132, v17, s63
    s_mov_b32 s12, 0
    buffer_store_dwordx4 v[88:91], v11, s[52:55], s12 offen sc1
    v_perm_b32 v92, v121, v17, s60
    v_perm_b32 v93, v125, v17, s61
    v_perm_b32 v94, v129, v17, s62
    v_perm_b32 v95, v133, v17, s63
    s_mov_b32 s12, 18432
    buffer_store_dwordx4 v[92:95], v11, s[52:55], s12 offen sc1
    v_perm_b32 v96, v122, v17, s60
    v_perm_b32 v97, v126, v17, s61
    v_perm_b32 v98, v130, v17, s62
    v_perm_b32 v99, v134, v17, s63
    s_mov_b32 s12, 36864
    buffer_store_dwordx4 v[96:99], v11, s[52:55], s12 offen sc1
    v_perm_b32 v100, v123, v17, s60
    v_perm_b32 v101, v127, v17, s61
    v_perm_b32 v102, v131, v17, s62
    v_perm_b32 v103, v135, v17, s63
    s_mov_b32 s12, 55296
    buffer_store_dwordx4 v[100:103], v11, s[52:55], s12 offen sc1
    s_endpgm
F_DN2:
    v_lshl_add_u32 v8, v3, 3, v8
    s_add_u32 s13, s13, 1024
    v_lshl_add_u32 v6, v4, 2, v7
    v_add_u32 v6, 128, v6
    v_mul_u32_u24 v6, 9216, v6
    v_add_u32 v11, v6, v11
    s_mov_b32 s9, 0
SP_54:
    ds_read_b32 v17, v1 offset:8
    s_waitcnt lgkmcnt(0)
    v_readfirstlane_b32 s8, v17
    s_add_u32 s9, s9, 1
    s_cmp_lg_u32 s8, 0
    s_cbranch_scc1 SP_54_D
    s_cmp_lt_u32 s9, 524288
    s_cbranch_scc1 SP_54
SP_54_D:
    buffer_load_dwordx2 v[24:25], v8, s[68:71], s13 offen offset:0
    buffer_load_dwordx2 v[26:27], v8, s[68:71], s13 offen offset:1152
    buffer_load_dwordx2 v[28:29], v8, s[68:71], s13 offen offset:2304
    buffer_load_dwordx2 v[30:31], v8, s[68:71], s13 offen offset:3456
    s_add_u32 s13, s13, 4608
    buffer_load_dwordx2 v[32:33], v8, s[68:71], s13 offen offset:0
    buffer_load_dwordx2 v[34:35], v8, s[68:71], s13 offen offset:1152
    buffer_load_dwordx2 v[36:37], v8, s[68:71], s13 offen offset:2304
    buffer_load_dwordx2 v[38:39], v8, s[68:71], s13 offen offset:3456
    s_add_u32 s13, s13, 32256
    buffer_load_dwordx2 v[88:89], v8, s[68:71], s13 offen offset:0
    buffer_load_dwordx2 v[90:91], v8, s[68:71], s13 offen offset:1152
    buffer_load_dwordx2 v[92:93], v8, s[68:71], s13 offen offset:2304
    buffer_load_dwordx2 v[94:95], v8, s[68:71], s13 offen offset:3456
    s_add_u32 s13, s13, 4608
    buffer_load_dwordx2 v[96:97], v8, s[68:71], s13 offen offset:0
    buffer_load_dwordx2 v[98:99], v8, s[68:71], s13 offen offset:1152
    buffer_load_dwordx2 v[100:101], v8, s[68:71], s13 offen offset:2304
    buffer_load_dwordx2 v[102:103], v8, s[68:71], s13 offen offset:3456
    s_add_u32 s13, s13, 32256
    s_waitcnt vmcnt(14)
    v_perm_b32 v56, v26, v24, s64
    v_perm_b32 v60, v26, v24, s65
    v_perm_b32 v64, v27, v25, s64
    v_perm_b32 v68, v27, v25, s65
    s_waitcnt vmcnt(12)
    v_perm_b32 v57, v30, v28, s64
    v_perm_b32 v61, v30, v28, s65
    v_perm_b32 v65, v31, v29, s64
    v_perm_b32 v69, v31, v29, s65
    s_waitcnt vmcnt(10)
    v_perm_b32 v58, v34, v32, s64
    v_perm_b32 v62, v34, v32, s65
    v_perm_b32 v66, v35, v33, s64
    v_perm_b32 v70, v35, v33, s65
    s_waitcnt vmcnt(8)
    v_perm_b32 v59, v38, v36, s64
    v_perm_b32 v63, v38, v36, s65
    v_perm_b32 v67, v39, v37, s64
    v_perm_b32 v71, v39, v37, s65
    s_waitcnt vmcnt(6)
    v_perm_b32 v24, v90, v88, s64
    v_perm_b32 v28, v90, v88, s65
    v_perm_b32 v32, v91, v89, s64
    v_perm_b32 v36, v91, v89, s65
    s_waitcnt vmcnt(4)
    v_perm_b32 v25, v94, v92, s64
    v_perm_b32 v29, v94, v92, s65
    v_perm_b32 v33, v95, v93, s64
    v_perm_b32 v37, v95, v93, s65
    s_mov_b32 s9, 0
SP_55:
    ds_read_b32 v12, v1 offset:88
    s_waitcnt lgkmcnt(0)
    v_readfirstlane_b32 s8, v12
    s_add_u32 s9, s9, 1
    s_cmp_ge_u32 s8, 4
    s_cbranch_scc1 SP_55_D
    s_cmp_lt_u32 s9, 524288
    s_cbranch_scc1 SP_55
SP_55_D:
    ds_read_b128 v[152:155], v10 offset:0
    ds_read_b128 v[156:159], v10 offset:64
    s_waitcnt lgkmcnt(1)
    v_mfma_f32_16x16x32_bf16 v[120:123], v[56:59], v[152:155], 0
    v_mfma_f32_16x16x32_bf16 v[124:127], v[60:63], v[152:155], 0
    v_mfma_f32_16x16x32_bf16 v[128:131], v[64:67], v[152:155], 0
    v_mfma_f32_16x16x32_bf16 v[132:135], v[68:71], v[152:155], 0
    s_waitcnt lgkmcnt(0)
    s_waitcnt vmcnt(2)
    v_perm_b32 v26, v98, v96, s64
    v_perm_b32 v30, v98, v96, s65
    v_perm_b32 v34, v99, v97, s64
    v_perm_b32 v38, v99, v97, s65
    s_waitcnt vmcnt(0)
    v_perm_b32 v27, v102, v100, s64
    v_perm_b32 v31, v102, v100, s65
    v_perm_b32 v35, v103, v101, s64
    v_perm_b32 v39, v103, v101, s65
    v_mfma_f32_16x16x32_bf16 v[120:123], v[24:27], v[156:159], v[120:123]
    v_mfma_f32_16x16x32_bf16 v[124:127], v[28:31], v[156:159], v[124:127]
    v_mfma_f32_16x16x32_bf16 v[128:131], v[32:35], v[156:159], v[128:131]
    v_mfma_f32_16x16x32_bf16 v[132:135], v[36:39], v[156:159], v[132:135]
    s_nop 4
    v_cndmask_b32 v88, v120, v121, s[56:57]
    v_cndmask_b32 v89, v124, v125, s[56:57]
    v_cndmask_b32 v90, v128, v129, s[56:57]
    v_cndmask_b32 v91, v132, v133, s[56:57]
    v_perm_b32 v88, v88, v17, s60
    v_perm_b32 v89, v89, v17, s61
    v_perm_b32 v90, v90, v17, s62
    v_perm_b32 v91, v91, v17, s63
    s_mov_b32 s12, 0
    buffer_store_dwordx4 v[88:91], v11, s[52:55], s12 offen sc1
    v_cndmask_b32 v92, v122, v123, s[56:57]
    v_cndmask_b32 v93, v126, v127, s[56:57]
    v_cndmask_b32 v94, v130, v131, s[56:57]
    v_cndmask_b32 v95, v134, v135, s[56:57]
    v_perm_b32 v92, v92, v17, s60
    v_perm_b32 v93, v93, v17, s61
    v_perm_b32 v94, v94, v17, s62
    v_perm_b32 v95, v95, v17, s63
    s_mov_b32 s12, 18432
    buffer_store_dwordx4 v[92:95], v11, s[52:55], s12 offen sc1
    s_endpgm
K_END:
    s_endpgm
CODE_END:
.section .rodata,"a"
.p2align 6
.amdhsa_kernel k1_kernel
  .amdhsa_next_free_vgpr 168
  .amdhsa_next_free_sgpr 102
  .amdhsa_accum_offset 168
  .amdhsa_group_segment_fixed_size 0
  .amdhsa_kernarg_size 144
  .amdhsa_user_sgpr_count 2
  .amdhsa_user_sgpr_kernarg_segment_ptr 1
  .amdhsa_system_sgpr_workgroup_id_x 1
.end_amdhsa_kernel
```

```asm
; @launch kernel=k1_kernel grid=(256,1,1) block=(768,1,1) lds=163840
.amdgcn_target "amdgcn-amd-amdhsa--gfx950"
.text
.p2align 8
.globl k1_kernel
.type k1_kernel,@function
k1_kernel:
    v_and_b32 v2, 63, v0
    v_mov_b32 v1, 0
    v_lshlrev_b32 v3, 2, v2
    ds_write_b32 v3, v1
    s_lshr_b32 s5, s2, 3
    v_lshlrev_b32 v8, 7, v0
    s_cmp_lg_u32 s5, 9
    s_cbranch_scc1 K_NOCPF
    s_getpc_b64 s[8:9]
    v_min_u32 v8, CODE_END-k1_kernel-64, v8
    global_load_dword v160, v8, s[8:9]
K_NOCPF:
    s_waitcnt lgkmcnt(0)
    s_load_dwordx16 s[16:31], s[0:1], 0
    s_load_dwordx16 s[32:47], s[0:1], 64
    s_load_dwordx4 s[48:51], s[0:1], 128
    v_lshrrev_b32 v4, 6, v0
    s_cmp_ge_u32 s5, 32
    v_readfirstlane_b32 s3, v4
    s_cbranch_scc1 K_END
    s_barrier
    s_cmp_eq_u32 s3, 8
    s_cbranch_scc1 ROUTER
    s_cmp_lt_u32 s5, 14
    s_cbranch_scc1 K_OTHER
    s_cmp_ge_u32 s3, 8
    s_cbranch_scc1 K_CIO
C_KGEN:
    s_and_b32 s4, s2, 7
    s_mul_i32 s7, s4, 18
    s_add_u32 s7, s7, s5
    s_sub_u32 s7, s7, 14
    s_and_b32 s12, s3, 3
    s_lshr_b32 s13, s3, 2
    s_lshl2_add_u32 s8, s7, s12
    s_lshl1_add_u32 s8, s8, s13
    s_lshl_b32 s8, s8, 7
    v_lshl_add_u32 v5, v2, 1, s8
    v_mov_b64 v[16:17], 0
    v_mov_b64 v[18:19], 0
    v_mov_b64 v[20:21], 0
    s_lshl_b32 s55, s7, 3
    s_waitcnt lgkmcnt(0)
    s_load_dwordx2 s[58:59], s[30:31], s55
    global_load_short_d16_hi v16, v5, s[18:19]
    global_load_short_d16_hi v17, v5, s[20:21]
    global_load_short_d16_hi v18, v5, s[22:23]
    global_load_short_d16_hi v19, v5, s[24:25]
    global_load_short_d16_hi v20, v5, s[26:27]
    global_load_short_d16_hi v21, v5, s[28:29]
    s_branch C_KBODY
.p2align 7
ROUTER:
    v_lshrrev_b32 v5, 3, v2
    v_and_b32 v6, 7, v2
    v_lshlrev_b32 v9, 4, v6
    v_lshl_add_u32 v5, s2, 3, v5
    v_mul_u32_u24 v8, 1152, v5
    v_add_u32 v8, v8, v9
    v_min_u32 v10, 8, v2
    v_lshlrev_b32 v10, 7, v10
    s_waitcnt lgkmcnt(0)
    global_load_dword v90, v10, s[36:37]
    global_load_dwordx4 v[16:19], v8, s[16:17] offset:0
    global_load_dwordx4 v[20:23], v8, s[16:17] offset:128
    global_load_dwordx4 v[24:27], v8, s[16:17] offset:256
    global_load_dwordx4 v[28:31], v8, s[16:17] offset:384
    global_load_dwordx4 v[32:35], v8, s[16:17] offset:512
    global_load_dwordx4 v[36:39], v8, s[16:17] offset:640
    global_load_dwordx4 v[40:43], v8, s[16:17] offset:768
    global_load_dwordx4 v[44:47], v8, s[16:17] offset:896
    global_load_dwordx4 v[48:51], v8, s[16:17] offset:1024
    s_load_dword s10, s[50:51], 8448
    s_setprio 3
    global_load_dwordx4 v[52:55], v9, s[36:37] offset:0
    global_load_dwordx4 v[56:59], v9, s[36:37] offset:128
    global_load_dwordx4 v[60:63], v9, s[36:37] offset:256
    global_load_dwordx4 v[64:67], v9, s[36:37] offset:384
    global_load_dwordx4 v[68:71], v9, s[36:37] offset:512
    global_load_dwordx4 v[72:75], v9, s[36:37] offset:640
    global_load_dwordx4 v[76:79], v9, s[36:37] offset:768
    global_load_dwordx4 v[80:83], v9, s[36:37] offset:896
    global_load_dwordx4 v[84:87], v9, s[36:37] offset:1024
    v_lshlrev_b32 v7, 4, v2
    v_min_u32 v10, 7, v2
    s_mov_b32 m0, 158224
    v_lshlrev_b32 v10, 4, v10
    global_load_lds_dwordx4 v7, s[44:45]
    global_load_lds_dwordx4 v10, s[44:45] offset:1024
    v_mov_b32 v11, 1
    ds_write_b32 v1, v11 offset:4
    v_and_b32 v3, 15, v2
    v_lshrrev_b32 v4, 4, v2
    s_and_b32 s4, s2, 7
    v_add_u32 v7, 147712, v7
    s_lshl_b32 s8, s2, 5
    v_lshl_add_u32 v15, v4, 3, s8
    s_mov_b32 s11, 0xffff
    v_mov_b32 v8, 0
    v_mov_b32 v9, 0
    v_mov_b32 v10, 0
    v_mov_b32 v11, 0
    s_waitcnt lgkmcnt(0)
    s_add_u32 s10, s10, 1
    s_addc_u32 s10, s10, 0
    v_mov_b32 v14, s10
    v_mov_b32 v13, s10
    s_waitcnt vmcnt(10)
    v_dot2c_f32_bf16 v8, v16, v52
    v_dot2c_f32_bf16 v9, v17, v53
    v_dot2c_f32_bf16 v10, v18, v54
    v_dot2c_f32_bf16 v11, v19, v55
    s_waitcnt vmcnt(9)
    v_dot2c_f32_bf16 v8, v20, v56
    v_dot2c_f32_bf16 v9, v21, v57
    v_dot2c_f32_bf16 v10, v22, v58
    v_dot2c_f32_bf16 v11, v23, v59
    s_waitcnt vmcnt(8)
    v_dot2c_f32_bf16 v8, v24, v60
    v_dot2c_f32_bf16 v9, v25, v61
    v_dot2c_f32_bf16 v10, v26, v62
    v_dot2c_f32_bf16 v11, v27, v63
    s_waitcnt vmcnt(7)
    v_dot2c_f32_bf16 v8, v28, v64
    v_dot2c_f32_bf16 v9, v29, v65
    v_dot2c_f32_bf16 v10, v30, v66
    v_dot2c_f32_bf16 v11, v31, v67
    s_waitcnt vmcnt(6)
    v_dot2c_f32_bf16 v8, v32, v68
    v_dot2c_f32_bf16 v9, v33, v69
    v_dot2c_f32_bf16 v10, v34, v70
    v_dot2c_f32_bf16 v11, v35, v71
    s_waitcnt vmcnt(5)
    v_dot2c_f32_bf16 v8, v36, v72
    v_dot2c_f32_bf16 v9, v37, v73
    v_dot2c_f32_bf16 v10, v38, v74
    v_dot2c_f32_bf16 v11, v39, v75
    s_waitcnt vmcnt(4)
    v_dot2c_f32_bf16 v8, v40, v76
    v_dot2c_f32_bf16 v9, v41, v77
    v_dot2c_f32_bf16 v10, v42, v78
    v_dot2c_f32_bf16 v11, v43, v79
    s_waitcnt vmcnt(3)
    v_dot2c_f32_bf16 v8, v44, v80
    v_dot2c_f32_bf16 v9, v45, v81
    v_dot2c_f32_bf16 v10, v46, v82
    v_dot2c_f32_bf16 v11, v47, v83
    s_waitcnt vmcnt(2)
    v_dot2c_f32_bf16 v8, v48, v84
    v_dot2c_f32_bf16 v9, v49, v85
    v_dot2c_f32_bf16 v10, v50, v86
    v_dot2c_f32_bf16 v11, v51, v87
    s_nop 0
    v_add_f32 v8, v8, v9
    s_nop 0
    v_add_f32 v10, v10, v11
    v_add_f32 v8, v8, v10
    s_nop 1
    v_add_f32_dpp v8, v8, v8 quad_perm:[1,0,3,2] row_mask:0xf bank_mask:0xf
    s_nop 1
    v_add_f32_dpp v8, v8, v8 quad_perm:[2,3,0,1] row_mask:0xf bank_mask:0xf
    s_nop 1
    v_add_f32_dpp v8, v8, v8 row_half_mirror row_mask:0xf bank_mask:0xf
    v_cvt_pk_bf16_f32 v8, v8, v8
    v_ashrrev_i32 v9, 31, v8
    v_or_b32 v9, 0x80008000, v9
    v_xor_b32 v8, v8, v9
    s_nop 1
    v_mov_b32_dpp v9, v8 row_ror:8 row_mask:0xf bank_mask:0xf
    s_mov_b32 exec_lo, 0x10001
    s_mov_b32 exec_hi, 0x10001
    v_bfi_b32 v12, s11, v8, v9
    global_store_dwordx2 v15, v[12:13], s[50:51] sc1
    s_mov_b64 exec, -1
    ds_write_b32 v1, v14 offset:0
    s_setprio 0
    ds_write_b128 v7, v[16:19] offset:0
    ds_write_b128 v7, v[20:23] offset:1024
    ds_write_b128 v7, v[24:27] offset:2048
    ds_write_b128 v7, v[28:31] offset:3072
    ds_write_b128 v7, v[32:35] offset:4096
    ds_write_b128 v7, v[36:39] offset:5120
    ds_write_b128 v7, v[40:43] offset:6144
    ds_write_b128 v7, v[44:47] offset:7168
    ds_write_b128 v7, v[48:51] offset:8192
    s_waitcnt vmcnt(1)
    ds_write_b32 v1, v14 offset:8
    s_cmp_ge_u32 s5, 14
    s_cbranch_scc1 C_IO
    s_cmp_lt_u32 s5, 9
    s_cbranch_scc1 SELECT
    s_endpgm
.p2align 7
K_OTHER:
    v_and_b32 v3, 15, v2
    v_lshrrev_b32 v4, 4, v2
    s_and_b32 s4, s2, 7
    s_mul_i32 s7, s4, 9
    s_add_u32 s7, s7, s5
    s_mov_b32 s12, s3
    s_cmp_lt_u32 s3, 2
    s_cbranch_scc1 GATE
    s_cmp_ge_u32 s5, 9
    s_cbranch_scc1 HELPER
    s_cmp_lt_u32 s3, 8
    s_cbranch_scc1 F_COMP
F_LOAD:
    s_setprio 3
    s_sub_u32 s12, s3, 9
    v_lshrrev_b32 v5, 3, v2
    v_bfe_u32 v6, v2, 4, 1
    v_xor_b32 v6, v6, v2
    v_and_b32 v6, 7, v6
    v_mul_u32_u24 v7, 9216, v5
    v_lshl_add_u32 v8, v6, 4, v7
    v_xor_b32 v9, 32, v8
    v_xor_b32 v10, 64, v8
    v_xor_b32 v11, 96, v8
    s_mul_i32 s13, s12, 294912
    s_lshl_b32 s8, s7, 7
    s_add_u32 s13, s13, s8
    s_lshl_b32 s15, s12, 13
    s_add_u32 s15, s15, 256
    s_mov_b32 s54, 5308416
    s_mov_b32 s55, 0x20000
    s_mov_b32 s58, 5308416
    s_mov_b32 s59, 0x20000
    s_waitcnt lgkmcnt(0)
    s_mov_b64 s[52:53], s[38:39]
    s_mov_b64 s[56:57], s[40:41]
    s_add_u32 m0, s15, 0
    s_nop 0
    buffer_load_dwordx4 v8, s[52:55], s13 offen  lds
    s_add_u32 m0, s15, 1024
    s_nop 0
    buffer_load_dwordx4 v10, s[56:59], s13 offen  lds
    s_add_u32 s13, s13, 73728
    s_mov_b32 s9, 0
SP_1:
    ds_read_b32 v14, v1 offset:4
    s_waitcnt lgkmcnt(0)
    v_readfirstlane_b32 s8, v14
    s_add_u32 s9, s9, 1
    s_cmp_ge_u32 s8, 1
    s_cbranch_scc1 SP_1_D
    s_cmp_lt_u32 s9, 524288
    s_cbranch_scc1 SP_1
SP_1_D:
    s_add_u32 m0, s15, 2048
    s_nop 0
    buffer_load_dwordx4 v9, s[52:55], s13 offen  lds
    s_add_u32 m0, s15, 3072
    s_nop 0
    buffer_load_dwordx4 v11, s[56:59], s13 offen  lds
    s_add_u32 s13, s13, 73728
    s_add_u32 m0, s15, 4096
    s_nop 0
    buffer_load_dwordx4 v8, s[52:55], s13 offen  lds
    s_add_u32 m0, s15, 5120
    s_nop 0
    buffer_load_dwordx4 v10, s[56:59], s13 offen  lds
    s_add_u32 s13, s13, 73728
    s_add_u32 m0, s15, 6144
    s_nop 0
    buffer_load_dwordx4 v9, s[52:55], s13 offen  lds
    s_add_u32 m0, s15, 7168
    s_nop 0
    buffer_load_dwordx4 v11, s[56:59], s13 offen  lds
    s_add_u32 s13, s13, 663552
    s_add_u32 m0, s15, 24576
    s_nop 0
    buffer_load_dwordx4 v8, s[52:55], s13 offen  lds
    s_add_u32 m0, s15, 25600
    s_nop 0
    buffer_load_dwordx4 v10, s[56:59], s13 offen  lds
    s_add_u32 s13, s13, 73728
    s_waitcnt vmcnt(9)
    s_add_u32 m0, s15, 26624
    s_nop 0
    buffer_load_dwordx4 v9, s[52:55], s13 offen  lds
    s_waitcnt vmcnt(9)
    s_add_u32 m0, s15, 27648
    s_nop 0
    buffer_load_dwordx4 v11, s[56:59], s13 offen  lds
    s_add_u32 s13, s13, 73728
    s_waitcnt vmcnt(9)
    s_add_u32 m0, s15, 28672
    s_nop 0
    buffer_load_dwordx4 v8, s[52:55], s13 offen  lds
    s_waitcnt vmcnt(9)
    s_add_u32 m0, s15, 29696
    s_nop 0
    buffer_load_dwordx4 v10, s[56:59], s13 offen  lds
    s_add_u32 s13, s13, 73728
    s_waitcnt vmcnt(9)
    s_add_u32 m0, s15, 30720
    s_nop 0
    buffer_load_dwordx4 v9, s[52:55], s13 offen  lds
    s_waitcnt vmcnt(9)
    s_add_u32 m0, s15, 31744
    s_nop 0
    buffer_load_dwordx4 v11, s[56:59], s13 offen  lds
    s_add_u32 s13, s13, 663552
    s_waitcnt vmcnt(9)
    s_add_u32 m0, s15, 49152
    s_nop 0
    buffer_load_dwordx4 v8, s[52:55], s13 offen  lds
    s_waitcnt vmcnt(9)
    v_mov_b32 v14, 1
    s_mov_b64 exec, 1
    ds_add_u32 v1, v14 offset:16
    s_mov_b64 exec, -1
    s_add_u32 m0, s15, 50176
    s_nop 0
    buffer_load_dwordx4 v10, s[56:59], s13 offen  lds
    s_add_u32 s13, s13, 73728
    s_waitcnt vmcnt(9)
    s_add_u32 m0, s15, 51200
    s_nop 0
    buffer_load_dwordx4 v9, s[52:55], s13 offen  lds
    s_waitcnt vmcnt(9)
    s_add_u32 m0, s15, 52224
    s_nop 0
    buffer_load_dwordx4 v11, s[56:59], s13 offen  lds
    s_add_u32 s13, s13, 73728
    s_waitcnt vmcnt(9)
    s_add_u32 m0, s15, 53248
    s_nop 0
    buffer_load_dwordx4 v8, s[52:55], s13 offen  lds
    s_waitcnt vmcnt(9)
    s_add_u32 m0, s15, 54272
    s_nop 0
    buffer_load_dwordx4 v10, s[56:59], s13 offen  lds
    s_add_u32 s13, s13, 73728
    s_waitcnt vmcnt(9)
    s_add_u32 m0, s15, 55296
    s_nop 0
    buffer_load_dwordx4 v9, s[52:55], s13 offen  lds
    s_waitcnt vmcnt(9)
    s_add_u32 m0, s15, 56320
    s_nop 0
    buffer_load_dwordx4 v11, s[56:59], s13 offen  lds
    s_add_u32 s13, s13, 663552
    s_mov_b32 s9, 0
SP_2:
    ds_read_b32 v14, v1 offset:48
    s_waitcnt lgkmcnt(0)
    v_readfirstlane_b32 s8, v14
    s_add_u32 s9, s9, 1
    s_cmp_ge_u32 s8, 4
    s_cbranch_scc1 SP_2_D
    s_cmp_lt_u32 s9, 524288
    s_cbranch_scc1 SP_2
SP_2_D:
    s_waitcnt vmcnt(9)
    s_add_u32 m0, s15, 0
    s_nop 0
    buffer_load_dwordx4 v8, s[52:55], s13 offen  lds
    s_waitcnt vmcnt(9)
    v_mov_b32 v14, 1
    s_mov_b64 exec, 1
    ds_add_u32 v1, v14 offset:20
    s_mov_b64 exec, -1
    s_add_u32 m0, s15, 1024
    s_nop 0
    buffer_load_dwordx4 v10, s[56:59], s13 offen  lds
    s_add_u32 s13, s13, 73728
    s_waitcnt vmcnt(9)
    s_add_u32 m0, s15, 2048
    s_nop 0
    buffer_load_dwordx4 v9, s[52:55], s13 offen  lds
    s_waitcnt vmcnt(9)
    s_add_u32 m0, s15, 3072
    s_nop 0
    buffer_load_dwordx4 v11, s[56:59], s13 offen  lds
    s_add_u32 s13, s13, 73728
    s_waitcnt vmcnt(9)
    s_add_u32 m0, s15, 4096
    s_nop 0
    buffer_load_dwordx4 v8, s[52:55], s13 offen  lds
    s_waitcnt vmcnt(9)
    s_add_u32 m0, s15, 5120
    s_nop 0
    buffer_load_dwordx4 v10, s[56:59], s13 offen  lds
    s_add_u32 s13, s13, 73728
    s_waitcnt vmcnt(9)
    s_add_u32 m0, s15, 6144
    s_nop 0
    buffer_load_dwordx4 v9, s[52:55], s13 offen  lds
    s_waitcnt vmcnt(9)
    s_add_u32 m0, s15, 7168
    s_nop 0
    buffer_load_dwordx4 v11, s[56:59], s13 offen  lds
    s_add_u32 s13, s13, 663552
    s_mov_b32 s9, 0
SP_3:
    ds_read_b32 v14, v1 offset:52
    s_waitcnt lgkmcnt(0)
    v_readfirstlane_b32 s8, v14
    s_add_u32 s9, s9, 1
    s_cmp_ge_u32 s8, 4
    s_cbranch_scc1 SP_3_D
    s_cmp_lt_u32 s9, 524288
    s_cbranch_scc1 SP_3
SP_3_D:
    s_waitcnt vmcnt(9)
    s_add_u32 m0, s15, 24576
    s_nop 0
    buffer_load_dwordx4 v8, s[52:55], s13 offen  lds
    s_waitcnt vmcnt(9)
    v_mov_b32 v14, 1
    s_mov_b64 exec, 1
    ds_add_u32 v1, v14 offset:24
    s_mov_b64 exec, -1
    s_add_u32 m0, s15, 25600
    s_nop 0
    buffer_load_dwordx4 v10, s[56:59], s13 offen  lds
    s_add_u32 s13, s13, 73728
    s_waitcnt vmcnt(9)
    s_add_u32 m0, s15, 26624
    s_nop 0
    buffer_load_dwordx4 v9, s[52:55], s13 offen  lds
    s_waitcnt vmcnt(9)
    s_add_u32 m0, s15, 27648
    s_nop 0
    buffer_load_dwordx4 v11, s[56:59], s13 offen  lds
    s_add_u32 s13, s13, 73728
    s_waitcnt vmcnt(9)
    s_add_u32 m0, s15, 28672
    s_nop 0
    buffer_load_dwordx4 v8, s[52:55], s13 offen  lds
    s_waitcnt vmcnt(9)
    s_add_u32 m0, s15, 29696
    s_nop 0
    buffer_load_dwordx4 v10, s[56:59], s13 offen  lds
    s_add_u32 s13, s13, 73728
    s_waitcnt vmcnt(9)
    s_add_u32 m0, s15, 30720
    s_nop 0
    buffer_load_dwordx4 v9, s[52:55], s13 offen  lds
    s_waitcnt vmcnt(9)
    s_add_u32 m0, s15, 31744
    s_nop 0
    buffer_load_dwordx4 v11, s[56:59], s13 offen  lds
    s_add_u32 s13, s13, 663552
    s_mov_b32 s9, 0
SP_4:
    ds_read_b32 v14, v1 offset:56
    s_waitcnt lgkmcnt(0)
    v_readfirstlane_b32 s8, v14
    s_add_u32 s9, s9, 1
    s_cmp_ge_u32 s8, 4
    s_cbranch_scc1 SP_4_D
    s_cmp_lt_u32 s9, 524288
    s_cbranch_scc1 SP_4
SP_4_D:
    s_waitcnt vmcnt(9)
    s_add_u32 m0, s15, 49152
    s_nop 0
    buffer_load_dwordx4 v8, s[52:55], s13 offen  lds
    s_waitcnt vmcnt(9)
    v_mov_b32 v14, 1
    s_mov_b64 exec, 1
    ds_add_u32 v1, v14 offset:28
    s_mov_b64 exec, -1
    s_add_u32 m0, s15, 50176
    s_nop 0
    buffer_load_dwordx4 v10, s[56:59], s13 offen  lds
    s_add_u32 s13, s13, 73728
    s_waitcnt vmcnt(9)
    s_add_u32 m0, s15, 51200
    s_nop 0
    buffer_load_dwordx4 v9, s[52:55], s13 offen  lds
    s_waitcnt vmcnt(9)
    s_add_u32 m0, s15, 52224
    s_nop 0
    buffer_load_dwordx4 v11, s[56:59], s13 offen  lds
    s_add_u32 s13, s13, 73728
    s_waitcnt vmcnt(9)
    s_add_u32 m0, s15, 53248
    s_nop 0
    buffer_load_dwordx4 v8, s[52:55], s13 offen  lds
    s_waitcnt vmcnt(9)
    s_add_u32 m0, s15, 54272
    s_nop 0
    buffer_load_dwordx4 v10, s[56:59], s13 offen  lds
    s_add_u32 s13, s13, 73728
    s_waitcnt vmcnt(9)
    s_add_u32 m0, s15, 55296
    s_nop 0
    buffer_load_dwordx4 v9, s[52:55], s13 offen  lds
    s_waitcnt vmcnt(9)
    s_add_u32 m0, s15, 56320
    s_nop 0
    buffer_load_dwordx4 v11, s[56:59], s13 offen  lds
    s_add_u32 s13, s13, 663552
    v_mov_b32 v14, 1
    s_mov_b64 exec, 1
    ds_add_u32 v1, v14 offset:40
    s_mov_b64 exec, -1
    s_waitcnt vmcnt(8)
    v_mov_b32 v14, 1
    s_mov_b64 exec, 1
    ds_add_u32 v1, v14 offset:32
    s_mov_b64 exec, -1
    s_waitcnt vmcnt(0)
    v_mov_b32 v14, 1
    s_mov_b64 exec, 1
    ds_add_u32 v1, v14 offset:36
    s_mov_b64 exec, -1
    s_cmp_eq_u32 s3, 9
    s_cbranch_scc1 F_COMP2
    s_endpgm
.p2align 7
K_CIO:
    v_and_b32 v3, 15, v2
    v_lshrrev_b32 v4, 4, v2
    s_and_b32 s4, s2, 7
    s_mul_i32 s7, s4, 18
    s_add_u32 s7, s7, s5
    s_sub_u32 s7, s7, 14
    s_sub_u32 s12, s3, 9
    s_cmp_lg_u32 s3, 11
    s_cbranch_scc1 C_CONST
C_LOAD:
    s_setprio 3
    s_sub_u32 s13, s5, 14
    s_mov_b32 s8, s13
    s_mul_i32 s8, s8, 73728
    s_lshl_b32 s9, s4, 7
    s_add_u32 s8, s8, s9
    v_mul_u32_u24 v9, 1152, v2
    v_add_u32 v9, s8, v9
    s_add_u32 s8, s13, 18
    s_min_u32 s8, s8, 31
    s_sub_u32 s8, s8, s13
    s_mul_i32 s8, s8, 73728
    v_add_u32 v8, s8, v9
    v_mul_u32_u24 v6, 4608, v2
    s_lshl_b32 s8, s7, 3
    v_add_u32 v6, s8, v6
    v_lshlrev_b32 v7, 3, v2
    v_sub_u32 v7, 57080, v7
    s_mov_b32 s56, 0x05040100
    s_mov_b32 s58, 0x07060302
    s_mov_b32 s57, s13
    s_waitcnt lgkmcnt(0)
    s_mov_b32 s72, s16
    s_mov_b32 s73, s17
    s_mov_b32 s74, 2359296
    s_mov_b32 s75, 0x20000
    s_mov_b32 s9, 0
SP_5:
    ds_read_b32 v12, v1 offset:4
    s_waitcnt lgkmcnt(0)
    v_readfirstlane_b32 s8, v12
    s_add_u32 s9, s9, 1
    s_cmp_ge_u32 s8, 1
    s_cbranch_scc1 SP_5_D
    s_cmp_lt_u32 s9, 524288
    s_cbranch_scc1 SP_5
SP_5_D:
    global_load_dword v10, v9, s[16:17]
    global_load_dword v11, v9, s[16:17] offset:128
    global_load_dword v10, v8, s[16:17]
    global_load_dword v11, v8, s[16:17] offset:128
    s_mul_i32 s7, s4, 18
    s_add_u32 s7, s7, s5
    s_sub_u32 s7, s7, 14
    s_lshl_b32 s55, s7, 3
    s_sub_u32 s12, s3, 8
    s_mov_b32 s60, s46
    s_mov_b32 s61, s47
    s_mov_b32 s62, 2359296
    s_mov_b32 s63, 0x20000
    v_bfe_u32 v79, v2, 2, 2
    v_and_b32 v80, 3, v2
    v_lshl_add_u32 v80, v4, 2, v80
    s_lshl_b32 s8, s12, 7
    v_mul_u32_u24 v72, 4672, v79
    v_lshl_add_u32 v72, v80, 3, v72
    s_sub_u32 s9, 56960, s8
    v_add_u32 v72, s9, v72
    v_mul_u32_u24 v73, 4160, v79
    v_lshl_add_u32 v73, v80, 3, v73
    s_sub_u32 s9, 83840, s8
    v_add_u32 v73, s9, v73
    v_xor_b32 v79, 63, v2
    s_lshl_b32 s8, s12, 9
    s_add_u32 s8, s8, 16384
    v_lshl_add_u32 v74, v79, 3, s8
    v_add_u32 v75, 4096, v74
    v_add_u32 v76, 8192, v74
    v_add_u32 v77, 12288, v74
    v_mul_u32_u24 v78, 1152, v79
    v_add_u32 v78, s55, v78
    s_mul_i32 s68, s12, 73728
    s_mov_b32 s70, 0x05040100
    s_mov_b32 s71, 0x07060302
    s_sub_u32 s9, s5, 14
    s_mul_i32 s9, s9, 3
    s_min_u32 s8, s12, 2
    s_add_u32 s9, s9, s8
    s_mul_i32 s9, s9, 12288
    s_mul_i32 s8, s4, 663552
    s_add_u32 s8, s8, s9
    v_lshl_add_u32 v88, v2, 7, s8
    v_min_u32 v89, 31, v2
    v_lshl_add_u32 v89, v89, 7, s8
    v_add_u32 v89, 8192, v89
    v_mov_b32 v24, 0
    v_mov_b32 v25, 0
    v_mov_b32 v26, 0
    v_mov_b32 v27, 0
    v_lshrrev_b32 v28, 2, v2
    v_mul_u32_u24 v28, 1216, v28
    v_add_u32 v28, 37120, v28
    v_and_b32 v29, 3, v2
    v_lshl_add_u32 v30, v29, 4, v28
    ds_write_b128 v30, v[24:27] offset:1072
    v_and_b32 v29, 1, v2
    v_lshl_add_u32 v30, v29, 4, v28
    ds_write_b128 v30, v[24:27]
    v_lshrrev_b32 v28, 5, v2
    v_mul_u32_u24 v28, 4672, v28
    v_and_b32 v29, 31, v2
    v_lshl_add_u32 v30, v29, 4, v28
    v_add_u32 v30, 60672, v30
    ds_write_b128 v30, v[24:27]
    ds_write_b128 v30, v[24:27] offset:9344
    s_mov_b32 s15, 0
    v_mov_b32 v12, 1
    s_waitcnt vmcnt(2)
    buffer_load_dwordx2 v[104:105], v6, s[72:75], s15 offen offset:0
    buffer_load_dwordx2 v[106:107], v6, s[72:75], s15 offen offset:1152
    buffer_load_dwordx2 v[108:109], v6, s[72:75], s15 offen offset:2304
    buffer_load_dwordx2 v[110:111], v6, s[72:75], s15 offen offset:3456
    s_add_u32 s15, s15, 294912
    buffer_load_dwordx2 v[112:113], v6, s[72:75], s15 offen offset:0
    buffer_load_dwordx2 v[114:115], v6, s[72:75], s15 offen offset:1152
    s_waitcnt vmcnt(5)
    buffer_load_dwordx2 v[116:117], v6, s[72:75], s15 offen offset:2304
    s_waitcnt vmcnt(5)
    buffer_load_dwordx2 v[118:119], v6, s[72:75], s15 offen offset:3456
    s_add_u32 s15, s15, 294912
    s_waitcnt vmcnt(5)
    buffer_load_dwordx2 v[120:121], v6, s[72:75], s15 offen offset:0
    s_waitcnt vmcnt(5)
    buffer_load_dwordx2 v[122:123], v6, s[72:75], s15 offen offset:1152
    v_perm_b32 v16, v108, v110, s56
    v_perm_b32 v17, v104, v106, s56
    ds_write_b64 v7, v[16:17] offset:3584
    v_perm_b32 v18, v108, v110, s58
    v_perm_b32 v19, v104, v106, s58
    ds_write_b64 v7, v[18:19] offset:8256
    v_perm_b32 v20, v109, v111, s56
    v_perm_b32 v21, v105, v107, s56
    ds_write_b64 v7, v[20:21] offset:12928
    v_perm_b32 v22, v109, v111, s58
    v_perm_b32 v23, v105, v107, s58
    ds_write_b64 v7, v[22:23] offset:17600
    v_mov_b32 v36, 1
    ds_write_b32 v1, v36 offset:80
    s_waitcnt vmcnt(5)
    buffer_load_dwordx2 v[124:125], v6, s[72:75], s15 offen offset:2304
    s_waitcnt vmcnt(5)
    buffer_load_dwordx2 v[126:127], v6, s[72:75], s15 offen offset:3456
    s_add_u32 s15, s15, 294912
    s_waitcnt vmcnt(5)
    buffer_load_dwordx2 v[128:129], v6, s[72:75], s15 offen offset:0
    s_waitcnt vmcnt(5)
    buffer_load_dwordx2 v[130:131], v6, s[72:75], s15 offen offset:1152
    v_perm_b32 v24, v116, v118, s56
    v_perm_b32 v25, v112, v114, s56
    ds_write_b64 v7, v[24:25] offset:3072
    v_perm_b32 v26, v116, v118, s58
    v_perm_b32 v27, v112, v114, s58
    ds_write_b64 v7, v[26:27] offset:7744
    v_perm_b32 v28, v117, v119, s56
    v_perm_b32 v29, v113, v115, s56
    ds_write_b64 v7, v[28:29] offset:12416
    v_perm_b32 v30, v117, v119, s58
    v_perm_b32 v31, v113, v115, s58
    ds_write_b64 v7, v[30:31] offset:17088
    v_mov_b32 v36, 2
    ds_write_b32 v1, v36 offset:80
    s_waitcnt vmcnt(5)
    buffer_load_dwordx2 v[132:133], v6, s[72:75], s15 offen offset:2304
    s_waitcnt vmcnt(5)
    buffer_load_dwordx2 v[134:135], v6, s[72:75], s15 offen offset:3456
    s_add_u32 s15, s15, 294912
    s_waitcnt vmcnt(5)
    buffer_load_dwordx2 v[136:137], v6, s[72:75], s15 offen offset:0
    s_waitcnt vmcnt(5)
    buffer_load_dwordx2 v[138:139], v6, s[72:75], s15 offen offset:1152
    v_perm_b32 v16, v124, v126, s56
    v_perm_b32 v17, v120, v122, s56
    ds_write_b64 v7, v[16:17] offset:2560
    v_perm_b32 v18, v124, v126, s58
    v_perm_b32 v19, v120, v122, s58
    ds_write_b64 v7, v[18:19] offset:7232
    v_perm_b32 v20, v125, v127, s56
    v_perm_b32 v21, v121, v123, s56
    ds_write_b64 v7, v[20:21] offset:11904
    v_perm_b32 v22, v125, v127, s58
    v_perm_b32 v23, v121, v123, s58
    ds_write_b64 v7, v[22:23] offset:16576
    v_mov_b32 v36, 3
    ds_write_b32 v1, v36 offset:80
    s_waitcnt vmcnt(5)
    buffer_load_dwordx2 v[140:141], v6, s[72:75], s15 offen offset:2304
    s_waitcnt vmcnt(5)
    buffer_load_dwordx2 v[142:143], v6, s[72:75], s15 offen offset:3456
    s_add_u32 s15, s15, 294912
    s_waitcnt vmcnt(5)
    buffer_load_dwordx2 v[144:145], v6, s[72:75], s15 offen offset:0
    s_waitcnt vmcnt(5)
    buffer_load_dwordx2 v[146:147], v6, s[72:75], s15 offen offset:1152
    v_perm_b32 v24, v132, v134, s56
    v_perm_b32 v25, v128, v130, s56
    ds_write_b64 v7, v[24:25] offset:2048
    v_perm_b32 v26, v132, v134, s58
    v_perm_b32 v27, v128, v130, s58
    ds_write_b64 v7, v[26:27] offset:6720
    v_perm_b32 v28, v133, v135, s56
    v_perm_b32 v29, v129, v131, s56
    ds_write_b64 v7, v[28:29] offset:11392
    v_perm_b32 v30, v133, v135, s58
    v_perm_b32 v31, v129, v131, s58
    ds_write_b64 v7, v[30:31] offset:16064
    v_mov_b32 v36, 4
    ds_write_b32 v1, v36 offset:80
    s_waitcnt vmcnt(5)
    buffer_load_dwordx2 v[148:149], v6, s[72:75], s15 offen offset:2304
    s_waitcnt vmcnt(5)
    buffer_load_dwordx2 v[150:151], v6, s[72:75], s15 offen offset:3456
    s_add_u32 s15, s15, 294912
    s_waitcnt vmcnt(5)
    buffer_load_dwordx2 v[152:153], v6, s[72:75], s15 offen offset:0
    s_waitcnt vmcnt(5)
    buffer_load_dwordx2 v[154:155], v6, s[72:75], s15 offen offset:1152
    v_perm_b32 v16, v140, v142, s56
    v_perm_b32 v17, v136, v138, s56
    ds_write_b64 v7, v[16:17] offset:1536
    v_perm_b32 v18, v140, v142, s58
    v_perm_b32 v19, v136, v138, s58
    ds_write_b64 v7, v[18:19] offset:6208
    v_perm_b32 v20, v141, v143, s56
    v_perm_b32 v21, v137, v139, s56
    ds_write_b64 v7, v[20:21] offset:10880
    v_perm_b32 v22, v141, v143, s58
    v_perm_b32 v23, v137, v139, s58
    ds_write_b64 v7, v[22:23] offset:15552
    v_mov_b32 v36, 5
    ds_write_b32 v1, v36 offset:80
    s_waitcnt vmcnt(5)
    buffer_load_dwordx2 v[156:157], v6, s[72:75], s15 offen offset:2304
    s_waitcnt vmcnt(5)
    buffer_load_dwordx2 v[158:159], v6, s[72:75], s15 offen offset:3456
    s_add_u32 s15, s15, 294912
    s_waitcnt vmcnt(5)
    buffer_load_dwordx2 v[160:161], v6, s[72:75], s15 offen offset:0
    s_waitcnt vmcnt(5)
    buffer_load_dwordx2 v[162:163], v6, s[72:75], s15 offen offset:1152
    v_perm_b32 v24, v148, v150, s56
    v_perm_b32 v25, v144, v146, s56
    ds_write_b64 v7, v[24:25] offset:1024
    v_perm_b32 v26, v148, v150, s58
    v_perm_b32 v27, v144, v146, s58
    ds_write_b64 v7, v[26:27] offset:5696
    v_perm_b32 v28, v149, v151, s56
    v_perm_b32 v29, v145, v147, s56
    ds_write_b64 v7, v[28:29] offset:10368
    v_perm_b32 v30, v149, v151, s58
    v_perm_b32 v31, v145, v147, s58
    ds_write_b64 v7, v[30:31] offset:15040
    v_mov_b32 v36, 6
    ds_write_b32 v1, v36 offset:80
    s_waitcnt vmcnt(5)
    buffer_load_dwordx2 v[164:165], v6, s[72:75], s15 offen offset:2304
    s_waitcnt vmcnt(5)
    buffer_load_dwordx2 v[166:167], v6, s[72:75], s15 offen offset:3456
    s_add_u32 s15, s15, 294912
    ds_write_b32 v1, v12 offset:88
    global_load_dwordx2 v[56:57], v74, s[50:51] offset:0 sc1
    global_load_dwordx2 v[58:59], v74, s[50:51] offset:2048 sc1
    global_load_dwordx2 v[60:61], v75, s[50:51] offset:0 sc1
    global_load_dwordx2 v[62:63], v75, s[50:51] offset:2048 sc1
    global_load_dwordx2 v[64:65], v76, s[50:51] offset:0 sc1
    global_load_dwordx2 v[66:67], v76, s[50:51] offset:2048 sc1
    global_load_dwordx2 v[68:69], v77, s[50:51] offset:0 sc1
    global_load_dwordx2 v[70:71], v77, s[50:51] offset:2048 sc1
    s_waitcnt vmcnt(13)
    s_waitcnt vmcnt(12)
    v_perm_b32 v16, v156, v158, s56
    v_perm_b32 v17, v152, v154, s56
    ds_write_b64 v7, v[16:17] offset:512
    v_perm_b32 v18, v156, v158, s58
    v_perm_b32 v19, v152, v154, s58
    ds_write_b64 v7, v[18:19] offset:5184
    v_perm_b32 v20, v157, v159, s56
    v_perm_b32 v21, v153, v155, s56
    ds_write_b64 v7, v[20:21] offset:9856
    v_perm_b32 v22, v157, v159, s58
    v_perm_b32 v23, v153, v155, s58
    ds_write_b64 v7, v[22:23] offset:14528
    v_mov_b32 v36, 7
    ds_write_b32 v1, v36 offset:80
    s_waitcnt vmcnt(11)
    s_waitcnt vmcnt(10)
    s_waitcnt vmcnt(9)
    s_waitcnt vmcnt(8)
    v_perm_b32 v24, v164, v166, s56
    v_perm_b32 v25, v160, v162, s56
    ds_write_b64 v7, v[24:25] offset:0
    v_perm_b32 v26, v164, v166, s58
    v_perm_b32 v27, v160, v162, s58
    ds_write_b64 v7, v[26:27] offset:4672
    v_perm_b32 v28, v165, v167, s56
    v_perm_b32 v29, v161, v163, s56
    ds_write_b64 v7, v[28:29] offset:9344
    v_perm_b32 v30, v165, v167, s58
    v_perm_b32 v31, v161, v163, s58
    ds_write_b64 v7, v[30:31] offset:14016
    v_mov_b32 v36, 8
    ds_write_b32 v1, v36 offset:80
    ds_read_b64_tr_b16 v[40:41], v72 offset:3584
    ds_read_b64_tr_b16 v[42:43], v72 offset:3072
    ds_read_b64_tr_b16 v[44:45], v72 offset:2560
    ds_read_b64_tr_b16 v[46:47], v72 offset:2048
    s_mov_b32 s9, 0
SP_6:
    ds_read_b32 v10, v1 offset:8
    s_waitcnt lgkmcnt(0)
    v_readfirstlane_b32 s8, v10
    s_add_u32 s9, s9, 1
    s_cmp_lg_u32 s8, 0
    s_cbranch_scc1 SP_6_D
    s_cmp_lt_u32 s9, 524288
    s_cbranch_scc1 SP_6
SP_6_D:
    v_lshlrev_b32 v120, 16, v40
    v_and_b32 v121, 0xffff0000, v40
    v_lshlrev_b32 v122, 16, v41
    v_and_b32 v123, 0xffff0000, v41
    v_lshlrev_b32 v124, 16, v42
    v_and_b32 v125, 0xffff0000, v42
    v_lshlrev_b32 v126, 16, v43
    v_and_b32 v127, 0xffff0000, v43
    v_lshlrev_b32 v128, 16, v44
    v_and_b32 v129, 0xffff0000, v44
    v_lshlrev_b32 v130, 16, v45
    v_and_b32 v131, 0xffff0000, v45
    v_lshlrev_b32 v132, 16, v46
    v_and_b32 v133, 0xffff0000, v46
    v_lshlrev_b32 v134, 16, v47
    v_and_b32 v135, 0xffff0000, v47
    s_waitcnt vmcnt(0)
    s_branch C_IO3
C_IO:
    s_mul_i32 s7, s4, 18
    s_add_u32 s7, s7, s5
    s_sub_u32 s7, s7, 14
    s_lshl_b32 s55, s7, 3
    s_sub_u32 s12, s3, 8
    s_mov_b32 s60, s46
    s_mov_b32 s61, s47
    s_mov_b32 s62, 2359296
    s_mov_b32 s63, 0x20000
    v_bfe_u32 v79, v2, 2, 2
    v_and_b32 v80, 3, v2
    v_lshl_add_u32 v80, v4, 2, v80
    s_lshl_b32 s8, s12, 7
    v_mul_u32_u24 v72, 4672, v79
    v_lshl_add_u32 v72, v80, 3, v72
    s_sub_u32 s9, 56960, s8
    v_add_u32 v72, s9, v72
    v_mul_u32_u24 v73, 4160, v79
    v_lshl_add_u32 v73, v80, 3, v73
    s_sub_u32 s9, 83840, s8
    v_add_u32 v73, s9, v73
    v_xor_b32 v79, 63, v2
    s_lshl_b32 s8, s12, 9
    s_add_u32 s8, s8, 16384
    v_lshl_add_u32 v74, v79, 3, s8
    v_add_u32 v75, 4096, v74
    v_add_u32 v76, 8192, v74
    v_add_u32 v77, 12288, v74
    v_mul_u32_u24 v78, 1152, v79
    v_add_u32 v78, s55, v78
    s_mul_i32 s68, s12, 73728
    s_mov_b32 s70, 0x05040100
    s_mov_b32 s71, 0x07060302
    s_sub_u32 s9, s5, 14
    s_mul_i32 s9, s9, 3
    s_min_u32 s8, s12, 2
    s_add_u32 s9, s9, s8
    s_mul_i32 s9, s9, 12288
    s_mul_i32 s8, s4, 663552
    s_add_u32 s8, s8, s9
    v_lshl_add_u32 v88, v2, 7, s8
    v_min_u32 v89, 31, v2
    v_lshl_add_u32 v89, v89, 7, s8
    v_add_u32 v89, 8192, v89
    s_mov_b32 s9, 0
SP_7:
    ds_read_b32 v10, v1 offset:8
    s_waitcnt lgkmcnt(0)
    v_readfirstlane_b32 s8, v10
    s_add_u32 s9, s9, 1
    s_cmp_lg_u32 s8, 0
    s_cbranch_scc1 SP_7_D
    s_cmp_lt_u32 s9, 524288
    s_cbranch_scc1 SP_7
SP_7_D:
    s_setprio 3
    s_mov_b32 s9, 0
SP_8:
    ds_read_b32 v12, v1 offset:80
    s_waitcnt lgkmcnt(0)
    v_readfirstlane_b32 s8, v12
    s_add_u32 s9, s9, 1
    s_cmp_ge_u32 s8, 4
    s_cbranch_scc1 SP_8_D
    s_sleep 2
    s_cmp_lt_u32 s9, 524288
    s_cbranch_scc1 SP_8
SP_8_D:
    s_setprio 3
    ds_read_b64_tr_b16 v[40:41], v72 offset:3584
    ds_read_b64_tr_b16 v[42:43], v72 offset:3072
    ds_read_b64_tr_b16 v[44:45], v72 offset:2560
    ds_read_b64_tr_b16 v[46:47], v72 offset:2048
    s_waitcnt lgkmcnt(0)
    v_lshlrev_b32 v120, 16, v40
    v_and_b32 v121, 0xffff0000, v40
    v_lshlrev_b32 v122, 16, v41
    v_and_b32 v123, 0xffff0000, v41
    v_lshlrev_b32 v124, 16, v42
    v_and_b32 v125, 0xffff0000, v42
    v_lshlrev_b32 v126, 16, v43
    v_and_b32 v127, 0xffff0000, v43
    v_lshlrev_b32 v128, 16, v44
    v_and_b32 v129, 0xffff0000, v44
    v_lshlrev_b32 v130, 16, v45
    v_and_b32 v131, 0xffff0000, v45
    v_lshlrev_b32 v132, 16, v46
    v_and_b32 v133, 0xffff0000, v46
    v_lshlrev_b32 v134, 16, v47
    v_and_b32 v135, 0xffff0000, v47
    s_setprio 3
    s_mov_b32 s9, 0
SP_9:
    ds_read_b32 v12, v1 offset:88
    s_waitcnt lgkmcnt(0)
    v_readfirstlane_b32 s8, v12
    s_add_u32 s9, s9, 1
    s_cmp_ge_u32 s8, 1
    s_cbranch_scc1 SP_9_D
    s_sleep 1
    s_cmp_lt_u32 s9, 524288
    s_cbranch_scc1 SP_9
SP_9_D:
    s_setprio 3
    global_load_dwordx2 v[56:57], v74, s[50:51] offset:0 sc1
    global_load_dwordx2 v[58:59], v74, s[50:51] offset:2048 sc1
    global_load_dwordx2 v[60:61], v75, s[50:51] offset:0 sc1
    global_load_dwordx2 v[62:63], v75, s[50:51] offset:2048 sc1
    global_load_dwordx2 v[64:65], v76, s[50:51] offset:0 sc1
    global_load_dwordx2 v[66:67], v76, s[50:51] offset:2048 sc1
    global_load_dwordx2 v[68:69], v77, s[50:51] offset:0 sc1
    global_load_dwordx2 v[70:71], v77, s[50:51] offset:2048 sc1
    v_mov_b32 v12, 1
    s_mov_b64 exec, 1
    ds_add_u32 v1, v12 offset:36
    s_mov_b64 exec, -1
    s_mov_b32 s9, 0
SP_10:
    ds_read_b32 v12, v1 offset:36
    s_waitcnt lgkmcnt(0)
    v_readfirstlane_b32 s8, v12
    s_add_u32 s9, s9, 1
    s_cmp_ge_u32 s8, 3
    s_cbranch_scc1 SP_10_D
    s_cmp_lt_u32 s9, 524288
    s_cbranch_scc1 SP_10
SP_10_D:
    global_load_dword v96, v88, s[42:43]
    global_load_dword v97, v89, s[42:43]
    s_waitcnt vmcnt(2)
C_IO3:
    s_waitcnt vmcnt(2)
    s_mov_b32 s9, 0
GP_11:
    v_xor_b32 v14, v57, v10
    v_bitop3_b32 v14, v14, v59, v10 bitop3:0xf6
    v_bitop3_b32 v14, v14, v61, v10 bitop3:0xf6
    v_bitop3_b32 v14, v14, v63, v10 bitop3:0xf6
    v_bitop3_b32 v14, v14, v65, v10 bitop3:0xf6
    v_bitop3_b32 v14, v14, v67, v10 bitop3:0xf6
    v_bitop3_b32 v14, v14, v69, v10 bitop3:0xf6
    v_bitop3_b32 v14, v14, v71, v10 bitop3:0xf6
    v_cmp_ne_u32 vcc, 0, v14
    s_add_u32 s9, s9, 1
    s_cmp_eq_u64 vcc, 0
    s_cbranch_scc1 GP_11_D
    s_cmp_ge_u32 s9, 131072
    s_cbranch_scc1 GP_11_D
    global_load_dwordx2 v[56:57], v74, s[50:51] offset:0 sc1
    global_load_dwordx2 v[58:59], v74, s[50:51] offset:2048 sc1
    global_load_dwordx2 v[60:61], v75, s[50:51] offset:0 sc1
    global_load_dwordx2 v[62:63], v75, s[50:51] offset:2048 sc1
    global_load_dwordx2 v[64:65], v76, s[50:51] offset:0 sc1
    global_load_dwordx2 v[66:67], v76, s[50:51] offset:2048 sc1
    global_load_dwordx2 v[68:69], v77, s[50:51] offset:0 sc1
    global_load_dwordx2 v[70:71], v77, s[50:51] offset:2048 sc1
    s_waitcnt vmcnt(0)
    s_branch GP_11
GP_11_D:
    v_and_b32 v16, 0xffff0000, v56
    v_lshlrev_b32 v57, 16, v56
    v_mul_f32 v120, v120, v16
    v_mul_f32 v121, v121, v16
    v_mul_f32 v122, v122, v16
    v_mul_f32 v123, v123, v16
    v_and_b32 v17, 0xffff0000, v58
    v_lshlrev_b32 v59, 16, v58
    v_mul_f32 v124, v124, v17
    v_mul_f32 v125, v125, v17
    v_mul_f32 v126, v126, v17
    v_mul_f32 v127, v127, v17
    v_and_b32 v18, 0xffff0000, v60
    v_lshlrev_b32 v61, 16, v60
    v_mul_f32 v128, v128, v18
    v_mul_f32 v129, v129, v18
    v_mul_f32 v130, v130, v18
    v_mul_f32 v131, v131, v18
    v_and_b32 v19, 0xffff0000, v62
    v_lshlrev_b32 v63, 16, v62
    v_mul_f32 v132, v132, v19
    v_mul_f32 v133, v133, v19
    v_mul_f32 v134, v134, v19
    v_mul_f32 v135, v135, v19
    s_setprio 3
    s_mov_b32 s9, 0
SP_12:
    ds_read_b32 v15, v1 offset:96
    s_waitcnt lgkmcnt(0)
    v_readfirstlane_b32 s8, v15
    s_add_u32 s9, s9, 1
    s_cmp_ge_u32 s8, 4
    s_cbranch_scc1 SP_12_D
    s_sleep 1
    s_cmp_lt_u32 s9, 524288
    s_cbranch_scc1 SP_12
SP_12_D:
    s_setprio 3
    ds_read_b64_tr_b16 v[16:17], v73 offset:3584
    ds_read_b64_tr_b16 v[18:19], v73 offset:3072
    s_waitcnt lgkmcnt(1)
    v_lshlrev_b32 v24, 16, v16
    v_and_b32 v25, 0xffff0000, v16
    v_lshlrev_b32 v26, 16, v17
    v_and_b32 v27, 0xffff0000, v17
    v_fma_f32 v24, v24, v57, v120
    v_fma_f32 v25, v25, v57, v121
    v_fma_f32 v26, v26, v57, v122
    v_fma_f32 v27, v27, v57, v123
    s_waitcnt lgkmcnt(0)
    v_lshlrev_b32 v28, 16, v18
    v_and_b32 v29, 0xffff0000, v18
    v_lshlrev_b32 v30, 16, v19
    v_and_b32 v31, 0xffff0000, v19
    v_fma_f32 v28, v28, v59, v124
    v_fma_f32 v29, v29, v59, v125
    v_fma_f32 v30, v30, v59, v126
    v_fma_f32 v31, v31, v59, v127
    v_cvt_pk_bf16_f32 v40, v24, v25
    v_cvt_pk_bf16_f32 v41, v26, v27
    buffer_store_dwordx2 v[40:41], v78, s[60:63], s68 offen
    s_add_u32 s68, s68, 294912
    v_cvt_pk_bf16_f32 v42, v28, v29
    v_cvt_pk_bf16_f32 v43, v30, v31
    buffer_store_dwordx2 v[42:43], v78, s[60:63], s68 offen
    s_add_u32 s68, s68, 294912
    s_setprio 3
    s_mov_b32 s9, 0
SP_13:
    ds_read_b32 v15, v1 offset:100
    s_waitcnt lgkmcnt(0)
    v_readfirstlane_b32 s8, v15
    s_add_u32 s9, s9, 1
    s_cmp_ge_u32 s8, 4
    s_cbranch_scc1 SP_13_D
    s_sleep 1
    s_cmp_lt_u32 s9, 524288
    s_cbranch_scc1 SP_13
SP_13_D:
    s_setprio 3
    ds_read_b64_tr_b16 v[16:17], v73 offset:2560
    ds_read_b64_tr_b16 v[18:19], v73 offset:2048
    s_waitcnt lgkmcnt(1)
    v_lshlrev_b32 v24, 16, v16
    v_and_b32 v25, 0xffff0000, v16
    v_lshlrev_b32 v26, 16, v17
    v_and_b32 v27, 0xffff0000, v17
    v_fma_f32 v24, v24, v61, v128
    v_fma_f32 v25, v25, v61, v129
    v_fma_f32 v26, v26, v61, v130
    v_fma_f32 v27, v27, v61, v131
    s_waitcnt lgkmcnt(0)
    v_lshlrev_b32 v28, 16, v18
    v_and_b32 v29, 0xffff0000, v18
    v_lshlrev_b32 v30, 16, v19
    v_and_b32 v31, 0xffff0000, v19
    v_fma_f32 v28, v28, v63, v132
    v_fma_f32 v29, v29, v63, v133
    v_fma_f32 v30, v30, v63, v134
    v_fma_f32 v31, v31, v63, v135
    v_cvt_pk_bf16_f32 v44, v24, v25
    v_cvt_pk_bf16_f32 v45, v26, v27
    buffer_store_dwordx2 v[44:45], v78, s[60:63], s68 offen
    s_add_u32 s68, s68, 294912
    v_cvt_pk_bf16_f32 v46, v28, v29
    v_cvt_pk_bf16_f32 v47, v30, v31
    buffer_store_dwordx2 v[46:47], v78, s[60:63], s68 offen
    s_add_u32 s68, s68, 294912
    s_mov_b32 s9, 0
SP_14:
    ds_read_b32 v12, v1 offset:80
    s_waitcnt lgkmcnt(0)
    v_readfirstlane_b32 s8, v12
    s_add_u32 s9, s9, 1
    s_cmp_ge_u32 s8, 8
    s_cbranch_scc1 SP_14_D
    s_cmp_lt_u32 s9, 524288
    s_cbranch_scc1 SP_14
SP_14_D:
    ds_read_b64_tr_b16 v[48:49], v72 offset:1536
    ds_read_b64_tr_b16 v[50:51], v72 offset:1024
    ds_read_b64_tr_b16 v[52:53], v72 offset:512
    ds_read_b64_tr_b16 v[54:55], v72 offset:0
    s_lshl_b32 s8, s12, 8
    s_sub_u32 s8, 76032, s8
    v_lshl_add_u32 v14, v2, 2, s8
    ds_write_b32 v14, v56 offset:7168
    ds_write_b32 v14, v58 offset:6144
    ds_write_b32 v14, v60 offset:5120
    ds_write_b32 v14, v62 offset:4096
    ds_write_b32 v14, v64 offset:3072
    ds_write_b32 v14, v66 offset:2048
    ds_write_b32 v14, v68 offset:1024
    ds_write_b32 v14, v70 offset:0
    s_setprio 3
    s_mov_b32 s9, 0
SP_15:
    ds_read_b32 v15, v1 offset:104
    s_waitcnt lgkmcnt(0)
    v_readfirstlane_b32 s8, v15
    s_add_u32 s9, s9, 1
    s_cmp_ge_u32 s8, 4
    s_cbranch_scc1 SP_15_D
    s_sleep 1
    s_cmp_lt_u32 s9, 524288
    s_cbranch_scc1 SP_15
SP_15_D:
    s_setprio 3
    ds_read_b64_tr_b16 v[16:17], v73 offset:1536
    ds_read_b64_tr_b16 v[18:19], v73 offset:1024
    s_waitcnt lgkmcnt(1)
    v_perm_b32 v24, v48, v16, s70
    v_perm_b32 v25, v48, v16, s71
    v_perm_b32 v26, v49, v17, s70
    v_perm_b32 v27, v49, v17, s71
    s_waitcnt lgkmcnt(0)
    v_perm_b32 v28, v50, v18, s70
    v_perm_b32 v29, v50, v18, s71
    v_perm_b32 v30, v51, v19, s70
    v_perm_b32 v31, v51, v19, s71
    v_dot2_f32_bf16 v24, v24, v64, 0
    v_dot2_f32_bf16 v25, v25, v64, 0
    v_dot2_f32_bf16 v26, v26, v64, 0
    v_dot2_f32_bf16 v27, v27, v64, 0
    v_dot2_f32_bf16 v28, v28, v66, 0
    v_dot2_f32_bf16 v29, v29, v66, 0
    v_dot2_f32_bf16 v30, v30, v66, 0
    v_dot2_f32_bf16 v31, v31, v66, 0
    v_cvt_pk_bf16_f32 v48, v24, v25
    v_cvt_pk_bf16_f32 v49, v26, v27
    buffer_store_dwordx2 v[48:49], v78, s[60:63], s68 offen
    s_add_u32 s68, s68, 294912
    v_cvt_pk_bf16_f32 v50, v28, v29
    v_cvt_pk_bf16_f32 v51, v30, v31
    buffer_store_dwordx2 v[50:51], v78, s[60:63], s68 offen
    s_add_u32 s68, s68, 294912
    s_setprio 3
    s_mov_b32 s9, 0
SP_16:
    ds_read_b32 v15, v1 offset:108
    s_waitcnt lgkmcnt(0)
    v_readfirstlane_b32 s8, v15
    s_add_u32 s9, s9, 1
    s_cmp_ge_u32 s8, 4
    s_cbranch_scc1 SP_16_D
    s_sleep 1
    s_cmp_lt_u32 s9, 524288
    s_cbranch_scc1 SP_16
SP_16_D:
    s_setprio 3
    ds_read_b64_tr_b16 v[16:17], v73 offset:512
    s_waitcnt lgkmcnt(0)
    v_perm_b32 v24, v52, v16, s70
    v_perm_b32 v25, v52, v16, s71
    v_perm_b32 v26, v53, v17, s70
    v_perm_b32 v27, v53, v17, s71
    v_dot2_f32_bf16 v24, v24, v68, 0
    v_dot2_f32_bf16 v25, v25, v68, 0
    v_dot2_f32_bf16 v26, v26, v68, 0
    v_dot2_f32_bf16 v27, v27, v68, 0
    s_nop 0
    v_cvt_pk_bf16_f32 v52, v24, v25
    s_nop 0
    v_cvt_pk_bf16_f32 v53, v26, v27
    buffer_store_dwordx2 v[52:53], v78, s[60:63], s68 offen
    s_add_u32 s68, s68, 294912
    s_setprio 3
    s_mov_b32 s9, 0
SP_17:
    ds_read_b32 v15, v1 offset:112
    s_waitcnt lgkmcnt(0)
    v_readfirstlane_b32 s8, v15
    s_add_u32 s9, s9, 1
    s_cmp_ge_u32 s8, 4
    s_cbranch_scc1 SP_17_D
    s_sleep 1
    s_cmp_lt_u32 s9, 524288
    s_cbranch_scc1 SP_17
SP_17_D:
    s_setprio 3
    ds_read_b64_tr_b16 v[16:17], v73 offset:0
    s_waitcnt lgkmcnt(0)
    v_perm_b32 v24, v54, v16, s70
    v_perm_b32 v25, v54, v16, s71
    v_perm_b32 v26, v55, v17, s70
    v_perm_b32 v27, v55, v17, s71
    v_dot2_f32_bf16 v24, v24, v70, 0
    v_dot2_f32_bf16 v25, v25, v70, 0
    v_dot2_f32_bf16 v26, v26, v70, 0
    v_dot2_f32_bf16 v27, v27, v70, 0
    s_nop 0
    v_cvt_pk_bf16_f32 v54, v24, v25
    s_nop 0
    v_cvt_pk_bf16_f32 v55, v26, v27
    buffer_store_dwordx2 v[54:55], v78, s[60:63], s68 offen
    s_add_u32 s68, s68, 294912
    v_mov_b32 v8, 1
    s_mov_b64 exec, 1
    ds_add_u32 v1, v8 offset:44
    s_mov_b64 exec, -1
    s_waitcnt vmcnt(0)
    v_mov_b32 v8, 1
    s_mov_b64 exec, 1
    ds_add_u32 v1, v8 offset:40
    s_mov_b64 exec, -1
    s_endpgm
C_FIN:
    s_setprio 0
    v_and_b32 v8, 7, v2
    v_lshlrev_b32 v8, 3, v8
    v_add_u32 v8, 8192, v8
    s_mul_i32 s8, s7, 9216
    s_add_u32 s8, s8, 32768
    v_lshl_add_u32 v5, v2, 4, s8
    v_add_u32 v6, 0x1000, v5
    v_add_u32 v7, 0x2000, v5
    v_and_b32 v19, 1, v4
    v_lshrrev_b32 v20, 1, v4
    v_lshl_or_b32 v19, v19, 1, v20
    v_mul_u32_u24 v12, 4672, v19
    v_add_u32 v12, 56576, v12
    v_mul_u32_u24 v13, 4160, v19
    v_add_u32 v13, 83456, v13
    s_add_u32 s8, s55, 2358144
    v_lshl_add_u32 v14, v19, 1, s8
    s_waitcnt lgkmcnt(0)
    v_bfe_u32 v110, v10, 0, 8
    v_bfe_u32 v111, v10, 8, 8
    v_bfe_u32 v112, v10, 16, 8
    v_bfe_u32 v113, v10, 24, 8
    s_setprio 3
    s_mov_b32 s9, 0
SP_18:
    ds_read_b32 v26, v1 offset:44
    s_waitcnt lgkmcnt(0)
    v_readfirstlane_b32 s8, v26
    s_add_u32 s9, s9, 1
    s_cmp_ge_u32 s8, 4
    s_cbranch_scc1 SP_18_D
    s_sleep 1
    s_cmp_lt_u32 s9, 524288
    s_cbranch_scc1 SP_18
SP_18_D:
    s_setprio 3
    s_mov_b32 s9, 0
C_MPOLL:
    global_load_dwordx2 v[16:17], v8, s[50:51] sc1
    global_load_dwordx4 v[120:123], v5, s[50:51] offset:0 sc1
    global_load_dwordx4 v[124:127], v5, s[50:51] offset:1024 sc1
    global_load_dwordx4 v[128:131], v5, s[50:51] offset:2048 sc1
    global_load_dwordx4 v[132:135], v5, s[50:51] offset:3072 sc1
    global_load_dwordx4 v[136:139], v6, s[50:51] offset:0 sc1
    global_load_dwordx4 v[140:143], v6, s[50:51] offset:1024 sc1
    global_load_dwordx4 v[144:147], v6, s[50:51] offset:2048 sc1
    global_load_dwordx4 v[148:151], v6, s[50:51] offset:3072 sc1
    global_load_dwordx4 v[152:155], v7, s[50:51] offset:0 sc1
    s_waitcnt vmcnt(9)
    v_and_b32 v22, 0x7ff, v16
    v_lshl_add_u32 v23, v22, 1, v12
    ds_read_u16 v105, v23
    v_lshl_add_u32 v23, v22, 1, v13
    ds_read_u16 v107, v23
    v_lshlrev_b32 v23, 2, v22
    v_add_u32 v23, 75264, v23
    ds_read_b32 v24, v23
    v_and_b32 v20, 0xffff0000, v16
    v_ashrrev_i32 v21, 31, v20
    v_not_b32 v21, v21
    v_or_b32 v21, 0x80000000, v21
    v_and_b32 v21, 0xffff0000, v21
    v_xor_b32 v20, v20, v21
    v_mul_f32 v21, 0xbfb8aa3b, v20
    v_exp_f32 v21, v21
    s_nop 0
    v_add_f32 v21, 1.0, v21
    v_rcp_f32 v104, v21
    s_nop 0
    v_cvt_pk_bf16_f32 v104, v104, v104
    v_and_b32 v104, 0xffff0000, v104
    v_mul_u32_u24 v108, 1152, v22
    v_sub_u32 v108, v14, v108
    s_waitcnt lgkmcnt(0)
    v_lshlrev_b32 v105, 16, v105
    s_waitcnt vmcnt(8)
    v_xor_b32 v120, v120, v110
    v_xor_b32 v121, v121, v111
    v_xor_b32 v122, v122, v112
    v_xor_b32 v123, v123, v113
    v_or3_b32 v26, v120, v121, 0
    v_or3_b32 v26, v122, v123, v26
    s_waitcnt vmcnt(7)
    v_xor_b32 v124, v124, v110
    v_xor_b32 v125, v125, v111
    v_xor_b32 v126, v126, v112
    v_xor_b32 v127, v127, v113
    v_or3_b32 v26, v124, v125, v26
    v_or3_b32 v26, v126, v127, v26
    v_pk_add_f32 v[28:29], v[120:121], v[124:125]
    v_pk_add_f32 v[30:31], v[122:123], v[126:127]
    s_waitcnt vmcnt(6)
    v_xor_b32 v128, v128, v110
    v_xor_b32 v129, v129, v111
    v_xor_b32 v130, v130, v112
    v_xor_b32 v131, v131, v113
    v_or3_b32 v26, v128, v129, v26
    v_or3_b32 v26, v130, v131, v26
    v_pk_add_f32 v[28:29], v[28:29], v[128:129]
    v_pk_add_f32 v[30:31], v[30:31], v[130:131]
    s_waitcnt vmcnt(5)
    v_xor_b32 v132, v132, v110
    v_xor_b32 v133, v133, v111
    v_xor_b32 v134, v134, v112
    v_xor_b32 v135, v135, v113
    v_or3_b32 v26, v132, v133, v26
    v_or3_b32 v26, v134, v135, v26
    v_pk_add_f32 v[28:29], v[28:29], v[132:133]
    v_pk_add_f32 v[30:31], v[30:31], v[134:135]
    s_waitcnt vmcnt(4)
    v_xor_b32 v136, v136, v110
    v_xor_b32 v137, v137, v111
    v_xor_b32 v138, v138, v112
    v_xor_b32 v139, v139, v113
    v_or3_b32 v26, v136, v137, v26
    v_or3_b32 v26, v138, v139, v26
    v_pk_add_f32 v[28:29], v[28:29], v[136:137]
    v_pk_add_f32 v[30:31], v[30:31], v[138:139]
    s_waitcnt vmcnt(3)
    v_xor_b32 v140, v140, v110
    v_xor_b32 v141, v141, v111
    v_xor_b32 v142, v142, v112
    v_xor_b32 v143, v143, v113
    v_or3_b32 v26, v140, v141, v26
    v_or3_b32 v26, v142, v143, v26
    v_pk_add_f32 v[28:29], v[28:29], v[140:141]
    v_pk_add_f32 v[30:31], v[30:31], v[142:143]
    s_waitcnt vmcnt(2)
    v_xor_b32 v144, v144, v110
    v_xor_b32 v145, v145, v111
    v_xor_b32 v146, v146, v112
    v_xor_b32 v147, v147, v113
    v_or3_b32 v26, v144, v145, v26
    v_or3_b32 v26, v146, v147, v26
    v_pk_add_f32 v[28:29], v[28:29], v[144:145]
    v_pk_add_f32 v[30:31], v[30:31], v[146:147]
    s_waitcnt vmcnt(1)
    v_xor_b32 v148, v148, v110
    v_xor_b32 v149, v149, v111
    v_xor_b32 v150, v150, v112
    v_xor_b32 v151, v151, v113
    v_or3_b32 v26, v148, v149, v26
    v_or3_b32 v26, v150, v151, v26
    v_pk_add_f32 v[28:29], v[28:29], v[148:149]
    v_pk_add_f32 v[30:31], v[30:31], v[150:151]
    s_waitcnt vmcnt(0)
    v_xor_b32 v152, v152, v110
    v_xor_b32 v153, v153, v111
    v_xor_b32 v154, v154, v112
    v_xor_b32 v155, v155, v113
    v_or3_b32 v26, v152, v153, v26
    v_or3_b32 v26, v154, v155, v26
    v_pk_add_f32 v[28:29], v[28:29], v[152:153]
    v_pk_add_f32 v[30:31], v[30:31], v[154:155]
    v_and_b32 v26, 0xff, v26
    v_bitop3_b32 v26, v26, v17, v10 bitop3:0xf6
    v_cmp_ne_u32 vcc, 0, v26
    s_add_u32 s9, s9, 1
    s_cmp_eq_u64 vcc, 0
    s_cbranch_scc1 C_MOK
    s_cmp_lt_u32 s9, 131072
    s_cbranch_scc1 C_MPOLL
C_MOK:
    v_permlane32_swap_b32 v28, v29
    v_permlane32_swap_b32 v30, v31
    v_add_f32 v28, v28, v29
    v_add_f32 v30, v30, v31
    s_nop 1
    v_permlane16_swap_b32 v28, v30
    v_add_f32 v28, v28, v30
    s_nop 1
    v_add_f32_dpp v28, v28, v28 row_ror:8 row_mask:0xf bank_mask:0xf
    v_cvt_pk_bf16_f32 v28, v28, v28
    v_and_b32 v28, 0xffff0000, v28
    v_mul_f32 v28, v28, v104
    v_cvt_pk_bf16_f32 v28, v28, v28
    v_and_b32 v28, 0xffff0000, v28
    v_add_f32 v28, v28, v105
    v_cvt_pk_bf16_f32 v28, v28, v28
    v_and_b32 v28, 0xffff0000, v28
    v_or_b32 v28, v28, v107
    v_dot2_f32_bf16 v28, v28, v24, 0
    s_nop 2
    v_cvt_pk_bf16_f32 v28, v28, v28
    s_mov_b32 s9, 0
SP_19:
    ds_read_b32 v27, v1 offset:40
    s_waitcnt lgkmcnt(0)
    v_readfirstlane_b32 s8, v27
    s_add_u32 s9, s9, 1
    s_cmp_ge_u32 s8, 4
    s_cbranch_scc1 SP_19_D
    s_cmp_lt_u32 s9, 524288
    s_cbranch_scc1 SP_19
SP_19_D:
    s_mov_b32 exec_lo, 0x00ff00ff
    s_mov_b32 exec_hi, 0x00ff00ff
    global_store_short v108, v28, s[46:47]
    s_mov_b64 exec, -1
    s_endpgm
C_CONST:
    v_lshl_add_u32 v14, v4, 3, v3
    v_sub_u32 v14, 39, v14
    s_lshl_b32 s8, s12, 11
    s_add_u32 s8, s8, 100096
    v_lshl_add_u32 v15, v2, 4, s8
    s_cmp_eq_u32 s12, 0
    s_cselect_b32 s8, 127, 7
    s_cselect_b32 s9, 19, 21
    s_movk_i32 s11, 0x3f80
    s_lshl_b32 s13, s11, 16
    v_mov_b32 v10, s8
    v_mov_b32 v11, 0
    v_lshlrev_b64 v[10:11], v14, v[10:11]
    v_alignbit_b32 v10, v11, v10, s9
    v_bfe_i32 v11, v10, 0, 1
    v_bfe_i32 v12, v10, 1, 1
    v_and_b32 v11, s11, v11
    v_and_or_b32 v16, v12, s13, v11
    v_bfe_i32 v11, v10, 2, 1
    v_bfe_i32 v12, v10, 3, 1
    v_and_b32 v11, s11, v11
    v_and_or_b32 v17, v12, s13, v11
    v_bfe_i32 v11, v10, 4, 1
    v_bfe_i32 v12, v10, 5, 1
    v_and_b32 v11, s11, v11
    v_and_or_b32 v18, v12, s13, v11
    v_bfe_i32 v11, v10, 6, 1
    v_bfe_i32 v12, v10, 7, 1
    v_and_b32 v11, s11, v11
    v_and_or_b32 v19, v12, s13, v11
    ds_write_b128 v15, v[16:19] offset:0
    s_cmp_eq_u32 s12, 0
    s_cselect_b32 s8, 511, 31
    s_cselect_b32 s9, 20, 18
    s_movk_i32 s11, 0x3f80
    s_lshl_b32 s13, s11, 16
    v_mov_b32 v10, s8
    v_mov_b32 v11, 0
    v_lshlrev_b64 v[10:11], v14, v[10:11]
    v_alignbit_b32 v10, v11, v10, s9
    v_bfe_i32 v11, v10, 0, 1
    v_bfe_i32 v12, v10, 1, 1
    v_and_b32 v11, s11, v11
    v_and_or_b32 v20, v12, s13, v11
    v_bfe_i32 v11, v10, 2, 1
    v_bfe_i32 v12, v10, 3, 1
    v_and_b32 v11, s11, v11
    v_and_or_b32 v21, v12, s13, v11
    v_bfe_i32 v11, v10, 4, 1
    v_bfe_i32 v12, v10, 5, 1
    v_and_b32 v11, s11, v11
    v_and_or_b32 v22, v12, s13, v11
    v_bfe_i32 v11, v10, 6, 1
    v_bfe_i32 v12, v10, 7, 1
    v_and_b32 v11, s11, v11
    v_and_or_b32 v23, v12, s13, v11
    ds_write_b128 v15, v[20:23] offset:1024
    s_cmp_eq_u32 s12, 0
    s_cselect_b32 s8, 7, 3
    s_cselect_b32 s9, 21, 21
    s_movk_i32 s11, 0x3f80
    s_cselect_b32 s11, s11, 0xffff
    s_lshl_b32 s13, s11, 16
    v_mov_b32 v10, s8
    v_mov_b32 v11, 0
    v_lshlrev_b64 v[10:11], v14, v[10:11]
    v_alignbit_b32 v10, v11, v10, s9
    v_bfe_i32 v11, v10, 0, 1
    v_bfe_i32 v12, v10, 1, 1
    v_and_b32 v11, s11, v11
    v_and_or_b32 v24, v12, s13, v11
    v_bfe_i32 v11, v10, 2, 1
    v_bfe_i32 v12, v10, 3, 1
    v_and_b32 v11, s11, v11
    v_and_or_b32 v25, v12, s13, v11
    v_bfe_i32 v11, v10, 4, 1
    v_bfe_i32 v12, v10, 5, 1
    v_and_b32 v11, s11, v11
    v_and_or_b32 v26, v12, s13, v11
    v_bfe_i32 v11, v10, 6, 1
    v_bfe_i32 v12, v10, 7, 1
    v_and_b32 v11, s11, v11
    v_and_or_b32 v27, v12, s13, v11
    ds_write_b128 v15, v[24:27] offset:2048
    v_mov_b32 v10, 1
    s_mov_b64 exec, 1
    ds_add_u32 v1, v10 offset:32
    s_mov_b64 exec, -1
    s_branch GATE
HELPER:
    s_cmp_ge_u32 s3, 6
    s_cbranch_scc1 K_END
    s_and_b32 s12, s3, 1
    s_sub_u32 s13, s3, 2
    s_lshr_b32 s13, s13, 1
    s_mul_i32 s13, s13, 5
    s_add_u32 s13, s13, s5
    s_add_u32 s13, s13, 44
    v_mul_u32_u24 v5, 57, v2
    v_lshrrev_b32 v5, 9, v5
    v_mul_u32_u24 v6, 9, v5
    v_sub_u32 v6, v2, v6
    s_waitcnt lgkmcnt(0)
    s_cmp_eq_u32 s12, 1
    s_cselect_b32 s52, s40, s38
    s_cselect_b32 s53, s41, s39
    s_mov_b32 s54, 5308416
    s_mov_b32 s55, 0x20000
    v_mul_u32_u24 v5, 9216, v5
    v_lshl_add_u32 v5, v6, 7, v5
    s_mul_i32 s8, s4, 1152
    s_sub_u32 s14, s13, 53
    s_lshr_b32 s9, s52, 7
    s_add_u32 s9, s9, s4
    s_sub_u32 s9, 3, s9
    s_and_b32 s9, s9, 7
    s_lshl_b32 s15, s9, 7
    s_add_u32 s15, s15, s8
    s_mul_i32 s14, s14, 258048
    s_add_u32 s15, s15, s14
    s_add_u32 s15, s15, 838656
    s_cmp_eq_u32 s9, 0
    s_cselect_b32 s9, 1024, 0
    v_and_b32 v7, 31, v2
    v_min_u32 v7, 27, v7
    v_mul_u32_u24 v7, 9216, v7
    v_lshrrev_b32 v9, 5, v2
    v_mul_u32_u24 v9, s9, v9
    v_add_u32 v7, v7, v9
    s_mul_i32 s13, s13, 64512
    s_add_u32 s13, s13, s8
    s_mov_b32 s9, 0
SP_20:
    ds_read_b32 v13, v1 offset:4
    s_waitcnt lgkmcnt(0)
    v_readfirstlane_b32 s8, v13
    s_add_u32 s9, s9, 1
    s_cmp_ge_u32 s8, 1
    s_cbranch_scc1 SP_20_D
    s_cmp_lt_u32 s9, 524288
    s_cbranch_scc1 SP_20
SP_20_D:
    buffer_load_dword v8, v7, s[52:55], s15 offen
    s_waitcnt vmcnt(0)
    buffer_load_dword v8, v5, s[52:55], s13 offen
    s_add_u32 s13, s13, 645120
    s_waitcnt vmcnt(0)
    buffer_load_dword v8, v5, s[52:55], s13 offen
    s_add_u32 s13, s13, 645120
    s_waitcnt vmcnt(0)
    buffer_load_dword v8, v5, s[52:55], s13 offen
    s_add_u32 s13, s13, 645120
    s_endpgm
GATE:
    s_lshl_b32 s8, s12, 9
    s_add_u32 s8, s8, 147712
    v_lshl_add_u32 v5, v2, 2, s8
    v_and_b32 v6, 31, v2
    v_lshlrev_b32 v6, 2, v6
    v_add_u32 v6, 158224, v6
    s_lshl_b32 s8, s2, 1
    s_add_u32 s8, s8, s12
    v_mov_b32 v8, 0
    v_mov_b32 v9, 0
    v_mov_b32 v10, 0x3f803f80
    s_lshl_b32 s8, s8, 5
    s_add_u32 s8, s8, 16384
    v_lshrrev_b32 v7, 5, v2
    v_lshl_add_u32 v7, v7, 3, s8
    v_and_b32 v11, 16, v2
    v_add_u32 v7, v7, v11
    s_mov_b32 s9, 0
SP_21:
    ds_read_b32 v13, v1 offset:8
    s_waitcnt lgkmcnt(0)
    v_readfirstlane_b32 s8, v13
    s_add_u32 s9, s9, 1
    s_cmp_lg_u32 s8, 0
    s_cbranch_scc1 SP_21_D
    s_sleep 1
    s_cmp_lt_u32 s9, 524288
    s_cbranch_scc1 SP_21
SP_21_D:
    ds_read2_b32 v[34:35], v6 offset0:0 offset1:32
    ds_read2_b32 v[36:37], v6 offset0:64 offset1:96
    ds_read2_b32 v[38:39], v6 offset0:128 offset1:160
    ds_read2_b32 v[40:41], v6 offset0:192 offset1:224
    ds_read_b32 v42, v6 offset:1024
    ds_read2st64_b32 v[16:17], v5 offset0:0 offset1:1
    ds_read2st64_b32 v[18:19], v5 offset0:4 offset1:5
    ds_read2st64_b32 v[20:21], v5 offset0:8 offset1:9
    ds_read2st64_b32 v[22:23], v5 offset0:12 offset1:13
    ds_read2st64_b32 v[24:25], v5 offset0:16 offset1:17
    ds_read2st64_b32 v[26:27], v5 offset0:20 offset1:21
    ds_read2st64_b32 v[28:29], v5 offset0:24 offset1:25
    ds_read2st64_b32 v[30:31], v5 offset0:28 offset1:29
    ds_read2st64_b32 v[32:33], v5 offset0:32 offset1:33
    s_waitcnt lgkmcnt(13)
    v_and_b32 v44, 0xffff, v34
    v_and_b32 v34, 0xffff0000, v34
    v_and_b32 v45, 0xffff, v35
    v_and_b32 v35, 0xffff0000, v35
    s_waitcnt lgkmcnt(12)
    v_and_b32 v46, 0xffff, v36
    v_and_b32 v36, 0xffff0000, v36
    v_and_b32 v47, 0xffff, v37
    v_and_b32 v37, 0xffff0000, v37
    s_waitcnt lgkmcnt(11)
    v_and_b32 v48, 0xffff, v38
    v_and_b32 v38, 0xffff0000, v38
    v_and_b32 v49, 0xffff, v39
    v_and_b32 v39, 0xffff0000, v39
    s_waitcnt lgkmcnt(10)
    v_and_b32 v50, 0xffff, v40
    v_and_b32 v40, 0xffff0000, v40
    v_and_b32 v51, 0xffff, v41
    v_and_b32 v41, 0xffff0000, v41
    s_waitcnt lgkmcnt(9)
    v_and_b32 v52, 0xffff, v42
    v_and_b32 v42, 0xffff0000, v42
    s_waitcnt lgkmcnt(8)
    v_dot2_f32_bf16 v56, v16, v44, 0
    v_dot2_f32_bf16 v57, v16, v34, 0
    v_dot2_f32_bf16 v58, v17, v44, 0
    v_dot2_f32_bf16 v59, v17, v34, 0
    s_waitcnt lgkmcnt(7)
    v_dot2_f32_bf16 v60, v18, v45, 0
    v_dot2_f32_bf16 v61, v18, v35, 0
    v_dot2_f32_bf16 v62, v19, v45, 0
    v_dot2_f32_bf16 v63, v19, v35, 0
    v_cvt_pk_bf16_f32 v56, v56, v57
    v_cvt_pk_bf16_f32 v58, v58, v59
    v_dot2c_f32_bf16 v8, v56, v10
    v_dot2c_f32_bf16 v9, v58, v10
    s_waitcnt lgkmcnt(6)
    v_dot2_f32_bf16 v56, v20, v46, 0
    v_dot2_f32_bf16 v57, v20, v36, 0
    v_dot2_f32_bf16 v58, v21, v46, 0
    v_dot2_f32_bf16 v59, v21, v36, 0
    v_cvt_pk_bf16_f32 v60, v60, v61
    v_cvt_pk_bf16_f32 v62, v62, v63
    v_dot2c_f32_bf16 v8, v60, v10
    v_dot2c_f32_bf16 v9, v62, v10
    s_waitcnt lgkmcnt(5)
    v_dot2_f32_bf16 v60, v22, v47, 0
    v_dot2_f32_bf16 v61, v22, v37, 0
    v_dot2_f32_bf16 v62, v23, v47, 0
    v_dot2_f32_bf16 v63, v23, v37, 0
    v_cvt_pk_bf16_f32 v56, v56, v57
    v_cvt_pk_bf16_f32 v58, v58, v59
    v_dot2c_f32_bf16 v8, v56, v10
    v_dot2c_f32_bf16 v9, v58, v10
    s_waitcnt lgkmcnt(4)
    v_dot2_f32_bf16 v56, v24, v48, 0
    v_dot2_f32_bf16 v57, v24, v38, 0
    v_dot2_f32_bf16 v58, v25, v48, 0
    v_dot2_f32_bf16 v59, v25, v38, 0
    v_cvt_pk_bf16_f32 v60, v60, v61
    v_cvt_pk_bf16_f32 v62, v62, v63
    v_dot2c_f32_bf16 v8, v60, v10
    v_dot2c_f32_bf16 v9, v62, v10
    s_waitcnt lgkmcnt(3)
    v_dot2_f32_bf16 v60, v26, v49, 0
    v_dot2_f32_bf16 v61, v26, v39, 0
    v_dot2_f32_bf16 v62, v27, v49, 0
    v_dot2_f32_bf16 v63, v27, v39, 0
    v_cvt_pk_bf16_f32 v56, v56, v57
    v_cvt_pk_bf16_f32 v58, v58, v59
    v_dot2c_f32_bf16 v8, v56, v10
    v_dot2c_f32_bf16 v9, v58, v10
    s_waitcnt lgkmcnt(2)
    v_dot2_f32_bf16 v56, v28, v50, 0
    v_dot2_f32_bf16 v57, v28, v40, 0
    v_dot2_f32_bf16 v58, v29, v50, 0
    v_dot2_f32_bf16 v59, v29, v40, 0
    v_cvt_pk_bf16_f32 v60, v60, v61
    v_cvt_pk_bf16_f32 v62, v62, v63
    v_dot2c_f32_bf16 v8, v60, v10
    v_dot2c_f32_bf16 v9, v62, v10
    s_waitcnt lgkmcnt(1)
    v_dot2_f32_bf16 v60, v30, v51, 0
    v_dot2_f32_bf16 v61, v30, v41, 0
    v_dot2_f32_bf16 v62, v31, v51, 0
    v_dot2_f32_bf16 v63, v31, v41, 0
    v_cvt_pk_bf16_f32 v56, v56, v57
    v_cvt_pk_bf16_f32 v58, v58, v59
    v_dot2c_f32_bf16 v8, v56, v10
    v_dot2c_f32_bf16 v9, v58, v10
    s_waitcnt lgkmcnt(0)
    v_dot2_f32_bf16 v56, v32, v52, 0
    v_dot2_f32_bf16 v57, v32, v42, 0
    v_dot2_f32_bf16 v58, v33, v52, 0
    v_dot2_f32_bf16 v59, v33, v42, 0
    v_cvt_pk_bf16_f32 v60, v60, v61
    v_cvt_pk_bf16_f32 v62, v62, v63
    v_dot2c_f32_bf16 v8, v60, v10
    v_dot2c_f32_bf16 v9, v62, v10
    v_cvt_pk_bf16_f32 v56, v56, v57
    v_cvt_pk_bf16_f32 v58, v58, v59
    v_dot2c_f32_bf16 v8, v56, v10
    v_dot2c_f32_bf16 v9, v58, v10
    v_mov_b32 v11, 1
    s_mov_b64 exec, 1
    ds_add_u32 v1, v11 offset:12
    s_mov_b64 exec, -1
    v_permlane16_swap_b32 v8, v9
    v_add_f32 v8, v8, v9
    s_nop 1
    v_add_f32_dpp v8, v8, v8 row_ror:8 row_mask:0xf bank_mask:0xf
    s_nop 1
    v_add_f32_dpp v8, v8, v8 row_ror:4 row_mask:0xf bank_mask:0xf
    s_nop 1
    v_add_f32_dpp v8, v8, v8 row_ror:2 row_mask:0xf bank_mask:0xf
    s_nop 1
    v_add_f32_dpp v8, v8, v8 row_ror:1 row_mask:0xf bank_mask:0xf
    v_cvt_pk_bf16_f32 v8, v8, v8
    v_and_b32 v8, 0xffff0000, v8
    v_mul_f32 v9, 0xbfb8aa3b, v8
    v_exp_f32 v9, v9
    s_nop 0
    v_add_f32 v9, 1.0, v9
    v_rcp_f32 v8, v9
    s_nop 0
    v_cvt_pk_bf16_f32 v8, v8, v8
    v_and_b32 v8, 0xffff0000, v8
    v_sub_f32 v9, 1.0, v8
    v_cvt_pk_bf16_f32 v12, v8, v9
    s_mov_b32 exec_lo, 0x00010001
    s_mov_b32 exec_hi, 0x00010001
    global_store_dwordx2 v7, v[12:13], s[50:51] sc1
    s_mov_b64 exec, -1
    s_cmp_lt_u32 s5, 9
    s_cbranch_scc1 F_COMP2
    s_cmp_ge_u32 s5, 14
    s_cbranch_scc1 C_IO
    s_endpgm
C_KBODY:
    s_load_dwordx2 s[68:69], s[32:33], s55
    s_setprio 2
    v_and_b32 v3, 15, v2
    v_lshrrev_b32 v4, 4, v2
    s_and_b32 s4, s2, 7
    s_mul_i32 s15, s3, 4608
    s_add_u32 s15, s15, 256
    s_mul_i32 s52, s12, 4864
    s_add_u32 s52, s52, 37120
    s_mul_i32 s53, s12, 4672
    s_add_u32 s53, s53, 56576
    v_mul_u32_u24 v7, 288, v3
    v_lshl_add_u32 v7, v4, 4, v7
    v_add_u32 v7, s15, v7
    s_mov_b32 m0, s15
C_SETD:
    s_waitcnt lgkmcnt(0)
    s_lshl_b32 s8, s12, 4
    s_lshr_b64 s[58:59], s[58:59], s8
    s_lshl_b32 s8, s58, 16
    v_mov_b32 v44, s8
    v_mul_f32 v45, 0x3fb8aa3b, v44
    v_mov_b32 v46, 0x3fb8aa3b
    v_fma_f32 v46, v44, v46, -v45
    v_mov_b32 v47, 0x32a57060
    v_fma_f32 v46, v44, v47, v46
    v_exp_f32 v45, v45
    v_mul_f32 v46, 0x3f317218, v46
    v_fma_f32 v45, v45, v46, v45
    v_cvt_pk_bf16_f32 v45, v45, v45
    v_and_b32 v36, 0xffff0000, v45
    v_mul_f32 v37, 0x3fb8aa3b, v36
    v_mul_f32 v38, 0x3e22f983, v36
    s_waitcnt vmcnt(0)
    v_mul_f32 v40, v16, v37
    v_mul_f32 v41, v17, v38
    v_exp_f32 v24, v40
    v_fract_f32 v47, v41
    v_cos_f32 v46, v47
    v_sin_f32 v47, v47
    v_mul_f32 v46, v24, v46
    v_mul_f32 v47, v24, v47
    v_mul_f32 v18, v18, v36
    v_mul_f32 v19, v19, v36
    v_pk_mul_f32 v[42:43], v[20:21], v[18:19] op_sel:[0,0] op_sel_hi:[0,1]
    v_pk_fma_f32 v[42:43], v[20:21], v[18:19], v[42:43] op_sel:[1,1,0] op_sel_hi:[1,0,1] neg_lo:[0,1,0]
    v_max_f32 v39, |v42|, |v43|
    v_pk_mul_f32 v[48:49], v[46:47], v[46:47] op_sel:[0,0] op_sel_hi:[0,1]
    v_pk_fma_f32 v[48:49], v[46:47], v[46:47], v[48:49] op_sel:[1,1,0] op_sel_hi:[1,0,1] neg_lo:[0,1,0]
    v_pk_mul_f32 v[52:53], v[48:49], v[48:49] op_sel:[0,0] op_sel_hi:[0,1]
    v_pk_fma_f32 v[52:53], v[48:49], v[48:49], v[52:53] op_sel:[1,1,0] op_sel_hi:[1,0,1] neg_lo:[0,1,0]
    v_pk_mul_f32 v[60:61], v[52:53], v[52:53] op_sel:[0,0] op_sel_hi:[0,1]
    v_pk_fma_f32 v[60:61], v[52:53], v[52:53], v[60:61] op_sel:[1,1,0] op_sel_hi:[1,0,1] neg_lo:[0,1,0]
    v_mov_b32 v30, 0x3c00
    v_xor_b32 v61, 0x80000000, v61
    ds_write_addtid_b32 v30
    v_cvt_pk_f16_f32 v26, v60, v61
    v_pk_mul_f32 v[62:63], v[60:61], v[60:61] op_sel:[0,0] op_sel_hi:[0,1]
    v_pk_fma_f32 v[62:63], v[60:61], v[60:61], v[62:63] op_sel:[1,1,0] op_sel_hi:[1,0,1] neg_lo:[0,1,0]
    v_max_u32_dpp v39, v39, v39 row_shr:1 row_mask:0xf bank_mask:0xf
    ds_write_addtid_b32 v26 offset:288
    v_cvt_pk_f16_f32 v27, v62, v63
    v_pk_mul_f32 v[64:65], v[62:63], v[60:61] op_sel:[0,0] op_sel_hi:[0,1]
    v_pk_fma_f32 v[64:65], v[62:63], v[60:61], v[64:65] op_sel:[1,1,0] op_sel_hi:[1,0,1] neg_lo:[0,1,0]
    v_max_u32_dpp v39, v39, v39 row_shr:2 row_mask:0xf bank_mask:0xf
    ds_write_addtid_b32 v27 offset:576
    v_cvt_pk_f16_f32 v28, v64, v65
    v_pk_mul_f32 v[62:63], v[64:65], v[60:61] op_sel:[0,0] op_sel_hi:[0,1]
    v_pk_fma_f32 v[62:63], v[64:65], v[60:61], v[62:63] op_sel:[1,1,0] op_sel_hi:[1,0,1] neg_lo:[0,1,0]
    v_max_u32_dpp v39, v39, v39 row_shr:4 row_mask:0xf bank_mask:0xf
    ds_write_addtid_b32 v28 offset:864
    v_cvt_pk_f16_f32 v29, v62, v63
    v_pk_mul_f32 v[64:65], v[62:63], v[60:61] op_sel:[0,0] op_sel_hi:[0,1]
    v_pk_fma_f32 v[64:65], v[62:63], v[60:61], v[64:65] op_sel:[1,1,0] op_sel_hi:[1,0,1] neg_lo:[0,1,0]
    v_max_u32_dpp v39, v39, v39 row_shr:8 row_mask:0xf bank_mask:0xf
    ds_write_addtid_b32 v29 offset:1152
    v_cvt_pk_f16_f32 v26, v64, v65
    v_pk_mul_f32 v[62:63], v[64:65], v[60:61] op_sel:[0,0] op_sel_hi:[0,1]
    v_pk_fma_f32 v[62:63], v[64:65], v[60:61], v[62:63] op_sel:[1,1,0] op_sel_hi:[1,0,1] neg_lo:[0,1,0]
    v_max_u32_dpp v39, v39, v39 row_bcast:15 row_mask:0xa bank_mask:0xf
    ds_write_addtid_b32 v26 offset:1440
    v_cvt_pk_f16_f32 v27, v62, v63
    v_pk_mul_f32 v[64:65], v[62:63], v[60:61] op_sel:[0,0] op_sel_hi:[0,1]
    v_pk_fma_f32 v[64:65], v[62:63], v[60:61], v[64:65] op_sel:[1,1,0] op_sel_hi:[1,0,1] neg_lo:[0,1,0]
    v_max_u32_dpp v39, v39, v39 row_bcast:31 row_mask:0xc bank_mask:0xf
    ds_write_addtid_b32 v27 offset:1728
    v_cvt_pk_f16_f32 v28, v64, v65
    v_pk_mul_f32 v[62:63], v[64:65], v[60:61] op_sel:[0,0] op_sel_hi:[0,1]
    v_pk_fma_f32 v[62:63], v[64:65], v[60:61], v[62:63] op_sel:[1,1,0] op_sel_hi:[1,0,1] neg_lo:[0,1,0]
    v_readlane_b32 s8, v39, 63
    ds_write_addtid_b32 v28 offset:2016
    v_cvt_pk_f16_f32 v29, v62, v63
    v_pk_mul_f32 v[64:65], v[62:63], v[60:61] op_sel:[0,0] op_sel_hi:[0,1]
    v_pk_fma_f32 v[64:65], v[62:63], v[60:61], v[64:65] op_sel:[1,1,0] op_sel_hi:[1,0,1] neg_lo:[0,1,0]
    ds_write_addtid_b32 v29 offset:2304
    v_cvt_pk_f16_f32 v26, v64, v65
    v_pk_mul_f32 v[62:63], v[64:65], v[60:61] op_sel:[0,0] op_sel_hi:[0,1]
    v_pk_fma_f32 v[62:63], v[64:65], v[60:61], v[62:63] op_sel:[1,1,0] op_sel_hi:[1,0,1] neg_lo:[0,1,0]
    ds_write_addtid_b32 v26 offset:2592
    v_cvt_pk_f16_f32 v27, v62, v63
    v_pk_mul_f32 v[64:65], v[62:63], v[60:61] op_sel:[0,0] op_sel_hi:[0,1]
    v_pk_fma_f32 v[64:65], v[62:63], v[60:61], v[64:65] op_sel:[1,1,0] op_sel_hi:[1,0,1] neg_lo:[0,1,0]
    ds_write_addtid_b32 v27 offset:2880
    v_cvt_pk_f16_f32 v28, v64, v65
    v_pk_mul_f32 v[62:63], v[64:65], v[60:61] op_sel:[0,0] op_sel_hi:[0,1]
    v_pk_fma_f32 v[62:63], v[64:65], v[60:61], v[62:63] op_sel:[1,1,0] op_sel_hi:[1,0,1] neg_lo:[0,1,0]
    ds_write_addtid_b32 v28 offset:3168
    v_cvt_pk_f16_f32 v29, v62, v63
    v_pk_mul_f32 v[64:65], v[62:63], v[60:61] op_sel:[0,0] op_sel_hi:[0,1]
    v_pk_fma_f32 v[64:65], v[62:63], v[60:61], v[64:65] op_sel:[1,1,0] op_sel_hi:[1,0,1] neg_lo:[0,1,0]
    ds_write_addtid_b32 v29 offset:3456
    v_cvt_pk_f16_f32 v26, v64, v65
    v_pk_mul_f32 v[62:63], v[64:65], v[60:61] op_sel:[0,0] op_sel_hi:[0,1]
    v_pk_fma_f32 v[62:63], v[64:65], v[60:61], v[62:63] op_sel:[1,1,0] op_sel_hi:[1,0,1] neg_lo:[0,1,0]
    ds_write_addtid_b32 v26 offset:3744
    v_cvt_pk_f16_f32 v27, v62, v63
    v_pk_mul_f32 v[64:65], v[62:63], v[60:61] op_sel:[0,0] op_sel_hi:[0,1]
    v_pk_fma_f32 v[64:65], v[62:63], v[60:61], v[64:65] op_sel:[1,1,0] op_sel_hi:[1,0,1] neg_lo:[0,1,0]
    ds_write_addtid_b32 v27 offset:4032
    v_cvt_pk_f16_f32 v28, v64, v65
    s_lshr_b32 s8, s8, 23
    s_sub_u32 s8, 258, s8
    s_min_u32 s54, s8, 253
    s_lshl_b32 s8, s54, 23
    v_mul_f32 v42, s8, v42
    v_mul_f32 v43, s8, v43
    ds_write_addtid_b32 v28 offset:4320
    ds_read_b128 v[72:75], v7 offset:0
    ds_read_b128 v[76:79], v7 offset:64
    ds_read_b128 v[80:83], v7 offset:128
    ds_read_b128 v[84:87], v7 offset:192
    v_mul_f32 v44, 0x43000000, v40
    v_mul_f32 v45, 0x43000000, v41
    v_exp_f32 v24, v44
    v_fract_f32 v45, v45
    v_cos_f32 v44, v45
    v_sin_f32 v45, v45
    v_mul_f32 v44, v24, v44
    v_mul_f32 v45, v24, v45
    v_pk_mul_f32 v[50:51], v[48:49], v[46:47] op_sel:[0,0] op_sel_hi:[0,1]
    v_pk_fma_f32 v[50:51], v[48:49], v[46:47], v[50:51] op_sel:[1,1,0] op_sel_hi:[1,0,1] neg_lo:[0,1,0]
    v_pk_mul_f32 v[54:55], v[52:53], v[46:47] op_sel:[0,0] op_sel_hi:[0,1]
    v_pk_fma_f32 v[54:55], v[52:53], v[46:47], v[54:55] op_sel:[1,1,0] op_sel_hi:[1,0,1] neg_lo:[0,1,0]
    v_pk_mul_f32 v[56:57], v[50:51], v[50:51] op_sel:[0,0] op_sel_hi:[0,1]
    v_pk_fma_f32 v[56:57], v[50:51], v[50:51], v[56:57] op_sel:[1,1,0] op_sel_hi:[1,0,1] neg_lo:[0,1,0]
    v_pk_mul_f32 v[58:59], v[56:57], v[46:47] op_sel:[0,0] op_sel_hi:[0,1]
    v_pk_fma_f32 v[58:59], v[56:57], v[46:47], v[58:59] op_sel:[1,1,0] op_sel_hi:[1,0,1] neg_lo:[0,1,0]
    v_cvt_pk_f16_f32 v29, v42, v43
    v_pk_mul_f32 v[60:61], v[42:43], v[46:47] op_sel:[0,0] op_sel_hi:[0,1]
    v_pk_fma_f32 v[60:61], v[42:43], v[46:47], v[60:61] op_sel:[1,1,0] op_sel_hi:[1,0,1] neg_lo:[0,1,0]
    ds_write_addtid_b32 v29 offset:0
    v_cvt_pk_f16_f32 v26, v60, v61
    v_pk_mul_f32 v[62:63], v[42:43], v[48:49] op_sel:[0,0] op_sel_hi:[0,1]
    v_pk_fma_f32 v[62:63], v[42:43], v[48:49], v[62:63] op_sel:[1,1,0] op_sel_hi:[1,0,1] neg_lo:[0,1,0]
    ds_write_addtid_b32 v26 offset:288
    v_cvt_pk_f16_f32 v27, v62, v63
    v_pk_mul_f32 v[60:61], v[42:43], v[50:51] op_sel:[0,0] op_sel_hi:[0,1]
    v_pk_fma_f32 v[60:61], v[42:43], v[50:51], v[60:61] op_sel:[1,1,0] op_sel_hi:[1,0,1] neg_lo:[0,1,0]
    ds_write_addtid_b32 v27 offset:576
    v_cvt_pk_f16_f32 v28, v60, v61
    v_pk_mul_f32 v[62:63], v[42:43], v[52:53] op_sel:[0,0] op_sel_hi:[0,1]
    v_pk_fma_f32 v[62:63], v[42:43], v[52:53], v[62:63] op_sel:[1,1,0] op_sel_hi:[1,0,1] neg_lo:[0,1,0]
    ds_write_addtid_b32 v28 offset:864
    v_cvt_pk_f16_f32 v29, v62, v63
    v_pk_mul_f32 v[60:61], v[42:43], v[54:55] op_sel:[0,0] op_sel_hi:[0,1]
    v_pk_fma_f32 v[60:61], v[42:43], v[54:55], v[60:61] op_sel:[1,1,0] op_sel_hi:[1,0,1] neg_lo:[0,1,0]
    ds_write_addtid_b32 v29 offset:1152
    v_cvt_pk_f16_f32 v26, v60, v61
    v_pk_mul_f32 v[62:63], v[42:43], v[56:57] op_sel:[0,0] op_sel_hi:[0,1]
    v_pk_fma_f32 v[62:63], v[42:43], v[56:57], v[62:63] op_sel:[1,1,0] op_sel_hi:[1,0,1] neg_lo:[0,1,0]
    ds_write_addtid_b32 v26 offset:1440
    v_cvt_pk_f16_f32 v27, v62, v63
    v_pk_mul_f32 v[60:61], v[42:43], v[58:59] op_sel:[0,0] op_sel_hi:[0,1]
    v_pk_fma_f32 v[60:61], v[42:43], v[58:59], v[60:61] op_sel:[1,1,0] op_sel_hi:[1,0,1] neg_lo:[0,1,0]
    ds_write_addtid_b32 v27 offset:1728
    v_cvt_pk_f16_f32 v28, v60, v61
    v_pk_mul_f32 v[66:67], v[42:43], v[44:45] op_sel:[0,0] op_sel_hi:[0,1]
    v_pk_fma_f32 v[66:67], v[42:43], v[44:45], v[66:67] op_sel:[1,1,0] op_sel_hi:[1,0,1] neg_lo:[0,1,0]
    ds_write_addtid_b32 v28 offset:2016
    v_cvt_pk_f16_f32 v29, v66, v67
    v_pk_mul_f32 v[62:63], v[66:67], v[46:47] op_sel:[0,0] op_sel_hi:[0,1]
    v_pk_fma_f32 v[62:63], v[66:67], v[46:47], v[62:63] op_sel:[1,1,0] op_sel_hi:[1,0,1] neg_lo:[0,1,0]
    ds_write_addtid_b32 v29 offset:2304
    v_cvt_pk_f16_f32 v26, v62, v63
    v_pk_mul_f32 v[60:61], v[66:67], v[48:49] op_sel:[0,0] op_sel_hi:[0,1]
    v_pk_fma_f32 v[60:61], v[66:67], v[48:49], v[60:61] op_sel:[1,1,0] op_sel_hi:[1,0,1] neg_lo:[0,1,0]
    ds_write_addtid_b32 v26 offset:2592
    v_cvt_pk_f16_f32 v27, v60, v61
    v_pk_mul_f32 v[62:63], v[66:67], v[50:51] op_sel:[0,0] op_sel_hi:[0,1]
    v_pk_fma_f32 v[62:63], v[66:67], v[50:51], v[62:63] op_sel:[1,1,0] op_sel_hi:[1,0,1] neg_lo:[0,1,0]
    ds_write_addtid_b32 v27 offset:2880
    v_cvt_pk_f16_f32 v28, v62, v63
    v_pk_mul_f32 v[60:61], v[66:67], v[52:53] op_sel:[0,0] op_sel_hi:[0,1]
    v_pk_fma_f32 v[60:61], v[66:67], v[52:53], v[60:61] op_sel:[1,1,0] op_sel_hi:[1,0,1] neg_lo:[0,1,0]
    ds_write_addtid_b32 v28 offset:3168
    v_cvt_pk_f16_f32 v29, v60, v61
    v_pk_mul_f32 v[62:63], v[66:67], v[54:55] op_sel:[0,0] op_sel_hi:[0,1]
    v_pk_fma_f32 v[62:63], v[66:67], v[54:55], v[62:63] op_sel:[1,1,0] op_sel_hi:[1,0,1] neg_lo:[0,1,0]
    ds_write_addtid_b32 v29 offset:3456
    v_cvt_pk_f16_f32 v26, v62, v63
    v_pk_mul_f32 v[60:61], v[66:67], v[56:57] op_sel:[0,0] op_sel_hi:[0,1]
    v_pk_fma_f32 v[60:61], v[66:67], v[56:57], v[60:61] op_sel:[1,1,0] op_sel_hi:[1,0,1] neg_lo:[0,1,0]
    ds_write_addtid_b32 v26 offset:3744
    v_cvt_pk_f16_f32 v27, v60, v61
    v_pk_mul_f32 v[62:63], v[66:67], v[58:59] op_sel:[0,0] op_sel_hi:[0,1]
    v_pk_fma_f32 v[62:63], v[66:67], v[58:59], v[62:63] op_sel:[1,1,0] op_sel_hi:[1,0,1] neg_lo:[0,1,0]
    ds_write_addtid_b32 v27 offset:4032
    v_cvt_pk_f16_f32 v28, v62, v63
    v_pk_mul_f32 v[68:69], v[66:67], v[44:45] op_sel:[0,0] op_sel_hi:[0,1]
    v_pk_fma_f32 v[68:69], v[66:67], v[44:45], v[68:69] op_sel:[1,1,0] op_sel_hi:[1,0,1] neg_lo:[0,1,0]
    ds_write_addtid_b32 v28 offset:4320
    ds_read_b128 v[88:91], v7 offset:0
    ds_read_b128 v[92:95], v7 offset:64
    ds_read_b128 v[96:99], v7 offset:128
    ds_read_b128 v[100:103], v7 offset:192
    v_cvt_pk_f16_f32 v29, v68, v69
    v_pk_mul_f32 v[60:61], v[68:69], v[48:49] op_sel:[0,0] op_sel_hi:[0,1]
    v_pk_fma_f32 v[60:61], v[68:69], v[48:49], v[60:61] op_sel:[1,1,0] op_sel_hi:[1,0,1] neg_lo:[0,1,0]
    ds_write_addtid_b32 v29 offset:0
    v_cvt_pk_f16_f32 v26, v60, v61
    v_pk_mul_f32 v[62:63], v[68:69], v[52:53] op_sel:[0,0] op_sel_hi:[0,1]
    v_pk_fma_f32 v[62:63], v[68:69], v[52:53], v[62:63] op_sel:[1,1,0] op_sel_hi:[1,0,1] neg_lo:[0,1,0]
    ds_write_addtid_b32 v26 offset:288
    v_cvt_pk_f16_f32 v27, v62, v63
    v_pk_mul_f32 v[60:61], v[68:69], v[56:57] op_sel:[0,0] op_sel_hi:[0,1]
    v_pk_fma_f32 v[60:61], v[68:69], v[56:57], v[60:61] op_sel:[1,1,0] op_sel_hi:[1,0,1] neg_lo:[0,1,0]
    ds_write_addtid_b32 v27 offset:576
    v_cvt_pk_f16_f32 v28, v60, v61
    v_pk_mul_f32 v[66:67], v[68:69], v[44:45] op_sel:[0,0] op_sel_hi:[0,1]
    v_pk_fma_f32 v[66:67], v[68:69], v[44:45], v[66:67] op_sel:[1,1,0] op_sel_hi:[1,0,1] neg_lo:[0,1,0]
    ds_write_addtid_b32 v28 offset:864
    v_cvt_pk_f16_f32 v29, v66, v67
    s_waitcnt lgkmcnt(7)
    v_mfma_f32_16x16x32_f16 v[104:107], v[88:91], v[72:75], 0
    v_pk_mul_f32 v[62:63], v[66:67], v[48:49] op_sel:[0,0] op_sel_hi:[0,1]
    v_pk_fma_f32 v[62:63], v[66:67], v[48:49], v[62:63] op_sel:[1,1,0] op_sel_hi:[1,0,1] neg_lo:[0,1,0]
    ds_write_addtid_b32 v29 offset:1152
    v_cvt_pk_f16_f32 v26, v62, v63
    s_waitcnt lgkmcnt(7)
    v_mfma_f32_16x16x32_f16 v[104:107], v[92:95], v[76:79], v[104:107]
    v_pk_mul_f32 v[60:61], v[66:67], v[52:53] op_sel:[0,0] op_sel_hi:[0,1]
    v_pk_fma_f32 v[60:61], v[66:67], v[52:53], v[60:61] op_sel:[1,1,0] op_sel_hi:[1,0,1] neg_lo:[0,1,0]
    ds_write_addtid_b32 v26 offset:1440
    v_cvt_pk_f16_f32 v27, v60, v61
    s_waitcnt lgkmcnt(7)
    v_mfma_f32_16x16x32_f16 v[104:107], v[96:99], v[80:83], v[104:107]
    v_pk_mul_f32 v[62:63], v[66:67], v[56:57] op_sel:[0,0] op_sel_hi:[0,1]
    v_pk_fma_f32 v[62:63], v[66:67], v[56:57], v[62:63] op_sel:[1,1,0] op_sel_hi:[1,0,1] neg_lo:[0,1,0]
    ds_write_addtid_b32 v27 offset:1728
    v_cvt_pk_f16_f32 v28, v62, v63
    s_waitcnt lgkmcnt(7)
    v_mfma_f32_16x16x32_f16 v[104:107], v[100:103], v[84:87], v[104:107]
    v_pk_mul_f32 v[68:69], v[66:67], v[44:45] op_sel:[0,0] op_sel_hi:[0,1]
    v_pk_fma_f32 v[68:69], v[66:67], v[44:45], v[68:69] op_sel:[1,1,0] op_sel_hi:[1,0,1] neg_lo:[0,1,0]
    ds_write_addtid_b32 v28 offset:2016
    v_cvt_pk_f16_f32 v29, v68, v69
    v_pk_mul_f32 v[60:61], v[68:69], v[52:53] op_sel:[0,0] op_sel_hi:[0,1]
    v_pk_fma_f32 v[60:61], v[68:69], v[52:53], v[60:61] op_sel:[1,1,0] op_sel_hi:[1,0,1] neg_lo:[0,1,0]
    ds_write_addtid_b32 v29 offset:2304
    v_cvt_pk_f16_f32 v26, v60, v61
    v_pk_mul_f32 v[66:67], v[68:69], v[44:45] op_sel:[0,0] op_sel_hi:[0,1]
    v_pk_fma_f32 v[66:67], v[68:69], v[44:45], v[66:67] op_sel:[1,1,0] op_sel_hi:[1,0,1] neg_lo:[0,1,0]
    ds_write_addtid_b32 v26 offset:2592
    v_cvt_pk_f16_f32 v27, v66, v67
    v_pk_mul_f32 v[62:63], v[66:67], v[52:53] op_sel:[0,0] op_sel_hi:[0,1]
    v_pk_fma_f32 v[62:63], v[66:67], v[52:53], v[62:63] op_sel:[1,1,0] op_sel_hi:[1,0,1] neg_lo:[0,1,0]
    ds_write_addtid_b32 v27 offset:2880
    v_cvt_pk_f16_f32 v28, v62, v63
    v_pk_mul_f32 v[68:69], v[66:67], v[44:45] op_sel:[0,0] op_sel_hi:[0,1]
    v_pk_fma_f32 v[68:69], v[66:67], v[44:45], v[68:69] op_sel:[1,1,0] op_sel_hi:[1,0,1] neg_lo:[0,1,0]
    ds_write_addtid_b32 v28 offset:3168
    v_cvt_pk_f16_f32 v29, v68, v69
    v_pk_mul_f32 v[60:61], v[68:69], v[52:53] op_sel:[0,0] op_sel_hi:[0,1]
    v_pk_fma_f32 v[60:61], v[68:69], v[52:53], v[60:61] op_sel:[1,1,0] op_sel_hi:[1,0,1] neg_lo:[0,1,0]
    ds_write_addtid_b32 v29 offset:3456
    v_cvt_pk_f16_f32 v26, v60, v61
    v_pk_mul_f32 v[66:67], v[68:69], v[44:45] op_sel:[0,0] op_sel_hi:[0,1]
    v_pk_fma_f32 v[66:67], v[68:69], v[44:45], v[66:67] op_sel:[1,1,0] op_sel_hi:[1,0,1] neg_lo:[0,1,0]
    ds_write_addtid_b32 v26 offset:3744
    v_cvt_pk_f16_f32 v27, v66, v67
    v_pk_mul_f32 v[62:63], v[66:67], v[52:53] op_sel:[0,0] op_sel_hi:[0,1]
    v_pk_fma_f32 v[62:63], v[66:67], v[52:53], v[62:63] op_sel:[1,1,0] op_sel_hi:[1,0,1] neg_lo:[0,1,0]
    ds_write_addtid_b32 v27 offset:4032
    v_cvt_pk_f16_f32 v28, v62, v63
    v_pk_mul_f32 v[68:69], v[66:67], v[44:45] op_sel:[0,0] op_sel_hi:[0,1]
    v_pk_fma_f32 v[68:69], v[66:67], v[44:45], v[68:69] op_sel:[1,1,0] op_sel_hi:[1,0,1] neg_lo:[0,1,0]
    ds_write_addtid_b32 v28 offset:4320
    ds_read_b128 v[88:91], v7 offset:0
    ds_read_b128 v[92:95], v7 offset:64
    ds_read_b128 v[96:99], v7 offset:128
    ds_read_b128 v[100:103], v7 offset:192
    v_cvt_pk_f16_f32 v29, v68, v69
    v_pk_mul_f32 v[66:67], v[68:69], v[44:45] op_sel:[0,0] op_sel_hi:[0,1]
    v_pk_fma_f32 v[66:67], v[68:69], v[44:45], v[66:67] op_sel:[1,1,0] op_sel_hi:[1,0,1] neg_lo:[0,1,0]
    ds_write_addtid_b32 v29 offset:0
    v_cvt_pk_f16_f32 v26, v66, v67
    v_pk_mul_f32 v[68:69], v[66:67], v[44:45] op_sel:[0,0] op_sel_hi:[0,1]
    v_pk_fma_f32 v[68:69], v[66:67], v[44:45], v[68:69] op_sel:[1,1,0] op_sel_hi:[1,0,1] neg_lo:[0,1,0]
    ds_write_addtid_b32 v26 offset:288
    v_cvt_pk_f16_f32 v27, v68, v69
    v_pk_mul_f32 v[66:67], v[68:69], v[44:45] op_sel:[0,0] op_sel_hi:[0,1]
    v_pk_fma_f32 v[66:67], v[68:69], v[44:45], v[66:67] op_sel:[1,1,0] op_sel_hi:[1,0,1] neg_lo:[0,1,0]
    ds_write_addtid_b32 v27 offset:576
    v_cvt_pk_f16_f32 v28, v66, v67
    v_pk_mul_f32 v[68:69], v[66:67], v[44:45] op_sel:[0,0] op_sel_hi:[0,1]
    v_pk_fma_f32 v[68:69], v[66:67], v[44:45], v[68:69] op_sel:[1,1,0] op_sel_hi:[1,0,1] neg_lo:[0,1,0]
    ds_write_addtid_b32 v28 offset:864
    v_cvt_pk_f16_f32 v29, v68, v69
    v_pk_mul_f32 v[66:67], v[68:69], v[44:45] op_sel:[0,0] op_sel_hi:[0,1]
    v_pk_fma_f32 v[66:67], v[68:69], v[44:45], v[66:67] op_sel:[1,1,0] op_sel_hi:[1,0,1] neg_lo:[0,1,0]
    s_waitcnt lgkmcnt(7)
    v_mfma_f32_16x16x32_f16 v[108:111], v[88:91], v[72:75], 0
    ds_write_addtid_b32 v29 offset:1152
    v_cvt_pk_f16_f32 v26, v66, v67
    v_pk_mul_f32 v[68:69], v[66:67], v[44:45] op_sel:[0,0] op_sel_hi:[0,1]
    v_pk_fma_f32 v[68:69], v[66:67], v[44:45], v[68:69] op_sel:[1,1,0] op_sel_hi:[1,0,1] neg_lo:[0,1,0]
    s_waitcnt lgkmcnt(7)
    v_mfma_f32_16x16x32_f16 v[108:111], v[92:95], v[76:79], v[108:111]
    ds_write_addtid_b32 v26 offset:1440
    v_cvt_pk_f16_f32 v27, v68, v69
    v_pk_mul_f32 v[66:67], v[68:69], v[44:45] op_sel:[0,0] op_sel_hi:[0,1]
    v_pk_fma_f32 v[66:67], v[68:69], v[44:45], v[66:67] op_sel:[1,1,0] op_sel_hi:[1,0,1] neg_lo:[0,1,0]
    s_waitcnt lgkmcnt(7)
    v_mfma_f32_16x16x32_f16 v[108:111], v[96:99], v[80:83], v[108:111]
    ds_write_addtid_b32 v27 offset:1728
    v_cvt_pk_f16_f32 v28, v66, v67
    v_pk_mul_f32 v[68:69], v[66:67], v[44:45] op_sel:[0,0] op_sel_hi:[0,1]
    v_pk_fma_f32 v[68:69], v[66:67], v[44:45], v[68:69] op_sel:[1,1,0] op_sel_hi:[1,0,1] neg_lo:[0,1,0]
    s_waitcnt lgkmcnt(7)
    v_mfma_f32_16x16x32_f16 v[108:111], v[100:103], v[84:87], v[108:111]
    ds_write_addtid_b32 v28 offset:2016
    v_cvt_pk_f16_f32 v29, v68, v69
    ds_write_addtid_b32 v29 offset:2304
    ds_read_b128 v[88:91], v7 offset:0
    ds_read_b128 v[92:95], v7 offset:64
    ds_read_b128 v[96:99], v7 offset:128
    ds_read_b128 v[100:103], v7 offset:192
    v_lshl_add_u32 v8, v2, 4, s15
    s_waitcnt lgkmcnt(3)
    v_mfma_f32_16x16x32_f16 v[112:115], v[88:91], v[72:75], 0
    s_waitcnt lgkmcnt(2)
    v_mfma_f32_16x16x32_f16 v[112:115], v[92:95], v[76:79], v[112:115]
    s_waitcnt lgkmcnt(1)
    v_mfma_f32_16x16x32_f16 v[112:115], v[96:99], v[80:83], v[112:115]
    s_waitcnt lgkmcnt(0)
    v_mfma_f32_16x16x32_f16 v[112:115], v[100:103], v[84:87], v[112:115]
    s_lshl_b32 s8, s12, 2
    s_add_u32 s8, s8, 16
    v_mov_b32 v9, s8
    s_cmp_eq_u32 s13, 0
    s_cbranch_scc1 C_KA
    ds_write_b128 v8, v[104:107] offset:0
    ds_write_b128 v8, v[108:111] offset:1024
    s_nop 0
    ds_write_b128 v8, v[112:115] offset:2048
    v_mov_b32 v10, s54
    ds_write_b32 v9, v10
    s_setprio 0
    v_and_b32 v14, 3, v3
    v_sub_u32 v14, 3, v14
    v_mul_u32_u24 v14, 1216, v14
    v_lshrrev_b32 v13, 2, v3
    v_lshl_add_u32 v13, v4, 1, v13
    v_lshl_add_u32 v14, v13, 3, v14
    v_add3_u32 v5, v14, s52, 8
    v_lshlrev_b32 v14, 1, v3
    v_sub_u32 v14, v4, v14
    v_lshlrev_b32 v14, 4, v14
    s_add_u32 s8, s53, 480
    v_add_u32 v6, s8, v14
    v_lshl_add_u32 v14, v3, 2, v4
    s_mul_i32 s8, s12, 4160
    s_add_u32 s8, s8, 83960
    v_lshlrev_b32 v14, 3, v14
    v_sub_u32 v7, s8, v14
    s_setprio 3
    s_mov_b32 s9, 0
SP_22:
    ds_read_b32 v10, v1 offset:80
    s_waitcnt lgkmcnt(0)
    v_readfirstlane_b32 s8, v10
    s_add_u32 s9, s9, 1
    s_cmp_ge_u32 s8, 1
    s_cbranch_scc1 SP_22_D
    s_sleep 1
    s_cmp_lt_u32 s9, 524288
    s_cbranch_scc1 SP_22
SP_22_D:
    s_setprio 3
    s_mov_b32 s9, 0
SP_23:
    ds_read_b32 v10, v9 offset:48
    s_waitcnt lgkmcnt(0)
    v_readfirstlane_b32 s8, v10
    s_add_u32 s9, s9, 1
    s_cmp_lg_u32 s8, 0
    s_cbranch_scc1 SP_23_D
    s_cmp_lt_u32 s9, 524288
    s_cbranch_scc1 SP_23
SP_23_D:
    s_setprio 2
    v_subrev_u32 v8, 18432, v8
    v_cmp_eq_u32 vcc, 0, v2
    v_mov_b32 v13, 96
    s_nop 0
    v_cndmask_b32 v12, 0, 1, vcc
    v_lshlrev_b32 v14, 2, v2
    v_add_u32 v14, 105216, v14
    v_cndmask_b32 v13, v14, v13, vcc
    ds_read_b64 v[40:41], v5 offset:0
    ds_read_b64 v[42:43], v5 offset:8
    ds_read_b128 v[104:107], v6 offset:3584
    ds_read_b64 v[72:73], v5 offset:512
    ds_read_b64 v[74:75], v5 offset:520
    ds_read_b128 v[108:111], v6 offset:3648
    ds_read_b64 v[44:45], v5 offset:64
    ds_read_b64 v[46:47], v5 offset:72
    ds_read_b64 v[76:77], v5 offset:576
    ds_read_b64 v[78:79], v5 offset:584
    ds_read_b128 v[112:115], v6 offset:3712
    ds_read_b128 v[116:119], v6 offset:3776
    s_waitcnt lgkmcnt(9)
    v_mfma_f32_16x16x32_bf16 v[16:19], v[40:43], v[104:107], 0
    ds_read_b64 v[48:49], v5 offset:128
    ds_read_b64 v[50:51], v5 offset:136
    s_waitcnt lgkmcnt(9)
    v_mfma_f32_16x16x32_bf16 v[20:23], v[72:75], v[104:107], 0
    ds_read_b128 v[120:123], v6 offset:3840
    ds_read_b64 v[80:81], v5 offset:640
    ds_read_b64 v[82:83], v5 offset:648
    s_waitcnt lgkmcnt(9)
    v_mfma_f32_16x16x32_bf16 v[16:19], v[44:47], v[108:111], v[16:19]
    ds_read_b64 v[52:53], v5 offset:192
    ds_read_b64 v[54:55], v5 offset:200
    s_waitcnt lgkmcnt(9)
    v_mfma_f32_16x16x32_bf16 v[20:23], v[76:79], v[108:111], v[20:23]
    ds_read_b128 v[124:127], v6 offset:3904
    ds_read_b64 v[84:85], v5 offset:704
    ds_read_b64 v[86:87], v5 offset:712
    s_waitcnt lgkmcnt(8)
    v_mfma_f32_16x16x32_bf16 v[16:19], v[48:51], v[112:115], v[16:19]
    ds_read_b64 v[56:57], v5 offset:256
    ds_read_b64 v[58:59], v5 offset:264
    s_waitcnt lgkmcnt(7)
    v_mfma_f32_16x16x32_bf16 v[20:23], v[80:83], v[112:115], v[20:23]
    ds_read_b128 v[104:107], v6 offset:3968
    ds_read_b64 v[88:89], v5 offset:768
    ds_read_b64 v[90:91], v5 offset:776
    s_waitcnt lgkmcnt(8)
    v_mfma_f32_16x16x32_bf16 v[16:19], v[52:55], v[116:119], v[16:19]
    ds_read_b64 v[60:61], v5 offset:320
    ds_read_b64 v[62:63], v5 offset:328
    s_waitcnt lgkmcnt(7)
    v_mfma_f32_16x16x32_bf16 v[20:23], v[84:87], v[116:119], v[20:23]
    ds_read_b128 v[108:111], v6 offset:4032
    ds_read_b64 v[92:93], v5 offset:832
    ds_read_b64 v[94:95], v5 offset:840
    s_waitcnt lgkmcnt(8)
    v_mfma_f32_16x16x32_bf16 v[16:19], v[56:59], v[120:123], v[16:19]
    ds_read_b64 v[64:65], v5 offset:384
    ds_read_b64 v[66:67], v5 offset:392
    ds_read_b32 v28, v1 offset:80
    ds_read_b32 v29, v9 offset:32
    s_waitcnt lgkmcnt(9)
    v_mfma_f32_16x16x32_bf16 v[20:23], v[88:91], v[120:123], v[20:23]
    ds_read_b128 v[112:115], v6 offset:3072
    ds_read_b64 v[96:97], v5 offset:896
    ds_read_b64 v[98:99], v5 offset:904
    s_waitcnt lgkmcnt(10)
    v_mfma_f32_16x16x32_bf16 v[16:19], v[60:63], v[124:127], v[16:19]
    ds_read_b64 v[68:69], v5 offset:448
    ds_read_b64 v[70:71], v5 offset:456
    s_waitcnt lgkmcnt(9)
    v_mfma_f32_16x16x32_bf16 v[20:23], v[92:95], v[124:127], v[20:23]
    ds_read_b128 v[116:119], v6 offset:3136
    ds_read_b64 v[100:101], v5 offset:960
    ds_read_b64 v[102:103], v5 offset:968
    s_waitcnt lgkmcnt(10)
    v_mfma_f32_16x16x32_bf16 v[16:19], v[64:67], v[104:107], v[16:19]
    s_waitcnt lgkmcnt(5)
    v_mfma_f32_16x16x32_bf16 v[20:23], v[96:99], v[104:107], v[20:23]
    ds_read_b128 v[120:123], v6 offset:3200
    v_readfirstlane_b32 s9, v29
    s_waitcnt lgkmcnt(4)
    v_mfma_f32_16x16x32_bf16 v[16:19], v[68:71], v[108:111], v[16:19]
    v_readfirstlane_b32 s8, v28
    s_add_u32 s9, s9, 2
    s_waitcnt lgkmcnt(1)
    v_mfma_f32_16x16x32_bf16 v[20:23], v[100:103], v[108:111], v[20:23]
    ds_read_b128 v[124:127], v6 offset:3264
    s_cmp_lt_u32 s8, 2
    s_cbranch_scc1 C_SLOW0
KEEP_P0:
    v_mfma_f32_16x16x32_bf16 v[20:23], v[40:43], v[112:115], v[20:23]
    v_mfma_f32_16x16x32_bf16 v[24:27], v[72:75], v[112:115], 0
    ds_read_b128 v[104:107], v6 offset:3328
    v_mfma_f32_16x16x32_bf16 v[20:23], v[44:47], v[116:119], v[20:23]
    v_mfma_f32_16x16x32_bf16 v[24:27], v[76:79], v[116:119], v[24:27]
    ds_read_b128 v[108:111], v6 offset:3392
    s_waitcnt lgkmcnt(3)
    v_mfma_f32_16x16x32_bf16 v[20:23], v[48:51], v[120:123], v[20:23]
    v_cvt_pk_bf16_f32 v30, v19, v18
    v_cvt_pk_bf16_f32 v31, v17, v16
    v_mfma_f32_16x16x32_bf16 v[24:27], v[80:83], v[120:123], v[24:27]
    ds_read_b128 v[112:115], v6 offset:3456
    ds_write_b64 v7, v[30:31] offset:3584
    s_waitcnt lgkmcnt(4)
    v_mfma_f32_16x16x32_bf16 v[20:23], v[52:55], v[124:127], v[20:23]
    v_mfma_f32_16x16x32_bf16 v[24:27], v[84:87], v[124:127], v[24:27]
    ds_read_b128 v[116:119], v6 offset:3520
    s_waitcnt lgkmcnt(4)
    v_mfma_f32_16x16x32_bf16 v[20:23], v[56:59], v[104:107], v[20:23]
    ds_read_b32 v28, v1 offset:80
    ds_read_b32 v29, v9 offset:32
    v_mfma_f32_16x16x32_bf16 v[24:27], v[88:91], v[104:107], v[24:27]
    ds_read_b128 v[120:123], v6 offset:2560
    s_waitcnt lgkmcnt(6)
    v_mfma_f32_16x16x32_bf16 v[20:23], v[60:63], v[108:111], v[20:23]
    v_mfma_f32_16x16x32_bf16 v[24:27], v[92:95], v[108:111], v[24:27]
    ds_read_b128 v[124:127], v6 offset:2624
    s_waitcnt lgkmcnt(6)
    v_mfma_f32_16x16x32_bf16 v[20:23], v[64:67], v[112:115], v[20:23]
    v_mfma_f32_16x16x32_bf16 v[24:27], v[96:99], v[112:115], v[24:27]
    ds_read_b128 v[104:107], v6 offset:2688
    s_waitcnt lgkmcnt(3)
    v_readfirstlane_b32 s9, v29
    v_mfma_f32_16x16x32_bf16 v[20:23], v[68:71], v[116:119], v[20:23]
    v_readfirstlane_b32 s8, v28
    s_add_u32 s9, s9, 2
    v_mfma_f32_16x16x32_bf16 v[24:27], v[100:103], v[116:119], v[24:27]
    ds_read_b128 v[108:111], v6 offset:2752
    s_cmp_lt_u32 s8, 3
    s_cbranch_scc1 C_SLOW1
KEEP_P1:
    s_waitcnt lgkmcnt(3)
    v_mfma_f32_16x16x32_bf16 v[24:27], v[40:43], v[120:123], v[24:27]
    v_mfma_f32_16x16x32_bf16 v[16:19], v[72:75], v[120:123], 0
    ds_read_b128 v[112:115], v6 offset:2816
    s_waitcnt lgkmcnt(3)
    v_mfma_f32_16x16x32_bf16 v[24:27], v[44:47], v[124:127], v[24:27]
    v_mfma_f32_16x16x32_bf16 v[16:19], v[76:79], v[124:127], v[16:19]
    ds_read_b128 v[116:119], v6 offset:2880
    s_waitcnt lgkmcnt(3)
    v_mfma_f32_16x16x32_bf16 v[24:27], v[48:51], v[104:107], v[24:27]
    v_cvt_pk_bf16_f32 v30, v23, v22
    v_cvt_pk_bf16_f32 v31, v21, v20
    v_mfma_f32_16x16x32_bf16 v[16:19], v[80:83], v[104:107], v[16:19]
    ds_read_b128 v[120:123], v6 offset:2944
    ds_write_b64 v7, v[30:31] offset:3072
    ds_add_u32 v13, v12 offset:0
    s_waitcnt lgkmcnt(5)
    v_mfma_f32_16x16x32_bf16 v[24:27], v[52:55], v[108:111], v[24:27]
    v_mfma_f32_16x16x32_bf16 v[16:19], v[84:87], v[108:111], v[16:19]
    ds_read_b128 v[124:127], v6 offset:3008
    s_waitcnt lgkmcnt(5)
    v_mfma_f32_16x16x32_bf16 v[24:27], v[56:59], v[112:115], v[24:27]
    ds_read_b32 v28, v1 offset:80
    ds_read_b32 v29, v9 offset:32
    v_mfma_f32_16x16x32_bf16 v[16:19], v[88:91], v[112:115], v[16:19]
    ds_read_b128 v[104:107], v6 offset:2048
    s_waitcnt lgkmcnt(7)
    v_mfma_f32_16x16x32_bf16 v[24:27], v[60:63], v[116:119], v[24:27]
    ds_read_b128 v[32:35], v8 offset:0
    v_mfma_f32_16x16x32_bf16 v[16:19], v[92:95], v[116:119], v[16:19]
    ds_read_b128 v[108:111], v6 offset:2112
    s_waitcnt lgkmcnt(8)
    v_mfma_f32_16x16x32_bf16 v[24:27], v[64:67], v[120:123], v[24:27]
    v_mfma_f32_16x16x32_bf16 v[16:19], v[96:99], v[120:123], v[16:19]
    ds_read_b128 v[112:115], v6 offset:2176
    s_waitcnt lgkmcnt(4)
    v_readfirstlane_b32 s9, v29
    v_mfma_f32_16x16x32_bf16 v[24:27], v[68:71], v[124:127], v[24:27]
    v_readfirstlane_b32 s8, v28
    s_add_u32 s9, s9, 2
    v_mfma_f32_16x16x32_bf16 v[16:19], v[100:103], v[124:127], v[16:19]
    ds_read_b128 v[116:119], v6 offset:2240
    s_min_u32 s8, s8, s9
    s_cmp_lt_u32 s8, 4
    s_cbranch_scc1 C_SLOW2
KEEP_P2:
    s_waitcnt lgkmcnt(4)
    v_mfma_f32_16x16x32_bf16 v[16:19], v[40:43], v[104:107], v[16:19]
    v_mfma_f32_16x16x32_bf16 v[20:23], v[72:75], v[104:107], 0
    ds_read_b128 v[120:123], v6 offset:2304
    s_waitcnt lgkmcnt(3)
    v_mfma_f32_16x16x32_bf16 v[16:19], v[44:47], v[108:111], v[16:19]
    v_mfma_f32_16x16x32_bf16 v[20:23], v[76:79], v[108:111], v[20:23]
    ds_read_b128 v[124:127], v6 offset:2368
    s_waitcnt lgkmcnt(3)
    v_mfma_f32_16x16x32_bf16 v[16:19], v[48:51], v[112:115], v[16:19]
    v_add_f32 v24, v24, v32
    v_add_f32 v25, v25, v33
    v_mfma_f32_16x16x32_bf16 v[20:23], v[80:83], v[112:115], v[20:23]
    ds_read_b128 v[104:107], v6 offset:2432
    v_add_f32 v26, v26, v34
    v_add_f32 v27, v27, v35
    s_waitcnt lgkmcnt(3)
    v_mfma_f32_16x16x32_bf16 v[16:19], v[52:55], v[116:119], v[16:19]
    v_cvt_pk_bf16_f32 v30, v27, v26
    v_cvt_pk_bf16_f32 v31, v25, v24
    v_mfma_f32_16x16x32_bf16 v[20:23], v[84:87], v[116:119], v[20:23]
    ds_read_b128 v[108:111], v6 offset:2496
    ds_write_b64 v7, v[30:31] offset:2560
    s_waitcnt lgkmcnt(4)
    v_mfma_f32_16x16x32_bf16 v[16:19], v[56:59], v[120:123], v[16:19]
    ds_read_b32 v28, v1 offset:80
    ds_read_b32 v29, v9 offset:32
    v_mfma_f32_16x16x32_bf16 v[20:23], v[88:91], v[120:123], v[20:23]
    ds_read_b128 v[112:115], v6 offset:1536
    s_waitcnt lgkmcnt(6)
    v_mfma_f32_16x16x32_bf16 v[16:19], v[60:63], v[124:127], v[16:19]
    ds_read_b128 v[32:35], v8 offset:1024
    v_mfma_f32_16x16x32_bf16 v[20:23], v[92:95], v[124:127], v[20:23]
    ds_read_b128 v[116:119], v6 offset:1600
    s_waitcnt lgkmcnt(7)
    v_mfma_f32_16x16x32_bf16 v[16:19], v[64:67], v[104:107], v[16:19]
    v_mfma_f32_16x16x32_bf16 v[20:23], v[96:99], v[104:107], v[20:23]
    ds_read_b128 v[120:123], v6 offset:1664
    s_waitcnt lgkmcnt(4)
    v_readfirstlane_b32 s9, v29
    v_mfma_f32_16x16x32_bf16 v[16:19], v[68:71], v[108:111], v[16:19]
    v_readfirstlane_b32 s8, v28
    s_add_u32 s9, s9, 2
    v_mfma_f32_16x16x32_bf16 v[20:23], v[100:103], v[108:111], v[20:23]
    ds_read_b128 v[124:127], v6 offset:1728
    s_min_u32 s8, s8, s9
    s_cmp_lt_u32 s8, 5
    s_cbranch_scc1 C_SLOW3
KEEP_P3:
    s_waitcnt lgkmcnt(4)
    v_mfma_f32_16x16x32_bf16 v[20:23], v[40:43], v[112:115], v[20:23]
    v_mfma_f32_16x16x32_bf16 v[24:27], v[72:75], v[112:115], 0
    ds_read_b128 v[104:107], v6 offset:1792
    s_waitcnt lgkmcnt(3)
    v_mfma_f32_16x16x32_bf16 v[20:23], v[44:47], v[116:119], v[20:23]
    v_mfma_f32_16x16x32_bf16 v[24:27], v[76:79], v[116:119], v[24:27]
    ds_read_b128 v[108:111], v6 offset:1856
    s_waitcnt lgkmcnt(3)
    v_mfma_f32_16x16x32_bf16 v[20:23], v[48:51], v[120:123], v[20:23]
    v_add_f32 v16, v16, v32
    v_add_f32 v17, v17, v33
    v_mfma_f32_16x16x32_bf16 v[24:27], v[80:83], v[120:123], v[24:27]
    ds_read_b128 v[112:115], v6 offset:1920
    v_add_f32 v18, v18, v34
    v_add_f32 v19, v19, v35
    s_waitcnt lgkmcnt(3)
    v_mfma_f32_16x16x32_bf16 v[20:23], v[52:55], v[124:127], v[20:23]
    v_cvt_pk_bf16_f32 v30, v19, v18
    v_cvt_pk_bf16_f32 v31, v17, v16
    v_mfma_f32_16x16x32_bf16 v[24:27], v[84:87], v[124:127], v[24:27]
    ds_read_b128 v[116:119], v6 offset:1984
    ds_write_b64 v7, v[30:31] offset:2048
    ds_add_u32 v13, v12 offset:4
    s_waitcnt lgkmcnt(5)
    v_mfma_f32_16x16x32_bf16 v[20:23], v[56:59], v[104:107], v[20:23]
    ds_read_b32 v28, v1 offset:80
    ds_read_b32 v29, v9 offset:32
    v_mfma_f32_16x16x32_bf16 v[24:27], v[88:91], v[104:107], v[24:27]
    ds_read_b128 v[120:123], v6 offset:1024
    s_waitcnt lgkmcnt(7)
    v_mfma_f32_16x16x32_bf16 v[20:23], v[60:63], v[108:111], v[20:23]
    ds_read_b128 v[32:35], v8 offset:2048
    v_mfma_f32_16x16x32_bf16 v[24:27], v[92:95], v[108:111], v[24:27]
    ds_read_b128 v[124:127], v6 offset:1088
    s_waitcnt lgkmcnt(8)
    v_mfma_f32_16x16x32_bf16 v[20:23], v[64:67], v[112:115], v[20:23]
    v_mfma_f32_16x16x32_bf16 v[24:27], v[96:99], v[112:115], v[24:27]
    ds_read_b128 v[104:107], v6 offset:1152
    s_waitcnt lgkmcnt(4)
    v_readfirstlane_b32 s9, v29
    v_mfma_f32_16x16x32_bf16 v[20:23], v[68:71], v[116:119], v[20:23]
    v_readfirstlane_b32 s8, v28
    s_add_u32 s9, s9, 2
    v_mfma_f32_16x16x32_bf16 v[24:27], v[100:103], v[116:119], v[24:27]
    ds_read_b128 v[108:111], v6 offset:1216
    s_min_u32 s8, s8, s9
    s_cmp_lt_u32 s8, 6
    s_cbranch_scc1 C_SLOW4
KEEP_P4:
    s_waitcnt lgkmcnt(4)
    v_mfma_f32_16x16x32_bf16 v[24:27], v[40:43], v[120:123], v[24:27]
    v_mfma_f32_16x16x32_bf16 v[16:19], v[72:75], v[120:123], 0
    ds_read_b128 v[112:115], v6 offset:1280
    s_waitcnt lgkmcnt(3)
    v_mfma_f32_16x16x32_bf16 v[24:27], v[44:47], v[124:127], v[24:27]
    v_mfma_f32_16x16x32_bf16 v[16:19], v[76:79], v[124:127], v[16:19]
    ds_read_b128 v[116:119], v6 offset:1344
    s_waitcnt lgkmcnt(3)
    v_mfma_f32_16x16x32_bf16 v[24:27], v[48:51], v[104:107], v[24:27]
    v_add_f32 v20, v20, v32
    v_add_f32 v21, v21, v33
    v_mfma_f32_16x16x32_bf16 v[16:19], v[80:83], v[104:107], v[16:19]
    ds_read_b128 v[120:123], v6 offset:1408
    v_add_f32 v22, v22, v34
    v_add_f32 v23, v23, v35
    s_waitcnt lgkmcnt(3)
    v_mfma_f32_16x16x32_bf16 v[24:27], v[52:55], v[108:111], v[24:27]
    v_cvt_pk_bf16_f32 v30, v23, v22
    v_cvt_pk_bf16_f32 v31, v21, v20
    v_mfma_f32_16x16x32_bf16 v[16:19], v[84:87], v[108:111], v[16:19]
    ds_read_b128 v[124:127], v6 offset:1472
    ds_write_b64 v7, v[30:31] offset:1536
    s_waitcnt lgkmcnt(4)
    v_mfma_f32_16x16x32_bf16 v[24:27], v[56:59], v[112:115], v[24:27]
    ds_read_b32 v28, v1 offset:80
    ds_read_b32 v29, v9 offset:32
    v_mfma_f32_16x16x32_bf16 v[16:19], v[88:91], v[112:115], v[16:19]
    ds_read_b128 v[104:107], v6 offset:512
    s_waitcnt lgkmcnt(6)
    v_mfma_f32_16x16x32_bf16 v[24:27], v[60:63], v[116:119], v[24:27]
    ds_read_b128 v[32:35], v8 offset:3072
    v_mfma_f32_16x16x32_bf16 v[16:19], v[92:95], v[116:119], v[16:19]
    ds_read_b128 v[108:111], v6 offset:576
    s_waitcnt lgkmcnt(7)
    v_mfma_f32_16x16x32_bf16 v[24:27], v[64:67], v[120:123], v[24:27]
    v_mfma_f32_16x16x32_bf16 v[16:19], v[96:99], v[120:123], v[16:19]
    ds_read_b128 v[112:115], v6 offset:640
    s_waitcnt lgkmcnt(4)
    v_readfirstlane_b32 s9, v29
    v_mfma_f32_16x16x32_bf16 v[24:27], v[68:71], v[124:127], v[24:27]
    v_readfirstlane_b32 s8, v28
    s_add_u32 s9, s9, 2
    v_mfma_f32_16x16x32_bf16 v[16:19], v[100:103], v[124:127], v[16:19]
    ds_read_b128 v[116:119], v6 offset:704
    s_min_u32 s8, s8, s9
    s_cmp_lt_u32 s8, 7
    s_cbranch_scc1 C_SLOW5
KEEP_P5:
    s_waitcnt lgkmcnt(4)
    v_mfma_f32_16x16x32_bf16 v[16:19], v[40:43], v[104:107], v[16:19]
    v_mfma_f32_16x16x32_bf16 v[20:23], v[72:75], v[104:107], 0
    ds_read_b128 v[120:123], v6 offset:768
    s_waitcnt lgkmcnt(3)
    v_mfma_f32_16x16x32_bf16 v[16:19], v[44:47], v[108:111], v[16:19]
    v_mfma_f32_16x16x32_bf16 v[20:23], v[76:79], v[108:111], v[20:23]
    ds_read_b128 v[124:127], v6 offset:832
    s_waitcnt lgkmcnt(3)
    v_mfma_f32_16x16x32_bf16 v[16:19], v[48:51], v[112:115], v[16:19]
    v_add_f32 v24, v24, v32
    v_add_f32 v25, v25, v33
    v_mfma_f32_16x16x32_bf16 v[20:23], v[80:83], v[112:115], v[20:23]
    ds_read_b128 v[104:107], v6 offset:896
    v_add_f32 v26, v26, v34
    v_add_f32 v27, v27, v35
    s_waitcnt lgkmcnt(3)
    v_mfma_f32_16x16x32_bf16 v[16:19], v[52:55], v[116:119], v[16:19]
    v_cvt_pk_bf16_f32 v30, v27, v26
    v_cvt_pk_bf16_f32 v31, v25, v24
    v_mfma_f32_16x16x32_bf16 v[20:23], v[84:87], v[116:119], v[20:23]
    ds_read_b128 v[108:111], v6 offset:960
    ds_write_b64 v7, v[30:31] offset:1024
    ds_add_u32 v13, v12 offset:8
    s_waitcnt lgkmcnt(5)
    v_mfma_f32_16x16x32_bf16 v[16:19], v[56:59], v[120:123], v[16:19]
    ds_read_b32 v28, v1 offset:80
    ds_read_b32 v29, v9 offset:32
    v_mfma_f32_16x16x32_bf16 v[20:23], v[88:91], v[120:123], v[20:23]
    ds_read_b128 v[112:115], v6 offset:0
    s_waitcnt lgkmcnt(7)
    v_mfma_f32_16x16x32_bf16 v[16:19], v[60:63], v[124:127], v[16:19]
    ds_read_b128 v[32:35], v8 offset:18432
    v_mfma_f32_16x16x32_bf16 v[20:23], v[92:95], v[124:127], v[20:23]
    ds_read_b128 v[116:119], v6 offset:64
    s_waitcnt lgkmcnt(8)
    v_mfma_f32_16x16x32_bf16 v[16:19], v[64:67], v[104:107], v[16:19]
    v_mfma_f32_16x16x32_bf16 v[20:23], v[96:99], v[104:107], v[20:23]
    ds_read_b128 v[120:123], v6 offset:128
    s_waitcnt lgkmcnt(4)
    v_readfirstlane_b32 s9, v29
    v_mfma_f32_16x16x32_bf16 v[16:19], v[68:71], v[108:111], v[16:19]
    v_readfirstlane_b32 s8, v28
    s_add_u32 s9, s9, 2
    v_mfma_f32_16x16x32_bf16 v[20:23], v[100:103], v[108:111], v[20:23]
    ds_read_b128 v[124:127], v6 offset:192
    s_min_u32 s8, s8, s9
    s_cmp_lt_u32 s8, 8
    s_cbranch_scc1 C_SLOW6
KEEP_P6:
    s_waitcnt lgkmcnt(4)
    v_mfma_f32_16x16x32_bf16 v[20:23], v[40:43], v[112:115], v[20:23]
    ds_read_b128 v[104:107], v6 offset:256
    s_waitcnt lgkmcnt(3)
    v_mfma_f32_16x16x32_bf16 v[20:23], v[44:47], v[116:119], v[20:23]
    ds_read_b128 v[108:111], v6 offset:320
    s_waitcnt lgkmcnt(3)
    v_mfma_f32_16x16x32_bf16 v[20:23], v[48:51], v[120:123], v[20:23]
    v_add_f32 v16, v16, v32
    v_add_f32 v17, v17, v33
    ds_read_b128 v[112:115], v6 offset:384
    v_add_f32 v18, v18, v34
    v_add_f32 v19, v19, v35
    s_waitcnt lgkmcnt(3)
    v_mfma_f32_16x16x32_bf16 v[20:23], v[52:55], v[124:127], v[20:23]
    v_cvt_pk_bf16_f32 v30, v19, v18
    v_cvt_pk_bf16_f32 v31, v17, v16
    ds_read_b128 v[116:119], v6 offset:448
    ds_write_b64 v7, v[30:31] offset:512
    ds_add_u32 v13, v12 offset:12
    s_waitcnt lgkmcnt(5)
    v_mfma_f32_16x16x32_bf16 v[20:23], v[56:59], v[104:107], v[20:23]
    ds_read_b32 v28, v1 offset:80
    ds_read_b32 v29, v9 offset:32
    s_waitcnt lgkmcnt(6)
    v_mfma_f32_16x16x32_bf16 v[20:23], v[60:63], v[108:111], v[20:23]
    ds_read_b128 v[32:35], v8 offset:19456
    s_waitcnt lgkmcnt(6)
    v_mfma_f32_16x16x32_bf16 v[20:23], v[64:67], v[112:115], v[20:23]
    s_waitcnt lgkmcnt(1)
    v_readfirstlane_b32 s9, v29
    v_mfma_f32_16x16x32_bf16 v[20:23], v[68:71], v[116:119], v[20:23]
    v_readfirstlane_b32 s8, v28
    s_add_u32 s9, s9, 2
    s_cmp_lt_u32 s9, 9
    s_cbranch_scc1 C_SLOW7
KEEP_P7:
    s_waitcnt lgkmcnt(0)
    s_nop 2
    v_add_f32 v20, v20, v32
    v_add_f32 v21, v21, v33
    v_add_f32 v22, v22, v34
    v_add_f32 v23, v23, v35
    v_cvt_pk_bf16_f32 v30, v23, v22
    v_cvt_pk_bf16_f32 v31, v21, v20
    ds_write_b64 v7, v[30:31] offset:0
    ds_add_u32 v13, v12 offset:16
    ds_read_b32 v10, v1 offset:8
    s_cmp_eq_u32 s3, 4
    s_cbranch_scc1 C_FIN
    s_endpgm
C_SLOW0:
    s_mov_b32 s9, 0
SP_24:
    ds_read_b32 v28, v1 offset:80
    s_waitcnt lgkmcnt(0)
    v_readfirstlane_b32 s8, v28
    s_add_u32 s9, s9, 1
    s_cmp_ge_u32 s8, 2
    s_cbranch_scc1 SP_24_D
    s_cmp_lt_u32 s9, 524288
    s_cbranch_scc1 SP_24
SP_24_D:
    ds_read_b128 v[112:115], v6 offset:3072
    ds_read_b128 v[116:119], v6 offset:3136
    ds_read_b128 v[120:123], v6 offset:3200
    ds_read_b128 v[124:127], v6 offset:3264
    s_waitcnt lgkmcnt(0)
    s_branch KEEP_P0
C_SLOW1:
    s_mov_b32 s9, 0
SP_25:
    ds_read_b32 v28, v1 offset:80
    s_waitcnt lgkmcnt(0)
    v_readfirstlane_b32 s8, v28
    s_add_u32 s9, s9, 1
    s_cmp_ge_u32 s8, 3
    s_cbranch_scc1 SP_25_D
    s_cmp_lt_u32 s9, 524288
    s_cbranch_scc1 SP_25
SP_25_D:
    ds_read_b128 v[120:123], v6 offset:2560
    ds_read_b128 v[124:127], v6 offset:2624
    ds_read_b128 v[104:107], v6 offset:2688
    ds_read_b128 v[108:111], v6 offset:2752
    s_waitcnt lgkmcnt(0)
    s_branch KEEP_P1
C_SLOW2:
    s_mov_b32 s9, 0
SP_26:
    ds_read_b32 v28, v1 offset:80
    s_waitcnt lgkmcnt(0)
    v_readfirstlane_b32 s8, v28
    s_add_u32 s9, s9, 1
    s_cmp_ge_u32 s8, 4
    s_cbranch_scc1 SP_26_D
    s_cmp_lt_u32 s9, 524288
    s_cbranch_scc1 SP_26
SP_26_D:
    s_mov_b32 s9, 0
SP_27:
    ds_read_b32 v28, v9 offset:32
    s_waitcnt lgkmcnt(0)
    v_readfirstlane_b32 s8, v28
    s_add_u32 s9, s9, 1
    s_cmp_ge_u32 s8, 2
    s_cbranch_scc1 SP_27_D
    s_cmp_lt_u32 s9, 524288
    s_cbranch_scc1 SP_27
SP_27_D:
    ds_read_b128 v[32:35], v8 offset:0
    ds_read_b128 v[104:107], v6 offset:2048
    ds_read_b128 v[108:111], v6 offset:2112
    ds_read_b128 v[112:115], v6 offset:2176
    ds_read_b128 v[116:119], v6 offset:2240
    s_waitcnt lgkmcnt(0)
    s_branch KEEP_P2
C_SLOW3:
    s_mov_b32 s9, 0
SP_28:
    ds_read_b32 v28, v1 offset:80
    s_waitcnt lgkmcnt(0)
    v_readfirstlane_b32 s8, v28
    s_add_u32 s9, s9, 1
    s_cmp_ge_u32 s8, 5
    s_cbranch_scc1 SP_28_D
    s_cmp_lt_u32 s9, 524288
    s_cbranch_scc1 SP_28
SP_28_D:
    s_mov_b32 s9, 0
SP_29:
    ds_read_b32 v28, v9 offset:32
    s_waitcnt lgkmcnt(0)
    v_readfirstlane_b32 s8, v28
    s_add_u32 s9, s9, 1
    s_cmp_ge_u32 s8, 3
    s_cbranch_scc1 SP_29_D
    s_cmp_lt_u32 s9, 524288
    s_cbranch_scc1 SP_29
SP_29_D:
    ds_read_b128 v[32:35], v8 offset:1024
    ds_read_b128 v[112:115], v6 offset:1536
    ds_read_b128 v[116:119], v6 offset:1600
    ds_read_b128 v[120:123], v6 offset:1664
    ds_read_b128 v[124:127], v6 offset:1728
    s_waitcnt lgkmcnt(0)
    s_branch KEEP_P3
C_SLOW4:
    s_mov_b32 s9, 0
SP_30:
    ds_read_b32 v28, v1 offset:80
    s_waitcnt lgkmcnt(0)
    v_readfirstlane_b32 s8, v28
    s_add_u32 s9, s9, 1
    s_cmp_ge_u32 s8, 6
    s_cbranch_scc1 SP_30_D
    s_cmp_lt_u32 s9, 524288
    s_cbranch_scc1 SP_30
SP_30_D:
    s_mov_b32 s9, 0
SP_31:
    ds_read_b32 v28, v9 offset:32
    s_waitcnt lgkmcnt(0)
    v_readfirstlane_b32 s8, v28
    s_add_u32 s9, s9, 1
    s_cmp_ge_u32 s8, 4
    s_cbranch_scc1 SP_31_D
    s_cmp_lt_u32 s9, 524288
    s_cbranch_scc1 SP_31
SP_31_D:
    ds_read_b128 v[32:35], v8 offset:2048
    ds_read_b128 v[120:123], v6 offset:1024
    ds_read_b128 v[124:127], v6 offset:1088
    ds_read_b128 v[104:107], v6 offset:1152
    ds_read_b128 v[108:111], v6 offset:1216
    s_waitcnt lgkmcnt(0)
    s_branch KEEP_P4
C_SLOW5:
    s_mov_b32 s9, 0
SP_32:
    ds_read_b32 v28, v1 offset:80
    s_waitcnt lgkmcnt(0)
    v_readfirstlane_b32 s8, v28
    s_add_u32 s9, s9, 1
    s_cmp_ge_u32 s8, 7
    s_cbranch_scc1 SP_32_D
    s_cmp_lt_u32 s9, 524288
    s_cbranch_scc1 SP_32
SP_32_D:
    s_mov_b32 s9, 0
SP_33:
    ds_read_b32 v28, v9 offset:32
    s_waitcnt lgkmcnt(0)
    v_readfirstlane_b32 s8, v28
    s_add_u32 s9, s9, 1
    s_cmp_ge_u32 s8, 5
    s_cbranch_scc1 SP_33_D
    s_cmp_lt_u32 s9, 524288
    s_cbranch_scc1 SP_33
SP_33_D:
    ds_read_b128 v[32:35], v8 offset:3072
    ds_read_b128 v[104:107], v6 offset:512
    ds_read_b128 v[108:111], v6 offset:576
    ds_read_b128 v[112:115], v6 offset:640
    ds_read_b128 v[116:119], v6 offset:704
    s_waitcnt lgkmcnt(0)
    s_branch KEEP_P5
C_SLOW6:
    s_mov_b32 s9, 0
SP_34:
    ds_read_b32 v28, v1 offset:80
    s_waitcnt lgkmcnt(0)
    v_readfirstlane_b32 s8, v28
    s_add_u32 s9, s9, 1
    s_cmp_ge_u32 s8, 8
    s_cbranch_scc1 SP_34_D
    s_cmp_lt_u32 s9, 524288
    s_cbranch_scc1 SP_34
SP_34_D:
    s_mov_b32 s9, 0
SP_35:
    ds_read_b32 v28, v9 offset:32
    s_waitcnt lgkmcnt(0)
    v_readfirstlane_b32 s8, v28
    s_add_u32 s9, s9, 1
    s_cmp_ge_u32 s8, 6
    s_cbranch_scc1 SP_35_D
    s_cmp_lt_u32 s9, 524288
    s_cbranch_scc1 SP_35
SP_35_D:
    ds_read_b128 v[32:35], v8 offset:18432
    ds_read_b128 v[112:115], v6 offset:0
    ds_read_b128 v[116:119], v6 offset:64
    ds_read_b128 v[120:123], v6 offset:128
    ds_read_b128 v[124:127], v6 offset:192
    s_waitcnt lgkmcnt(0)
    s_branch KEEP_P6
C_SLOW7:
    s_mov_b32 s9, 0
SP_36:
    ds_read_b32 v28, v9 offset:32
    s_waitcnt lgkmcnt(0)
    v_readfirstlane_b32 s8, v28
    s_add_u32 s9, s9, 1
    s_cmp_ge_u32 s8, 7
    s_cbranch_scc1 SP_36_D
    s_cmp_lt_u32 s9, 524288
    s_cbranch_scc1 SP_36
SP_36_D:
    ds_read_b128 v[32:35], v8 offset:19456
    s_waitcnt lgkmcnt(0)
    s_branch KEEP_P7
C_KA:
    s_setprio 1
    v_and_b32 v14, 3, v3
    v_sub_u32 v14, 3, v14
    v_mul_u32_u24 v14, 1216, v14
    v_lshrrev_b32 v13, 2, v3
    v_lshl_add_u32 v13, v4, 1, v13
    v_lshl_add_u32 v14, v13, 3, v14
    v_add3_u32 v5, v14, s52, 8
    v_lshlrev_b32 v14, 1, v3
    v_sub_u32 v14, v4, v14
    v_lshlrev_b32 v14, 4, v14
    s_add_u32 s8, s53, 480
    v_add_u32 v6, s8, v14
    v_lshl_add_u32 v14, v3, 2, v4
    s_mul_i32 s8, s12, 4160
    s_add_u32 s8, s8, 83960
    v_lshlrev_b32 v14, 3, v14
    v_sub_u32 v7, s8, v14
    v_lshrrev_b32 v11, 1, v4
    v_and_b32 v12, 1, v4
    v_lshlrev_b32 v11, 8, v11
    v_lshl_add_u32 v11, v12, 3, v11
    v_lshl_add_u32 v11, v3, 4, v11
    v_add_u32 v11, s15, v11
    v_cmp_gt_u32 vcc, 2, v4
    v_lshlrev_b32 v12, 2, v3
    v_lshlrev_b32 v13, 3, v3
    v_cndmask_b32 v12, v12, v13, vcc
    v_lshl_add_u32 v12, v4, 7, v12
    v_add_u32 v12, s15, v12
    v_mov_b32 v13, 64
    v_cndmask_b32 v13, v13, 4, vcc
    v_add_u32 v13, v13, v12
    v_lshlrev_b32 v14, 1, v3
    v_lshl_add_u32 v14, v4, 7, v14
    v_add_u32 v14, s15, v14
    v_lshlrev_b32 v15, 4, v2
    v_lshlrev_b32 v16, 3, v2
    v_add_u32 v16, 256, v16
    v_min_u32 v15, v15, v16
    v_add_u32 v15, s15, v15
    v_min_u32 v16, 15, v2
    v_lshl_add_u32 v16, v16, 2, s15
    v_lshrrev_b32 v26, 5, v2
    v_lshlrev_b32 v26, 8, v26
    v_lshl_add_u32 v26, v2, 2, v26
    v_add_u32 v26, s15, v26
    v_lshlrev_b32 v17, 2, v4
    v_sub_u32 v17, v3, v17
    v_lshl_add_u32 v27, v17, 3, s15
    v_add_u32 v27, 3176, v27
    v_lshl_add_u32 v17, v17, 2, s15
    v_add_u32 v17, 2100, v17
    v_lshl_add_u32 v19, v2, 4, s52
    s_mov_b32 s56, 0x01000100
    s_mov_b32 s57, 0x03020302
    s_lshl_b32 s8, s12, 4
    s_lshr_b64 s[68:69], s[68:69], s8
    s_lshl_b32 s68, s68, 16
    s_sub_u32 s58, 254, s54
    s_lshl_b32 s58, s58, 23
    v_mul_f32 v104, s58, v104
    v_mul_f32 v105, s58, v105
    v_mul_f32 v106, s58, v106
    v_mul_f32 v107, s58, v107
    v_mul_f32 v108, s58, v108
    v_mul_f32 v109, s58, v109
    v_mul_f32 v110, s58, v110
    v_mul_f32 v111, s58, v111
    v_mul_f32 v112, s58, v112
    v_mul_f32 v113, s58, v113
    v_mul_f32 v114, s58, v114
    v_mul_f32 v115, s58, v115
    s_mov_b64 exec, 1
    v_add_f32 v104, s68, v104
    s_mov_b64 exec, -1
    v_mov_b32 v75, 0
    v_mov_b32 v79, 0
    v_mov_b32 v82, 0
    v_mov_b32 v83, 0
    v_mov_b32 v86, 0
    v_mov_b32 v87, 0
    v_lshlrev_b32 v28, 4, v2
    v_add_u32 v28, 100096, v28
    s_mov_b32 s9, 0
SP_37:
    ds_read_b32 v18, v1 offset:32
    s_waitcnt lgkmcnt(0)
    v_readfirstlane_b32 s8, v18
    s_add_u32 s9, s9, 1
    s_cmp_ge_u32 s8, 2
    s_cbranch_scc1 SP_37_D
    s_cmp_lt_u32 s9, 524288
    s_cbranch_scc1 SP_37
SP_37_D:
    ds_read_b128 v[116:119], v28 offset:2048
    ds_read_b128 v[120:123], v28 offset:3072
    ds_read_b128 v[124:127], v28 offset:4096
    s_setprio 0
    s_mov_b32 s9, 0
SP_38:
    ds_read_b32 v18, v9
    s_waitcnt lgkmcnt(0)
    v_readfirstlane_b32 s8, v18
    s_add_u32 s9, s9, 1
    s_cmp_lg_u32 s8, 0
    s_cbranch_scc1 SP_38_D
    s_cmp_lt_u32 s9, 524288
    s_cbranch_scc1 SP_38
SP_38_D:
    s_setprio 2
    s_sub_u32 s60, 254, s8
    s_lshl_b32 s60, s60, 23
    ds_read_b128 v[88:91], v8 offset:18432
    ds_read_b128 v[92:95], v8 offset:19456
    ds_read_b128 v[96:99], v8 offset:20480
    s_waitcnt lgkmcnt(2)
    v_pk_fma_f32 v[104:105], v[88:89], s[60:61], v[104:105] op_sel_hi:[1,0,1]
    v_cvt_pk_bf16_f32 v20, v104, v105
    v_pk_fma_f32 v[106:107], v[90:91], s[60:61], v[106:107] op_sel_hi:[1,0,1]
    v_cvt_pk_bf16_f32 v21, v106, v107
    ds_write_b64 v11, v[20:21]
    s_waitcnt lgkmcnt(2)
    v_pk_fma_f32 v[108:109], v[92:93], s[60:61], v[108:109] op_sel_hi:[1,0,1]
    v_cvt_pk_bf16_f32 v22, v108, v109
    v_pk_fma_f32 v[110:111], v[94:95], s[60:61], v[110:111] op_sel_hi:[1,0,1]
    v_cvt_pk_bf16_f32 v23, v110, v111
    ds_write_b32 v12, v22 offset:512
    ds_write_b32 v13, v23 offset:512
    ds_read_b64 v[32:33], v15 offset:0
    ds_read_b64 v[34:35], v15 offset:8
    s_waitcnt lgkmcnt(5)
    v_pk_fma_f32 v[112:113], v[96:97], s[60:61], v[112:113] op_sel_hi:[1,0,1]
    v_cvt_pk_bf16_f32 v24, v112, v113
    v_pk_fma_f32 v[114:115], v[98:99], s[60:61], v[114:115] op_sel_hi:[1,0,1]
    v_cvt_pk_bf16_f32 v25, v114, v115
    s_mov_b32 exec_lo, 0
    s_waitcnt lgkmcnt(0)
    v_alignbit_b32 v35, v34, v33, 16
    v_perm_b32 v34, v33, v33, s56
    v_alignbit_b32 v33, v33, v32, 16
    v_perm_b32 v32, v32, v32, s56
    s_mov_b32 exec_lo, -1
    ds_write_b128 v19, v[32:35] offset:32
    v_mov_b32_dpp v30, v34 wave_shr:1 row_mask:0xf bank_mask:0xf bound_ctrl:0
    v_mov_b32_dpp v31, v35 wave_shr:1 row_mask:0xf bank_mask:0xf bound_ctrl:0
    v_alignbit_b32 v44, v32, v31, 16
    v_alignbit_b32 v45, v33, v32, 16
    v_alignbit_b32 v46, v34, v33, 16
    v_alignbit_b32 v47, v35, v34, 16
    ds_write_b128 v19, v[44:47] offset:1248
    v_mov_b32 v52, v31
    v_mov_b32 v53, v32
    v_mov_b32 v54, v33
    v_mov_b32 v55, v34
    ds_write_b128 v19, v[52:55] offset:2464
    v_alignbit_b32 v60, v31, v30, 16
    v_alignbit_b32 v61, v32, v31, 16
    v_alignbit_b32 v62, v33, v32, 16
    v_alignbit_b32 v63, v34, v33, 16
    ds_write_b128 v19, v[60:63] offset:3680
    v_mov_b32 v10, 1
    ds_write_b32 v9, v10 offset:48
    s_setprio 3
    v_perm_b32 v73, v35, v35, s57
    v_alignbit_b32 v72, v35, v34, 16
    v_lshrrev_b32 v78, 16, v35
    v_mov_b32 v76, v35
    v_mov_b32 v74, v73
    v_mov_b32 v77, v73
    v_mov_b32 v80, v73
    v_mov_b32 v81, v73
    v_mov_b32 v84, v73
    v_mov_b32 v85, v78
    s_mov_b32 exec_lo, 0
    ds_write_b16 v12, v22 offset:2942
    ds_write_b16_d16_hi v12, v22 offset:2944
    ds_write_b16 v13, v23 offset:2942
    ds_write_b16_d16_hi v13, v23 offset:2944
    s_mov_b32 exec_hi, 0x80000000
    ds_write_b128 v19, v[84:87] offset:48
    ds_write_b128 v19, v[80:83] offset:1264
    ds_write_b128 v19, v[76:79] offset:2480
    ds_write_b128 v19, v[72:75] offset:3696
    s_mov_b64 exec, 1
    ds_write_b16 v14, v24 offset:3454
    s_mov_b64 exec, -1
    ds_write_b32 v26, v1 offset:3072
    ds_write_b16 v14, v24 offset:2110
    ds_write_b16_d16_hi v14, v24 offset:2142
    ds_write_b16 v14, v25 offset:2174
    ds_write_b16_d16_hi v14, v25 offset:2206
    ds_write_b32 v16, v1 offset:2048
    v_readlane_b32 s59, v24, 0
    v_mov_b32 v11, v27
    v_mov_b32 v12, v17
    v_mov_b32 v13, v28
    s_pack_ll_b32_b16 s59, s59, s59
    s_mov_b32 s9, 0
SP_39:
    ds_read_b32 v10, v1 offset:80
    s_waitcnt lgkmcnt(0)
    v_readfirstlane_b32 s8, v10
    s_add_u32 s9, s9, 1
    s_cmp_ge_u32 s8, 2
    s_cbranch_scc1 SP_39_D
    s_sleep 1
    s_cmp_lt_u32 s9, 524288
    s_cbranch_scc1 SP_39
SP_39_D:
    s_setprio 1
    ds_read_b128 v[40:43], v6 offset:3584
    ds_read_b128 v[44:47], v6 offset:3600
    ds_read_b128 v[48:51], v6 offset:3072
    ds_read_b128 v[52:55], v6 offset:3088
    ds_read_b64 v[112:113], v5 offset:1024
    ds_read_b64 v[114:115], v5 offset:1032
    ds_read2_b32 v[128:129], v11 offset0:6 offset1:4
    ds_read2_b32 v[130:131], v11 offset0:2 offset1:0
    ds_read2_b32 v[132:133], v11 offset0:7 offset1:5
    ds_read2_b32 v[134:135], v11 offset0:3 offset1:1
    v_and_b32 v124, s59, v124
    v_and_b32 v125, s59, v125
    v_and_b32 v126, s59, v126
    v_and_b32 v127, s59, v127
    s_waitcnt lgkmcnt(9)
    v_mfma_f32_16x16x32_bf16 v[56:59], v[40:43], v[116:119], 0
    ds_read2_b32 v[136:137], v11 offset0:38 offset1:36
    v_mfma_f32_16x16x32_bf16 v[60:63], v[40:43], v[120:123], 0
    ds_read2_b32 v[138:139], v11 offset0:34 offset1:32
    s_waitcnt lgkmcnt(10)
    v_mfma_f32_16x16x32_bf16 v[64:67], v[44:47], v[116:119], 0
    ds_read2_b32 v[140:141], v11 offset0:39 offset1:37
    v_mfma_f32_16x16x32_bf16 v[68:71], v[44:47], v[120:123], 0
    ds_read2_b32 v[142:143], v11 offset0:35 offset1:33
    s_waitcnt lgkmcnt(8)
    v_mfma_f32_16x16x32_bf16 v[16:19], v[112:115], v[40:43], 0
    ds_read_b128 v[104:107], v13
    ds_read_b128 v[108:111], v13 offset:1024
    v_mfma_f32_16x16x32_bf16 v[80:83], v[48:51], v[116:119], 0
    v_cvt_pk_bf16_f32 v56, v56, v60
    v_cvt_pk_bf16_f32 v57, v57, v61
    v_mfma_f32_16x16x32_bf16 v[84:87], v[48:51], v[120:123], 0
    v_cvt_pk_bf16_f32 v58, v58, v62
    v_cvt_pk_bf16_f32 v59, v59, v63
    v_mfma_f32_16x16x32_bf16 v[88:91], v[52:55], v[116:119], 0
    v_cvt_pk_bf16_f32 v64, v64, v68
    v_cvt_pk_bf16_f32 v65, v65, v69
    v_mfma_f32_16x16x32_bf16 v[92:95], v[52:55], v[120:123], 0
    v_cvt_pk_bf16_f32 v66, v66, v70
    v_cvt_pk_bf16_f32 v67, v67, v71
    v_mfma_f32_16x16x32_bf16 v[20:23], v[112:115], v[48:51], 0
    s_waitcnt lgkmcnt(8)
    v_mfma_f32_16x16x32_bf16 v[16:19], v[56:59], v[128:131], v[16:19]
    v_cvt_pk_bf16_f32 v80, v80, v84
    v_cvt_pk_bf16_f32 v81, v81, v85
    s_waitcnt lgkmcnt(6)
    v_mfma_f32_16x16x32_bf16 v[16:19], v[64:67], v[132:135], v[16:19]
    v_cvt_pk_bf16_f32 v82, v82, v86
    v_cvt_pk_bf16_f32 v83, v83, v87
    s_waitcnt lgkmcnt(4)
    v_mfma_f32_16x16x32_bf16 v[20:23], v[56:59], v[136:139], v[20:23]
    v_cvt_pk_bf16_f32 v88, v88, v92
    v_cvt_pk_bf16_f32 v89, v89, v93
    s_waitcnt lgkmcnt(2)
    v_mfma_f32_16x16x32_bf16 v[20:23], v[64:67], v[140:143], v[20:23]
    v_cvt_pk_bf16_f32 v90, v90, v94
    v_cvt_pk_bf16_f32 v91, v91, v95
    v_mfma_f32_16x16x32_bf16 v[20:23], v[80:83], v[128:131], v[20:23]
    ds_read2_b32 v[144:145], v11 offset0:70 offset1:68
    ds_read2_b32 v[146:147], v11 offset0:66 offset1:64
    v_mfma_f32_16x16x32_bf16 v[20:23], v[88:91], v[132:135], v[20:23]
    ds_read2_b32 v[148:149], v11 offset0:71 offset1:69
    ds_read2_b32 v[150:151], v11 offset0:67 offset1:65
    s_waitcnt lgkmcnt(5)
    v_mfma_f32_16x16x32_bf16 v[72:75], v[40:43], v[104:107], 0
    ds_write_b128 v8, v[16:19] offset:0
    v_mov_b32 v10, 2
    s_waitcnt lgkmcnt(5)
    v_mfma_f32_16x16x32_bf16 v[76:79], v[44:47], v[108:111], 0
    ds_write_b32 v9, v10 offset:32
    ds_read2_b32 v[152:153], v12 offset0:3 offset1:2
    v_mfma_f32_16x16x32_bf16 v[24:27], v[124:127], v[40:43], 0
    ds_read2_b32 v[154:155], v12 offset0:1 offset1:0
    ds_read2_b32 v[156:157], v12 offset0:19 offset1:18
    v_mfma_f32_16x16x32_bf16 v[96:99], v[48:51], v[104:107], 0
    ds_read2_b32 v[158:159], v12 offset0:17 offset1:16
    ds_read2_b32 v[160:161], v12 offset0:35 offset1:34
    v_mfma_f32_16x16x32_bf16 v[100:103], v[52:55], v[108:111], 0
    ds_read2_b32 v[162:163], v12 offset0:33 offset1:32
    ds_read2_b32 v[164:165], v12 offset0:51 offset1:50
    v_mfma_f32_16x16x32_bf16 v[28:31], v[124:127], v[48:51], 0
    ds_read2_b32 v[166:167], v12 offset0:49 offset1:48
    ds_write_b128 v8, v[20:23] offset:1024
    v_mov_b32 v10, 3
    ds_write_b32 v9, v10 offset:32
    s_mov_b32 s9, 0
SP_40:
    ds_read_b32 v10, v1 offset:80
    s_waitcnt lgkmcnt(0)
    v_readfirstlane_b32 s8, v10
    s_add_u32 s9, s9, 1
    s_cmp_ge_u32 s8, 4
    s_cbranch_scc1 SP_40_D
    s_sleep 1
    s_cmp_lt_u32 s9, 524288
    s_cbranch_scc1 SP_40
SP_40_D:
    s_setprio 3
    ds_read_b128 v[40:43], v6 offset:2560
    ds_read_b128 v[44:47], v6 offset:2576
    ds_read_b128 v[48:51], v6 offset:2048
    ds_read_b128 v[52:55], v6 offset:2064
    v_mfma_f32_16x16x32_bf16 v[24:27], v[56:59], v[144:147], v[24:27]
    v_cvt_pk_bf16_f32 v72, v72, v76
    v_cvt_pk_bf16_f32 v73, v73, v77
    v_mfma_f32_16x16x32_bf16 v[24:27], v[64:67], v[148:151], v[24:27]
    v_cvt_pk_bf16_f32 v74, v74, v78
    v_cvt_pk_bf16_f32 v75, v75, v79
    v_mfma_f32_16x16x32_bf16 v[24:27], v[80:83], v[136:139], v[24:27]
    v_cvt_pk_bf16_f32 v96, v96, v100
    v_cvt_pk_bf16_f32 v97, v97, v101
    v_mfma_f32_16x16x32_bf16 v[24:27], v[88:91], v[140:143], v[24:27]
    v_cvt_pk_bf16_f32 v98, v98, v102
    v_cvt_pk_bf16_f32 v99, v99, v103
    v_mfma_f32_16x16x32_bf16 v[28:31], v[80:83], v[144:147], v[28:31]
    v_mfma_f32_16x16x32_bf16 v[28:31], v[88:91], v[148:151], v[28:31]
    s_waitcnt lgkmcnt(3)
    v_mfma_f32_16x16x32_bf16 v[56:59], v[40:43], v[116:119], 0
    v_mfma_f32_16x16x32_bf16 v[60:63], v[40:43], v[120:123], 0
    s_waitcnt lgkmcnt(2)
    v_mfma_f32_16x16x32_bf16 v[64:67], v[44:47], v[116:119], 0
    v_mfma_f32_16x16x32_bf16 v[68:71], v[44:47], v[120:123], 0
    v_mfma_f32_16x16x32_bf16 v[24:27], v[112:115], v[40:43], v[24:27]
    v_mfma_f32_16x16x32_bf16 v[24:27], v[72:75], v[152:155], v[24:27]
    v_mfma_f32_16x16x32_bf16 v[28:31], v[72:75], v[156:159], v[28:31]
    v_mfma_f32_16x16x32_bf16 v[32:35], v[72:75], v[160:163], 0
    v_mfma_f32_16x16x32_bf16 v[36:39], v[72:75], v[164:167], 0
    v_mfma_f32_16x16x32_bf16 v[28:31], v[96:99], v[152:155], v[28:31]
    v_mfma_f32_16x16x32_bf16 v[32:35], v[96:99], v[156:159], v[32:35]
    v_mfma_f32_16x16x32_bf16 v[36:39], v[96:99], v[160:163], v[36:39]
    s_waitcnt lgkmcnt(1)
    v_mfma_f32_16x16x32_bf16 v[80:83], v[48:51], v[116:119], 0
    v_cvt_pk_bf16_f32 v56, v56, v60
    v_cvt_pk_bf16_f32 v57, v57, v61
    v_mfma_f32_16x16x32_bf16 v[84:87], v[48:51], v[120:123], 0
    v_cvt_pk_bf16_f32 v58, v58, v62
    v_cvt_pk_bf16_f32 v59, v59, v63
    s_waitcnt lgkmcnt(0)
    v_mfma_f32_16x16x32_bf16 v[88:91], v[52:55], v[116:119], 0
    v_cvt_pk_bf16_f32 v64, v64, v68
    v_cvt_pk_bf16_f32 v65, v65, v69
    v_mfma_f32_16x16x32_bf16 v[92:95], v[52:55], v[120:123], 0
    v_cvt_pk_bf16_f32 v66, v66, v70
    v_cvt_pk_bf16_f32 v67, v67, v71
    v_mfma_f32_16x16x32_bf16 v[28:31], v[112:115], v[48:51], v[28:31]
    v_mfma_f32_16x16x32_bf16 v[72:75], v[40:43], v[104:107], 0
    v_mfma_f32_16x16x32_bf16 v[76:79], v[44:47], v[108:111], 0
    v_mfma_f32_16x16x32_bf16 v[32:35], v[124:127], v[40:43], v[32:35]
    v_mfma_f32_16x16x32_bf16 v[24:27], v[56:59], v[128:131], v[24:27]
    v_cvt_pk_bf16_f32 v80, v80, v84
    v_cvt_pk_bf16_f32 v81, v81, v85
    v_mfma_f32_16x16x32_bf16 v[24:27], v[64:67], v[132:135], v[24:27]
    v_cvt_pk_bf16_f32 v82, v82, v86
    v_cvt_pk_bf16_f32 v83, v83, v87
    v_mfma_f32_16x16x32_bf16 v[28:31], v[56:59], v[136:139], v[28:31]
    v_cvt_pk_bf16_f32 v88, v88, v92
    v_cvt_pk_bf16_f32 v89, v89, v93
    v_mfma_f32_16x16x32_bf16 v[28:31], v[64:67], v[140:143], v[28:31]
    v_cvt_pk_bf16_f32 v90, v90, v94
    v_cvt_pk_bf16_f32 v91, v91, v95
    v_mfma_f32_16x16x32_bf16 v[32:35], v[56:59], v[144:147], v[32:35]
    v_cvt_pk_bf16_f32 v72, v72, v76
    v_cvt_pk_bf16_f32 v73, v73, v77
    v_mfma_f32_16x16x32_bf16 v[32:35], v[64:67], v[148:151], v[32:35]
    v_cvt_pk_bf16_f32 v74, v74, v78
    v_cvt_pk_bf16_f32 v75, v75, v79
    v_mfma_f32_16x16x32_bf16 v[96:99], v[48:51], v[104:107], 0
    ds_write_b128 v8, v[24:27] offset:2048
    v_mov_b32 v10, 4
    v_mfma_f32_16x16x32_bf16 v[100:103], v[52:55], v[108:111], 0
    ds_write_b32 v9, v10 offset:32
    v_mfma_f32_16x16x32_bf16 v[36:39], v[124:127], v[48:51], v[36:39]
    v_mfma_f32_16x16x32_bf16 v[28:31], v[80:83], v[128:131], v[28:31]
    s_nop 4
    v_cvt_pk_bf16_f32 v96, v96, v100
    v_cvt_pk_bf16_f32 v97, v97, v101
    v_mfma_f32_16x16x32_bf16 v[28:31], v[88:91], v[132:135], v[28:31]
    v_cvt_pk_bf16_f32 v98, v98, v102
    v_cvt_pk_bf16_f32 v99, v99, v103
    v_mfma_f32_16x16x32_bf16 v[32:35], v[80:83], v[136:139], v[32:35]
    s_nop 0
    s_nop 0
    v_mfma_f32_16x16x32_bf16 v[32:35], v[88:91], v[140:143], v[32:35]
    s_nop 0
    s_nop 0
    v_mfma_f32_16x16x32_bf16 v[36:39], v[80:83], v[144:147], v[36:39]
    ds_write_b128 v8, v[28:31] offset:3072
    v_mov_b32 v10, 5
    v_mfma_f32_16x16x32_bf16 v[36:39], v[88:91], v[148:151], v[36:39]
    ds_write_b32 v9, v10 offset:32
    v_mfma_f32_16x16x32_bf16 v[32:35], v[72:75], v[152:155], v[32:35]
    v_mfma_f32_16x16x32_bf16 v[36:39], v[72:75], v[156:159], v[36:39]
    v_mfma_f32_16x16x32_bf16 v[36:39], v[96:99], v[152:155], v[36:39]
    s_setprio 3
    s_mov_b32 s9, 0
SP_41:
    ds_read_b32 v10, v1 offset:80
    s_waitcnt lgkmcnt(0)
    v_readfirstlane_b32 s8, v10
    s_add_u32 s9, s9, 1
    s_cmp_ge_u32 s8, 6
    s_cbranch_scc1 SP_41_D
    s_sleep 1
    s_cmp_lt_u32 s9, 524288
    s_cbranch_scc1 SP_41
SP_41_D:
    ds_read_b128 v[40:43], v6 offset:1536
    ds_read_b128 v[44:47], v6 offset:1552
    ds_read_b128 v[48:51], v6 offset:1024
    ds_read_b128 v[52:55], v6 offset:1040
    s_waitcnt lgkmcnt(3)
    v_mfma_f32_16x16x32_bf16 v[56:59], v[40:43], v[116:119], 0
    v_mfma_f32_16x16x32_bf16 v[60:63], v[40:43], v[120:123], 0
    s_waitcnt lgkmcnt(2)
    v_mfma_f32_16x16x32_bf16 v[64:67], v[44:47], v[116:119], 0
    v_mfma_f32_16x16x32_bf16 v[68:71], v[44:47], v[120:123], 0
    v_mfma_f32_16x16x32_bf16 v[32:35], v[112:115], v[40:43], v[32:35]
    s_waitcnt lgkmcnt(1)
    v_mfma_f32_16x16x32_bf16 v[80:83], v[48:51], v[116:119], 0
    s_nop 1
    v_cvt_pk_bf16_f32 v56, v56, v60
    v_cvt_pk_bf16_f32 v57, v57, v61
    v_mfma_f32_16x16x32_bf16 v[84:87], v[48:51], v[120:123], 0
    v_cvt_pk_bf16_f32 v58, v58, v62
    v_cvt_pk_bf16_f32 v59, v59, v63
    s_waitcnt lgkmcnt(0)
    v_mfma_f32_16x16x32_bf16 v[88:91], v[52:55], v[116:119], 0
    v_cvt_pk_bf16_f32 v64, v64, v68
    v_cvt_pk_bf16_f32 v65, v65, v69
    v_mfma_f32_16x16x32_bf16 v[92:95], v[52:55], v[120:123], 0
    v_cvt_pk_bf16_f32 v66, v66, v70
    v_cvt_pk_bf16_f32 v67, v67, v71
    v_mfma_f32_16x16x32_bf16 v[36:39], v[112:115], v[48:51], v[36:39]
    v_mfma_f32_16x16x32_bf16 v[32:35], v[56:59], v[128:131], v[32:35]
    v_cvt_pk_bf16_f32 v80, v80, v84
    v_cvt_pk_bf16_f32 v81, v81, v85
    v_mfma_f32_16x16x32_bf16 v[32:35], v[64:67], v[132:135], v[32:35]
    v_cvt_pk_bf16_f32 v82, v82, v86
    v_cvt_pk_bf16_f32 v83, v83, v87
    v_mfma_f32_16x16x32_bf16 v[36:39], v[56:59], v[136:139], v[36:39]
    v_cvt_pk_bf16_f32 v88, v88, v92
    v_cvt_pk_bf16_f32 v89, v89, v93
    v_mfma_f32_16x16x32_bf16 v[36:39], v[64:67], v[140:143], v[36:39]
    v_cvt_pk_bf16_f32 v90, v90, v94
    v_cvt_pk_bf16_f32 v91, v91, v95
    v_mfma_f32_16x16x32_bf16 v[36:39], v[80:83], v[128:131], v[36:39]
    s_nop 0
    v_mfma_f32_16x16x32_bf16 v[36:39], v[88:91], v[132:135], v[36:39]
    ds_write_b128 v8, v[32:35] offset:18432
    v_mov_b32 v10, 6
    ds_write_b32 v9, v10 offset:32
    s_nop 4
    ds_write_b128 v8, v[36:39] offset:19456
    v_mov_b32 v10, 7
    ds_write_b32 v9, v10 offset:32
    s_endpgm
SELECT:
    s_setprio 3
    s_mov_b32 s52, s16
    s_mov_b32 s53, s17
    s_mov_b32 s54, 2359296
    s_mov_b32 s55, 0x20000
    v_lshlrev_b32 v7, 4, v2
    v_add_u32 v15, 0x1000, v7
    v_lshlrev_b32 v8, 2, v2
    v_sub_u32 v8, 2047, v8
    v_subrev_u32 v48, 0, v8
    v_subrev_u32 v49, 1, v8
    v_subrev_u32 v50, 2, v8
    v_subrev_u32 v51, 3, v8
    v_subrev_u32 v52, 256, v8
    v_subrev_u32 v53, 257, v8
    v_subrev_u32 v54, 258, v8
    v_subrev_u32 v55, 259, v8
    v_subrev_u32 v56, 512, v8
    v_subrev_u32 v57, 513, v8
    v_subrev_u32 v58, 514, v8
    v_subrev_u32 v59, 515, v8
    v_subrev_u32 v60, 768, v8
    v_subrev_u32 v61, 769, v8
    v_subrev_u32 v62, 770, v8
    v_subrev_u32 v63, 771, v8
    v_subrev_u32 v64, 1024, v8
    v_subrev_u32 v65, 1025, v8
    v_subrev_u32 v66, 1026, v8
    v_subrev_u32 v67, 1027, v8
    v_subrev_u32 v68, 1280, v8
    v_subrev_u32 v69, 1281, v8
    v_subrev_u32 v70, 1282, v8
    v_subrev_u32 v71, 1283, v8
    v_subrev_u32 v72, 1536, v8
    v_subrev_u32 v73, 1537, v8
    v_subrev_u32 v74, 1538, v8
    v_subrev_u32 v75, 1539, v8
    v_subrev_u32 v76, 1792, v8
    v_subrev_u32 v77, 1793, v8
    v_subrev_u32 v78, 1794, v8
    v_subrev_u32 v79, 1795, v8
    v_lshrrev_b32 v9, 3, v2
    v_and_b32 v9, 6, v9
    v_xor_b32 v9, v9, v2
    v_and_b32 v9, 7, v9
    v_lshlrev_b32 v5, 4, v9
    v_mov_b32 v12, 0
    v_mov_b32 v6, 0
    s_mov_b32 s11, 0xffff0000
    s_mov_b32 s15, 0
    s_mov_b32 s9, 0
SP_42:
    ds_read_b32 v13, v1 offset:12
    s_waitcnt lgkmcnt(0)
    v_readfirstlane_b32 s8, v13
    s_add_u32 s9, s9, 1
    s_cmp_ge_u32 s8, 2
    s_cbranch_scc1 SP_42_D
    s_cmp_lt_u32 s9, 524288
    s_cbranch_scc1 SP_42
SP_42_D:
    s_mov_b32 s9, 0
    s_waitcnt vmcnt(0)
    s_sleep 16
SEL_POLL:
    global_load_dwordx4 v[16:19], v7, s[50:51] offset:0 sc1
    global_load_dwordx4 v[20:23], v7, s[50:51] offset:1024 sc1
    global_load_dwordx4 v[24:27], v7, s[50:51] offset:2048 sc1
    global_load_dwordx4 v[28:31], v7, s[50:51] offset:3072 sc1
    global_load_dwordx4 v[32:35], v15, s[50:51] offset:0 sc1
    global_load_dwordx4 v[36:39], v15, s[50:51] offset:1024 sc1
    global_load_dwordx4 v[40:43], v15, s[50:51] offset:2048 sc1
    global_load_dwordx4 v[44:47], v15, s[50:51] offset:3072 sc1
    s_waitcnt vmcnt(7)
    v_xor_b32 v13, v17, v14
    v_bitop3_b32 v13, v13, v19, v14 bitop3:0xf6
    s_waitcnt vmcnt(6)
    v_bitop3_b32 v13, v13, v21, v14 bitop3:0xf6
    v_bitop3_b32 v13, v13, v23, v14 bitop3:0xf6
    s_waitcnt vmcnt(5)
    v_bitop3_b32 v13, v13, v25, v14 bitop3:0xf6
    v_bitop3_b32 v13, v13, v27, v14 bitop3:0xf6
    s_waitcnt vmcnt(4)
    v_bitop3_b32 v13, v13, v29, v14 bitop3:0xf6
    v_bitop3_b32 v13, v13, v31, v14 bitop3:0xf6
    s_waitcnt vmcnt(3)
    v_bitop3_b32 v13, v13, v33, v14 bitop3:0xf6
    v_bitop3_b32 v13, v13, v35, v14 bitop3:0xf6
    s_waitcnt vmcnt(2)
    v_bitop3_b32 v13, v13, v37, v14 bitop3:0xf6
    v_bitop3_b32 v13, v13, v39, v14 bitop3:0xf6
    s_waitcnt vmcnt(1)
    v_bitop3_b32 v13, v13, v41, v14 bitop3:0xf6
    v_bitop3_b32 v13, v13, v43, v14 bitop3:0xf6
    s_waitcnt vmcnt(0)
    v_bitop3_b32 v13, v13, v45, v14 bitop3:0xf6
    v_bitop3_b32 v13, v13, v47, v14 bitop3:0xf6
    v_cmp_ne_u32 vcc, 0, v13
    s_add_u32 s9, s9, 1
    s_cmp_eq_u64 vcc, 0
    s_cbranch_scc1 SEL_GOT
    s_cmp_lt_u32 s9, 131072
    s_cbranch_scc1 SEL_POLL
SEL_GOT:
    v_lshl_or_b32 v80, v16, 16, v48
    v_and_or_b32 v81, v16, s11, v49
    v_lshl_or_b32 v82, v18, 16, v50
    v_and_or_b32 v83, v18, s11, v51
    v_min_u32 v9, v80, v81
    v_max_u32 v8, v80, v81
    v_med3_u32 v9, v8, v9, v82
    v_max_u32 v8, v8, v82
    v_med3_u32 v9, v8, v9, v83
    v_max_u32 v8, v8, v83
    v_lshl_or_b32 v84, v20, 16, v52
    v_and_or_b32 v85, v20, s11, v53
    v_lshl_or_b32 v86, v22, 16, v54
    v_and_or_b32 v87, v22, s11, v55
    v_med3_u32 v9, v8, v9, v84
    v_max_u32 v8, v8, v84
    v_med3_u32 v9, v8, v9, v85
    v_max_u32 v8, v8, v85
    v_med3_u32 v9, v8, v9, v86
    v_max_u32 v8, v8, v86
    v_med3_u32 v9, v8, v9, v87
    v_max_u32 v8, v8, v87
    v_lshl_or_b32 v88, v24, 16, v56
    v_and_or_b32 v89, v24, s11, v57
    v_lshl_or_b32 v90, v26, 16, v58
    v_and_or_b32 v91, v26, s11, v59
    v_med3_u32 v9, v8, v9, v88
    v_max_u32 v8, v8, v88
    v_med3_u32 v9, v8, v9, v89
    v_max_u32 v8, v8, v89
    v_med3_u32 v9, v8, v9, v90
    v_max_u32 v8, v8, v90
    v_med3_u32 v9, v8, v9, v91
    v_max_u32 v8, v8, v91
    v_lshl_or_b32 v92, v28, 16, v60
    v_and_or_b32 v93, v28, s11, v61
    v_lshl_or_b32 v94, v30, 16, v62
    v_and_or_b32 v95, v30, s11, v63
    v_med3_u32 v9, v8, v9, v92
    v_max_u32 v8, v8, v92
    v_med3_u32 v9, v8, v9, v93
    v_max_u32 v8, v8, v93
    v_med3_u32 v9, v8, v9, v94
    v_max_u32 v8, v8, v94
    v_med3_u32 v9, v8, v9, v95
    v_max_u32 v8, v8, v95
    v_lshl_or_b32 v96, v32, 16, v64
    v_and_or_b32 v97, v32, s11, v65
    v_lshl_or_b32 v98, v34, 16, v66
    v_and_or_b32 v99, v34, s11, v67
    v_med3_u32 v9, v8, v9, v96
    v_max_u32 v8, v8, v96
    v_med3_u32 v9, v8, v9, v97
    v_max_u32 v8, v8, v97
    v_med3_u32 v9, v8, v9, v98
    v_max_u32 v8, v8, v98
    v_med3_u32 v9, v8, v9, v99
    v_max_u32 v8, v8, v99
    v_lshl_or_b32 v100, v36, 16, v68
    v_and_or_b32 v101, v36, s11, v69
    v_lshl_or_b32 v102, v38, 16, v70
    v_and_or_b32 v103, v38, s11, v71
    v_med3_u32 v9, v8, v9, v100
    v_max_u32 v8, v8, v100
    v_med3_u32 v9, v8, v9, v101
    v_max_u32 v8, v8, v101
    v_med3_u32 v9, v8, v9, v102
    v_max_u32 v8, v8, v102
    v_med3_u32 v9, v8, v9, v103
    v_max_u32 v8, v8, v103
    v_lshl_or_b32 v104, v40, 16, v72
    v_and_or_b32 v105, v40, s11, v73
    v_lshl_or_b32 v106, v42, 16, v74
    v_and_or_b32 v107, v42, s11, v75
    v_med3_u32 v9, v8, v9, v104
    v_max_u32 v8, v8, v104
    v_med3_u32 v9, v8, v9, v105
    v_max_u32 v8, v8, v105
    v_med3_u32 v9, v8, v9, v106
    v_max_u32 v8, v8, v106
    v_med3_u32 v9, v8, v9, v107
    v_max_u32 v8, v8, v107
    v_lshl_or_b32 v108, v44, 16, v76
    v_and_or_b32 v109, v44, s11, v77
    v_lshl_or_b32 v110, v46, 16, v78
    v_and_or_b32 v111, v46, s11, v79
    v_med3_u32 v9, v8, v9, v108
    v_max_u32 v8, v8, v108
    v_med3_u32 v9, v8, v9, v109
    v_max_u32 v8, v8, v109
    v_med3_u32 v9, v8, v9, v110
    v_max_u32 v8, v8, v110
    v_med3_u32 v9, v8, v9, v111
    v_max_u32 v8, v8, v111
    v_mov_b32 v10, v8
    s_nop 1
    v_max_u32_dpp v10, v10, v10 row_shr:1 row_mask:0xf bank_mask:0xf
    s_nop 1
    v_max_u32_dpp v10, v10, v10 row_shr:2 row_mask:0xf bank_mask:0xf
    s_nop 1
    v_max_u32_dpp v10, v10, v10 row_shr:4 row_mask:0xf bank_mask:0xf
    s_nop 1
    v_max_u32_dpp v10, v10, v10 row_shr:8 row_mask:0xf bank_mask:0xf
    s_nop 1
    v_max_u32_dpp v10, v10, v10 row_bcast:15 row_mask:0xa bank_mask:0xf
    s_nop 1
    v_max_u32_dpp v10, v10, v10 row_bcast:31 row_mask:0xc bank_mask:0xf
    s_nop 0
    v_readlane_b32 s8, v10, 63
    s_mov_b32 s12, s8
    v_subrev_u32 v10, s12, v8
    v_subrev_u32 v11, s12, v9
    v_max_u32 v10, v10, v11
    s_and_b32 s13, s12, 0x7ff
    s_sub_u32 s13, 2047, s13
    v_max_u32_dpp v10, v10, v10 row_shr:1 row_mask:0xf bank_mask:0xf
    s_mul_i32 s13, s13, 1152
    s_nop 0
    v_max_u32_dpp v10, v10, v10 row_shr:2 row_mask:0xf bank_mask:0xf
    s_mov_b32 exec_lo, 0xff
    s_mov_b32 exec_hi, 0x0
    v_add_u32 v12, s13, v5
    v_mov_b32 v6, s12
    s_mov_b64 exec, -1
    v_max_u32_dpp v10, v10, v10 row_shr:4 row_mask:0xf bank_mask:0xf
    s_nop 1
    v_max_u32_dpp v10, v10, v10 row_shr:8 row_mask:0xf bank_mask:0xf
    s_nop 1
    v_max_u32_dpp v10, v10, v10 row_bcast:15 row_mask:0xa bank_mask:0xf
    s_nop 1
    v_max_u32_dpp v10, v10, v10 row_bcast:31 row_mask:0xc bank_mask:0xf
    s_nop 0
    v_readlane_b32 s8, v10, 63
    s_add_u32 s12, s12, s8
    v_subrev_u32 v10, s12, v8
    v_subrev_u32 v11, s12, v9
    v_max_u32 v10, v10, v11
    s_and_b32 s13, s12, 0x7ff
    s_sub_u32 s13, 2047, s13
    v_max_u32_dpp v10, v10, v10 row_shr:1 row_mask:0xf bank_mask:0xf
    s_mul_i32 s13, s13, 1152
    s_nop 0
    v_max_u32_dpp v10, v10, v10 row_shr:2 row_mask:0xf bank_mask:0xf
    s_mov_b32 exec_lo, 0xff00
    s_mov_b32 exec_hi, 0x0
    v_add_u32 v12, s13, v5
    v_mov_b32 v6, s12
    s_mov_b64 exec, -1
    v_max_u32_dpp v10, v10, v10 row_shr:4 row_mask:0xf bank_mask:0xf
    s_nop 1
    v_max_u32_dpp v10, v10, v10 row_shr:8 row_mask:0xf bank_mask:0xf
    s_nop 1
    v_max_u32_dpp v10, v10, v10 row_bcast:15 row_mask:0xa bank_mask:0xf
    s_nop 1
    v_max_u32_dpp v10, v10, v10 row_bcast:31 row_mask:0xc bank_mask:0xf
    s_nop 0
    v_readlane_b32 s8, v10, 63
    s_add_u32 s12, s12, s8
    v_subrev_u32 v10, s12, v8
    v_subrev_u32 v11, s12, v9
    v_max_u32 v10, v10, v11
    s_and_b32 s13, s12, 0x7ff
    s_sub_u32 s13, 2047, s13
    v_max_u32_dpp v10, v10, v10 row_shr:1 row_mask:0xf bank_mask:0xf
    s_mul_i32 s13, s13, 1152
    s_nop 0
    v_max_u32_dpp v10, v10, v10 row_shr:2 row_mask:0xf bank_mask:0xf
    s_mov_b32 exec_lo, 0xff0000
    s_mov_b32 exec_hi, 0x0
    v_add_u32 v12, s13, v5
    v_mov_b32 v6, s12
    s_mov_b64 exec, -1
    v_max_u32_dpp v10, v10, v10 row_shr:4 row_mask:0xf bank_mask:0xf
    s_nop 1
    v_max_u32_dpp v10, v10, v10 row_shr:8 row_mask:0xf bank_mask:0xf
    s_nop 1
    v_max_u32_dpp v10, v10, v10 row_bcast:15 row_mask:0xa bank_mask:0xf
    s_nop 1
    v_max_u32_dpp v10, v10, v10 row_bcast:31 row_mask:0xc bank_mask:0xf
    s_nop 0
    v_readlane_b32 s8, v10, 63
    s_add_u32 s12, s12, s8
    v_subrev_u32 v10, s12, v8
    v_subrev_u32 v11, s12, v9
    v_max_u32 v10, v10, v11
    s_and_b32 s13, s12, 0x7ff
    s_sub_u32 s13, 2047, s13
    v_max_u32_dpp v10, v10, v10 row_shr:1 row_mask:0xf bank_mask:0xf
    s_mul_i32 s13, s13, 1152
    s_nop 0
    v_max_u32_dpp v10, v10, v10 row_shr:2 row_mask:0xf bank_mask:0xf
    s_mov_b32 exec_lo, 0xff000000
    s_mov_b32 exec_hi, 0x0
    v_add_u32 v12, s13, v5
    v_mov_b32 v6, s12
    s_mov_b64 exec, -1
    v_max_u32_dpp v10, v10, v10 row_shr:4 row_mask:0xf bank_mask:0xf
    s_nop 1
    v_max_u32_dpp v10, v10, v10 row_shr:8 row_mask:0xf bank_mask:0xf
    s_nop 1
    v_max_u32_dpp v10, v10, v10 row_bcast:15 row_mask:0xa bank_mask:0xf
    s_nop 1
    v_max_u32_dpp v10, v10, v10 row_bcast:31 row_mask:0xc bank_mask:0xf
    s_nop 0
    v_readlane_b32 s8, v10, 63
    s_add_u32 s12, s12, s8
    v_subrev_u32 v10, s12, v8
    v_subrev_u32 v11, s12, v9
    v_max_u32 v10, v10, v11
    s_and_b32 s13, s12, 0x7ff
    s_sub_u32 s13, 2047, s13
    v_max_u32_dpp v10, v10, v10 row_shr:1 row_mask:0xf bank_mask:0xf
    s_mul_i32 s13, s13, 1152
    s_nop 0
    v_max_u32_dpp v10, v10, v10 row_shr:2 row_mask:0xf bank_mask:0xf
    s_mov_b32 exec_lo, 0x0
    s_mov_b32 exec_hi, 0xff
    v_add_u32 v12, s13, v5
    v_mov_b32 v6, s12
    s_mov_b64 exec, -1
    v_max_u32_dpp v10, v10, v10 row_shr:4 row_mask:0xf bank_mask:0xf
    s_nop 1
    v_max_u32_dpp v10, v10, v10 row_shr:8 row_mask:0xf bank_mask:0xf
    s_nop 1
    v_max_u32_dpp v10, v10, v10 row_bcast:15 row_mask:0xa bank_mask:0xf
    s_nop 1
    v_max_u32_dpp v10, v10, v10 row_bcast:31 row_mask:0xc bank_mask:0xf
    s_nop 0
    v_readlane_b32 s8, v10, 63
    s_add_u32 s12, s12, s8
    v_subrev_u32 v10, s12, v8
    v_subrev_u32 v11, s12, v9
    v_max_u32 v10, v10, v11
    s_and_b32 s13, s12, 0x7ff
    s_sub_u32 s13, 2047, s13
    v_max_u32_dpp v10, v10, v10 row_shr:1 row_mask:0xf bank_mask:0xf
    s_mul_i32 s13, s13, 1152
    s_nop 0
    v_max_u32_dpp v10, v10, v10 row_shr:2 row_mask:0xf bank_mask:0xf
    s_mov_b32 exec_lo, 0x0
    s_mov_b32 exec_hi, 0xff00
    v_add_u32 v12, s13, v5
    v_mov_b32 v6, s12
    s_mov_b64 exec, -1
    v_max_u32_dpp v10, v10, v10 row_shr:4 row_mask:0xf bank_mask:0xf
    s_nop 1
    v_max_u32_dpp v10, v10, v10 row_shr:8 row_mask:0xf bank_mask:0xf
    s_nop 1
    v_max_u32_dpp v10, v10, v10 row_bcast:15 row_mask:0xa bank_mask:0xf
    s_nop 1
    v_max_u32_dpp v10, v10, v10 row_bcast:31 row_mask:0xc bank_mask:0xf
    s_nop 0
    v_readlane_b32 s8, v10, 63
    s_add_u32 s12, s12, s8
    v_subrev_u32 v10, s12, v8
    v_subrev_u32 v11, s12, v9
    v_max_u32 v10, v10, v11
    s_and_b32 s13, s12, 0x7ff
    s_sub_u32 s13, 2047, s13
    v_max_u32_dpp v10, v10, v10 row_shr:1 row_mask:0xf bank_mask:0xf
    s_mul_i32 s13, s13, 1152
    s_nop 0
    v_max_u32_dpp v10, v10, v10 row_shr:2 row_mask:0xf bank_mask:0xf
    s_mov_b32 exec_lo, 0x0
    s_mov_b32 exec_hi, 0xff0000
    v_add_u32 v12, s13, v5
    v_mov_b32 v6, s12
    s_mov_b64 exec, -1
    v_max_u32_dpp v10, v10, v10 row_shr:4 row_mask:0xf bank_mask:0xf
    s_nop 1
    v_max_u32_dpp v10, v10, v10 row_shr:8 row_mask:0xf bank_mask:0xf
    s_nop 1
    v_max_u32_dpp v10, v10, v10 row_bcast:15 row_mask:0xa bank_mask:0xf
    s_nop 1
    v_max_u32_dpp v10, v10, v10 row_bcast:31 row_mask:0xc bank_mask:0xf
    s_nop 0
    v_readlane_b32 s8, v10, 63
    s_add_u32 s12, s12, s8
    s_and_b32 s13, s12, 0x7ff
    s_sub_u32 s13, 2047, s13
    s_mul_i32 s13, s13, 1152
    s_mov_b32 exec_lo, 0x0
    s_mov_b32 exec_hi, 0xff000000
    v_add_u32 v12, s13, v5
    v_mov_b32 v6, s12
    s_mov_b64 exec, -1
    s_mov_b32 s14, 0
SEL_GATHER:
    s_mov_b32 m0, 147712
    s_nop 0
    buffer_load_dwordx4 v12, s[52:55], 0 offen offset:0 lds
    s_mov_b32 m0, 148608
    s_nop 0
    buffer_load_dwordx4 v12, s[52:55], 0 offen offset:128 lds
    s_mov_b32 m0, 149504
    s_nop 0
    buffer_load_dwordx4 v12, s[52:55], 0 offen offset:256 lds
    s_mov_b32 m0, 150400
    s_nop 0
    buffer_load_dwordx4 v12, s[52:55], 0 offen offset:384 lds
    s_mov_b32 m0, 151296
    s_nop 0
    buffer_load_dwordx4 v12, s[52:55], 0 offen offset:512 lds
    s_mov_b32 m0, 152192
    s_nop 0
    buffer_load_dwordx4 v12, s[52:55], 0 offen offset:640 lds
    s_mov_b32 m0, 153088
    s_nop 0
    buffer_load_dwordx4 v12, s[52:55], 0 offen offset:768 lds
    s_mov_b32 m0, 153984
    s_nop 0
    buffer_load_dwordx4 v12, s[52:55], 0 offen offset:896 lds
    s_mov_b32 m0, 154880
    s_nop 0
    buffer_load_dwordx4 v12, s[52:55], 0 offen offset:1024 lds
    v_mov_b32 v13, 1
    s_mov_b64 exec, 1
    ds_add_u32 v1, v13 offset:40
    s_mov_b64 exec, -1
    s_cmp_lg_u32 s14, 0
    s_cbranch_scc1 SEL_OK
    v_sub_u32 v16, v80, v9
    v_sub_u32 v17, v81, v9
    v_sub_u32 v18, v82, v9
    v_sub_u32 v19, v83, v9
    v_sub_u32 v20, v84, v9
    v_sub_u32 v21, v85, v9
    v_sub_u32 v22, v86, v9
    v_sub_u32 v23, v87, v9
    v_sub_u32 v24, v88, v9
    v_sub_u32 v25, v89, v9
    v_sub_u32 v26, v90, v9
    v_sub_u32 v27, v91, v9
    v_sub_u32 v28, v92, v9
    v_sub_u32 v29, v93, v9
    v_sub_u32 v30, v94, v9
    v_sub_u32 v31, v95, v9
    v_sub_u32 v32, v96, v9
    v_sub_u32 v33, v97, v9
    v_sub_u32 v34, v98, v9
    v_sub_u32 v35, v99, v9
    v_sub_u32 v36, v100, v9
    v_sub_u32 v37, v101, v9
    v_sub_u32 v38, v102, v9
    v_sub_u32 v39, v103, v9
    v_sub_u32 v40, v104, v9
    v_sub_u32 v41, v105, v9
    v_sub_u32 v42, v106, v9
    v_sub_u32 v43, v107, v9
    v_sub_u32 v44, v108, v9
    v_sub_u32 v45, v109, v9
    v_sub_u32 v46, v110, v9
    v_sub_u32 v47, v111, v9
    v_max3_u32 v16, v16, v17, v18
    v_max3_u32 v19, v19, v20, v21
    v_max3_u32 v22, v22, v23, v24
    v_max3_u32 v25, v25, v26, v27
    v_max3_u32 v28, v28, v29, v30
    v_max3_u32 v31, v31, v32, v33
    v_max3_u32 v34, v34, v35, v36
    v_max3_u32 v37, v37, v38, v39
    v_max3_u32 v40, v40, v41, v42
    v_max3_u32 v43, v43, v44, v45
    v_max3_u32 v16, v16, v19, v22
    v_max3_u32 v25, v25, v28, v31
    v_max3_u32 v34, v34, v37, v40
    v_max3_u32 v43, v43, v46, v47
    v_max3_u32 v16, v16, v25, v34
    v_max_u32 v16, v16, v43
    v_add_u32 v16, v16, v9
    v_cmp_lt_u32 vcc, s12, v16
    s_cmp_eq_u64 vcc, 0
    s_cbranch_scc1 SEL_OK
    s_waitcnt vmcnt(0)
    s_mov_b32 s12, 0
    s_mov_b64 s[56:57], 0xff
SEL_SLOW:
    v_subrev_u32 v16, s12, v80
    v_subrev_u32 v17, s12, v81
    v_subrev_u32 v18, s12, v82
    v_subrev_u32 v19, s12, v83
    v_subrev_u32 v20, s12, v84
    v_subrev_u32 v21, s12, v85
    v_subrev_u32 v22, s12, v86
    v_subrev_u32 v23, s12, v87
    v_subrev_u32 v24, s12, v88
    v_subrev_u32 v25, s12, v89
    v_subrev_u32 v26, s12, v90
    v_subrev_u32 v27, s12, v91
    v_subrev_u32 v28, s12, v92
    v_subrev_u32 v29, s12, v93
    v_subrev_u32 v30, s12, v94
    v_subrev_u32 v31, s12, v95
    v_subrev_u32 v32, s12, v96
    v_subrev_u32 v33, s12, v97
    v_subrev_u32 v34, s12, v98
    v_subrev_u32 v35, s12, v99
    v_subrev_u32 v36, s12, v100
    v_subrev_u32 v37, s12, v101
    v_subrev_u32 v38, s12, v102
    v_subrev_u32 v39, s12, v103
    v_subrev_u32 v40, s12, v104
    v_subrev_u32 v41, s12, v105
    v_subrev_u32 v42, s12, v106
    v_subrev_u32 v43, s12, v107
    v_subrev_u32 v44, s12, v108
    v_subrev_u32 v45, s12, v109
    v_subrev_u32 v46, s12, v110
    v_subrev_u32 v47, s12, v111
    v_max3_u32 v16, v16, v17, v18
    v_max3_u32 v19, v19, v20, v21
    v_max3_u32 v22, v22, v23, v24
    v_max3_u32 v25, v25, v26, v27
    v_max3_u32 v28, v28, v29, v30
    v_max3_u32 v31, v31, v32, v33
    v_max3_u32 v34, v34, v35, v36
    v_max3_u32 v37, v37, v38, v39
    v_max3_u32 v40, v40, v41, v42
    v_max3_u32 v43, v43, v44, v45
    v_max3_u32 v16, v16, v19, v22
    v_max3_u32 v25, v25, v28, v31
    v_max3_u32 v34, v34, v37, v40
    v_max3_u32 v43, v43, v46, v47
    v_max3_u32 v16, v16, v25, v34
    v_max_u32 v16, v16, v43
    s_nop 1
    v_max_u32_dpp v16, v16, v16 row_shr:1 row_mask:0xf bank_mask:0xf
    s_nop 1
    v_max_u32_dpp v16, v16, v16 row_shr:2 row_mask:0xf bank_mask:0xf
    s_nop 1
    v_max_u32_dpp v16, v16, v16 row_shr:4 row_mask:0xf bank_mask:0xf
    s_nop 1
    v_max_u32_dpp v16, v16, v16 row_shr:8 row_mask:0xf bank_mask:0xf
    s_nop 1
    v_max_u32_dpp v16, v16, v16 row_bcast:15 row_mask:0xa bank_mask:0xf
    s_nop 1
    v_max_u32_dpp v16, v16, v16 row_bcast:31 row_mask:0xc bank_mask:0xf
    s_nop 0
    v_readlane_b32 s8, v16, 63
    s_add_u32 s12, s12, s8
    s_and_b32 s13, s12, 0x7ff
    s_sub_u32 s13, 2047, s13
    s_mul_i32 s13, s13, 1152
    s_mov_b64 exec, s[56:57]
    v_add_u32 v12, s13, v5
    v_mov_b32 v6, s12
    s_mov_b64 exec, -1
    s_lshl_b64 s[56:57], s[56:57], 8
    s_add_u32 s14, s14, 1
    s_cmp_lt_u32 s14, 8
    s_cbranch_scc1 SEL_SLOW
    s_branch SEL_GATHER
SEL_OK:
    s_cmp_lg_u32 s2, 0
    s_cbranch_scc1 SEL_NOPUB
    v_mov_b32 v7, v14
    v_add_u32 v8, 8192, v2
    s_mov_b32 exec_lo, 0x01010101
    s_mov_b32 exec_hi, 0x01010101
    global_store_dwordx2 v8, v[6:7], s[50:51] sc1
    s_mov_b64 exec, 1
    global_store_dword v8, v14, s[50:51] offset:256 sc1
    s_mov_b64 exec, -1
    s_waitcnt vmcnt(2)
    s_branch SEL_END
SEL_NOPUB:
    s_waitcnt vmcnt(0)
SEL_END:
    v_mov_b32 v8, 3
    ds_write_b32 v1, v8 offset:84
    s_endpgm
F_COMP:
F_COMP2:
    s_and_b32 s12, s3, 3
    v_lshrrev_b32 v5, 2, v3
    v_bfe_u32 v7, v3, 3, 1
    v_and_b32 v13, 1, v4
    v_lshl_or_b32 v14, v13, 1, v7
    v_and_b32 v15, 7, v3
    v_mul_u32_u24 v16, 144, v15
    v_add_u32 v16, 156928, v16
    s_mov_b32 s56, 0xff00ff00
    s_mov_b32 s57, 0xff00ff00
    s_lshr_b32 s8, s3, 2
    s_cmp_lg_u32 s8, 1
    s_cbranch_scc1 F_DOWN
    v_bfe_u32 v6, v3, 1, 1
    v_lshl_or_b32 v8, v6, 2, v14
    v_xor_b32 v8, s12, v8
    v_lshlrev_b32 v8, 4, v8
    v_lshl_add_u32 v8, v5, 7, v8
    v_lshl_add_u32 v8, v6, 10, v8
    v_lshl_add_u32 v8, v4, 11, v8
    v_and_b32 v9, 1, v3
    v_lshl_add_u32 v8, v9, 3, v8
    v_xor_b32 v9, 64, v8
    v_add_u32 v10, 49408, v8
    v_add_u32 v11, 49408, v9
    v_lshlrev_b32 v6, 2, v13
    v_lshrrev_b32 v5, 1, v4
    v_add_u32 v6, v6, v5
    v_lshl_add_u32 v6, v7, 5, v6
    s_lshl_b32 s8, s12, 3
    v_add_lshl_u32 v6, v6, s8, 1
    v_add_u32 v5, v6, v16
    v_and_b32 v6, 6, v3
    v_xor_b32 v6, v6, v4
    v_lshlrev_b32 v6, 4, v6
    v_lshl_add_u32 v6, v15, 7, v6
    v_add_u32 v6, 147712, v6
    v_xor_b32 v7, 64, v6
    s_mov_b32 s9, 0
SP_43:
    ds_read_b32 v12, v1 offset:16
    s_waitcnt lgkmcnt(0)
    v_readfirstlane_b32 s8, v12
    s_add_u32 s9, s9, 1
    s_cmp_ge_u32 s8, 3
    s_cbranch_scc1 SP_43_D
    s_sleep 1
    s_cmp_lt_u32 s9, 524288
    s_cbranch_scc1 SP_43
SP_43_D:
    ds_read_b64_tr_b16 v[24:25], v8 offset:256
    ds_read_b64_tr_b16 v[26:27], v8 offset:768
    ds_read_b64_tr_b16 v[28:29], v9 offset:256
    ds_read_b64_tr_b16 v[30:31], v9 offset:768
    ds_read_b64_tr_b16 v[32:33], v8 offset:8448
    ds_read_b64_tr_b16 v[34:35], v8 offset:8960
    ds_read_b64_tr_b16 v[36:37], v9 offset:8448
    ds_read_b64_tr_b16 v[38:39], v9 offset:8960
    ds_read_b64_tr_b16 v[40:41], v8 offset:16640
    ds_read_b64_tr_b16 v[42:43], v8 offset:17152
    ds_read_b64_tr_b16 v[44:45], v9 offset:16640
    ds_read_b64_tr_b16 v[46:47], v9 offset:17152
    s_waitcnt lgkmcnt(0)
    v_mov_b32 v12, 1
    s_mov_b64 exec, 1
    ds_add_u32 v1, v12 offset:48
    s_mov_b64 exec, -1
    s_mov_b32 s9, 0
SP_44:
    ds_read_b32 v12, v1 offset:20
    s_waitcnt lgkmcnt(0)
    v_readfirstlane_b32 s8, v12
    s_add_u32 s9, s9, 1
    s_cmp_ge_u32 s8, 3
    s_cbranch_scc1 SP_44_D
    s_sleep 1
    s_cmp_lt_u32 s9, 524288
    s_cbranch_scc1 SP_44
SP_44_D:
    ds_read_b64_tr_b16 v[48:49], v8 offset:24832
    ds_read_b64_tr_b16 v[50:51], v8 offset:25344
    ds_read_b64_tr_b16 v[52:53], v9 offset:24832
    ds_read_b64_tr_b16 v[54:55], v9 offset:25344
    ds_read_b64_tr_b16 v[56:57], v8 offset:33024
    ds_read_b64_tr_b16 v[58:59], v8 offset:33536
    ds_read_b64_tr_b16 v[60:61], v9 offset:33024
    ds_read_b64_tr_b16 v[62:63], v9 offset:33536
    ds_read_b64_tr_b16 v[64:65], v8 offset:41216
    ds_read_b64_tr_b16 v[66:67], v8 offset:41728
    ds_read_b64_tr_b16 v[68:69], v9 offset:41216
    ds_read_b64_tr_b16 v[70:71], v9 offset:41728
    s_waitcnt lgkmcnt(0)
    v_mov_b32 v12, 1
    s_mov_b64 exec, 1
    ds_add_u32 v1, v12 offset:52
    s_mov_b64 exec, -1
    s_mov_b32 s9, 0
SP_45:
    ds_read_b32 v12, v1 offset:24
    s_waitcnt lgkmcnt(0)
    v_readfirstlane_b32 s8, v12
    s_add_u32 s9, s9, 1
    s_cmp_ge_u32 s8, 3
    s_cbranch_scc1 SP_45_D
    s_sleep 1
    s_cmp_lt_u32 s9, 524288
    s_cbranch_scc1 SP_45
SP_45_D:
    ds_read_b64_tr_b16 v[72:73], v10 offset:0
    ds_read_b64_tr_b16 v[74:75], v10 offset:512
    ds_read_b64_tr_b16 v[76:77], v11 offset:0
    ds_read_b64_tr_b16 v[78:79], v11 offset:512
    ds_read_b64_tr_b16 v[80:81], v10 offset:8192
    ds_read_b64_tr_b16 v[82:83], v10 offset:8704
    ds_read_b64_tr_b16 v[84:85], v11 offset:8192
    ds_read_b64_tr_b16 v[86:87], v11 offset:8704
    ds_read_b64_tr_b16 v[88:89], v10 offset:16384
    ds_read_b64_tr_b16 v[90:91], v10 offset:16896
    ds_read_b64_tr_b16 v[92:93], v11 offset:16384
    ds_read_b64_tr_b16 v[94:95], v11 offset:16896
    s_waitcnt lgkmcnt(0)
    v_mov_b32 v12, 1
    s_mov_b64 exec, 1
    ds_add_u32 v1, v12 offset:56
    s_mov_b64 exec, -1
    s_mov_b32 s9, 0
SP_46:
    ds_read_b32 v12, v1 offset:28
    s_waitcnt lgkmcnt(0)
    v_readfirstlane_b32 s8, v12
    s_add_u32 s9, s9, 1
    s_cmp_ge_u32 s8, 3
    s_cbranch_scc1 SP_46_D
    s_sleep 1
    s_cmp_lt_u32 s9, 524288
    s_cbranch_scc1 SP_46
SP_46_D:
    ds_read_b64_tr_b16 v[96:97], v8 offset:256
    ds_read_b64_tr_b16 v[98:99], v8 offset:768
    ds_read_b64_tr_b16 v[100:101], v9 offset:256
    ds_read_b64_tr_b16 v[102:103], v9 offset:768
    ds_read_b64_tr_b16 v[104:105], v8 offset:8448
    ds_read_b64_tr_b16 v[106:107], v8 offset:8960
    ds_read_b64_tr_b16 v[108:109], v9 offset:8448
    ds_read_b64_tr_b16 v[110:111], v9 offset:8960
    ds_read_b64_tr_b16 v[112:113], v8 offset:16640
    ds_read_b64_tr_b16 v[114:115], v8 offset:17152
    ds_read_b64_tr_b16 v[116:117], v9 offset:16640
    ds_read_b64_tr_b16 v[118:119], v9 offset:17152
    s_mov_b32 s9, 0
SP_47:
    ds_read_b32 v12, v1 offset:32
    s_waitcnt lgkmcnt(0)
    v_readfirstlane_b32 s8, v12
    s_add_u32 s9, s9, 1
    s_cmp_ge_u32 s8, 3
    s_cbranch_scc1 SP_47_D
    s_sleep 1
    s_cmp_lt_u32 s9, 524288
    s_cbranch_scc1 SP_47
SP_47_D:
    ds_read_b64_tr_b16 v[120:121], v8 offset:24832
    ds_read_b64_tr_b16 v[122:123], v8 offset:25344
    ds_read_b64_tr_b16 v[124:125], v9 offset:24832
    ds_read_b64_tr_b16 v[126:127], v9 offset:25344
    ds_read_b64_tr_b16 v[128:129], v8 offset:33024
    ds_read_b64_tr_b16 v[130:131], v8 offset:33536
    ds_read_b64_tr_b16 v[132:133], v9 offset:33024
    ds_read_b64_tr_b16 v[134:135], v9 offset:33536
    ds_read_b64_tr_b16 v[136:137], v8 offset:41216
    ds_read_b64_tr_b16 v[138:139], v8 offset:41728
    ds_read_b64_tr_b16 v[140:141], v9 offset:41216
    ds_read_b64_tr_b16 v[142:143], v9 offset:41728
    s_mov_b32 s9, 0
SP_48:
    ds_read_b32 v12, v1 offset:36
    s_waitcnt lgkmcnt(0)
    v_readfirstlane_b32 s8, v12
    s_add_u32 s9, s9, 1
    s_cmp_ge_u32 s8, 3
    s_cbranch_scc1 SP_48_D
    s_sleep 1
    s_cmp_lt_u32 s9, 524288
    s_cbranch_scc1 SP_48
SP_48_D:
    ds_read_b64_tr_b16 v[144:145], v10 offset:0
    ds_read_b64_tr_b16 v[146:147], v10 offset:512
    ds_read_b64_tr_b16 v[148:149], v11 offset:0
    ds_read_b64_tr_b16 v[150:151], v11 offset:512
    ds_read_b64_tr_b16 v[152:153], v10 offset:8192
    ds_read_b64_tr_b16 v[154:155], v10 offset:8704
    ds_read_b64_tr_b16 v[156:157], v11 offset:8192
    ds_read_b64_tr_b16 v[158:159], v11 offset:8704
    ds_read_b64_tr_b16 v[160:161], v10 offset:16384
    ds_read_b64_tr_b16 v[162:163], v10 offset:16896
    ds_read_b64_tr_b16 v[164:165], v11 offset:16384
    ds_read_b64_tr_b16 v[166:167], v11 offset:16896
    s_setprio 3
    s_mov_b32 s9, 0
SP_49:
    ds_read_b32 v12, v1 offset:84
    s_waitcnt lgkmcnt(0)
    v_readfirstlane_b32 s8, v12
    s_add_u32 s9, s9, 1
    s_cmp_ge_u32 s8, 1
    s_cbranch_scc1 SP_49_D
    s_cmp_lt_u32 s9, 524288
    s_cbranch_scc1 SP_49
SP_49_D:
    ds_read_b128 v[16:19], v6 offset:0
    ds_read_b128 v[20:23], v7 offset:0
    s_waitcnt lgkmcnt(1)
    v_mfma_f32_16x16x32_bf16 v[8:11], v[24:27], v[16:19], 0
    ds_read_b128 v[24:27], v6 offset:1024
    v_mfma_f32_16x16x32_bf16 v[12:15], v[28:31], v[16:19], 0
    ds_read_b128 v[28:31], v7 offset:1024
    s_waitcnt lgkmcnt(2)
    v_mfma_f32_16x16x32_bf16 v[8:11], v[32:35], v[20:23], v[8:11]
    ds_read_b128 v[32:35], v6 offset:2048
    v_mfma_f32_16x16x32_bf16 v[12:15], v[36:39], v[20:23], v[12:15]
    ds_read_b128 v[36:39], v7 offset:2048
    s_waitcnt lgkmcnt(3)
    v_mfma_f32_16x16x32_bf16 v[8:11], v[40:43], v[24:27], v[8:11]
    ds_read_b128 v[40:43], v6 offset:3072
    v_mfma_f32_16x16x32_bf16 v[12:15], v[44:47], v[24:27], v[12:15]
    ds_read_b128 v[44:47], v7 offset:3072
    s_waitcnt lgkmcnt(4)
    v_mfma_f32_16x16x32_bf16 v[8:11], v[48:51], v[28:31], v[8:11]
    ds_read_b128 v[48:51], v6 offset:4096
    v_mfma_f32_16x16x32_bf16 v[12:15], v[52:55], v[28:31], v[12:15]
    ds_read_b128 v[52:55], v7 offset:4096
    s_waitcnt lgkmcnt(5)
    v_mfma_f32_16x16x32_bf16 v[8:11], v[56:59], v[32:35], v[8:11]
    ds_read_b128 v[56:59], v6 offset:5120
    v_mfma_f32_16x16x32_bf16 v[12:15], v[60:63], v[32:35], v[12:15]
    ds_read_b128 v[60:63], v7 offset:5120
    s_waitcnt lgkmcnt(6)
    v_mfma_f32_16x16x32_bf16 v[8:11], v[64:67], v[36:39], v[8:11]
    ds_read_b128 v[64:67], v6 offset:6144
    v_mfma_f32_16x16x32_bf16 v[12:15], v[68:71], v[36:39], v[12:15]
    ds_read_b128 v[68:71], v7 offset:6144
    s_waitcnt lgkmcnt(7)
    v_mfma_f32_16x16x32_bf16 v[8:11], v[72:75], v[40:43], v[8:11]
    ds_read_b128 v[72:75], v6 offset:7168
    v_mfma_f32_16x16x32_bf16 v[12:15], v[76:79], v[40:43], v[12:15]
    ds_read_b128 v[76:79], v7 offset:7168
    s_waitcnt lgkmcnt(8)
    v_mfma_f32_16x16x32_bf16 v[8:11], v[80:83], v[44:47], v[8:11]
    ds_read_b128 v[80:83], v6 offset:8192
    v_mfma_f32_16x16x32_bf16 v[12:15], v[84:87], v[44:47], v[12:15]
    ds_read_b128 v[84:87], v7 offset:8192
    s_waitcnt lgkmcnt(9)
    v_mfma_f32_16x16x32_bf16 v[8:11], v[88:91], v[48:51], v[8:11]
    v_mfma_f32_16x16x32_bf16 v[12:15], v[92:95], v[48:51], v[12:15]
    s_waitcnt lgkmcnt(8)
    v_mfma_f32_16x16x32_bf16 v[8:11], v[96:99], v[52:55], v[8:11]
    v_mfma_f32_16x16x32_bf16 v[12:15], v[100:103], v[52:55], v[12:15]
    s_waitcnt lgkmcnt(7)
    v_mfma_f32_16x16x32_bf16 v[8:11], v[104:107], v[56:59], v[8:11]
    v_mfma_f32_16x16x32_bf16 v[12:15], v[108:111], v[56:59], v[12:15]
    s_waitcnt lgkmcnt(6)
    v_mfma_f32_16x16x32_bf16 v[8:11], v[112:115], v[60:63], v[8:11]
    v_mfma_f32_16x16x32_bf16 v[12:15], v[116:119], v[60:63], v[12:15]
    s_waitcnt lgkmcnt(5)
    v_mfma_f32_16x16x32_bf16 v[8:11], v[120:123], v[64:67], v[8:11]
    v_mfma_f32_16x16x32_bf16 v[12:15], v[124:127], v[64:67], v[12:15]
    s_waitcnt lgkmcnt(4)
    v_mfma_f32_16x16x32_bf16 v[8:11], v[128:131], v[68:71], v[8:11]
    v_mfma_f32_16x16x32_bf16 v[12:15], v[132:135], v[68:71], v[12:15]
    s_waitcnt lgkmcnt(3)
    v_mfma_f32_16x16x32_bf16 v[8:11], v[136:139], v[72:75], v[8:11]
    v_mfma_f32_16x16x32_bf16 v[12:15], v[140:143], v[72:75], v[12:15]
    s_waitcnt lgkmcnt(2)
    v_mfma_f32_16x16x32_bf16 v[8:11], v[144:147], v[76:79], v[8:11]
    v_mfma_f32_16x16x32_bf16 v[12:15], v[148:151], v[76:79], v[12:15]
    s_waitcnt lgkmcnt(1)
    v_mfma_f32_16x16x32_bf16 v[8:11], v[152:155], v[80:83], v[8:11]
    v_mfma_f32_16x16x32_bf16 v[12:15], v[156:159], v[80:83], v[12:15]
    s_waitcnt lgkmcnt(0)
    v_mfma_f32_16x16x32_bf16 v[8:11], v[160:163], v[84:87], v[8:11]
    v_mfma_f32_16x16x32_bf16 v[12:15], v[164:167], v[84:87], v[12:15]
    s_nop 7
    v_cndmask_b32 v8, v8, v12, s[56:57]
    v_cndmask_b32 v9, v9, v13, s[56:57]
    v_cndmask_b32 v10, v10, v14, s[56:57]
    v_cndmask_b32 v11, v11, v15, s[56:57]
    v_permlane32_swap_b32 v8, v9
    s_nop 0
    v_permlane32_swap_b32 v10, v11
    v_cvt_pk_bf16_f32 v9, v8, v9
    v_cvt_pk_bf16_f32 v11, v10, v11
    v_lshlrev_b32 v8, 16, v9
    v_lshlrev_b32 v10, 16, v11
    v_mul_f32 v12, 0xbfb8aa3b, v8
    v_mul_f32 v13, 0xbfb8aa3b, v10
    v_exp_f32 v12, v12
    v_exp_f32 v13, v13
    v_and_b32 v9, 0xffff0000, v9
    v_and_b32 v11, 0xffff0000, v11
    v_add_f32 v12, 1.0, v12
    v_add_f32 v13, 1.0, v13
    v_rcp_f32 v12, v12
    v_rcp_f32 v13, v13
    v_mul_f32 v8, v8, v12
    v_mul_f32 v10, v10, v13
    v_cvt_pk_bf16_f32 v8, v8, v8
    v_cvt_pk_bf16_f32 v10, v10, v10
    v_and_b32 v8, 0xffff0000, v8
    v_and_b32 v10, 0xffff0000, v10
    v_mul_f32 v8, v8, v9
    v_mul_f32 v10, v10, v11
    v_cvt_pk_bf16_f32 v8, v8, v10
    ds_write_b16 v5, v8
    ds_write_b16_d16_hi v5, v8 offset:4
    v_mov_b32 v12, 1
    s_mov_b64 exec, 1
    ds_add_u32 v1, v12 offset:88
    s_mov_b64 exec, -1
    s_endpgm
F_DOWN:
    v_lshl_add_u32 v10, v4, 4, v16
    v_mov_b32 v18, 158080
    v_cndmask_b32 v19, v18, v10, s[56:57]
    v_cndmask_b32 v18, v10, v18, s[56:57]
    v_and_b32 v20, 31, v2
    v_lshlrev_b32 v20, 2, v20
    v_add_u32 v20, 158080, v20
    ds_write_b32 v20, v1
    v_mul_u32_u24 v8, 9216, v4
    s_mul_i32 s13, s7, 73728
    s_mov_b32 s60, 0x7060500
    s_mov_b32 s61, 0x7060501
    s_mov_b32 s62, 0x7060502
    s_mov_b32 s63, 0x7060503
    s_mov_b32 s64, 0x05040100
    s_mov_b32 s65, 0x07060302
    s_lshl_b32 s14, s7, 7
    s_add_u32 s14, s14, 32768
    v_lshl_add_u32 v11, v15, 4, s14
    s_waitcnt lgkmcnt(0)
    s_mov_b32 s52, s50
    s_mov_b32 s53, s51
    s_mov_b32 s54, 268435456
    s_mov_b32 s55, 0x20000
    s_mov_b32 s68, s42
    s_mov_b32 s69, s43
    s_mov_b32 s70, 5308416
    s_mov_b32 s71, 0x20000
    s_cmp_eq_u32 s3, 9
    s_cbranch_scc1 F_DN2
    v_lshl_add_u32 v8, v3, 4, v8
    s_lshl_b32 s8, s3, 8
    s_add_u32 s13, s13, s8
    s_lshl_b32 s8, s3, 5
    v_lshl_add_u32 v6, v4, 3, v7
    v_add_u32 v6, s8, v6
    v_mul_u32_u24 v6, 9216, v6
    v_add_u32 v11, v6, v11
    s_mov_b32 s9, 0
SP_50:
    ds_read_b32 v17, v1 offset:8
    s_waitcnt lgkmcnt(0)
    v_readfirstlane_b32 s8, v17
    s_add_u32 s9, s9, 1
    s_cmp_lg_u32 s8, 0
    s_cbranch_scc1 SP_50_D
    s_sleep 2
    s_cmp_lt_u32 s9, 524288
    s_cbranch_scc1 SP_50
SP_50_D:
    s_mov_b32 s9, 0
SP_51:
    ds_read_b32 v12, v1 offset:40
    s_waitcnt lgkmcnt(0)
    v_readfirstlane_b32 s8, v12
    s_add_u32 s9, s9, 1
    s_cmp_ge_u32 s8, 3
    s_cbranch_scc1 SP_51_D
    s_sleep 1
    s_cmp_lt_u32 s9, 524288
    s_cbranch_scc1 SP_51
SP_51_D:
    s_setprio 2
    buffer_load_dwordx4 v[24:27], v8, s[68:71], s13 offen offset:0
    buffer_load_dwordx4 v[28:31], v8, s[68:71], s13 offen offset:1152
    buffer_load_dwordx4 v[32:35], v8, s[68:71], s13 offen offset:2304
    buffer_load_dwordx4 v[36:39], v8, s[68:71], s13 offen offset:3456
    s_add_u32 s13, s13, 4608
    s_mov_b32 s9, 0
SP_52:
    ds_read_b32 v12, v1 offset:40
    s_waitcnt lgkmcnt(0)
    v_readfirstlane_b32 s8, v12
    s_add_u32 s9, s9, 1
    s_cmp_ge_u32 s8, 4
    s_cbranch_scc1 SP_52_D
    s_sleep 1
    s_cmp_lt_u32 s9, 524288
    s_cbranch_scc1 SP_52
SP_52_D:
    buffer_load_dwordx4 v[40:43], v8, s[68:71], s13 offen offset:0
    buffer_load_dwordx4 v[44:47], v8, s[68:71], s13 offen offset:1152
    buffer_load_dwordx4 v[48:51], v8, s[68:71], s13 offen offset:2304
    buffer_load_dwordx4 v[52:55], v8, s[68:71], s13 offen offset:3456
    s_add_u32 s13, s13, 32256
    buffer_load_dwordx4 v[88:91], v8, s[68:71], s13 offen offset:0
    buffer_load_dwordx4 v[92:95], v8, s[68:71], s13 offen offset:1152
    buffer_load_dwordx4 v[96:99], v8, s[68:71], s13 offen offset:2304
    buffer_load_dwordx4 v[100:103], v8, s[68:71], s13 offen offset:3456
    s_add_u32 s13, s13, 4608
    buffer_load_dwordx4 v[104:107], v8, s[68:71], s13 offen offset:0
    buffer_load_dwordx4 v[108:111], v8, s[68:71], s13 offen offset:1152
    buffer_load_dwordx4 v[112:115], v8, s[68:71], s13 offen offset:2304
    buffer_load_dwordx4 v[116:119], v8, s[68:71], s13 offen offset:3456
    s_add_u32 s13, s13, 32256
    s_waitcnt vmcnt(14)
    v_perm_b32 v56, v28, v24, s64
    v_perm_b32 v60, v28, v24, s65
    v_perm_b32 v64, v29, v25, s64
    v_perm_b32 v68, v29, v25, s65
    v_perm_b32 v72, v30, v26, s64
    v_perm_b32 v76, v30, v26, s65
    v_perm_b32 v80, v31, v27, s64
    v_perm_b32 v84, v31, v27, s65
    s_waitcnt vmcnt(12)
    v_perm_b32 v57, v36, v32, s64
    v_perm_b32 v61, v36, v32, s65
    v_perm_b32 v65, v37, v33, s64
    v_perm_b32 v69, v37, v33, s65
    v_perm_b32 v73, v38, v34, s64
    v_perm_b32 v77, v38, v34, s65
    v_perm_b32 v81, v39, v35, s64
    v_perm_b32 v85, v39, v35, s65
    s_waitcnt vmcnt(10)
    v_perm_b32 v58, v44, v40, s64
    v_perm_b32 v62, v44, v40, s65
    v_perm_b32 v66, v45, v41, s64
    v_perm_b32 v70, v45, v41, s65
    v_perm_b32 v74, v46, v42, s64
    v_perm_b32 v78, v46, v42, s65
    v_perm_b32 v82, v47, v43, s64
    v_perm_b32 v86, v47, v43, s65
    s_waitcnt vmcnt(8)
    v_perm_b32 v59, v52, v48, s64
    v_perm_b32 v63, v52, v48, s65
    v_perm_b32 v67, v53, v49, s64
    v_perm_b32 v71, v53, v49, s65
    v_perm_b32 v75, v54, v50, s64
    v_perm_b32 v79, v54, v50, s65
    v_perm_b32 v83, v55, v51, s64
    v_perm_b32 v87, v55, v51, s65
    s_waitcnt vmcnt(6)
    v_perm_b32 v24, v92, v88, s64
    v_perm_b32 v28, v92, v88, s65
    v_perm_b32 v32, v93, v89, s64
    v_perm_b32 v36, v93, v89, s65
    v_perm_b32 v40, v94, v90, s64
    v_perm_b32 v44, v94, v90, s65
    v_perm_b32 v48, v95, v91, s64
    v_perm_b32 v52, v95, v91, s65
    s_waitcnt vmcnt(4)
    v_perm_b32 v25, v100, v96, s64
    v_perm_b32 v29, v100, v96, s65
    v_perm_b32 v33, v101, v97, s64
    v_perm_b32 v37, v101, v97, s65
    v_perm_b32 v41, v102, v98, s64
    v_perm_b32 v45, v102, v98, s65
    v_perm_b32 v49, v103, v99, s64
    v_perm_b32 v53, v103, v99, s65
    s_mov_b32 s9, 0
SP_53:
    ds_read_b32 v12, v1 offset:88
    s_waitcnt lgkmcnt(0)
    v_readfirstlane_b32 s8, v12
    s_add_u32 s9, s9, 1
    s_cmp_ge_u32 s8, 4
    s_cbranch_scc1 SP_53_D
    s_cmp_lt_u32 s9, 524288
    s_cbranch_scc1 SP_53
SP_53_D:
    ds_read_b128 v[152:155], v18 offset:0
    ds_read_b128 v[160:163], v19 offset:0
    ds_read_b128 v[156:159], v18 offset:64
    ds_read_b128 v[164:167], v19 offset:64
    s_waitcnt lgkmcnt(2)
    v_mfma_f32_16x16x32_bf16 v[120:123], v[56:59], v[152:155], 0
    v_mfma_f32_16x16x32_bf16 v[124:127], v[60:63], v[152:155], 0
    v_mfma_f32_16x16x32_bf16 v[128:131], v[64:67], v[152:155], 0
    v_mfma_f32_16x16x32_bf16 v[132:135], v[68:71], v[152:155], 0
    v_mfma_f32_16x16x32_bf16 v[120:123], v[72:75], v[160:163], v[120:123]
    v_mfma_f32_16x16x32_bf16 v[124:127], v[76:79], v[160:163], v[124:127]
    v_mfma_f32_16x16x32_bf16 v[128:131], v[80:83], v[160:163], v[128:131]
    v_mfma_f32_16x16x32_bf16 v[132:135], v[84:87], v[160:163], v[132:135]
    s_waitcnt lgkmcnt(0)
    s_waitcnt vmcnt(2)
    v_perm_b32 v26, v108, v104, s64
    v_perm_b32 v30, v108, v104, s65
    v_perm_b32 v34, v109, v105, s64
    v_perm_b32 v38, v109, v105, s65
    v_perm_b32 v42, v110, v106, s64
    v_perm_b32 v46, v110, v106, s65
    v_perm_b32 v50, v111, v107, s64
    v_perm_b32 v54, v111, v107, s65
    s_waitcnt vmcnt(0)
    v_perm_b32 v27, v116, v112, s64
    v_perm_b32 v31, v116, v112, s65
    v_perm_b32 v35, v117, v113, s64
    v_perm_b32 v39, v117, v113, s65
    v_perm_b32 v43, v118, v114, s64
    v_perm_b32 v47, v118, v114, s65
    v_perm_b32 v51, v119, v115, s64
    v_perm_b32 v55, v119, v115, s65
    v_mfma_f32_16x16x32_bf16 v[120:123], v[24:27], v[156:159], v[120:123]
    v_mfma_f32_16x16x32_bf16 v[124:127], v[28:31], v[156:159], v[124:127]
    v_mfma_f32_16x16x32_bf16 v[128:131], v[32:35], v[156:159], v[128:131]
    v_mfma_f32_16x16x32_bf16 v[132:135], v[36:39], v[156:159], v[132:135]
    v_mfma_f32_16x16x32_bf16 v[120:123], v[40:43], v[164:167], v[120:123]
    v_mfma_f32_16x16x32_bf16 v[124:127], v[44:47], v[164:167], v[124:127]
    v_mfma_f32_16x16x32_bf16 v[128:131], v[48:51], v[164:167], v[128:131]
    v_mfma_f32_16x16x32_bf16 v[132:135], v[52:55], v[164:167], v[132:135]
    s_nop 4
    v_perm_b32 v88, v120, v17, s60
    v_perm_b32 v89, v124, v17, s61
    v_perm_b32 v90, v128, v17, s62
    v_perm_b32 v91, v132, v17, s63
    s_mov_b32 s12, 0
    buffer_store_dwordx4 v[88:91], v11, s[52:55], s12 offen sc1
    v_perm_b32 v92, v121, v17, s60
    v_perm_b32 v93, v125, v17, s61
    v_perm_b32 v94, v129, v17, s62
    v_perm_b32 v95, v133, v17, s63
    s_mov_b32 s12, 18432
    buffer_store_dwordx4 v[92:95], v11, s[52:55], s12 offen sc1
    v_perm_b32 v96, v122, v17, s60
    v_perm_b32 v97, v126, v17, s61
    v_perm_b32 v98, v130, v17, s62
    v_perm_b32 v99, v134, v17, s63
    s_mov_b32 s12, 36864
    buffer_store_dwordx4 v[96:99], v11, s[52:55], s12 offen sc1
    v_perm_b32 v100, v123, v17, s60
    v_perm_b32 v101, v127, v17, s61
    v_perm_b32 v102, v131, v17, s62
    v_perm_b32 v103, v135, v17, s63
    s_mov_b32 s12, 55296
    buffer_store_dwordx4 v[100:103], v11, s[52:55], s12 offen sc1
    s_endpgm
F_DN2:
    v_lshl_add_u32 v8, v3, 3, v8
    s_add_u32 s13, s13, 1024
    v_lshl_add_u32 v6, v4, 2, v7
    v_add_u32 v6, 128, v6
    v_mul_u32_u24 v6, 9216, v6
    v_add_u32 v11, v6, v11
    s_mov_b32 s9, 0
SP_54:
    ds_read_b32 v17, v1 offset:8
    s_waitcnt lgkmcnt(0)
    v_readfirstlane_b32 s8, v17
    s_add_u32 s9, s9, 1
    s_cmp_lg_u32 s8, 0
    s_cbranch_scc1 SP_54_D
    s_cmp_lt_u32 s9, 524288
    s_cbranch_scc1 SP_54
SP_54_D:
    buffer_load_dwordx2 v[24:25], v8, s[68:71], s13 offen offset:0
    buffer_load_dwordx2 v[26:27], v8, s[68:71], s13 offen offset:1152
    buffer_load_dwordx2 v[28:29], v8, s[68:71], s13 offen offset:2304
    buffer_load_dwordx2 v[30:31], v8, s[68:71], s13 offen offset:3456
    s_add_u32 s13, s13, 4608
    buffer_load_dwordx2 v[32:33], v8, s[68:71], s13 offen offset:0
    buffer_load_dwordx2 v[34:35], v8, s[68:71], s13 offen offset:1152
    buffer_load_dwordx2 v[36:37], v8, s[68:71], s13 offen offset:2304
    buffer_load_dwordx2 v[38:39], v8, s[68:71], s13 offen offset:3456
    s_add_u32 s13, s13, 32256
    buffer_load_dwordx2 v[88:89], v8, s[68:71], s13 offen offset:0
    buffer_load_dwordx2 v[90:91], v8, s[68:71], s13 offen offset:1152
    buffer_load_dwordx2 v[92:93], v8, s[68:71], s13 offen offset:2304
    buffer_load_dwordx2 v[94:95], v8, s[68:71], s13 offen offset:3456
    s_add_u32 s13, s13, 4608
    buffer_load_dwordx2 v[96:97], v8, s[68:71], s13 offen offset:0
    buffer_load_dwordx2 v[98:99], v8, s[68:71], s13 offen offset:1152
    buffer_load_dwordx2 v[100:101], v8, s[68:71], s13 offen offset:2304
    buffer_load_dwordx2 v[102:103], v8, s[68:71], s13 offen offset:3456
    s_add_u32 s13, s13, 32256
    s_waitcnt vmcnt(14)
    v_perm_b32 v56, v26, v24, s64
    v_perm_b32 v60, v26, v24, s65
    v_perm_b32 v64, v27, v25, s64
    v_perm_b32 v68, v27, v25, s65
    s_waitcnt vmcnt(12)
    v_perm_b32 v57, v30, v28, s64
    v_perm_b32 v61, v30, v28, s65
    v_perm_b32 v65, v31, v29, s64
    v_perm_b32 v69, v31, v29, s65
    s_waitcnt vmcnt(10)
    v_perm_b32 v58, v34, v32, s64
    v_perm_b32 v62, v34, v32, s65
    v_perm_b32 v66, v35, v33, s64
    v_perm_b32 v70, v35, v33, s65
    s_waitcnt vmcnt(8)
    v_perm_b32 v59, v38, v36, s64
    v_perm_b32 v63, v38, v36, s65
    v_perm_b32 v67, v39, v37, s64
    v_perm_b32 v71, v39, v37, s65
    s_waitcnt vmcnt(6)
    v_perm_b32 v24, v90, v88, s64
    v_perm_b32 v28, v90, v88, s65
    v_perm_b32 v32, v91, v89, s64
    v_perm_b32 v36, v91, v89, s65
    s_waitcnt vmcnt(4)
    v_perm_b32 v25, v94, v92, s64
    v_perm_b32 v29, v94, v92, s65
    v_perm_b32 v33, v95, v93, s64
    v_perm_b32 v37, v95, v93, s65
    s_mov_b32 s9, 0
SP_55:
    ds_read_b32 v12, v1 offset:88
    s_waitcnt lgkmcnt(0)
    v_readfirstlane_b32 s8, v12
    s_add_u32 s9, s9, 1
    s_cmp_ge_u32 s8, 4
    s_cbranch_scc1 SP_55_D
    s_cmp_lt_u32 s9, 524288
    s_cbranch_scc1 SP_55
SP_55_D:
    ds_read_b128 v[152:155], v10 offset:0
    ds_read_b128 v[156:159], v10 offset:64
    s_waitcnt lgkmcnt(1)
    v_mfma_f32_16x16x32_bf16 v[120:123], v[56:59], v[152:155], 0
    v_mfma_f32_16x16x32_bf16 v[124:127], v[60:63], v[152:155], 0
    v_mfma_f32_16x16x32_bf16 v[128:131], v[64:67], v[152:155], 0
    v_mfma_f32_16x16x32_bf16 v[132:135], v[68:71], v[152:155], 0
    s_waitcnt lgkmcnt(0)
    s_waitcnt vmcnt(2)
    v_perm_b32 v26, v98, v96, s64
    v_perm_b32 v30, v98, v96, s65
    v_perm_b32 v34, v99, v97, s64
    v_perm_b32 v38, v99, v97, s65
    s_waitcnt vmcnt(0)
    v_perm_b32 v27, v102, v100, s64
    v_perm_b32 v31, v102, v100, s65
    v_perm_b32 v35, v103, v101, s64
    v_perm_b32 v39, v103, v101, s65
    v_mfma_f32_16x16x32_bf16 v[120:123], v[24:27], v[156:159], v[120:123]
    v_mfma_f32_16x16x32_bf16 v[124:127], v[28:31], v[156:159], v[124:127]
    v_mfma_f32_16x16x32_bf16 v[128:131], v[32:35], v[156:159], v[128:131]
    v_mfma_f32_16x16x32_bf16 v[132:135], v[36:39], v[156:159], v[132:135]
    s_nop 4
    v_cndmask_b32 v88, v120, v121, s[56:57]
    v_cndmask_b32 v89, v124, v125, s[56:57]
    v_cndmask_b32 v90, v128, v129, s[56:57]
    v_cndmask_b32 v91, v132, v133, s[56:57]
    v_perm_b32 v88, v88, v17, s60
    v_perm_b32 v89, v89, v17, s61
    v_perm_b32 v90, v90, v17, s62
    v_perm_b32 v91, v91, v17, s63
    s_mov_b32 s12, 0
    buffer_store_dwordx4 v[88:91], v11, s[52:55], s12 offen sc1
    v_cndmask_b32 v92, v122, v123, s[56:57]
    v_cndmask_b32 v93, v126, v127, s[56:57]
    v_cndmask_b32 v94, v130, v131, s[56:57]
    v_cndmask_b32 v95, v134, v135, s[56:57]
    v_perm_b32 v92, v92, v17, s60
    v_perm_b32 v93, v93, v17, s61
    v_perm_b32 v94, v94, v17, s62
    v_perm_b32 v95, v95, v17, s63
    s_mov_b32 s12, 18432
    buffer_store_dwordx4 v[92:95], v11, s[52:55], s12 offen sc1
    s_endpgm
K_END:
    s_endpgm
CODE_END:
.section .rodata,"a"
.p2align 6
.amdhsa_kernel k1_kernel
  .amdhsa_next_free_vgpr 168
  .amdhsa_next_free_sgpr 102
  .amdhsa_accum_offset 168
  .amdhsa_group_segment_fixed_size 0
  .amdhsa_kernarg_size 144
  .amdhsa_user_sgpr_count 2
  .amdhsa_user_sgpr_kernarg_segment_ptr 1
  .amdhsa_system_sgpr_workgroup_id_x 1
.end_amdhsa_kernel
```
